```python
import torch

def _softmax(x, axis=-1):
    return torch.softmax(x, dim=axis)
def _gelu(x):
    return torch.nn.functional.gelu(x, approximate="tanh")
def _silu(x):
    return torch.nn.functional.silu(x)
def _sigmoid(x):
    return torch.sigmoid(x)
def _layernorm(x, axis=-1, eps=1e-5):
    m = x.mean(dim=axis, keepdim=True)
    v = x.var(dim=axis, keepdim=True, unbiased=False)
    return (x - m) / torch.sqrt(v + eps)
def _scatter_add(tgt, idx, src, axis=0):
    return tgt.clone().index_add_(axis, idx, src)
def _segment_sum(src, seg, n):
    out = torch.zeros((n,) + src.shape[1:], dtype=src.dtype)
    return out.index_add_(0, seg, src)
def _pad(x, pw):
    flat = tuple(v for pair in reversed(pw) for v in pair)
    return torch.nn.functional.pad(x, flat)

kernel_name = 'standalone__mha_block_cached__near_ridge'

def setup_inputs():

    _w = (lambda a: (lambda t: t.to(torch.bfloat16) if t.is_floating_point() else t)(torch.as_tensor(a)))
    B, Sq, D = 8, 240, 640
    H, Sk, Dh = 32, 1024, 192
    return {
        "x": _w((lambda *s: torch.randn(*s, dtype=torch.bfloat16) * 0.8)(B, Sq, D)),
        "k_cache": _w((lambda *s: torch.randn(*s, dtype=torch.bfloat16) * 0.8)(B, H, Sk, Dh)),
        "v_cache": _w((lambda *s: torch.randn(*s, dtype=torch.bfloat16) * 0.05)(B, H, Sk, Dh)),
        "wq": _w((lambda *s: torch.randn(*s, dtype=torch.bfloat16) * 0.8)(D, H * Dh) * (D ** -0.5)),
        "wo": _w((lambda *s: torch.randn(*s, dtype=torch.bfloat16) * 0.05)(H * Dh, D) * ((H * Dh) ** -0.5)),
    }

def reference(x, k_cache, v_cache, wq, wo):
    B, Sq, D = x.shape
    H, Dh = 32, 192
    q = (lambda x, *d: x.permute(*d))((x @ wq).reshape(B, Sq, H, Dh), 0, 2, 1, 3)
    scores = torch.einsum("bhqd,bhkd->bhqk", q, k_cache) * (Dh ** -0.5)
    p = _softmax(scores, axis=-1)
    o = torch.einsum("bhqk,bhkd->bhqd", p, v_cache)
    return (lambda x, *d: x.permute(*d))(o, 0, 2, 1, 3).reshape(B, Sq, H * Dh) @ wo
```

```asm
; @launch grid=(256,1,1) block=(256,1,1) lds=163840
.amdgcn_target "amdgcn-amd-amdhsa--gfx950"
.macro mma a:vararg
v_mfma_f32_16x16x32_bf16 \a
.endm
.macro ldt a:vararg
ds_read_b64_tr_b16 \a
.endm
.macro cvt a:vararg
v_cvt_pk_bf16_f32 \a
.endm
.macro ard a:vararg
v_accvgpr_read_b32 \a
.endm
.macro awr a:vararg
v_accvgpr_write_b32 \a
.endm
.macro bld a:vararg
buffer_load_dwordx4 \a
.endm
.macro ldq a:vararg
ds_read_b128 \a
.endm
.text
.globl standalone__mha_block_cached__near_ridge_kernel
.p2align 8
.type standalone__mha_block_cached__near_ridge_kernel,@function
standalone__mha_block_cached__near_ridge_kernel:
s_cmp_ge_u32 s2, 256
s_cbranch_scc1 L_exit
s_load_dwordx16 s[64:79], s[0:1], 0
s_lshr_b32 s31, s2, 3
s_getpc_b64 s[44:45]
L_pc:
s_add_u32 s44, s44, L_w0b-L_pc
s_addc_u32 s45, s45, 0
s_mul_i32 s42, s31, ((L_hot_end-L_w0b+4095)/4096)
v_min_u32 v60, ((L_hot_end-L_w0b+4095)/4096)-1, v0
v_add_lshl_u32 v46, v60, s42, 7
v_min_u32 v60, 7, v0
s_lshl_b32 s42, s31, 9
v_lshrrev_b32 v61, 2, v60
v_mul_u32_u24 v61, L_w3b-L_w0b-512, v61
v_lshlrev_b32 v60, 7, v60
v_add3_u32 v60, v60, v61, s42
global_load_dword v19, v60, s[44:45]
v_lshrrev_b32 v61, 6, v0
v_and_b32 v1, 63, v0
v_readfirstlane_b32 s24, v61
s_and_b32 s25, s31, 7
s_lshr_b32 s42, s31, 3
s_and_b32 s26, s2, 7
s_lshl_b32 s26, s26, 2
s_add_u32 s26, s26, s42
v_add_u32 v60, 0, v1
v_mul_u32_u24 v61, 2731, v60
v_lshrrev_b32 v61, 16, v61
v_and_b32 v62, 6, v61
v_xor_b32 v63, v1, v62
v_lshlrev_b32 v8, 4, v63
v_and_b32 v62, 4, v61
v_mul_u32_u24 v62, 12288, v62
v_mul_u32_u24 v61, 11904, v61
v_add3_u32 v48, v62, v61, v8
v_add_u32 v60, 64, v1
v_mul_u32_u24 v61, 2731, v60
v_lshrrev_b32 v61, 16, v61
v_and_b32 v62, 6, v61
v_xor_b32 v63, v1, v62
v_lshlrev_b32 v9, 4, v63
v_and_b32 v62, 4, v61
v_mul_u32_u24 v62, 12288, v62
v_mul_u32_u24 v61, 11904, v61
v_add3_u32 v49, v62, v61, v9
v_add_u32 v60, 128, v1
v_mul_u32_u24 v61, 2731, v60
v_lshrrev_b32 v61, 16, v61
v_and_b32 v62, 6, v61
v_xor_b32 v63, v1, v62
v_lshlrev_b32 v10, 4, v63
v_and_b32 v62, 4, v61
v_mul_u32_u24 v62, 12288, v62
v_mul_u32_u24 v61, 11904, v61
v_add3_u32 v50, v62, v61, v10
v_lshrrev_b32 v60, 3, v1
v_and_b32 v62, 6, v60
v_xor_b32 v61, v1, v62
v_lshlrev_b32 v61, 4, v61
v_mul_u32_u24 v60, 1152, v60
v_add_u32 v51, v60, v61
s_lshl_b32 s27, s24, 13
s_add_u32 s27, s27, 49152
s_cmp_eq_u32 s24, 3
s_cselect_b32 s27, 43008, s27
s_mul_i32 s28, s24, 81920
s_and_b32 s31, s24, 1
s_lshl_b32 s31, s31, 4
s_lshr_b32 s42, s24, 1
s_lshl_b32 s42, s42, 2
s_add_u32 s31, s31, s42
s_mul_i32 s29, s31, 12288
s_mul_i32 s30, s24, 3072
s_add_u32 s30, s30, 110592
s_mul_i32 s31, s25, 307200
s_mul_i32 s42, s26, 384
s_mov_b32 s6, 307200
s_mov_b32 s7, 131072
s_sub_u32 s18, 7864320, s42
s_mov_b32 s19, 131072
s_cmp_eq_u32 s24, 3
s_cbranch_scc1 L_w3
L_w0:
s_waitcnt lgkmcnt(0)
s_add_u32 s16, s70, s42
s_addc_u32 s17, s71, 0
s_add_u32 s4, s64, s31
s_addc_u32 s5, s65, 0
s_add_u32 m0, s30, 0
s_add_u32 s31, s29, 0
bld v48,s[16:19],s31 offen lds
bld v49,s[16:19],s31 offen offset:1024 lds
bld v50,s[16:19],s31 offen offset:2048 lds
s_add_u32 m0, s27, 0
s_add_u32 s31, s28, 0
bld v51,s[4:7],s31 offen lds
s_add_u32 s31, s28, 9216
bld v51,s[4:7],s31 offen offset:1024 lds
s_add_u32 m0, s27, 2048
s_add_u32 s31, s28, 20480
bld v51,s[4:7],s31 offen lds
s_add_u32 s31, s28, 29696
bld v51,s[4:7],s31 offen offset:1024 lds
v_and_b32 v60, 15, v1
v_lshrrev_b32 v61, 4, v1
v_and_b32 v62, 6, v60
v_xor_b32 v61, v61, v62
v_lshlrev_b32 v61, 4, v61
v_mul_u32_u24 v62, 384, v60
v_add_u32 v2, v62, v61
v_lshlrev_b32 v62, 7, v60
v_add3_u32 v52, v62, v61, s27
v_xor_b32 v53, 64, v52
v_lshrrev_b32 v60, 2, v1
v_and_b32 v61, 3, v1
v_lshlrev_b32 v61, 3, v61
v_mul_u32_u24 v62, 384, v60
v_and_b32 v63, 6, v60
v_lshlrev_b32 v63, 4, v63
v_add3_u32 v63, v63, v62, v61
v_add_u32 v54, 110592, v63
v_subrev_u32 v4, 24576, v54
v_and_b32 v61, 3, v1
v_and_b32 v63, 6, v60
v_xor_b32 v61, v61, v63
v_lshl_add_u32 v61, v61, 4, v62
v_add_u32 v54, 110592, v61
v_xor_b32 v55, 64, v54
s_add_u32 m0, s27, 4096
s_add_u32 s31, s28, 40960
bld v51,s[4:7],s31 offen lds
s_add_u32 s31, s28, 50176
bld v51,s[4:7],s31 offen offset:1024 lds
s_add_u32 m0, s27, 6144
s_add_u32 s31, s28, 61440
bld v51,s[4:7],s31 offen lds
s_add_u32 s31, s28, 70656
bld v51,s[4:7],s31 offen offset:1024 lds
s_add_u32 m0, s30, 12288
s_add_u32 s31, s29, 393216
bld v48,s[16:19],s31 offen lds
bld v49,s[16:19],s31 offen offset:1024 lds
bld v50,s[16:19],s31 offen offset:2048 lds
s_branch L_w0b
L_w3:
v_mov_b32 v63, 2147483632
v_cmp_le_u32 vcc, 12, v1
v_lshlrev_b32 v60, 7, v1
v_add_u32 v61, 10752, v60
v_cndmask_b32 v60, v60, v61, vcc
s_lshr_b32 s3, s2, 3
s_mul_i32 s3, s3, 24576
s_and_b32 s47, s26, 3
s_mul_i32 s47, s47, 384
s_sub_u32 s3, s3, s47
s_add_u32 s3, s3, 12288
v_cmp_gt_u32 vcc, 24, v1
v_add_u32 v60, s3, v60
s_and_b32 s3, s26, 31
s_mul_i32 s3, s3, 15
s_lshr_b32 s3, s3, 1
v_cndmask_b32 v58, v63, v60, vcc
v_add_u32 v61, s3, v1
v_cmp_gt_u32 vcc, 8, v1
v_mul_u32_u24 v61, 1280, v61
s_lshr_b32 s3, s26, 2
s_mul_i32 s3, s3, 7680
v_cndmask_b32 v59, v63, v61, vcc
s_waitcnt lgkmcnt(0)
s_add_u32 s16, s70, s42
s_addc_u32 s17, s71, 0
s_add_u32 s4, s64, s31
s_addc_u32 s5, s65, 0
s_mov_b32 s31, 774144
buffer_load_dword v45, v58, s[16:19], s31 offen
s_mov_b32 s31, 128
buffer_load_dword v45, v59, s[4:7], s31 offen
s_mov_b32 s31, 1560576
buffer_load_dword v45, v58, s[16:19], s31 offen
s_mov_b32 s31, 256
buffer_load_dword v45, v59, s[4:7], s31 offen
s_mov_b32 s31, 2347008
buffer_load_dword v45, v58, s[16:19], s31 offen
s_mov_b32 s31, 384
buffer_load_dword v45, v59, s[4:7], s31 offen
s_add_u32 m0, s30, 0
s_add_u32 s31, s29, 0
bld v48,s[16:19],s31 offen lds
bld v49,s[16:19],s31 offen offset:1024 lds
bld v50,s[16:19],s31 offen offset:2048 lds
s_add_u32 m0, s27, 36864
s_add_u32 s31, s28, 0
bld v51,s[4:7],s31 offen lds
s_add_u32 s31, s28, 9216
bld v51,s[4:7],s31 offen offset:1024 lds
s_add_u32 m0, s27, 38912
s_add_u32 s31, s28, 20480
bld v51,s[4:7],s31 offen lds
s_add_u32 s31, s28, 29696
bld v51,s[4:7],s31 offen offset:1024 lds
v_and_b32 v60, 15, v1
v_lshrrev_b32 v61, 4, v1
v_and_b32 v62, 6, v60
v_xor_b32 v61, v61, v62
v_lshlrev_b32 v61, 4, v61
v_mul_u32_u24 v62, 384, v60
v_add_u32 v2, v62, v61
v_lshlrev_b32 v62, 7, v60
v_add3_u32 v52, v62, v61, s27
v_xor_b32 v53, 64, v52
v_lshrrev_b32 v60, 2, v1
v_and_b32 v61, 3, v1
v_lshlrev_b32 v61, 3, v61
v_mul_u32_u24 v62, 384, v60
v_and_b32 v63, 6, v60
v_lshlrev_b32 v63, 4, v63
v_add3_u32 v63, v63, v62, v61
v_add_u32 v54, 110592, v63
v_subrev_u32 v4, 24576, v54
v_and_b32 v61, 3, v1
v_and_b32 v63, 6, v60
v_xor_b32 v61, v61, v63
v_lshl_add_u32 v61, v61, 4, v62
v_add_u32 v54, 110592, v61
v_xor_b32 v55, 64, v54
s_add_u32 m0, s27, 40960
s_add_u32 s31, s28, 40960
bld v51,s[4:7],s31 offen lds
s_add_u32 s31, s28, 50176
bld v51,s[4:7],s31 offen offset:1024 lds
s_add_u32 m0, s30, 12288
s_add_u32 s31, s29, 393216
bld v48,s[16:19],s31 offen lds
bld v49,s[16:19],s31 offen offset:1024 lds
bld v50,s[16:19],s31 offen offset:2048 lds
s_lshr_b32 s3, s26, 2
s_mul_i32 s3, s3, 7680
v_mov_b32 v63, 2147483632
s_lshr_b32 s47, s2, 3
s_mul_i32 s47, s47, 240
s_add_u32 s3, s3, s47
v_cmp_gt_u32 vcc, 30, v1
v_add_lshl_u32 v60, v1, s3, 7
s_mov_b32 s48, s72
s_mov_b32 s49, s73
s_mov_b32 s50, 7864320
s_mov_b32 s51, 131072
v_cndmask_b32 v31, v63, v60, vcc
s_lshl_b32 s3, s25, 5
s_add_u32 s3, s3, s26
s_mul_i32 s3, s3, 393216
s_add_u32 s8, s66, s3
s_addc_u32 s9, s67, 0
s_mov_b32 s10, 393216
s_mov_b32 s11, 131072
s_add_u32 s12, s68, s3
s_addc_u32 s13, s69, 0
s_mov_b32 s14, 393216
s_mov_b32 s15, 131072
s_lshr_b32 s3, s2, 3
s_mul_i32 s3, s3, ((L_hot_end-L_w0b+4095)/4096)
v_min_u32 v27, ((L_hot_end-L_w0b+4095)/4096)-1, v1
v_add_lshl_u32 v27, v27, s3, 7
s_branch L_w3b
L_exit:
s_endpgm
L_w0_tr1:
s_call_b64 s[0:1], L_w0_rare1
s_branch L_w0_tr1_ret
L_w0_tr2:
s_call_b64 s[0:1], L_w0_rare2
s_branch L_w0_tr2_ret
L_w0_tr3:
s_call_b64 s[0:1], L_w0_rare3
s_branch L_w0_tr3_ret
L_w0_tr4:
s_call_b64 s[0:1], L_w0_rare0
s_branch L_w0_tr4_ret
L_w0_tr5:
s_call_b64 s[0:1], L_w0_rare1
s_branch L_w0_tr5_ret
L_w0_tr6:
s_call_b64 s[0:1], L_w0_rare2
s_branch L_w0_tr6_ret
L_w0_tr7:
s_call_b64 s[0:1], L_w0_rare3
s_branch L_w0_tr7_ret
L_w0_rare0:
s_nop 15
s_mov_b32 s47, 4294901760
v_max3_f32 v41, v160, v161, v162
v_max3_f32 v42, v164, v165, v166
v_max3_f32 v43, v168, v169, v170
v_max3_f32 v44, v172, v173, v174
v_max3_f32 v41, v41, v163, v176
v_max3_f32 v42, v42, v167, v180
v_max3_f32 v43, v43, v171, v184
v_max3_f32 v44, v44, v175, v188
v_max3_f32 v41, v41, v177, v178
v_max3_f32 v42, v42, v181, v182
v_max3_f32 v43, v43, v185, v186
v_max3_f32 v44, v44, v189, v190
v_max_f32 v41, v41, v179
v_max_f32 v42, v42, v183
v_max_f32 v43, v43, v187
v_max_f32 v44, v44, v191
v_mov_b32 v32, v41
v_mov_b32 v33, v42
v_mov_b32 v34, v43
v_mov_b32 v35, v44
v_permlane32_swap_b32 v41, v32
v_permlane32_swap_b32 v42, v33
v_permlane32_swap_b32 v43, v34
v_permlane32_swap_b32 v44, v35
v_max_f32 v41, v41, v32
v_max_f32 v42, v42, v33
v_max_f32 v43, v43, v34
v_max_f32 v44, v44, v35
v_mov_b32 v32, v41
v_mov_b32 v33, v42
v_mov_b32 v34, v43
v_mov_b32 v35, v44
v_permlane16_swap_b32 v41, v32
v_permlane16_swap_b32 v42, v33
v_permlane16_swap_b32 v43, v34
v_permlane16_swap_b32 v44, v35
v_max_f32 v41, v41, v32
v_max_f32 v42, v42, v33
v_max_f32 v43, v43, v34
v_max_f32 v44, v44, v35
v_max_f32 v41, 0, v41
v_max_f32 v42, 0, v42
v_max_f32 v43, 0, v43
v_max_f32 v44, 0, v44
v_ceil_f32 v41, v41
v_ceil_f32 v42, v42
v_ceil_f32 v43, v43
v_ceil_f32 v44, v44
v_exp_f32 v36, -v41
v_exp_f32 v37, -v42
v_exp_f32 v38, -v43
v_exp_f32 v39, -v44
v_sub_f32 v160, v160, v41
v_sub_f32 v161, v161, v41
v_sub_f32 v162, v162, v41
v_sub_f32 v163, v163, v41
v_sub_f32 v176, v176, v41
v_sub_f32 v177, v177, v41
v_sub_f32 v178, v178, v41
v_sub_f32 v179, v179, v41
v_sub_f32 v224, v224, v41
v_sub_f32 v225, v225, v41
v_sub_f32 v226, v226, v41
v_sub_f32 v227, v227, v41
v_mul_f32 v28, v28, v36
ard v192,a0
ard v193,a1
ard v194,a2
ard v195,a3
ard v196,a16
ard v197,a17
ard v198,a18
ard v199,a19
v_mul_f32 v192, v192, v36
v_mul_f32 v193, v193, v36
v_mul_f32 v194, v194, v36
v_mul_f32 v195, v195, v36
v_mul_f32 v196, v196, v36
v_mul_f32 v197, v197, v36
v_mul_f32 v198, v198, v36
v_mul_f32 v199, v199, v36
awr a0,v192
awr a1,v193
awr a2,v194
awr a3,v195
awr a16,v196
awr a17,v197
awr a18,v198
awr a19,v199
ard v192,a32
ard v193,a33
ard v194,a34
ard v195,a35
ard v196,a48
ard v197,a49
ard v198,a50
ard v199,a51
v_mul_f32 v192, v192, v36
v_mul_f32 v193, v193, v36
v_mul_f32 v194, v194, v36
v_mul_f32 v195, v195, v36
v_mul_f32 v196, v196, v36
v_mul_f32 v197, v197, v36
v_mul_f32 v198, v198, v36
v_mul_f32 v199, v199, v36
awr a32,v192
awr a33,v193
awr a34,v194
awr a35,v195
awr a48,v196
awr a49,v197
awr a50,v198
awr a51,v199
ard v192,a64
ard v193,a65
ard v194,a66
ard v195,a67
ard v196,a80
ard v197,a81
ard v198,a82
ard v199,a83
v_mul_f32 v192, v192, v36
v_mul_f32 v193, v193, v36
v_mul_f32 v194, v194, v36
v_mul_f32 v195, v195, v36
v_mul_f32 v196, v196, v36
v_mul_f32 v197, v197, v36
v_mul_f32 v198, v198, v36
v_mul_f32 v199, v199, v36
awr a64,v192
awr a65,v193
awr a66,v194
awr a67,v195
awr a80,v196
awr a81,v197
awr a82,v198
awr a83,v199
ard v192,a96
ard v193,a97
ard v194,a98
ard v195,a99
ard v196,a112
ard v197,a113
ard v198,a114
ard v199,a115
v_mul_f32 v192, v192, v36
v_mul_f32 v193, v193, v36
v_mul_f32 v194, v194, v36
v_mul_f32 v195, v195, v36
v_mul_f32 v196, v196, v36
v_mul_f32 v197, v197, v36
v_mul_f32 v198, v198, v36
v_mul_f32 v199, v199, v36
awr a96,v192
awr a97,v193
awr a98,v194
awr a99,v195
awr a112,v196
awr a113,v197
awr a114,v198
awr a115,v199
ard v192,a128
ard v193,a129
ard v194,a130
ard v195,a131
ard v196,a144
ard v197,a145
ard v198,a146
ard v199,a147
v_mul_f32 v192, v192, v36
v_mul_f32 v193, v193, v36
v_mul_f32 v194, v194, v36
v_mul_f32 v195, v195, v36
v_mul_f32 v196, v196, v36
v_mul_f32 v197, v197, v36
v_mul_f32 v198, v198, v36
v_mul_f32 v199, v199, v36
awr a128,v192
awr a129,v193
awr a130,v194
awr a131,v195
awr a144,v196
awr a145,v197
awr a146,v198
awr a147,v199
ard v192,a160
ard v193,a161
ard v194,a162
ard v195,a163
ard v196,a176
ard v197,a177
ard v198,a178
ard v199,a179
v_mul_f32 v192, v192, v36
v_mul_f32 v193, v193, v36
v_mul_f32 v194, v194, v36
v_mul_f32 v195, v195, v36
v_mul_f32 v196, v196, v36
v_mul_f32 v197, v197, v36
v_mul_f32 v198, v198, v36
v_mul_f32 v199, v199, v36
awr a160,v192
awr a161,v193
awr a162,v194
awr a163,v195
awr a176,v196
awr a177,v197
awr a178,v198
awr a179,v199
v_lshlrev_b32 v192, 16, v240
v_and_b32 v193, s47, v240
v_lshlrev_b32 v194, 16, v241
v_and_b32 v195, s47, v241
v_lshlrev_b32 v196, 16, v242
v_and_b32 v197, s47, v242
v_lshlrev_b32 v198, 16, v243
v_and_b32 v199, s47, v243
v_mul_f32 v192, v192, v36
v_mul_f32 v193, v193, v36
v_mul_f32 v194, v194, v36
v_mul_f32 v195, v195, v36
v_mul_f32 v196, v196, v36
v_mul_f32 v197, v197, v36
v_mul_f32 v198, v198, v36
v_mul_f32 v199, v199, v36
cvt v240,v192,v193
cvt v241,v194,v195
cvt v242,v196,v197
cvt v243,v198,v199
v_lshlrev_b32 v192, 16, v48
v_and_b32 v193, s47, v48
v_lshlrev_b32 v194, 16, v49
v_and_b32 v195, s47, v49
v_lshlrev_b32 v196, 16, v50
v_and_b32 v197, s47, v50
v_lshlrev_b32 v198, 16, v51
v_and_b32 v199, s47, v51
v_mul_f32 v192, v192, v36
v_mul_f32 v193, v193, v36
v_mul_f32 v194, v194, v36
v_mul_f32 v195, v195, v36
v_mul_f32 v196, v196, v36
v_mul_f32 v197, v197, v36
v_mul_f32 v198, v198, v36
v_mul_f32 v199, v199, v36
cvt v48,v192,v193
cvt v49,v194,v195
cvt v50,v196,v197
cvt v51,v198,v199
v_sub_f32 v164, v164, v42
v_sub_f32 v165, v165, v42
v_sub_f32 v166, v166, v42
v_sub_f32 v167, v167, v42
v_sub_f32 v180, v180, v42
v_sub_f32 v181, v181, v42
v_sub_f32 v182, v182, v42
v_sub_f32 v183, v183, v42
v_sub_f32 v228, v228, v42
v_sub_f32 v229, v229, v42
v_sub_f32 v230, v230, v42
v_sub_f32 v231, v231, v42
v_mul_f32 v29, v29, v37
ard v192,a4
ard v193,a5
ard v194,a6
ard v195,a7
ard v196,a20
ard v197,a21
ard v198,a22
ard v199,a23
v_mul_f32 v192, v192, v37
v_mul_f32 v193, v193, v37
v_mul_f32 v194, v194, v37
v_mul_f32 v195, v195, v37
v_mul_f32 v196, v196, v37
v_mul_f32 v197, v197, v37
v_mul_f32 v198, v198, v37
v_mul_f32 v199, v199, v37
awr a4,v192
awr a5,v193
awr a6,v194
awr a7,v195
awr a20,v196
awr a21,v197
awr a22,v198
awr a23,v199
ard v192,a36
ard v193,a37
ard v194,a38
ard v195,a39
ard v196,a52
ard v197,a53
ard v198,a54
ard v199,a55
v_mul_f32 v192, v192, v37
v_mul_f32 v193, v193, v37
v_mul_f32 v194, v194, v37
v_mul_f32 v195, v195, v37
v_mul_f32 v196, v196, v37
v_mul_f32 v197, v197, v37
v_mul_f32 v198, v198, v37
v_mul_f32 v199, v199, v37
awr a36,v192
awr a37,v193
awr a38,v194
awr a39,v195
awr a52,v196
awr a53,v197
awr a54,v198
awr a55,v199
ard v192,a68
ard v193,a69
ard v194,a70
ard v195,a71
ard v196,a84
ard v197,a85
ard v198,a86
ard v199,a87
v_mul_f32 v192, v192, v37
v_mul_f32 v193, v193, v37
v_mul_f32 v194, v194, v37
v_mul_f32 v195, v195, v37
v_mul_f32 v196, v196, v37
v_mul_f32 v197, v197, v37
v_mul_f32 v198, v198, v37
v_mul_f32 v199, v199, v37
awr a68,v192
awr a69,v193
awr a70,v194
awr a71,v195
awr a84,v196
awr a85,v197
awr a86,v198
awr a87,v199
ard v192,a100
ard v193,a101
ard v194,a102
ard v195,a103
ard v196,a116
ard v197,a117
ard v198,a118
ard v199,a119
v_mul_f32 v192, v192, v37
v_mul_f32 v193, v193, v37
v_mul_f32 v194, v194, v37
v_mul_f32 v195, v195, v37
v_mul_f32 v196, v196, v37
v_mul_f32 v197, v197, v37
v_mul_f32 v198, v198, v37
v_mul_f32 v199, v199, v37
awr a100,v192
awr a101,v193
awr a102,v194
awr a103,v195
awr a116,v196
awr a117,v197
awr a118,v198
awr a119,v199
ard v192,a132
ard v193,a133
ard v194,a134
ard v195,a135
ard v196,a148
ard v197,a149
ard v198,a150
ard v199,a151
v_mul_f32 v192, v192, v37
v_mul_f32 v193, v193, v37
v_mul_f32 v194, v194, v37
v_mul_f32 v195, v195, v37
v_mul_f32 v196, v196, v37
v_mul_f32 v197, v197, v37
v_mul_f32 v198, v198, v37
v_mul_f32 v199, v199, v37
awr a132,v192
awr a133,v193
awr a134,v194
awr a135,v195
awr a148,v196
awr a149,v197
awr a150,v198
awr a151,v199
ard v192,a164
ard v193,a165
ard v194,a166
ard v195,a167
ard v196,a180
ard v197,a181
ard v198,a182
ard v199,a183
v_mul_f32 v192, v192, v37
v_mul_f32 v193, v193, v37
v_mul_f32 v194, v194, v37
v_mul_f32 v195, v195, v37
v_mul_f32 v196, v196, v37
v_mul_f32 v197, v197, v37
v_mul_f32 v198, v198, v37
v_mul_f32 v199, v199, v37
awr a164,v192
awr a165,v193
awr a166,v194
awr a167,v195
awr a180,v196
awr a181,v197
awr a182,v198
awr a183,v199
v_lshlrev_b32 v192, 16, v244
v_and_b32 v193, s47, v244
v_lshlrev_b32 v194, 16, v245
v_and_b32 v195, s47, v245
v_lshlrev_b32 v196, 16, v246
v_and_b32 v197, s47, v246
v_lshlrev_b32 v198, 16, v247
v_and_b32 v199, s47, v247
v_mul_f32 v192, v192, v37
v_mul_f32 v193, v193, v37
v_mul_f32 v194, v194, v37
v_mul_f32 v195, v195, v37
v_mul_f32 v196, v196, v37
v_mul_f32 v197, v197, v37
v_mul_f32 v198, v198, v37
v_mul_f32 v199, v199, v37
cvt v244,v192,v193
cvt v245,v194,v195
cvt v246,v196,v197
cvt v247,v198,v199
v_lshlrev_b32 v192, 16, v52
v_and_b32 v193, s47, v52
v_lshlrev_b32 v194, 16, v53
v_and_b32 v195, s47, v53
v_lshlrev_b32 v196, 16, v54
v_and_b32 v197, s47, v54
v_lshlrev_b32 v198, 16, v55
v_and_b32 v199, s47, v55
v_mul_f32 v192, v192, v37
v_mul_f32 v193, v193, v37
v_mul_f32 v194, v194, v37
v_mul_f32 v195, v195, v37
v_mul_f32 v196, v196, v37
v_mul_f32 v197, v197, v37
v_mul_f32 v198, v198, v37
v_mul_f32 v199, v199, v37
cvt v52,v192,v193
cvt v53,v194,v195
cvt v54,v196,v197
cvt v55,v198,v199
v_sub_f32 v168, v168, v43
v_sub_f32 v169, v169, v43
v_sub_f32 v170, v170, v43
v_sub_f32 v171, v171, v43
v_sub_f32 v184, v184, v43
v_sub_f32 v185, v185, v43
v_sub_f32 v186, v186, v43
v_sub_f32 v187, v187, v43
v_sub_f32 v232, v232, v43
v_sub_f32 v233, v233, v43
v_sub_f32 v234, v234, v43
v_sub_f32 v235, v235, v43
v_mul_f32 v30, v30, v38
ard v192,a8
ard v193,a9
ard v194,a10
ard v195,a11
ard v196,a24
ard v197,a25
ard v198,a26
ard v199,a27
v_mul_f32 v192, v192, v38
v_mul_f32 v193, v193, v38
v_mul_f32 v194, v194, v38
v_mul_f32 v195, v195, v38
v_mul_f32 v196, v196, v38
v_mul_f32 v197, v197, v38
v_mul_f32 v198, v198, v38
v_mul_f32 v199, v199, v38
awr a8,v192
awr a9,v193
awr a10,v194
awr a11,v195
awr a24,v196
awr a25,v197
awr a26,v198
awr a27,v199
ard v192,a40
ard v193,a41
ard v194,a42
ard v195,a43
ard v196,a56
ard v197,a57
ard v198,a58
ard v199,a59
v_mul_f32 v192, v192, v38
v_mul_f32 v193, v193, v38
v_mul_f32 v194, v194, v38
v_mul_f32 v195, v195, v38
v_mul_f32 v196, v196, v38
v_mul_f32 v197, v197, v38
v_mul_f32 v198, v198, v38
v_mul_f32 v199, v199, v38
awr a40,v192
awr a41,v193
awr a42,v194
awr a43,v195
awr a56,v196
awr a57,v197
awr a58,v198
awr a59,v199
ard v192,a72
ard v193,a73
ard v194,a74
ard v195,a75
ard v196,a88
ard v197,a89
ard v198,a90
ard v199,a91
v_mul_f32 v192, v192, v38
v_mul_f32 v193, v193, v38
v_mul_f32 v194, v194, v38
v_mul_f32 v195, v195, v38
v_mul_f32 v196, v196, v38
v_mul_f32 v197, v197, v38
v_mul_f32 v198, v198, v38
v_mul_f32 v199, v199, v38
awr a72,v192
awr a73,v193
awr a74,v194
awr a75,v195
awr a88,v196
awr a89,v197
awr a90,v198
awr a91,v199
ard v192,a104
ard v193,a105
ard v194,a106
ard v195,a107
ard v196,a120
ard v197,a121
ard v198,a122
ard v199,a123
v_mul_f32 v192, v192, v38
v_mul_f32 v193, v193, v38
v_mul_f32 v194, v194, v38
v_mul_f32 v195, v195, v38
v_mul_f32 v196, v196, v38
v_mul_f32 v197, v197, v38
v_mul_f32 v198, v198, v38
v_mul_f32 v199, v199, v38
awr a104,v192
awr a105,v193
awr a106,v194
awr a107,v195
awr a120,v196
awr a121,v197
awr a122,v198
awr a123,v199
ard v192,a136
ard v193,a137
ard v194,a138
ard v195,a139
ard v196,a152
ard v197,a153
ard v198,a154
ard v199,a155
v_mul_f32 v192, v192, v38
v_mul_f32 v193, v193, v38
v_mul_f32 v194, v194, v38
v_mul_f32 v195, v195, v38
v_mul_f32 v196, v196, v38
v_mul_f32 v197, v197, v38
v_mul_f32 v198, v198, v38
v_mul_f32 v199, v199, v38
awr a136,v192
awr a137,v193
awr a138,v194
awr a139,v195
awr a152,v196
awr a153,v197
awr a154,v198
awr a155,v199
ard v192,a168
ard v193,a169
ard v194,a170
ard v195,a171
ard v196,a184
ard v197,a185
ard v198,a186
ard v199,a187
v_mul_f32 v192, v192, v38
v_mul_f32 v193, v193, v38
v_mul_f32 v194, v194, v38
v_mul_f32 v195, v195, v38
v_mul_f32 v196, v196, v38
v_mul_f32 v197, v197, v38
v_mul_f32 v198, v198, v38
v_mul_f32 v199, v199, v38
awr a168,v192
awr a169,v193
awr a170,v194
awr a171,v195
awr a184,v196
awr a185,v197
awr a186,v198
awr a187,v199
v_lshlrev_b32 v192, 16, v248
v_and_b32 v193, s47, v248
v_lshlrev_b32 v194, 16, v249
v_and_b32 v195, s47, v249
v_lshlrev_b32 v196, 16, v250
v_and_b32 v197, s47, v250
v_lshlrev_b32 v198, 16, v251
v_and_b32 v199, s47, v251
v_mul_f32 v192, v192, v38
v_mul_f32 v193, v193, v38
v_mul_f32 v194, v194, v38
v_mul_f32 v195, v195, v38
v_mul_f32 v196, v196, v38
v_mul_f32 v197, v197, v38
v_mul_f32 v198, v198, v38
v_mul_f32 v199, v199, v38
cvt v248,v192,v193
cvt v249,v194,v195
cvt v250,v196,v197
cvt v251,v198,v199
v_lshlrev_b32 v192, 16, v56
v_and_b32 v193, s47, v56
v_lshlrev_b32 v194, 16, v57
v_and_b32 v195, s47, v57
v_lshlrev_b32 v196, 16, v58
v_and_b32 v197, s47, v58
v_lshlrev_b32 v198, 16, v59
v_and_b32 v199, s47, v59
v_mul_f32 v192, v192, v38
v_mul_f32 v193, v193, v38
v_mul_f32 v194, v194, v38
v_mul_f32 v195, v195, v38
v_mul_f32 v196, v196, v38
v_mul_f32 v197, v197, v38
v_mul_f32 v198, v198, v38
v_mul_f32 v199, v199, v38
cvt v56,v192,v193
cvt v57,v194,v195
cvt v58,v196,v197
cvt v59,v198,v199
v_sub_f32 v172, v172, v44
v_sub_f32 v173, v173, v44
v_sub_f32 v174, v174, v44
v_sub_f32 v175, v175, v44
v_sub_f32 v188, v188, v44
v_sub_f32 v189, v189, v44
v_sub_f32 v190, v190, v44
v_sub_f32 v191, v191, v44
v_sub_f32 v236, v236, v44
v_sub_f32 v237, v237, v44
v_sub_f32 v238, v238, v44
v_sub_f32 v239, v239, v44
v_mul_f32 v31, v31, v39
ard v192,a12
ard v193,a13
ard v194,a14
ard v195,a15
ard v196,a28
ard v197,a29
ard v198,a30
ard v199,a31
v_mul_f32 v192, v192, v39
v_mul_f32 v193, v193, v39
v_mul_f32 v194, v194, v39
v_mul_f32 v195, v195, v39
v_mul_f32 v196, v196, v39
v_mul_f32 v197, v197, v39
v_mul_f32 v198, v198, v39
v_mul_f32 v199, v199, v39
awr a12,v192
awr a13,v193
awr a14,v194
awr a15,v195
awr a28,v196
awr a29,v197
awr a30,v198
awr a31,v199
ard v192,a44
ard v193,a45
ard v194,a46
ard v195,a47
ard v196,a60
ard v197,a61
ard v198,a62
ard v199,a63
v_mul_f32 v192, v192, v39
v_mul_f32 v193, v193, v39
v_mul_f32 v194, v194, v39
v_mul_f32 v195, v195, v39
v_mul_f32 v196, v196, v39
v_mul_f32 v197, v197, v39
v_mul_f32 v198, v198, v39
v_mul_f32 v199, v199, v39
awr a44,v192
awr a45,v193
awr a46,v194
awr a47,v195
awr a60,v196
awr a61,v197
awr a62,v198
awr a63,v199
ard v192,a76
ard v193,a77
ard v194,a78
ard v195,a79
ard v196,a92
ard v197,a93
ard v198,a94
ard v199,a95
v_mul_f32 v192, v192, v39
v_mul_f32 v193, v193, v39
v_mul_f32 v194, v194, v39
v_mul_f32 v195, v195, v39
v_mul_f32 v196, v196, v39
v_mul_f32 v197, v197, v39
v_mul_f32 v198, v198, v39
v_mul_f32 v199, v199, v39
awr a76,v192
awr a77,v193
awr a78,v194
awr a79,v195
awr a92,v196
awr a93,v197
awr a94,v198
awr a95,v199
ard v192,a108
ard v193,a109
ard v194,a110
ard v195,a111
ard v196,a124
ard v197,a125
ard v198,a126
ard v199,a127
v_mul_f32 v192, v192, v39
v_mul_f32 v193, v193, v39
v_mul_f32 v194, v194, v39
v_mul_f32 v195, v195, v39
v_mul_f32 v196, v196, v39
v_mul_f32 v197, v197, v39
v_mul_f32 v198, v198, v39
v_mul_f32 v199, v199, v39
awr a108,v192
awr a109,v193
awr a110,v194
awr a111,v195
awr a124,v196
awr a125,v197
awr a126,v198
awr a127,v199
ard v192,a140
ard v193,a141
ard v194,a142
ard v195,a143
ard v196,a156
ard v197,a157
ard v198,a158
ard v199,a159
v_mul_f32 v192, v192, v39
v_mul_f32 v193, v193, v39
v_mul_f32 v194, v194, v39
v_mul_f32 v195, v195, v39
v_mul_f32 v196, v196, v39
v_mul_f32 v197, v197, v39
v_mul_f32 v198, v198, v39
v_mul_f32 v199, v199, v39
awr a140,v192
awr a141,v193
awr a142,v194
awr a143,v195
awr a156,v196
awr a157,v197
awr a158,v198
awr a159,v199
ard v192,a172
ard v193,a173
ard v194,a174
ard v195,a175
ard v196,a188
ard v197,a189
ard v198,a190
ard v199,a191
v_mul_f32 v192, v192, v39
v_mul_f32 v193, v193, v39
v_mul_f32 v194, v194, v39
v_mul_f32 v195, v195, v39
v_mul_f32 v196, v196, v39
v_mul_f32 v197, v197, v39
v_mul_f32 v198, v198, v39
v_mul_f32 v199, v199, v39
awr a172,v192
awr a173,v193
awr a174,v194
awr a175,v195
awr a188,v196
awr a189,v197
awr a190,v198
awr a191,v199
v_lshlrev_b32 v192, 16, v252
v_and_b32 v193, s47, v252
v_lshlrev_b32 v194, 16, v253
v_and_b32 v195, s47, v253
v_lshlrev_b32 v196, 16, v254
v_and_b32 v197, s47, v254
v_lshlrev_b32 v198, 16, v255
v_and_b32 v199, s47, v255
v_mul_f32 v192, v192, v39
v_mul_f32 v193, v193, v39
v_mul_f32 v194, v194, v39
v_mul_f32 v195, v195, v39
v_mul_f32 v196, v196, v39
v_mul_f32 v197, v197, v39
v_mul_f32 v198, v198, v39
v_mul_f32 v199, v199, v39
cvt v252,v192,v193
cvt v253,v194,v195
cvt v254,v196,v197
cvt v255,v198,v199
v_lshlrev_b32 v192, 16, v60
v_and_b32 v193, s47, v60
v_lshlrev_b32 v194, 16, v61
v_and_b32 v195, s47, v61
v_lshlrev_b32 v196, 16, v62
v_and_b32 v197, s47, v62
v_lshlrev_b32 v198, 16, v63
v_and_b32 v199, s47, v63
v_mul_f32 v192, v192, v39
v_mul_f32 v193, v193, v39
v_mul_f32 v194, v194, v39
v_mul_f32 v195, v195, v39
v_mul_f32 v196, v196, v39
v_mul_f32 v197, v197, v39
v_mul_f32 v198, v198, v39
v_mul_f32 v199, v199, v39
cvt v60,v192,v193
cvt v61,v194,v195
cvt v62,v196,v197
cvt v63,v198,v199
v_exp_f32 v32, v160
v_exp_f32 v33, v161
v_exp_f32 v34, v162
v_exp_f32 v35, v163
v_add_f32 v24, v32, v33
cvt v192,v32,v33
v_add_f32 v24, v24, v34
cvt v193,v34,v35
v_add_f32 v24, v24, v35
v_exp_f32 v36, v164
v_exp_f32 v37, v165
v_exp_f32 v38, v166
v_exp_f32 v39, v167
v_add_f32 v25, v36, v37
cvt v196,v36,v37
v_add_f32 v25, v25, v38
cvt v197,v38,v39
v_add_f32 v25, v25, v39
v_exp_f32 v32, v168
v_exp_f32 v33, v169
v_exp_f32 v34, v170
v_exp_f32 v35, v171
v_add_f32 v26, v32, v33
cvt v200,v32,v33
v_add_f32 v26, v26, v34
cvt v201,v34,v35
v_add_f32 v26, v26, v35
v_exp_f32 v36, v172
v_exp_f32 v37, v173
v_exp_f32 v38, v174
v_exp_f32 v39, v175
v_add_f32 v27, v36, v37
cvt v204,v36,v37
v_add_f32 v27, v27, v38
cvt v205,v38,v39
v_add_f32 v27, v27, v39
v_exp_f32 v32, v176
v_exp_f32 v33, v177
v_exp_f32 v34, v178
v_exp_f32 v35, v179
v_add_f32 v24, v24, v32
cvt v194,v32,v33
v_add_f32 v24, v24, v33
v_add_f32 v24, v24, v34
cvt v195,v34,v35
v_add_f32 v24, v24, v35
v_exp_f32 v36, v180
v_exp_f32 v37, v181
v_exp_f32 v38, v182
v_exp_f32 v39, v183
v_add_f32 v25, v25, v36
cvt v198,v36,v37
v_add_f32 v25, v25, v37
v_add_f32 v25, v25, v38
cvt v199,v38,v39
v_add_f32 v25, v25, v39
v_exp_f32 v32, v184
v_exp_f32 v33, v185
v_exp_f32 v34, v186
v_exp_f32 v35, v187
v_add_f32 v26, v26, v32
cvt v202,v32,v33
v_add_f32 v26, v26, v33
v_add_f32 v26, v26, v34
cvt v203,v34,v35
v_add_f32 v26, v26, v35
v_exp_f32 v36, v188
v_exp_f32 v37, v189
v_exp_f32 v38, v190
v_exp_f32 v39, v191
v_add_f32 v27, v27, v36
cvt v206,v36,v37
v_add_f32 v27, v27, v37
v_add_f32 v27, v27, v38
cvt v207,v38,v39
v_add_f32 v27, v27, v39
s_nop 3
s_setpc_b64 s[0:1]
L_w0_rare1:
s_nop 15
s_mov_b32 s47, 4294901760
v_max3_f32 v41, v160, v161, v162
v_max3_f32 v42, v164, v165, v166
v_max3_f32 v43, v168, v169, v170
v_max3_f32 v44, v172, v173, v174
v_max3_f32 v41, v41, v163, v176
v_max3_f32 v42, v42, v167, v180
v_max3_f32 v43, v43, v171, v184
v_max3_f32 v44, v44, v175, v188
v_max3_f32 v41, v41, v177, v178
v_max3_f32 v42, v42, v181, v182
v_max3_f32 v43, v43, v185, v186
v_max3_f32 v44, v44, v189, v190
v_max_f32 v41, v41, v179
v_max_f32 v42, v42, v183
v_max_f32 v43, v43, v187
v_max_f32 v44, v44, v191
v_mov_b32 v32, v41
v_mov_b32 v33, v42
v_mov_b32 v34, v43
v_mov_b32 v35, v44
v_permlane32_swap_b32 v41, v32
v_permlane32_swap_b32 v42, v33
v_permlane32_swap_b32 v43, v34
v_permlane32_swap_b32 v44, v35
v_max_f32 v41, v41, v32
v_max_f32 v42, v42, v33
v_max_f32 v43, v43, v34
v_max_f32 v44, v44, v35
v_mov_b32 v32, v41
v_mov_b32 v33, v42
v_mov_b32 v34, v43
v_mov_b32 v35, v44
v_permlane16_swap_b32 v41, v32
v_permlane16_swap_b32 v42, v33
v_permlane16_swap_b32 v43, v34
v_permlane16_swap_b32 v44, v35
v_max_f32 v41, v41, v32
v_max_f32 v42, v42, v33
v_max_f32 v43, v43, v34
v_max_f32 v44, v44, v35
v_max_f32 v41, 0, v41
v_max_f32 v42, 0, v42
v_max_f32 v43, 0, v43
v_max_f32 v44, 0, v44
v_ceil_f32 v41, v41
v_ceil_f32 v42, v42
v_ceil_f32 v43, v43
v_ceil_f32 v44, v44
v_exp_f32 v36, -v41
v_exp_f32 v37, -v42
v_exp_f32 v38, -v43
v_exp_f32 v39, -v44
v_sub_f32 v160, v160, v41
v_sub_f32 v161, v161, v41
v_sub_f32 v162, v162, v41
v_sub_f32 v163, v163, v41
v_sub_f32 v176, v176, v41
v_sub_f32 v177, v177, v41
v_sub_f32 v178, v178, v41
v_sub_f32 v179, v179, v41
v_sub_f32 v224, v224, v41
v_sub_f32 v225, v225, v41
v_sub_f32 v226, v226, v41
v_sub_f32 v227, v227, v41
v_mul_f32 v28, v28, v36
ard v208,a0
ard v209,a1
ard v210,a2
ard v211,a3
ard v212,a16
ard v213,a17
ard v214,a18
ard v215,a19
v_mul_f32 v208, v208, v36
v_mul_f32 v209, v209, v36
v_mul_f32 v210, v210, v36
v_mul_f32 v211, v211, v36
v_mul_f32 v212, v212, v36
v_mul_f32 v213, v213, v36
v_mul_f32 v214, v214, v36
v_mul_f32 v215, v215, v36
awr a0,v208
awr a1,v209
awr a2,v210
awr a3,v211
awr a16,v212
awr a17,v213
awr a18,v214
awr a19,v215
ard v208,a32
ard v209,a33
ard v210,a34
ard v211,a35
ard v212,a48
ard v213,a49
ard v214,a50
ard v215,a51
v_mul_f32 v208, v208, v36
v_mul_f32 v209, v209, v36
v_mul_f32 v210, v210, v36
v_mul_f32 v211, v211, v36
v_mul_f32 v212, v212, v36
v_mul_f32 v213, v213, v36
v_mul_f32 v214, v214, v36
v_mul_f32 v215, v215, v36
awr a32,v208
awr a33,v209
awr a34,v210
awr a35,v211
awr a48,v212
awr a49,v213
awr a50,v214
awr a51,v215
ard v208,a64
ard v209,a65
ard v210,a66
ard v211,a67
ard v212,a80
ard v213,a81
ard v214,a82
ard v215,a83
v_mul_f32 v208, v208, v36
v_mul_f32 v209, v209, v36
v_mul_f32 v210, v210, v36
v_mul_f32 v211, v211, v36
v_mul_f32 v212, v212, v36
v_mul_f32 v213, v213, v36
v_mul_f32 v214, v214, v36
v_mul_f32 v215, v215, v36
awr a64,v208
awr a65,v209
awr a66,v210
awr a67,v211
awr a80,v212
awr a81,v213
awr a82,v214
awr a83,v215
ard v208,a96
ard v209,a97
ard v210,a98
ard v211,a99
ard v212,a112
ard v213,a113
ard v214,a114
ard v215,a115
v_mul_f32 v208, v208, v36
v_mul_f32 v209, v209, v36
v_mul_f32 v210, v210, v36
v_mul_f32 v211, v211, v36
v_mul_f32 v212, v212, v36
v_mul_f32 v213, v213, v36
v_mul_f32 v214, v214, v36
v_mul_f32 v215, v215, v36
awr a96,v208
awr a97,v209
awr a98,v210
awr a99,v211
awr a112,v212
awr a113,v213
awr a114,v214
awr a115,v215
ard v208,a128
ard v209,a129
ard v210,a130
ard v211,a131
ard v212,a144
ard v213,a145
ard v214,a146
ard v215,a147
v_mul_f32 v208, v208, v36
v_mul_f32 v209, v209, v36
v_mul_f32 v210, v210, v36
v_mul_f32 v211, v211, v36
v_mul_f32 v212, v212, v36
v_mul_f32 v213, v213, v36
v_mul_f32 v214, v214, v36
v_mul_f32 v215, v215, v36
awr a128,v208
awr a129,v209
awr a130,v210
awr a131,v211
awr a144,v212
awr a145,v213
awr a146,v214
awr a147,v215
ard v208,a160
ard v209,a161
ard v210,a162
ard v211,a163
ard v212,a176
ard v213,a177
ard v214,a178
ard v215,a179
v_mul_f32 v208, v208, v36
v_mul_f32 v209, v209, v36
v_mul_f32 v210, v210, v36
v_mul_f32 v211, v211, v36
v_mul_f32 v212, v212, v36
v_mul_f32 v213, v213, v36
v_mul_f32 v214, v214, v36
v_mul_f32 v215, v215, v36
awr a160,v208
awr a161,v209
awr a162,v210
awr a163,v211
awr a176,v212
awr a177,v213
awr a178,v214
awr a179,v215
v_lshlrev_b32 v208, 16, v192
v_and_b32 v209, s47, v192
v_lshlrev_b32 v210, 16, v193
v_and_b32 v211, s47, v193
v_lshlrev_b32 v212, 16, v194
v_and_b32 v213, s47, v194
v_lshlrev_b32 v214, 16, v195
v_and_b32 v215, s47, v195
v_mul_f32 v208, v208, v36
v_mul_f32 v209, v209, v36
v_mul_f32 v210, v210, v36
v_mul_f32 v211, v211, v36
v_mul_f32 v212, v212, v36
v_mul_f32 v213, v213, v36
v_mul_f32 v214, v214, v36
v_mul_f32 v215, v215, v36
cvt v192,v208,v209
cvt v193,v210,v211
cvt v194,v212,v213
cvt v195,v214,v215
v_sub_f32 v164, v164, v42
v_sub_f32 v165, v165, v42
v_sub_f32 v166, v166, v42
v_sub_f32 v167, v167, v42
v_sub_f32 v180, v180, v42
v_sub_f32 v181, v181, v42
v_sub_f32 v182, v182, v42
v_sub_f32 v183, v183, v42
v_sub_f32 v228, v228, v42
v_sub_f32 v229, v229, v42
v_sub_f32 v230, v230, v42
v_sub_f32 v231, v231, v42
v_mul_f32 v29, v29, v37
ard v208,a4
ard v209,a5
ard v210,a6
ard v211,a7
ard v212,a20
ard v213,a21
ard v214,a22
ard v215,a23
v_mul_f32 v208, v208, v37
v_mul_f32 v209, v209, v37
v_mul_f32 v210, v210, v37
v_mul_f32 v211, v211, v37
v_mul_f32 v212, v212, v37
v_mul_f32 v213, v213, v37
v_mul_f32 v214, v214, v37
v_mul_f32 v215, v215, v37
awr a4,v208
awr a5,v209
awr a6,v210
awr a7,v211
awr a20,v212
awr a21,v213
awr a22,v214
awr a23,v215
ard v208,a36
ard v209,a37
ard v210,a38
ard v211,a39
ard v212,a52
ard v213,a53
ard v214,a54
ard v215,a55
v_mul_f32 v208, v208, v37
v_mul_f32 v209, v209, v37
v_mul_f32 v210, v210, v37
v_mul_f32 v211, v211, v37
v_mul_f32 v212, v212, v37
v_mul_f32 v213, v213, v37
v_mul_f32 v214, v214, v37
v_mul_f32 v215, v215, v37
awr a36,v208
awr a37,v209
awr a38,v210
awr a39,v211
awr a52,v212
awr a53,v213
awr a54,v214
awr a55,v215
ard v208,a68
ard v209,a69
ard v210,a70
ard v211,a71
ard v212,a84
ard v213,a85
ard v214,a86
ard v215,a87
v_mul_f32 v208, v208, v37
v_mul_f32 v209, v209, v37
v_mul_f32 v210, v210, v37
v_mul_f32 v211, v211, v37
v_mul_f32 v212, v212, v37
v_mul_f32 v213, v213, v37
v_mul_f32 v214, v214, v37
v_mul_f32 v215, v215, v37
awr a68,v208
awr a69,v209
awr a70,v210
awr a71,v211
awr a84,v212
awr a85,v213
awr a86,v214
awr a87,v215
ard v208,a100
ard v209,a101
ard v210,a102
ard v211,a103
ard v212,a116
ard v213,a117
ard v214,a118
ard v215,a119
v_mul_f32 v208, v208, v37
v_mul_f32 v209, v209, v37
v_mul_f32 v210, v210, v37
v_mul_f32 v211, v211, v37
v_mul_f32 v212, v212, v37
v_mul_f32 v213, v213, v37
v_mul_f32 v214, v214, v37
v_mul_f32 v215, v215, v37
awr a100,v208
awr a101,v209
awr a102,v210
awr a103,v211
awr a116,v212
awr a117,v213
awr a118,v214
awr a119,v215
ard v208,a132
ard v209,a133
ard v210,a134
ard v211,a135
ard v212,a148
ard v213,a149
ard v214,a150
ard v215,a151
v_mul_f32 v208, v208, v37
v_mul_f32 v209, v209, v37
v_mul_f32 v210, v210, v37
v_mul_f32 v211, v211, v37
v_mul_f32 v212, v212, v37
v_mul_f32 v213, v213, v37
v_mul_f32 v214, v214, v37
v_mul_f32 v215, v215, v37
awr a132,v208
awr a133,v209
awr a134,v210
awr a135,v211
awr a148,v212
awr a149,v213
awr a150,v214
awr a151,v215
ard v208,a164
ard v209,a165
ard v210,a166
ard v211,a167
ard v212,a180
ard v213,a181
ard v214,a182
ard v215,a183
v_mul_f32 v208, v208, v37
v_mul_f32 v209, v209, v37
v_mul_f32 v210, v210, v37
v_mul_f32 v211, v211, v37
v_mul_f32 v212, v212, v37
v_mul_f32 v213, v213, v37
v_mul_f32 v214, v214, v37
v_mul_f32 v215, v215, v37
awr a164,v208
awr a165,v209
awr a166,v210
awr a167,v211
awr a180,v212
awr a181,v213
awr a182,v214
awr a183,v215
v_lshlrev_b32 v208, 16, v196
v_and_b32 v209, s47, v196
v_lshlrev_b32 v210, 16, v197
v_and_b32 v211, s47, v197
v_lshlrev_b32 v212, 16, v198
v_and_b32 v213, s47, v198
v_lshlrev_b32 v214, 16, v199
v_and_b32 v215, s47, v199
v_mul_f32 v208, v208, v37
v_mul_f32 v209, v209, v37
v_mul_f32 v210, v210, v37
v_mul_f32 v211, v211, v37
v_mul_f32 v212, v212, v37
v_mul_f32 v213, v213, v37
v_mul_f32 v214, v214, v37
v_mul_f32 v215, v215, v37
cvt v196,v208,v209
cvt v197,v210,v211
cvt v198,v212,v213
cvt v199,v214,v215
v_sub_f32 v168, v168, v43
v_sub_f32 v169, v169, v43
v_sub_f32 v170, v170, v43
v_sub_f32 v171, v171, v43
v_sub_f32 v184, v184, v43
v_sub_f32 v185, v185, v43
v_sub_f32 v186, v186, v43
v_sub_f32 v187, v187, v43
v_sub_f32 v232, v232, v43
v_sub_f32 v233, v233, v43
v_sub_f32 v234, v234, v43
v_sub_f32 v235, v235, v43
v_mul_f32 v30, v30, v38
ard v208,a8
ard v209,a9
ard v210,a10
ard v211,a11
ard v212,a24
ard v213,a25
ard v214,a26
ard v215,a27
v_mul_f32 v208, v208, v38
v_mul_f32 v209, v209, v38
v_mul_f32 v210, v210, v38
v_mul_f32 v211, v211, v38
v_mul_f32 v212, v212, v38
v_mul_f32 v213, v213, v38
v_mul_f32 v214, v214, v38
v_mul_f32 v215, v215, v38
awr a8,v208
awr a9,v209
awr a10,v210
awr a11,v211
awr a24,v212
awr a25,v213
awr a26,v214
awr a27,v215
ard v208,a40
ard v209,a41
ard v210,a42
ard v211,a43
ard v212,a56
ard v213,a57
ard v214,a58
ard v215,a59
v_mul_f32 v208, v208, v38
v_mul_f32 v209, v209, v38
v_mul_f32 v210, v210, v38
v_mul_f32 v211, v211, v38
v_mul_f32 v212, v212, v38
v_mul_f32 v213, v213, v38
v_mul_f32 v214, v214, v38
v_mul_f32 v215, v215, v38
awr a40,v208
awr a41,v209
awr a42,v210
awr a43,v211
awr a56,v212
awr a57,v213
awr a58,v214
awr a59,v215
ard v208,a72
ard v209,a73
ard v210,a74
ard v211,a75
ard v212,a88
ard v213,a89
ard v214,a90
ard v215,a91
v_mul_f32 v208, v208, v38
v_mul_f32 v209, v209, v38
v_mul_f32 v210, v210, v38
v_mul_f32 v211, v211, v38
v_mul_f32 v212, v212, v38
v_mul_f32 v213, v213, v38
v_mul_f32 v214, v214, v38
v_mul_f32 v215, v215, v38
awr a72,v208
awr a73,v209
awr a74,v210
awr a75,v211
awr a88,v212
awr a89,v213
awr a90,v214
awr a91,v215
ard v208,a104
ard v209,a105
ard v210,a106
ard v211,a107
ard v212,a120
ard v213,a121
ard v214,a122
ard v215,a123
v_mul_f32 v208, v208, v38
v_mul_f32 v209, v209, v38
v_mul_f32 v210, v210, v38
v_mul_f32 v211, v211, v38
v_mul_f32 v212, v212, v38
v_mul_f32 v213, v213, v38
v_mul_f32 v214, v214, v38
v_mul_f32 v215, v215, v38
awr a104,v208
awr a105,v209
awr a106,v210
awr a107,v211
awr a120,v212
awr a121,v213
awr a122,v214
awr a123,v215
ard v208,a136
ard v209,a137
ard v210,a138
ard v211,a139
ard v212,a152
ard v213,a153
ard v214,a154
ard v215,a155
v_mul_f32 v208, v208, v38
v_mul_f32 v209, v209, v38
v_mul_f32 v210, v210, v38
v_mul_f32 v211, v211, v38
v_mul_f32 v212, v212, v38
v_mul_f32 v213, v213, v38
v_mul_f32 v214, v214, v38
v_mul_f32 v215, v215, v38
awr a136,v208
awr a137,v209
awr a138,v210
awr a139,v211
awr a152,v212
awr a153,v213
awr a154,v214
awr a155,v215
ard v208,a168
ard v209,a169
ard v210,a170
ard v211,a171
ard v212,a184
ard v213,a185
ard v214,a186
ard v215,a187
v_mul_f32 v208, v208, v38
v_mul_f32 v209, v209, v38
v_mul_f32 v210, v210, v38
v_mul_f32 v211, v211, v38
v_mul_f32 v212, v212, v38
v_mul_f32 v213, v213, v38
v_mul_f32 v214, v214, v38
v_mul_f32 v215, v215, v38
awr a168,v208
awr a169,v209
awr a170,v210
awr a171,v211
awr a184,v212
awr a185,v213
awr a186,v214
awr a187,v215
v_lshlrev_b32 v208, 16, v200
v_and_b32 v209, s47, v200
v_lshlrev_b32 v210, 16, v201
v_and_b32 v211, s47, v201
v_lshlrev_b32 v212, 16, v202
v_and_b32 v213, s47, v202
v_lshlrev_b32 v214, 16, v203
v_and_b32 v215, s47, v203
v_mul_f32 v208, v208, v38
v_mul_f32 v209, v209, v38
v_mul_f32 v210, v210, v38
v_mul_f32 v211, v211, v38
v_mul_f32 v212, v212, v38
v_mul_f32 v213, v213, v38
v_mul_f32 v214, v214, v38
v_mul_f32 v215, v215, v38
cvt v200,v208,v209
cvt v201,v210,v211
cvt v202,v212,v213
cvt v203,v214,v215
v_sub_f32 v172, v172, v44
v_sub_f32 v173, v173, v44
v_sub_f32 v174, v174, v44
v_sub_f32 v175, v175, v44
v_sub_f32 v188, v188, v44
v_sub_f32 v189, v189, v44
v_sub_f32 v190, v190, v44
v_sub_f32 v191, v191, v44
v_sub_f32 v236, v236, v44
v_sub_f32 v237, v237, v44
v_sub_f32 v238, v238, v44
v_sub_f32 v239, v239, v44
v_mul_f32 v31, v31, v39
ard v208,a12
ard v209,a13
ard v210,a14
ard v211,a15
ard v212,a28
ard v213,a29
ard v214,a30
ard v215,a31
v_mul_f32 v208, v208, v39
v_mul_f32 v209, v209, v39
v_mul_f32 v210, v210, v39
v_mul_f32 v211, v211, v39
v_mul_f32 v212, v212, v39
v_mul_f32 v213, v213, v39
v_mul_f32 v214, v214, v39
v_mul_f32 v215, v215, v39
awr a12,v208
awr a13,v209
awr a14,v210
awr a15,v211
awr a28,v212
awr a29,v213
awr a30,v214
awr a31,v215
ard v208,a44
ard v209,a45
ard v210,a46
ard v211,a47
ard v212,a60
ard v213,a61
ard v214,a62
ard v215,a63
v_mul_f32 v208, v208, v39
v_mul_f32 v209, v209, v39
v_mul_f32 v210, v210, v39
v_mul_f32 v211, v211, v39
v_mul_f32 v212, v212, v39
v_mul_f32 v213, v213, v39
v_mul_f32 v214, v214, v39
v_mul_f32 v215, v215, v39
awr a44,v208
awr a45,v209
awr a46,v210
awr a47,v211
awr a60,v212
awr a61,v213
awr a62,v214
awr a63,v215
ard v208,a76
ard v209,a77
ard v210,a78
ard v211,a79
ard v212,a92
ard v213,a93
ard v214,a94
ard v215,a95
v_mul_f32 v208, v208, v39
v_mul_f32 v209, v209, v39
v_mul_f32 v210, v210, v39
v_mul_f32 v211, v211, v39
v_mul_f32 v212, v212, v39
v_mul_f32 v213, v213, v39
v_mul_f32 v214, v214, v39
v_mul_f32 v215, v215, v39
awr a76,v208
awr a77,v209
awr a78,v210
awr a79,v211
awr a92,v212
awr a93,v213
awr a94,v214
awr a95,v215
ard v208,a108
ard v209,a109
ard v210,a110
ard v211,a111
ard v212,a124
ard v213,a125
ard v214,a126
ard v215,a127
v_mul_f32 v208, v208, v39
v_mul_f32 v209, v209, v39
v_mul_f32 v210, v210, v39
v_mul_f32 v211, v211, v39
v_mul_f32 v212, v212, v39
v_mul_f32 v213, v213, v39
v_mul_f32 v214, v214, v39
v_mul_f32 v215, v215, v39
awr a108,v208
awr a109,v209
awr a110,v210
awr a111,v211
awr a124,v212
awr a125,v213
awr a126,v214
awr a127,v215
ard v208,a140
ard v209,a141
ard v210,a142
ard v211,a143
ard v212,a156
ard v213,a157
ard v214,a158
ard v215,a159
v_mul_f32 v208, v208, v39
v_mul_f32 v209, v209, v39
v_mul_f32 v210, v210, v39
v_mul_f32 v211, v211, v39
v_mul_f32 v212, v212, v39
v_mul_f32 v213, v213, v39
v_mul_f32 v214, v214, v39
v_mul_f32 v215, v215, v39
awr a140,v208
awr a141,v209
awr a142,v210
awr a143,v211
awr a156,v212
awr a157,v213
awr a158,v214
awr a159,v215
ard v208,a172
ard v209,a173
ard v210,a174
ard v211,a175
ard v212,a188
ard v213,a189
ard v214,a190
ard v215,a191
v_mul_f32 v208, v208, v39
v_mul_f32 v209, v209, v39
v_mul_f32 v210, v210, v39
v_mul_f32 v211, v211, v39
v_mul_f32 v212, v212, v39
v_mul_f32 v213, v213, v39
v_mul_f32 v214, v214, v39
v_mul_f32 v215, v215, v39
awr a172,v208
awr a173,v209
awr a174,v210
awr a175,v211
awr a188,v212
awr a189,v213
awr a190,v214
awr a191,v215
v_lshlrev_b32 v208, 16, v204
v_and_b32 v209, s47, v204
v_lshlrev_b32 v210, 16, v205
v_and_b32 v211, s47, v205
v_lshlrev_b32 v212, 16, v206
v_and_b32 v213, s47, v206
v_lshlrev_b32 v214, 16, v207
v_and_b32 v215, s47, v207
v_mul_f32 v208, v208, v39
v_mul_f32 v209, v209, v39
v_mul_f32 v210, v210, v39
v_mul_f32 v211, v211, v39
v_mul_f32 v212, v212, v39
v_mul_f32 v213, v213, v39
v_mul_f32 v214, v214, v39
v_mul_f32 v215, v215, v39
cvt v204,v208,v209
cvt v205,v210,v211
cvt v206,v212,v213
cvt v207,v214,v215
v_exp_f32 v32, v160
v_exp_f32 v33, v161
v_exp_f32 v34, v162
v_exp_f32 v35, v163
v_add_f32 v24, v32, v33
cvt v208,v32,v33
v_add_f32 v24, v24, v34
cvt v209,v34,v35
v_add_f32 v24, v24, v35
v_exp_f32 v36, v164
v_exp_f32 v37, v165
v_exp_f32 v38, v166
v_exp_f32 v39, v167
v_add_f32 v25, v36, v37
cvt v212,v36,v37
v_add_f32 v25, v25, v38
cvt v213,v38,v39
v_add_f32 v25, v25, v39
v_exp_f32 v32, v168
v_exp_f32 v33, v169
v_exp_f32 v34, v170
v_exp_f32 v35, v171
v_add_f32 v26, v32, v33
cvt v216,v32,v33
v_add_f32 v26, v26, v34
cvt v217,v34,v35
v_add_f32 v26, v26, v35
v_exp_f32 v36, v172
v_exp_f32 v37, v173
v_exp_f32 v38, v174
v_exp_f32 v39, v175
v_add_f32 v27, v36, v37
cvt v220,v36,v37
v_add_f32 v27, v27, v38
cvt v221,v38,v39
v_add_f32 v27, v27, v39
v_exp_f32 v32, v176
v_exp_f32 v33, v177
v_exp_f32 v34, v178
v_exp_f32 v35, v179
v_add_f32 v24, v24, v32
cvt v210,v32,v33
v_add_f32 v24, v24, v33
v_add_f32 v24, v24, v34
cvt v211,v34,v35
v_add_f32 v24, v24, v35
v_exp_f32 v36, v180
v_exp_f32 v37, v181
v_exp_f32 v38, v182
v_exp_f32 v39, v183
v_add_f32 v25, v25, v36
cvt v214,v36,v37
v_add_f32 v25, v25, v37
v_add_f32 v25, v25, v38
cvt v215,v38,v39
v_add_f32 v25, v25, v39
v_exp_f32 v32, v184
v_exp_f32 v33, v185
v_exp_f32 v34, v186
v_exp_f32 v35, v187
v_add_f32 v26, v26, v32
cvt v218,v32,v33
v_add_f32 v26, v26, v33
v_add_f32 v26, v26, v34
cvt v219,v34,v35
v_add_f32 v26, v26, v35
v_exp_f32 v36, v188
v_exp_f32 v37, v189
v_exp_f32 v38, v190
v_exp_f32 v39, v191
v_add_f32 v27, v27, v36
cvt v222,v36,v37
v_add_f32 v27, v27, v37
v_add_f32 v27, v27, v38
cvt v223,v38,v39
v_add_f32 v27, v27, v39
s_nop 3
s_setpc_b64 s[0:1]
L_w0_rare2:
s_nop 15
s_mov_b32 s47, 4294901760
v_max3_f32 v41, v160, v161, v162
v_max3_f32 v42, v164, v165, v166
v_max3_f32 v43, v168, v169, v170
v_max3_f32 v44, v172, v173, v174
v_max3_f32 v41, v41, v163, v176
v_max3_f32 v42, v42, v167, v180
v_max3_f32 v43, v43, v171, v184
v_max3_f32 v44, v44, v175, v188
v_max3_f32 v41, v41, v177, v178
v_max3_f32 v42, v42, v181, v182
v_max3_f32 v43, v43, v185, v186
v_max3_f32 v44, v44, v189, v190
v_max_f32 v41, v41, v179
v_max_f32 v42, v42, v183
v_max_f32 v43, v43, v187
v_max_f32 v44, v44, v191
v_mov_b32 v32, v41
v_mov_b32 v33, v42
v_mov_b32 v34, v43
v_mov_b32 v35, v44
v_permlane32_swap_b32 v41, v32
v_permlane32_swap_b32 v42, v33
v_permlane32_swap_b32 v43, v34
v_permlane32_swap_b32 v44, v35
v_max_f32 v41, v41, v32
v_max_f32 v42, v42, v33
v_max_f32 v43, v43, v34
v_max_f32 v44, v44, v35
v_mov_b32 v32, v41
v_mov_b32 v33, v42
v_mov_b32 v34, v43
v_mov_b32 v35, v44
v_permlane16_swap_b32 v41, v32
v_permlane16_swap_b32 v42, v33
v_permlane16_swap_b32 v43, v34
v_permlane16_swap_b32 v44, v35
v_max_f32 v41, v41, v32
v_max_f32 v42, v42, v33
v_max_f32 v43, v43, v34
v_max_f32 v44, v44, v35
v_max_f32 v41, 0, v41
v_max_f32 v42, 0, v42
v_max_f32 v43, 0, v43
v_max_f32 v44, 0, v44
v_ceil_f32 v41, v41
v_ceil_f32 v42, v42
v_ceil_f32 v43, v43
v_ceil_f32 v44, v44
v_exp_f32 v36, -v41
v_exp_f32 v37, -v42
v_exp_f32 v38, -v43
v_exp_f32 v39, -v44
v_sub_f32 v160, v160, v41
v_sub_f32 v161, v161, v41
v_sub_f32 v162, v162, v41
v_sub_f32 v163, v163, v41
v_sub_f32 v176, v176, v41
v_sub_f32 v177, v177, v41
v_sub_f32 v178, v178, v41
v_sub_f32 v179, v179, v41
v_sub_f32 v224, v224, v41
v_sub_f32 v225, v225, v41
v_sub_f32 v226, v226, v41
v_sub_f32 v227, v227, v41
v_mul_f32 v28, v28, v36
ard v240,a0
ard v241,a1
ard v242,a2
ard v243,a3
ard v244,a16
ard v245,a17
ard v246,a18
ard v247,a19
v_mul_f32 v240, v240, v36
v_mul_f32 v241, v241, v36
v_mul_f32 v242, v242, v36
v_mul_f32 v243, v243, v36
v_mul_f32 v244, v244, v36
v_mul_f32 v245, v245, v36
v_mul_f32 v246, v246, v36
v_mul_f32 v247, v247, v36
awr a0,v240
awr a1,v241
awr a2,v242
awr a3,v243
awr a16,v244
awr a17,v245
awr a18,v246
awr a19,v247
ard v240,a32
ard v241,a33
ard v242,a34
ard v243,a35
ard v244,a48
ard v245,a49
ard v246,a50
ard v247,a51
v_mul_f32 v240, v240, v36
v_mul_f32 v241, v241, v36
v_mul_f32 v242, v242, v36
v_mul_f32 v243, v243, v36
v_mul_f32 v244, v244, v36
v_mul_f32 v245, v245, v36
v_mul_f32 v246, v246, v36
v_mul_f32 v247, v247, v36
awr a32,v240
awr a33,v241
awr a34,v242
awr a35,v243
awr a48,v244
awr a49,v245
awr a50,v246
awr a51,v247
ard v240,a64
ard v241,a65
ard v242,a66
ard v243,a67
ard v244,a80
ard v245,a81
ard v246,a82
ard v247,a83
v_mul_f32 v240, v240, v36
v_mul_f32 v241, v241, v36
v_mul_f32 v242, v242, v36
v_mul_f32 v243, v243, v36
v_mul_f32 v244, v244, v36
v_mul_f32 v245, v245, v36
v_mul_f32 v246, v246, v36
v_mul_f32 v247, v247, v36
awr a64,v240
awr a65,v241
awr a66,v242
awr a67,v243
awr a80,v244
awr a81,v245
awr a82,v246
awr a83,v247
ard v240,a96
ard v241,a97
ard v242,a98
ard v243,a99
ard v244,a112
ard v245,a113
ard v246,a114
ard v247,a115
v_mul_f32 v240, v240, v36
v_mul_f32 v241, v241, v36
v_mul_f32 v242, v242, v36
v_mul_f32 v243, v243, v36
v_mul_f32 v244, v244, v36
v_mul_f32 v245, v245, v36
v_mul_f32 v246, v246, v36
v_mul_f32 v247, v247, v36
awr a96,v240
awr a97,v241
awr a98,v242
awr a99,v243
awr a112,v244
awr a113,v245
awr a114,v246
awr a115,v247
ard v240,a128
ard v241,a129
ard v242,a130
ard v243,a131
ard v244,a144
ard v245,a145
ard v246,a146
ard v247,a147
v_mul_f32 v240, v240, v36
v_mul_f32 v241, v241, v36
v_mul_f32 v242, v242, v36
v_mul_f32 v243, v243, v36
v_mul_f32 v244, v244, v36
v_mul_f32 v245, v245, v36
v_mul_f32 v246, v246, v36
v_mul_f32 v247, v247, v36
awr a128,v240
awr a129,v241
awr a130,v242
awr a131,v243
awr a144,v244
awr a145,v245
awr a146,v246
awr a147,v247
ard v240,a160
ard v241,a161
ard v242,a162
ard v243,a163
ard v244,a176
ard v245,a177
ard v246,a178
ard v247,a179
v_mul_f32 v240, v240, v36
v_mul_f32 v241, v241, v36
v_mul_f32 v242, v242, v36
v_mul_f32 v243, v243, v36
v_mul_f32 v244, v244, v36
v_mul_f32 v245, v245, v36
v_mul_f32 v246, v246, v36
v_mul_f32 v247, v247, v36
awr a160,v240
awr a161,v241
awr a162,v242
awr a163,v243
awr a176,v244
awr a177,v245
awr a178,v246
awr a179,v247
v_lshlrev_b32 v240, 16, v192
v_and_b32 v241, s47, v192
v_lshlrev_b32 v242, 16, v193
v_and_b32 v243, s47, v193
v_lshlrev_b32 v244, 16, v194
v_and_b32 v245, s47, v194
v_lshlrev_b32 v246, 16, v195
v_and_b32 v247, s47, v195
v_mul_f32 v240, v240, v36
v_mul_f32 v241, v241, v36
v_mul_f32 v242, v242, v36
v_mul_f32 v243, v243, v36
v_mul_f32 v244, v244, v36
v_mul_f32 v245, v245, v36
v_mul_f32 v246, v246, v36
v_mul_f32 v247, v247, v36
cvt v192,v240,v241
cvt v193,v242,v243
cvt v194,v244,v245
cvt v195,v246,v247
v_lshlrev_b32 v240, 16, v208
v_and_b32 v241, s47, v208
v_lshlrev_b32 v242, 16, v209
v_and_b32 v243, s47, v209
v_lshlrev_b32 v244, 16, v210
v_and_b32 v245, s47, v210
v_lshlrev_b32 v246, 16, v211
v_and_b32 v247, s47, v211
v_mul_f32 v240, v240, v36
v_mul_f32 v241, v241, v36
v_mul_f32 v242, v242, v36
v_mul_f32 v243, v243, v36
v_mul_f32 v244, v244, v36
v_mul_f32 v245, v245, v36
v_mul_f32 v246, v246, v36
v_mul_f32 v247, v247, v36
cvt v208,v240,v241
cvt v209,v242,v243
cvt v210,v244,v245
cvt v211,v246,v247
v_sub_f32 v164, v164, v42
v_sub_f32 v165, v165, v42
v_sub_f32 v166, v166, v42
v_sub_f32 v167, v167, v42
v_sub_f32 v180, v180, v42
v_sub_f32 v181, v181, v42
v_sub_f32 v182, v182, v42
v_sub_f32 v183, v183, v42
v_sub_f32 v228, v228, v42
v_sub_f32 v229, v229, v42
v_sub_f32 v230, v230, v42
v_sub_f32 v231, v231, v42
v_mul_f32 v29, v29, v37
ard v240,a4
ard v241,a5
ard v242,a6
ard v243,a7
ard v244,a20
ard v245,a21
ard v246,a22
ard v247,a23
v_mul_f32 v240, v240, v37
v_mul_f32 v241, v241, v37
v_mul_f32 v242, v242, v37
v_mul_f32 v243, v243, v37
v_mul_f32 v244, v244, v37
v_mul_f32 v245, v245, v37
v_mul_f32 v246, v246, v37
v_mul_f32 v247, v247, v37
awr a4,v240
awr a5,v241
awr a6,v242
awr a7,v243
awr a20,v244
awr a21,v245
awr a22,v246
awr a23,v247
ard v240,a36
ard v241,a37
ard v242,a38
ard v243,a39
ard v244,a52
ard v245,a53
ard v246,a54
ard v247,a55
v_mul_f32 v240, v240, v37
v_mul_f32 v241, v241, v37
v_mul_f32 v242, v242, v37
v_mul_f32 v243, v243, v37
v_mul_f32 v244, v244, v37
v_mul_f32 v245, v245, v37
v_mul_f32 v246, v246, v37
v_mul_f32 v247, v247, v37
awr a36,v240
awr a37,v241
awr a38,v242
awr a39,v243
awr a52,v244
awr a53,v245
awr a54,v246
awr a55,v247
ard v240,a68
ard v241,a69
ard v242,a70
ard v243,a71
ard v244,a84
ard v245,a85
ard v246,a86
ard v247,a87
v_mul_f32 v240, v240, v37
v_mul_f32 v241, v241, v37
v_mul_f32 v242, v242, v37
v_mul_f32 v243, v243, v37
v_mul_f32 v244, v244, v37
v_mul_f32 v245, v245, v37
v_mul_f32 v246, v246, v37
v_mul_f32 v247, v247, v37
awr a68,v240
awr a69,v241
awr a70,v242
awr a71,v243
awr a84,v244
awr a85,v245
awr a86,v246
awr a87,v247
ard v240,a100
ard v241,a101
ard v242,a102
ard v243,a103
ard v244,a116
ard v245,a117
ard v246,a118
ard v247,a119
v_mul_f32 v240, v240, v37
v_mul_f32 v241, v241, v37
v_mul_f32 v242, v242, v37
v_mul_f32 v243, v243, v37
v_mul_f32 v244, v244, v37
v_mul_f32 v245, v245, v37
v_mul_f32 v246, v246, v37
v_mul_f32 v247, v247, v37
awr a100,v240
awr a101,v241
awr a102,v242
awr a103,v243
awr a116,v244
awr a117,v245
awr a118,v246
awr a119,v247
ard v240,a132
ard v241,a133
ard v242,a134
ard v243,a135
ard v244,a148
ard v245,a149
ard v246,a150
ard v247,a151
v_mul_f32 v240, v240, v37
v_mul_f32 v241, v241, v37
v_mul_f32 v242, v242, v37
v_mul_f32 v243, v243, v37
v_mul_f32 v244, v244, v37
v_mul_f32 v245, v245, v37
v_mul_f32 v246, v246, v37
v_mul_f32 v247, v247, v37
awr a132,v240
awr a133,v241
awr a134,v242
awr a135,v243
awr a148,v244
awr a149,v245
awr a150,v246
awr a151,v247
ard v240,a164
ard v241,a165
ard v242,a166
ard v243,a167
ard v244,a180
ard v245,a181
ard v246,a182
ard v247,a183
v_mul_f32 v240, v240, v37
v_mul_f32 v241, v241, v37
v_mul_f32 v242, v242, v37
v_mul_f32 v243, v243, v37
v_mul_f32 v244, v244, v37
v_mul_f32 v245, v245, v37
v_mul_f32 v246, v246, v37
v_mul_f32 v247, v247, v37
awr a164,v240
awr a165,v241
awr a166,v242
awr a167,v243
awr a180,v244
awr a181,v245
awr a182,v246
awr a183,v247
v_lshlrev_b32 v240, 16, v196
v_and_b32 v241, s47, v196
v_lshlrev_b32 v242, 16, v197
v_and_b32 v243, s47, v197
v_lshlrev_b32 v244, 16, v198
v_and_b32 v245, s47, v198
v_lshlrev_b32 v246, 16, v199
v_and_b32 v247, s47, v199
v_mul_f32 v240, v240, v37
v_mul_f32 v241, v241, v37
v_mul_f32 v242, v242, v37
v_mul_f32 v243, v243, v37
v_mul_f32 v244, v244, v37
v_mul_f32 v245, v245, v37
v_mul_f32 v246, v246, v37
v_mul_f32 v247, v247, v37
cvt v196,v240,v241
cvt v197,v242,v243
cvt v198,v244,v245
cvt v199,v246,v247
v_lshlrev_b32 v240, 16, v212
v_and_b32 v241, s47, v212
v_lshlrev_b32 v242, 16, v213
v_and_b32 v243, s47, v213
v_lshlrev_b32 v244, 16, v214
v_and_b32 v245, s47, v214
v_lshlrev_b32 v246, 16, v215
v_and_b32 v247, s47, v215
v_mul_f32 v240, v240, v37
v_mul_f32 v241, v241, v37
v_mul_f32 v242, v242, v37
v_mul_f32 v243, v243, v37
v_mul_f32 v244, v244, v37
v_mul_f32 v245, v245, v37
v_mul_f32 v246, v246, v37
v_mul_f32 v247, v247, v37
cvt v212,v240,v241
cvt v213,v242,v243
cvt v214,v244,v245
cvt v215,v246,v247
v_sub_f32 v168, v168, v43
v_sub_f32 v169, v169, v43
v_sub_f32 v170, v170, v43
v_sub_f32 v171, v171, v43
v_sub_f32 v184, v184, v43
v_sub_f32 v185, v185, v43
v_sub_f32 v186, v186, v43
v_sub_f32 v187, v187, v43
v_sub_f32 v232, v232, v43
v_sub_f32 v233, v233, v43
v_sub_f32 v234, v234, v43
v_sub_f32 v235, v235, v43
v_mul_f32 v30, v30, v38
ard v240,a8
ard v241,a9
ard v242,a10
ard v243,a11
ard v244,a24
ard v245,a25
ard v246,a26
ard v247,a27
v_mul_f32 v240, v240, v38
v_mul_f32 v241, v241, v38
v_mul_f32 v242, v242, v38
v_mul_f32 v243, v243, v38
v_mul_f32 v244, v244, v38
v_mul_f32 v245, v245, v38
v_mul_f32 v246, v246, v38
v_mul_f32 v247, v247, v38
awr a8,v240
awr a9,v241
awr a10,v242
awr a11,v243
awr a24,v244
awr a25,v245
awr a26,v246
awr a27,v247
ard v240,a40
ard v241,a41
ard v242,a42
ard v243,a43
ard v244,a56
ard v245,a57
ard v246,a58
ard v247,a59
v_mul_f32 v240, v240, v38
v_mul_f32 v241, v241, v38
v_mul_f32 v242, v242, v38
v_mul_f32 v243, v243, v38
v_mul_f32 v244, v244, v38
v_mul_f32 v245, v245, v38
v_mul_f32 v246, v246, v38
v_mul_f32 v247, v247, v38
awr a40,v240
awr a41,v241
awr a42,v242
awr a43,v243
awr a56,v244
awr a57,v245
awr a58,v246
awr a59,v247
ard v240,a72
ard v241,a73
ard v242,a74
ard v243,a75
ard v244,a88
ard v245,a89
ard v246,a90
ard v247,a91
v_mul_f32 v240, v240, v38
v_mul_f32 v241, v241, v38
v_mul_f32 v242, v242, v38
v_mul_f32 v243, v243, v38
v_mul_f32 v244, v244, v38
v_mul_f32 v245, v245, v38
v_mul_f32 v246, v246, v38
v_mul_f32 v247, v247, v38
awr a72,v240
awr a73,v241
awr a74,v242
awr a75,v243
awr a88,v244
awr a89,v245
awr a90,v246
awr a91,v247
ard v240,a104
ard v241,a105
ard v242,a106
ard v243,a107
ard v244,a120
ard v245,a121
ard v246,a122
ard v247,a123
v_mul_f32 v240, v240, v38
v_mul_f32 v241, v241, v38
v_mul_f32 v242, v242, v38
v_mul_f32 v243, v243, v38
v_mul_f32 v244, v244, v38
v_mul_f32 v245, v245, v38
v_mul_f32 v246, v246, v38
v_mul_f32 v247, v247, v38
awr a104,v240
awr a105,v241
awr a106,v242
awr a107,v243
awr a120,v244
awr a121,v245
awr a122,v246
awr a123,v247
ard v240,a136
ard v241,a137
ard v242,a138
ard v243,a139
ard v244,a152
ard v245,a153
ard v246,a154
ard v247,a155
v_mul_f32 v240, v240, v38
v_mul_f32 v241, v241, v38
v_mul_f32 v242, v242, v38
v_mul_f32 v243, v243, v38
v_mul_f32 v244, v244, v38
v_mul_f32 v245, v245, v38
v_mul_f32 v246, v246, v38
v_mul_f32 v247, v247, v38
awr a136,v240
awr a137,v241
awr a138,v242
awr a139,v243
awr a152,v244
awr a153,v245
awr a154,v246
awr a155,v247
ard v240,a168
ard v241,a169
ard v242,a170
ard v243,a171
ard v244,a184
ard v245,a185
ard v246,a186
ard v247,a187
v_mul_f32 v240, v240, v38
v_mul_f32 v241, v241, v38
v_mul_f32 v242, v242, v38
v_mul_f32 v243, v243, v38
v_mul_f32 v244, v244, v38
v_mul_f32 v245, v245, v38
v_mul_f32 v246, v246, v38
v_mul_f32 v247, v247, v38
awr a168,v240
awr a169,v241
awr a170,v242
awr a171,v243
awr a184,v244
awr a185,v245
awr a186,v246
awr a187,v247
v_lshlrev_b32 v240, 16, v200
v_and_b32 v241, s47, v200
v_lshlrev_b32 v242, 16, v201
v_and_b32 v243, s47, v201
v_lshlrev_b32 v244, 16, v202
v_and_b32 v245, s47, v202
v_lshlrev_b32 v246, 16, v203
v_and_b32 v247, s47, v203
v_mul_f32 v240, v240, v38
v_mul_f32 v241, v241, v38
v_mul_f32 v242, v242, v38
v_mul_f32 v243, v243, v38
v_mul_f32 v244, v244, v38
v_mul_f32 v245, v245, v38
v_mul_f32 v246, v246, v38
v_mul_f32 v247, v247, v38
cvt v200,v240,v241
cvt v201,v242,v243
cvt v202,v244,v245
cvt v203,v246,v247
v_lshlrev_b32 v240, 16, v216
v_and_b32 v241, s47, v216
v_lshlrev_b32 v242, 16, v217
v_and_b32 v243, s47, v217
v_lshlrev_b32 v244, 16, v218
v_and_b32 v245, s47, v218
v_lshlrev_b32 v246, 16, v219
v_and_b32 v247, s47, v219
v_mul_f32 v240, v240, v38
v_mul_f32 v241, v241, v38
v_mul_f32 v242, v242, v38
v_mul_f32 v243, v243, v38
v_mul_f32 v244, v244, v38
v_mul_f32 v245, v245, v38
v_mul_f32 v246, v246, v38
v_mul_f32 v247, v247, v38
cvt v216,v240,v241
cvt v217,v242,v243
cvt v218,v244,v245
cvt v219,v246,v247
v_sub_f32 v172, v172, v44
v_sub_f32 v173, v173, v44
v_sub_f32 v174, v174, v44
v_sub_f32 v175, v175, v44
v_sub_f32 v188, v188, v44
v_sub_f32 v189, v189, v44
v_sub_f32 v190, v190, v44
v_sub_f32 v191, v191, v44
v_sub_f32 v236, v236, v44
v_sub_f32 v237, v237, v44
v_sub_f32 v238, v238, v44
v_sub_f32 v239, v239, v44
v_mul_f32 v31, v31, v39
ard v240,a12
ard v241,a13
ard v242,a14
ard v243,a15
ard v244,a28
ard v245,a29
ard v246,a30
ard v247,a31
v_mul_f32 v240, v240, v39
v_mul_f32 v241, v241, v39
v_mul_f32 v242, v242, v39
v_mul_f32 v243, v243, v39
v_mul_f32 v244, v244, v39
v_mul_f32 v245, v245, v39
v_mul_f32 v246, v246, v39
v_mul_f32 v247, v247, v39
awr a12,v240
awr a13,v241
awr a14,v242
awr a15,v243
awr a28,v244
awr a29,v245
awr a30,v246
awr a31,v247
ard v240,a44
ard v241,a45
ard v242,a46
ard v243,a47
ard v244,a60
ard v245,a61
ard v246,a62
ard v247,a63
v_mul_f32 v240, v240, v39
v_mul_f32 v241, v241, v39
v_mul_f32 v242, v242, v39
v_mul_f32 v243, v243, v39
v_mul_f32 v244, v244, v39
v_mul_f32 v245, v245, v39
v_mul_f32 v246, v246, v39
v_mul_f32 v247, v247, v39
awr a44,v240
awr a45,v241
awr a46,v242
awr a47,v243
awr a60,v244
awr a61,v245
awr a62,v246
awr a63,v247
ard v240,a76
ard v241,a77
ard v242,a78
ard v243,a79
ard v244,a92
ard v245,a93
ard v246,a94
ard v247,a95
v_mul_f32 v240, v240, v39
v_mul_f32 v241, v241, v39
v_mul_f32 v242, v242, v39
v_mul_f32 v243, v243, v39
v_mul_f32 v244, v244, v39
v_mul_f32 v245, v245, v39
v_mul_f32 v246, v246, v39
v_mul_f32 v247, v247, v39
awr a76,v240
awr a77,v241
awr a78,v242
awr a79,v243
awr a92,v244
awr a93,v245
awr a94,v246
awr a95,v247
ard v240,a108
ard v241,a109
ard v242,a110
ard v243,a111
ard v244,a124
ard v245,a125
ard v246,a126
ard v247,a127
v_mul_f32 v240, v240, v39
v_mul_f32 v241, v241, v39
v_mul_f32 v242, v242, v39
v_mul_f32 v243, v243, v39
v_mul_f32 v244, v244, v39
v_mul_f32 v245, v245, v39
v_mul_f32 v246, v246, v39
v_mul_f32 v247, v247, v39
awr a108,v240
awr a109,v241
awr a110,v242
awr a111,v243
awr a124,v244
awr a125,v245
awr a126,v246
awr a127,v247
ard v240,a140
ard v241,a141
ard v242,a142
ard v243,a143
ard v244,a156
ard v245,a157
ard v246,a158
ard v247,a159
v_mul_f32 v240, v240, v39
v_mul_f32 v241, v241, v39
v_mul_f32 v242, v242, v39
v_mul_f32 v243, v243, v39
v_mul_f32 v244, v244, v39
v_mul_f32 v245, v245, v39
v_mul_f32 v246, v246, v39
v_mul_f32 v247, v247, v39
awr a140,v240
awr a141,v241
awr a142,v242
awr a143,v243
awr a156,v244
awr a157,v245
awr a158,v246
awr a159,v247
ard v240,a172
ard v241,a173
ard v242,a174
ard v243,a175
ard v244,a188
ard v245,a189
ard v246,a190
ard v247,a191
v_mul_f32 v240, v240, v39
v_mul_f32 v241, v241, v39
v_mul_f32 v242, v242, v39
v_mul_f32 v243, v243, v39
v_mul_f32 v244, v244, v39
v_mul_f32 v245, v245, v39
v_mul_f32 v246, v246, v39
v_mul_f32 v247, v247, v39
awr a172,v240
awr a173,v241
awr a174,v242
awr a175,v243
awr a188,v244
awr a189,v245
awr a190,v246
awr a191,v247
v_lshlrev_b32 v240, 16, v204
v_and_b32 v241, s47, v204
v_lshlrev_b32 v242, 16, v205
v_and_b32 v243, s47, v205
v_lshlrev_b32 v244, 16, v206
v_and_b32 v245, s47, v206
v_lshlrev_b32 v246, 16, v207
v_and_b32 v247, s47, v207
v_mul_f32 v240, v240, v39
v_mul_f32 v241, v241, v39
v_mul_f32 v242, v242, v39
v_mul_f32 v243, v243, v39
v_mul_f32 v244, v244, v39
v_mul_f32 v245, v245, v39
v_mul_f32 v246, v246, v39
v_mul_f32 v247, v247, v39
cvt v204,v240,v241
cvt v205,v242,v243
cvt v206,v244,v245
cvt v207,v246,v247
v_lshlrev_b32 v240, 16, v220
v_and_b32 v241, s47, v220
v_lshlrev_b32 v242, 16, v221
v_and_b32 v243, s47, v221
v_lshlrev_b32 v244, 16, v222
v_and_b32 v245, s47, v222
v_lshlrev_b32 v246, 16, v223
v_and_b32 v247, s47, v223
v_mul_f32 v240, v240, v39
v_mul_f32 v241, v241, v39
v_mul_f32 v242, v242, v39
v_mul_f32 v243, v243, v39
v_mul_f32 v244, v244, v39
v_mul_f32 v245, v245, v39
v_mul_f32 v246, v246, v39
v_mul_f32 v247, v247, v39
cvt v220,v240,v241
cvt v221,v242,v243
cvt v222,v244,v245
cvt v223,v246,v247
v_exp_f32 v32, v160
v_exp_f32 v33, v161
v_exp_f32 v34, v162
v_exp_f32 v35, v163
v_add_f32 v24, v32, v33
cvt v240,v32,v33
v_add_f32 v24, v24, v34
cvt v241,v34,v35
v_add_f32 v24, v24, v35
v_exp_f32 v36, v164
v_exp_f32 v37, v165
v_exp_f32 v38, v166
v_exp_f32 v39, v167
v_add_f32 v25, v36, v37
cvt v244,v36,v37
v_add_f32 v25, v25, v38
cvt v245,v38,v39
v_add_f32 v25, v25, v39
v_exp_f32 v32, v168
v_exp_f32 v33, v169
v_exp_f32 v34, v170
v_exp_f32 v35, v171
v_add_f32 v26, v32, v33
cvt v248,v32,v33
v_add_f32 v26, v26, v34
cvt v249,v34,v35
v_add_f32 v26, v26, v35
v_exp_f32 v36, v172
v_exp_f32 v37, v173
v_exp_f32 v38, v174
v_exp_f32 v39, v175
v_add_f32 v27, v36, v37
cvt v252,v36,v37
v_add_f32 v27, v27, v38
cvt v253,v38,v39
v_add_f32 v27, v27, v39
v_exp_f32 v32, v176
v_exp_f32 v33, v177
v_exp_f32 v34, v178
v_exp_f32 v35, v179
v_add_f32 v24, v24, v32
cvt v242,v32,v33
v_add_f32 v24, v24, v33
v_add_f32 v24, v24, v34
cvt v243,v34,v35
v_add_f32 v24, v24, v35
v_exp_f32 v36, v180
v_exp_f32 v37, v181
v_exp_f32 v38, v182
v_exp_f32 v39, v183
v_add_f32 v25, v25, v36
cvt v246,v36,v37
v_add_f32 v25, v25, v37
v_add_f32 v25, v25, v38
cvt v247,v38,v39
v_add_f32 v25, v25, v39
v_exp_f32 v32, v184
v_exp_f32 v33, v185
v_exp_f32 v34, v186
v_exp_f32 v35, v187
v_add_f32 v26, v26, v32
cvt v250,v32,v33
v_add_f32 v26, v26, v33
v_add_f32 v26, v26, v34
cvt v251,v34,v35
v_add_f32 v26, v26, v35
v_exp_f32 v36, v188
v_exp_f32 v37, v189
v_exp_f32 v38, v190
v_exp_f32 v39, v191
v_add_f32 v27, v27, v36
cvt v254,v36,v37
v_add_f32 v27, v27, v37
v_add_f32 v27, v27, v38
cvt v255,v38,v39
v_add_f32 v27, v27, v39
s_nop 3
s_setpc_b64 s[0:1]
L_w0_rare3:
s_nop 15
s_mov_b32 s47, 4294901760
v_max3_f32 v41, v160, v161, v162
v_max3_f32 v42, v164, v165, v166
v_max3_f32 v43, v168, v169, v170
v_max3_f32 v44, v172, v173, v174
v_max3_f32 v41, v41, v163, v176
v_max3_f32 v42, v42, v167, v180
v_max3_f32 v43, v43, v171, v184
v_max3_f32 v44, v44, v175, v188
v_max3_f32 v41, v41, v177, v178
v_max3_f32 v42, v42, v181, v182
v_max3_f32 v43, v43, v185, v186
v_max3_f32 v44, v44, v189, v190
v_max_f32 v41, v41, v179
v_max_f32 v42, v42, v183
v_max_f32 v43, v43, v187
v_max_f32 v44, v44, v191
v_mov_b32 v32, v41
v_mov_b32 v33, v42
v_mov_b32 v34, v43
v_mov_b32 v35, v44
v_permlane32_swap_b32 v41, v32
v_permlane32_swap_b32 v42, v33
v_permlane32_swap_b32 v43, v34
v_permlane32_swap_b32 v44, v35
v_max_f32 v41, v41, v32
v_max_f32 v42, v42, v33
v_max_f32 v43, v43, v34
v_max_f32 v44, v44, v35
v_mov_b32 v32, v41
v_mov_b32 v33, v42
v_mov_b32 v34, v43
v_mov_b32 v35, v44
v_permlane16_swap_b32 v41, v32
v_permlane16_swap_b32 v42, v33
v_permlane16_swap_b32 v43, v34
v_permlane16_swap_b32 v44, v35
v_max_f32 v41, v41, v32
v_max_f32 v42, v42, v33
v_max_f32 v43, v43, v34
v_max_f32 v44, v44, v35
v_max_f32 v41, 0, v41
v_max_f32 v42, 0, v42
v_max_f32 v43, 0, v43
v_max_f32 v44, 0, v44
v_ceil_f32 v41, v41
v_ceil_f32 v42, v42
v_ceil_f32 v43, v43
v_ceil_f32 v44, v44
v_exp_f32 v36, -v41
v_exp_f32 v37, -v42
v_exp_f32 v38, -v43
v_exp_f32 v39, -v44
v_sub_f32 v160, v160, v41
v_sub_f32 v161, v161, v41
v_sub_f32 v162, v162, v41
v_sub_f32 v163, v163, v41
v_sub_f32 v176, v176, v41
v_sub_f32 v177, v177, v41
v_sub_f32 v178, v178, v41
v_sub_f32 v179, v179, v41
v_sub_f32 v224, v224, v41
v_sub_f32 v225, v225, v41
v_sub_f32 v226, v226, v41
v_sub_f32 v227, v227, v41
v_mul_f32 v28, v28, v36
ard v48,a0
ard v49,a1
ard v50,a2
ard v51,a3
ard v52,a16
ard v53,a17
ard v54,a18
ard v55,a19
v_mul_f32 v48, v48, v36
v_mul_f32 v49, v49, v36
v_mul_f32 v50, v50, v36
v_mul_f32 v51, v51, v36
v_mul_f32 v52, v52, v36
v_mul_f32 v53, v53, v36
v_mul_f32 v54, v54, v36
v_mul_f32 v55, v55, v36
awr a0,v48
awr a1,v49
awr a2,v50
awr a3,v51
awr a16,v52
awr a17,v53
awr a18,v54
awr a19,v55
ard v48,a32
ard v49,a33
ard v50,a34
ard v51,a35
ard v52,a48
ard v53,a49
ard v54,a50
ard v55,a51
v_mul_f32 v48, v48, v36
v_mul_f32 v49, v49, v36
v_mul_f32 v50, v50, v36
v_mul_f32 v51, v51, v36
v_mul_f32 v52, v52, v36
v_mul_f32 v53, v53, v36
v_mul_f32 v54, v54, v36
v_mul_f32 v55, v55, v36
awr a32,v48
awr a33,v49
awr a34,v50
awr a35,v51
awr a48,v52
awr a49,v53
awr a50,v54
awr a51,v55
ard v48,a64
ard v49,a65
ard v50,a66
ard v51,a67
ard v52,a80
ard v53,a81
ard v54,a82
ard v55,a83
v_mul_f32 v48, v48, v36
v_mul_f32 v49, v49, v36
v_mul_f32 v50, v50, v36
v_mul_f32 v51, v51, v36
v_mul_f32 v52, v52, v36
v_mul_f32 v53, v53, v36
v_mul_f32 v54, v54, v36
v_mul_f32 v55, v55, v36
awr a64,v48
awr a65,v49
awr a66,v50
awr a67,v51
awr a80,v52
awr a81,v53
awr a82,v54
awr a83,v55
ard v48,a96
ard v49,a97
ard v50,a98
ard v51,a99
ard v52,a112
ard v53,a113
ard v54,a114
ard v55,a115
v_mul_f32 v48, v48, v36
v_mul_f32 v49, v49, v36
v_mul_f32 v50, v50, v36
v_mul_f32 v51, v51, v36
v_mul_f32 v52, v52, v36
v_mul_f32 v53, v53, v36
v_mul_f32 v54, v54, v36
v_mul_f32 v55, v55, v36
awr a96,v48
awr a97,v49
awr a98,v50
awr a99,v51
awr a112,v52
awr a113,v53
awr a114,v54
awr a115,v55
ard v48,a128
ard v49,a129
ard v50,a130
ard v51,a131
ard v52,a144
ard v53,a145
ard v54,a146
ard v55,a147
v_mul_f32 v48, v48, v36
v_mul_f32 v49, v49, v36
v_mul_f32 v50, v50, v36
v_mul_f32 v51, v51, v36
v_mul_f32 v52, v52, v36
v_mul_f32 v53, v53, v36
v_mul_f32 v54, v54, v36
v_mul_f32 v55, v55, v36
awr a128,v48
awr a129,v49
awr a130,v50
awr a131,v51
awr a144,v52
awr a145,v53
awr a146,v54
awr a147,v55
ard v48,a160
ard v49,a161
ard v50,a162
ard v51,a163
ard v52,a176
ard v53,a177
ard v54,a178
ard v55,a179
v_mul_f32 v48, v48, v36
v_mul_f32 v49, v49, v36
v_mul_f32 v50, v50, v36
v_mul_f32 v51, v51, v36
v_mul_f32 v52, v52, v36
v_mul_f32 v53, v53, v36
v_mul_f32 v54, v54, v36
v_mul_f32 v55, v55, v36
awr a160,v48
awr a161,v49
awr a162,v50
awr a163,v51
awr a176,v52
awr a177,v53
awr a178,v54
awr a179,v55
v_lshlrev_b32 v48, 16, v240
v_and_b32 v49, s47, v240
v_lshlrev_b32 v50, 16, v241
v_and_b32 v51, s47, v241
v_lshlrev_b32 v52, 16, v242
v_and_b32 v53, s47, v242
v_lshlrev_b32 v54, 16, v243
v_and_b32 v55, s47, v243
v_mul_f32 v48, v48, v36
v_mul_f32 v49, v49, v36
v_mul_f32 v50, v50, v36
v_mul_f32 v51, v51, v36
v_mul_f32 v52, v52, v36
v_mul_f32 v53, v53, v36
v_mul_f32 v54, v54, v36
v_mul_f32 v55, v55, v36
cvt v240,v48,v49
cvt v241,v50,v51
cvt v242,v52,v53
cvt v243,v54,v55
v_sub_f32 v164, v164, v42
v_sub_f32 v165, v165, v42
v_sub_f32 v166, v166, v42
v_sub_f32 v167, v167, v42
v_sub_f32 v180, v180, v42
v_sub_f32 v181, v181, v42
v_sub_f32 v182, v182, v42
v_sub_f32 v183, v183, v42
v_sub_f32 v228, v228, v42
v_sub_f32 v229, v229, v42
v_sub_f32 v230, v230, v42
v_sub_f32 v231, v231, v42
v_mul_f32 v29, v29, v37
ard v48,a4
ard v49,a5
ard v50,a6
ard v51,a7
ard v52,a20
ard v53,a21
ard v54,a22
ard v55,a23
v_mul_f32 v48, v48, v37
v_mul_f32 v49, v49, v37
v_mul_f32 v50, v50, v37
v_mul_f32 v51, v51, v37
v_mul_f32 v52, v52, v37
v_mul_f32 v53, v53, v37
v_mul_f32 v54, v54, v37
v_mul_f32 v55, v55, v37
awr a4,v48
awr a5,v49
awr a6,v50
awr a7,v51
awr a20,v52
awr a21,v53
awr a22,v54
awr a23,v55
ard v48,a36
ard v49,a37
ard v50,a38
ard v51,a39
ard v52,a52
ard v53,a53
ard v54,a54
ard v55,a55
v_mul_f32 v48, v48, v37
v_mul_f32 v49, v49, v37
v_mul_f32 v50, v50, v37
v_mul_f32 v51, v51, v37
v_mul_f32 v52, v52, v37
v_mul_f32 v53, v53, v37
v_mul_f32 v54, v54, v37
v_mul_f32 v55, v55, v37
awr a36,v48
awr a37,v49
awr a38,v50
awr a39,v51
awr a52,v52
awr a53,v53
awr a54,v54
awr a55,v55
ard v48,a68
ard v49,a69
ard v50,a70
ard v51,a71
ard v52,a84
ard v53,a85
ard v54,a86
ard v55,a87
v_mul_f32 v48, v48, v37
v_mul_f32 v49, v49, v37
v_mul_f32 v50, v50, v37
v_mul_f32 v51, v51, v37
v_mul_f32 v52, v52, v37
v_mul_f32 v53, v53, v37
v_mul_f32 v54, v54, v37
v_mul_f32 v55, v55, v37
awr a68,v48
awr a69,v49
awr a70,v50
awr a71,v51
awr a84,v52
awr a85,v53
awr a86,v54
awr a87,v55
ard v48,a100
ard v49,a101
ard v50,a102
ard v51,a103
ard v52,a116
ard v53,a117
ard v54,a118
ard v55,a119
v_mul_f32 v48, v48, v37
v_mul_f32 v49, v49, v37
v_mul_f32 v50, v50, v37
v_mul_f32 v51, v51, v37
v_mul_f32 v52, v52, v37
v_mul_f32 v53, v53, v37
v_mul_f32 v54, v54, v37
v_mul_f32 v55, v55, v37
awr a100,v48
awr a101,v49
awr a102,v50
awr a103,v51
awr a116,v52
awr a117,v53
awr a118,v54
awr a119,v55
ard v48,a132
ard v49,a133
ard v50,a134
ard v51,a135
ard v52,a148
ard v53,a149
ard v54,a150
ard v55,a151
v_mul_f32 v48, v48, v37
v_mul_f32 v49, v49, v37
v_mul_f32 v50, v50, v37
v_mul_f32 v51, v51, v37
v_mul_f32 v52, v52, v37
v_mul_f32 v53, v53, v37
v_mul_f32 v54, v54, v37
v_mul_f32 v55, v55, v37
awr a132,v48
awr a133,v49
awr a134,v50
awr a135,v51
awr a148,v52
awr a149,v53
awr a150,v54
awr a151,v55
ard v48,a164
ard v49,a165
ard v50,a166
ard v51,a167
ard v52,a180
ard v53,a181
ard v54,a182
ard v55,a183
v_mul_f32 v48, v48, v37
v_mul_f32 v49, v49, v37
v_mul_f32 v50, v50, v37
v_mul_f32 v51, v51, v37
v_mul_f32 v52, v52, v37
v_mul_f32 v53, v53, v37
v_mul_f32 v54, v54, v37
v_mul_f32 v55, v55, v37
awr a164,v48
awr a165,v49
awr a166,v50
awr a167,v51
awr a180,v52
awr a181,v53
awr a182,v54
awr a183,v55
v_lshlrev_b32 v48, 16, v244
v_and_b32 v49, s47, v244
v_lshlrev_b32 v50, 16, v245
v_and_b32 v51, s47, v245
v_lshlrev_b32 v52, 16, v246
v_and_b32 v53, s47, v246
v_lshlrev_b32 v54, 16, v247
v_and_b32 v55, s47, v247
v_mul_f32 v48, v48, v37
v_mul_f32 v49, v49, v37
v_mul_f32 v50, v50, v37
v_mul_f32 v51, v51, v37
v_mul_f32 v52, v52, v37
v_mul_f32 v53, v53, v37
v_mul_f32 v54, v54, v37
v_mul_f32 v55, v55, v37
cvt v244,v48,v49
cvt v245,v50,v51
cvt v246,v52,v53
cvt v247,v54,v55
v_sub_f32 v168, v168, v43
v_sub_f32 v169, v169, v43
v_sub_f32 v170, v170, v43
v_sub_f32 v171, v171, v43
v_sub_f32 v184, v184, v43
v_sub_f32 v185, v185, v43
v_sub_f32 v186, v186, v43
v_sub_f32 v187, v187, v43
v_sub_f32 v232, v232, v43
v_sub_f32 v233, v233, v43
v_sub_f32 v234, v234, v43
v_sub_f32 v235, v235, v43
v_mul_f32 v30, v30, v38
ard v48,a8
ard v49,a9
ard v50,a10
ard v51,a11
ard v52,a24
ard v53,a25
ard v54,a26
ard v55,a27
v_mul_f32 v48, v48, v38
v_mul_f32 v49, v49, v38
v_mul_f32 v50, v50, v38
v_mul_f32 v51, v51, v38
v_mul_f32 v52, v52, v38
v_mul_f32 v53, v53, v38
v_mul_f32 v54, v54, v38
v_mul_f32 v55, v55, v38
awr a8,v48
awr a9,v49
awr a10,v50
awr a11,v51
awr a24,v52
awr a25,v53
awr a26,v54
awr a27,v55
ard v48,a40
ard v49,a41
ard v50,a42
ard v51,a43
ard v52,a56
ard v53,a57
ard v54,a58
ard v55,a59
v_mul_f32 v48, v48, v38
v_mul_f32 v49, v49, v38
v_mul_f32 v50, v50, v38
v_mul_f32 v51, v51, v38
v_mul_f32 v52, v52, v38
v_mul_f32 v53, v53, v38
v_mul_f32 v54, v54, v38
v_mul_f32 v55, v55, v38
awr a40,v48
awr a41,v49
awr a42,v50
awr a43,v51
awr a56,v52
awr a57,v53
awr a58,v54
awr a59,v55
ard v48,a72
ard v49,a73
ard v50,a74
ard v51,a75
ard v52,a88
ard v53,a89
ard v54,a90
ard v55,a91
v_mul_f32 v48, v48, v38
v_mul_f32 v49, v49, v38
v_mul_f32 v50, v50, v38
v_mul_f32 v51, v51, v38
v_mul_f32 v52, v52, v38
v_mul_f32 v53, v53, v38
v_mul_f32 v54, v54, v38
v_mul_f32 v55, v55, v38
awr a72,v48
awr a73,v49
awr a74,v50
awr a75,v51
awr a88,v52
awr a89,v53
awr a90,v54
awr a91,v55
ard v48,a104
ard v49,a105
ard v50,a106
ard v51,a107
ard v52,a120
ard v53,a121
ard v54,a122
ard v55,a123
v_mul_f32 v48, v48, v38
v_mul_f32 v49, v49, v38
v_mul_f32 v50, v50, v38
v_mul_f32 v51, v51, v38
v_mul_f32 v52, v52, v38
v_mul_f32 v53, v53, v38
v_mul_f32 v54, v54, v38
v_mul_f32 v55, v55, v38
awr a104,v48
awr a105,v49
awr a106,v50
awr a107,v51
awr a120,v52
awr a121,v53
awr a122,v54
awr a123,v55
ard v48,a136
ard v49,a137
ard v50,a138
ard v51,a139
ard v52,a152
ard v53,a153
ard v54,a154
ard v55,a155
v_mul_f32 v48, v48, v38
v_mul_f32 v49, v49, v38
v_mul_f32 v50, v50, v38
v_mul_f32 v51, v51, v38
v_mul_f32 v52, v52, v38
v_mul_f32 v53, v53, v38
v_mul_f32 v54, v54, v38
v_mul_f32 v55, v55, v38
awr a136,v48
awr a137,v49
awr a138,v50
awr a139,v51
awr a152,v52
awr a153,v53
awr a154,v54
awr a155,v55
ard v48,a168
ard v49,a169
ard v50,a170
ard v51,a171
ard v52,a184
ard v53,a185
ard v54,a186
ard v55,a187
v_mul_f32 v48, v48, v38
v_mul_f32 v49, v49, v38
v_mul_f32 v50, v50, v38
v_mul_f32 v51, v51, v38
v_mul_f32 v52, v52, v38
v_mul_f32 v53, v53, v38
v_mul_f32 v54, v54, v38
v_mul_f32 v55, v55, v38
awr a168,v48
awr a169,v49
awr a170,v50
awr a171,v51
awr a184,v52
awr a185,v53
awr a186,v54
awr a187,v55
v_lshlrev_b32 v48, 16, v248
v_and_b32 v49, s47, v248
v_lshlrev_b32 v50, 16, v249
v_and_b32 v51, s47, v249
v_lshlrev_b32 v52, 16, v250
v_and_b32 v53, s47, v250
v_lshlrev_b32 v54, 16, v251
v_and_b32 v55, s47, v251
v_mul_f32 v48, v48, v38
v_mul_f32 v49, v49, v38
v_mul_f32 v50, v50, v38
v_mul_f32 v51, v51, v38
v_mul_f32 v52, v52, v38
v_mul_f32 v53, v53, v38
v_mul_f32 v54, v54, v38
v_mul_f32 v55, v55, v38
cvt v248,v48,v49
cvt v249,v50,v51
cvt v250,v52,v53
cvt v251,v54,v55
v_sub_f32 v172, v172, v44
v_sub_f32 v173, v173, v44
v_sub_f32 v174, v174, v44
v_sub_f32 v175, v175, v44
v_sub_f32 v188, v188, v44
v_sub_f32 v189, v189, v44
v_sub_f32 v190, v190, v44
v_sub_f32 v191, v191, v44
v_sub_f32 v236, v236, v44
v_sub_f32 v237, v237, v44
v_sub_f32 v238, v238, v44
v_sub_f32 v239, v239, v44
v_mul_f32 v31, v31, v39
ard v48,a12
ard v49,a13
ard v50,a14
ard v51,a15
ard v52,a28
ard v53,a29
ard v54,a30
ard v55,a31
v_mul_f32 v48, v48, v39
v_mul_f32 v49, v49, v39
v_mul_f32 v50, v50, v39
v_mul_f32 v51, v51, v39
v_mul_f32 v52, v52, v39
v_mul_f32 v53, v53, v39
v_mul_f32 v54, v54, v39
v_mul_f32 v55, v55, v39
awr a12,v48
awr a13,v49
awr a14,v50
awr a15,v51
awr a28,v52
awr a29,v53
awr a30,v54
awr a31,v55
ard v48,a44
ard v49,a45
ard v50,a46
ard v51,a47
ard v52,a60
ard v53,a61
ard v54,a62
ard v55,a63
v_mul_f32 v48, v48, v39
v_mul_f32 v49, v49, v39
v_mul_f32 v50, v50, v39
v_mul_f32 v51, v51, v39
v_mul_f32 v52, v52, v39
v_mul_f32 v53, v53, v39
v_mul_f32 v54, v54, v39
v_mul_f32 v55, v55, v39
awr a44,v48
awr a45,v49
awr a46,v50
awr a47,v51
awr a60,v52
awr a61,v53
awr a62,v54
awr a63,v55
ard v48,a76
ard v49,a77
ard v50,a78
ard v51,a79
ard v52,a92
ard v53,a93
ard v54,a94
ard v55,a95
v_mul_f32 v48, v48, v39
v_mul_f32 v49, v49, v39
v_mul_f32 v50, v50, v39
v_mul_f32 v51, v51, v39
v_mul_f32 v52, v52, v39
v_mul_f32 v53, v53, v39
v_mul_f32 v54, v54, v39
v_mul_f32 v55, v55, v39
awr a76,v48
awr a77,v49
awr a78,v50
awr a79,v51
awr a92,v52
awr a93,v53
awr a94,v54
awr a95,v55
ard v48,a108
ard v49,a109
ard v50,a110
ard v51,a111
ard v52,a124
ard v53,a125
ard v54,a126
ard v55,a127
v_mul_f32 v48, v48, v39
v_mul_f32 v49, v49, v39
v_mul_f32 v50, v50, v39
v_mul_f32 v51, v51, v39
v_mul_f32 v52, v52, v39
v_mul_f32 v53, v53, v39
v_mul_f32 v54, v54, v39
v_mul_f32 v55, v55, v39
awr a108,v48
awr a109,v49
awr a110,v50
awr a111,v51
awr a124,v52
awr a125,v53
awr a126,v54
awr a127,v55
ard v48,a140
ard v49,a141
ard v50,a142
ard v51,a143
ard v52,a156
ard v53,a157
ard v54,a158
ard v55,a159
v_mul_f32 v48, v48, v39
v_mul_f32 v49, v49, v39
v_mul_f32 v50, v50, v39
v_mul_f32 v51, v51, v39
v_mul_f32 v52, v52, v39
v_mul_f32 v53, v53, v39
v_mul_f32 v54, v54, v39
v_mul_f32 v55, v55, v39
awr a140,v48
awr a141,v49
awr a142,v50
awr a143,v51
awr a156,v52
awr a157,v53
awr a158,v54
awr a159,v55
ard v48,a172
ard v49,a173
ard v50,a174
ard v51,a175
ard v52,a188
ard v53,a189
ard v54,a190
ard v55,a191
v_mul_f32 v48, v48, v39
v_mul_f32 v49, v49, v39
v_mul_f32 v50, v50, v39
v_mul_f32 v51, v51, v39
v_mul_f32 v52, v52, v39
v_mul_f32 v53, v53, v39
v_mul_f32 v54, v54, v39
v_mul_f32 v55, v55, v39
awr a172,v48
awr a173,v49
awr a174,v50
awr a175,v51
awr a188,v52
awr a189,v53
awr a190,v54
awr a191,v55
v_lshlrev_b32 v48, 16, v252
v_and_b32 v49, s47, v252
v_lshlrev_b32 v50, 16, v253
v_and_b32 v51, s47, v253
v_lshlrev_b32 v52, 16, v254
v_and_b32 v53, s47, v254
v_lshlrev_b32 v54, 16, v255
v_and_b32 v55, s47, v255
v_mul_f32 v48, v48, v39
v_mul_f32 v49, v49, v39
v_mul_f32 v50, v50, v39
v_mul_f32 v51, v51, v39
v_mul_f32 v52, v52, v39
v_mul_f32 v53, v53, v39
v_mul_f32 v54, v54, v39
v_mul_f32 v55, v55, v39
cvt v252,v48,v49
cvt v253,v50,v51
cvt v254,v52,v53
cvt v255,v54,v55
v_exp_f32 v32, v160
v_exp_f32 v33, v161
v_exp_f32 v34, v162
v_exp_f32 v35, v163
v_add_f32 v24, v32, v33
cvt v48,v32,v33
v_add_f32 v24, v24, v34
cvt v49,v34,v35
v_add_f32 v24, v24, v35
v_exp_f32 v36, v164
v_exp_f32 v37, v165
v_exp_f32 v38, v166
v_exp_f32 v39, v167
v_add_f32 v25, v36, v37
cvt v52,v36,v37
v_add_f32 v25, v25, v38
cvt v53,v38,v39
v_add_f32 v25, v25, v39
v_exp_f32 v32, v168
v_exp_f32 v33, v169
v_exp_f32 v34, v170
v_exp_f32 v35, v171
v_add_f32 v26, v32, v33
cvt v56,v32,v33
v_add_f32 v26, v26, v34
cvt v57,v34,v35
v_add_f32 v26, v26, v35
v_exp_f32 v36, v172
v_exp_f32 v37, v173
v_exp_f32 v38, v174
v_exp_f32 v39, v175
v_add_f32 v27, v36, v37
cvt v60,v36,v37
v_add_f32 v27, v27, v38
cvt v61,v38,v39
v_add_f32 v27, v27, v39
v_exp_f32 v32, v176
v_exp_f32 v33, v177
v_exp_f32 v34, v178
v_exp_f32 v35, v179
v_add_f32 v24, v24, v32
cvt v50,v32,v33
v_add_f32 v24, v24, v33
v_add_f32 v24, v24, v34
cvt v51,v34,v35
v_add_f32 v24, v24, v35
v_exp_f32 v36, v180
v_exp_f32 v37, v181
v_exp_f32 v38, v182
v_exp_f32 v39, v183
v_add_f32 v25, v25, v36
cvt v54,v36,v37
v_add_f32 v25, v25, v37
v_add_f32 v25, v25, v38
cvt v55,v38,v39
v_add_f32 v25, v25, v39
v_exp_f32 v32, v184
v_exp_f32 v33, v185
v_exp_f32 v34, v186
v_exp_f32 v35, v187
v_add_f32 v26, v26, v32
cvt v58,v32,v33
v_add_f32 v26, v26, v33
v_add_f32 v26, v26, v34
cvt v59,v34,v35
v_add_f32 v26, v26, v35
v_exp_f32 v36, v188
v_exp_f32 v37, v189
v_exp_f32 v38, v190
v_exp_f32 v39, v191
v_add_f32 v27, v27, v36
cvt v62,v36,v37
v_add_f32 v27, v27, v37
v_add_f32 v27, v27, v38
cvt v63,v38,v39
v_add_f32 v27, v27, v39
s_nop 3
s_setpc_b64 s[0:1]
.p2align 12
L_w0b:
s_waitcnt vmcnt(3)
s_barrier
ldq a[112:115],v52
ldt a[0:1],v54
ldt a[2:3],v54 offset:6144
ldq a[116:119],v52 offset:2048
ldq a[120:123],v52 offset:4096
ldq a[124:127],v52 offset:6144
ldt a[4:5],v54 offset:8
ldt a[6:7],v54 offset:6152
ldt a[8:9],v55
ldt a[10:11],v55 offset:6144
s_waitcnt lgkmcnt(7)
mma v[64:67],a[0:3],a[112:115],0
ldt a[12:13],v55 offset:8
s_add_u32 m0, s30, 24576
s_add_u32 s31, s29, 786432
s_waitcnt lgkmcnt(7)
bld v48,s[16:19],s31 offen lds
mma v[160:163],a[0:3],a[116:119],0
s_waitcnt lgkmcnt(6)
ldt a[14:15],v55 offset:6152
mma v[112:115],a[0:3],a[120:123],0
s_waitcnt lgkmcnt(6)
ldt a[16:17],v54 offset:128
mma v[208:211],a[0:3],a[124:127],0
s_waitcnt lgkmcnt(5)
ldt a[18:19],v54 offset:6272
bld v49,s[16:19],s31 offen offset:1024 lds
mma v[212:215],a[4:7],a[124:127],0
ldt a[20:21],v54 offset:136
mma v[116:119],a[4:7],a[120:123],0
ldt a[22:23],v54 offset:6280
mma v[164:167],a[4:7],a[116:119],0
ldt a[24:25],v55 offset:128
bld v50,s[16:19],s31 offen offset:2048 lds
mma v[68:71],a[4:7],a[112:115],0
s_waitcnt lgkmcnt(7)
ldt a[26:27],v55 offset:6272
mma v[72:75],a[8:11],a[112:115],0
ldt a[28:29],v55 offset:136
mma v[168:171],a[8:11],a[116:119],0
ldt a[30:31],v55 offset:6280
s_add_u32 m0, s30, 36864
s_add_u32 s31, s29, 1179648
bld v48,s[16:19],s31 offen lds
mma v[120:123],a[8:11],a[120:123],0
ldt a[32:33],v54 offset:256
mma v[216:219],a[8:11],a[124:127],0
s_waitcnt lgkmcnt(9)
ldt a[34:35],v54 offset:6400
mma v[220:223],a[12:15],a[124:127],0
ldt a[36:37],v54 offset:264
bld v49,s[16:19],s31 offen offset:1024 lds
mma v[124:127],a[12:15],a[120:123],0
ldt a[38:39],v54 offset:6408
mma v[172:175],a[12:15],a[116:119],0
ldt a[40:41],v55 offset:256
mma v[76:79],a[12:15],a[112:115],0
s_waitcnt lgkmcnt(11)
ldt a[42:43],v55 offset:6400
bld v50,s[16:19],s31 offen offset:2048 lds
mma v[80:83],a[16:19],a[112:115],0
ldt a[44:45],v55 offset:264
mma v[176:179],a[16:19],a[116:119],0
ldt a[46:47],v55 offset:6408
mma v[128:131],a[16:19],a[120:123],0
s_waitcnt vmcnt(6)
s_barrier
s_add_u32 m0, s27, 36864
s_add_u32 s31, s28, 128
bld v51,s[4:7],s31 offen lds
mma v[224:227],a[16:19],a[124:127],0
s_waitcnt lgkmcnt(12)
ldq a[128:131],v53
mma v[228:231],a[20:23],a[124:127],0
ldq a[132:135],v53 offset:2048
mma v[132:135],a[20:23],a[120:123],0
ldq a[136:139],v53 offset:4096
mma v[180:183],a[20:23],a[116:119],0
ldq a[140:143],v53 offset:6144
mma v[84:87],a[20:23],a[112:115],0
s_add_u32 s31, s28, 9344
s_waitcnt lgkmcnt(14)
bld v51,s[4:7],s31 offen offset:1024 lds
mma v[88:91],a[24:27],a[112:115],0
ldt a[48:49],v54 offset:12288
s_add_u32 m0, s27, 38912
s_add_u32 s31, s28, 20608
bld v51,s[4:7],s31 offen lds
mma v[184:187],a[24:27],a[116:119],0
ldt a[50:51],v54 offset:18432
mma v[136:139],a[24:27],a[120:123],0
ldt a[52:53],v54 offset:12296
mma v[232:235],a[24:27],a[124:127],0
s_waitcnt lgkmcnt(14)
ldt a[54:55],v54 offset:18440
mma v[236:239],a[28:31],a[124:127],0
s_add_u32 s31, s28, 29824
bld v51,s[4:7],s31 offen offset:1024 lds
mma v[140:143],a[28:31],a[120:123],0
ldt a[56:57],v55 offset:12288
mma v[188:191],a[28:31],a[116:119],0
ldt a[58:59],v55 offset:18432
mma v[92:95],a[28:31],a[112:115],0
s_waitcnt lgkmcnt(14)
ldt a[60:61],v55 offset:12296
mma v[96:99],a[32:35],a[112:115],0
s_add_u32 m0, s27, 40960
ldt a[62:63],v55 offset:18440
mma v[192:195],a[32:35],a[116:119],0
s_add_u32 s31, s28, 41088
bld v51,s[4:7],s31 offen lds
s_add_u32 s31, s28, 50304
bld v51,s[4:7],s31 offen offset:1024 lds
mma v[144:147],a[32:35],a[120:123],0
ldt a[64:65],v54 offset:12416
mma v[240:243],a[32:35],a[124:127],0
ldt a[66:67],v54 offset:18560
mma v[244:247],a[36:39],a[124:127],0
ldt a[68:69],v54 offset:12424
mma v[148:151],a[36:39],a[120:123],0
s_add_u32 m0, s27, 43008
ldt a[70:71],v54 offset:18568
mma v[196:199],a[36:39],a[116:119],0
s_add_u32 s31, s28, 61568
bld v51,s[4:7],s31 offen lds
mma v[100:103],a[36:39],a[112:115],0
ldt a[72:73],v55 offset:12416
s_add_u32 s31, s28, 70784
s_waitcnt lgkmcnt(14)
bld v51,s[4:7],s31 offen offset:1024 lds
mma v[104:107],a[40:43],a[112:115],0
ldt a[74:75],v55 offset:18560
mma v[200:203],a[40:43],a[116:119],0
ldt a[76:77],v55 offset:12424
mma v[152:155],a[40:43],a[120:123],0
ldt a[78:79],v55 offset:18568
mma v[248:251],a[40:43],a[124:127],0
mma v[252:255],a[44:47],a[124:127],0
ldt a[80:81],v54 offset:12544
mma v[156:159],a[44:47],a[120:123],0
ldt a[82:83],v54 offset:18688
mma v[204:207],a[44:47],a[116:119],0
ldt a[84:85],v54 offset:12552
mma v[108:111],a[44:47],a[112:115],0
s_waitcnt lgkmcnt(14)
ldt a[86:87],v54 offset:18696
mma v[64:67],a[48:51],a[128:131],v[64:67]
mma v[160:163],a[48:51],a[132:135],v[160:163]
ldt a[88:89],v55 offset:12544
mma v[112:115],a[48:51],a[136:139],v[112:115]
ldt a[90:91],v55 offset:18688
mma v[208:211],a[48:51],a[140:143],v[208:211]
ldt a[92:93],v55 offset:12552
mma v[212:215],a[52:55],a[140:143],v[212:215]
ldt a[94:95],v55 offset:18696
mma v[116:119],a[52:55],a[136:139],v[116:119]
mma v[164:167],a[52:55],a[132:135],v[164:167]
mma v[68:71],a[52:55],a[128:131],v[68:71]
s_waitcnt lgkmcnt(14)
mma v[72:75],a[56:59],a[128:131],v[72:75]
mma v[168:171],a[56:59],a[132:135],v[168:171]
mma v[120:123],a[56:59],a[136:139],v[120:123]
mma v[216:219],a[56:59],a[140:143],v[216:219]
mma v[220:223],a[60:63],a[140:143],v[220:223]
mma v[124:127],a[60:63],a[136:139],v[124:127]
s_waitcnt vmcnt(8) lgkmcnt(0)
s_barrier
mma v[172:175],a[60:63],a[132:135],v[172:175]
s_mov_b32 s20, s78
ldt a[96:97],v54 offset:24576
mma v[76:79],a[60:63],a[128:131],v[76:79]
s_mov_b32 s21, s79
ldt a[98:99],v54 offset:30720
mma v[80:83],a[64:67],a[128:131],v[80:83]
s_mov_b32 s22, 50331648
mma v[176:179],a[64:67],a[132:135],v[176:179]
s_mov_b32 s23, 131072
ldt a[100:101],v54 offset:36864
mma v[128:131],a[64:67],a[136:139],v[128:131]
s_mov_b32 s52, s76
ldt a[102:103],v54 offset:43008
mma v[224:227],a[64:67],a[140:143],v[224:227]
s_mov_b32 s53, s77
mma v[228:231],a[68:71],a[140:143],v[228:231]
s_mov_b32 s54, 256
ldt a[104:105],v54 offset:24584
mma v[132:135],a[68:71],a[136:139],v[132:135]
s_mov_b32 s55, 131072
ldt a[106:107],v54 offset:30728
mma v[180:183],a[68:71],a[132:135],v[180:183]
s_lshl_b32 s87, s2, 2
mma v[84:87],a[68:71],a[128:131],v[84:87]
s_add_u32 s87, s87, s24
ldt a[108:109],v54 offset:36872
mma v[88:91],a[72:75],a[128:131],v[88:91]
s_lshl_b32 s87, s87, 11
ldt a[110:111],v54 offset:43016
mma v[184:187],a[72:75],a[132:135],v[184:187]
s_add_u32 s87, s87, 48234496
v_lshlrev_b32 v21, 4, v1
v_mov_b32 v61, 2147483632
mma v[136:139],a[72:75],a[136:139],v[136:139]
ldt a[0:1],v55 offset:24576
v_mov_b32 v32, 0
mma v[232:235],a[72:75],a[140:143],v[232:235]
ldt a[2:3],v55 offset:30720
v_mov_b32 v33, 0
mma v[236:239],a[76:79],a[140:143],v[236:239]
s_add_u32 m0, s30, 0
s_add_u32 s31, s29, 1572864
bld v48,s[16:19],s31 offen lds
mma v[140:143],a[76:79],a[136:139],v[140:143]
ldt a[4:5],v55 offset:36864
v_mov_b32 v34, 0
mma v[188:191],a[76:79],a[132:135],v[188:191]
ldt a[6:7],v55 offset:43008
v_mov_b32 v35, 0
mma v[92:95],a[76:79],a[128:131],v[92:95]
s_lshl_b32 s3, s25, 5
v_mov_b32 v60, s3
v_cmp_eq_u32 vcc, 0, v1
mma v[96:99],a[80:83],a[128:131],v[96:99]
ldt a[8:9],v55 offset:24584
v_mov_b32 v47, 1
mma v[192:195],a[80:83],a[132:135],v[192:195]
ldt a[10:11],v55 offset:30728
v_xor_b32 v3, 64, v2
mma v[144:147],a[80:83],a[136:139],v[144:147]
s_waitcnt vmcnt(1)
ldq a[144:147],v52 offset:36864
bld v49,s[16:19],s31 offen offset:1024 lds
mma v[240:243],a[80:83],a[140:143],v[240:243]
ldq a[148:151],v52 offset:38912
v_cndmask_b32 v20, v61, v60, vcc
mma v[244:247],a[84:87],a[140:143],v[244:247]
ldq a[152:155],v52 offset:40960
v_xor_b32 v5, 32, v4
mma v[148:151],a[84:87],a[136:139],v[148:151]
ldq a[156:159],v52 offset:43008
v_xor_b32 v6, 64, v4
mma v[196:199],a[84:87],a[132:135],v[196:199]
ldq a[160:163],v53 offset:36864
v_xor_b32 v7, 96, v4
mma v[100:103],a[84:87],a[128:131],v[100:103]
ldq a[164:167],v53 offset:38912
v_lshrrev_b32 v60, 2, v1
mma v[104:107],a[88:91],a[128:131],v[104:107]
ldq a[168:171],v53 offset:40960
v_and_b32 v61, 3, v1
mma v[200:203],a[88:91],a[132:135],v[200:203]
ldq a[172:175],v53 offset:43008
v_lshlrev_b32 v61, 3, v61
mma v[152:155],a[88:91],a[136:139],v[152:155]
bld v50,s[16:19],s31 offen offset:2048 lds
mma v[248:251],a[88:91],a[140:143],v[248:251]
ldt a[12:13],v55 offset:36872
v_mul_u32_u24 v62, 320, v60
mma v[252:255],a[92:95],a[140:143],v[252:255]
ldt a[14:15],v55 offset:43016
v_and_b32 v63, 4, v60
mma v[156:159],a[92:95],a[136:139],v[156:159]
s_add_u32 m0, s30, 12288
ldt a[16:17],v54 offset:24704
v_lshlrev_b32 v63, 3, v63
mma v[204:207],a[92:95],a[132:135],v[204:207]
s_add_u32 s31, s29, 1966080
bld v48,s[16:19],s31 offen lds
mma v[108:111],a[92:95],a[128:131],v[108:111]
s_waitcnt lgkmcnt(10)
ldt a[18:19],v54 offset:30848
v_add3_u32 v15, v61, v62, v63
mma v[64:67],a[96:99],a[144:147],v[64:67]
s_waitcnt lgkmcnt(7)
ldt a[20:21],v54 offset:36992
v_xor_b32 v16, 32, v15
mma v[64:67],a[100:103],a[160:163],v[64:67]
s_waitcnt lgkmcnt(7)
ldt a[22:23],v54 offset:43136
v_mov_b32 v61, 2147483632
mma v[160:163],a[100:103],a[164:167],v[160:163]
ldt a[24:25],v54 offset:24712
v_lshl_add_u32 v60, v1, 2, s87
mma v[160:163],a[96:99],a[148:151],v[160:163]
ldt a[26:27],v54 offset:30856
v_cmp_gt_u32 vcc, 8, v1
mma v[112:115],a[96:99],a[152:155],v[112:115]
s_waitcnt lgkmcnt(9)
bld v49,s[16:19],s31 offen offset:1024 lds
mma v[112:115],a[100:103],a[168:171],v[112:115]
s_waitcnt lgkmcnt(8)
ldt a[28:29],v54 offset:37000
v_add_u32 v62, 1, v1
mma v[208:211],a[100:103],a[172:175],v[208:211]
ldt a[30:31],v54 offset:43144
v_lshlrev_b32 v62, 6, v62
mma v[208:211],a[96:99],a[156:159],v[208:211]
ldt a[32:33],v55 offset:24704
v_cndmask_b32 v18, v61, v60, vcc
mma v[212:215],a[104:107],a[156:159],v[212:215]
ldt a[34:35],v55 offset:30848
v_add_u32 v60, s2, v62
mma v[212:215],a[108:111],a[172:175],v[212:215]
ldt a[36:37],v55 offset:36992
v_and_b32 v60, 255, v60
mma v[116:119],a[108:111],a[168:171],v[116:119]
bld v50,s[16:19],s31 offen offset:2048 lds
mma v[116:119],a[104:107],a[152:155],v[116:119]
ldt a[38:39],v55 offset:43136
v_lshlrev_b32 v60, 13, v60
mma v[164:167],a[104:107],a[148:151],v[164:167]
s_lshl_b32 s3, s24, 11
ldt a[40:41],v55 offset:24712
mma v[164:167],a[108:111],a[164:167],v[164:167]
s_add_u32 s3, s3, 48234496
ldt a[42:43],v55 offset:30856
mma v[68:71],a[108:111],a[160:163],v[68:71]
s_and_b32 s47, s26, 3
ldt a[44:45],v55 offset:37000
mma v[68:71],a[104:107],a[144:147],v[68:71]
s_mul_i32 s33, s47, 320
ldt a[46:47],v55 offset:43144
mma v[72:75],a[0:3],a[144:147],v[72:75]
s_lshl_b32 s47, s47, 2
ldt a[48:49],v54 offset:24832
mma v[72:75],a[4:7],a[160:163],v[72:75]
s_add_u32 s3, s3, s47
ldt a[50:51],v54 offset:30976
v_cmp_gt_u32 vcc, 3, v1
mma v[168:171],a[4:7],a[164:167],v[168:171]
ldt a[52:53],v54 offset:37120
v_add_u32 v60, s3, v60
mma v[168:171],a[0:3],a[148:151],v[168:171]
s_add_u32 m0, s27, 0
s_add_u32 s31, s28, 256
bld v51,s[4:7],s31 offen lds
mma v[120:123],a[0:3],a[152:155],v[120:123]
ldt a[54:55],v54 offset:43264
v_cndmask_b32 v17, v61, v60, vcc
mma v[120:123],a[4:7],a[168:171],v[120:123]
s_mul_i32 s47, s24, 24576
ldt a[56:57],v54 offset:24840
mma v[216:219],a[4:7],a[172:175],v[216:219]
s_add_u32 s31, s28, 9472
bld v51,s[4:7],s31 offen offset:1024 lds
mma v[216:219],a[0:3],a[156:159],v[216:219]
s_mul_i32 s41, s2, 92160
ldt a[58:59],v54 offset:30984
mma v[220:223],a[8:11],a[156:159],v[220:223]
s_add_u32 m0, s27, 2048
s_waitcnt lgkmcnt(14)
ldt a[60:61],v54 offset:37128
mma v[220:223],a[12:15],a[172:175],v[220:223]
s_add_u32 s31, s28, 20736
bld v51,s[4:7],s31 offen lds
mma v[124:127],a[12:15],a[168:171],v[124:127]
s_add_u32 s41, s41, s47
ldt a[62:63],v54 offset:43272
mma v[124:127],a[8:11],a[152:155],v[124:127]
s_mul_i32 s59, s26, 245760
ldt a[64:65],v55 offset:24832
mma v[172:175],a[8:11],a[148:151],v[172:175]
s_add_u32 s59, s59, s33
ldt a[66:67],v55 offset:30976
mma v[172:175],a[12:15],a[164:167],v[172:175]
s_add_u32 s31, s28, 29952
bld v51,s[4:7],s31 offen offset:1024 lds
mma v[76:79],a[12:15],a[160:163],v[76:79]
s_add_u32 s3, s2, 64
ldt a[68:69],v55 offset:37120
mma v[76:79],a[8:11],a[144:147],v[76:79]
s_add_u32 m0, s27, 4096
ldt a[70:71],v55 offset:43264
mma v[80:83],a[16:19],a[144:147],v[80:83]
s_add_u32 s31, s28, 41216
bld v51,s[4:7],s31 offen lds
mma v[80:83],a[20:23],a[160:163],v[80:83]
s_and_b32 s3, s3, 255
ldt a[72:73],v55 offset:24840
mma v[176:179],a[20:23],a[164:167],v[176:179]
s_mul_i32 s56, s3, 92160
ldt a[74:75],v55 offset:30984
mma v[176:179],a[16:19],a[148:151],v[176:179]
s_add_u32 s31, s28, 50432
bld v51,s[4:7],s31 offen offset:1024 lds
mma v[128:131],a[16:19],a[152:155],v[128:131]
s_add_u32 s56, s56, s47
ldt a[76:77],v55 offset:37128
mma v[128:131],a[20:23],a[168:171],v[128:131]
s_lshr_b32 s3, s3, 6
ldt a[78:79],v55 offset:43272
mma v[224:227],a[20:23],a[172:175],v[224:227]
s_add_u32 m0, s27, 6144
mma v[224:227],a[16:19],a[156:159],v[224:227]
s_add_u32 s31, s28, 61696
bld v51,s[4:7],s31 offen lds
mma v[228:231],a[24:27],a[156:159],v[228:231]
s_and_b32 s60, s26, 28
mma v[228:231],a[28:31],a[172:175],v[228:231]
s_add_u32 s3, s3, s60
mma v[132:135],a[28:31],a[168:171],v[132:135]
s_add_u32 s31, s28, 70912
bld v51,s[4:7],s31 offen offset:1024 lds
mma v[132:135],a[24:27],a[152:155],v[132:135]
s_mul_i32 s60, s3, 245760
mma v[180:183],a[24:27],a[148:151],v[180:183]
s_add_u32 s60, s60, s33
mma v[180:183],a[28:31],a[164:167],v[180:183]
s_add_u32 s3, s2, 128
mma v[84:87],a[28:31],a[160:163],v[84:87]
s_and_b32 s3, s3, 255
mma v[84:87],a[24:27],a[144:147],v[84:87]
s_mul_i32 s57, s3, 92160
s_waitcnt lgkmcnt(14)
mma v[88:91],a[32:35],a[144:147],v[88:91]
s_waitcnt vmcnt(8) lgkmcnt(0)
s_barrier
mma v[88:91],a[36:39],a[160:163],v[88:91]
s_add_u32 s57, s57, s47
ldt a[80:81],v54
mma v[184:187],a[36:39],a[164:167],v[184:187]
s_lshr_b32 s3, s3, 6
ldt a[82:83],v54 offset:6144
mma v[184:187],a[32:35],a[148:151],v[184:187]
s_and_b32 s61, s26, 28
mma v[136:139],a[32:35],a[152:155],v[136:139]
s_add_u32 s3, s3, s61
ldt a[84:85],v54 offset:12288
mma v[136:139],a[36:39],a[168:171],v[136:139]
s_mul_i32 s61, s3, 245760
ldt a[86:87],v54 offset:18432
mma v[232:235],a[36:39],a[172:175],v[232:235]
s_add_u32 s61, s61, s33
mma v[232:235],a[32:35],a[156:159],v[232:235]
s_add_u32 s3, s2, 192
mma v[236:239],a[40:43],a[156:159],v[236:239]
s_and_b32 s3, s3, 255
ldt a[88:89],v54 offset:8
mma v[236:239],a[44:47],a[172:175],v[236:239]
s_mul_i32 s58, s3, 92160
ldt a[90:91],v54 offset:6152
mma v[140:143],a[44:47],a[168:171],v[140:143]
s_add_u32 s58, s58, s47
mma v[140:143],a[40:43],a[152:155],v[140:143]
s_lshr_b32 s3, s3, 6
ldt a[92:93],v54 offset:12296
mma v[188:191],a[40:43],a[148:151],v[188:191]
s_and_b32 s62, s26, 28
ldt a[94:95],v54 offset:18440
mma v[188:191],a[44:47],a[164:167],v[188:191]
s_add_u32 s3, s3, s62
mma v[92:95],a[44:47],a[160:163],v[92:95]
s_mul_i32 s62, s3, 245760
mma v[92:95],a[40:43],a[144:147],v[92:95]
s_add_u32 m0, s30, 24576
s_add_u32 s31, s29, 2359296
bld v48,s[16:19],s31 offen lds
mma v[96:99],a[48:51],a[144:147],v[96:99]
s_add_u32 s62, s62, s33
ldt a[100:101],v55
mma v[96:99],a[52:55],a[160:163],v[96:99]
s_lshl_b32 s3, s25, 2
ldt a[102:103],v55 offset:6144
mma v[192:195],a[52:55],a[164:167],v[192:195]
s_and_b32 s47, s26, 3
ldt a[96:97],v55 offset:12288
mma v[192:195],a[48:51],a[148:151],v[192:195]
s_add_u32 s3, s3, s47
ldt a[98:99],v55 offset:18432
mma v[144:147],a[48:51],a[152:155],v[144:147]
s_mul_i32 s3, s3, 614400
mma v[144:147],a[52:55],a[168:171],v[144:147]
s_add_u32 s3, s3, 25165824
mma v[240:243],a[52:55],a[172:175],v[240:243]
s_lshr_b32 s47, s26, 2
ldt a[108:109],v55 offset:8
mma v[240:243],a[48:51],a[156:159],v[240:243]
bld v49,s[16:19],s31 offen offset:1024 lds
mma v[244:247],a[56:59],a[156:159],v[244:247]
s_mul_i32 s46, s47, 76800
ldt a[110:111],v55 offset:6152
mma v[244:247],a[60:63],a[172:175],v[244:247]
s_add_u32 s46, s46, s3
mma v[148:151],a[60:63],a[168:171],v[148:151]
s_mul_i32 s47, s24, 20480
ldt a[104:105],v55 offset:12296
mma v[148:151],a[56:59],a[152:155],v[148:151]
s_add_u32 s46, s46, s47
ldt a[106:107],v55 offset:18440
mma v[196:199],a[56:59],a[148:151],v[196:199]
s_and_b32 s47, s26, 28
mma v[196:199],a[60:63],a[164:167],v[196:199]
s_add_u32 s47, s47, s24
ldt a[4:5],v54 offset:128
mma v[100:103],a[60:63],a[160:163],v[100:103]
s_lshr_b32 s96, s47, 1
ldt a[6:7],v54 offset:6272
mma v[100:103],a[56:59],a[144:147],v[100:103]
bld v50,s[16:19],s31 offen offset:2048 lds
mma v[104:107],a[64:67],a[144:147],v[104:107]
s_mul_i32 s96, s96, 5120
mma v[104:107],a[68:71],a[160:163],v[104:107]
s_add_u32 s96, s96, s3
ldt a[0:1],v54 offset:12416
mma v[200:203],a[68:71],a[164:167],v[200:203]
s_waitcnt vmcnt(3)
ldq a[112:115],v52
mma v[200:203],a[64:67],a[148:151],v[200:203]
s_and_b32 s3, s47, 1
ldq a[116:119],v52 offset:2048
mma v[152:155],a[64:67],a[152:155],v[152:155]
s_lshl_b32 s3, s3, 9
ldq a[120:123],v52 offset:4096
mma v[152:155],a[68:71],a[168:171],v[152:155]
s_add_u32 s96, s96, s3
ldq a[124:127],v52 offset:6144
mma v[248:251],a[68:71],a[172:175],v[248:251]
s_mul_i32 s97, s25, 30
ldq a[128:131],v53
mma v[248:251],a[64:67],a[156:159],v[248:251]
s_add_u32 s97, s97, s47
ldq a[132:135],v53 offset:2048
mma v[252:255],a[72:75],a[156:159],v[252:255]
s_mul_i32 s97, s97, 10240
ldq a[136:139],v53 offset:4096
mma v[252:255],a[76:79],a[172:175],v[252:255]
s_add_u32 m0, s30, 36864
ldq a[140:143],v53 offset:6144
mma v[156:159],a[76:79],a[168:171],v[156:159]
s_add_u32 s31, s29, 2752512
bld v48,s[16:19],s31 offen lds
mma v[156:159],a[72:75],a[152:155],v[156:159]
s_add_u32 s97, s97, s33
ldt a[2:3],v54 offset:18560
mma v[204:207],a[72:75],a[148:151],v[204:207]
s_cmp_ge_u32 s47, 30
s_cselect_b32 s97, -1, s97
ldt a[12:13],v54 offset:136
mma v[204:207],a[76:79],a[164:167],v[204:207]
s_mov_b32 s32, 0x3dd53b95
ldt a[14:15],v54 offset:6280
mma v[108:111],a[76:79],a[160:163],v[108:111]
s_mov_b32 s34, 0x47800000
ldt a[8:9],v54 offset:12424
mma v[108:111],a[72:75],a[144:147],v[108:111]
s_waitcnt lgkmcnt(11)
bld v49,s[16:19],s31 offen offset:1024 lds
mma v[64:67],a[80:83],a[112:115],v[64:67]
s_mov_b32 s63, 0
s_waitcnt lgkmcnt(7)
ldt a[10:11],v54 offset:18568
mma v[64:67],a[84:87],a[128:131],v[64:67]
s_mov_b32 s37, 0
s_waitcnt lgkmcnt(7)
ldt a[20:21],v55 offset:128
mma v[160:163],a[84:87],a[132:135],v[160:163]
s_mov_b32 s36, 0
ldt a[22:23],v55 offset:6272
v_mov_b32 v28, 0
mma v[160:163],a[80:83],a[116:119],v[160:163]
ldt a[16:17],v55 offset:12416
v_mov_b32 v29, 0
mma v[112:115],a[80:83],a[120:123],v[112:115]
s_waitcnt lgkmcnt(9)
ldt a[18:19],v55 offset:18560
v_mov_b32 v30, 0
mma v[112:115],a[84:87],a[136:139],v[112:115]
s_waitcnt lgkmcnt(9)
ldt a[28:29],v55 offset:136
v_mov_b32 v31, 0
mma v[208:211],a[84:87],a[140:143],v[208:211]
s_and_b32 s92, s2, 248
ldt a[30:31],v55 offset:6280
mma v[208:211],a[80:83],a[124:127],v[208:211]
bld v50,s[16:19],s31 offen offset:2048 lds
mma v[212:215],a[88:91],a[124:127],v[212:215]
s_lshl_b32 s92, s92, 2
ldt a[24:25],v55 offset:12424
mma v[212:215],a[92:95],a[140:143],v[212:215]
s_lshl_b32 s93, s24, 3
ldt a[26:27],v55 offset:18568
mma v[116:119],a[92:95],a[136:139],v[116:119]
s_add_u32 s92, s92, s93
ldt a[36:37],v54 offset:256
mma v[116:119],a[88:91],a[120:123],v[116:119]
s_lshl_b32 s92, s92, 11
ldt a[38:39],v54 offset:6400
mma v[164:167],a[88:91],a[116:119],v[164:167]
s_and_b32 s94, s26, 28
mma v[164:167],a[92:95],a[132:135],v[164:167]
s_add_u32 s92, s92, s94
ldt a[32:33],v54 offset:12544
mma v[68:71],a[92:95],a[128:131],v[68:71]
s_add_u32 s92, s92, 48234880
ldt a[34:35],v54 offset:18688
mma v[68:71],a[88:91],a[112:115],v[68:71]
s_sub_u32 s93, 30, s93
mma v[72:75],a[100:103],a[112:115],v[72:75]
s_mov_b32 s94, 9600
v_and_b32 v60, 7, v1
v_lshrrev_b32 v62, 3, v1
mma v[72:75],a[96:99],a[128:131],v[72:75]
ldt a[44:45],v54 offset:264
v_lshlrev_b32 v63, 11, v60
mma v[168:171],a[96:99],a[132:135],v[168:171]
ldt a[46:47],v54 offset:6408
v_lshl_add_u32 v63, v62, 7, v63
mma v[168:171],a[100:103],a[116:119],v[168:171]
s_add_u32 m0, s27, 0
s_add_u32 s31, s28, 384
bld v51,s[4:7],s31 offen lds
mma v[120:123],a[100:103],a[120:123],v[120:123]
v_add_u32 v63, s92, v63
v_mov_b32 v61, 2147483632
mma v[120:123],a[96:99],a[136:139],v[120:123]
ldt a[40:41],v54 offset:12552
v_cmp_gt_u32 vcc, s93, v60
mma v[216:219],a[96:99],a[140:143],v[216:219]
s_add_u32 s31, s28, 9600
bld v51,s[4:7],s31 offen offset:1024 lds
mma v[216:219],a[100:103],a[124:127],v[216:219]
ldt a[42:43],v54 offset:18696
v_lshlrev_b32 v62, 4, v60
mma v[220:223],a[108:111],a[124:127],v[220:223]
s_add_u32 m0, s27, 2048
ldt a[52:53],v55 offset:256
v_mul_u32_u24 v60, 1280, v60
mma v[220:223],a[104:107],a[140:143],v[220:223]
s_add_u32 s31, s28, 20864
bld v51,s[4:7],s31 offen lds
mma v[124:127],a[104:107],a[136:139],v[124:127]
ldt a[54:55],v55 offset:6400
v_cndmask_b32 v63, v61, v63, vcc
mma v[124:127],a[108:111],a[120:123],v[124:127]
v_cmp_gt_u32 vcc, 8, v1
v_and_b32 v14, 48, v1
mma v[172:175],a[108:111],a[116:119],v[172:175]
ldt a[48:49],v55 offset:12544
v_lshl_add_u32 v62, v14, 3, v62
mma v[172:175],a[104:107],a[132:135],v[172:175]
s_add_u32 s31, s28, 30080
bld v51,s[4:7],s31 offen offset:1024 lds
mma v[76:79],a[104:107],a[128:131],v[76:79]
ldt a[50:51],v55 offset:18688
v_cndmask_b32 v11, v61, v63, vcc
mma v[76:79],a[108:111],a[112:115],v[76:79]
s_add_u32 m0, s27, 4096
ldt a[60:61],v55 offset:264
v_add_u32 v14, v14, v60
mma v[80:83],a[4:7],a[112:115],v[80:83]
s_add_u32 s31, s28, 41344
s_waitcnt lgkmcnt(14)
bld v51,s[4:7],s31 offen lds
mma v[80:83],a[0:3],a[128:131],v[80:83]
ldt a[62:63],v55 offset:6408
v_and_b32 v60, 8, v1
mma v[176:179],a[0:3],a[132:135],v[176:179]
v_cmp_eq_u32 vcc, 0, v60
v_lshl_add_u32 v12, v60, 6, v62
mma v[176:179],a[4:7],a[116:119],v[176:179]
s_add_u32 s31, s28, 50560
bld v51,s[4:7],s31 offen offset:1024 lds
mma v[128:131],a[4:7],a[120:123],v[128:131]
ldt a[56:57],v55 offset:12552
v_mad_u32_u24 v13, v60, s94, v62
mma v[128:131],a[0:3],a[136:139],v[128:131]
ldt a[58:59],v55 offset:18696
v_cndmask_b32 v14, v61, v14, vcc
mma v[224:227],a[0:3],a[140:143],v[224:227]
s_add_u32 m0, s27, 6144
v_add_u32 v60, 73728, v2
v_add_u32 v61, 73728, v3
mma v[224:227],a[4:7],a[124:127],v[224:227]
s_add_u32 s31, s28, 61824
bld v51,s[4:7],s31 offen lds
mma v[228:231],a[12:15],a[124:127],v[228:231]
mma v[228:231],a[8:11],a[140:143],v[228:231]
mma v[132:135],a[8:11],a[136:139],v[132:135]
s_add_u32 s31, s28, 71040
bld v51,s[4:7],s31 offen offset:1024 lds
mma v[132:135],a[12:15],a[120:123],v[132:135]
mma v[180:183],a[12:15],a[116:119],v[180:183]
mma v[180:183],a[8:11],a[132:135],v[180:183]
mma v[84:87],a[8:11],a[128:131],v[84:87]
mma v[84:87],a[12:15],a[112:115],v[84:87]
mma v[88:91],a[20:23],a[112:115],v[88:91]
s_waitcnt vmcnt(8) lgkmcnt(0)
s_barrier
mma v[88:91],a[16:19],a[128:131],v[88:91]
ldt a[68:69],v54 offset:24576
mma v[184:187],a[16:19],a[132:135],v[184:187]
ldt a[70:71],v54 offset:30720
mma v[184:187],a[20:23],a[116:119],v[184:187]
mma v[136:139],a[20:23],a[120:123],v[136:139]
ldt a[64:65],v54 offset:36864
mma v[136:139],a[16:19],a[136:139],v[136:139]
ldt a[66:67],v54 offset:43008
mma v[232:235],a[16:19],a[140:143],v[232:235]
mma v[232:235],a[20:23],a[124:127],v[232:235]
mma v[236:239],a[28:31],a[124:127],v[236:239]
ldt a[76:77],v54 offset:24584
mma v[236:239],a[24:27],a[140:143],v[236:239]
ldt a[78:79],v54 offset:30728
mma v[140:143],a[24:27],a[136:139],v[140:143]
mma v[140:143],a[28:31],a[120:123],v[140:143]
ldt a[72:73],v54 offset:36872
mma v[188:191],a[28:31],a[116:119],v[188:191]
ldt a[74:75],v54 offset:43016
mma v[188:191],a[24:27],a[132:135],v[188:191]
mma v[92:95],a[24:27],a[128:131],v[92:95]
mma v[92:95],a[28:31],a[112:115],v[92:95]
s_add_u32 m0, s30, 0
s_add_u32 s31, s29, 3145728
bld v48,s[16:19],s31 offen lds
mma v[96:99],a[36:39],a[112:115],v[96:99]
ldt a[84:85],v55 offset:24576
mma v[96:99],a[32:35],a[128:131],v[96:99]
ldt a[86:87],v55 offset:30720
mma v[192:195],a[32:35],a[132:135],v[192:195]
ldt a[80:81],v55 offset:36864
mma v[192:195],a[36:39],a[116:119],v[192:195]
ldt a[82:83],v55 offset:43008
mma v[144:147],a[36:39],a[120:123],v[144:147]
mma v[144:147],a[32:35],a[136:139],v[144:147]
mma v[240:243],a[32:35],a[140:143],v[240:243]
ldt a[92:93],v55 offset:24584
mma v[240:243],a[36:39],a[124:127],v[240:243]
bld v49,s[16:19],s31 offen offset:1024 lds
mma v[244:247],a[44:47],a[124:127],v[244:247]
ldt a[94:95],v55 offset:30728
mma v[244:247],a[40:43],a[140:143],v[244:247]
mma v[148:151],a[40:43],a[136:139],v[148:151]
ldt a[88:89],v55 offset:36872
mma v[148:151],a[44:47],a[120:123],v[148:151]
ldt a[90:91],v55 offset:43016
mma v[196:199],a[44:47],a[116:119],v[196:199]
mma v[196:199],a[40:43],a[132:135],v[196:199]
ldt a[96:97],v54 offset:24704
mma v[100:103],a[40:43],a[128:131],v[100:103]
ldt a[98:99],v54 offset:30848
mma v[100:103],a[44:47],a[112:115],v[100:103]
bld v50,s[16:19],s31 offen offset:2048 lds
mma v[104:107],a[52:55],a[112:115],v[104:107]
mma v[104:107],a[48:51],a[128:131],v[104:107]
ldt a[100:101],v54 offset:36992
mma v[200:203],a[48:51],a[132:135],v[200:203]
s_waitcnt vmcnt(3)
ldq a[144:147],v52
mma v[200:203],a[52:55],a[116:119],v[200:203]
ldq a[148:151],v52 offset:2048
mma v[152:155],a[52:55],a[120:123],v[152:155]
ldq a[152:155],v52 offset:4096
mma v[152:155],a[48:51],a[136:139],v[152:155]
ldq a[156:159],v52 offset:6144
mma v[248:251],a[48:51],a[140:143],v[248:251]
ldq a[160:163],v53
mma v[248:251],a[52:55],a[124:127],v[248:251]
ldq a[164:167],v53 offset:2048
mma v[252:255],a[60:63],a[124:127],v[252:255]
ldq a[168:171],v53 offset:4096
mma v[252:255],a[56:59],a[140:143],v[252:255]
s_add_u32 m0, s30, 12288
ldq a[172:175],v53 offset:6144
mma v[156:159],a[56:59],a[136:139],v[156:159]
s_add_u32 s31, s29, 3538944
bld v48,s[16:19],s31 offen lds
mma v[156:159],a[60:63],a[120:123],v[156:159]
ldt a[102:103],v54 offset:43136
mma v[204:207],a[60:63],a[116:119],v[204:207]
ldt a[104:105],v54 offset:24712
mma v[204:207],a[56:59],a[132:135],v[204:207]
ldt a[106:107],v54 offset:30856
mma v[108:111],a[56:59],a[128:131],v[108:111]
ldt a[108:109],v54 offset:37000
mma v[108:111],a[60:63],a[112:115],v[108:111]
s_waitcnt lgkmcnt(11)
bld v49,s[16:19],s31 offen offset:1024 lds
mma v[64:67],a[68:71],a[144:147],v[64:67]
s_waitcnt lgkmcnt(7)
ldt a[110:111],v54 offset:43144
mma v[64:67],a[64:67],a[160:163],v[64:67]
s_waitcnt lgkmcnt(7)
ldt a[0:1],v55 offset:24704
mma v[160:163],a[64:67],a[164:167],v[160:163]
ldt a[2:3],v55 offset:30848
mma v[160:163],a[68:71],a[148:151],v[160:163]
ldt a[4:5],v55 offset:36992
mma v[112:115],a[68:71],a[152:155],v[112:115]
s_waitcnt lgkmcnt(9)
ldt a[6:7],v55 offset:43136
mma v[112:115],a[64:67],a[168:171],v[112:115]
s_waitcnt lgkmcnt(9)
ldt a[8:9],v55 offset:24712
mma v[208:211],a[64:67],a[172:175],v[208:211]
ldt a[10:11],v55 offset:30856
mma v[208:211],a[68:71],a[156:159],v[208:211]
bld v50,s[16:19],s31 offen offset:2048 lds
mma v[212:215],a[76:79],a[156:159],v[212:215]
ldt a[12:13],v55 offset:37000
mma v[212:215],a[72:75],a[172:175],v[212:215]
ldt a[14:15],v55 offset:43144
mma v[116:119],a[72:75],a[168:171],v[116:119]
ldt a[16:17],v54 offset:24832
mma v[116:119],a[76:79],a[152:155],v[116:119]
ldt a[18:19],v54 offset:30976
mma v[164:167],a[76:79],a[148:151],v[164:167]
mma v[164:167],a[72:75],a[164:167],v[164:167]
ldt a[20:21],v54 offset:37120
mma v[68:71],a[72:75],a[160:163],v[68:71]
ldt a[22:23],v54 offset:43264
mma v[68:71],a[76:79],a[144:147],v[68:71]
mma v[72:75],a[84:87],a[144:147],v[72:75]
mma v[72:75],a[80:83],a[160:163],v[72:75]
ldt a[24:25],v54 offset:24840
mma v[168:171],a[80:83],a[164:167],v[168:171]
ldt a[26:27],v54 offset:30984
mma v[168:171],a[84:87],a[148:151],v[168:171]
s_add_u32 m0, s27, 0
s_add_u32 s31, s28, 512
bld v51,s[4:7],s31 offen lds
mma v[120:123],a[84:87],a[152:155],v[120:123]
mma v[120:123],a[80:83],a[168:171],v[120:123]
ldt a[28:29],v54 offset:37128
mma v[216:219],a[80:83],a[172:175],v[216:219]
s_add_u32 s31, s28, 9728
bld v51,s[4:7],s31 offen offset:1024 lds
mma v[216:219],a[84:87],a[156:159],v[216:219]
ldt a[30:31],v54 offset:43272
mma v[220:223],a[92:95],a[156:159],v[220:223]
s_add_u32 m0, s27, 2048
ldt a[32:33],v55 offset:24832
mma v[220:223],a[88:91],a[172:175],v[220:223]
s_add_u32 s31, s28, 20992
bld v51,s[4:7],s31 offen lds
mma v[124:127],a[88:91],a[168:171],v[124:127]
ldt a[34:35],v55 offset:30976
mma v[124:127],a[92:95],a[152:155],v[124:127]
mma v[172:175],a[92:95],a[148:151],v[172:175]
ldt a[36:37],v55 offset:37120
mma v[172:175],a[88:91],a[164:167],v[172:175]
s_add_u32 s31, s28, 30208
bld v51,s[4:7],s31 offen offset:1024 lds
mma v[76:79],a[88:91],a[160:163],v[76:79]
ldt a[38:39],v55 offset:43264
mma v[76:79],a[92:95],a[144:147],v[76:79]
s_add_u32 m0, s27, 4096
ldt a[40:41],v55 offset:24840
mma v[80:83],a[96:99],a[144:147],v[80:83]
s_add_u32 s31, s28, 41472
s_waitcnt lgkmcnt(14)
bld v51,s[4:7],s31 offen lds
mma v[80:83],a[100:103],a[160:163],v[80:83]
ldt a[42:43],v55 offset:30984
mma v[176:179],a[100:103],a[164:167],v[176:179]
mma v[176:179],a[96:99],a[148:151],v[176:179]
s_add_u32 s31, s28, 50688
bld v51,s[4:7],s31 offen offset:1024 lds
mma v[128:131],a[96:99],a[152:155],v[128:131]
ldt a[44:45],v55 offset:37128
mma v[128:131],a[100:103],a[168:171],v[128:131]
ldt a[46:47],v55 offset:43272
mma v[224:227],a[100:103],a[172:175],v[224:227]
s_add_u32 m0, s27, 6144
mma v[224:227],a[96:99],a[156:159],v[224:227]
s_add_u32 s31, s28, 61952
bld v51,s[4:7],s31 offen lds
mma v[228:231],a[104:107],a[156:159],v[228:231]
mma v[228:231],a[108:111],a[172:175],v[228:231]
mma v[132:135],a[108:111],a[168:171],v[132:135]
s_add_u32 s31, s28, 71168
bld v51,s[4:7],s31 offen offset:1024 lds
mma v[132:135],a[104:107],a[152:155],v[132:135]
mma v[180:183],a[104:107],a[148:151],v[180:183]
mma v[180:183],a[108:111],a[164:167],v[180:183]
mma v[84:87],a[108:111],a[160:163],v[84:87]
mma v[84:87],a[104:107],a[144:147],v[84:87]
mma v[88:91],a[0:3],a[144:147],v[88:91]
s_waitcnt vmcnt(8) lgkmcnt(0)
s_barrier
mma v[88:91],a[4:7],a[160:163],v[88:91]
ldt a[48:49],v54
mma v[184:187],a[4:7],a[164:167],v[184:187]
ldt a[50:51],v54 offset:6144
mma v[184:187],a[0:3],a[148:151],v[184:187]
mma v[136:139],a[0:3],a[152:155],v[136:139]
ldt a[52:53],v54 offset:12288
mma v[136:139],a[4:7],a[168:171],v[136:139]
ldt a[54:55],v54 offset:18432
mma v[232:235],a[4:7],a[172:175],v[232:235]
mma v[232:235],a[0:3],a[156:159],v[232:235]
mma v[236:239],a[8:11],a[156:159],v[236:239]
ldt a[56:57],v54 offset:8
mma v[236:239],a[12:15],a[172:175],v[236:239]
ldt a[58:59],v54 offset:6152
mma v[140:143],a[12:15],a[168:171],v[140:143]
mma v[140:143],a[8:11],a[152:155],v[140:143]
ldt a[60:61],v54 offset:12296
mma v[188:191],a[8:11],a[148:151],v[188:191]
ldt a[62:63],v54 offset:18440
mma v[188:191],a[12:15],a[164:167],v[188:191]
mma v[92:95],a[12:15],a[160:163],v[92:95]
mma v[92:95],a[8:11],a[144:147],v[92:95]
s_add_u32 m0, s30, 24576
s_add_u32 s31, s29, 3932160
bld v48,s[16:19],s31 offen lds
mma v[96:99],a[16:19],a[144:147],v[96:99]
ldt a[64:65],v55
mma v[96:99],a[20:23],a[160:163],v[96:99]
ldt a[66:67],v55 offset:6144
mma v[192:195],a[20:23],a[164:167],v[192:195]
ldt a[68:69],v55 offset:12288
mma v[192:195],a[16:19],a[148:151],v[192:195]
ldt a[70:71],v55 offset:18432
mma v[144:147],a[16:19],a[152:155],v[144:147]
mma v[144:147],a[20:23],a[168:171],v[144:147]
mma v[240:243],a[20:23],a[172:175],v[240:243]
ldt a[72:73],v55 offset:8
mma v[240:243],a[16:19],a[156:159],v[240:243]
bld v49,s[16:19],s31 offen offset:1024 lds
mma v[244:247],a[24:27],a[156:159],v[244:247]
ldt a[74:75],v55 offset:6152
mma v[244:247],a[28:31],a[172:175],v[244:247]
mma v[148:151],a[28:31],a[168:171],v[148:151]
ldt a[76:77],v55 offset:12296
mma v[148:151],a[24:27],a[152:155],v[148:151]
ldt a[78:79],v55 offset:18440
mma v[196:199],a[24:27],a[148:151],v[196:199]
mma v[196:199],a[28:31],a[164:167],v[196:199]
ldt a[80:81],v54 offset:128
mma v[100:103],a[28:31],a[160:163],v[100:103]
ldt a[82:83],v54 offset:6272
mma v[100:103],a[24:27],a[144:147],v[100:103]
bld v50,s[16:19],s31 offen offset:2048 lds
mma v[104:107],a[32:35],a[144:147],v[104:107]
mma v[104:107],a[36:39],a[160:163],v[104:107]
ldt a[84:85],v54 offset:12416
mma v[200:203],a[36:39],a[164:167],v[200:203]
s_waitcnt vmcnt(3)
ldq a[112:115],v52
mma v[200:203],a[32:35],a[148:151],v[200:203]
ldq a[116:119],v52 offset:2048
mma v[152:155],a[32:35],a[152:155],v[152:155]
ldq a[120:123],v52 offset:4096
mma v[152:155],a[36:39],a[168:171],v[152:155]
ldq a[124:127],v52 offset:6144
mma v[248:251],a[36:39],a[172:175],v[248:251]
ldq a[128:131],v53
mma v[248:251],a[32:35],a[156:159],v[248:251]
ldq a[132:135],v53 offset:2048
mma v[252:255],a[40:43],a[156:159],v[252:255]
ldq a[136:139],v53 offset:4096
mma v[252:255],a[44:47],a[172:175],v[252:255]
s_add_u32 m0, s30, 36864
ldq a[140:143],v53 offset:6144
mma v[156:159],a[44:47],a[168:171],v[156:159]
s_add_u32 s31, s29, 4325376
bld v48,s[16:19],s31 offen lds
mma v[156:159],a[40:43],a[152:155],v[156:159]
ldt a[86:87],v54 offset:18560
mma v[204:207],a[40:43],a[148:151],v[204:207]
ldt a[88:89],v54 offset:136
mma v[204:207],a[44:47],a[164:167],v[204:207]
ldt a[90:91],v54 offset:6280
mma v[108:111],a[44:47],a[160:163],v[108:111]
ldt a[92:93],v54 offset:12424
mma v[108:111],a[40:43],a[144:147],v[108:111]
s_waitcnt lgkmcnt(11)
bld v49,s[16:19],s31 offen offset:1024 lds
mma v[64:67],a[48:51],a[112:115],v[64:67]
s_waitcnt lgkmcnt(7)
ldt a[94:95],v54 offset:18568
mma v[64:67],a[52:55],a[128:131],v[64:67]
s_waitcnt lgkmcnt(7)
ldt a[100:101],v55 offset:128
mma v[160:163],a[52:55],a[132:135],v[160:163]
ldt a[102:103],v55 offset:6272
mma v[160:163],a[48:51],a[116:119],v[160:163]
ldt a[96:97],v55 offset:12416
mma v[112:115],a[48:51],a[120:123],v[112:115]
s_waitcnt lgkmcnt(9)
ldt a[98:99],v55 offset:18560
mma v[112:115],a[52:55],a[136:139],v[112:115]
s_waitcnt lgkmcnt(9)
ldt a[108:109],v55 offset:136
mma v[208:211],a[52:55],a[140:143],v[208:211]
ldt a[110:111],v55 offset:6280
mma v[208:211],a[48:51],a[124:127],v[208:211]
bld v50,s[16:19],s31 offen offset:2048 lds
mma v[212:215],a[56:59],a[124:127],v[212:215]
ldt a[104:105],v55 offset:12424
mma v[212:215],a[60:63],a[140:143],v[212:215]
ldt a[106:107],v55 offset:18568
mma v[116:119],a[60:63],a[136:139],v[116:119]
ldt a[4:5],v54 offset:256
mma v[116:119],a[56:59],a[120:123],v[116:119]
ldt a[6:7],v54 offset:6400
mma v[164:167],a[56:59],a[116:119],v[164:167]
mma v[164:167],a[60:63],a[132:135],v[164:167]
ldt a[0:1],v54 offset:12544
mma v[68:71],a[60:63],a[128:131],v[68:71]
ldt a[2:3],v54 offset:18688
mma v[68:71],a[56:59],a[112:115],v[68:71]
mma v[72:75],a[64:67],a[112:115],v[72:75]
mma v[72:75],a[68:71],a[128:131],v[72:75]
ldt a[12:13],v54 offset:264
mma v[168:171],a[68:71],a[132:135],v[168:171]
ldt a[14:15],v54 offset:6408
mma v[168:171],a[64:67],a[116:119],v[168:171]
s_add_u32 m0, s27, 0
s_add_u32 s31, s28, 640
bld v51,s[4:7],s31 offen lds
mma v[120:123],a[64:67],a[120:123],v[120:123]
mma v[120:123],a[68:71],a[136:139],v[120:123]
ldt a[8:9],v54 offset:12552
mma v[216:219],a[68:71],a[140:143],v[216:219]
s_add_u32 s31, s28, 9856
bld v51,s[4:7],s31 offen offset:1024 lds
mma v[216:219],a[64:67],a[124:127],v[216:219]
ldt a[10:11],v54 offset:18696
mma v[220:223],a[72:75],a[124:127],v[220:223]
s_add_u32 m0, s27, 2048
ldt a[20:21],v55 offset:256
mma v[220:223],a[76:79],a[140:143],v[220:223]
s_add_u32 s31, s28, 21120
bld v51,s[4:7],s31 offen lds
mma v[124:127],a[76:79],a[136:139],v[124:127]
ldt a[22:23],v55 offset:6400
mma v[124:127],a[72:75],a[120:123],v[124:127]
mma v[172:175],a[72:75],a[116:119],v[172:175]
ldt a[16:17],v55 offset:12544
mma v[172:175],a[76:79],a[132:135],v[172:175]
s_add_u32 s31, s28, 30336
bld v51,s[4:7],s31 offen offset:1024 lds
mma v[76:79],a[76:79],a[128:131],v[76:79]
ldt a[18:19],v55 offset:18688
mma v[76:79],a[72:75],a[112:115],v[76:79]
s_add_u32 m0, s27, 4096
ldt a[28:29],v55 offset:264
mma v[80:83],a[80:83],a[112:115],v[80:83]
s_add_u32 s31, s28, 41600
s_waitcnt lgkmcnt(14)
bld v51,s[4:7],s31 offen lds
mma v[80:83],a[84:87],a[128:131],v[80:83]
ldt a[30:31],v55 offset:6408
mma v[176:179],a[84:87],a[132:135],v[176:179]
mma v[176:179],a[80:83],a[116:119],v[176:179]
s_add_u32 s31, s28, 50816
bld v51,s[4:7],s31 offen offset:1024 lds
mma v[128:131],a[80:83],a[120:123],v[128:131]
ldt a[24:25],v55 offset:12552
mma v[128:131],a[84:87],a[136:139],v[128:131]
ldt a[26:27],v55 offset:18696
mma v[224:227],a[84:87],a[140:143],v[224:227]
s_add_u32 m0, s27, 6144
mma v[224:227],a[80:83],a[124:127],v[224:227]
s_add_u32 s31, s28, 62080
bld v51,s[4:7],s31 offen lds
mma v[228:231],a[88:91],a[124:127],v[228:231]
mma v[228:231],a[92:95],a[140:143],v[228:231]
mma v[132:135],a[92:95],a[136:139],v[132:135]
s_add_u32 s31, s28, 71296
bld v51,s[4:7],s31 offen offset:1024 lds
mma v[132:135],a[88:91],a[120:123],v[132:135]
mma v[180:183],a[88:91],a[116:119],v[180:183]
mma v[180:183],a[92:95],a[132:135],v[180:183]
mma v[84:87],a[92:95],a[128:131],v[84:87]
mma v[84:87],a[88:91],a[112:115],v[84:87]
mma v[88:91],a[100:103],a[112:115],v[88:91]
s_waitcnt vmcnt(8) lgkmcnt(0)
s_barrier
mma v[88:91],a[96:99],a[128:131],v[88:91]
ldt a[36:37],v54 offset:24576
mma v[184:187],a[96:99],a[132:135],v[184:187]
ldt a[38:39],v54 offset:30720
mma v[184:187],a[100:103],a[116:119],v[184:187]
mma v[136:139],a[100:103],a[120:123],v[136:139]
ldt a[32:33],v54 offset:36864
mma v[136:139],a[96:99],a[136:139],v[136:139]
ldt a[34:35],v54 offset:43008
mma v[232:235],a[96:99],a[140:143],v[232:235]
mma v[232:235],a[100:103],a[124:127],v[232:235]
mma v[236:239],a[108:111],a[124:127],v[236:239]
ldt a[44:45],v54 offset:24584
mma v[236:239],a[104:107],a[140:143],v[236:239]
ldt a[46:47],v54 offset:30728
mma v[140:143],a[104:107],a[136:139],v[140:143]
mma v[140:143],a[108:111],a[120:123],v[140:143]
ldt a[40:41],v54 offset:36872
mma v[188:191],a[108:111],a[116:119],v[188:191]
ldt a[42:43],v54 offset:43016
mma v[188:191],a[104:107],a[132:135],v[188:191]
mma v[92:95],a[104:107],a[128:131],v[92:95]
mma v[92:95],a[108:111],a[112:115],v[92:95]
s_add_u32 m0, s30, 0
s_add_u32 s31, s29, 4718592
bld v48,s[16:19],s31 offen lds
mma v[96:99],a[4:7],a[112:115],v[96:99]
ldt a[52:53],v55 offset:24576
mma v[96:99],a[0:3],a[128:131],v[96:99]
ldt a[54:55],v55 offset:30720
mma v[192:195],a[0:3],a[132:135],v[192:195]
ldt a[48:49],v55 offset:36864
mma v[192:195],a[4:7],a[116:119],v[192:195]
ldt a[50:51],v55 offset:43008
mma v[144:147],a[4:7],a[120:123],v[144:147]
mma v[144:147],a[0:3],a[136:139],v[144:147]
mma v[240:243],a[0:3],a[140:143],v[240:243]
ldt a[60:61],v55 offset:24584
mma v[240:243],a[4:7],a[124:127],v[240:243]
bld v49,s[16:19],s31 offen offset:1024 lds
mma v[244:247],a[12:15],a[124:127],v[244:247]
ldt a[62:63],v55 offset:30728
mma v[244:247],a[8:11],a[140:143],v[244:247]
mma v[148:151],a[8:11],a[136:139],v[148:151]
ldt a[56:57],v55 offset:36872
mma v[148:151],a[12:15],a[120:123],v[148:151]
ldt a[58:59],v55 offset:43016
mma v[196:199],a[12:15],a[116:119],v[196:199]
mma v[196:199],a[8:11],a[132:135],v[196:199]
ldt a[68:69],v54 offset:24704
mma v[100:103],a[8:11],a[128:131],v[100:103]
ldt a[70:71],v54 offset:30848
mma v[100:103],a[12:15],a[112:115],v[100:103]
bld v50,s[16:19],s31 offen offset:2048 lds
mma v[104:107],a[20:23],a[112:115],v[104:107]
mma v[104:107],a[16:19],a[128:131],v[104:107]
ldt a[64:65],v54 offset:36992
mma v[200:203],a[16:19],a[132:135],v[200:203]
s_waitcnt vmcnt(3)
ldq a[144:147],v52
mma v[200:203],a[20:23],a[116:119],v[200:203]
ldq a[148:151],v52 offset:2048
mma v[152:155],a[20:23],a[120:123],v[152:155]
ldq a[152:155],v52 offset:4096
mma v[152:155],a[16:19],a[136:139],v[152:155]
ldq a[156:159],v52 offset:6144
mma v[248:251],a[16:19],a[140:143],v[248:251]
ldq a[160:163],v53
mma v[248:251],a[20:23],a[124:127],v[248:251]
ldq a[164:167],v53 offset:2048
mma v[252:255],a[28:31],a[124:127],v[252:255]
ldq a[168:171],v53 offset:4096
mma v[252:255],a[24:27],a[140:143],v[252:255]
s_add_u32 m0, s30, 12288
ldq a[172:175],v53 offset:6144
mma v[156:159],a[24:27],a[136:139],v[156:159]
s_add_u32 s31, s29, 5111808
bld v48,s[16:19],s31 offen lds
mma v[156:159],a[28:31],a[120:123],v[156:159]
ldt a[66:67],v54 offset:43136
mma v[204:207],a[28:31],a[116:119],v[204:207]
ldt a[76:77],v54 offset:24712
mma v[204:207],a[24:27],a[132:135],v[204:207]
ldt a[78:79],v54 offset:30856
mma v[108:111],a[24:27],a[128:131],v[108:111]
ldt a[72:73],v54 offset:37000
mma v[108:111],a[28:31],a[112:115],v[108:111]
s_waitcnt lgkmcnt(11)
bld v49,s[16:19],s31 offen offset:1024 lds
mma v[64:67],a[36:39],a[144:147],v[64:67]
s_waitcnt lgkmcnt(7)
ldt a[74:75],v54 offset:43144
mma v[64:67],a[32:35],a[160:163],v[64:67]
s_waitcnt lgkmcnt(7)
ldt a[84:85],v55 offset:24704
mma v[160:163],a[32:35],a[164:167],v[160:163]
ldt a[86:87],v55 offset:30848
mma v[160:163],a[36:39],a[148:151],v[160:163]
ldt a[80:81],v55 offset:36992
mma v[112:115],a[36:39],a[152:155],v[112:115]
s_waitcnt lgkmcnt(9)
ldt a[82:83],v55 offset:43136
mma v[112:115],a[32:35],a[168:171],v[112:115]
s_waitcnt lgkmcnt(9)
ldt a[92:93],v55 offset:24712
mma v[208:211],a[32:35],a[172:175],v[208:211]
ldt a[94:95],v55 offset:30856
mma v[208:211],a[36:39],a[156:159],v[208:211]
bld v50,s[16:19],s31 offen offset:2048 lds
mma v[212:215],a[44:47],a[156:159],v[212:215]
ldt a[88:89],v55 offset:37000
mma v[212:215],a[40:43],a[172:175],v[212:215]
ldt a[90:91],v55 offset:43144
mma v[116:119],a[40:43],a[168:171],v[116:119]
ldt a[96:97],v54 offset:24832
mma v[116:119],a[44:47],a[152:155],v[116:119]
ldt a[98:99],v54 offset:30976
mma v[164:167],a[44:47],a[148:151],v[164:167]
mma v[164:167],a[40:43],a[164:167],v[164:167]
ldt a[100:101],v54 offset:37120
mma v[68:71],a[40:43],a[160:163],v[68:71]
ldt a[102:103],v54 offset:43264
mma v[68:71],a[44:47],a[144:147],v[68:71]
mma v[72:75],a[52:55],a[144:147],v[72:75]
mma v[72:75],a[48:51],a[160:163],v[72:75]
ldt a[104:105],v54 offset:24840
mma v[168:171],a[48:51],a[164:167],v[168:171]
ldt a[106:107],v54 offset:30984
mma v[168:171],a[52:55],a[148:151],v[168:171]
s_add_u32 m0, s27, 0
s_add_u32 s31, s28, 768
bld v51,s[4:7],s31 offen lds
mma v[120:123],a[52:55],a[152:155],v[120:123]
mma v[120:123],a[48:51],a[168:171],v[120:123]
ldt a[108:109],v54 offset:37128
mma v[216:219],a[48:51],a[172:175],v[216:219]
s_add_u32 s31, s28, 9984
bld v51,s[4:7],s31 offen offset:1024 lds
mma v[216:219],a[52:55],a[156:159],v[216:219]
ldt a[110:111],v54 offset:43272
mma v[220:223],a[60:63],a[156:159],v[220:223]
s_add_u32 m0, s27, 2048
ldt a[0:1],v55 offset:24832
mma v[220:223],a[56:59],a[172:175],v[220:223]
s_add_u32 s31, s28, 21248
bld v51,s[4:7],s31 offen lds
mma v[124:127],a[56:59],a[168:171],v[124:127]
ldt a[2:3],v55 offset:30976
mma v[124:127],a[60:63],a[152:155],v[124:127]
mma v[172:175],a[60:63],a[148:151],v[172:175]
ldt a[4:5],v55 offset:37120
mma v[172:175],a[56:59],a[164:167],v[172:175]
s_add_u32 s31, s28, 30464
bld v51,s[4:7],s31 offen offset:1024 lds
mma v[76:79],a[56:59],a[160:163],v[76:79]
ldt a[6:7],v55 offset:43264
mma v[76:79],a[60:63],a[144:147],v[76:79]
s_add_u32 m0, s27, 4096
ldt a[8:9],v55 offset:24840
mma v[80:83],a[68:71],a[144:147],v[80:83]
s_add_u32 s31, s28, 41728
s_waitcnt lgkmcnt(14)
bld v51,s[4:7],s31 offen lds
mma v[80:83],a[64:67],a[160:163],v[80:83]
ldt a[10:11],v55 offset:30984
mma v[176:179],a[64:67],a[164:167],v[176:179]
mma v[176:179],a[68:71],a[148:151],v[176:179]
s_add_u32 s31, s28, 50944
bld v51,s[4:7],s31 offen offset:1024 lds
mma v[128:131],a[68:71],a[152:155],v[128:131]
ldt a[12:13],v55 offset:37128
mma v[128:131],a[64:67],a[168:171],v[128:131]
ldt a[14:15],v55 offset:43272
mma v[224:227],a[64:67],a[172:175],v[224:227]
s_add_u32 m0, s27, 6144
mma v[224:227],a[68:71],a[156:159],v[224:227]
s_add_u32 s31, s28, 62208
bld v51,s[4:7],s31 offen lds
mma v[228:231],a[76:79],a[156:159],v[228:231]
mma v[228:231],a[72:75],a[172:175],v[228:231]
mma v[132:135],a[72:75],a[168:171],v[132:135]
s_add_u32 s31, s28, 71424
bld v51,s[4:7],s31 offen offset:1024 lds
mma v[132:135],a[76:79],a[152:155],v[132:135]
mma v[180:183],a[76:79],a[148:151],v[180:183]
mma v[180:183],a[72:75],a[164:167],v[180:183]
mma v[84:87],a[72:75],a[160:163],v[84:87]
mma v[84:87],a[76:79],a[144:147],v[84:87]
mma v[88:91],a[84:87],a[144:147],v[88:91]
s_waitcnt vmcnt(8) lgkmcnt(0)
s_barrier
mma v[88:91],a[80:83],a[160:163],v[88:91]
ldt a[16:17],v54
mma v[184:187],a[80:83],a[164:167],v[184:187]
ldt a[18:19],v54 offset:6144
mma v[184:187],a[84:87],a[148:151],v[184:187]
mma v[136:139],a[84:87],a[152:155],v[136:139]
ldt a[20:21],v54 offset:12288
mma v[136:139],a[80:83],a[168:171],v[136:139]
ldt a[22:23],v54 offset:18432
mma v[232:235],a[80:83],a[172:175],v[232:235]
mma v[232:235],a[84:87],a[156:159],v[232:235]
mma v[236:239],a[92:95],a[156:159],v[236:239]
ldt a[24:25],v54 offset:8
mma v[236:239],a[88:91],a[172:175],v[236:239]
ldt a[26:27],v54 offset:6152
mma v[140:143],a[88:91],a[168:171],v[140:143]
mma v[140:143],a[92:95],a[152:155],v[140:143]
ldt a[28:29],v54 offset:12296
mma v[188:191],a[92:95],a[148:151],v[188:191]
ldt a[30:31],v54 offset:18440
mma v[188:191],a[88:91],a[164:167],v[188:191]
mma v[92:95],a[88:91],a[160:163],v[92:95]
mma v[92:95],a[92:95],a[144:147],v[92:95]
s_add_u32 m0, s30, 24576
s_add_u32 s31, s29, 5505024
bld v48,s[16:19],s31 offen lds
mma v[96:99],a[96:99],a[144:147],v[96:99]
ldt a[32:33],v55
mma v[96:99],a[100:103],a[160:163],v[96:99]
ldt a[34:35],v55 offset:6144
mma v[192:195],a[100:103],a[164:167],v[192:195]
ldt a[36:37],v55 offset:12288
mma v[192:195],a[96:99],a[148:151],v[192:195]
ldt a[38:39],v55 offset:18432
mma v[144:147],a[96:99],a[152:155],v[144:147]
mma v[144:147],a[100:103],a[168:171],v[144:147]
mma v[240:243],a[100:103],a[172:175],v[240:243]
ldt a[40:41],v55 offset:8
mma v[240:243],a[96:99],a[156:159],v[240:243]
bld v49,s[16:19],s31 offen offset:1024 lds
mma v[244:247],a[104:107],a[156:159],v[244:247]
ldt a[42:43],v55 offset:6152
mma v[244:247],a[108:111],a[172:175],v[244:247]
mma v[148:151],a[108:111],a[168:171],v[148:151]
ldt a[44:45],v55 offset:12296
mma v[148:151],a[104:107],a[152:155],v[148:151]
ldt a[46:47],v55 offset:18440
mma v[196:199],a[104:107],a[148:151],v[196:199]
mma v[196:199],a[108:111],a[164:167],v[196:199]
ldt a[48:49],v54 offset:128
mma v[100:103],a[108:111],a[160:163],v[100:103]
ldt a[50:51],v54 offset:6272
mma v[100:103],a[104:107],a[144:147],v[100:103]
bld v50,s[16:19],s31 offen offset:2048 lds
mma v[104:107],a[0:3],a[144:147],v[104:107]
mma v[104:107],a[4:7],a[160:163],v[104:107]
ldt a[52:53],v54 offset:12416
mma v[200:203],a[4:7],a[164:167],v[200:203]
s_waitcnt vmcnt(3)
ldq a[112:115],v52
mma v[200:203],a[0:3],a[148:151],v[200:203]
ldq a[116:119],v52 offset:2048
mma v[152:155],a[0:3],a[152:155],v[152:155]
ldq a[120:123],v52 offset:4096
mma v[152:155],a[4:7],a[168:171],v[152:155]
ldq a[124:127],v52 offset:6144
mma v[248:251],a[4:7],a[172:175],v[248:251]
ldq a[128:131],v53
mma v[248:251],a[0:3],a[156:159],v[248:251]
ldq a[132:135],v53 offset:2048
mma v[252:255],a[8:11],a[156:159],v[252:255]
ldq a[136:139],v53 offset:4096
mma v[252:255],a[12:15],a[172:175],v[252:255]
s_add_u32 m0, s30, 36864
ldq a[140:143],v53 offset:6144
mma v[156:159],a[12:15],a[168:171],v[156:159]
s_add_u32 s31, s29, 5898240
bld v48,s[16:19],s31 offen lds
mma v[156:159],a[8:11],a[152:155],v[156:159]
ldt a[54:55],v54 offset:18560
mma v[204:207],a[8:11],a[148:151],v[204:207]
ldt a[56:57],v54 offset:136
mma v[204:207],a[12:15],a[164:167],v[204:207]
ldt a[58:59],v54 offset:6280
mma v[108:111],a[12:15],a[160:163],v[108:111]
ldt a[60:61],v54 offset:12424
mma v[108:111],a[8:11],a[144:147],v[108:111]
s_waitcnt lgkmcnt(11)
bld v49,s[16:19],s31 offen offset:1024 lds
mma v[64:67],a[16:19],a[112:115],v[64:67]
s_waitcnt lgkmcnt(7)
ldt a[62:63],v54 offset:18568
mma v[64:67],a[20:23],a[128:131],v[64:67]
s_waitcnt lgkmcnt(7)
ldt a[64:65],v55 offset:128
mma v[160:163],a[20:23],a[132:135],v[160:163]
ldt a[66:67],v55 offset:6272
mma v[160:163],a[16:19],a[116:119],v[160:163]
ldt a[68:69],v55 offset:12416
mma v[112:115],a[16:19],a[120:123],v[112:115]
s_waitcnt lgkmcnt(9)
ldt a[70:71],v55 offset:18560
mma v[112:115],a[20:23],a[136:139],v[112:115]
s_waitcnt lgkmcnt(9)
ldt a[72:73],v55 offset:136
mma v[208:211],a[20:23],a[140:143],v[208:211]
ldt a[74:75],v55 offset:6280
mma v[208:211],a[16:19],a[124:127],v[208:211]
bld v50,s[16:19],s31 offen offset:2048 lds
mma v[212:215],a[24:27],a[124:127],v[212:215]
ldt a[76:77],v55 offset:12424
mma v[212:215],a[28:31],a[140:143],v[212:215]
ldt a[78:79],v55 offset:18568
mma v[116:119],a[28:31],a[136:139],v[116:119]
ldt a[80:81],v54 offset:256
mma v[116:119],a[24:27],a[120:123],v[116:119]
ldt a[82:83],v54 offset:6400
mma v[164:167],a[24:27],a[116:119],v[164:167]
mma v[164:167],a[28:31],a[132:135],v[164:167]
ldt a[84:85],v54 offset:12544
mma v[68:71],a[28:31],a[128:131],v[68:71]
ldt a[86:87],v54 offset:18688
mma v[68:71],a[24:27],a[112:115],v[68:71]
mma v[72:75],a[32:35],a[112:115],v[72:75]
mma v[72:75],a[36:39],a[128:131],v[72:75]
ldt a[88:89],v54 offset:264
mma v[168:171],a[36:39],a[132:135],v[168:171]
ldt a[90:91],v54 offset:6408
mma v[168:171],a[32:35],a[116:119],v[168:171]
s_add_u32 m0, s27, 0
s_add_u32 s31, s28, 896
bld v51,s[4:7],s31 offen lds
mma v[120:123],a[32:35],a[120:123],v[120:123]
mma v[120:123],a[36:39],a[136:139],v[120:123]
ldt a[92:93],v54 offset:12552
mma v[216:219],a[36:39],a[140:143],v[216:219]
s_add_u32 s31, s28, 10112
bld v51,s[4:7],s31 offen offset:1024 lds
mma v[216:219],a[32:35],a[124:127],v[216:219]
ldt a[94:95],v54 offset:18696
mma v[220:223],a[40:43],a[124:127],v[220:223]
s_add_u32 m0, s27, 2048
ldt a[100:101],v55 offset:256
mma v[220:223],a[44:47],a[140:143],v[220:223]
s_add_u32 s31, s28, 21376
bld v51,s[4:7],s31 offen lds
mma v[124:127],a[44:47],a[136:139],v[124:127]
ldt a[102:103],v55 offset:6400
mma v[124:127],a[40:43],a[120:123],v[124:127]
mma v[172:175],a[40:43],a[116:119],v[172:175]
ldt a[96:97],v55 offset:12544
mma v[172:175],a[44:47],a[132:135],v[172:175]
s_add_u32 s31, s28, 30592
bld v51,s[4:7],s31 offen offset:1024 lds
mma v[76:79],a[44:47],a[128:131],v[76:79]
ldt a[98:99],v55 offset:18688
mma v[76:79],a[40:43],a[112:115],v[76:79]
s_add_u32 m0, s27, 4096
ldt a[108:109],v55 offset:264
mma v[80:83],a[48:51],a[112:115],v[80:83]
s_add_u32 s31, s28, 41856
s_waitcnt lgkmcnt(14)
bld v51,s[4:7],s31 offen lds
mma v[80:83],a[52:55],a[128:131],v[80:83]
ldt a[110:111],v55 offset:6408
mma v[176:179],a[52:55],a[132:135],v[176:179]
mma v[176:179],a[48:51],a[116:119],v[176:179]
s_add_u32 s31, s28, 51072
bld v51,s[4:7],s31 offen offset:1024 lds
mma v[128:131],a[48:51],a[120:123],v[128:131]
ldt a[104:105],v55 offset:12552
mma v[128:131],a[52:55],a[136:139],v[128:131]
ldt a[106:107],v55 offset:18696
mma v[224:227],a[52:55],a[140:143],v[224:227]
s_add_u32 m0, s27, 6144
mma v[224:227],a[48:51],a[124:127],v[224:227]
s_add_u32 s31, s28, 62336
bld v51,s[4:7],s31 offen lds
mma v[228:231],a[56:59],a[124:127],v[228:231]
mma v[228:231],a[60:63],a[140:143],v[228:231]
mma v[132:135],a[60:63],a[136:139],v[132:135]
s_add_u32 s31, s28, 71552
bld v51,s[4:7],s31 offen offset:1024 lds
mma v[132:135],a[56:59],a[120:123],v[132:135]
mma v[180:183],a[56:59],a[116:119],v[180:183]
mma v[180:183],a[60:63],a[132:135],v[180:183]
mma v[84:87],a[60:63],a[128:131],v[84:87]
mma v[84:87],a[56:59],a[112:115],v[84:87]
mma v[88:91],a[64:67],a[112:115],v[88:91]
s_waitcnt vmcnt(8) lgkmcnt(0)
s_barrier
mma v[88:91],a[68:71],a[128:131],v[88:91]
ldt a[4:5],v54 offset:24576
mma v[184:187],a[68:71],a[132:135],v[184:187]
ldt a[6:7],v54 offset:30720
mma v[184:187],a[64:67],a[116:119],v[184:187]
mma v[136:139],a[64:67],a[120:123],v[136:139]
ldt a[0:1],v54 offset:36864
mma v[136:139],a[68:71],a[136:139],v[136:139]
ldt a[2:3],v54 offset:43008
mma v[232:235],a[68:71],a[140:143],v[232:235]
mma v[232:235],a[64:67],a[124:127],v[232:235]
mma v[236:239],a[72:75],a[124:127],v[236:239]
ldt a[12:13],v54 offset:24584
mma v[236:239],a[76:79],a[140:143],v[236:239]
ldt a[14:15],v54 offset:30728
mma v[140:143],a[76:79],a[136:139],v[140:143]
mma v[140:143],a[72:75],a[120:123],v[140:143]
ldt a[8:9],v54 offset:36872
mma v[188:191],a[72:75],a[116:119],v[188:191]
ldt a[10:11],v54 offset:43016
mma v[188:191],a[76:79],a[132:135],v[188:191]
mma v[92:95],a[76:79],a[128:131],v[92:95]
mma v[92:95],a[72:75],a[112:115],v[92:95]
s_add_u32 m0, s30, 0
s_add_u32 s31, s29, 6291456
bld v48,s[16:19],s31 offen lds
mma v[96:99],a[80:83],a[112:115],v[96:99]
ldt a[20:21],v55 offset:24576
mma v[96:99],a[84:87],a[128:131],v[96:99]
ldt a[22:23],v55 offset:30720
mma v[192:195],a[84:87],a[132:135],v[192:195]
ldt a[16:17],v55 offset:36864
mma v[192:195],a[80:83],a[116:119],v[192:195]
ldt a[18:19],v55 offset:43008
mma v[144:147],a[80:83],a[120:123],v[144:147]
mma v[144:147],a[84:87],a[136:139],v[144:147]
mma v[240:243],a[84:87],a[140:143],v[240:243]
ldt a[28:29],v55 offset:24584
mma v[240:243],a[80:83],a[124:127],v[240:243]
bld v49,s[16:19],s31 offen offset:1024 lds
mma v[244:247],a[88:91],a[124:127],v[244:247]
ldt a[30:31],v55 offset:30728
mma v[244:247],a[92:95],a[140:143],v[244:247]
mma v[148:151],a[92:95],a[136:139],v[148:151]
ldt a[24:25],v55 offset:36872
mma v[148:151],a[88:91],a[120:123],v[148:151]
ldt a[26:27],v55 offset:43016
mma v[196:199],a[88:91],a[116:119],v[196:199]
mma v[196:199],a[92:95],a[132:135],v[196:199]
ldt a[36:37],v54 offset:24704
mma v[100:103],a[92:95],a[128:131],v[100:103]
ldt a[38:39],v54 offset:30848
mma v[100:103],a[88:91],a[112:115],v[100:103]
bld v50,s[16:19],s31 offen offset:2048 lds
mma v[104:107],a[100:103],a[112:115],v[104:107]
mma v[104:107],a[96:99],a[128:131],v[104:107]
ldt a[32:33],v54 offset:36992
mma v[200:203],a[96:99],a[132:135],v[200:203]
s_waitcnt vmcnt(3)
ldq a[144:147],v52
mma v[200:203],a[100:103],a[116:119],v[200:203]
ldq a[148:151],v52 offset:2048
mma v[152:155],a[100:103],a[120:123],v[152:155]
ldq a[152:155],v52 offset:4096
mma v[152:155],a[96:99],a[136:139],v[152:155]
ldq a[156:159],v52 offset:6144
mma v[248:251],a[96:99],a[140:143],v[248:251]
ldq a[160:163],v53
mma v[248:251],a[100:103],a[124:127],v[248:251]
ldq a[164:167],v53 offset:2048
mma v[252:255],a[108:111],a[124:127],v[252:255]
ldq a[168:171],v53 offset:4096
mma v[252:255],a[104:107],a[140:143],v[252:255]
s_add_u32 m0, s30, 12288
ldq a[172:175],v53 offset:6144
mma v[156:159],a[104:107],a[136:139],v[156:159]
s_add_u32 s31, s29, 6684672
bld v48,s[16:19],s31 offen lds
mma v[156:159],a[108:111],a[120:123],v[156:159]
ldt a[34:35],v54 offset:43136
mma v[204:207],a[108:111],a[116:119],v[204:207]
ldt a[44:45],v54 offset:24712
mma v[204:207],a[104:107],a[132:135],v[204:207]
ldt a[46:47],v54 offset:30856
mma v[108:111],a[104:107],a[128:131],v[108:111]
ldt a[40:41],v54 offset:37000
mma v[108:111],a[108:111],a[112:115],v[108:111]
s_waitcnt lgkmcnt(11)
bld v49,s[16:19],s31 offen offset:1024 lds
mma v[64:67],a[4:7],a[144:147],v[64:67]
s_waitcnt lgkmcnt(7)
ldt a[42:43],v54 offset:43144
mma v[64:67],a[0:3],a[160:163],v[64:67]
s_waitcnt lgkmcnt(7)
ldt a[52:53],v55 offset:24704
mma v[160:163],a[0:3],a[164:167],v[160:163]
ldt a[54:55],v55 offset:30848
mma v[160:163],a[4:7],a[148:151],v[160:163]
ldt a[48:49],v55 offset:36992
mma v[112:115],a[4:7],a[152:155],v[112:115]
s_waitcnt lgkmcnt(9)
ldt a[50:51],v55 offset:43136
mma v[112:115],a[0:3],a[168:171],v[112:115]
s_waitcnt lgkmcnt(9)
ldt a[60:61],v55 offset:24712
mma v[208:211],a[0:3],a[172:175],v[208:211]
ldt a[62:63],v55 offset:30856
mma v[208:211],a[4:7],a[156:159],v[208:211]
bld v50,s[16:19],s31 offen offset:2048 lds
mma v[212:215],a[12:15],a[156:159],v[212:215]
ldt a[56:57],v55 offset:37000
mma v[212:215],a[8:11],a[172:175],v[212:215]
ldt a[58:59],v55 offset:43144
mma v[116:119],a[8:11],a[168:171],v[116:119]
ldt a[68:69],v54 offset:24832
mma v[116:119],a[12:15],a[152:155],v[116:119]
ldt a[70:71],v54 offset:30976
mma v[164:167],a[12:15],a[148:151],v[164:167]
mma v[164:167],a[8:11],a[164:167],v[164:167]
ldt a[64:65],v54 offset:37120
mma v[68:71],a[8:11],a[160:163],v[68:71]
ldt a[66:67],v54 offset:43264
mma v[68:71],a[12:15],a[144:147],v[68:71]
mma v[72:75],a[20:23],a[144:147],v[72:75]
mma v[72:75],a[16:19],a[160:163],v[72:75]
ldt a[76:77],v54 offset:24840
mma v[168:171],a[16:19],a[164:167],v[168:171]
ldt a[78:79],v54 offset:30984
mma v[168:171],a[20:23],a[148:151],v[168:171]
s_add_u32 m0, s27, 0
s_add_u32 s31, s28, 1024
bld v51,s[4:7],s31 offen lds
mma v[120:123],a[20:23],a[152:155],v[120:123]
mma v[120:123],a[16:19],a[168:171],v[120:123]
ldt a[72:73],v54 offset:37128
mma v[216:219],a[16:19],a[172:175],v[216:219]
s_add_u32 s31, s28, 10240
bld v51,s[4:7],s31 offen offset:1024 lds
mma v[216:219],a[20:23],a[156:159],v[216:219]
ldt a[74:75],v54 offset:43272
mma v[220:223],a[28:31],a[156:159],v[220:223]
s_add_u32 m0, s27, 2048
ldt a[84:85],v55 offset:24832
mma v[220:223],a[24:27],a[172:175],v[220:223]
s_add_u32 s31, s28, 21504
bld v51,s[4:7],s31 offen lds
mma v[124:127],a[24:27],a[168:171],v[124:127]
ldt a[86:87],v55 offset:30976
mma v[124:127],a[28:31],a[152:155],v[124:127]
mma v[172:175],a[28:31],a[148:151],v[172:175]
ldt a[80:81],v55 offset:37120
mma v[172:175],a[24:27],a[164:167],v[172:175]
s_add_u32 s31, s28, 30720
bld v51,s[4:7],s31 offen offset:1024 lds
mma v[76:79],a[24:27],a[160:163],v[76:79]
ldt a[82:83],v55 offset:43264
mma v[76:79],a[28:31],a[144:147],v[76:79]
s_add_u32 m0, s27, 4096
ldt a[92:93],v55 offset:24840
mma v[80:83],a[36:39],a[144:147],v[80:83]
s_add_u32 s31, s28, 41984
s_waitcnt lgkmcnt(14)
bld v51,s[4:7],s31 offen lds
mma v[80:83],a[32:35],a[160:163],v[80:83]
ldt a[94:95],v55 offset:30984
mma v[176:179],a[32:35],a[164:167],v[176:179]
mma v[176:179],a[36:39],a[148:151],v[176:179]
s_add_u32 s31, s28, 51200
bld v51,s[4:7],s31 offen offset:1024 lds
mma v[128:131],a[36:39],a[152:155],v[128:131]
ldt a[88:89],v55 offset:37128
mma v[128:131],a[32:35],a[168:171],v[128:131]
ldt a[90:91],v55 offset:43272
mma v[224:227],a[32:35],a[172:175],v[224:227]
s_add_u32 m0, s27, 6144
mma v[224:227],a[36:39],a[156:159],v[224:227]
s_add_u32 s31, s28, 62464
bld v51,s[4:7],s31 offen lds
mma v[228:231],a[44:47],a[156:159],v[228:231]
mma v[228:231],a[40:43],a[172:175],v[228:231]
mma v[132:135],a[40:43],a[168:171],v[132:135]
s_add_u32 s31, s28, 71680
bld v51,s[4:7],s31 offen offset:1024 lds
mma v[132:135],a[44:47],a[152:155],v[132:135]
mma v[180:183],a[44:47],a[148:151],v[180:183]
mma v[180:183],a[40:43],a[164:167],v[180:183]
mma v[84:87],a[40:43],a[160:163],v[84:87]
mma v[84:87],a[44:47],a[144:147],v[84:87]
mma v[88:91],a[52:55],a[144:147],v[88:91]
s_waitcnt vmcnt(8) lgkmcnt(0)
s_barrier
mma v[88:91],a[48:51],a[160:163],v[88:91]
ldt a[96:97],v54
mma v[184:187],a[48:51],a[164:167],v[184:187]
ldt a[98:99],v54 offset:6144
mma v[184:187],a[52:55],a[148:151],v[184:187]
mma v[136:139],a[52:55],a[152:155],v[136:139]
ldt a[100:101],v54 offset:12288
mma v[136:139],a[48:51],a[168:171],v[136:139]
ldt a[102:103],v54 offset:18432
mma v[232:235],a[48:51],a[172:175],v[232:235]
mma v[232:235],a[52:55],a[156:159],v[232:235]
mma v[236:239],a[60:63],a[156:159],v[236:239]
ldt a[104:105],v54 offset:8
mma v[236:239],a[56:59],a[172:175],v[236:239]
ldt a[106:107],v54 offset:6152
mma v[140:143],a[56:59],a[168:171],v[140:143]
mma v[140:143],a[60:63],a[152:155],v[140:143]
ldt a[108:109],v54 offset:12296
mma v[188:191],a[60:63],a[148:151],v[188:191]
ldt a[110:111],v54 offset:18440
mma v[188:191],a[56:59],a[164:167],v[188:191]
mma v[92:95],a[56:59],a[160:163],v[92:95]
mma v[92:95],a[60:63],a[144:147],v[92:95]
s_add_u32 m0, s30, 24576
s_add_u32 s31, s29, 7077888
bld v48,s[16:19],s31 offen lds
mma v[96:99],a[68:71],a[144:147],v[96:99]
ldt a[0:1],v55
mma v[96:99],a[64:67],a[160:163],v[96:99]
ldt a[2:3],v55 offset:6144
mma v[192:195],a[64:67],a[164:167],v[192:195]
ldt a[4:5],v55 offset:12288
mma v[192:195],a[68:71],a[148:151],v[192:195]
ldt a[6:7],v55 offset:18432
mma v[144:147],a[68:71],a[152:155],v[144:147]
mma v[144:147],a[64:67],a[168:171],v[144:147]
mma v[240:243],a[64:67],a[172:175],v[240:243]
ldt a[8:9],v55 offset:8
mma v[240:243],a[68:71],a[156:159],v[240:243]
bld v49,s[16:19],s31 offen offset:1024 lds
mma v[244:247],a[76:79],a[156:159],v[244:247]
ldt a[10:11],v55 offset:6152
mma v[244:247],a[72:75],a[172:175],v[244:247]
mma v[148:151],a[72:75],a[168:171],v[148:151]
ldt a[12:13],v55 offset:12296
mma v[148:151],a[76:79],a[152:155],v[148:151]
ldt a[14:15],v55 offset:18440
mma v[196:199],a[76:79],a[148:151],v[196:199]
mma v[196:199],a[72:75],a[164:167],v[196:199]
ldt a[16:17],v54 offset:128
mma v[100:103],a[72:75],a[160:163],v[100:103]
ldt a[18:19],v54 offset:6272
mma v[100:103],a[76:79],a[144:147],v[100:103]
bld v50,s[16:19],s31 offen offset:2048 lds
mma v[104:107],a[84:87],a[144:147],v[104:107]
mma v[104:107],a[80:83],a[160:163],v[104:107]
ldt a[20:21],v54 offset:12416
mma v[200:203],a[80:83],a[164:167],v[200:203]
s_waitcnt vmcnt(3)
ldq a[112:115],v52
mma v[200:203],a[84:87],a[148:151],v[200:203]
ldq a[116:119],v52 offset:2048
mma v[152:155],a[84:87],a[152:155],v[152:155]
ldq a[120:123],v52 offset:4096
mma v[152:155],a[80:83],a[168:171],v[152:155]
ldq a[124:127],v52 offset:6144
mma v[248:251],a[80:83],a[172:175],v[248:251]
ldq a[128:131],v53
mma v[248:251],a[84:87],a[156:159],v[248:251]
ldq a[132:135],v53 offset:2048
mma v[252:255],a[92:95],a[156:159],v[252:255]
ldq a[136:139],v53 offset:4096
mma v[252:255],a[88:91],a[172:175],v[252:255]
s_add_u32 m0, s30, 36864
ldq a[140:143],v53 offset:6144
mma v[156:159],a[88:91],a[168:171],v[156:159]
s_add_u32 s31, s29, 7471104
bld v48,s[16:19],s31 offen lds
mma v[156:159],a[92:95],a[152:155],v[156:159]
ldt a[22:23],v54 offset:18560
mma v[204:207],a[92:95],a[148:151],v[204:207]
ldt a[24:25],v54 offset:136
mma v[204:207],a[88:91],a[164:167],v[204:207]
ldt a[26:27],v54 offset:6280
mma v[108:111],a[88:91],a[160:163],v[108:111]
ldt a[28:29],v54 offset:12424
mma v[108:111],a[92:95],a[144:147],v[108:111]
s_waitcnt lgkmcnt(11)
bld v49,s[16:19],s31 offen offset:1024 lds
mma v[64:67],a[96:99],a[112:115],v[64:67]
s_waitcnt lgkmcnt(7)
ldt a[30:31],v54 offset:18568
mma v[64:67],a[100:103],a[128:131],v[64:67]
s_waitcnt lgkmcnt(7)
ldt a[32:33],v55 offset:128
mma v[160:163],a[100:103],a[132:135],v[160:163]
ldt a[34:35],v55 offset:6272
mma v[160:163],a[96:99],a[116:119],v[160:163]
ldt a[36:37],v55 offset:12416
mma v[112:115],a[96:99],a[120:123],v[112:115]
s_waitcnt lgkmcnt(9)
ldt a[38:39],v55 offset:18560
mma v[112:115],a[100:103],a[136:139],v[112:115]
s_waitcnt lgkmcnt(9)
ldt a[40:41],v55 offset:136
mma v[208:211],a[100:103],a[140:143],v[208:211]
ldt a[42:43],v55 offset:6280
mma v[208:211],a[96:99],a[124:127],v[208:211]
bld v50,s[16:19],s31 offen offset:2048 lds
mma v[212:215],a[104:107],a[124:127],v[212:215]
ldt a[44:45],v55 offset:12424
mma v[212:215],a[108:111],a[140:143],v[212:215]
ldt a[46:47],v55 offset:18568
mma v[116:119],a[108:111],a[136:139],v[116:119]
ldt a[48:49],v54 offset:256
mma v[116:119],a[104:107],a[120:123],v[116:119]
ldt a[50:51],v54 offset:6400
mma v[164:167],a[104:107],a[116:119],v[164:167]
mma v[164:167],a[108:111],a[132:135],v[164:167]
ldt a[52:53],v54 offset:12544
mma v[68:71],a[108:111],a[128:131],v[68:71]
ldt a[54:55],v54 offset:18688
mma v[68:71],a[104:107],a[112:115],v[68:71]
mma v[72:75],a[0:3],a[112:115],v[72:75]
mma v[72:75],a[4:7],a[128:131],v[72:75]
ldt a[56:57],v54 offset:264
mma v[168:171],a[4:7],a[132:135],v[168:171]
ldt a[58:59],v54 offset:6408
mma v[168:171],a[0:3],a[116:119],v[168:171]
s_add_u32 m0, s27, 0
s_add_u32 s31, s28, 1152
bld v51,s[4:7],s31 offen lds
mma v[120:123],a[0:3],a[120:123],v[120:123]
mma v[120:123],a[4:7],a[136:139],v[120:123]
ldt a[60:61],v54 offset:12552
mma v[216:219],a[4:7],a[140:143],v[216:219]
s_add_u32 s31, s28, 10368
bld v51,s[4:7],s31 offen offset:1024 lds
mma v[216:219],a[0:3],a[124:127],v[216:219]
ldt a[62:63],v54 offset:18696
mma v[220:223],a[8:11],a[124:127],v[220:223]
s_add_u32 m0, s27, 2048
ldt a[64:65],v55 offset:256
mma v[220:223],a[12:15],a[140:143],v[220:223]
s_add_u32 s31, s28, 21632
bld v51,s[4:7],s31 offen lds
mma v[124:127],a[12:15],a[136:139],v[124:127]
ldt a[66:67],v55 offset:6400
mma v[124:127],a[8:11],a[120:123],v[124:127]
mma v[172:175],a[8:11],a[116:119],v[172:175]
ldt a[68:69],v55 offset:12544
mma v[172:175],a[12:15],a[132:135],v[172:175]
s_add_u32 s31, s28, 30848
bld v51,s[4:7],s31 offen offset:1024 lds
mma v[76:79],a[12:15],a[128:131],v[76:79]
ldt a[70:71],v55 offset:18688
mma v[76:79],a[8:11],a[112:115],v[76:79]
s_add_u32 m0, s27, 4096
ldt a[72:73],v55 offset:264
mma v[80:83],a[16:19],a[112:115],v[80:83]
s_add_u32 s31, s28, 42112
s_waitcnt lgkmcnt(14)
bld v51,s[4:7],s31 offen lds
mma v[80:83],a[20:23],a[128:131],v[80:83]
ldt a[74:75],v55 offset:6408
mma v[176:179],a[20:23],a[132:135],v[176:179]
mma v[176:179],a[16:19],a[116:119],v[176:179]
s_add_u32 s31, s28, 51328
bld v51,s[4:7],s31 offen offset:1024 lds
mma v[128:131],a[16:19],a[120:123],v[128:131]
ldt a[76:77],v55 offset:12552
mma v[128:131],a[20:23],a[136:139],v[128:131]
ldt a[78:79],v55 offset:18696
mma v[224:227],a[20:23],a[140:143],v[224:227]
s_add_u32 m0, s27, 6144
mma v[224:227],a[16:19],a[124:127],v[224:227]
s_add_u32 s31, s28, 62592
bld v51,s[4:7],s31 offen lds
mma v[228:231],a[24:27],a[124:127],v[228:231]
mma v[228:231],a[28:31],a[140:143],v[228:231]
mma v[132:135],a[28:31],a[136:139],v[132:135]
s_add_u32 s31, s28, 71808
bld v51,s[4:7],s31 offen offset:1024 lds
mma v[132:135],a[24:27],a[120:123],v[132:135]
mma v[180:183],a[24:27],a[116:119],v[180:183]
mma v[180:183],a[28:31],a[132:135],v[180:183]
mma v[84:87],a[28:31],a[128:131],v[84:87]
mma v[84:87],a[24:27],a[112:115],v[84:87]
mma v[88:91],a[32:35],a[112:115],v[88:91]
s_waitcnt vmcnt(8) lgkmcnt(0)
s_barrier
mma v[88:91],a[36:39],a[128:131],v[88:91]
ldt a[80:81],v54 offset:24576
mma v[184:187],a[36:39],a[132:135],v[184:187]
ldt a[82:83],v54 offset:30720
mma v[184:187],a[32:35],a[116:119],v[184:187]
ldt a[84:85],v54 offset:36864
mma v[136:139],a[32:35],a[120:123],v[136:139]
ldt a[86:87],v54 offset:43008
mma v[136:139],a[36:39],a[136:139],v[136:139]
ldt a[88:89],v54 offset:24584
mma v[232:235],a[36:39],a[140:143],v[232:235]
ldt a[90:91],v54 offset:30728
mma v[232:235],a[32:35],a[124:127],v[232:235]
ldt a[92:93],v54 offset:36872
mma v[236:239],a[40:43],a[124:127],v[236:239]
ldt a[94:95],v54 offset:43016
mma v[236:239],a[44:47],a[140:143],v[236:239]
ldt a[100:101],v55 offset:24576
mma v[140:143],a[44:47],a[136:139],v[140:143]
ldt a[102:103],v55 offset:30720
mma v[140:143],a[40:43],a[120:123],v[140:143]
ldt a[96:97],v55 offset:36864
mma v[188:191],a[40:43],a[116:119],v[188:191]
ldt a[98:99],v55 offset:43008
mma v[188:191],a[44:47],a[132:135],v[188:191]
ldt a[108:109],v55 offset:24584
mma v[92:95],a[44:47],a[128:131],v[92:95]
ldt a[110:111],v55 offset:30728
mma v[92:95],a[40:43],a[112:115],v[92:95]
ldt a[104:105],v55 offset:36872
mma v[96:99],a[48:51],a[112:115],v[96:99]
ldt a[106:107],v55 offset:43016
mma v[96:99],a[52:55],a[128:131],v[96:99]
ldt a[4:5],v54 offset:24704
mma v[192:195],a[52:55],a[132:135],v[192:195]
ldt a[6:7],v54 offset:30848
mma v[192:195],a[48:51],a[116:119],v[192:195]
ldt a[0:1],v54 offset:36992
mma v[144:147],a[48:51],a[120:123],v[144:147]
ldt a[2:3],v54 offset:43136
mma v[144:147],a[52:55],a[136:139],v[144:147]
ldt a[12:13],v54 offset:24712
ldt a[14:15],v54 offset:30856
mma v[240:243],a[52:55],a[140:143],v[240:243]
ldt a[8:9],v54 offset:37000
ldt a[10:11],v54 offset:43144
mma v[240:243],a[48:51],a[124:127],v[240:243]
ldt a[20:21],v55 offset:24704
ldt a[22:23],v55 offset:30848
mma v[244:247],a[56:59],a[124:127],v[244:247]
ldt a[16:17],v55 offset:36992
ldt a[18:19],v55 offset:43136
mma v[244:247],a[60:63],a[140:143],v[244:247]
ldt a[28:29],v55 offset:24712
ldt a[30:31],v55 offset:30856
mma v[148:151],a[60:63],a[136:139],v[148:151]
ldt a[24:25],v55 offset:37000
ldt a[26:27],v55 offset:43144
mma v[148:151],a[56:59],a[120:123],v[148:151]
ldt a[36:37],v54 offset:24832
ldt a[38:39],v54 offset:30976
mma v[196:199],a[56:59],a[116:119],v[196:199]
ldt a[32:33],v54 offset:37120
ldt a[34:35],v54 offset:43264
mma v[196:199],a[60:63],a[132:135],v[196:199]
ldt a[44:45],v54 offset:24840
ldt a[46:47],v54 offset:30984
mma v[100:103],a[60:63],a[128:131],v[100:103]
ldt a[40:41],v54 offset:37128
ldt a[42:43],v54 offset:43272
mma v[100:103],a[56:59],a[112:115],v[100:103]
ldt a[52:53],v55 offset:24832
ldt a[54:55],v55 offset:30976
mma v[104:107],a[64:67],a[112:115],v[104:107]
ldt a[48:49],v55 offset:37120
ldt a[50:51],v55 offset:43264
mma v[104:107],a[68:71],a[128:131],v[104:107]
ldt a[60:61],v55 offset:24840
ldt a[62:63],v55 offset:30984
mma v[200:203],a[68:71],a[132:135],v[200:203]
s_waitcnt vmcnt(0)
ldq a[144:147],v52
ldt a[56:57],v55 offset:37128
mma v[200:203],a[64:67],a[116:119],v[200:203]
ldq a[148:151],v52 offset:2048
ldt a[58:59],v55 offset:43272
mma v[152:155],a[64:67],a[120:123],v[152:155]
ldq a[152:155],v52 offset:4096
mma v[152:155],a[68:71],a[136:139],v[152:155]
ldq a[156:159],v52 offset:6144
mma v[248:251],a[68:71],a[140:143],v[248:251]
ldq a[160:163],v53
mma v[248:251],a[64:67],a[124:127],v[248:251]
ldq a[164:167],v53 offset:2048
mma v[252:255],a[72:75],a[124:127],v[252:255]
ldq a[168:171],v53 offset:4096
mma v[252:255],a[76:79],a[140:143],v[252:255]
ldq a[172:175],v53 offset:6144
mma v[156:159],a[76:79],a[136:139],v[156:159]
mma v[156:159],a[72:75],a[120:123],v[156:159]
buffer_store_dwordx4 v[32:35], v21, s[20:23], s87 offen sc1
mma v[204:207],a[72:75],a[116:119],v[204:207]
mma v[204:207],a[76:79],a[132:135],v[204:207]
mma v[108:111],a[76:79],a[128:131],v[108:111]
s_waitcnt lgkmcnt(0)
s_barrier
mma v[108:111],a[72:75],a[112:115],v[108:111]
mma v[64:67],a[80:83],a[144:147],v[64:67]
mma v[64:67],a[84:87],a[160:163],v[64:67]
ldq a[192:195],v60
mma v[68:71],a[92:95],a[160:163],v[68:71]
mma v[68:71],a[88:91],a[144:147],v[68:71]
ldq a[196:199],v61
mma v[72:75],a[100:103],a[144:147],v[72:75]
mma v[72:75],a[96:99],a[160:163],v[72:75]
ldq a[200:203],v60 offset:128
mma v[76:79],a[104:107],a[160:163],v[76:79]
mma v[76:79],a[108:111],a[144:147],v[76:79]
ldq a[204:207],v61 offset:128
mma v[80:83],a[4:7],a[144:147],v[80:83]
mma v[80:83],a[0:3],a[160:163],v[80:83]
ldq a[208:211],v60 offset:256
mma v[84:87],a[8:11],a[160:163],v[84:87]
mma v[84:87],a[12:15],a[144:147],v[84:87]
ldq a[212:215],v61 offset:256
mma v[88:91],a[20:23],a[144:147],v[88:91]
mma v[88:91],a[16:19],a[160:163],v[88:91]
ldq a[216:219],v2
mma v[92:95],a[24:27],a[160:163],v[92:95]
mma v[92:95],a[28:31],a[144:147],v[92:95]
ldq a[220:223],v3
mma v[96:99],a[36:39],a[144:147],v[96:99]
mma v[96:99],a[32:35],a[160:163],v[96:99]
ldq a[224:227],v2 offset:128
mma v[100:103],a[40:43],a[160:163],v[100:103]
mma v[100:103],a[44:47],a[144:147],v[100:103]
ldq a[228:231],v3 offset:128
mma v[104:107],a[52:55],a[144:147],v[104:107]
mma v[104:107],a[48:51],a[160:163],v[104:107]
ldq a[232:235],v2 offset:256
mma v[108:111],a[56:59],a[160:163],v[108:111]
mma v[108:111],a[60:63],a[144:147],v[108:111]
ldq a[236:239],v3 offset:256
mma v[160:163],a[80:83],a[148:151],v[160:163]
v_mul_f32 v64, s32, v64
v_mul_f32 v65, s32, v65
v_mul_f32 v66, s32, v66
mma v[160:163],a[84:87],a[164:167],v[160:163]
v_mul_f32 v67, s32, v67
v_mul_f32 v68, s32, v68
v_mul_f32 v69, s32, v69
mma v[164:167],a[92:95],a[164:167],v[164:167]
v_mul_f32 v70, s32, v70
v_mul_f32 v71, s32, v71
cvt v64,v64,v65
mma v[164:167],a[88:91],a[148:151],v[164:167]
cvt v65,v66,v67
cvt v66,v68,v69
cvt v67,v70,v71
mma v[168:171],a[100:103],a[148:151],v[168:171]
v_mul_f32 v72, s32, v72
v_mul_f32 v73, s32, v73
v_mul_f32 v74, s32, v74
mma v[168:171],a[96:99],a[164:167],v[168:171]
v_mul_f32 v75, s32, v75
v_mul_f32 v76, s32, v76
v_mul_f32 v77, s32, v77
mma v[172:175],a[104:107],a[164:167],v[172:175]
v_mul_f32 v78, s32, v78
v_mul_f32 v79, s32, v79
cvt v68,v72,v73
mma v[172:175],a[108:111],a[148:151],v[172:175]
cvt v69,v74,v75
cvt v70,v76,v77
cvt v71,v78,v79
mma v[176:179],a[4:7],a[148:151],v[176:179]
v_mul_f32 v80, s32, v80
v_mul_f32 v81, s32, v81
v_mul_f32 v82, s32, v82
mma v[176:179],a[0:3],a[164:167],v[176:179]
v_mul_f32 v83, s32, v83
v_mul_f32 v84, s32, v84
v_mul_f32 v85, s32, v85
mma v[180:183],a[8:11],a[164:167],v[180:183]
v_mul_f32 v86, s32, v86
v_mul_f32 v87, s32, v87
cvt v72,v80,v81
mma v[180:183],a[12:15],a[148:151],v[180:183]
cvt v73,v82,v83
cvt v74,v84,v85
cvt v75,v86,v87
mma v[184:187],a[20:23],a[148:151],v[184:187]
v_mul_f32 v88, s32, v88
v_mul_f32 v89, s32, v89
v_mul_f32 v90, s32, v90
mma v[184:187],a[16:19],a[164:167],v[184:187]
v_mul_f32 v91, s32, v91
v_mul_f32 v92, s32, v92
v_mul_f32 v93, s32, v93
mma v[188:191],a[24:27],a[164:167],v[188:191]
v_mul_f32 v94, s32, v94
v_mul_f32 v95, s32, v95
cvt v76,v88,v89
mma v[188:191],a[28:31],a[148:151],v[188:191]
cvt v77,v90,v91
cvt v78,v92,v93
cvt v79,v94,v95
mma v[192:195],a[36:39],a[148:151],v[192:195]
v_mul_f32 v96, s32, v96
v_mul_f32 v97, s32, v97
v_mul_f32 v98, s32, v98
mma v[192:195],a[32:35],a[164:167],v[192:195]
v_mul_f32 v99, s32, v99
v_mul_f32 v100, s32, v100
v_mul_f32 v101, s32, v101
mma v[196:199],a[40:43],a[164:167],v[196:199]
v_mul_f32 v102, s32, v102
v_mul_f32 v103, s32, v103
cvt v80,v96,v97
mma v[196:199],a[44:47],a[148:151],v[196:199]
cvt v81,v98,v99
cvt v82,v100,v101
cvt v83,v102,v103
mma v[200:203],a[52:55],a[148:151],v[200:203]
v_mul_f32 v104, s32, v104
v_mul_f32 v105, s32, v105
v_mul_f32 v106, s32, v106
mma v[200:203],a[48:51],a[164:167],v[200:203]
v_mul_f32 v107, s32, v107
v_mul_f32 v108, s32, v108
v_mul_f32 v109, s32, v109
mma v[204:207],a[56:59],a[164:167],v[204:207]
v_mul_f32 v110, s32, v110
v_mul_f32 v111, s32, v111
cvt v84,v104,v105
mma v[204:207],a[60:63],a[148:151],v[204:207]
cvt v85,v106,v107
cvt v86,v108,v109
cvt v87,v110,v111
mma v[112:115],a[80:83],a[152:155],v[112:115]
v_mul_f32 v160, s32, v160
v_mul_f32 v161, s32, v161
v_mul_f32 v162, s32, v162
mma v[112:115],a[84:87],a[168:171],v[112:115]
v_mul_f32 v163, s32, v163
v_mul_f32 v164, s32, v164
v_mul_f32 v165, s32, v165
mma v[116:119],a[92:95],a[168:171],v[116:119]
v_mul_f32 v166, s32, v166
v_mul_f32 v167, s32, v167
cvt v88,v160,v161
mma v[116:119],a[88:91],a[152:155],v[116:119]
cvt v89,v162,v163
cvt v90,v164,v165
cvt v91,v166,v167
mma v[120:123],a[100:103],a[152:155],v[120:123]
v_mul_f32 v168, s32, v168
v_mul_f32 v169, s32, v169
v_mul_f32 v170, s32, v170
mma v[120:123],a[96:99],a[168:171],v[120:123]
v_mul_f32 v171, s32, v171
v_mul_f32 v172, s32, v172
v_mul_f32 v173, s32, v173
mma v[124:127],a[104:107],a[168:171],v[124:127]
v_mul_f32 v174, s32, v174
v_mul_f32 v175, s32, v175
cvt v92,v168,v169
mma v[124:127],a[108:111],a[152:155],v[124:127]
cvt v93,v170,v171
cvt v94,v172,v173
cvt v95,v174,v175
mma v[128:131],a[4:7],a[152:155],v[128:131]
v_mul_f32 v176, s32, v176
v_mul_f32 v177, s32, v177
v_mul_f32 v178, s32, v178
mma v[128:131],a[0:3],a[168:171],v[128:131]
v_mul_f32 v179, s32, v179
v_mul_f32 v180, s32, v180
v_mul_f32 v181, s32, v181
mma v[132:135],a[8:11],a[168:171],v[132:135]
v_mul_f32 v182, s32, v182
v_mul_f32 v183, s32, v183
cvt v96,v176,v177
mma v[132:135],a[12:15],a[152:155],v[132:135]
cvt v97,v178,v179
cvt v98,v180,v181
cvt v99,v182,v183
mma v[136:139],a[20:23],a[152:155],v[136:139]
v_mul_f32 v184, s32, v184
v_mul_f32 v185, s32, v185
v_mul_f32 v186, s32, v186
mma v[136:139],a[16:19],a[168:171],v[136:139]
v_mul_f32 v187, s32, v187
v_mul_f32 v188, s32, v188
v_mul_f32 v189, s32, v189
mma v[140:143],a[24:27],a[168:171],v[140:143]
v_mul_f32 v190, s32, v190
v_mul_f32 v191, s32, v191
cvt v100,v184,v185
mma v[140:143],a[28:31],a[152:155],v[140:143]
cvt v101,v186,v187
cvt v102,v188,v189
cvt v103,v190,v191
mma v[144:147],a[36:39],a[152:155],v[144:147]
v_mul_f32 v192, s32, v192
v_mul_f32 v193, s32, v193
v_mul_f32 v194, s32, v194
mma v[144:147],a[32:35],a[168:171],v[144:147]
v_mul_f32 v195, s32, v195
v_mul_f32 v196, s32, v196
v_mul_f32 v197, s32, v197
mma v[148:151],a[40:43],a[168:171],v[148:151]
v_mul_f32 v198, s32, v198
v_mul_f32 v199, s32, v199
cvt v104,v192,v193
mma v[148:151],a[44:47],a[152:155],v[148:151]
cvt v105,v194,v195
cvt v106,v196,v197
cvt v107,v198,v199
mma v[152:155],a[52:55],a[152:155],v[152:155]
v_mul_f32 v200, s32, v200
v_mul_f32 v201, s32, v201
v_mul_f32 v202, s32, v202
mma v[152:155],a[48:51],a[168:171],v[152:155]
v_mul_f32 v203, s32, v203
v_mul_f32 v204, s32, v204
v_mul_f32 v205, s32, v205
mma v[156:159],a[56:59],a[168:171],v[156:159]
v_mul_f32 v206, s32, v206
v_mul_f32 v207, s32, v207
cvt v108,v200,v201
mma v[156:159],a[60:63],a[152:155],v[156:159]
cvt v109,v202,v203
cvt v110,v204,v205
cvt v111,v206,v207
mma v[208:211],a[80:83],a[156:159],v[208:211]
v_mul_f32 v112, s32, v112
v_mul_f32 v113, s32, v113
mma v[208:211],a[84:87],a[172:175],v[208:211]
v_mul_f32 v114, s32, v114
v_mul_f32 v115, s32, v115
mma v[212:215],a[92:95],a[172:175],v[212:215]
v_mul_f32 v116, s32, v116
v_mul_f32 v117, s32, v117
mma v[212:215],a[88:91],a[156:159],v[212:215]
v_mul_f32 v118, s32, v118
v_mul_f32 v119, s32, v119
mma v[216:219],a[100:103],a[156:159],v[216:219]
cvt v112,v112,v113
cvt v113,v114,v115
mma v[216:219],a[96:99],a[172:175],v[216:219]
cvt v114,v116,v117
cvt v115,v118,v119
mma v[220:223],a[104:107],a[172:175],v[220:223]
v_mul_f32 v120, s32, v120
v_mul_f32 v121, s32, v121
mma v[220:223],a[108:111],a[156:159],v[220:223]
v_mul_f32 v122, s32, v122
v_mul_f32 v123, s32, v123
mma v[224:227],a[4:7],a[156:159],v[224:227]
v_mul_f32 v124, s32, v124
v_mul_f32 v125, s32, v125
mma v[224:227],a[0:3],a[172:175],v[224:227]
v_mul_f32 v126, s32, v126
v_mul_f32 v127, s32, v127
mma v[228:231],a[8:11],a[172:175],v[228:231]
cvt v116,v120,v121
cvt v117,v122,v123
mma v[228:231],a[12:15],a[156:159],v[228:231]
cvt v118,v124,v125
cvt v119,v126,v127
mma v[232:235],a[20:23],a[156:159],v[232:235]
v_mul_f32 v128, s32, v128
v_mul_f32 v129, s32, v129
mma v[232:235],a[16:19],a[172:175],v[232:235]
v_mul_f32 v130, s32, v130
v_mul_f32 v131, s32, v131
mma v[236:239],a[24:27],a[172:175],v[236:239]
v_mul_f32 v132, s32, v132
v_mul_f32 v133, s32, v133
mma v[236:239],a[28:31],a[156:159],v[236:239]
v_mul_f32 v134, s32, v134
v_mul_f32 v135, s32, v135
mma v[240:243],a[36:39],a[156:159],v[240:243]
cvt v120,v128,v129
cvt v121,v130,v131
mma v[240:243],a[32:35],a[172:175],v[240:243]
cvt v122,v132,v133
cvt v123,v134,v135
mma v[244:247],a[40:43],a[172:175],v[244:247]
v_mul_f32 v136, s32, v136
v_mul_f32 v137, s32, v137
mma v[244:247],a[44:47],a[156:159],v[244:247]
v_mul_f32 v138, s32, v138
v_mul_f32 v139, s32, v139
mma v[248:251],a[52:55],a[156:159],v[248:251]
v_mul_f32 v140, s32, v140
v_mul_f32 v141, s32, v141
mma v[248:251],a[48:51],a[172:175],v[248:251]
v_mul_f32 v142, s32, v142
v_mul_f32 v143, s32, v143
mma v[252:255],a[56:59],a[172:175],v[252:255]
cvt v124,v136,v137
cvt v125,v138,v139
mma v[252:255],a[60:63],a[156:159],v[252:255]
s_waitcnt lgkmcnt(11)
cvt v126,v140,v141
cvt v127,v142,v143
mma v[160:163],a[192:195],v[64:67],0
s_waitcnt lgkmcnt(10)
v_mul_f32 v144, s32, v144
v_mul_f32 v145, s32, v145
mma v[160:163],a[196:199],v[68:71],v[160:163]
s_waitcnt lgkmcnt(9)
v_mul_f32 v146, s32, v146
v_mul_f32 v147, s32, v147
mma v[160:163],a[200:203],v[72:75],v[160:163]
s_waitcnt lgkmcnt(8)
v_mul_f32 v148, s32, v148
v_mul_f32 v149, s32, v149
mma v[160:163],a[204:207],v[76:79],v[160:163]
s_waitcnt lgkmcnt(7)
v_mul_f32 v150, s32, v150
v_mul_f32 v151, s32, v151
mma v[160:163],a[208:211],v[80:83],v[160:163]
s_waitcnt lgkmcnt(6)
cvt v128,v144,v145
cvt v129,v146,v147
mma v[160:163],a[212:215],v[84:87],v[160:163]
s_waitcnt lgkmcnt(5)
cvt v130,v148,v149
cvt v131,v150,v151
mma v[176:179],a[216:219],v[64:67],0
s_waitcnt lgkmcnt(4)
v_mul_f32 v152, s32, v152
v_mul_f32 v153, s32, v153
mma v[176:179],a[220:223],v[68:71],v[176:179]
s_waitcnt lgkmcnt(3)
v_mul_f32 v154, s32, v154
v_mul_f32 v155, s32, v155
mma v[176:179],a[224:227],v[72:75],v[176:179]
s_waitcnt lgkmcnt(2)
v_mul_f32 v156, s32, v156
v_mul_f32 v157, s32, v157
mma v[176:179],a[228:231],v[76:79],v[176:179]
s_waitcnt lgkmcnt(1)
v_mul_f32 v158, s32, v158
v_mul_f32 v159, s32, v159
mma v[176:179],a[232:235],v[80:83],v[176:179]
s_waitcnt lgkmcnt(0)
cvt v132,v152,v153
cvt v133,v154,v155
mma v[176:179],a[236:239],v[84:87],v[176:179]
cvt v134,v156,v157
cvt v135,v158,v159
mma v[164:167],a[192:195],v[88:91],0
v_mul_f32 v208, s32, v208
v_mul_f32 v209, s32, v209
v_mul_f32 v210, s32, v210
mma v[164:167],a[196:199],v[92:95],v[164:167]
v_mul_f32 v211, s32, v211
v_mul_f32 v212, s32, v212
v_mul_f32 v213, s32, v213
mma v[164:167],a[200:203],v[96:99],v[164:167]
v_mul_f32 v214, s32, v214
v_mul_f32 v215, s32, v215
v_max3_f32 v41, v160, v161, v162
cvt v136,v208,v209
mma v[164:167],a[204:207],v[100:103],v[164:167]
cvt v137,v210,v211
cvt v138,v212,v213
cvt v139,v214,v215
mma v[164:167],a[208:211],v[104:107],v[164:167]
v_mul_f32 v216, s32, v216
v_mul_f32 v217, s32, v217
v_mul_f32 v218, s32, v218
v_max3_f32 v41, v41, v163, v176
mma v[164:167],a[212:215],v[108:111],v[164:167]
v_mul_f32 v219, s32, v219
v_mul_f32 v220, s32, v220
v_mul_f32 v221, s32, v221
mma v[180:183],a[216:219],v[88:91],0
v_mul_f32 v222, s32, v222
v_mul_f32 v223, s32, v223
cvt v140,v216,v217
mma v[180:183],a[220:223],v[92:95],v[180:183]
cvt v141,v218,v219
v_max3_f32 v41, v41, v177, v178
cvt v142,v220,v221
cvt v143,v222,v223
mma v[180:183],a[224:227],v[96:99],v[180:183]
v_mul_f32 v224, s32, v224
v_mul_f32 v225, s32, v225
v_mul_f32 v226, s32, v226
mma v[180:183],a[228:231],v[100:103],v[180:183]
v_mul_f32 v227, s32, v227
v_mul_f32 v228, s32, v228
v_max_f32 v41, v41, v179
v_mul_f32 v229, s32, v229
mma v[180:183],a[232:235],v[104:107],v[180:183]
v_mul_f32 v230, s32, v230
v_mul_f32 v231, s32, v231
cvt v144,v224,v225
mma v[180:183],a[236:239],v[108:111],v[180:183]
cvt v145,v226,v227
cvt v146,v228,v229
cvt v147,v230,v231
v_mov_b32 v40, v41
mma v[168:171],a[192:195],v[112:115],0
v_mul_f32 v232, s32, v232
v_mul_f32 v233, s32, v233
v_mul_f32 v234, s32, v234
mma v[168:171],a[196:199],v[116:119],v[168:171]
v_mul_f32 v235, s32, v235
v_mul_f32 v236, s32, v236
v_mul_f32 v237, s32, v237
mma v[168:171],a[200:203],v[120:123],v[168:171]
v_mul_f32 v238, s32, v238
v_mul_f32 v239, s32, v239
v_permlane32_swap_b32 v41, v40
cvt v148,v232,v233
mma v[168:171],a[204:207],v[124:127],v[168:171]
cvt v149,v234,v235
cvt v150,v236,v237
cvt v151,v238,v239
mma v[168:171],a[208:211],v[128:131],v[168:171]
v_mul_f32 v240, s32, v240
v_mul_f32 v241, s32, v241
v_mul_f32 v242, s32, v242
v_max_f32 v41, v41, v40
mma v[168:171],a[212:215],v[132:135],v[168:171]
v_mul_f32 v243, s32, v243
v_mul_f32 v244, s32, v244
v_mul_f32 v245, s32, v245
mma v[184:187],a[216:219],v[112:115],0
v_mul_f32 v246, s32, v246
v_mul_f32 v247, s32, v247
cvt v152,v240,v241
mma v[184:187],a[220:223],v[116:119],v[184:187]
cvt v153,v242,v243
v_mov_b32 v40, v41
cvt v154,v244,v245
cvt v155,v246,v247
mma v[184:187],a[224:227],v[120:123],v[184:187]
v_mul_f32 v248, s32, v248
v_mul_f32 v249, s32, v249
v_mul_f32 v250, s32, v250
mma v[184:187],a[228:231],v[124:127],v[184:187]
v_mul_f32 v251, s32, v251
v_mul_f32 v252, s32, v252
v_permlane16_swap_b32 v41, v40
v_mul_f32 v253, s32, v253
mma v[184:187],a[232:235],v[128:131],v[184:187]
v_mul_f32 v254, s32, v254
v_mul_f32 v255, s32, v255
cvt v156,v248,v249
mma v[184:187],a[236:239],v[132:135],v[184:187]
cvt v157,v250,v251
cvt v158,v252,v253
cvt v159,v254,v255
v_max_f32 v41, v41, v40
mma v[172:175],a[192:195],v[136:139],0
v_sub_f32 v160, v160, v41
v_sub_f32 v161, v161, v41
v_sub_f32 v162, v162, v41
v_max3_f32 v42, v164, v165, v166
v_sub_f32 v163, v163, v41
v_sub_f32 v176, v176, v41
mma v[172:175],a[196:199],v[140:143],v[172:175]
v_sub_f32 v177, v177, v41
v_max3_f32 v42, v42, v167, v180
v_sub_f32 v178, v178, v41
v_sub_f32 v179, v179, v41
v_exp_f32 v32, v160
v_max3_f32 v42, v42, v181, v182
mma v[172:175],a[200:203],v[144:147],v[172:175]
v_exp_f32 v33, v161
v_exp_f32 v34, v162
v_max_f32 v42, v42, v183
v_exp_f32 v35, v163
v_add_f32 v24, v32, v33
cvt v192,v32,v33
mma v[172:175],a[204:207],v[148:151],v[172:175]
v_mov_b32 v40, v42
v_add_f32 v24, v24, v34
cvt v193,v34,v35
v_add_f32 v24, v24, v35
v_permlane32_swap_b32 v42, v40
v_exp_f32 v36, v176
mma v[172:175],a[208:211],v[152:155],v[172:175]
v_exp_f32 v37, v177
v_max_f32 v42, v42, v40
v_exp_f32 v38, v178
v_exp_f32 v39, v179
v_add_f32 v24, v24, v36
v_mov_b32 v40, v42
mma v[172:175],a[212:215],v[156:159],v[172:175]
cvt v194,v36,v37
v_add_f32 v24, v24, v37
v_add_f32 v24, v24, v38
v_permlane16_swap_b32 v42, v40
cvt v195,v38,v39
v_add_f32 v24, v24, v39
v_max_f32 v42, v42, v40
mma v[188:191],a[216:219],v[136:139],0
v_sub_f32 v164, v164, v42
v_sub_f32 v165, v165, v42
v_sub_f32 v166, v166, v42
v_max3_f32 v43, v168, v169, v170
v_sub_f32 v167, v167, v42
v_sub_f32 v180, v180, v42
mma v[188:191],a[220:223],v[140:143],v[188:191]
v_sub_f32 v181, v181, v42
v_max3_f32 v43, v43, v171, v184
v_sub_f32 v182, v182, v42
v_sub_f32 v183, v183, v42
v_exp_f32 v32, v164
v_max3_f32 v43, v43, v185, v186
mma v[188:191],a[224:227],v[144:147],v[188:191]
v_exp_f32 v33, v165
v_exp_f32 v34, v166
v_max_f32 v43, v43, v187
v_exp_f32 v35, v167
v_add_f32 v25, v32, v33
cvt v196,v32,v33
mma v[188:191],a[228:231],v[148:151],v[188:191]
v_mov_b32 v40, v43
v_add_f32 v25, v25, v34
cvt v197,v34,v35
v_add_f32 v25, v25, v35
v_permlane32_swap_b32 v43, v40
v_exp_f32 v36, v180
mma v[188:191],a[232:235],v[152:155],v[188:191]
v_exp_f32 v37, v181
v_max_f32 v43, v43, v40
v_exp_f32 v38, v182
v_exp_f32 v39, v183
v_add_f32 v25, v25, v36
v_mov_b32 v40, v43
mma v[188:191],a[236:239],v[156:159],v[188:191]
cvt v198,v36,v37
v_add_f32 v25, v25, v37
v_add_f32 v25, v25, v38
v_permlane16_swap_b32 v43, v40
cvt v199,v38,v39
v_add_f32 v25, v25, v39
v_max_f32 v43, v43, v40
v_sub_f32 v168, v168, v43
v_sub_f32 v169, v169, v43
v_sub_f32 v170, v170, v43
v_max3_f32 v44, v172, v173, v174
v_sub_f32 v171, v171, v43
v_sub_f32 v184, v184, v43
v_sub_f32 v185, v185, v43
v_max3_f32 v44, v44, v175, v188
v_sub_f32 v186, v186, v43
v_sub_f32 v187, v187, v43
v_exp_f32 v32, v168
v_max3_f32 v44, v44, v189, v190
v_exp_f32 v33, v169
v_exp_f32 v34, v170
v_max_f32 v44, v44, v191
v_exp_f32 v35, v171
v_add_f32 v26, v32, v33
cvt v200,v32,v33
v_mov_b32 v40, v44
v_add_f32 v26, v26, v34
cvt v201,v34,v35
v_add_f32 v26, v26, v35
v_permlane32_swap_b32 v44, v40
v_exp_f32 v36, v184
v_exp_f32 v37, v185
v_max_f32 v44, v44, v40
v_exp_f32 v38, v186
v_exp_f32 v39, v187
v_add_f32 v26, v26, v36
v_mov_b32 v40, v44
cvt v202,v36,v37
v_add_f32 v26, v26, v37
v_add_f32 v26, v26, v38
v_permlane16_swap_b32 v44, v40
cvt v203,v38,v39
v_add_f32 v26, v26, v39
v_max_f32 v44, v44, v40
ldq a[192:195],v2 offset:6144
ldq a[196:199],v3 offset:6144
ldq a[200:203],v2 offset:6272
ldq a[204:207],v3 offset:6272
ldq a[208:211],v2 offset:6400
ldq a[212:215],v3 offset:6400
v_sub_f32 v172, v172, v44
v_sub_f32 v173, v173, v44
v_sub_f32 v224, 0, v41
v_sub_f32 v174, v174, v44
v_sub_f32 v175, v175, v44
v_sub_f32 v225, 0, v41
v_sub_f32 v188, v188, v44
v_sub_f32 v189, v189, v44
v_sub_f32 v226, 0, v41
v_sub_f32 v190, v190, v44
v_sub_f32 v227, 0, v41
v_sub_f32 v191, v191, v44
v_exp_f32 v32, v172
v_sub_f32 v228, 0, v42
v_exp_f32 v33, v173
v_exp_f32 v34, v174
v_sub_f32 v229, 0, v42
v_exp_f32 v35, v175
v_sub_f32 v230, 0, v42
v_add_f32 v27, v32, v33
cvt v204,v32,v33
v_sub_f32 v231, 0, v42
v_add_f32 v27, v27, v34
cvt v205,v34,v35
v_sub_f32 v232, 0, v43
v_add_f32 v27, v27, v35
v_sub_f32 v233, 0, v43
v_exp_f32 v36, v188
v_exp_f32 v37, v189
v_sub_f32 v234, 0, v43
v_exp_f32 v38, v190
v_exp_f32 v39, v191
v_sub_f32 v235, 0, v43
v_add_f32 v27, v27, v36
v_sub_f32 v236, 0, v44
cvt v206,v36,v37
v_add_f32 v27, v27, v37
v_sub_f32 v237, 0, v44
v_add_f32 v27, v27, v38
cvt v207,v38,v39
v_sub_f32 v238, 0, v44
v_add_f32 v27, v27, v39
v_sub_f32 v239, 0, v44
v_add_u32 v2, 12288, v2
v_add_u32 v3, 12288, v3
s_mov_b32 s37, 1
s_mov_b32 s40, 0
s_mov_b32 s43, 12288
s_mov_b32 s42, 24576
s_mov_b32 s35, 7
s_waitcnt vmcnt(0) lgkmcnt(0)
s_barrier
s_cmp_lg_u32 s24, 0
s_cbranch_scc1 L_w0_noadd
s_mov_b64 exec, 1
buffer_atomic_add v47, v20, s[52:55], 0 offen sc1
s_mov_b64 exec, -1
global_load_dword v19, v46, s[44:45]
L_w0_noadd:
mma v[160:163],a[192:195],v[64:67],v[224:227]
ldq a[216:219],v2
v_add_f32 v28, v28, v24
v_add_f32 v29, v29, v25
mma v[160:163],a[196:199],v[68:71],v[160:163]
ldq a[220:223],v3
v_add_f32 v30, v30, v26
v_add_f32 v31, v31, v27
mma v[160:163],a[200:203],v[72:75],v[160:163]
ldq a[224:227],v2 offset:128
mma v[160:163],a[204:207],v[76:79],v[160:163]
ldq a[228:231],v3 offset:128
mma v[160:163],a[208:211],v[80:83],v[160:163]
ldq a[232:235],v2 offset:256
mma v[160:163],a[212:215],v[84:87],v[160:163]
ldq a[236:239],v3 offset:256
mma v[164:167],a[212:215],v[108:111],v[228:231]
mma v[164:167],a[208:211],v[104:107],v[164:167]
s_add_u32 s37, s37, 1
mma v[164:167],a[204:207],v[100:103],v[164:167]
s_cmp_eq_u32 s37, 7
s_cselect_b32 s36, 4294893568, s43
s_cselect_b32 s37, 0, s37
mma v[164:167],a[200:203],v[96:99],v[164:167]
s_nop 0
v_exp_f32 v32, v160
mma v[164:167],a[196:199],v[92:95],v[164:167]
v_exp_f32 v33, v161
mma v[164:167],a[192:195],v[88:91],v[164:167]
v_exp_f32 v34, v162
v_add_f32 v24, v32, v33
mma v[168:171],a[192:195],v[112:115],v[232:235]
v_exp_f32 v35, v163
cvt v208,v32,v33
mma v[168:171],a[196:199],v[116:119],v[168:171]
v_add_f32 v24, v24, v34
cvt v209,v34,v35
v_add_f32 v24, v24, v35
mma v[168:171],a[200:203],v[120:123],v[168:171]
mma v[168:171],a[204:207],v[124:127],v[168:171]
v_exp_f32 v36, v164
mma v[168:171],a[208:211],v[128:131],v[168:171]
v_exp_f32 v37, v165
mma v[168:171],a[212:215],v[132:135],v[168:171]
v_exp_f32 v38, v166
v_add_f32 v25, v36, v37
mma v[172:175],a[212:215],v[156:159],v[236:239]
v_exp_f32 v39, v167
cvt v212,v36,v37
mma v[172:175],a[208:211],v[152:155],v[172:175]
v_add_f32 v25, v25, v38
cvt v213,v38,v39
v_add_f32 v25, v25, v39
mma v[172:175],a[204:207],v[148:151],v[172:175]
mma v[172:175],a[200:203],v[144:147],v[172:175]
v_exp_f32 v32, v168
mma v[172:175],a[196:199],v[140:143],v[172:175]
v_exp_f32 v33, v169
mma v[172:175],a[192:195],v[136:139],v[172:175]
s_waitcnt lgkmcnt(5)
v_exp_f32 v34, v170
v_add_f32 v26, v32, v33
mma v[176:179],a[216:219],v[64:67],v[224:227]
s_waitcnt lgkmcnt(4)
v_exp_f32 v35, v171
cvt v216,v32,v33
mma v[176:179],a[220:223],v[68:71],v[176:179]
s_waitcnt lgkmcnt(3)
ldq a[192:195],v2 offset:6144
v_add_f32 v26, v26, v34
cvt v217,v34,v35
mma v[176:179],a[224:227],v[72:75],v[176:179]
s_waitcnt lgkmcnt(3)
ldq a[196:199],v3 offset:6144
v_add_f32 v26, v26, v35
mma v[176:179],a[228:231],v[76:79],v[176:179]
s_waitcnt lgkmcnt(3)
ldq a[200:203],v2 offset:6272
v_exp_f32 v36, v172
mma v[176:179],a[232:235],v[80:83],v[176:179]
s_waitcnt lgkmcnt(3)
ldq a[204:207],v3 offset:6272
v_exp_f32 v37, v173
mma v[176:179],a[236:239],v[84:87],v[176:179]
ldq a[208:211],v2 offset:6400
v_exp_f32 v38, v174
mma v[180:183],a[236:239],v[108:111],v[228:231]
ldq a[212:215],v3 offset:6400
v_exp_f32 v39, v175
mma v[180:183],a[232:235],v[104:107],v[180:183]
v_add_f32 v27, v36, v37
cvt v220,v36,v37
v_add_f32 v27, v27, v38
mma v[180:183],a[228:231],v[100:103],v[180:183]
cvt v221,v38,v39
v_add_f32 v27, v27, v39
mma v[180:183],a[224:227],v[96:99],v[180:183]
v_exp_f32 v32, v176
mma v[180:183],a[220:223],v[92:95],v[180:183]
v_exp_f32 v33, v177
v_add_f32 v24, v24, v32
mma v[180:183],a[216:219],v[88:91],v[180:183]
v_exp_f32 v34, v178
cvt v210,v32,v33
mma v[184:187],a[216:219],v[112:115],v[232:235]
v_exp_f32 v35, v179
v_add_f32 v24, v24, v33
mma v[184:187],a[220:223],v[116:119],v[184:187]
v_add_f32 v24, v24, v34
cvt v211,v34,v35
v_add_f32 v24, v24, v35
mma v[184:187],a[224:227],v[120:123],v[184:187]
mma v[184:187],a[228:231],v[124:127],v[184:187]
v_exp_f32 v36, v180
mma v[184:187],a[232:235],v[128:131],v[184:187]
v_add_u32 v2, s36, v2
v_exp_f32 v37, v181
mma v[184:187],a[236:239],v[132:135],v[184:187]
v_add_u32 v3, s36, v3
v_exp_f32 v38, v182
mma v[188:191],a[236:239],v[156:159],v[236:239]
v_exp_f32 v39, v183
v_add_f32 v25, v25, v36
mma v[188:191],a[232:235],v[152:155],v[188:191]
cvt v214,v36,v37
v_add_f32 v25, v25, v37
v_add_f32 v25, v25, v38
mma v[188:191],a[228:231],v[148:151],v[188:191]
cvt v215,v38,v39
v_add_f32 v25, v25, v39
mma v[188:191],a[224:227],v[144:147],v[188:191]
v_exp_f32 v32, v184
mma v[188:191],a[220:223],v[140:143],v[188:191]
s_waitcnt lgkmcnt(0)
s_barrier
mma v[188:191],a[216:219],v[136:139],v[188:191]
v_exp_f32 v33, v185
v_add_f32 v26, v26, v32
v_exp_f32 v34, v186
v_exp_f32 v35, v187
cvt v218,v32,v33
v_add_f32 v26, v26, v33
v_add_f32 v26, v26, v34
cvt v219,v34,v35
v_add_f32 v26, v26, v35
v_exp_f32 v36, v188
v_exp_f32 v37, v189
v_exp_f32 v38, v190
v_exp_f32 v39, v191
v_add_f32 v27, v27, v36
cvt v222,v36,v37
v_add_f32 v27, v27, v37
v_add_f32 v27, v27, v38
cvt v223,v38,v39
v_add_f32 v27, v27, v39
v_max3_f32 v40, v24, v25, v26
v_max_f32 v40, v40, v27
v_cmp_nge_f32 vcc, s34, v40
s_nop 4
s_cbranch_vccnz L_w0_tr1
L_w0_tr1_ret:
mma v[160:163],a[192:195],v[64:67],v[224:227]
ldq a[216:219],v2
v_add_f32 v28, v28, v24
mma v[160:163],a[196:199],v[68:71],v[160:163]
ldq a[220:223],v3
v_add_f32 v29, v29, v25
mma v[160:163],a[200:203],v[72:75],v[160:163]
ldq a[224:227],v2 offset:128
v_add_f32 v30, v30, v26
mma v[160:163],a[204:207],v[76:79],v[160:163]
ldq a[228:231],v3 offset:128
v_add_f32 v31, v31, v27
mma v[160:163],a[208:211],v[80:83],v[160:163]
ldq a[232:235],v2 offset:256
mma v[160:163],a[212:215],v[84:87],v[160:163]
ldq a[236:239],v3 offset:256
mma v[164:167],a[212:215],v[108:111],v[228:231]
mma v[164:167],a[208:211],v[104:107],v[164:167]
s_add_u32 s37, s37, 1
mma v[164:167],a[204:207],v[100:103],v[164:167]
s_cmp_eq_u32 s37, 7
s_cselect_b32 s36, 4294893568, s43
s_cselect_b32 s37, 0, s37
mma v[164:167],a[200:203],v[96:99],v[164:167]
s_nop 0
v_exp_f32 v32, v160
mma v[164:167],a[196:199],v[92:95],v[164:167]
v_exp_f32 v33, v161
mma v[164:167],a[192:195],v[88:91],v[164:167]
v_exp_f32 v34, v162
mma v[168:171],a[192:195],v[112:115],v[232:235]
v_exp_f32 v35, v163
mma v[168:171],a[196:199],v[116:119],v[168:171]
v_add_f32 v24, v32, v33
cvt v240,v32,v33
mma v[168:171],a[200:203],v[120:123],v[168:171]
v_add_f32 v24, v24, v34
cvt v241,v34,v35
mma v[168:171],a[204:207],v[124:127],v[168:171]
v_exp_f32 v36, v164
mma v[168:171],a[208:211],v[128:131],v[168:171]
v_exp_f32 v37, v165
mma v[168:171],a[212:215],v[132:135],v[168:171]
v_exp_f32 v38, v166
mma v[172:175],a[212:215],v[156:159],v[236:239]
v_exp_f32 v39, v167
mma v[172:175],a[208:211],v[152:155],v[172:175]
v_add_f32 v24, v24, v35
v_add_f32 v25, v36, v37
mma v[172:175],a[204:207],v[148:151],v[172:175]
cvt v244,v36,v37
v_add_f32 v25, v25, v38
mma v[172:175],a[200:203],v[144:147],v[172:175]
v_exp_f32 v32, v168
mma v[172:175],a[196:199],v[140:143],v[172:175]
v_exp_f32 v33, v169
mma v[172:175],a[192:195],v[136:139],v[172:175]
s_waitcnt lgkmcnt(5)
v_exp_f32 v34, v170
mma v[176:179],a[216:219],v[64:67],v[224:227]
s_waitcnt lgkmcnt(4)
v_exp_f32 v35, v171
mma v[176:179],a[220:223],v[68:71],v[176:179]
s_waitcnt lgkmcnt(3)
ldq a[192:195],v2 offset:6144
cvt v245,v38,v39
mma v[176:179],a[224:227],v[72:75],v[176:179]
s_waitcnt lgkmcnt(3)
ldq a[196:199],v3 offset:6144
v_add_f32 v25, v25, v39
mma v[176:179],a[228:231],v[76:79],v[176:179]
s_waitcnt lgkmcnt(3)
ldq a[200:203],v2 offset:6272
v_add_f32 v26, v32, v33
mma v[176:179],a[232:235],v[80:83],v[176:179]
s_waitcnt lgkmcnt(3)
ldq a[204:207],v3 offset:6272
cvt v248,v32,v33
mma v[176:179],a[236:239],v[84:87],v[176:179]
ldq a[208:211],v2 offset:6400
v_add_f32 v26, v26, v34
mma v[180:183],a[236:239],v[108:111],v[228:231]
ldq a[212:215],v3 offset:6400
cvt v249,v34,v35
mma v[180:183],a[232:235],v[104:107],v[180:183]
v_exp_f32 v36, v172
mma v[180:183],a[228:231],v[100:103],v[180:183]
ldt a[240:241],v4
v_add_f32 v26, v26, v35
mma v[180:183],a[224:227],v[96:99],v[180:183]
v_exp_f32 v37, v173
mma v[180:183],a[220:223],v[92:95],v[180:183]
ldt a[242:243],v4 offset:6144
v_add_f32 v27, v36, v37
mma v[180:183],a[216:219],v[88:91],v[180:183]
v_exp_f32 v38, v174
mma v[184:187],a[216:219],v[112:115],v[232:235]
ldt a[244:245],v4 offset:12288
cvt v252,v36,v37
mma v[184:187],a[220:223],v[116:119],v[184:187]
v_exp_f32 v39, v175
mma v[184:187],a[224:227],v[120:123],v[184:187]
ldt a[246:247],v4 offset:18432
v_add_f32 v27, v27, v38
mma v[184:187],a[228:231],v[124:127],v[184:187]
v_exp_f32 v32, v176
mma v[184:187],a[232:235],v[128:131],v[184:187]
ldt a[248:249],v5
cvt v253,v38,v39
mma v[184:187],a[236:239],v[132:135],v[184:187]
v_exp_f32 v33, v177
mma v[188:191],a[236:239],v[156:159],v[236:239]
ldt a[250:251],v5 offset:6144
v_add_f32 v27, v27, v39
mma v[188:191],a[232:235],v[152:155],v[188:191]
v_exp_f32 v34, v178
mma v[188:191],a[228:231],v[148:151],v[188:191]
ldt a[252:253],v5 offset:12288
v_add_f32 v24, v24, v32
mma v[188:191],a[224:227],v[144:147],v[188:191]
v_exp_f32 v35, v179
mma v[188:191],a[220:223],v[140:143],v[188:191]
ldt a[254:255],v5 offset:18432
mma v[188:191],a[216:219],v[136:139],v[188:191]
s_waitcnt lgkmcnt(6)
v_exp_f32 v36, v180
mma a[0:3],a[240:243],v[192:195],0
s_waitcnt lgkmcnt(4)
ldt a[216:217],v6
cvt v242,v32,v33
mma a[0:3],a[244:247],v[208:211],a[0:3]
v_exp_f32 v37, v181
mma a[4:7],a[244:247],v[212:215],0
ldt a[218:219],v6 offset:6144
mma a[4:7],a[240:243],v[196:199],a[4:7]
v_exp_f32 v38, v182
mma a[8:11],a[240:243],v[200:203],0
ldt a[220:221],v6 offset:12288
mma a[8:11],a[244:247],v[216:219],a[8:11]
v_exp_f32 v39, v183
mma a[12:15],a[244:247],v[220:223],0
ldt a[222:223],v6 offset:18432
v_add_f32 v24, v24, v33
mma a[12:15],a[240:243],v[204:207],a[12:15]
s_waitcnt lgkmcnt(6)
v_exp_f32 v32, v184
mma a[28:31],a[248:251],v[204:207],0
s_waitcnt lgkmcnt(4)
ldt a[224:225],v7
mma a[28:31],a[252:255],v[220:223],a[28:31]
v_exp_f32 v33, v185
mma a[24:27],a[252:255],v[216:219],0
ldt a[226:227],v7 offset:6144
v_add_f32 v24, v24, v34
mma a[24:27],a[248:251],v[200:203],a[24:27]
cvt v243,v34,v35
mma a[20:23],a[248:251],v[196:199],0
ldt a[228:229],v7 offset:12288
v_add_f32 v24, v24, v35
mma a[20:23],a[252:255],v[212:215],a[20:23]
v_exp_f32 v34, v186
mma a[16:19],a[252:255],v[208:211],0
ldt a[230:231],v7 offset:18432
mma a[16:19],a[248:251],v[192:195],a[16:19]
s_waitcnt lgkmcnt(6)
v_exp_f32 v35, v187
mma a[32:35],a[216:219],v[192:195],0
s_waitcnt lgkmcnt(4)
ldt a[232:233],v4 offset:128
v_add_f32 v25, v25, v36
mma a[32:35],a[220:223],v[208:211],a[32:35]
cvt v246,v36,v37
mma a[36:39],a[220:223],v[212:215],0
ldt a[234:235],v4 offset:6272
v_add_f32 v25, v25, v37
mma a[36:39],a[216:219],v[196:199],a[36:39]
v_exp_f32 v36, v188
mma a[40:43],a[216:219],v[200:203],0
ldt a[236:237],v4 offset:12416
v_add_f32 v25, v25, v38
mma a[40:43],a[220:223],v[216:219],a[40:43]
v_exp_f32 v37, v189
mma a[44:47],a[220:223],v[220:223],0
ldt a[238:239],v4 offset:18560
mma a[44:47],a[216:219],v[204:207],a[44:47]
s_waitcnt lgkmcnt(6)
cvt v247,v38,v39
mma a[60:63],a[224:227],v[204:207],0
s_waitcnt lgkmcnt(4)
ldt a[240:241],v5 offset:128
v_add_f32 v25, v25, v39
mma a[60:63],a[228:231],v[220:223],a[60:63]
v_exp_f32 v38, v190
mma a[56:59],a[228:231],v[216:219],0
ldt a[242:243],v5 offset:6272
v_add_f32 v26, v26, v32
mma a[56:59],a[224:227],v[200:203],a[56:59]
v_exp_f32 v39, v191
mma a[52:55],a[224:227],v[196:199],0
ldt a[244:245],v5 offset:12416
mma a[52:55],a[228:231],v[212:215],a[52:55]
cvt v250,v32,v33
mma a[48:51],a[228:231],v[208:211],0
ldt a[246:247],v5 offset:18560
v_add_f32 v26, v26, v33
mma a[48:51],a[224:227],v[192:195],a[48:51]
s_waitcnt lgkmcnt(6)
v_add_f32 v26, v26, v34
cvt v251,v34,v35
mma a[64:67],a[232:235],v[192:195],0
s_waitcnt lgkmcnt(4)
v_add_f32 v26, v26, v35
mma a[64:67],a[236:239],v[208:211],a[64:67]
v_add_f32 v27, v27, v36
mma a[68:71],a[236:239],v[212:215],0
cvt v254,v36,v37
mma a[68:71],a[232:235],v[196:199],a[68:71]
v_add_f32 v27, v27, v37
v_add_f32 v27, v27, v38
mma a[72:75],a[232:235],v[200:203],0
cvt v255,v38,v39
mma a[72:75],a[236:239],v[216:219],a[72:75]
v_add_f32 v27, v27, v39
mma a[76:79],a[236:239],v[220:223],0
v_max3_f32 v40, v24, v25, v26
mma a[76:79],a[232:235],v[204:207],a[76:79]
s_waitcnt lgkmcnt(2)
v_max_f32 v40, v40, v27
mma a[92:95],a[240:243],v[204:207],0
s_waitcnt lgkmcnt(0)
v_add_u32 v2, s36, v2
v_cmp_nge_f32 vcc, s34, v40
mma a[92:95],a[244:247],v[220:223],a[92:95]
v_add_u32 v3, s36, v3
mma a[88:91],a[244:247],v[216:219],0
mma a[88:91],a[240:243],v[200:203],a[88:91]
s_barrier
mma a[84:87],a[240:243],v[196:199],0
mma a[84:87],a[244:247],v[212:215],a[84:87]
mma a[80:83],a[244:247],v[208:211],0
mma a[80:83],a[240:243],v[192:195],a[80:83]
s_cbranch_vccnz L_w0_tr2
L_w0_tr2_ret:
mma v[160:163],a[192:195],v[64:67],v[224:227]
ldq a[216:219],v2
v_add_f32 v28, v28, v24
mma v[160:163],a[196:199],v[68:71],v[160:163]
ldq a[220:223],v3
v_add_f32 v29, v29, v25
mma v[160:163],a[200:203],v[72:75],v[160:163]
ldq a[224:227],v2 offset:128
v_add_f32 v30, v30, v26
mma v[160:163],a[204:207],v[76:79],v[160:163]
ldq a[228:231],v3 offset:128
v_add_f32 v31, v31, v27
mma v[160:163],a[208:211],v[80:83],v[160:163]
ldq a[232:235],v2 offset:256
mma v[160:163],a[212:215],v[84:87],v[160:163]
ldq a[236:239],v3 offset:256
mma v[164:167],a[212:215],v[108:111],v[228:231]
mma v[164:167],a[208:211],v[104:107],v[164:167]
s_add_u32 s37, s37, 1
mma v[164:167],a[204:207],v[100:103],v[164:167]
s_cmp_eq_u32 s37, 7
s_cselect_b32 s36, 4294893568, s43
s_cselect_b32 s37, 0, s37
mma v[164:167],a[200:203],v[96:99],v[164:167]
s_nop 0
v_exp_f32 v32, v160
mma v[164:167],a[196:199],v[92:95],v[164:167]
v_exp_f32 v33, v161
mma v[164:167],a[192:195],v[88:91],v[164:167]
v_exp_f32 v34, v162
mma v[168:171],a[192:195],v[112:115],v[232:235]
v_exp_f32 v35, v163
mma v[168:171],a[196:199],v[116:119],v[168:171]
v_add_f32 v24, v32, v33
cvt v48,v32,v33
mma v[168:171],a[200:203],v[120:123],v[168:171]
v_add_f32 v24, v24, v34
cvt v49,v34,v35
mma v[168:171],a[204:207],v[124:127],v[168:171]
v_exp_f32 v36, v164
mma v[168:171],a[208:211],v[128:131],v[168:171]
v_exp_f32 v37, v165
mma v[168:171],a[212:215],v[132:135],v[168:171]
v_exp_f32 v38, v166
mma v[172:175],a[212:215],v[156:159],v[236:239]
v_exp_f32 v39, v167
mma v[172:175],a[208:211],v[152:155],v[172:175]
v_add_f32 v24, v24, v35
v_add_f32 v25, v36, v37
mma v[172:175],a[204:207],v[148:151],v[172:175]
cvt v52,v36,v37
v_add_f32 v25, v25, v38
mma v[172:175],a[200:203],v[144:147],v[172:175]
v_exp_f32 v32, v168
mma v[172:175],a[196:199],v[140:143],v[172:175]
v_exp_f32 v33, v169
mma v[172:175],a[192:195],v[136:139],v[172:175]
s_waitcnt lgkmcnt(5)
v_exp_f32 v34, v170
mma v[176:179],a[216:219],v[64:67],v[224:227]
s_waitcnt lgkmcnt(4)
v_exp_f32 v35, v171
mma v[176:179],a[220:223],v[68:71],v[176:179]
s_waitcnt lgkmcnt(3)
ldq a[192:195],v2 offset:6144
cvt v53,v38,v39
mma v[176:179],a[224:227],v[72:75],v[176:179]
s_waitcnt lgkmcnt(3)
ldq a[196:199],v3 offset:6144
v_add_f32 v25, v25, v39
mma v[176:179],a[228:231],v[76:79],v[176:179]
s_waitcnt lgkmcnt(3)
ldq a[200:203],v2 offset:6272
v_add_f32 v26, v32, v33
mma v[176:179],a[232:235],v[80:83],v[176:179]
s_waitcnt lgkmcnt(3)
ldq a[204:207],v3 offset:6272
cvt v56,v32,v33
mma v[176:179],a[236:239],v[84:87],v[176:179]
ldq a[208:211],v2 offset:6400
v_add_f32 v26, v26, v34
mma v[180:183],a[236:239],v[108:111],v[228:231]
ldq a[212:215],v3 offset:6400
cvt v57,v34,v35
mma v[180:183],a[232:235],v[104:107],v[180:183]
v_exp_f32 v36, v172
mma v[180:183],a[228:231],v[100:103],v[180:183]
ldt a[240:241],v6 offset:128
v_add_f32 v26, v26, v35
mma v[180:183],a[224:227],v[96:99],v[180:183]
v_exp_f32 v37, v173
mma v[180:183],a[220:223],v[92:95],v[180:183]
ldt a[242:243],v6 offset:6272
v_add_f32 v27, v36, v37
mma v[180:183],a[216:219],v[88:91],v[180:183]
v_exp_f32 v38, v174
mma v[184:187],a[216:219],v[112:115],v[232:235]
ldt a[244:245],v6 offset:12416
cvt v60,v36,v37
mma v[184:187],a[220:223],v[116:119],v[184:187]
v_exp_f32 v39, v175
mma v[184:187],a[224:227],v[120:123],v[184:187]
ldt a[246:247],v6 offset:18560
v_add_f32 v27, v27, v38
mma v[184:187],a[228:231],v[124:127],v[184:187]
v_exp_f32 v32, v176
mma v[184:187],a[232:235],v[128:131],v[184:187]
ldt a[248:249],v7 offset:128
cvt v61,v38,v39
mma v[184:187],a[236:239],v[132:135],v[184:187]
v_exp_f32 v33, v177
mma v[188:191],a[236:239],v[156:159],v[236:239]
ldt a[250:251],v7 offset:6272
v_add_f32 v27, v27, v39
mma v[188:191],a[232:235],v[152:155],v[188:191]
v_exp_f32 v34, v178
mma v[188:191],a[228:231],v[148:151],v[188:191]
ldt a[252:253],v7 offset:12416
v_add_f32 v24, v24, v32
mma v[188:191],a[224:227],v[144:147],v[188:191]
v_exp_f32 v35, v179
mma v[188:191],a[220:223],v[140:143],v[188:191]
ldt a[254:255],v7 offset:18560
mma v[188:191],a[216:219],v[136:139],v[188:191]
s_waitcnt lgkmcnt(6)
v_exp_f32 v36, v180
mma a[96:99],a[240:243],v[192:195],0
s_waitcnt lgkmcnt(4)
ldt a[216:217],v4 offset:256
cvt v50,v32,v33
mma a[96:99],a[244:247],v[208:211],a[96:99]
v_exp_f32 v37, v181
mma a[100:103],a[244:247],v[212:215],0
ldt a[218:219],v4 offset:6400
mma a[100:103],a[240:243],v[196:199],a[100:103]
v_exp_f32 v38, v182
mma a[104:107],a[240:243],v[200:203],0
ldt a[220:221],v4 offset:12544
mma a[104:107],a[244:247],v[216:219],a[104:107]
v_exp_f32 v39, v183
mma a[108:111],a[244:247],v[220:223],0
ldt a[222:223],v4 offset:18688
v_add_f32 v24, v24, v33
mma a[108:111],a[240:243],v[204:207],a[108:111]
s_waitcnt lgkmcnt(6)
v_exp_f32 v32, v184
mma a[124:127],a[248:251],v[204:207],0
s_waitcnt lgkmcnt(4)
ldt a[224:225],v5 offset:256
mma a[124:127],a[252:255],v[220:223],a[124:127]
v_exp_f32 v33, v185
mma a[120:123],a[252:255],v[216:219],0
ldt a[226:227],v5 offset:6400
v_add_f32 v24, v24, v34
mma a[120:123],a[248:251],v[200:203],a[120:123]
cvt v51,v34,v35
mma a[116:119],a[248:251],v[196:199],0
ldt a[228:229],v5 offset:12544
v_add_f32 v24, v24, v35
mma a[116:119],a[252:255],v[212:215],a[116:119]
v_exp_f32 v34, v186
mma a[112:115],a[252:255],v[208:211],0
ldt a[230:231],v5 offset:18688
mma a[112:115],a[248:251],v[192:195],a[112:115]
s_waitcnt lgkmcnt(6)
v_exp_f32 v35, v187
mma a[128:131],a[216:219],v[192:195],0
s_waitcnt lgkmcnt(4)
ldt a[232:233],v6 offset:256
v_add_f32 v25, v25, v36
mma a[128:131],a[220:223],v[208:211],a[128:131]
cvt v54,v36,v37
mma a[132:135],a[220:223],v[212:215],0
ldt a[234:235],v6 offset:6400
v_add_f32 v25, v25, v37
mma a[132:135],a[216:219],v[196:199],a[132:135]
v_exp_f32 v36, v188
mma a[136:139],a[216:219],v[200:203],0
ldt a[236:237],v6 offset:12544
v_add_f32 v25, v25, v38
mma a[136:139],a[220:223],v[216:219],a[136:139]
v_exp_f32 v37, v189
mma a[140:143],a[220:223],v[220:223],0
ldt a[238:239],v6 offset:18688
mma a[140:143],a[216:219],v[204:207],a[140:143]
s_waitcnt lgkmcnt(6)
cvt v55,v38,v39
mma a[156:159],a[224:227],v[204:207],0
s_waitcnt lgkmcnt(4)
ldt a[240:241],v7 offset:256
v_add_f32 v25, v25, v39
mma a[156:159],a[228:231],v[220:223],a[156:159]
v_exp_f32 v38, v190
mma a[152:155],a[228:231],v[216:219],0
ldt a[242:243],v7 offset:6400
v_add_f32 v26, v26, v32
mma a[152:155],a[224:227],v[200:203],a[152:155]
v_exp_f32 v39, v191
mma a[148:151],a[224:227],v[196:199],0
ldt a[244:245],v7 offset:12544
mma a[148:151],a[228:231],v[212:215],a[148:151]
cvt v58,v32,v33
mma a[144:147],a[228:231],v[208:211],0
ldt a[246:247],v7 offset:18688
v_add_f32 v26, v26, v33
mma a[144:147],a[224:227],v[192:195],a[144:147]
s_waitcnt lgkmcnt(6)
v_add_f32 v26, v26, v34
cvt v59,v34,v35
mma a[160:163],a[232:235],v[192:195],0
s_waitcnt lgkmcnt(4)
v_add_f32 v26, v26, v35
mma a[160:163],a[236:239],v[208:211],a[160:163]
v_add_f32 v27, v27, v36
mma a[164:167],a[236:239],v[212:215],0
cvt v62,v36,v37
mma a[164:167],a[232:235],v[196:199],a[164:167]
v_add_f32 v27, v27, v37
v_add_f32 v27, v27, v38
mma a[168:171],a[232:235],v[200:203],0
cvt v63,v38,v39
mma a[168:171],a[236:239],v[216:219],a[168:171]
v_add_f32 v27, v27, v39
mma a[172:175],a[236:239],v[220:223],0
v_max3_f32 v40, v24, v25, v26
mma a[172:175],a[232:235],v[204:207],a[172:175]
s_waitcnt lgkmcnt(2)
v_max_f32 v40, v40, v27
mma a[188:191],a[240:243],v[204:207],0
s_waitcnt lgkmcnt(0)
v_add_u32 v2, s36, v2
v_cmp_nge_f32 vcc, s34, v40
mma a[188:191],a[244:247],v[220:223],a[188:191]
v_add_u32 v3, s36, v3
mma a[184:187],a[244:247],v[216:219],0
mma a[184:187],a[240:243],v[200:203],a[184:187]
s_barrier
mma a[180:183],a[240:243],v[196:199],0
mma a[180:183],a[244:247],v[212:215],a[180:183]
s_add_u32 s40, s40, 1
mma a[176:179],a[244:247],v[208:211],0
s_cmp_eq_u32 s40, 3
s_cselect_b32 s39, 4294918144, s42
s_cselect_b32 s40, 0, s40
mma a[176:179],a[240:243],v[192:195],a[176:179]
s_cbranch_vccnz L_w0_tr3
L_w0_tr3_ret:
L_w0_loop:
mma v[160:163],a[192:195],v[64:67],v[224:227]
ldq a[216:219],v2
v_add_f32 v28, v28, v24
mma v[160:163],a[196:199],v[68:71],v[160:163]
ldq a[220:223],v3
v_add_f32 v29, v29, v25
mma v[160:163],a[200:203],v[72:75],v[160:163]
ldq a[224:227],v2 offset:128
v_add_f32 v30, v30, v26
mma v[160:163],a[204:207],v[76:79],v[160:163]
ldq a[228:231],v3 offset:128
v_add_f32 v31, v31, v27
mma v[160:163],a[208:211],v[80:83],v[160:163]
ldq a[232:235],v2 offset:256
v_add_u32 v4, s39, v4
mma v[160:163],a[212:215],v[84:87],v[160:163]
ldq a[236:239],v3 offset:256
v_add_u32 v5, s39, v5
mma v[164:167],a[212:215],v[108:111],v[228:231]
v_add_u32 v6, s39, v6
v_add_u32 v7, s39, v7
mma v[164:167],a[208:211],v[104:107],v[164:167]
s_add_u32 s37, s37, 1
mma v[164:167],a[204:207],v[100:103],v[164:167]
s_cmp_eq_u32 s37, 7
s_cselect_b32 s36, 4294893568, s43
s_cselect_b32 s37, 0, s37
mma v[164:167],a[200:203],v[96:99],v[164:167]
v_exp_f32 v32, v160
mma v[164:167],a[196:199],v[92:95],v[164:167]
v_exp_f32 v33, v161
mma v[164:167],a[192:195],v[88:91],v[164:167]
v_exp_f32 v34, v162
mma v[168:171],a[192:195],v[112:115],v[232:235]
v_exp_f32 v35, v163
mma v[168:171],a[196:199],v[116:119],v[168:171]
v_add_f32 v24, v32, v33
cvt v192,v32,v33
mma v[168:171],a[200:203],v[120:123],v[168:171]
v_add_f32 v24, v24, v34
cvt v193,v34,v35
mma v[168:171],a[204:207],v[124:127],v[168:171]
v_exp_f32 v36, v164
mma v[168:171],a[208:211],v[128:131],v[168:171]
v_exp_f32 v37, v165
mma v[168:171],a[212:215],v[132:135],v[168:171]
v_exp_f32 v38, v166
mma v[172:175],a[212:215],v[156:159],v[236:239]
v_exp_f32 v39, v167
mma v[172:175],a[208:211],v[152:155],v[172:175]
v_add_f32 v24, v24, v35
v_add_f32 v25, v36, v37
mma v[172:175],a[204:207],v[148:151],v[172:175]
cvt v196,v36,v37
v_add_f32 v25, v25, v38
mma v[172:175],a[200:203],v[144:147],v[172:175]
v_exp_f32 v32, v168
mma v[172:175],a[196:199],v[140:143],v[172:175]
v_exp_f32 v33, v169
mma v[172:175],a[192:195],v[136:139],v[172:175]
s_waitcnt lgkmcnt(5)
v_exp_f32 v34, v170
mma v[176:179],a[216:219],v[64:67],v[224:227]
s_waitcnt lgkmcnt(4)
v_exp_f32 v35, v171
mma v[176:179],a[220:223],v[68:71],v[176:179]
s_waitcnt lgkmcnt(3)
ldq a[192:195],v2 offset:6144
cvt v197,v38,v39
mma v[176:179],a[224:227],v[72:75],v[176:179]
s_waitcnt lgkmcnt(3)
ldq a[196:199],v3 offset:6144
v_add_f32 v25, v25, v39
mma v[176:179],a[228:231],v[76:79],v[176:179]
s_waitcnt lgkmcnt(3)
ldq a[200:203],v2 offset:6272
v_add_f32 v26, v32, v33
mma v[176:179],a[232:235],v[80:83],v[176:179]
s_waitcnt lgkmcnt(3)
ldq a[204:207],v3 offset:6272
cvt v200,v32,v33
mma v[176:179],a[236:239],v[84:87],v[176:179]
ldq a[208:211],v2 offset:6400
v_add_f32 v26, v26, v34
mma v[180:183],a[236:239],v[108:111],v[228:231]
ldq a[212:215],v3 offset:6400
cvt v201,v34,v35
mma v[180:183],a[232:235],v[104:107],v[180:183]
v_exp_f32 v36, v172
mma v[180:183],a[228:231],v[100:103],v[180:183]
ldt a[240:241],v4
v_add_f32 v26, v26, v35
mma v[180:183],a[224:227],v[96:99],v[180:183]
v_exp_f32 v37, v173
mma v[180:183],a[220:223],v[92:95],v[180:183]
ldt a[242:243],v4 offset:6144
v_add_f32 v27, v36, v37
mma v[180:183],a[216:219],v[88:91],v[180:183]
v_exp_f32 v38, v174
mma v[184:187],a[216:219],v[112:115],v[232:235]
ldt a[244:245],v4 offset:12288
cvt v204,v36,v37
mma v[184:187],a[220:223],v[116:119],v[184:187]
v_exp_f32 v39, v175
mma v[184:187],a[224:227],v[120:123],v[184:187]
ldt a[246:247],v4 offset:18432
v_add_f32 v27, v27, v38
mma v[184:187],a[228:231],v[124:127],v[184:187]
v_exp_f32 v32, v176
mma v[184:187],a[232:235],v[128:131],v[184:187]
ldt a[248:249],v5
mma v[184:187],a[236:239],v[132:135],v[184:187]
v_exp_f32 v33, v177
mma v[188:191],a[236:239],v[156:159],v[236:239]
ldt a[250:251],v5 offset:6144
mma v[188:191],a[232:235],v[152:155],v[188:191]
v_exp_f32 v34, v178
mma v[188:191],a[228:231],v[148:151],v[188:191]
ldt a[252:253],v5 offset:12288
cvt v205,v38,v39
mma v[188:191],a[224:227],v[144:147],v[188:191]
v_exp_f32 v35, v179
mma v[188:191],a[220:223],v[140:143],v[188:191]
ldt a[254:255],v5 offset:18432
mma v[188:191],a[216:219],v[136:139],v[188:191]
s_waitcnt lgkmcnt(6)
v_exp_f32 v36, v180
mma a[0:3],a[240:243],v[240:243],a[0:3]
s_waitcnt lgkmcnt(4)
ldt a[216:217],v6
v_add_f32 v27, v27, v39
mma a[0:3],a[244:247],v[48:51],a[0:3]
v_exp_f32 v37, v181
mma a[4:7],a[244:247],v[52:55],a[4:7]
ldt a[218:219],v6 offset:6144
mma a[4:7],a[240:243],v[244:247],a[4:7]
v_exp_f32 v38, v182
mma a[8:11],a[240:243],v[248:251],a[8:11]
ldt a[220:221],v6 offset:12288
v_add_f32 v24, v24, v32
mma a[8:11],a[244:247],v[56:59],a[8:11]
v_exp_f32 v39, v183
mma a[12:15],a[244:247],v[60:63],a[12:15]
ldt a[222:223],v6 offset:18432
mma a[12:15],a[240:243],v[252:255],a[12:15]
s_waitcnt lgkmcnt(6)
cvt v194,v32,v33
v_add_f32 v24, v24, v33
mma a[28:31],a[248:251],v[252:255],a[28:31]
s_waitcnt lgkmcnt(4)
ldt a[224:225],v7
v_add_f32 v24, v24, v34
mma a[28:31],a[252:255],v[60:63],a[28:31]
v_exp_f32 v32, v184
mma a[24:27],a[252:255],v[56:59],a[24:27]
ldt a[226:227],v7 offset:6144
mma a[24:27],a[248:251],v[248:251],a[24:27]
v_exp_f32 v33, v185
mma a[20:23],a[248:251],v[244:247],a[20:23]
ldt a[228:229],v7 offset:12288
cvt v195,v34,v35
mma a[20:23],a[252:255],v[52:55],a[20:23]
v_exp_f32 v34, v186
mma a[16:19],a[252:255],v[48:51],a[16:19]
ldt a[230:231],v7 offset:18432
mma a[16:19],a[248:251],v[240:243],a[16:19]
s_waitcnt lgkmcnt(6)
v_add_f32 v24, v24, v35
v_add_f32 v25, v25, v36
mma a[32:35],a[216:219],v[240:243],a[32:35]
s_waitcnt lgkmcnt(4)
ldt a[232:233],v4 offset:128
cvt v198,v36,v37
mma a[32:35],a[220:223],v[48:51],a[32:35]
v_exp_f32 v35, v187
mma a[36:39],a[220:223],v[52:55],a[36:39]
ldt a[234:235],v4 offset:6272
mma a[36:39],a[216:219],v[244:247],a[36:39]
v_exp_f32 v36, v188
mma a[40:43],a[216:219],v[248:251],a[40:43]
ldt a[236:237],v4 offset:12416
v_add_f32 v25, v25, v37
mma a[40:43],a[220:223],v[56:59],a[40:43]
v_exp_f32 v37, v189
mma a[44:47],a[220:223],v[60:63],a[44:47]
ldt a[238:239],v4 offset:18560
mma a[44:47],a[216:219],v[252:255],a[44:47]
s_waitcnt lgkmcnt(6)
v_add_f32 v25, v25, v38
mma a[60:63],a[224:227],v[252:255],a[60:63]
s_waitcnt lgkmcnt(4)
ldt a[240:241],v5 offset:128
cvt v199,v38,v39
mma a[60:63],a[228:231],v[60:63],a[60:63]
v_exp_f32 v38, v190
mma a[56:59],a[228:231],v[56:59],a[56:59]
ldt a[242:243],v5 offset:6272
v_add_f32 v25, v25, v39
mma a[56:59],a[224:227],v[248:251],a[56:59]
v_exp_f32 v39, v191
mma a[52:55],a[224:227],v[244:247],a[52:55]
ldt a[244:245],v5 offset:12416
v_add_f32 v26, v26, v32
mma a[52:55],a[228:231],v[52:55],a[52:55]
cvt v202,v32,v33
mma a[48:51],a[228:231],v[48:51],a[48:51]
ldt a[246:247],v5 offset:18560
v_add_f32 v26, v26, v33
mma a[48:51],a[224:227],v[240:243],a[48:51]
s_waitcnt lgkmcnt(6)
v_add_f32 v26, v26, v34
mma a[64:67],a[232:235],v[240:243],a[64:67]
s_waitcnt lgkmcnt(4)
cvt v203,v34,v35
v_add_f32 v26, v26, v35
mma a[64:67],a[236:239],v[48:51],a[64:67]
v_add_f32 v27, v27, v36
mma a[68:71],a[236:239],v[52:55],a[68:71]
cvt v206,v36,v37
mma a[68:71],a[232:235],v[244:247],a[68:71]
v_add_f32 v27, v27, v37
mma a[72:75],a[232:235],v[248:251],a[72:75]
v_add_f32 v27, v27, v38
cvt v207,v38,v39
mma a[72:75],a[236:239],v[56:59],a[72:75]
v_add_f32 v27, v27, v39
mma a[76:79],a[236:239],v[60:63],a[76:79]
v_max3_f32 v40, v24, v25, v26
mma a[76:79],a[232:235],v[252:255],a[76:79]
s_waitcnt lgkmcnt(2)
v_max_f32 v40, v40, v27
mma a[92:95],a[240:243],v[252:255],a[92:95]
s_waitcnt lgkmcnt(0)
v_add_u32 v2, s36, v2
v_cmp_nge_f32 vcc, s34, v40
mma a[92:95],a[244:247],v[60:63],a[92:95]
v_add_u32 v3, s36, v3
mma a[88:91],a[244:247],v[56:59],a[88:91]
mma a[88:91],a[240:243],v[248:251],a[88:91]
s_barrier
mma a[84:87],a[240:243],v[244:247],a[84:87]
mma a[84:87],a[244:247],v[52:55],a[84:87]
mma a[80:83],a[244:247],v[48:51],a[80:83]
mma a[80:83],a[240:243],v[240:243],a[80:83]
s_cbranch_vccnz L_w0_tr4
L_w0_tr4_ret:
mma v[160:163],a[192:195],v[64:67],v[224:227]
ldq a[216:219],v2
v_add_f32 v28, v28, v24
mma v[160:163],a[196:199],v[68:71],v[160:163]
ldq a[220:223],v3
v_add_f32 v29, v29, v25
mma v[160:163],a[200:203],v[72:75],v[160:163]
ldq a[224:227],v2 offset:128
v_add_f32 v30, v30, v26
mma v[160:163],a[204:207],v[76:79],v[160:163]
ldq a[228:231],v3 offset:128
v_add_f32 v31, v31, v27
mma v[160:163],a[208:211],v[80:83],v[160:163]
ldq a[232:235],v2 offset:256
mma v[160:163],a[212:215],v[84:87],v[160:163]
ldq a[236:239],v3 offset:256
mma v[164:167],a[212:215],v[108:111],v[228:231]
mma v[164:167],a[208:211],v[104:107],v[164:167]
s_add_u32 s37, s37, 1
mma v[164:167],a[204:207],v[100:103],v[164:167]
s_cmp_eq_u32 s37, 7
s_cselect_b32 s36, 4294893568, s43
s_cselect_b32 s37, 0, s37
mma v[164:167],a[200:203],v[96:99],v[164:167]
s_nop 0
v_exp_f32 v32, v160
mma v[164:167],a[196:199],v[92:95],v[164:167]
v_exp_f32 v33, v161
mma v[164:167],a[192:195],v[88:91],v[164:167]
v_exp_f32 v34, v162
mma v[168:171],a[192:195],v[112:115],v[232:235]
v_exp_f32 v35, v163
mma v[168:171],a[196:199],v[116:119],v[168:171]
v_add_f32 v24, v32, v33
cvt v208,v32,v33
mma v[168:171],a[200:203],v[120:123],v[168:171]
v_add_f32 v24, v24, v34
cvt v209,v34,v35
mma v[168:171],a[204:207],v[124:127],v[168:171]
v_exp_f32 v36, v164
mma v[168:171],a[208:211],v[128:131],v[168:171]
v_exp_f32 v37, v165
mma v[168:171],a[212:215],v[132:135],v[168:171]
v_exp_f32 v38, v166
mma v[172:175],a[212:215],v[156:159],v[236:239]
v_exp_f32 v39, v167
mma v[172:175],a[208:211],v[152:155],v[172:175]
v_add_f32 v24, v24, v35
v_add_f32 v25, v36, v37
mma v[172:175],a[204:207],v[148:151],v[172:175]
cvt v212,v36,v37
v_add_f32 v25, v25, v38
mma v[172:175],a[200:203],v[144:147],v[172:175]
v_exp_f32 v32, v168
mma v[172:175],a[196:199],v[140:143],v[172:175]
v_exp_f32 v33, v169
mma v[172:175],a[192:195],v[136:139],v[172:175]
s_waitcnt lgkmcnt(5)
v_exp_f32 v34, v170
mma v[176:179],a[216:219],v[64:67],v[224:227]
s_waitcnt lgkmcnt(4)
v_exp_f32 v35, v171
mma v[176:179],a[220:223],v[68:71],v[176:179]
s_waitcnt lgkmcnt(3)
ldq a[192:195],v2 offset:6144
cvt v213,v38,v39
mma v[176:179],a[224:227],v[72:75],v[176:179]
s_waitcnt lgkmcnt(3)
ldq a[196:199],v3 offset:6144
v_add_f32 v25, v25, v39
mma v[176:179],a[228:231],v[76:79],v[176:179]
s_waitcnt lgkmcnt(3)
ldq a[200:203],v2 offset:6272
v_add_f32 v26, v32, v33
mma v[176:179],a[232:235],v[80:83],v[176:179]
s_waitcnt lgkmcnt(3)
ldq a[204:207],v3 offset:6272
cvt v216,v32,v33
mma v[176:179],a[236:239],v[84:87],v[176:179]
ldq a[208:211],v2 offset:6400
v_add_f32 v26, v26, v34
mma v[180:183],a[236:239],v[108:111],v[228:231]
ldq a[212:215],v3 offset:6400
cvt v217,v34,v35
mma v[180:183],a[232:235],v[104:107],v[180:183]
v_exp_f32 v36, v172
mma v[180:183],a[228:231],v[100:103],v[180:183]
ldt a[240:241],v6 offset:128
v_add_f32 v26, v26, v35
mma v[180:183],a[224:227],v[96:99],v[180:183]
v_exp_f32 v37, v173
mma v[180:183],a[220:223],v[92:95],v[180:183]
ldt a[242:243],v6 offset:6272
v_add_f32 v27, v36, v37
mma v[180:183],a[216:219],v[88:91],v[180:183]
v_exp_f32 v38, v174
mma v[184:187],a[216:219],v[112:115],v[232:235]
ldt a[244:245],v6 offset:12416
cvt v220,v36,v37
mma v[184:187],a[220:223],v[116:119],v[184:187]
v_exp_f32 v39, v175
mma v[184:187],a[224:227],v[120:123],v[184:187]
ldt a[246:247],v6 offset:18560
v_add_f32 v27, v27, v38
mma v[184:187],a[228:231],v[124:127],v[184:187]
v_exp_f32 v32, v176
mma v[184:187],a[232:235],v[128:131],v[184:187]
ldt a[248:249],v7 offset:128
cvt v221,v38,v39
mma v[184:187],a[236:239],v[132:135],v[184:187]
v_exp_f32 v33, v177
mma v[188:191],a[236:239],v[156:159],v[236:239]
ldt a[250:251],v7 offset:6272
v_add_f32 v27, v27, v39
mma v[188:191],a[232:235],v[152:155],v[188:191]
v_exp_f32 v34, v178
mma v[188:191],a[228:231],v[148:151],v[188:191]
ldt a[252:253],v7 offset:12416
v_add_f32 v24, v24, v32
mma v[188:191],a[224:227],v[144:147],v[188:191]
v_exp_f32 v35, v179
mma v[188:191],a[220:223],v[140:143],v[188:191]
ldt a[254:255],v7 offset:18560
mma v[188:191],a[216:219],v[136:139],v[188:191]
s_waitcnt lgkmcnt(6)
v_exp_f32 v36, v180
mma a[96:99],a[240:243],v[240:243],a[96:99]
s_waitcnt lgkmcnt(4)
ldt a[216:217],v4 offset:256
cvt v210,v32,v33
mma a[96:99],a[244:247],v[48:51],a[96:99]
v_exp_f32 v37, v181
mma a[100:103],a[244:247],v[52:55],a[100:103]
ldt a[218:219],v4 offset:6400
mma a[100:103],a[240:243],v[244:247],a[100:103]
v_exp_f32 v38, v182
mma a[104:107],a[240:243],v[248:251],a[104:107]
ldt a[220:221],v4 offset:12544
mma a[104:107],a[244:247],v[56:59],a[104:107]
v_exp_f32 v39, v183
mma a[108:111],a[244:247],v[60:63],a[108:111]
ldt a[222:223],v4 offset:18688
v_add_f32 v24, v24, v33
mma a[108:111],a[240:243],v[252:255],a[108:111]
s_waitcnt lgkmcnt(6)
v_exp_f32 v32, v184
mma a[124:127],a[248:251],v[252:255],a[124:127]
s_waitcnt lgkmcnt(4)
ldt a[224:225],v5 offset:256
mma a[124:127],a[252:255],v[60:63],a[124:127]
v_exp_f32 v33, v185
mma a[120:123],a[252:255],v[56:59],a[120:123]
ldt a[226:227],v5 offset:6400
v_add_f32 v24, v24, v34
mma a[120:123],a[248:251],v[248:251],a[120:123]
cvt v211,v34,v35
mma a[116:119],a[248:251],v[244:247],a[116:119]
ldt a[228:229],v5 offset:12544
v_add_f32 v24, v24, v35
mma a[116:119],a[252:255],v[52:55],a[116:119]
v_exp_f32 v34, v186
mma a[112:115],a[252:255],v[48:51],a[112:115]
ldt a[230:231],v5 offset:18688
mma a[112:115],a[248:251],v[240:243],a[112:115]
s_waitcnt lgkmcnt(6)
v_exp_f32 v35, v187
mma a[128:131],a[216:219],v[240:243],a[128:131]
s_waitcnt lgkmcnt(4)
ldt a[232:233],v6 offset:256
v_add_f32 v25, v25, v36
mma a[128:131],a[220:223],v[48:51],a[128:131]
cvt v214,v36,v37
mma a[132:135],a[220:223],v[52:55],a[132:135]
ldt a[234:235],v6 offset:6400
v_add_f32 v25, v25, v37
mma a[132:135],a[216:219],v[244:247],a[132:135]
v_exp_f32 v36, v188
mma a[136:139],a[216:219],v[248:251],a[136:139]
ldt a[236:237],v6 offset:12544
v_add_f32 v25, v25, v38
mma a[136:139],a[220:223],v[56:59],a[136:139]
v_exp_f32 v37, v189
mma a[140:143],a[220:223],v[60:63],a[140:143]
ldt a[238:239],v6 offset:18688
mma a[140:143],a[216:219],v[252:255],a[140:143]
s_waitcnt lgkmcnt(6)
cvt v215,v38,v39
mma a[156:159],a[224:227],v[252:255],a[156:159]
s_waitcnt lgkmcnt(4)
ldt a[240:241],v7 offset:256
v_add_f32 v25, v25, v39
mma a[156:159],a[228:231],v[60:63],a[156:159]
v_exp_f32 v38, v190
mma a[152:155],a[228:231],v[56:59],a[152:155]
ldt a[242:243],v7 offset:6400
v_add_f32 v26, v26, v32
mma a[152:155],a[224:227],v[248:251],a[152:155]
v_exp_f32 v39, v191
mma a[148:151],a[224:227],v[244:247],a[148:151]
ldt a[244:245],v7 offset:12544
mma a[148:151],a[228:231],v[52:55],a[148:151]
cvt v218,v32,v33
mma a[144:147],a[228:231],v[48:51],a[144:147]
ldt a[246:247],v7 offset:18688
v_add_f32 v26, v26, v33
mma a[144:147],a[224:227],v[240:243],a[144:147]
s_waitcnt lgkmcnt(6)
v_add_f32 v26, v26, v34
cvt v219,v34,v35
mma a[160:163],a[232:235],v[240:243],a[160:163]
s_waitcnt lgkmcnt(4)
v_add_f32 v26, v26, v35
mma a[160:163],a[236:239],v[48:51],a[160:163]
v_add_f32 v27, v27, v36
mma a[164:167],a[236:239],v[52:55],a[164:167]
cvt v222,v36,v37
mma a[164:167],a[232:235],v[244:247],a[164:167]
v_add_f32 v27, v27, v37
v_add_f32 v27, v27, v38
mma a[168:171],a[232:235],v[248:251],a[168:171]
cvt v223,v38,v39
mma a[168:171],a[236:239],v[56:59],a[168:171]
v_add_f32 v27, v27, v39
mma a[172:175],a[236:239],v[60:63],a[172:175]
v_max3_f32 v40, v24, v25, v26
mma a[172:175],a[232:235],v[252:255],a[172:175]
s_waitcnt lgkmcnt(2)
v_max_f32 v40, v40, v27
mma a[188:191],a[240:243],v[252:255],a[188:191]
s_waitcnt lgkmcnt(0)
v_add_u32 v2, s36, v2
v_cmp_nge_f32 vcc, s34, v40
mma a[188:191],a[244:247],v[60:63],a[188:191]
v_add_u32 v3, s36, v3
mma a[184:187],a[244:247],v[56:59],a[184:187]
mma a[184:187],a[240:243],v[248:251],a[184:187]
s_barrier
mma a[180:183],a[240:243],v[244:247],a[180:183]
mma a[180:183],a[244:247],v[52:55],a[180:183]
s_add_u32 s40, s40, 1
mma a[176:179],a[244:247],v[48:51],a[176:179]
s_cmp_eq_u32 s40, 3
s_cselect_b32 s39, 4294918144, s42
s_cselect_b32 s40, 0, s40
mma a[176:179],a[240:243],v[240:243],a[176:179]
s_cbranch_vccnz L_w0_tr5
L_w0_tr5_ret:
mma v[160:163],a[192:195],v[64:67],v[224:227]
ldq a[216:219],v2
v_add_f32 v28, v28, v24
mma v[160:163],a[196:199],v[68:71],v[160:163]
ldq a[220:223],v3
v_add_f32 v29, v29, v25
mma v[160:163],a[200:203],v[72:75],v[160:163]
ldq a[224:227],v2 offset:128
v_add_f32 v30, v30, v26
mma v[160:163],a[204:207],v[76:79],v[160:163]
ldq a[228:231],v3 offset:128
v_add_f32 v31, v31, v27
mma v[160:163],a[208:211],v[80:83],v[160:163]
ldq a[232:235],v2 offset:256
v_add_u32 v4, s39, v4
mma v[160:163],a[212:215],v[84:87],v[160:163]
ldq a[236:239],v3 offset:256
v_add_u32 v5, s39, v5
mma v[164:167],a[212:215],v[108:111],v[228:231]
v_add_u32 v6, s39, v6
v_add_u32 v7, s39, v7
mma v[164:167],a[208:211],v[104:107],v[164:167]
s_add_u32 s37, s37, 1
mma v[164:167],a[204:207],v[100:103],v[164:167]
s_cmp_eq_u32 s37, 7
s_cselect_b32 s36, 4294893568, s43
s_cselect_b32 s37, 0, s37
mma v[164:167],a[200:203],v[96:99],v[164:167]
v_exp_f32 v32, v160
mma v[164:167],a[196:199],v[92:95],v[164:167]
v_exp_f32 v33, v161
mma v[164:167],a[192:195],v[88:91],v[164:167]
v_exp_f32 v34, v162
mma v[168:171],a[192:195],v[112:115],v[232:235]
v_exp_f32 v35, v163
mma v[168:171],a[196:199],v[116:119],v[168:171]
v_add_f32 v24, v32, v33
cvt v240,v32,v33
mma v[168:171],a[200:203],v[120:123],v[168:171]
v_add_f32 v24, v24, v34
cvt v241,v34,v35
mma v[168:171],a[204:207],v[124:127],v[168:171]
v_exp_f32 v36, v164
mma v[168:171],a[208:211],v[128:131],v[168:171]
v_exp_f32 v37, v165
mma v[168:171],a[212:215],v[132:135],v[168:171]
v_exp_f32 v38, v166
mma v[172:175],a[212:215],v[156:159],v[236:239]
v_exp_f32 v39, v167
mma v[172:175],a[208:211],v[152:155],v[172:175]
v_add_f32 v24, v24, v35
v_add_f32 v25, v36, v37
mma v[172:175],a[204:207],v[148:151],v[172:175]
cvt v244,v36,v37
v_add_f32 v25, v25, v38
mma v[172:175],a[200:203],v[144:147],v[172:175]
v_exp_f32 v32, v168
mma v[172:175],a[196:199],v[140:143],v[172:175]
v_exp_f32 v33, v169
mma v[172:175],a[192:195],v[136:139],v[172:175]
s_waitcnt lgkmcnt(5)
v_exp_f32 v34, v170
mma v[176:179],a[216:219],v[64:67],v[224:227]
s_waitcnt lgkmcnt(4)
v_exp_f32 v35, v171
mma v[176:179],a[220:223],v[68:71],v[176:179]
s_waitcnt lgkmcnt(3)
ldq a[192:195],v2 offset:6144
cvt v245,v38,v39
mma v[176:179],a[224:227],v[72:75],v[176:179]
s_waitcnt lgkmcnt(3)
ldq a[196:199],v3 offset:6144
v_add_f32 v25, v25, v39
mma v[176:179],a[228:231],v[76:79],v[176:179]
s_waitcnt lgkmcnt(3)
ldq a[200:203],v2 offset:6272
v_add_f32 v26, v32, v33
mma v[176:179],a[232:235],v[80:83],v[176:179]
s_waitcnt lgkmcnt(3)
ldq a[204:207],v3 offset:6272
cvt v248,v32,v33
mma v[176:179],a[236:239],v[84:87],v[176:179]
ldq a[208:211],v2 offset:6400
v_add_f32 v26, v26, v34
mma v[180:183],a[236:239],v[108:111],v[228:231]
ldq a[212:215],v3 offset:6400
cvt v249,v34,v35
mma v[180:183],a[232:235],v[104:107],v[180:183]
v_exp_f32 v36, v172
mma v[180:183],a[228:231],v[100:103],v[180:183]
ldt a[240:241],v4
v_add_f32 v26, v26, v35
mma v[180:183],a[224:227],v[96:99],v[180:183]
v_exp_f32 v37, v173
mma v[180:183],a[220:223],v[92:95],v[180:183]
ldt a[242:243],v4 offset:6144
v_add_f32 v27, v36, v37
mma v[180:183],a[216:219],v[88:91],v[180:183]
v_exp_f32 v38, v174
mma v[184:187],a[216:219],v[112:115],v[232:235]
ldt a[244:245],v4 offset:12288
cvt v252,v36,v37
mma v[184:187],a[220:223],v[116:119],v[184:187]
v_exp_f32 v39, v175
mma v[184:187],a[224:227],v[120:123],v[184:187]
ldt a[246:247],v4 offset:18432
v_add_f32 v27, v27, v38
mma v[184:187],a[228:231],v[124:127],v[184:187]
v_exp_f32 v32, v176
mma v[184:187],a[232:235],v[128:131],v[184:187]
ldt a[248:249],v5
mma v[184:187],a[236:239],v[132:135],v[184:187]
v_exp_f32 v33, v177
mma v[188:191],a[236:239],v[156:159],v[236:239]
ldt a[250:251],v5 offset:6144
mma v[188:191],a[232:235],v[152:155],v[188:191]
v_exp_f32 v34, v178
mma v[188:191],a[228:231],v[148:151],v[188:191]
ldt a[252:253],v5 offset:12288
cvt v253,v38,v39
mma v[188:191],a[224:227],v[144:147],v[188:191]
v_exp_f32 v35, v179
mma v[188:191],a[220:223],v[140:143],v[188:191]
ldt a[254:255],v5 offset:18432
mma v[188:191],a[216:219],v[136:139],v[188:191]
s_waitcnt lgkmcnt(6)
v_exp_f32 v36, v180
mma a[0:3],a[240:243],v[192:195],a[0:3]
s_waitcnt lgkmcnt(4)
ldt a[216:217],v6
v_add_f32 v27, v27, v39
mma a[0:3],a[244:247],v[208:211],a[0:3]
v_exp_f32 v37, v181
mma a[4:7],a[244:247],v[212:215],a[4:7]
ldt a[218:219],v6 offset:6144
mma a[4:7],a[240:243],v[196:199],a[4:7]
v_exp_f32 v38, v182
mma a[8:11],a[240:243],v[200:203],a[8:11]
ldt a[220:221],v6 offset:12288
v_add_f32 v24, v24, v32
mma a[8:11],a[244:247],v[216:219],a[8:11]
v_exp_f32 v39, v183
mma a[12:15],a[244:247],v[220:223],a[12:15]
ldt a[222:223],v6 offset:18432
mma a[12:15],a[240:243],v[204:207],a[12:15]
s_waitcnt lgkmcnt(6)
cvt v242,v32,v33
v_add_f32 v24, v24, v33
mma a[28:31],a[248:251],v[204:207],a[28:31]
s_waitcnt lgkmcnt(4)
ldt a[224:225],v7
v_add_f32 v24, v24, v34
mma a[28:31],a[252:255],v[220:223],a[28:31]
v_exp_f32 v32, v184
mma a[24:27],a[252:255],v[216:219],a[24:27]
ldt a[226:227],v7 offset:6144
mma a[24:27],a[248:251],v[200:203],a[24:27]
v_exp_f32 v33, v185
mma a[20:23],a[248:251],v[196:199],a[20:23]
ldt a[228:229],v7 offset:12288
cvt v243,v34,v35
mma a[20:23],a[252:255],v[212:215],a[20:23]
v_exp_f32 v34, v186
mma a[16:19],a[252:255],v[208:211],a[16:19]
ldt a[230:231],v7 offset:18432
mma a[16:19],a[248:251],v[192:195],a[16:19]
s_waitcnt lgkmcnt(6)
v_add_f32 v24, v24, v35
v_add_f32 v25, v25, v36
mma a[32:35],a[216:219],v[192:195],a[32:35]
s_waitcnt lgkmcnt(4)
ldt a[232:233],v4 offset:128
cvt v246,v36,v37
mma a[32:35],a[220:223],v[208:211],a[32:35]
v_exp_f32 v35, v187
mma a[36:39],a[220:223],v[212:215],a[36:39]
ldt a[234:235],v4 offset:6272
mma a[36:39],a[216:219],v[196:199],a[36:39]
v_exp_f32 v36, v188
mma a[40:43],a[216:219],v[200:203],a[40:43]
ldt a[236:237],v4 offset:12416
v_add_f32 v25, v25, v37
mma a[40:43],a[220:223],v[216:219],a[40:43]
v_exp_f32 v37, v189
mma a[44:47],a[220:223],v[220:223],a[44:47]
ldt a[238:239],v4 offset:18560
mma a[44:47],a[216:219],v[204:207],a[44:47]
s_waitcnt lgkmcnt(6)
v_add_f32 v25, v25, v38
mma a[60:63],a[224:227],v[204:207],a[60:63]
s_waitcnt lgkmcnt(4)
ldt a[240:241],v5 offset:128
cvt v247,v38,v39
mma a[60:63],a[228:231],v[220:223],a[60:63]
v_exp_f32 v38, v190
mma a[56:59],a[228:231],v[216:219],a[56:59]
ldt a[242:243],v5 offset:6272
v_add_f32 v25, v25, v39
mma a[56:59],a[224:227],v[200:203],a[56:59]
v_exp_f32 v39, v191
mma a[52:55],a[224:227],v[196:199],a[52:55]
ldt a[244:245],v5 offset:12416
v_add_f32 v26, v26, v32
mma a[52:55],a[228:231],v[212:215],a[52:55]
cvt v250,v32,v33
mma a[48:51],a[228:231],v[208:211],a[48:51]
ldt a[246:247],v5 offset:18560
v_add_f32 v26, v26, v33
mma a[48:51],a[224:227],v[192:195],a[48:51]
s_waitcnt lgkmcnt(6)
v_add_f32 v26, v26, v34
mma a[64:67],a[232:235],v[192:195],a[64:67]
s_waitcnt lgkmcnt(4)
cvt v251,v34,v35
v_add_f32 v26, v26, v35
mma a[64:67],a[236:239],v[208:211],a[64:67]
v_add_f32 v27, v27, v36
mma a[68:71],a[236:239],v[212:215],a[68:71]
cvt v254,v36,v37
mma a[68:71],a[232:235],v[196:199],a[68:71]
v_add_f32 v27, v27, v37
mma a[72:75],a[232:235],v[200:203],a[72:75]
v_add_f32 v27, v27, v38
cvt v255,v38,v39
mma a[72:75],a[236:239],v[216:219],a[72:75]
v_add_f32 v27, v27, v39
mma a[76:79],a[236:239],v[220:223],a[76:79]
v_max3_f32 v40, v24, v25, v26
mma a[76:79],a[232:235],v[204:207],a[76:79]
s_waitcnt lgkmcnt(2)
v_max_f32 v40, v40, v27
mma a[92:95],a[240:243],v[204:207],a[92:95]
s_waitcnt lgkmcnt(0)
v_add_u32 v2, s36, v2
v_cmp_nge_f32 vcc, s34, v40
mma a[92:95],a[244:247],v[220:223],a[92:95]
v_add_u32 v3, s36, v3
mma a[88:91],a[244:247],v[216:219],a[88:91]
mma a[88:91],a[240:243],v[200:203],a[88:91]
s_barrier
mma a[84:87],a[240:243],v[196:199],a[84:87]
mma a[84:87],a[244:247],v[212:215],a[84:87]
mma a[80:83],a[244:247],v[208:211],a[80:83]
mma a[80:83],a[240:243],v[192:195],a[80:83]
s_cbranch_vccnz L_w0_tr6
L_w0_tr6_ret:
mma v[160:163],a[192:195],v[64:67],v[224:227]
ldq a[216:219],v2
v_add_f32 v28, v28, v24
mma v[160:163],a[196:199],v[68:71],v[160:163]
ldq a[220:223],v3
v_add_f32 v29, v29, v25
mma v[160:163],a[200:203],v[72:75],v[160:163]
ldq a[224:227],v2 offset:128
v_add_f32 v30, v30, v26
mma v[160:163],a[204:207],v[76:79],v[160:163]
ldq a[228:231],v3 offset:128
v_add_f32 v31, v31, v27
mma v[160:163],a[208:211],v[80:83],v[160:163]
ldq a[232:235],v2 offset:256
mma v[160:163],a[212:215],v[84:87],v[160:163]
ldq a[236:239],v3 offset:256
mma v[164:167],a[212:215],v[108:111],v[228:231]
mma v[164:167],a[208:211],v[104:107],v[164:167]
s_add_u32 s37, s37, 1
mma v[164:167],a[204:207],v[100:103],v[164:167]
s_cmp_eq_u32 s37, 7
s_cselect_b32 s36, 4294893568, s43
s_cselect_b32 s37, 0, s37
mma v[164:167],a[200:203],v[96:99],v[164:167]
s_nop 0
v_exp_f32 v32, v160
mma v[164:167],a[196:199],v[92:95],v[164:167]
v_exp_f32 v33, v161
mma v[164:167],a[192:195],v[88:91],v[164:167]
v_exp_f32 v34, v162
mma v[168:171],a[192:195],v[112:115],v[232:235]
v_exp_f32 v35, v163
mma v[168:171],a[196:199],v[116:119],v[168:171]
v_add_f32 v24, v32, v33
cvt v48,v32,v33
mma v[168:171],a[200:203],v[120:123],v[168:171]
v_add_f32 v24, v24, v34
cvt v49,v34,v35
mma v[168:171],a[204:207],v[124:127],v[168:171]
v_exp_f32 v36, v164
mma v[168:171],a[208:211],v[128:131],v[168:171]
v_exp_f32 v37, v165
mma v[168:171],a[212:215],v[132:135],v[168:171]
v_exp_f32 v38, v166
mma v[172:175],a[212:215],v[156:159],v[236:239]
v_exp_f32 v39, v167
mma v[172:175],a[208:211],v[152:155],v[172:175]
v_add_f32 v24, v24, v35
v_add_f32 v25, v36, v37
mma v[172:175],a[204:207],v[148:151],v[172:175]
cvt v52,v36,v37
v_add_f32 v25, v25, v38
mma v[172:175],a[200:203],v[144:147],v[172:175]
v_exp_f32 v32, v168
mma v[172:175],a[196:199],v[140:143],v[172:175]
v_exp_f32 v33, v169
mma v[172:175],a[192:195],v[136:139],v[172:175]
s_waitcnt lgkmcnt(5)
v_exp_f32 v34, v170
mma v[176:179],a[216:219],v[64:67],v[224:227]
s_waitcnt lgkmcnt(4)
v_exp_f32 v35, v171
mma v[176:179],a[220:223],v[68:71],v[176:179]
s_waitcnt lgkmcnt(3)
ldq a[192:195],v2 offset:6144
cvt v53,v38,v39
mma v[176:179],a[224:227],v[72:75],v[176:179]
s_waitcnt lgkmcnt(3)
ldq a[196:199],v3 offset:6144
v_add_f32 v25, v25, v39
mma v[176:179],a[228:231],v[76:79],v[176:179]
s_waitcnt lgkmcnt(3)
ldq a[200:203],v2 offset:6272
v_add_f32 v26, v32, v33
mma v[176:179],a[232:235],v[80:83],v[176:179]
s_waitcnt lgkmcnt(3)
ldq a[204:207],v3 offset:6272
cvt v56,v32,v33
mma v[176:179],a[236:239],v[84:87],v[176:179]
ldq a[208:211],v2 offset:6400
v_add_f32 v26, v26, v34
mma v[180:183],a[236:239],v[108:111],v[228:231]
ldq a[212:215],v3 offset:6400
cvt v57,v34,v35
mma v[180:183],a[232:235],v[104:107],v[180:183]
v_exp_f32 v36, v172
mma v[180:183],a[228:231],v[100:103],v[180:183]
ldt a[240:241],v6 offset:128
v_add_f32 v26, v26, v35
mma v[180:183],a[224:227],v[96:99],v[180:183]
v_exp_f32 v37, v173
mma v[180:183],a[220:223],v[92:95],v[180:183]
ldt a[242:243],v6 offset:6272
v_add_f32 v27, v36, v37
mma v[180:183],a[216:219],v[88:91],v[180:183]
v_exp_f32 v38, v174
mma v[184:187],a[216:219],v[112:115],v[232:235]
ldt a[244:245],v6 offset:12416
cvt v60,v36,v37
mma v[184:187],a[220:223],v[116:119],v[184:187]
v_exp_f32 v39, v175
mma v[184:187],a[224:227],v[120:123],v[184:187]
ldt a[246:247],v6 offset:18560
v_add_f32 v27, v27, v38
mma v[184:187],a[228:231],v[124:127],v[184:187]
v_exp_f32 v32, v176
mma v[184:187],a[232:235],v[128:131],v[184:187]
ldt a[248:249],v7 offset:128
cvt v61,v38,v39
mma v[184:187],a[236:239],v[132:135],v[184:187]
v_exp_f32 v33, v177
mma v[188:191],a[236:239],v[156:159],v[236:239]
ldt a[250:251],v7 offset:6272
v_add_f32 v27, v27, v39
mma v[188:191],a[232:235],v[152:155],v[188:191]
v_exp_f32 v34, v178
mma v[188:191],a[228:231],v[148:151],v[188:191]
ldt a[252:253],v7 offset:12416
v_add_f32 v24, v24, v32
mma v[188:191],a[224:227],v[144:147],v[188:191]
v_exp_f32 v35, v179
mma v[188:191],a[220:223],v[140:143],v[188:191]
ldt a[254:255],v7 offset:18560
mma v[188:191],a[216:219],v[136:139],v[188:191]
s_waitcnt lgkmcnt(6)
v_exp_f32 v36, v180
mma a[96:99],a[240:243],v[192:195],a[96:99]
s_waitcnt lgkmcnt(4)
ldt a[216:217],v4 offset:256
cvt v50,v32,v33
mma a[96:99],a[244:247],v[208:211],a[96:99]
v_exp_f32 v37, v181
mma a[100:103],a[244:247],v[212:215],a[100:103]
ldt a[218:219],v4 offset:6400
mma a[100:103],a[240:243],v[196:199],a[100:103]
v_exp_f32 v38, v182
mma a[104:107],a[240:243],v[200:203],a[104:107]
ldt a[220:221],v4 offset:12544
mma a[104:107],a[244:247],v[216:219],a[104:107]
v_exp_f32 v39, v183
mma a[108:111],a[244:247],v[220:223],a[108:111]
ldt a[222:223],v4 offset:18688
v_add_f32 v24, v24, v33
mma a[108:111],a[240:243],v[204:207],a[108:111]
s_waitcnt lgkmcnt(6)
v_exp_f32 v32, v184
mma a[124:127],a[248:251],v[204:207],a[124:127]
s_waitcnt lgkmcnt(4)
ldt a[224:225],v5 offset:256
mma a[124:127],a[252:255],v[220:223],a[124:127]
v_exp_f32 v33, v185
mma a[120:123],a[252:255],v[216:219],a[120:123]
ldt a[226:227],v5 offset:6400
v_add_f32 v24, v24, v34
mma a[120:123],a[248:251],v[200:203],a[120:123]
cvt v51,v34,v35
mma a[116:119],a[248:251],v[196:199],a[116:119]
ldt a[228:229],v5 offset:12544
v_add_f32 v24, v24, v35
mma a[116:119],a[252:255],v[212:215],a[116:119]
v_exp_f32 v34, v186
mma a[112:115],a[252:255],v[208:211],a[112:115]
ldt a[230:231],v5 offset:18688
mma a[112:115],a[248:251],v[192:195],a[112:115]
s_waitcnt lgkmcnt(6)
v_exp_f32 v35, v187
mma a[128:131],a[216:219],v[192:195],a[128:131]
s_waitcnt lgkmcnt(4)
ldt a[232:233],v6 offset:256
v_add_f32 v25, v25, v36
mma a[128:131],a[220:223],v[208:211],a[128:131]
cvt v54,v36,v37
mma a[132:135],a[220:223],v[212:215],a[132:135]
ldt a[234:235],v6 offset:6400
v_add_f32 v25, v25, v37
mma a[132:135],a[216:219],v[196:199],a[132:135]
v_exp_f32 v36, v188
mma a[136:139],a[216:219],v[200:203],a[136:139]
ldt a[236:237],v6 offset:12544
v_add_f32 v25, v25, v38
mma a[136:139],a[220:223],v[216:219],a[136:139]
v_exp_f32 v37, v189
mma a[140:143],a[220:223],v[220:223],a[140:143]
ldt a[238:239],v6 offset:18688
mma a[140:143],a[216:219],v[204:207],a[140:143]
s_waitcnt lgkmcnt(6)
cvt v55,v38,v39
mma a[156:159],a[224:227],v[204:207],a[156:159]
s_waitcnt lgkmcnt(4)
ldt a[240:241],v7 offset:256
v_add_f32 v25, v25, v39
mma a[156:159],a[228:231],v[220:223],a[156:159]
v_exp_f32 v38, v190
mma a[152:155],a[228:231],v[216:219],a[152:155]
ldt a[242:243],v7 offset:6400
v_add_f32 v26, v26, v32
mma a[152:155],a[224:227],v[200:203],a[152:155]
v_exp_f32 v39, v191
mma a[148:151],a[224:227],v[196:199],a[148:151]
ldt a[244:245],v7 offset:12544
mma a[148:151],a[228:231],v[212:215],a[148:151]
cvt v58,v32,v33
mma a[144:147],a[228:231],v[208:211],a[144:147]
ldt a[246:247],v7 offset:18688
v_add_f32 v26, v26, v33
mma a[144:147],a[224:227],v[192:195],a[144:147]
s_waitcnt lgkmcnt(6)
v_add_f32 v26, v26, v34
cvt v59,v34,v35
mma a[160:163],a[232:235],v[192:195],a[160:163]
s_waitcnt lgkmcnt(4)
v_add_f32 v26, v26, v35
mma a[160:163],a[236:239],v[208:211],a[160:163]
v_add_f32 v27, v27, v36
mma a[164:167],a[236:239],v[212:215],a[164:167]
cvt v62,v36,v37
mma a[164:167],a[232:235],v[196:199],a[164:167]
v_add_f32 v27, v27, v37
v_add_f32 v27, v27, v38
mma a[168:171],a[232:235],v[200:203],a[168:171]
cvt v63,v38,v39
mma a[168:171],a[236:239],v[216:219],a[168:171]
v_add_f32 v27, v27, v39
mma a[172:175],a[236:239],v[220:223],a[172:175]
v_max3_f32 v40, v24, v25, v26
mma a[172:175],a[232:235],v[204:207],a[172:175]
s_waitcnt lgkmcnt(2)
v_max_f32 v40, v40, v27
mma a[188:191],a[240:243],v[204:207],a[188:191]
s_waitcnt lgkmcnt(0)
v_add_u32 v2, s36, v2
v_cmp_nge_f32 vcc, s34, v40
mma a[188:191],a[244:247],v[220:223],a[188:191]
v_add_u32 v3, s36, v3
mma a[184:187],a[244:247],v[216:219],a[184:187]
mma a[184:187],a[240:243],v[200:203],a[184:187]
s_barrier
mma a[180:183],a[240:243],v[196:199],a[180:183]
mma a[180:183],a[244:247],v[212:215],a[180:183]
s_add_u32 s40, s40, 1
mma a[176:179],a[244:247],v[208:211],a[176:179]
s_cmp_eq_u32 s40, 3
s_cselect_b32 s39, 4294918144, s42
s_cselect_b32 s40, 0, s40
mma a[176:179],a[240:243],v[192:195],a[176:179]
s_cbranch_vccnz L_w0_tr7
L_w0_tr7_ret:
s_sub_u32 s35, s35, 1
s_cmp_lg_u32 s35, 0
s_cbranch_scc1 L_w0_loop
L_w0_loop_end:
v_add_u32 v4, s39, v4
v_add_u32 v5, s39, v5
v_add_u32 v6, s39, v6
v_add_u32 v7, s39, v7
ldt a[240:241],v4
ldt a[242:243],v4 offset:6144
ldt a[244:245],v4 offset:12288
ldt a[246:247],v4 offset:18432
ldt a[248:249],v5
ldt a[250:251],v5 offset:6144
ldt a[252:253],v5 offset:12288
ldt a[254:255],v5 offset:18432
v_add_f32 v28, v28, v24
v_add_f32 v29, v29, v25
v_add_f32 v30, v30, v26
v_add_f32 v31, v31, v27
v_mov_b32 v32, v28
v_mov_b32 v33, v29
v_mov_b32 v34, v30
v_mov_b32 v35, v31
v_permlane32_swap_b32 v28, v32
v_permlane32_swap_b32 v29, v33
v_permlane32_swap_b32 v30, v34
v_permlane32_swap_b32 v31, v35
v_add_f32 v28, v28, v32
v_add_f32 v29, v29, v33
v_add_f32 v30, v30, v34
v_add_f32 v31, v31, v35
v_mov_b32 v32, v28
v_mov_b32 v33, v29
v_mov_b32 v34, v30
v_mov_b32 v35, v31
s_waitcnt lgkmcnt(6)
mma a[0:3],a[240:243],v[240:243],a[0:3]
s_waitcnt lgkmcnt(4)
ldt a[216:217],v6
v_permlane16_swap_b32 v28, v32
mma a[0:3],a[244:247],v[48:51],a[0:3]
v_permlane16_swap_b32 v29, v33
v_permlane16_swap_b32 v30, v34
mma a[4:7],a[244:247],v[52:55],a[4:7]
ldt a[218:219],v6 offset:6144
v_permlane16_swap_b32 v31, v35
mma a[4:7],a[240:243],v[244:247],a[4:7]
v_add_f32 v28, v28, v32
v_add_f32 v29, v29, v33
mma a[8:11],a[240:243],v[248:251],a[8:11]
ldt a[220:221],v6 offset:12288
v_add_f32 v30, v30, v34
mma a[8:11],a[244:247],v[56:59],a[8:11]
v_add_f32 v31, v31, v35
mma a[12:15],a[244:247],v[60:63],a[12:15]
ldt a[222:223],v6 offset:18432
mma a[12:15],a[240:243],v[252:255],a[12:15]
s_waitcnt lgkmcnt(6)
v_rcp_f32 v28, v28
mma a[28:31],a[248:251],v[252:255],a[28:31]
s_waitcnt lgkmcnt(4)
ldt a[224:225],v7
mma a[28:31],a[252:255],v[60:63],a[28:31]
v_rcp_f32 v29, v29
mma a[24:27],a[252:255],v[56:59],a[24:27]
ldt a[226:227],v7 offset:6144
mma a[24:27],a[248:251],v[248:251],a[24:27]
v_rcp_f32 v30, v30
mma a[20:23],a[248:251],v[244:247],a[20:23]
ldt a[228:229],v7 offset:12288
mma a[20:23],a[252:255],v[52:55],a[20:23]
v_rcp_f32 v31, v31
mma a[16:19],a[252:255],v[48:51],a[16:19]
ldt a[230:231],v7 offset:18432
ard v160,a0
mma a[16:19],a[248:251],v[240:243],a[16:19]
s_waitcnt lgkmcnt(6)
ard v161,a1
ard v162,a2
mma a[32:35],a[216:219],v[240:243],a[32:35]
s_waitcnt lgkmcnt(4)
ldt a[232:233],v4 offset:128
ard v163,a3
mma a[32:35],a[220:223],v[48:51],a[32:35]
mma a[36:39],a[220:223],v[52:55],a[36:39]
ldt a[234:235],v4 offset:6272
mma a[36:39],a[216:219],v[244:247],a[36:39]
mma a[40:43],a[216:219],v[248:251],a[40:43]
ldt a[236:237],v4 offset:12416
ard v164,a16
mma a[40:43],a[220:223],v[56:59],a[40:43]
ard v165,a17
ard v166,a18
mma a[44:47],a[220:223],v[60:63],a[44:47]
ldt a[238:239],v4 offset:18560
ard v167,a19
mma a[44:47],a[216:219],v[252:255],a[44:47]
s_waitcnt lgkmcnt(6)
v_mul_f32 v160, v160, v28
v_mul_f32 v161, v161, v28
mma a[60:63],a[224:227],v[252:255],a[60:63]
s_waitcnt lgkmcnt(4)
ldt a[240:241],v5 offset:128
v_mul_f32 v162, v162, v28
mma a[60:63],a[228:231],v[60:63],a[60:63]
v_mul_f32 v163, v163, v28
v_mul_f32 v164, v164, v28
mma a[56:59],a[228:231],v[56:59],a[56:59]
ldt a[242:243],v5 offset:6272
v_mul_f32 v165, v165, v28
mma a[56:59],a[224:227],v[248:251],a[56:59]
v_mul_f32 v166, v166, v28
v_mul_f32 v167, v167, v28
mma a[52:55],a[224:227],v[244:247],a[52:55]
ldt a[244:245],v5 offset:12416
cvt v64,v160,v161
mma a[52:55],a[228:231],v[52:55],a[52:55]
cvt v65,v162,v163
cvt v66,v164,v165
mma a[48:51],a[228:231],v[48:51],a[48:51]
ldt a[246:247],v5 offset:18560
cvt v67,v166,v167
mma a[48:51],a[224:227],v[240:243],a[48:51]
s_add_u32 s42, s41, 0
s_waitcnt lgkmcnt(6)
buffer_store_dwordx4 v[64:67], v21, s[20:23], s42 offen sc1
mma a[64:67],a[232:235],v[240:243],a[64:67]
s_waitcnt lgkmcnt(4)
ldt a[248:249],v6 offset:128
ard v168,a4
mma a[64:67],a[236:239],v[48:51],a[64:67]
ard v169,a5
ard v170,a6
mma a[68:71],a[236:239],v[52:55],a[68:71]
ldt a[250:251],v6 offset:6272
ard v171,a7
mma a[68:71],a[232:235],v[244:247],a[68:71]
ard v172,a20
ard v173,a21
mma a[72:75],a[232:235],v[248:251],a[72:75]
ldt a[252:253],v6 offset:12416
ard v174,a22
mma a[72:75],a[236:239],v[56:59],a[72:75]
ard v175,a23
v_mul_f32 v168, v168, v29
mma a[76:79],a[236:239],v[60:63],a[76:79]
ldt a[254:255],v6 offset:18560
v_mul_f32 v169, v169, v29
mma a[76:79],a[232:235],v[252:255],a[76:79]
s_waitcnt lgkmcnt(6)
v_mul_f32 v170, v170, v29
v_mul_f32 v171, v171, v29
mma a[92:95],a[240:243],v[252:255],a[92:95]
s_waitcnt lgkmcnt(4)
ldt a[216:217],v7 offset:128
v_mul_f32 v172, v172, v29
mma a[92:95],a[244:247],v[60:63],a[92:95]
v_mul_f32 v173, v173, v29
v_mul_f32 v174, v174, v29
mma a[88:91],a[244:247],v[56:59],a[88:91]
ldt a[218:219],v7 offset:6272
v_mul_f32 v175, v175, v29
mma a[88:91],a[240:243],v[248:251],a[88:91]
cvt v88,v168,v169
cvt v89,v170,v171
mma a[84:87],a[240:243],v[244:247],a[84:87]
ldt a[220:221],v7 offset:12416
cvt v90,v172,v173
mma a[84:87],a[244:247],v[52:55],a[84:87]
s_add_u32 s42, s41, 6144
cvt v91,v174,v175
mma a[80:83],a[244:247],v[48:51],a[80:83]
ldt a[222:223],v7 offset:18560
mma a[80:83],a[240:243],v[240:243],a[80:83]
s_waitcnt lgkmcnt(6)
buffer_store_dwordx4 v[88:91], v21, s[20:23], s42 offen sc1
mma a[96:99],a[248:251],v[240:243],a[96:99]
s_waitcnt lgkmcnt(4)
ldt a[224:225],v4 offset:256
ard v176,a8
mma a[96:99],a[252:255],v[48:51],a[96:99]
ard v177,a9
ard v178,a10
mma a[100:103],a[252:255],v[52:55],a[100:103]
ldt a[226:227],v4 offset:6400
ard v179,a11
mma a[100:103],a[248:251],v[244:247],a[100:103]
ard v180,a24
ard v181,a25
mma a[104:107],a[248:251],v[248:251],a[104:107]
ldt a[228:229],v4 offset:12544
ard v182,a26
mma a[104:107],a[252:255],v[56:59],a[104:107]
ard v183,a27
v_mul_f32 v176, v176, v30
mma a[108:111],a[252:255],v[60:63],a[108:111]
ldt a[230:231],v4 offset:18688
v_mul_f32 v177, v177, v30
mma a[108:111],a[248:251],v[252:255],a[108:111]
s_waitcnt lgkmcnt(6)
v_mul_f32 v178, v178, v30
v_mul_f32 v179, v179, v30
mma a[124:127],a[216:219],v[252:255],a[124:127]
s_waitcnt lgkmcnt(4)
ldt a[232:233],v5 offset:256
v_mul_f32 v180, v180, v30
mma a[124:127],a[220:223],v[60:63],a[124:127]
v_mul_f32 v181, v181, v30
v_mul_f32 v182, v182, v30
mma a[120:123],a[220:223],v[56:59],a[120:123]
ldt a[234:235],v5 offset:6400
v_mul_f32 v183, v183, v30
mma a[120:123],a[216:219],v[248:251],a[120:123]
cvt v112,v176,v177
cvt v113,v178,v179
mma a[116:119],a[216:219],v[244:247],a[116:119]
ldt a[236:237],v5 offset:12544
cvt v114,v180,v181
mma a[116:119],a[220:223],v[52:55],a[116:119]
s_add_u32 s42, s41, 12288
cvt v115,v182,v183
mma a[112:115],a[220:223],v[48:51],a[112:115]
ldt a[238:239],v5 offset:18688
mma a[112:115],a[216:219],v[240:243],a[112:115]
s_waitcnt lgkmcnt(6)
buffer_store_dwordx4 v[112:115], v21, s[20:23], s42 offen sc1
mma a[128:131],a[224:227],v[240:243],a[128:131]
s_waitcnt lgkmcnt(4)
ldt a[240:241],v6 offset:256
ard v184,a12
mma a[128:131],a[228:231],v[48:51],a[128:131]
ard v185,a13
ard v186,a14
mma a[132:135],a[228:231],v[52:55],a[132:135]
ldt a[242:243],v6 offset:6400
ard v187,a15
mma a[132:135],a[224:227],v[244:247],a[132:135]
ard v188,a28
ard v189,a29
mma a[136:139],a[224:227],v[248:251],a[136:139]
ldt a[244:245],v6 offset:12544
ard v190,a30
mma a[136:139],a[228:231],v[56:59],a[136:139]
ard v191,a31
v_mul_f32 v184, v184, v31
mma a[140:143],a[228:231],v[60:63],a[140:143]
ldt a[246:247],v6 offset:18688
v_mul_f32 v185, v185, v31
mma a[140:143],a[224:227],v[252:255],a[140:143]
s_waitcnt lgkmcnt(6)
v_mul_f32 v186, v186, v31
v_mul_f32 v187, v187, v31
mma a[156:159],a[232:235],v[252:255],a[156:159]
s_waitcnt lgkmcnt(4)
ldt a[248:249],v7 offset:256
v_mul_f32 v188, v188, v31
mma a[156:159],a[236:239],v[60:63],a[156:159]
v_mul_f32 v189, v189, v31
v_mul_f32 v190, v190, v31
mma a[152:155],a[236:239],v[56:59],a[152:155]
ldt a[250:251],v7 offset:6400
v_mul_f32 v191, v191, v31
mma a[152:155],a[232:235],v[248:251],a[152:155]
cvt v136,v184,v185
cvt v137,v186,v187
mma a[148:151],a[232:235],v[244:247],a[148:151]
ldt a[252:253],v7 offset:12544
cvt v138,v188,v189
mma a[148:151],a[236:239],v[52:55],a[148:151]
s_add_u32 s42, s41, 18432
cvt v139,v190,v191
mma a[144:147],a[236:239],v[48:51],a[144:147]
ldt a[254:255],v7 offset:18688
mma a[144:147],a[232:235],v[240:243],a[144:147]
s_waitcnt lgkmcnt(6)
buffer_store_dwordx4 v[136:139], v21, s[20:23], s42 offen sc1
mma a[160:163],a[240:243],v[240:243],a[160:163]
s_waitcnt lgkmcnt(4)
ard v160,a32
ard v161,a33
mma a[160:163],a[244:247],v[48:51],a[160:163]
ard v162,a34
ard v163,a35
mma a[164:167],a[244:247],v[52:55],a[164:167]
ard v164,a48
ard v165,a49
mma a[164:167],a[240:243],v[244:247],a[164:167]
ard v166,a50
ard v167,a51
mma a[168:171],a[240:243],v[248:251],a[168:171]
v_mul_f32 v160, v160, v28
v_mul_f32 v161, v161, v28
mma a[168:171],a[244:247],v[56:59],a[168:171]
v_mul_f32 v162, v162, v28
v_mul_f32 v163, v163, v28
mma a[172:175],a[244:247],v[60:63],a[172:175]
v_mul_f32 v164, v164, v28
v_mul_f32 v165, v165, v28
mma a[172:175],a[240:243],v[252:255],a[172:175]
s_waitcnt lgkmcnt(2)
v_mul_f32 v166, v166, v28
v_mul_f32 v167, v167, v28
mma a[188:191],a[248:251],v[252:255],a[188:191]
s_waitcnt lgkmcnt(0)
cvt v68,v160,v161
cvt v69,v162,v163
mma a[188:191],a[252:255],v[60:63],a[188:191]
cvt v70,v164,v165
cvt v71,v166,v167
mma a[184:187],a[252:255],v[56:59],a[184:187]
s_add_u32 s42, s41, 1024
buffer_store_dwordx4 v[68:71], v21, s[20:23], s42 offen sc1
mma a[184:187],a[248:251],v[248:251],a[184:187]
ard v168,a36
ard v169,a37
mma a[180:183],a[248:251],v[244:247],a[180:183]
ard v170,a38
ard v171,a39
mma a[180:183],a[252:255],v[52:55],a[180:183]
ard v172,a52
ard v173,a53
mma a[176:179],a[252:255],v[48:51],a[176:179]
ard v174,a54
ard v175,a55
mma a[176:179],a[248:251],v[240:243],a[176:179]
v_mul_f32 v168, v168, v29
v_mul_f32 v169, v169, v29
v_mul_f32 v170, v170, v29
v_mul_f32 v171, v171, v29
v_mul_f32 v172, v172, v29
v_mul_f32 v173, v173, v29
v_mul_f32 v174, v174, v29
v_mul_f32 v175, v175, v29
cvt v92,v168,v169
cvt v93,v170,v171
cvt v94,v172,v173
cvt v95,v174,v175
s_add_u32 s42, s41, 7168
buffer_store_dwordx4 v[92:95], v21, s[20:23], s42 offen sc1
ard v176,a40
ard v177,a41
ard v178,a42
ard v179,a43
ard v180,a56
ard v181,a57
ard v182,a58
ard v183,a59
v_mul_f32 v176, v176, v30
v_mul_f32 v177, v177, v30
v_mul_f32 v178, v178, v30
v_mul_f32 v179, v179, v30
v_mul_f32 v180, v180, v30
v_mul_f32 v181, v181, v30
v_mul_f32 v182, v182, v30
v_mul_f32 v183, v183, v30
cvt v116,v176,v177
cvt v117,v178,v179
cvt v118,v180,v181
cvt v119,v182,v183
s_add_u32 s42, s41, 13312
buffer_store_dwordx4 v[116:119], v21, s[20:23], s42 offen sc1
ard v184,a44
ard v185,a45
ard v186,a46
ard v187,a47
ard v188,a60
ard v189,a61
ard v190,a62
ard v191,a63
v_mul_f32 v184, v184, v31
v_mul_f32 v185, v185, v31
v_mul_f32 v186, v186, v31
v_mul_f32 v187, v187, v31
v_mul_f32 v188, v188, v31
v_mul_f32 v189, v189, v31
v_mul_f32 v190, v190, v31
v_mul_f32 v191, v191, v31
cvt v140,v184,v185
cvt v141,v186,v187
cvt v142,v188,v189
cvt v143,v190,v191
s_add_u32 s42, s41, 19456
buffer_store_dwordx4 v[140:143], v21, s[20:23], s42 offen sc1
ard v160,a64
ard v161,a65
ard v162,a66
ard v163,a67
ard v164,a80
ard v165,a81
ard v166,a82
ard v167,a83
v_mul_f32 v160, v160, v28
v_mul_f32 v161, v161, v28
v_mul_f32 v162, v162, v28
v_mul_f32 v163, v163, v28
v_mul_f32 v164, v164, v28
v_mul_f32 v165, v165, v28
v_mul_f32 v166, v166, v28
v_mul_f32 v167, v167, v28
cvt v72,v160,v161
cvt v73,v162,v163
cvt v74,v164,v165
cvt v75,v166,v167
ard v168,a68
ard v169,a69
ard v170,a70
ard v171,a71
ard v172,a84
ard v173,a85
ard v174,a86
ard v175,a87
v_mul_f32 v168, v168, v29
v_mul_f32 v169, v169, v29
v_mul_f32 v170, v170, v29
v_mul_f32 v171, v171, v29
v_mul_f32 v172, v172, v29
v_mul_f32 v173, v173, v29
v_mul_f32 v174, v174, v29
v_mul_f32 v175, v175, v29
cvt v96,v168,v169
cvt v97,v170,v171
cvt v98,v172,v173
cvt v99,v174,v175
ard v176,a72
ard v177,a73
ard v178,a74
ard v179,a75
ard v180,a88
ard v181,a89
ard v182,a90
ard v183,a91
v_mul_f32 v176, v176, v30
v_mul_f32 v177, v177, v30
v_mul_f32 v178, v178, v30
v_mul_f32 v179, v179, v30
v_mul_f32 v180, v180, v30
v_mul_f32 v181, v181, v30
v_mul_f32 v182, v182, v30
v_mul_f32 v183, v183, v30
cvt v120,v176,v177
cvt v121,v178,v179
cvt v122,v180,v181
cvt v123,v182,v183
ard v184,a76
ard v185,a77
ard v186,a78
ard v187,a79
ard v188,a92
ard v189,a93
ard v190,a94
ard v191,a95
v_mul_f32 v184, v184, v31
v_mul_f32 v185, v185, v31
v_mul_f32 v186, v186, v31
v_mul_f32 v187, v187, v31
v_mul_f32 v188, v188, v31
v_mul_f32 v189, v189, v31
v_mul_f32 v190, v190, v31
v_mul_f32 v191, v191, v31
cvt v144,v184,v185
cvt v145,v186,v187
cvt v146,v188,v189
cvt v147,v190,v191
s_add_u32 s42, s41, 2048
buffer_store_dwordx4 v[72:75], v21, s[20:23], s42 offen sc1
ard v160,a96
ard v161,a97
ard v162,a98
ard v163,a99
ard v164,a112
ard v165,a113
ard v166,a114
ard v167,a115
v_mul_f32 v160, v160, v28
v_mul_f32 v161, v161, v28
v_mul_f32 v162, v162, v28
v_mul_f32 v163, v163, v28
v_mul_f32 v164, v164, v28
v_mul_f32 v165, v165, v28
v_mul_f32 v166, v166, v28
v_mul_f32 v167, v167, v28
cvt v76,v160,v161
cvt v77,v162,v163
cvt v78,v164,v165
cvt v79,v166,v167
ard v168,a100
ard v169,a101
ard v170,a102
ard v171,a103
ard v172,a116
ard v173,a117
ard v174,a118
ard v175,a119
v_mul_f32 v168, v168, v29
v_mul_f32 v169, v169, v29
v_mul_f32 v170, v170, v29
v_mul_f32 v171, v171, v29
v_mul_f32 v172, v172, v29
v_mul_f32 v173, v173, v29
v_mul_f32 v174, v174, v29
v_mul_f32 v175, v175, v29
cvt v100,v168,v169
cvt v101,v170,v171
cvt v102,v172,v173
cvt v103,v174,v175
ard v176,a104
ard v177,a105
ard v178,a106
ard v179,a107
ard v180,a120
ard v181,a121
ard v182,a122
ard v183,a123
v_mul_f32 v176, v176, v30
v_mul_f32 v177, v177, v30
v_mul_f32 v178, v178, v30
v_mul_f32 v179, v179, v30
v_mul_f32 v180, v180, v30
v_mul_f32 v181, v181, v30
v_mul_f32 v182, v182, v30
v_mul_f32 v183, v183, v30
cvt v124,v176,v177
cvt v125,v178,v179
cvt v126,v180,v181
cvt v127,v182,v183
ard v184,a108
ard v185,a109
ard v186,a110
ard v187,a111
ard v188,a124
ard v189,a125
ard v190,a126
ard v191,a127
v_mul_f32 v184, v184, v31
v_mul_f32 v185, v185, v31
v_mul_f32 v186, v186, v31
v_mul_f32 v187, v187, v31
v_mul_f32 v188, v188, v31
v_mul_f32 v189, v189, v31
v_mul_f32 v190, v190, v31
v_mul_f32 v191, v191, v31
cvt v148,v184,v185
cvt v149,v186,v187
cvt v150,v188,v189
cvt v151,v190,v191
s_add_u32 s42, s41, 8192
buffer_store_dwordx4 v[96:99], v21, s[20:23], s42 offen sc1
s_barrier
ldt a[192:193],v15
ldt a[194:195],v15 offset:5120
ldt a[196:197],v15 offset:10240
ldt a[198:199],v15 offset:15360
ldt a[200:201],v15 offset:49152
ldt a[202:203],v15 offset:54272
ldt a[204:205],v15 offset:59392
ldt a[206:207],v15 offset:64512
ldt a[208:209],v15 offset:24576
ldt a[210:211],v15 offset:29696
ldt a[212:213],v15 offset:34816
ldt a[214:215],v15 offset:39936
ard v160,a128
ard v161,a129
ard v162,a130
ard v163,a131
ard v164,a144
ard v165,a145
ard v166,a146
ard v167,a147
v_mul_f32 v160, v160, v28
v_mul_f32 v161, v161, v28
v_mul_f32 v162, v162, v28
v_mul_f32 v163, v163, v28
v_mul_f32 v164, v164, v28
v_mul_f32 v165, v165, v28
v_mul_f32 v166, v166, v28
v_mul_f32 v167, v167, v28
cvt v80,v160,v161
cvt v81,v162,v163
cvt v82,v164,v165
cvt v83,v166,v167
ard v168,a132
ard v169,a133
ard v170,a134
ard v171,a135
ard v172,a148
ard v173,a149
ard v174,a150
ard v175,a151
v_mul_f32 v168, v168, v29
v_mul_f32 v169, v169, v29
v_mul_f32 v170, v170, v29
v_mul_f32 v171, v171, v29
v_mul_f32 v172, v172, v29
v_mul_f32 v173, v173, v29
v_mul_f32 v174, v174, v29
v_mul_f32 v175, v175, v29
cvt v104,v168,v169
cvt v105,v170,v171
cvt v106,v172,v173
cvt v107,v174,v175
ard v176,a136
ard v177,a137
ard v178,a138
ard v179,a139
ard v180,a152
ard v181,a153
ard v182,a154
ard v183,a155
v_mul_f32 v176, v176, v30
v_mul_f32 v177, v177, v30
v_mul_f32 v178, v178, v30
v_mul_f32 v179, v179, v30
v_mul_f32 v180, v180, v30
v_mul_f32 v181, v181, v30
v_mul_f32 v182, v182, v30
v_mul_f32 v183, v183, v30
cvt v128,v176,v177
cvt v129,v178,v179
cvt v130,v180,v181
cvt v131,v182,v183
ard v184,a140
ard v185,a141
ard v186,a142
ard v187,a143
ard v188,a156
ard v189,a157
ard v190,a158
ard v191,a159
v_mul_f32 v184, v184, v31
v_mul_f32 v185, v185, v31
v_mul_f32 v186, v186, v31
v_mul_f32 v187, v187, v31
v_mul_f32 v188, v188, v31
v_mul_f32 v189, v189, v31
v_mul_f32 v190, v190, v31
v_mul_f32 v191, v191, v31
cvt v152,v184,v185
cvt v153,v186,v187
cvt v154,v188,v189
cvt v155,v190,v191
s_add_u32 s42, s41, 14336
buffer_store_dwordx4 v[120:123], v21, s[20:23], s42 offen sc1
ard v160,a160
ard v161,a161
ard v162,a162
ard v163,a163
ard v164,a176
ard v165,a177
ard v166,a178
ard v167,a179
v_mul_f32 v160, v160, v28
v_mul_f32 v161, v161, v28
v_mul_f32 v162, v162, v28
v_mul_f32 v163, v163, v28
v_mul_f32 v164, v164, v28
v_mul_f32 v165, v165, v28
v_mul_f32 v166, v166, v28
v_mul_f32 v167, v167, v28
cvt v84,v160,v161
cvt v85,v162,v163
cvt v86,v164,v165
cvt v87,v166,v167
ard v168,a164
ard v169,a165
ard v170,a166
ard v171,a167
ard v172,a180
ard v173,a181
ard v174,a182
ard v175,a183
v_mul_f32 v168, v168, v29
v_mul_f32 v169, v169, v29
v_mul_f32 v170, v170, v29
v_mul_f32 v171, v171, v29
v_mul_f32 v172, v172, v29
v_mul_f32 v173, v173, v29
v_mul_f32 v174, v174, v29
v_mul_f32 v175, v175, v29
cvt v108,v168,v169
cvt v109,v170,v171
cvt v110,v172,v173
cvt v111,v174,v175
ard v176,a168
ard v177,a169
ard v178,a170
ard v179,a171
ard v180,a184
ard v181,a185
ard v182,a186
ard v183,a187
v_mul_f32 v176, v176, v30
v_mul_f32 v177, v177, v30
v_mul_f32 v178, v178, v30
v_mul_f32 v179, v179, v30
v_mul_f32 v180, v180, v30
v_mul_f32 v181, v181, v30
v_mul_f32 v182, v182, v30
v_mul_f32 v183, v183, v30
cvt v132,v176,v177
cvt v133,v178,v179
cvt v134,v180,v181
cvt v135,v182,v183
ard v184,a172
ard v185,a173
ard v186,a174
ard v187,a175
ard v188,a188
ard v189,a189
ard v190,a190
ard v191,a191
v_mul_f32 v184, v184, v31
v_mul_f32 v185, v185, v31
v_mul_f32 v186, v186, v31
v_mul_f32 v187, v187, v31
v_mul_f32 v188, v188, v31
v_mul_f32 v189, v189, v31
v_mul_f32 v190, v190, v31
v_mul_f32 v191, v191, v31
cvt v156,v184,v185
cvt v157,v186,v187
cvt v158,v188,v189
cvt v159,v190,v191
s_add_u32 s42, s41, 20480
s_waitcnt lgkmcnt(10)
buffer_store_dwordx4 v[144:147], v21, s[20:23], s42 offen sc1
mma a[96:99],a[192:195],v[64:67],0
s_waitcnt lgkmcnt(8)
ldt a[216:217],v16
mma a[96:99],a[196:199],v[68:71],a[96:99]
s_waitcnt lgkmcnt(7)
ldt a[218:219],v16 offset:5120
mma a[96:99],a[200:203],v[72:75],a[96:99]
s_waitcnt vmcnt(4)
s_waitcnt lgkmcnt(6)
buffer_store_dword v47, v17, s[20:23], 0 offen sc1
mma a[96:99],a[204:207],v[76:79],a[96:99]
s_waitcnt lgkmcnt(4)
ldt a[220:221],v16 offset:10240
mma a[96:99],a[208:211],v[80:83],a[96:99]
s_waitcnt lgkmcnt(3)
ldt a[222:223],v16 offset:15360
mma a[96:99],a[212:215],v[84:87],a[96:99]
s_add_u32 s42, s41, 3072
buffer_store_dwordx4 v[76:79], v21, s[20:23], s42 offen sc1
mma a[100:103],a[212:215],v[108:111],0
ldt a[224:225],v16 offset:49152
mma a[100:103],a[208:211],v[104:107],a[100:103]
v_add_u32 v5, 100352, v15
v_add_u32 v6, 100352, v16
mma a[100:103],a[204:207],v[100:103],a[100:103]
ldt a[226:227],v16 offset:54272
mma a[100:103],a[200:203],v[96:99],a[100:103]
ldt a[228:229],v16 offset:59392
mma a[100:103],a[196:199],v[92:95],a[100:103]
mma a[100:103],a[192:195],v[88:91],a[100:103]
ldt a[230:231],v16 offset:64512
mma a[104:107],a[192:195],v[112:115],0
ldt a[232:233],v16 offset:24576
mma a[104:107],a[196:199],v[116:119],a[104:107]
mma a[104:107],a[200:203],v[120:123],a[104:107]
ldt a[234:235],v16 offset:29696
mma a[104:107],a[204:207],v[124:127],a[104:107]
ldt a[236:237],v16 offset:34816
mma a[104:107],a[208:211],v[128:131],a[104:107]
mma a[104:107],a[212:215],v[132:135],a[104:107]
ldt a[238:239],v16 offset:39936
mma a[108:111],a[212:215],v[156:159],0
mma a[108:111],a[208:211],v[152:155],a[108:111]
s_add_u32 s42, s41, 9216
buffer_store_dwordx4 v[100:103], v21, s[20:23], s42 offen sc1
mma a[108:111],a[204:207],v[148:151],a[108:111]
mma a[108:111],a[200:203],v[144:147],a[108:111]
mma a[108:111],a[196:199],v[140:143],a[108:111]
mma a[108:111],a[192:195],v[136:139],a[108:111]
s_waitcnt lgkmcnt(10)
mma a[112:115],a[216:219],v[64:67],0
s_waitcnt lgkmcnt(8)
ldt a[192:193],v15 offset:64
awr a160,v84
mma a[112:115],a[220:223],v[68:71],a[112:115]
s_waitcnt lgkmcnt(7)
ldt a[194:195],v15 offset:5184
mma a[112:115],a[224:227],v[72:75],a[112:115]
s_waitcnt lgkmcnt(6)
mma a[112:115],a[228:231],v[76:79],a[112:115]
s_waitcnt lgkmcnt(4)
ldt a[196:197],v15 offset:10304
awr a161,v85
mma a[112:115],a[232:235],v[80:83],a[112:115]
s_waitcnt lgkmcnt(3)
ldt a[198:199],v15 offset:15424
mma a[112:115],a[236:239],v[84:87],a[112:115]
mma a[116:119],a[236:239],v[108:111],0
ldt a[200:201],v15 offset:49216
awr a162,v86
mma a[116:119],a[232:235],v[104:107],a[116:119]
ldt a[202:203],v15 offset:54336
mma a[116:119],a[228:231],v[100:103],a[116:119]
mma a[116:119],a[224:227],v[96:99],a[116:119]
ldt a[204:205],v15 offset:59456
awr a163,v87
mma a[116:119],a[220:223],v[92:95],a[116:119]
s_add_u32 s42, s41, 15360
buffer_store_dwordx4 v[124:127], v21, s[20:23], s42 offen sc1
mma a[116:119],a[216:219],v[88:91],a[116:119]
ldt a[206:207],v15 offset:64576
mma a[120:123],a[216:219],v[112:115],0
ldt a[208:209],v15 offset:24640
awr a164,v108
mma a[120:123],a[220:223],v[116:119],a[120:123]
mma a[120:123],a[224:227],v[120:123],a[120:123]
ldt a[210:211],v15 offset:29760
mma a[120:123],a[228:231],v[124:127],a[120:123]
ldt a[212:213],v15 offset:34880
awr a165,v109
mma a[120:123],a[232:235],v[128:131],a[120:123]
mma a[120:123],a[236:239],v[132:135],a[120:123]
ldt a[214:215],v15 offset:40000
mma a[124:127],a[236:239],v[156:159],0
awr a166,v110
mma a[124:127],a[232:235],v[152:155],a[124:127]
mma a[124:127],a[228:231],v[148:151],a[124:127]
mma a[124:127],a[224:227],v[144:147],a[124:127]
awr a167,v111
mma a[124:127],a[220:223],v[140:143],a[124:127]
mma a[124:127],a[216:219],v[136:139],a[124:127]
s_waitcnt lgkmcnt(10)
mma a[128:131],a[192:195],v[64:67],0
s_waitcnt lgkmcnt(8)
ldt a[216:217],v16 offset:64
awr a168,v132
mma a[128:131],a[196:199],v[68:71],a[128:131]
s_waitcnt lgkmcnt(7)
ldt a[218:219],v16 offset:5184
mma a[128:131],a[200:203],v[72:75],a[128:131]
s_add_u32 s42, s41, 21504
s_waitcnt lgkmcnt(6)
buffer_store_dwordx4 v[148:151], v21, s[20:23], s42 offen sc1
mma a[128:131],a[204:207],v[76:79],a[128:131]
s_waitcnt lgkmcnt(4)
ldt a[220:221],v16 offset:10304
awr a169,v133
mma a[128:131],a[208:211],v[80:83],a[128:131]
s_waitcnt lgkmcnt(3)
ldt a[222:223],v16 offset:15424
mma a[128:131],a[212:215],v[84:87],a[128:131]
mma a[132:135],a[212:215],v[108:111],0
ldt a[224:225],v16 offset:49216
awr a170,v134
mma a[132:135],a[208:211],v[104:107],a[132:135]
ldt a[226:227],v16 offset:54336
mma a[132:135],a[204:207],v[100:103],a[132:135]
mma a[132:135],a[200:203],v[96:99],a[132:135]
ldt a[228:229],v16 offset:59456
awr a171,v135
mma a[132:135],a[196:199],v[92:95],a[132:135]
mma a[132:135],a[192:195],v[88:91],a[132:135]
ldt a[230:231],v16 offset:64576
mma a[136:139],a[192:195],v[112:115],0
ldt a[232:233],v16 offset:24640
awr a172,v156
mma a[136:139],a[196:199],v[116:119],a[136:139]
mma a[136:139],a[200:203],v[120:123],a[136:139]
ldt a[234:235],v16 offset:29760
mma a[136:139],a[204:207],v[124:127],a[136:139]
ldt a[236:237],v16 offset:34880
awr a173,v157
mma a[136:139],a[208:211],v[128:131],a[136:139]
s_add_u32 s42, s41, 4096
buffer_store_dwordx4 v[80:83], v21, s[20:23], s42 offen sc1
mma a[136:139],a[212:215],v[132:135],a[136:139]
ldt a[238:239],v16 offset:40000
mma a[140:143],a[212:215],v[156:159],0
awr a174,v158
mma a[140:143],a[208:211],v[152:155],a[140:143]
mma a[140:143],a[204:207],v[148:151],a[140:143]
mma a[140:143],a[200:203],v[144:147],a[140:143]
awr a175,v159
mma a[140:143],a[196:199],v[140:143],a[140:143]
mma a[140:143],a[192:195],v[136:139],a[140:143]
s_waitcnt lgkmcnt(10)
mma a[144:147],a[216:219],v[64:67],0
s_buffer_load_dwordx4 s[88:91], s[20:23], s87 glc
ldt a[192:193],v15 offset:128
s_waitcnt lgkmcnt(9)
mma a[144:147],a[220:223],v[68:71],a[144:147]
s_waitcnt lgkmcnt(7)
ldt a[194:195],v15 offset:5248
mma a[144:147],a[224:227],v[72:75],a[144:147]
s_waitcnt lgkmcnt(6)
mma a[144:147],a[228:231],v[76:79],a[144:147]
s_waitcnt lgkmcnt(4)
ldt a[196:197],v15 offset:10368
mma a[144:147],a[232:235],v[80:83],a[144:147]
s_waitcnt lgkmcnt(3)
ldt a[198:199],v15 offset:15488
mma a[144:147],a[236:239],v[84:87],a[144:147]
s_add_u32 s42, s41, 10240
buffer_store_dwordx4 v[104:107], v21, s[20:23], s42 offen sc1
mma a[148:151],a[236:239],v[108:111],0
ldt a[200:201],v15 offset:49280
mma a[148:151],a[232:235],v[104:107],a[148:151]
ldt a[202:203],v15 offset:54400
mma a[148:151],a[228:231],v[100:103],a[148:151]
mma a[148:151],a[224:227],v[96:99],a[148:151]
ldt a[204:205],v15 offset:59520
mma a[148:151],a[220:223],v[92:95],a[148:151]
mma a[148:151],a[216:219],v[88:91],a[148:151]
ldt a[206:207],v15 offset:64640
mma a[152:155],a[216:219],v[112:115],0
ldt a[208:209],v15 offset:24704
mma a[152:155],a[220:223],v[116:119],a[152:155]
mma a[152:155],a[224:227],v[120:123],a[152:155]
ldt a[210:211],v15 offset:29824
mma a[152:155],a[228:231],v[124:127],a[152:155]
ldt a[212:213],v15 offset:34944
mma a[152:155],a[232:235],v[128:131],a[152:155]
mma a[152:155],a[236:239],v[132:135],a[152:155]
ldt a[214:215],v15 offset:40064
mma a[156:159],a[236:239],v[156:159],0
mma a[156:159],a[232:235],v[152:155],a[156:159]
s_add_u32 s42, s41, 16384
buffer_store_dwordx4 v[128:131], v21, s[20:23], s42 offen sc1
mma a[156:159],a[228:231],v[148:151],a[156:159]
mma a[156:159],a[224:227],v[144:147],a[156:159]
mma a[156:159],a[220:223],v[140:143],a[156:159]
mma a[156:159],a[216:219],v[136:139],a[156:159]
s_waitcnt lgkmcnt(10)
mma v[160:163],a[192:195],v[64:67],0
s_waitcnt lgkmcnt(8)
ldt a[216:217],v16 offset:128
mma v[160:163],a[196:199],v[68:71],v[160:163]
s_waitcnt lgkmcnt(7)
ldt a[218:219],v16 offset:5248
mma v[160:163],a[200:203],v[72:75],v[160:163]
s_waitcnt lgkmcnt(6)
mma v[160:163],a[204:207],v[76:79],v[160:163]
s_waitcnt lgkmcnt(4)
ldt a[220:221],v16 offset:10368
mma v[160:163],a[208:211],v[80:83],v[160:163]
s_waitcnt lgkmcnt(3)
ldt a[222:223],v16 offset:15488
mma v[160:163],a[212:215],v[84:87],v[160:163]
mma v[164:167],a[212:215],v[108:111],0
ldt a[224:225],v16 offset:49280
mma v[164:167],a[208:211],v[104:107],v[164:167]
ldt a[226:227],v16 offset:54400
mma v[164:167],a[204:207],v[100:103],v[164:167]
mma v[164:167],a[200:203],v[96:99],v[164:167]
ldt a[228:229],v16 offset:59520
mma v[164:167],a[196:199],v[92:95],v[164:167]
s_add_u32 s42, s41, 22528
buffer_store_dwordx4 v[152:155], v21, s[20:23], s42 offen sc1
mma v[164:167],a[192:195],v[88:91],v[164:167]
ldt a[230:231],v16 offset:64640
mma v[168:171],a[192:195],v[112:115],0
ldt a[232:233],v16 offset:24704
mma v[168:171],a[196:199],v[116:119],v[168:171]
mma v[168:171],a[200:203],v[120:123],v[168:171]
ldt a[234:235],v16 offset:29824
mma v[168:171],a[204:207],v[124:127],v[168:171]
ldt a[236:237],v16 offset:34944
mma v[168:171],a[208:211],v[128:131],v[168:171]
mma v[168:171],a[212:215],v[132:135],v[168:171]
ldt a[238:239],v16 offset:40064
mma v[172:175],a[212:215],v[156:159],0
mma v[172:175],a[208:211],v[152:155],v[172:175]
mma v[172:175],a[204:207],v[148:151],v[172:175]
mma v[172:175],a[200:203],v[144:147],v[172:175]
mma v[172:175],a[196:199],v[140:143],v[172:175]
mma v[172:175],a[192:195],v[136:139],v[172:175]
s_waitcnt lgkmcnt(10)
mma v[176:179],a[216:219],v[64:67],0
s_waitcnt lgkmcnt(8)
ldt a[192:193],v15 offset:192
mma v[176:179],a[220:223],v[68:71],v[176:179]
s_waitcnt lgkmcnt(7)
ldt a[194:195],v15 offset:5312
mma v[176:179],a[224:227],v[72:75],v[176:179]
s_waitcnt lgkmcnt(6)
mma v[176:179],a[228:231],v[76:79],v[176:179]
s_waitcnt lgkmcnt(4)
ldt a[196:197],v15 offset:10432
mma v[176:179],a[232:235],v[80:83],v[176:179]
s_waitcnt lgkmcnt(3)
ldt a[198:199],v15 offset:15552
mma v[176:179],a[236:239],v[84:87],v[176:179]
mma v[180:183],a[236:239],v[108:111],0
ldt a[200:201],v15 offset:49344
mma v[180:183],a[232:235],v[104:107],v[180:183]
ldt a[202:203],v15 offset:54464
mma v[180:183],a[228:231],v[100:103],v[180:183]
mma v[180:183],a[224:227],v[96:99],v[180:183]
ldt a[204:205],v15 offset:59584
mma v[180:183],a[220:223],v[92:95],v[180:183]
mma v[180:183],a[216:219],v[88:91],v[180:183]
ldt a[206:207],v15 offset:64704
mma v[184:187],a[216:219],v[112:115],0
ldt a[208:209],v15 offset:24768
mma v[184:187],a[220:223],v[116:119],v[184:187]
mma v[184:187],a[224:227],v[120:123],v[184:187]
ldt a[210:211],v15 offset:29888
mma v[184:187],a[228:231],v[124:127],v[184:187]
ldt a[212:213],v15 offset:35008
mma v[184:187],a[232:235],v[128:131],v[184:187]
mma v[184:187],a[236:239],v[132:135],v[184:187]
ldt a[214:215],v15 offset:40128
mma v[188:191],a[236:239],v[156:159],0
mma v[188:191],a[232:235],v[152:155],v[188:191]
mma v[188:191],a[228:231],v[148:151],v[188:191]
mma v[188:191],a[224:227],v[144:147],v[188:191]
mma v[188:191],a[220:223],v[140:143],v[188:191]
s_waitcnt lgkmcnt(0)
s_add_u32 s88, s88, s89
s_add_u32 s88, s88, s90
s_add_u32 s88, s88, s91
s_cmp_eq_u32 s88, 3
s_cbranch_scc0 L_w0_poll0
L_w0_poll0_ret:
mma v[188:191],a[216:219],v[136:139],v[188:191]
mma v[192:195],a[192:195],v[64:67],0
ldt a[216:217],v16 offset:192
mma v[192:195],a[196:199],v[68:71],v[192:195]
ldt a[218:219],v16 offset:5312
mma v[192:195],a[200:203],v[72:75],v[192:195]
s_add_u32 s38, s56, 0
bld a[0:3],v21,s[20:23],s38 offen sc1
mma v[192:195],a[204:207],v[76:79],v[192:195]
ldt a[220:221],v16 offset:10432
mma v[192:195],a[208:211],v[80:83],v[192:195]
ldt a[222:223],v16 offset:15552
mma v[192:195],a[212:215],v[84:87],v[192:195]
bld a[4:7],v21,s[20:23],s38 offen offset:1024 sc1
mma v[196:199],a[212:215],v[108:111],0
ldt a[224:225],v16 offset:49344
mma v[196:199],a[208:211],v[104:107],v[196:199]
ldt a[226:227],v16 offset:54464
mma v[196:199],a[204:207],v[100:103],v[196:199]
s_add_u32 s38, s57, 0
bld a[8:11],v21,s[20:23],s38 offen sc1
mma v[196:199],a[200:203],v[96:99],v[196:199]
ldt a[228:229],v16 offset:59584
mma v[196:199],a[196:199],v[92:95],v[196:199]
bld a[12:15],v21,s[20:23],s38 offen offset:1024 sc1
mma v[196:199],a[192:195],v[88:91],v[196:199]
ldt a[230:231],v16 offset:64704
mma v[200:203],a[192:195],v[112:115],0
ldt a[232:233],v16 offset:24768
mma v[200:203],a[196:199],v[116:119],v[200:203]
mma v[200:203],a[200:203],v[120:123],v[200:203]
ldt a[234:235],v16 offset:29888
mma v[200:203],a[204:207],v[124:127],v[200:203]
ldt a[236:237],v16 offset:35008
mma v[200:203],a[208:211],v[128:131],v[200:203]
s_add_u32 s38, s58, 0
bld a[16:19],v21,s[20:23],s38 offen sc1
mma v[200:203],a[212:215],v[132:135],v[200:203]
ldt a[238:239],v16 offset:40128
mma v[204:207],a[212:215],v[156:159],0
bld a[20:23],v21,s[20:23],s38 offen offset:1024 sc1
mma v[204:207],a[208:211],v[152:155],v[204:207]
mma v[204:207],a[204:207],v[148:151],v[204:207]
mma v[204:207],a[200:203],v[144:147],v[204:207]
s_add_u32 s38, s56, 6144
bld a[24:27],v21,s[20:23],s38 offen sc1
mma v[204:207],a[196:199],v[140:143],v[204:207]
mma v[204:207],a[192:195],v[136:139],v[204:207]
s_waitcnt lgkmcnt(10)
mma v[208:211],a[216:219],v[64:67],0
s_waitcnt lgkmcnt(8)
ldt a[192:193],v15 offset:256
mma v[208:211],a[220:223],v[68:71],v[208:211]
s_waitcnt lgkmcnt(7)
ldt a[194:195],v15 offset:5376
mma v[208:211],a[224:227],v[72:75],v[208:211]
s_waitcnt lgkmcnt(6)
bld a[28:31],v21,s[20:23],s38 offen offset:1024 sc1
mma v[208:211],a[228:231],v[76:79],v[208:211]
s_waitcnt lgkmcnt(4)
ldt a[196:197],v15 offset:10496
mma v[208:211],a[232:235],v[80:83],v[208:211]
s_waitcnt lgkmcnt(3)
ldt a[198:199],v15 offset:15616
mma v[208:211],a[236:239],v[84:87],v[208:211]
s_add_u32 s38, s57, 6144
bld a[32:35],v21,s[20:23],s38 offen sc1
mma v[212:215],a[236:239],v[108:111],0
ldt a[200:201],v15 offset:49408
mma v[212:215],a[232:235],v[104:107],v[212:215]
ldt a[202:203],v15 offset:54528
mma v[212:215],a[228:231],v[100:103],v[212:215]
bld a[36:39],v21,s[20:23],s38 offen offset:1024 sc1
mma v[212:215],a[224:227],v[96:99],v[212:215]
ldt a[204:205],v15 offset:59648
mma v[212:215],a[220:223],v[92:95],v[212:215]
mma v[212:215],a[216:219],v[88:91],v[212:215]
ldt a[206:207],v15 offset:64768
mma v[216:219],a[216:219],v[112:115],0
ldt a[208:209],v15 offset:24832
mma v[216:219],a[220:223],v[116:119],v[216:219]
s_add_u32 s38, s58, 6144
bld a[40:43],v21,s[20:23],s38 offen sc1
mma v[216:219],a[224:227],v[120:123],v[216:219]
ldt a[210:211],v15 offset:29952
mma v[216:219],a[228:231],v[124:127],v[216:219]
ldt a[212:213],v15 offset:35072
mma v[216:219],a[232:235],v[128:131],v[216:219]
bld a[44:47],v21,s[20:23],s38 offen offset:1024 sc1
mma v[216:219],a[236:239],v[132:135],v[216:219]
ldt a[214:215],v15 offset:40192
mma v[220:223],a[236:239],v[156:159],0
s_add_u32 s38, s56, 12288
bld a[48:51],v21,s[20:23],s38 offen sc1
mma v[220:223],a[232:235],v[152:155],v[220:223]
mma v[220:223],a[228:231],v[148:151],v[220:223]
mma v[220:223],a[224:227],v[144:147],v[220:223]
bld a[52:55],v21,s[20:23],s38 offen offset:1024 sc1
mma v[220:223],a[220:223],v[140:143],v[220:223]
mma v[220:223],a[216:219],v[136:139],v[220:223]
s_waitcnt lgkmcnt(10)
mma v[224:227],a[192:195],v[64:67],0
s_waitcnt vmcnt(18)
s_waitcnt lgkmcnt(8)
buffer_store_dword v47, v17, s[20:23], 0 offen offset:128 sc1
mma v[224:227],a[196:199],v[68:71],v[224:227]
ldt a[216:217],v16 offset:256
s_add_u32 s38, s57, 12288
s_waitcnt lgkmcnt(7)
bld a[56:59],v21,s[20:23],s38 offen sc1
mma v[224:227],a[200:203],v[72:75],v[224:227]
s_waitcnt lgkmcnt(5)
ldt a[218:219],v16 offset:5376
mma v[224:227],a[204:207],v[76:79],v[224:227]
s_waitcnt lgkmcnt(4)
ldt a[220:221],v16 offset:10496
mma v[224:227],a[208:211],v[80:83],v[224:227]
s_waitcnt lgkmcnt(3)
ldt a[222:223],v16 offset:15616
mma v[224:227],a[212:215],v[84:87],v[224:227]
bld a[60:63],v21,s[20:23],s38 offen offset:1024 sc1
mma v[228:231],a[212:215],v[108:111],0
ldt a[224:225],v16 offset:49408
mma v[228:231],a[208:211],v[104:107],v[228:231]
ldt a[226:227],v16 offset:54528
mma v[228:231],a[204:207],v[100:103],v[228:231]
s_add_u32 s38, s58, 12288
bld a[64:67],v21,s[20:23],s38 offen sc1
mma v[228:231],a[200:203],v[96:99],v[228:231]
ldt a[228:229],v16 offset:59648
mma v[228:231],a[196:199],v[92:95],v[228:231]
mma v[228:231],a[192:195],v[88:91],v[228:231]
ldt a[230:231],v16 offset:64768
mma v[232:235],a[192:195],v[112:115],0
ldt a[232:233],v16 offset:24832
mma v[232:235],a[196:199],v[116:119],v[232:235]
bld a[68:71],v21,s[20:23],s38 offen offset:1024 sc1
mma v[232:235],a[200:203],v[120:123],v[232:235]
ldt a[234:235],v16 offset:29952
mma v[232:235],a[204:207],v[124:127],v[232:235]
ldt a[236:237],v16 offset:35072
mma v[232:235],a[208:211],v[128:131],v[232:235]
s_add_u32 s38, s56, 18432
bld a[72:75],v21,s[20:23],s38 offen sc1
mma v[232:235],a[212:215],v[132:135],v[232:235]
ldt a[238:239],v16 offset:40192
mma v[236:239],a[212:215],v[156:159],0
bld a[76:79],v21,s[20:23],s38 offen offset:1024 sc1
mma v[236:239],a[208:211],v[152:155],v[236:239]
mma v[236:239],a[204:207],v[148:151],v[236:239]
mma v[236:239],a[200:203],v[144:147],v[236:239]
mma v[236:239],a[196:199],v[140:143],v[236:239]
s_add_u32 s38, s57, 18432
bld a[80:83],v21,s[20:23],s38 offen sc1
mma v[236:239],a[192:195],v[136:139],v[236:239]
s_waitcnt lgkmcnt(10)
mma v[240:243],a[216:219],v[64:67],0
s_waitcnt lgkmcnt(0)
s_barrier
mma v[240:243],a[220:223],v[68:71],v[240:243]
ldt a[192:193],v5 offset:10240
bld a[84:87],v21,s[20:23],s38 offen offset:1024 sc1
mma v[240:243],a[224:227],v[72:75],v[240:243]
ldt a[194:195],v5 offset:15360
mma v[240:243],a[228:231],v[76:79],v[240:243]
ldt a[196:197],v5 offset:20480
mma v[240:243],a[232:235],v[80:83],v[240:243]
ldt a[198:199],v5 offset:25600
mma v[240:243],a[236:239],v[84:87],v[240:243]
s_add_u32 s38, s58, 18432
bld a[88:91],v21,s[20:23],s38 offen sc1
mma v[244:247],a[236:239],v[108:111],0
ldt a[200:201],v5 offset:30720
mma v[244:247],a[232:235],v[104:107],v[244:247]
ldt a[202:203],v5 offset:35840
mma v[244:247],a[228:231],v[100:103],v[244:247]
bld a[92:95],v21,s[20:23],s38 offen offset:1024 sc1
mma v[244:247],a[224:227],v[96:99],v[244:247]
ldt a[204:205],v5 offset:40960
mma v[244:247],a[220:223],v[92:95],v[244:247]
mma v[244:247],a[216:219],v[88:91],v[244:247]
ldt a[206:207],v5 offset:46080
mma v[248:251],a[216:219],v[112:115],0
ldt a[208:209],v5 offset:51200
mma v[248:251],a[220:223],v[116:119],v[248:251]
mma v[248:251],a[224:227],v[120:123],v[248:251]
ldt a[210:211],v5 offset:56320
mma v[248:251],a[228:231],v[124:127],v[248:251]
ldt a[212:213],v5
mma v[248:251],a[232:235],v[128:131],v[248:251]
mma v[248:251],a[236:239],v[132:135],v[248:251]
ldt a[214:215],v5 offset:5120
mma v[252:255],a[236:239],v[156:159],0
mma v[252:255],a[232:235],v[152:155],v[252:255]
mma v[252:255],a[228:231],v[148:151],v[252:255]
mma v[252:255],a[224:227],v[144:147],v[252:255]
mma v[252:255],a[220:223],v[140:143],v[252:255]
mma v[252:255],a[216:219],v[136:139],v[252:255]
s_waitcnt vmcnt(24) lgkmcnt(10)
mma a[96:99],a[192:195],a[0:3],a[96:99]
s_waitcnt vmcnt(23) lgkmcnt(8)
ldt a[216:217],v6 offset:10240
mma a[96:99],a[196:199],a[4:7],a[96:99]
s_waitcnt vmcnt(22) lgkmcnt(7)
ldt a[218:219],v6 offset:15360
mma a[96:99],a[200:203],a[8:11],a[96:99]
s_waitcnt vmcnt(21) lgkmcnt(6)
mma a[96:99],a[204:207],a[12:15],a[96:99]
s_waitcnt vmcnt(20) lgkmcnt(4)
ldt a[220:221],v6 offset:20480
mma a[96:99],a[208:211],a[16:19],a[96:99]
s_waitcnt vmcnt(19) lgkmcnt(3)
ldt a[222:223],v6 offset:25600
mma a[96:99],a[212:215],a[20:23],a[96:99]
s_buffer_load_dwordx4 s[88:91], s[20:23], s87 offset:128 glc
s_waitcnt vmcnt(13)
mma a[100:103],a[212:215],a[44:47],a[100:103]
ldt a[224:225],v6 offset:30720
mma a[100:103],a[208:211],a[40:43],a[100:103]
ldt a[226:227],v6 offset:35840
mma a[100:103],a[204:207],a[36:39],a[100:103]
mma a[100:103],a[200:203],a[32:35],a[100:103]
ldt a[228:229],v6 offset:40960
mma a[100:103],a[196:199],a[28:31],a[100:103]
mma a[100:103],a[192:195],a[24:27],a[100:103]
s_waitcnt vmcnt(12)
ldt a[230:231],v6 offset:46080
mma a[104:107],a[192:195],a[48:51],a[104:107]
s_waitcnt vmcnt(11)
buffer_store_dword v47, v17, s[20:23], 0 offen offset:256 sc1
mma a[104:107],a[196:199],a[52:55],a[104:107]
s_waitcnt vmcnt(10)
ldt a[232:233],v6 offset:51200
mma a[104:107],a[200:203],a[56:59],a[104:107]
s_waitcnt vmcnt(9)
ldt a[234:235],v6 offset:56320
mma a[104:107],a[204:207],a[60:63],a[104:107]
s_waitcnt vmcnt(8)
ldt a[236:237],v6
mma a[104:107],a[208:211],a[64:67],a[104:107]
s_waitcnt vmcnt(7)
mma a[104:107],a[212:215],a[68:71],a[104:107]
s_waitcnt vmcnt(1)
ldt a[238:239],v6 offset:5120
mma a[108:111],a[212:215],a[92:95],a[108:111]
mma a[108:111],a[208:211],a[88:91],a[108:111]
mma a[108:111],a[204:207],a[84:87],a[108:111]
mma a[108:111],a[200:203],a[80:83],a[108:111]
mma a[108:111],a[196:199],a[76:79],a[108:111]
mma a[108:111],a[192:195],a[72:75],a[108:111]
s_waitcnt lgkmcnt(10)
mma a[112:115],a[216:219],a[0:3],a[112:115]
s_waitcnt lgkmcnt(8)
ldt a[192:193],v5 offset:10304
mma a[112:115],a[220:223],a[4:7],a[112:115]
s_waitcnt lgkmcnt(7)
ldt a[194:195],v5 offset:15424
mma a[112:115],a[224:227],a[8:11],a[112:115]
s_waitcnt lgkmcnt(6)
mma a[112:115],a[228:231],a[12:15],a[112:115]
s_waitcnt lgkmcnt(4)
ldt a[196:197],v5 offset:20544
mma a[112:115],a[232:235],a[16:19],a[112:115]
s_waitcnt lgkmcnt(3)
ldt a[198:199],v5 offset:25664
mma a[112:115],a[236:239],a[20:23],a[112:115]
mma a[116:119],a[236:239],a[44:47],a[116:119]
ldt a[200:201],v5 offset:30784
mma a[116:119],a[232:235],a[40:43],a[116:119]
ldt a[202:203],v5 offset:35904
mma a[116:119],a[228:231],a[36:39],a[116:119]
mma a[116:119],a[224:227],a[32:35],a[116:119]
ldt a[204:205],v5 offset:41024
mma a[116:119],a[220:223],a[28:31],a[116:119]
mma a[116:119],a[216:219],a[24:27],a[116:119]
ldt a[206:207],v5 offset:46144
mma a[120:123],a[216:219],a[48:51],a[120:123]
ldt a[208:209],v5 offset:51264
mma a[120:123],a[220:223],a[52:55],a[120:123]
mma a[120:123],a[224:227],a[56:59],a[120:123]
ldt a[210:211],v5 offset:56384
mma a[120:123],a[228:231],a[60:63],a[120:123]
ldt a[212:213],v5 offset:64
mma a[120:123],a[232:235],a[64:67],a[120:123]
mma a[120:123],a[236:239],a[68:71],a[120:123]
ldt a[214:215],v5 offset:5184
mma a[124:127],a[236:239],a[92:95],a[124:127]
mma a[124:127],a[232:235],a[88:91],a[124:127]
mma a[124:127],a[228:231],a[84:87],a[124:127]
mma a[124:127],a[224:227],a[80:83],a[124:127]
mma a[124:127],a[220:223],a[76:79],a[124:127]
s_waitcnt lgkmcnt(0)
s_add_u32 s88, s88, s89
s_add_u32 s88, s88, s90
s_add_u32 s88, s88, s91
s_cmp_eq_u32 s88, 3
s_cbranch_scc0 L_w0_poll1
L_w0_poll1_ret:
mma a[124:127],a[216:219],a[72:75],a[124:127]
mma a[128:131],a[192:195],a[0:3],a[128:131]
ldt a[216:217],v6 offset:10304
mma a[128:131],a[196:199],a[4:7],a[128:131]
ldt a[218:219],v6 offset:15424
mma a[128:131],a[200:203],a[8:11],a[128:131]
mma a[128:131],a[204:207],a[12:15],a[128:131]
ldt a[220:221],v6 offset:20544
mma a[128:131],a[208:211],a[16:19],a[128:131]
ldt a[222:223],v6 offset:25664
mma a[128:131],a[212:215],a[20:23],a[128:131]
mma a[132:135],a[212:215],a[44:47],a[132:135]
ldt a[224:225],v6 offset:30784
mma a[132:135],a[208:211],a[40:43],a[132:135]
ldt a[226:227],v6 offset:35904
mma a[132:135],a[204:207],a[36:39],a[132:135]
mma a[132:135],a[200:203],a[32:35],a[132:135]
ldt a[228:229],v6 offset:41024
mma a[132:135],a[196:199],a[28:31],a[132:135]
mma a[132:135],a[192:195],a[24:27],a[132:135]
ldt a[230:231],v6 offset:46144
mma a[136:139],a[192:195],a[48:51],a[136:139]
ldt a[232:233],v6 offset:51264
mma a[136:139],a[196:199],a[52:55],a[136:139]
mma a[136:139],a[200:203],a[56:59],a[136:139]
ldt a[234:235],v6 offset:56384
mma a[136:139],a[204:207],a[60:63],a[136:139]
ldt a[236:237],v6 offset:64
mma a[136:139],a[208:211],a[64:67],a[136:139]
mma a[136:139],a[212:215],a[68:71],a[136:139]
ldt a[238:239],v6 offset:5184
mma a[140:143],a[212:215],a[92:95],a[140:143]
mma a[140:143],a[208:211],a[88:91],a[140:143]
mma a[140:143],a[204:207],a[84:87],a[140:143]
mma a[140:143],a[200:203],a[80:83],a[140:143]
mma a[140:143],a[196:199],a[76:79],a[140:143]
mma a[140:143],a[192:195],a[72:75],a[140:143]
s_waitcnt lgkmcnt(10)
mma a[144:147],a[216:219],a[0:3],a[144:147]
s_waitcnt lgkmcnt(8)
ldt a[192:193],v5 offset:10368
mma a[144:147],a[220:223],a[4:7],a[144:147]
s_waitcnt lgkmcnt(7)
ldt a[194:195],v5 offset:15488
mma a[144:147],a[224:227],a[8:11],a[144:147]
s_add_u32 s38, s56, 2048
s_waitcnt lgkmcnt(6)
bld v[64:67],v21,s[20:23],s38 offen sc1
mma a[144:147],a[228:231],a[12:15],a[144:147]
s_waitcnt lgkmcnt(4)
ldt a[196:197],v5 offset:20608
mma a[144:147],a[232:235],a[16:19],a[144:147]
s_waitcnt lgkmcnt(3)
ldt a[198:199],v5 offset:25728
mma a[144:147],a[236:239],a[20:23],a[144:147]
bld v[68:71],v21,s[20:23],s38 offen offset:1024 sc1
mma a[148:151],a[236:239],a[44:47],a[148:151]
ldt a[200:201],v5 offset:30848
mma a[148:151],a[232:235],a[40:43],a[148:151]
ldt a[202:203],v5 offset:35968
mma a[148:151],a[228:231],a[36:39],a[148:151]
mma a[148:151],a[224:227],a[32:35],a[148:151]
ldt a[204:205],v5 offset:41088
mma a[148:151],a[220:223],a[28:31],a[148:151]
s_add_u32 s38, s57, 2048
bld v[72:75],v21,s[20:23],s38 offen sc1
mma a[148:151],a[216:219],a[24:27],a[148:151]
ldt a[206:207],v5 offset:46208
mma a[152:155],a[216:219],a[48:51],a[152:155]
ldt a[208:209],v5 offset:51328
mma a[152:155],a[220:223],a[52:55],a[152:155]
mma a[152:155],a[224:227],a[56:59],a[152:155]
ldt a[210:211],v5 offset:56448
mma a[152:155],a[228:231],a[60:63],a[152:155]
ldt a[212:213],v5 offset:128
mma a[152:155],a[232:235],a[64:67],a[152:155]
bld v[76:79],v21,s[20:23],s38 offen offset:1024 sc1
mma a[152:155],a[236:239],a[68:71],a[152:155]
ldt a[214:215],v5 offset:5248
mma a[156:159],a[236:239],a[92:95],a[156:159]
mma a[156:159],a[232:235],a[88:91],a[156:159]
mma a[156:159],a[228:231],a[84:87],a[156:159]
s_add_u32 s38, s56, 8192
bld v[88:91],v21,s[20:23],s38 offen sc1
mma a[156:159],a[224:227],a[80:83],a[156:159]
mma a[156:159],a[220:223],a[76:79],a[156:159]
mma a[156:159],a[216:219],a[72:75],a[156:159]
s_waitcnt lgkmcnt(10)
mma v[160:163],a[192:195],a[0:3],v[160:163]
s_waitcnt lgkmcnt(8)
ldt a[216:217],v6 offset:10368
mma v[160:163],a[196:199],a[4:7],v[160:163]
s_waitcnt lgkmcnt(7)
ldt a[218:219],v6 offset:15488
mma v[160:163],a[200:203],a[8:11],v[160:163]
s_waitcnt lgkmcnt(6)
bld v[92:95],v21,s[20:23],s38 offen offset:1024 sc1
mma v[160:163],a[204:207],a[12:15],v[160:163]
s_waitcnt lgkmcnt(4)
ldt a[220:221],v6 offset:20608
mma v[160:163],a[208:211],a[16:19],v[160:163]
s_waitcnt lgkmcnt(3)
ldt a[222:223],v6 offset:25728
mma v[160:163],a[212:215],a[20:23],v[160:163]
mma v[164:167],a[212:215],a[44:47],v[164:167]
ldt a[224:225],v6 offset:30848
mma v[164:167],a[208:211],a[40:43],v[164:167]
ldt a[226:227],v6 offset:35968
mma v[164:167],a[204:207],a[36:39],v[164:167]
s_add_u32 s38, s57, 8192
bld v[96:99],v21,s[20:23],s38 offen sc1
mma v[164:167],a[200:203],a[32:35],v[164:167]
ldt a[228:229],v6 offset:41088
mma v[164:167],a[196:199],a[28:31],v[164:167]
mma v[164:167],a[192:195],a[24:27],v[164:167]
ldt a[230:231],v6 offset:46208
mma v[168:171],a[192:195],a[48:51],v[168:171]
ldt a[232:233],v6 offset:51328
mma v[168:171],a[196:199],a[52:55],v[168:171]
bld v[100:103],v21,s[20:23],s38 offen offset:1024 sc1
mma v[168:171],a[200:203],a[56:59],v[168:171]
ldt a[234:235],v6 offset:56448
mma v[168:171],a[204:207],a[60:63],v[168:171]
ldt a[236:237],v6 offset:128
mma v[168:171],a[208:211],a[64:67],v[168:171]
s_add_u32 s38, s56, 14336
bld v[112:115],v21,s[20:23],s38 offen sc1
mma v[168:171],a[212:215],a[68:71],v[168:171]
ldt a[238:239],v6 offset:5248
mma v[172:175],a[212:215],a[92:95],v[172:175]
mma v[172:175],a[208:211],a[88:91],v[172:175]
mma v[172:175],a[204:207],a[84:87],v[172:175]
mma v[172:175],a[200:203],a[80:83],v[172:175]
bld v[116:119],v21,s[20:23],s38 offen offset:1024 sc1
mma v[172:175],a[196:199],a[76:79],v[172:175]
mma v[172:175],a[192:195],a[72:75],v[172:175]
s_waitcnt lgkmcnt(10)
mma v[176:179],a[216:219],a[0:3],v[176:179]
s_waitcnt lgkmcnt(8)
ldt a[192:193],v5 offset:10432
mma v[176:179],a[220:223],a[4:7],v[176:179]
s_waitcnt lgkmcnt(7)
ldt a[194:195],v5 offset:15552
mma v[176:179],a[224:227],a[8:11],v[176:179]
s_add_u32 s38, s57, 14336
s_waitcnt lgkmcnt(6)
bld v[120:123],v21,s[20:23],s38 offen sc1
mma v[176:179],a[228:231],a[12:15],v[176:179]
s_waitcnt lgkmcnt(4)
ldt a[196:197],v5 offset:20672
mma v[176:179],a[232:235],a[16:19],v[176:179]
s_waitcnt lgkmcnt(3)
ldt a[198:199],v5 offset:25792
mma v[176:179],a[236:239],a[20:23],v[176:179]
mma v[180:183],a[236:239],a[44:47],v[180:183]
ldt a[200:201],v5 offset:30912
mma v[180:183],a[232:235],a[40:43],v[180:183]
ldt a[202:203],v5 offset:36032
mma v[180:183],a[228:231],a[36:39],v[180:183]
bld v[124:127],v21,s[20:23],s38 offen offset:1024 sc1
mma v[180:183],a[224:227],a[32:35],v[180:183]
ldt a[204:205],v5 offset:41152
mma v[180:183],a[220:223],a[28:31],v[180:183]
mma v[180:183],a[216:219],a[24:27],v[180:183]
ldt a[206:207],v5 offset:46272
mma v[184:187],a[216:219],a[48:51],v[184:187]
ldt a[208:209],v5 offset:51392
mma v[184:187],a[220:223],a[52:55],v[184:187]
s_add_u32 s38, s56, 20480
bld v[136:139],v21,s[20:23],s38 offen sc1
mma v[184:187],a[224:227],a[56:59],v[184:187]
ldt a[210:211],v5 offset:56512
mma v[184:187],a[228:231],a[60:63],v[184:187]
ldt a[212:213],v5 offset:192
mma v[184:187],a[232:235],a[64:67],v[184:187]
mma v[184:187],a[236:239],a[68:71],v[184:187]
ldt a[214:215],v5 offset:5312
mma v[188:191],a[236:239],a[92:95],v[188:191]
bld v[140:143],v21,s[20:23],s38 offen offset:1024 sc1
mma v[188:191],a[232:235],a[88:91],v[188:191]
mma v[188:191],a[228:231],a[84:87],v[188:191]
mma v[188:191],a[224:227],a[80:83],v[188:191]
mma v[188:191],a[220:223],a[76:79],v[188:191]
s_add_u32 s38, s57, 20480
bld v[144:147],v21,s[20:23],s38 offen sc1
mma v[188:191],a[216:219],a[72:75],v[188:191]
s_waitcnt lgkmcnt(10)
mma v[192:195],a[192:195],a[0:3],v[192:195]
s_waitcnt lgkmcnt(8)
ldt a[216:217],v6 offset:10432
mma v[192:195],a[196:199],a[4:7],v[192:195]
s_waitcnt lgkmcnt(7)
ldt a[218:219],v6 offset:15552
mma v[192:195],a[200:203],a[8:11],v[192:195]
s_waitcnt lgkmcnt(6)
mma v[192:195],a[204:207],a[12:15],v[192:195]
s_waitcnt lgkmcnt(4)
ldt a[220:221],v6 offset:20672
mma v[192:195],a[208:211],a[16:19],v[192:195]
s_waitcnt lgkmcnt(3)
ldt a[222:223],v6 offset:25792
mma v[192:195],a[212:215],a[20:23],v[192:195]
bld v[148:151],v21,s[20:23],s38 offen offset:1024 sc1
mma v[196:199],a[212:215],a[44:47],v[196:199]
ldt a[224:225],v6 offset:30912
mma v[196:199],a[208:211],a[40:43],v[196:199]
ldt a[226:227],v6 offset:36032
mma v[196:199],a[204:207],a[36:39],v[196:199]
s_add_u32 s38, s58, 2048
bld v[80:83],v21,s[20:23],s38 offen sc1
mma v[196:199],a[200:203],a[32:35],v[196:199]
ldt a[228:229],v6 offset:41152
mma v[196:199],a[196:199],a[28:31],v[196:199]
mma v[196:199],a[192:195],a[24:27],v[196:199]
ldt a[230:231],v6 offset:46272
mma v[200:203],a[192:195],a[48:51],v[200:203]
ldt a[232:233],v6 offset:51392
mma v[200:203],a[196:199],a[52:55],v[200:203]
bld v[84:87],v21,s[20:23],s38 offen offset:1024 sc1
mma v[200:203],a[200:203],a[56:59],v[200:203]
ldt a[234:235],v6 offset:56512
mma v[200:203],a[204:207],a[60:63],v[200:203]
ldt a[236:237],v6 offset:192
mma v[200:203],a[208:211],a[64:67],v[200:203]
mma v[200:203],a[212:215],a[68:71],v[200:203]
ldt a[238:239],v6 offset:5312
mma v[204:207],a[212:215],a[92:95],v[204:207]
s_add_u32 s38, s58, 8192
bld v[104:107],v21,s[20:23],s38 offen sc1
mma v[204:207],a[208:211],a[88:91],v[204:207]
mma v[204:207],a[204:207],a[84:87],v[204:207]
mma v[204:207],a[200:203],a[80:83],v[204:207]
mma v[204:207],a[196:199],a[76:79],v[204:207]
mma v[204:207],a[192:195],a[72:75],v[204:207]
s_waitcnt lgkmcnt(10)
bld v[108:111],v21,s[20:23],s38 offen offset:1024 sc1
mma v[208:211],a[216:219],a[0:3],v[208:211]
s_buffer_load_dwordx4 s[88:91], s[20:23], s87 offset:256 glc
ldt a[192:193],v5 offset:10496
s_waitcnt lgkmcnt(9)
mma v[208:211],a[220:223],a[4:7],v[208:211]
s_waitcnt lgkmcnt(7)
ldt a[194:195],v5 offset:15616
mma v[208:211],a[224:227],a[8:11],v[208:211]
s_waitcnt lgkmcnt(6)
mma v[208:211],a[228:231],a[12:15],v[208:211]
s_waitcnt lgkmcnt(4)
ldt a[196:197],v5 offset:20736
mma v[208:211],a[232:235],a[16:19],v[208:211]
s_waitcnt lgkmcnt(3)
ldt a[198:199],v5 offset:25856
mma v[208:211],a[236:239],a[20:23],v[208:211]
s_add_u32 s38, s58, 14336
bld v[128:131],v21,s[20:23],s38 offen sc1
mma v[212:215],a[236:239],a[44:47],v[212:215]
ldt a[200:201],v5 offset:30976
mma v[212:215],a[232:235],a[40:43],v[212:215]
ldt a[202:203],v5 offset:36096
mma v[212:215],a[228:231],a[36:39],v[212:215]
mma v[212:215],a[224:227],a[32:35],v[212:215]
ldt a[204:205],v5 offset:41216
mma v[212:215],a[220:223],a[28:31],v[212:215]
bld v[132:135],v21,s[20:23],s38 offen offset:1024 sc1
mma v[212:215],a[216:219],a[24:27],v[212:215]
ldt a[206:207],v5 offset:46336
mma v[216:219],a[216:219],a[48:51],v[216:219]
ldt a[208:209],v5 offset:51456
mma v[216:219],a[220:223],a[52:55],v[216:219]
mma v[216:219],a[224:227],a[56:59],v[216:219]
ldt a[210:211],v5 offset:56576
mma v[216:219],a[228:231],a[60:63],v[216:219]
ldt a[212:213],v5 offset:256
mma v[216:219],a[232:235],a[64:67],v[216:219]
s_add_u32 s38, s58, 20480
bld v[152:155],v21,s[20:23],s38 offen sc1
mma v[216:219],a[236:239],a[68:71],v[216:219]
ldt a[214:215],v5 offset:5376
mma v[220:223],a[236:239],a[92:95],v[220:223]
mma v[220:223],a[232:235],a[88:91],v[220:223]
bld v[156:159],v21,s[20:23],s38 offen offset:1024 sc1
mma v[220:223],a[228:231],a[84:87],v[220:223]
mma v[220:223],a[224:227],a[80:83],v[220:223]
mma v[220:223],a[220:223],a[76:79],v[220:223]
mma v[220:223],a[216:219],a[72:75],v[220:223]
s_waitcnt lgkmcnt(10)
mma v[224:227],a[192:195],a[0:3],v[224:227]
s_waitcnt lgkmcnt(8)
ldt a[216:217],v6 offset:10496
mma v[224:227],a[196:199],a[4:7],v[224:227]
s_waitcnt lgkmcnt(7)
ldt a[218:219],v6 offset:15616
mma v[224:227],a[200:203],a[8:11],v[224:227]
s_add_u32 s42, s41, 5120
s_waitcnt lgkmcnt(6)
buffer_store_dwordx4 a[160:163], v21, s[20:23], s42 offen sc1
mma v[224:227],a[204:207],a[12:15],v[224:227]
s_waitcnt lgkmcnt(4)
ldt a[220:221],v6 offset:20736
mma v[224:227],a[208:211],a[16:19],v[224:227]
s_waitcnt lgkmcnt(3)
ldt a[222:223],v6 offset:25856
mma v[224:227],a[212:215],a[20:23],v[224:227]
mma v[228:231],a[212:215],a[44:47],v[228:231]
ldt a[224:225],v6 offset:30976
mma v[228:231],a[208:211],a[40:43],v[228:231]
ldt a[226:227],v6 offset:36096
mma v[228:231],a[204:207],a[36:39],v[228:231]
mma v[228:231],a[200:203],a[32:35],v[228:231]
ldt a[228:229],v6 offset:41216
mma v[228:231],a[196:199],a[28:31],v[228:231]
mma v[228:231],a[192:195],a[24:27],v[228:231]
ldt a[230:231],v6 offset:46336
mma v[232:235],a[192:195],a[48:51],v[232:235]
ldt a[232:233],v6 offset:51456
mma v[232:235],a[196:199],a[52:55],v[232:235]
s_add_u32 s42, s41, 11264
buffer_store_dwordx4 a[164:167], v21, s[20:23], s42 offen sc1
mma v[232:235],a[200:203],a[56:59],v[232:235]
ldt a[234:235],v6 offset:56576
mma v[232:235],a[204:207],a[60:63],v[232:235]
ldt a[236:237],v6 offset:256
mma v[232:235],a[208:211],a[64:67],v[232:235]
mma v[232:235],a[212:215],a[68:71],v[232:235]
ldt a[238:239],v6 offset:5376
mma v[236:239],a[212:215],a[92:95],v[236:239]
mma v[236:239],a[208:211],a[88:91],v[236:239]
mma v[236:239],a[204:207],a[84:87],v[236:239]
mma v[236:239],a[200:203],a[80:83],v[236:239]
mma v[236:239],a[196:199],a[76:79],v[236:239]
mma v[236:239],a[192:195],a[72:75],v[236:239]
s_waitcnt lgkmcnt(10)
mma v[240:243],a[216:219],a[0:3],v[240:243]
s_waitcnt lgkmcnt(0)
s_barrier
s_add_u32 s42, s41, 17408
buffer_store_dwordx4 a[168:171], v21, s[20:23], s42 offen sc1
mma v[240:243],a[220:223],a[4:7],v[240:243]
ldt a[192:193],v15
mma v[240:243],a[224:227],a[8:11],v[240:243]
ldt a[194:195],v15 offset:5120
mma v[240:243],a[228:231],a[12:15],v[240:243]
ldt a[196:197],v15 offset:10240
mma v[240:243],a[232:235],a[16:19],v[240:243]
ldt a[198:199],v15 offset:15360
mma v[240:243],a[236:239],a[20:23],v[240:243]
mma v[244:247],a[236:239],a[44:47],v[244:247]
ldt a[200:201],v15 offset:49152
mma v[244:247],a[232:235],a[40:43],v[244:247]
ldt a[202:203],v15 offset:54272
mma v[244:247],a[228:231],a[36:39],v[244:247]
mma v[244:247],a[224:227],a[32:35],v[244:247]
ldt a[204:205],v15 offset:59392
mma v[244:247],a[220:223],a[28:31],v[244:247]
mma v[244:247],a[216:219],a[24:27],v[244:247]
ldt a[206:207],v15 offset:64512
mma v[248:251],a[216:219],a[48:51],v[248:251]
ldt a[208:209],v15 offset:24576
mma v[248:251],a[220:223],a[52:55],v[248:251]
s_add_u32 s42, s41, 23552
buffer_store_dwordx4 a[172:175], v21, s[20:23], s42 offen sc1
mma v[248:251],a[224:227],a[56:59],v[248:251]
ldt a[210:211],v15 offset:29696
mma v[248:251],a[228:231],a[60:63],v[248:251]
ldt a[212:213],v15 offset:34816
mma v[248:251],a[232:235],a[64:67],v[248:251]
mma v[248:251],a[236:239],a[68:71],v[248:251]
ldt a[214:215],v15 offset:39936
mma v[252:255],a[236:239],a[92:95],v[252:255]
mma v[252:255],a[232:235],a[88:91],v[252:255]
mma v[252:255],a[228:231],a[84:87],v[252:255]
mma v[252:255],a[224:227],a[80:83],v[252:255]
mma v[252:255],a[220:223],a[76:79],v[252:255]
s_waitcnt lgkmcnt(0)
s_add_u32 s88, s88, s89
s_add_u32 s88, s88, s90
s_add_u32 s88, s88, s91
s_cmp_eq_u32 s88, 3
s_cbranch_scc0 L_w0_poll2
L_w0_poll2_ret:
mma v[252:255],a[216:219],a[72:75],v[252:255]
s_waitcnt vmcnt(27)
mma a[96:99],a[192:195],v[64:67],a[96:99]
s_waitcnt vmcnt(26)
ldt a[216:217],v16
mma a[96:99],a[196:199],v[68:71],a[96:99]
s_waitcnt vmcnt(25)
ldt a[218:219],v16 offset:5120
mma a[96:99],a[200:203],v[72:75],a[96:99]
s_waitcnt vmcnt(24)
mma a[96:99],a[204:207],v[76:79],a[96:99]
s_waitcnt vmcnt(11)
ldt a[220:221],v16 offset:10240
mma a[96:99],a[208:211],v[80:83],a[96:99]
s_waitcnt vmcnt(10)
ldt a[222:223],v16 offset:15360
mma a[96:99],a[212:215],v[84:87],a[96:99]
s_waitcnt vmcnt(8)
mma a[100:103],a[212:215],v[108:111],a[100:103]
ldt a[224:225],v16 offset:49152
mma a[100:103],a[208:211],v[104:107],a[100:103]
ldt a[226:227],v16 offset:54272
mma a[100:103],a[204:207],v[100:103],a[100:103]
mma a[100:103],a[200:203],v[96:99],a[100:103]
ldt a[228:229],v16 offset:59392
mma a[100:103],a[196:199],v[92:95],a[100:103]
mma a[100:103],a[192:195],v[88:91],a[100:103]
ldt a[230:231],v16 offset:64512
mma a[104:107],a[192:195],v[112:115],a[104:107]
ldt a[232:233],v16 offset:24576
mma a[104:107],a[196:199],v[116:119],a[104:107]
mma a[104:107],a[200:203],v[120:123],a[104:107]
ldt a[234:235],v16 offset:29696
mma a[104:107],a[204:207],v[124:127],a[104:107]
s_waitcnt vmcnt(7)
ldt a[236:237],v16 offset:34816
mma a[104:107],a[208:211],v[128:131],a[104:107]
s_waitcnt vmcnt(6)
mma a[104:107],a[212:215],v[132:135],a[104:107]
s_waitcnt vmcnt(4)
ldt a[238:239],v16 offset:39936
mma a[108:111],a[212:215],v[156:159],a[108:111]
mma a[108:111],a[208:211],v[152:155],a[108:111]
mma a[108:111],a[204:207],v[148:151],a[108:111]
mma a[108:111],a[200:203],v[144:147],a[108:111]
mma a[108:111],a[196:199],v[140:143],a[108:111]
s_lshr_b32 s3, s26, 2
mma a[108:111],a[192:195],v[136:139],a[108:111]
s_lshl_b32 s35, s24, 1
s_waitcnt lgkmcnt(10)
mma a[112:115],a[216:219],v[64:67],a[112:115]
s_cmp_eq_u32 s35, s3
s_cselect_b32 s27, 2146435072, s46
s_cselect_b32 s37, 0, 12288
s_waitcnt lgkmcnt(8)
ldt a[192:193],v15 offset:64
mma a[112:115],a[220:223],v[68:71],a[112:115]
s_add_u32 s37, s37, 73728
s_waitcnt lgkmcnt(7)
ldt a[194:195],v15 offset:5184
v_add_u32 v2, s37, v12
mma a[112:115],a[224:227],v[72:75],a[112:115]
s_add_u32 s35, s35, 1
s_waitcnt lgkmcnt(6)
mma a[112:115],a[228:231],v[76:79],a[112:115]
s_cmp_eq_u32 s35, s3
s_cselect_b32 s28, 2146435072, s46
s_cselect_b32 s37, 0, 12288
s_waitcnt lgkmcnt(4)
ldt a[196:197],v15 offset:10304
mma a[112:115],a[232:235],v[80:83],a[112:115]
s_add_u32 s37, s37, 73728
s_waitcnt lgkmcnt(3)
ldt a[198:199],v15 offset:15424
v_add_u32 v3, s37, v12
mma a[112:115],a[236:239],v[84:87],a[112:115]
s_add_u32 s35, s35, 1
mma a[116:119],a[236:239],v[108:111],a[116:119]
s_mov_b32 s37, 16711935
ldt a[200:201],v15 offset:49216
mma a[116:119],a[232:235],v[104:107],a[116:119]
s_and_b32 s35, s3, 1
s_cselect_b32 s32, 4278255360, s37
ldt a[202:203],v15 offset:54336
mma a[116:119],a[228:231],v[100:103],a[116:119]
s_mov_b32 s33, s32
mma a[116:119],a[224:227],v[96:99],a[116:119]
s_lshr_b32 s3, s3, 1
ldt a[204:205],v15 offset:59456
mma a[116:119],a[220:223],v[92:95],a[116:119]
s_mul_i32 s16, s3, 153600
mma a[116:119],a[216:219],v[88:91],a[116:119]
s_add_u32 s16, s16, s96
ldt a[206:207],v15 offset:64576
mma a[120:123],a[216:219],v[112:115],a[120:123]
s_add_u32 s3, s3, 1
ldt a[208:209],v15 offset:24640
mma a[120:123],a[220:223],v[116:119],a[120:123]
s_and_b32 s3, s3, 3
mma a[120:123],a[224:227],v[120:123],a[120:123]
s_mul_i32 s17, s3, 153600
ldt a[210:211],v15 offset:29760
mma a[120:123],a[228:231],v[124:127],a[120:123]
s_add_u32 s17, s17, s96
ldt a[212:213],v15 offset:34880
mma a[120:123],a[232:235],v[128:131],a[120:123]
s_add_u32 s3, s3, 1
mma a[120:123],a[236:239],v[132:135],a[120:123]
s_and_b32 s3, s3, 3
ldt a[214:215],v15 offset:40000
mma a[124:127],a[236:239],v[156:159],a[124:127]
s_mul_i32 s18, s3, 153600
mma a[124:127],a[232:235],v[152:155],a[124:127]
s_add_u32 s18, s18, s96
mma a[124:127],a[228:231],v[148:151],a[124:127]
s_add_u32 s3, s3, 1
mma a[124:127],a[224:227],v[144:147],a[124:127]
s_and_b32 s3, s3, 3
mma a[124:127],a[220:223],v[140:143],a[124:127]
s_mul_i32 s19, s3, 153600
mma a[124:127],a[216:219],v[136:139],a[124:127]
s_add_u32 s19, s19, s96
s_waitcnt lgkmcnt(10)
mma a[128:131],a[192:195],v[64:67],a[128:131]
s_add_u32 s3, s3, 1
s_waitcnt lgkmcnt(8)
ldt a[216:217],v16 offset:64
mma a[128:131],a[196:199],v[68:71],a[128:131]
s_and_b32 s3, s3, 3
s_waitcnt lgkmcnt(7)
ldt a[218:219],v16 offset:5184
mma a[128:131],a[200:203],v[72:75],a[128:131]
s_lshr_b32 s3, s24, 1
s_waitcnt lgkmcnt(6)
mma a[128:131],a[204:207],v[76:79],a[128:131]
s_mul_i32 s3, s3, 5120
s_waitcnt lgkmcnt(4)
ldt a[220:221],v16 offset:10304
mma a[128:131],a[208:211],v[80:83],a[128:131]
s_and_b32 s35, s24, 1
s_waitcnt lgkmcnt(3)
ldt a[222:223],v16 offset:15424
mma a[128:131],a[212:215],v[84:87],a[128:131]
s_lshl_b32 s35, s35, 9
mma a[132:135],a[212:215],v[108:111],a[132:135]
s_add_u32 s3, s3, s35
ldt a[224:225],v16 offset:49216
mma a[132:135],a[208:211],v[104:107],a[132:135]
s_add_u32 s3, s3, 73728
ldt a[226:227],v16 offset:54336
v_and_b32 v4, 511, v12
mma a[132:135],a[204:207],v[100:103],a[132:135]
s_mov_b32 s4, s74
v_add_u32 v4, s3, v4
mma a[132:135],a[200:203],v[96:99],a[132:135]
s_mov_b32 s5, s75
ldt a[228:229],v16 offset:59456
mma a[132:135],a[196:199],v[92:95],a[132:135]
s_mov_b32 s6, 2457600
mma a[132:135],a[192:195],v[88:91],a[132:135]
s_mov_b32 s7, 131072
ldt a[230:231],v16 offset:64576
mma a[136:139],a[192:195],v[112:115],a[136:139]
s_mov_b32 s43, 4294901760
ldt a[232:233],v16 offset:24640
mma a[136:139],a[196:199],v[116:119],a[136:139]
mma a[136:139],a[200:203],v[120:123],a[136:139]
ldt a[234:235],v16 offset:29760
mma a[136:139],a[204:207],v[124:127],a[136:139]
ldt a[236:237],v16 offset:34880
mma a[136:139],a[208:211],v[128:131],a[136:139]
mma a[136:139],a[212:215],v[132:135],a[136:139]
ldt a[238:239],v16 offset:40000
mma a[140:143],a[212:215],v[156:159],a[140:143]
mma a[140:143],a[208:211],v[152:155],a[140:143]
mma a[140:143],a[204:207],v[148:151],a[140:143]
mma a[140:143],a[200:203],v[144:147],a[140:143]
mma a[140:143],a[196:199],v[140:143],a[140:143]
mma a[140:143],a[192:195],v[136:139],a[140:143]
s_waitcnt lgkmcnt(10)
mma a[144:147],a[216:219],v[64:67],a[144:147]
s_waitcnt vmcnt(0)
s_waitcnt lgkmcnt(8)
buffer_store_dword v47, v17, s[20:23], 0 offen offset:768 sc1
mma a[144:147],a[220:223],v[68:71],a[144:147]
s_waitcnt lgkmcnt(6)
ldt a[192:193],v15 offset:128
mma a[144:147],a[224:227],v[72:75],a[144:147]
s_waitcnt lgkmcnt(5)
ldt a[194:195],v15 offset:5248
mma a[144:147],a[228:231],v[76:79],a[144:147]
s_waitcnt lgkmcnt(4)
ldt a[196:197],v15 offset:10368
mma a[144:147],a[232:235],v[80:83],a[144:147]
s_waitcnt lgkmcnt(3)
ldt a[198:199],v15 offset:15488
mma a[144:147],a[236:239],v[84:87],a[144:147]
mma a[148:151],a[236:239],v[108:111],a[148:151]
ldt a[200:201],v15 offset:49280
mma a[148:151],a[232:235],v[104:107],a[148:151]
ldt a[202:203],v15 offset:54400
mma a[148:151],a[228:231],v[100:103],a[148:151]
mma a[148:151],a[224:227],v[96:99],a[148:151]
ldt a[204:205],v15 offset:59520
mma a[148:151],a[220:223],v[92:95],a[148:151]
mma a[148:151],a[216:219],v[88:91],a[148:151]
ldt a[206:207],v15 offset:64640
mma a[152:155],a[216:219],v[112:115],a[152:155]
ldt a[208:209],v15 offset:24704
mma a[152:155],a[220:223],v[116:119],a[152:155]
mma a[152:155],a[224:227],v[120:123],a[152:155]
ldt a[210:211],v15 offset:29824
mma a[152:155],a[228:231],v[124:127],a[152:155]
ldt a[212:213],v15 offset:34944
mma a[152:155],a[232:235],v[128:131],a[152:155]
mma a[152:155],a[236:239],v[132:135],a[152:155]
ldt a[214:215],v15 offset:40064
mma a[156:159],a[236:239],v[156:159],a[156:159]
mma a[156:159],a[232:235],v[152:155],a[156:159]
mma a[156:159],a[228:231],v[148:151],a[156:159]
mma a[156:159],a[224:227],v[144:147],a[156:159]
mma a[156:159],a[220:223],v[140:143],a[156:159]
mma a[156:159],a[216:219],v[136:139],a[156:159]
s_waitcnt lgkmcnt(10)
mma v[160:163],a[192:195],v[64:67],v[160:163]
s_waitcnt lgkmcnt(8)
ldt a[216:217],v16 offset:128
mma v[160:163],a[196:199],v[68:71],v[160:163]
s_waitcnt lgkmcnt(7)
ldt a[218:219],v16 offset:5248
mma v[160:163],a[200:203],v[72:75],v[160:163]
s_add_u32 s38, s56, 4096
s_waitcnt lgkmcnt(6)
bld a[0:3],v21,s[20:23],s38 offen sc1
mma v[160:163],a[204:207],v[76:79],v[160:163]
s_waitcnt lgkmcnt(4)
ldt a[220:221],v16 offset:10368
mma v[160:163],a[208:211],v[80:83],v[160:163]
s_waitcnt lgkmcnt(3)
ldt a[222:223],v16 offset:15488
mma v[160:163],a[212:215],v[84:87],v[160:163]
s_add_u32 s38, s57, 4096
bld a[8:11],v21,s[20:23],s38 offen sc1
mma v[164:167],a[212:215],v[108:111],v[164:167]
ldt a[224:225],v16 offset:49280
mma v[164:167],a[208:211],v[104:107],v[164:167]
ldt a[226:227],v16 offset:54400
mma v[164:167],a[204:207],v[100:103],v[164:167]
mma v[164:167],a[200:203],v[96:99],v[164:167]
ldt a[228:229],v16 offset:59520
mma v[164:167],a[196:199],v[92:95],v[164:167]
s_add_u32 s38, s58, 4096
bld a[16:19],v21,s[20:23],s38 offen sc1
mma v[164:167],a[192:195],v[88:91],v[164:167]
ldt a[230:231],v16 offset:64640
mma v[168:171],a[192:195],v[112:115],v[168:171]
s_buffer_load_dwordx4 s[88:91], s[20:23], s87 offset:768 glc
ldt a[232:233],v16 offset:24704
mma v[168:171],a[196:199],v[116:119],v[168:171]
mma v[168:171],a[200:203],v[120:123],v[168:171]
ldt a[234:235],v16 offset:29824
mma v[168:171],a[204:207],v[124:127],v[168:171]
ldt a[236:237],v16 offset:34944
mma v[168:171],a[208:211],v[128:131],v[168:171]
s_add_u32 s38, s56, 10240
bld a[24:27],v21,s[20:23],s38 offen sc1
mma v[168:171],a[212:215],v[132:135],v[168:171]
ldt a[238:239],v16 offset:40064
mma v[172:175],a[212:215],v[156:159],v[172:175]
mma v[172:175],a[208:211],v[152:155],v[172:175]
mma v[172:175],a[204:207],v[148:151],v[172:175]
s_add_u32 s38, s57, 10240
bld a[32:35],v21,s[20:23],s38 offen sc1
mma v[172:175],a[200:203],v[144:147],v[172:175]
mma v[172:175],a[196:199],v[140:143],v[172:175]
mma v[172:175],a[192:195],v[136:139],v[172:175]
s_waitcnt lgkmcnt(10)
mma v[176:179],a[216:219],v[64:67],v[176:179]
s_waitcnt lgkmcnt(8)
ldt a[192:193],v15 offset:192
mma v[176:179],a[220:223],v[68:71],v[176:179]
s_waitcnt lgkmcnt(7)
ldt a[194:195],v15 offset:5312
mma v[176:179],a[224:227],v[72:75],v[176:179]
s_add_u32 s38, s58, 10240
s_waitcnt lgkmcnt(6)
bld a[40:43],v21,s[20:23],s38 offen sc1
mma v[176:179],a[228:231],v[76:79],v[176:179]
s_waitcnt lgkmcnt(4)
ldt a[196:197],v15 offset:10432
mma v[176:179],a[232:235],v[80:83],v[176:179]
s_waitcnt lgkmcnt(3)
ldt a[198:199],v15 offset:15552
mma v[176:179],a[236:239],v[84:87],v[176:179]
mma v[180:183],a[236:239],v[108:111],v[180:183]
ldt a[200:201],v15 offset:49344
mma v[180:183],a[232:235],v[104:107],v[180:183]
ldt a[202:203],v15 offset:54464
mma v[180:183],a[228:231],v[100:103],v[180:183]
s_add_u32 s38, s56, 16384
bld a[48:51],v21,s[20:23],s38 offen sc1
mma v[180:183],a[224:227],v[96:99],v[180:183]
ldt a[204:205],v15 offset:59584
mma v[180:183],a[220:223],v[92:95],v[180:183]
mma v[180:183],a[216:219],v[88:91],v[180:183]
ldt a[206:207],v15 offset:64704
mma v[184:187],a[216:219],v[112:115],v[184:187]
ldt a[208:209],v15 offset:24768
mma v[184:187],a[220:223],v[116:119],v[184:187]
s_add_u32 s38, s57, 16384
bld a[56:59],v21,s[20:23],s38 offen sc1
mma v[184:187],a[224:227],v[120:123],v[184:187]
ldt a[210:211],v15 offset:29888
mma v[184:187],a[228:231],v[124:127],v[184:187]
ldt a[212:213],v15 offset:35008
mma v[184:187],a[232:235],v[128:131],v[184:187]
s_add_u32 s38, s58, 16384
bld a[64:67],v21,s[20:23],s38 offen sc1
mma v[184:187],a[236:239],v[132:135],v[184:187]
ldt a[214:215],v15 offset:40128
mma v[188:191],a[236:239],v[156:159],v[188:191]
mma v[188:191],a[232:235],v[152:155],v[188:191]
mma v[188:191],a[228:231],v[148:151],v[188:191]
mma v[188:191],a[224:227],v[144:147],v[188:191]
s_add_u32 s38, s56, 22528
bld a[72:75],v21,s[20:23],s38 offen sc1
mma v[188:191],a[220:223],v[140:143],v[188:191]
mma v[188:191],a[216:219],v[136:139],v[188:191]
s_waitcnt lgkmcnt(10)
mma v[192:195],a[192:195],v[64:67],v[192:195]
s_waitcnt lgkmcnt(8)
ldt a[216:217],v16 offset:192
mma v[192:195],a[196:199],v[68:71],v[192:195]
s_waitcnt lgkmcnt(7)
ldt a[218:219],v16 offset:5312
mma v[192:195],a[200:203],v[72:75],v[192:195]
s_add_u32 s38, s57, 22528
s_waitcnt lgkmcnt(6)
bld a[80:83],v21,s[20:23],s38 offen sc1
mma v[192:195],a[204:207],v[76:79],v[192:195]
s_waitcnt lgkmcnt(4)
ldt a[220:221],v16 offset:10432
mma v[192:195],a[208:211],v[80:83],v[192:195]
s_waitcnt lgkmcnt(3)
ldt a[222:223],v16 offset:15552
mma v[192:195],a[212:215],v[84:87],v[192:195]
mma v[196:199],a[212:215],v[108:111],v[196:199]
ldt a[224:225],v16 offset:49344
mma v[196:199],a[208:211],v[104:107],v[196:199]
ldt a[226:227],v16 offset:54464
mma v[196:199],a[204:207],v[100:103],v[196:199]
s_add_u32 s38, s58, 22528
bld a[88:91],v21,s[20:23],s38 offen sc1
mma v[196:199],a[200:203],v[96:99],v[196:199]
ldt a[228:229],v16 offset:59584
mma v[196:199],a[196:199],v[92:95],v[196:199]
mma v[196:199],a[192:195],v[88:91],v[196:199]
ldt a[230:231],v16 offset:64704
mma v[200:203],a[192:195],v[112:115],v[200:203]
ldt a[232:233],v16 offset:24768
mma v[200:203],a[196:199],v[116:119],v[200:203]
mma v[200:203],a[200:203],v[120:123],v[200:203]
ldt a[234:235],v16 offset:29888
mma v[200:203],a[204:207],v[124:127],v[200:203]
ldt a[236:237],v16 offset:35008
mma v[200:203],a[208:211],v[128:131],v[200:203]
mma v[200:203],a[212:215],v[132:135],v[200:203]
ldt a[238:239],v16 offset:40128
mma v[204:207],a[212:215],v[156:159],v[204:207]
mma v[204:207],a[208:211],v[152:155],v[204:207]
mma v[204:207],a[204:207],v[148:151],v[204:207]
mma v[204:207],a[200:203],v[144:147],v[204:207]
mma v[204:207],a[196:199],v[140:143],v[204:207]
s_waitcnt lgkmcnt(0)
s_add_u32 s88, s88, s89
s_add_u32 s88, s88, s90
s_add_u32 s88, s88, s91
s_cmp_eq_u32 s88, 3
s_cbranch_scc0 L_w0_poll6
L_w0_poll6_ret:
mma v[204:207],a[192:195],v[136:139],v[204:207]
mma v[208:211],a[216:219],v[64:67],v[208:211]
ldt a[192:193],v15 offset:256
mma v[208:211],a[220:223],v[68:71],v[208:211]
ldt a[194:195],v15 offset:5376
mma v[208:211],a[224:227],v[72:75],v[208:211]
s_add_u32 s38, s56, 5120
bld a[4:7],v21,s[20:23],s38 offen sc1
mma v[208:211],a[228:231],v[76:79],v[208:211]
ldt a[196:197],v15 offset:10496
mma v[208:211],a[232:235],v[80:83],v[208:211]
ldt a[198:199],v15 offset:15616
mma v[208:211],a[236:239],v[84:87],v[208:211]
s_add_u32 s38, s57, 5120
bld a[12:15],v21,s[20:23],s38 offen sc1
mma v[212:215],a[236:239],v[108:111],v[212:215]
ldt a[200:201],v15 offset:49408
mma v[212:215],a[232:235],v[104:107],v[212:215]
ldt a[202:203],v15 offset:54528
mma v[212:215],a[228:231],v[100:103],v[212:215]
mma v[212:215],a[224:227],v[96:99],v[212:215]
ldt a[204:205],v15 offset:59648
mma v[212:215],a[220:223],v[92:95],v[212:215]
s_add_u32 s38, s58, 5120
bld a[20:23],v21,s[20:23],s38 offen sc1
mma v[212:215],a[216:219],v[88:91],v[212:215]
ldt a[206:207],v15 offset:64768
mma v[216:219],a[216:219],v[112:115],v[216:219]
ldt a[208:209],v15 offset:24832
mma v[216:219],a[220:223],v[116:119],v[216:219]
s_add_u32 s38, s56, 11264
bld a[28:31],v21,s[20:23],s38 offen sc1
mma v[216:219],a[224:227],v[120:123],v[216:219]
ldt a[210:211],v15 offset:29952
mma v[216:219],a[228:231],v[124:127],v[216:219]
ldt a[212:213],v15 offset:35072
mma v[216:219],a[232:235],v[128:131],v[216:219]
mma v[216:219],a[236:239],v[132:135],v[216:219]
ldt a[214:215],v15 offset:40192
mma v[220:223],a[236:239],v[156:159],v[220:223]
s_add_u32 s38, s57, 11264
bld a[36:39],v21,s[20:23],s38 offen sc1
mma v[220:223],a[232:235],v[152:155],v[220:223]
mma v[220:223],a[228:231],v[148:151],v[220:223]
mma v[220:223],a[224:227],v[144:147],v[220:223]
mma v[220:223],a[220:223],v[140:143],v[220:223]
s_add_u32 s38, s58, 11264
bld a[44:47],v21,s[20:23],s38 offen sc1
mma v[220:223],a[216:219],v[136:139],v[220:223]
s_waitcnt lgkmcnt(10)
mma v[224:227],a[192:195],v[64:67],v[224:227]
s_waitcnt lgkmcnt(8)
ldt a[216:217],v16 offset:256
mma v[224:227],a[196:199],v[68:71],v[224:227]
s_waitcnt lgkmcnt(7)
ldt a[218:219],v16 offset:5376
mma v[224:227],a[200:203],v[72:75],v[224:227]
s_waitcnt lgkmcnt(6)
mma v[224:227],a[204:207],v[76:79],v[224:227]
s_waitcnt lgkmcnt(4)
ldt a[220:221],v16 offset:10496
mma v[224:227],a[208:211],v[80:83],v[224:227]
s_waitcnt lgkmcnt(3)
ldt a[222:223],v16 offset:15616
mma v[224:227],a[212:215],v[84:87],v[224:227]
s_add_u32 s38, s56, 17408
bld a[52:55],v21,s[20:23],s38 offen sc1
mma v[228:231],a[212:215],v[108:111],v[228:231]
ldt a[224:225],v16 offset:49408
mma v[228:231],a[208:211],v[104:107],v[228:231]
ldt a[226:227],v16 offset:54528
mma v[228:231],a[204:207],v[100:103],v[228:231]
s_add_u32 s38, s57, 17408
bld a[60:63],v21,s[20:23],s38 offen sc1
mma v[228:231],a[200:203],v[96:99],v[228:231]
ldt a[228:229],v16 offset:59648
mma v[228:231],a[196:199],v[92:95],v[228:231]
mma v[228:231],a[192:195],v[88:91],v[228:231]
ldt a[230:231],v16 offset:64768
mma v[232:235],a[192:195],v[112:115],v[232:235]
ldt a[232:233],v16 offset:24832
mma v[232:235],a[196:199],v[116:119],v[232:235]
s_add_u32 s38, s58, 17408
bld a[68:71],v21,s[20:23],s38 offen sc1
mma v[232:235],a[200:203],v[120:123],v[232:235]
ldt a[234:235],v16 offset:29952
mma v[232:235],a[204:207],v[124:127],v[232:235]
ldt a[236:237],v16 offset:35072
mma v[232:235],a[208:211],v[128:131],v[232:235]
mma v[232:235],a[212:215],v[132:135],v[232:235]
ldt a[238:239],v16 offset:40192
mma v[236:239],a[212:215],v[156:159],v[236:239]
s_add_u32 s38, s56, 23552
bld a[76:79],v21,s[20:23],s38 offen sc1
mma v[236:239],a[208:211],v[152:155],v[236:239]
mma v[236:239],a[204:207],v[148:151],v[236:239]
mma v[236:239],a[200:203],v[144:147],v[236:239]
s_add_u32 s38, s57, 23552
bld a[84:87],v21,s[20:23],s38 offen sc1
mma v[236:239],a[196:199],v[140:143],v[236:239]
mma v[236:239],a[192:195],v[136:139],v[236:239]
s_waitcnt lgkmcnt(10)
mma v[240:243],a[216:219],v[64:67],v[240:243]
s_waitcnt lgkmcnt(0)
s_barrier
mma v[240:243],a[220:223],v[68:71],v[240:243]
ldt a[192:193],v5 offset:10240
mma v[240:243],a[224:227],v[72:75],v[240:243]
ldt a[194:195],v5 offset:15360
mma v[240:243],a[228:231],v[76:79],v[240:243]
ldt a[196:197],v5 offset:20480
mma v[240:243],a[232:235],v[80:83],v[240:243]
ldt a[198:199],v5 offset:25600
mma v[240:243],a[236:239],v[84:87],v[240:243]
s_add_u32 s38, s58, 23552
bld a[92:95],v21,s[20:23],s38 offen sc1
mma v[244:247],a[236:239],v[108:111],v[244:247]
ldt a[200:201],v5 offset:30720
mma v[244:247],a[232:235],v[104:107],v[244:247]
ldt a[202:203],v5 offset:35840
mma v[244:247],a[228:231],v[100:103],v[244:247]
mma v[244:247],a[224:227],v[96:99],v[244:247]
ldt a[204:205],v5 offset:40960
mma v[244:247],a[220:223],v[92:95],v[244:247]
mma v[244:247],a[216:219],v[88:91],v[244:247]
ldt a[206:207],v5 offset:46080
mma v[248:251],a[216:219],v[112:115],v[248:251]
ldt a[208:209],v5 offset:51200
mma v[248:251],a[220:223],v[116:119],v[248:251]
mma v[248:251],a[224:227],v[120:123],v[248:251]
ldt a[210:211],v5 offset:56320
mma v[248:251],a[228:231],v[124:127],v[248:251]
ldt a[212:213],v5
mma v[248:251],a[232:235],v[128:131],v[248:251]
mma v[248:251],a[236:239],v[132:135],v[248:251]
ldt a[214:215],v5 offset:5120
mma v[252:255],a[236:239],v[156:159],v[252:255]
mma v[252:255],a[232:235],v[152:155],v[252:255]
mma v[252:255],a[228:231],v[148:151],v[252:255]
mma v[252:255],a[224:227],v[144:147],v[252:255]
mma v[252:255],a[220:223],v[140:143],v[252:255]
mma v[252:255],a[216:219],v[136:139],v[252:255]
s_waitcnt vmcnt(23) lgkmcnt(10)
mma a[96:99],a[192:195],a[0:3],a[96:99]
s_waitcnt vmcnt(11) lgkmcnt(8)
ldt a[216:217],v6 offset:10240
mma a[96:99],a[196:199],a[4:7],a[96:99]
s_waitcnt lgkmcnt(7)
ldt a[218:219],v6 offset:15360
mma a[96:99],a[200:203],a[8:11],a[96:99]
s_waitcnt vmcnt(10) lgkmcnt(6)
mma a[96:99],a[204:207],a[12:15],a[96:99]
s_waitcnt lgkmcnt(4)
ldt a[220:221],v6 offset:20480
mma a[96:99],a[208:211],a[16:19],a[96:99]
s_waitcnt vmcnt(9) lgkmcnt(3)
ldt a[222:223],v6 offset:25600
mma a[96:99],a[212:215],a[20:23],a[96:99]
s_waitcnt vmcnt(6)
mma a[100:103],a[212:215],a[44:47],a[100:103]
ldt a[224:225],v6 offset:30720
mma a[100:103],a[208:211],a[40:43],a[100:103]
ldt a[226:227],v6 offset:35840
mma a[100:103],a[204:207],a[36:39],a[100:103]
mma a[100:103],a[200:203],a[32:35],a[100:103]
ldt a[228:229],v6 offset:40960
mma a[100:103],a[196:199],a[28:31],a[100:103]
mma a[100:103],a[192:195],a[24:27],a[100:103]
ldt a[230:231],v6 offset:46080
mma a[104:107],a[192:195],a[48:51],a[104:107]
s_waitcnt vmcnt(5)
ldt a[232:233],v6 offset:51200
ard v32,a96
mma a[104:107],a[196:199],a[52:55],a[104:107]
ard v33,a97
ard v34,a98
mma a[104:107],a[200:203],a[56:59],a[104:107]
s_waitcnt vmcnt(4)
ldt a[234:235],v6 offset:56320
ard v35,a99
mma a[104:107],a[204:207],a[60:63],a[104:107]
ldt a[236:237],v6
cvt v48,v32,v33
mma a[104:107],a[208:211],a[64:67],a[104:107]
s_waitcnt vmcnt(3)
cvt v49,v34,v35
mma a[104:107],a[212:215],a[68:71],a[104:107]
s_waitcnt vmcnt(0)
ldt a[238:239],v6 offset:5120
mma a[108:111],a[212:215],a[92:95],a[108:111]
ard v36,a100
ard v37,a101
mma a[108:111],a[208:211],a[88:91],a[108:111]
ard v38,a102
ard v39,a103
mma a[108:111],a[204:207],a[84:87],a[108:111]
cvt v52,v36,v37
cvt v53,v38,v39
mma a[108:111],a[200:203],a[80:83],a[108:111]
mma a[108:111],a[196:199],a[76:79],a[108:111]
mma a[108:111],a[192:195],a[72:75],a[108:111]
s_waitcnt lgkmcnt(10)
mma a[112:115],a[216:219],a[0:3],a[112:115]
s_waitcnt lgkmcnt(8)
ldt a[192:193],v5 offset:10304
ard v32,a104
mma a[112:115],a[220:223],a[4:7],a[112:115]
s_waitcnt lgkmcnt(7)
ldt a[194:195],v5 offset:15424
ard v33,a105
mma a[112:115],a[224:227],a[8:11],a[112:115]
s_waitcnt lgkmcnt(6)
ard v34,a106
ard v35,a107
mma a[112:115],a[228:231],a[12:15],a[112:115]
s_waitcnt lgkmcnt(4)
ldt a[196:197],v5 offset:20544
cvt v56,v32,v33
mma a[112:115],a[232:235],a[16:19],a[112:115]
s_waitcnt lgkmcnt(3)
ldt a[198:199],v5 offset:25664
cvt v57,v34,v35
mma a[112:115],a[236:239],a[20:23],a[112:115]
mma a[116:119],a[236:239],a[44:47],a[116:119]
ldt a[200:201],v5 offset:30784
ard v36,a108
mma a[116:119],a[232:235],a[40:43],a[116:119]
ldt a[202:203],v5 offset:35904
ard v37,a109
mma a[116:119],a[228:231],a[36:39],a[116:119]
ard v38,a110
ard v39,a111
mma a[116:119],a[224:227],a[32:35],a[116:119]
ldt a[204:205],v5 offset:41024
cvt v60,v36,v37
mma a[116:119],a[220:223],a[28:31],a[116:119]
cvt v61,v38,v39
mma a[116:119],a[216:219],a[24:27],a[116:119]
ldt a[206:207],v5 offset:46144
mma a[120:123],a[216:219],a[48:51],a[120:123]
ldt a[208:209],v5 offset:51264
ard v32,a112
mma a[120:123],a[220:223],a[52:55],a[120:123]
ard v33,a113
ard v34,a114
mma a[120:123],a[224:227],a[56:59],a[120:123]
ldt a[210:211],v5 offset:56384
ard v35,a115
mma a[120:123],a[228:231],a[60:63],a[120:123]
s_add_u32 s42, s27, 0
ldt a[212:213],v5 offset:64
cvt v50,v32,v33
mma a[120:123],a[232:235],a[64:67],a[120:123]
cvt v51,v34,v35
mma a[120:123],a[236:239],a[68:71],a[120:123]
ldt a[214:215],v5 offset:5184
mma a[124:127],a[236:239],a[92:95],a[124:127]
buffer_store_dwordx4 v[48:51], v12, s[20:23], s42 offen sc1
mma a[124:127],a[232:235],a[88:91],a[124:127]
ard v36,a116
ard v37,a117
mma a[124:127],a[228:231],a[84:87],a[124:127]
ard v38,a118
ard v39,a119
mma a[124:127],a[224:227],a[80:83],a[124:127]
s_add_u32 s42, s27, 5120
cvt v54,v36,v37
cvt v55,v38,v39
mma a[124:127],a[220:223],a[76:79],a[124:127]
buffer_store_dwordx4 v[52:55], v12, s[20:23], s42 offen sc1
mma a[124:127],a[216:219],a[72:75],a[124:127]
s_waitcnt lgkmcnt(10)
mma a[128:131],a[192:195],a[0:3],a[128:131]
s_waitcnt lgkmcnt(8)
ldt a[216:217],v6 offset:10304
ard v32,a120
mma a[128:131],a[196:199],a[4:7],a[128:131]
s_waitcnt lgkmcnt(7)
ldt a[218:219],v6 offset:15424
ard v33,a121
mma a[128:131],a[200:203],a[8:11],a[128:131]
s_waitcnt lgkmcnt(6)
ard v34,a122
ard v35,a123
mma a[128:131],a[204:207],a[12:15],a[128:131]
s_add_u32 s42, s28, 10240
s_waitcnt lgkmcnt(4)
ldt a[220:221],v6 offset:20544
cvt v58,v32,v33
mma a[128:131],a[208:211],a[16:19],a[128:131]
s_waitcnt lgkmcnt(3)
ldt a[222:223],v6 offset:25664
cvt v59,v34,v35
mma a[128:131],a[212:215],a[20:23],a[128:131]
buffer_store_dwordx4 v[56:59], v12, s[20:23], s42 offen sc1
mma a[132:135],a[212:215],a[44:47],a[132:135]
ldt a[224:225],v6 offset:30784
ard v36,a124
mma a[132:135],a[208:211],a[40:43],a[132:135]
ldt a[226:227],v6 offset:35904
ard v37,a125
mma a[132:135],a[204:207],a[36:39],a[132:135]
ard v38,a126
ard v39,a127
mma a[132:135],a[200:203],a[32:35],a[132:135]
s_add_u32 s42, s28, 15360
ldt a[228:229],v6 offset:41024
cvt v62,v36,v37
mma a[132:135],a[196:199],a[28:31],a[132:135]
cvt v63,v38,v39
mma a[132:135],a[192:195],a[24:27],a[132:135]
ldt a[230:231],v6 offset:46144
mma a[136:139],a[192:195],a[48:51],a[136:139]
ldt a[232:233],v6 offset:51264
mma a[136:139],a[196:199],a[52:55],a[136:139]
buffer_store_dwordx4 v[60:63], v12, s[20:23], s42 offen sc1
mma a[136:139],a[200:203],a[56:59],a[136:139]
ldt a[234:235],v6 offset:56384
ard v32,a128
mma a[136:139],a[204:207],a[60:63],a[136:139]
ldt a[236:237],v6 offset:64
ard v33,a129
mma a[136:139],a[208:211],a[64:67],a[136:139]
ard v34,a130
ard v35,a131
mma a[136:139],a[212:215],a[68:71],a[136:139]
ldt a[238:239],v6 offset:5184
cvt v144,v32,v33
mma a[140:143],a[212:215],a[92:95],a[140:143]
cvt v145,v34,v35
ard v36,a132
mma a[140:143],a[208:211],a[88:91],a[140:143]
ard v37,a133
ard v38,a134
mma a[140:143],a[204:207],a[84:87],a[140:143]
ard v39,a135
cvt v148,v36,v37
mma a[140:143],a[200:203],a[80:83],a[140:143]
cvt v149,v38,v39
mma a[140:143],a[196:199],a[76:79],a[140:143]
mma a[140:143],a[192:195],a[72:75],a[140:143]
s_waitcnt lgkmcnt(10)
mma a[144:147],a[216:219],a[0:3],a[144:147]
s_waitcnt lgkmcnt(8)
ldt a[192:193],v5 offset:10368
ard v32,a136
mma a[144:147],a[220:223],a[4:7],a[144:147]
s_waitcnt lgkmcnt(7)
ldt a[194:195],v5 offset:15488
ard v33,a137
mma a[144:147],a[224:227],a[8:11],a[144:147]
s_waitcnt lgkmcnt(6)
ard v34,a138
ard v35,a139
mma a[144:147],a[228:231],a[12:15],a[144:147]
s_waitcnt lgkmcnt(4)
ldt a[196:197],v5 offset:20608
cvt v152,v32,v33
mma a[144:147],a[232:235],a[16:19],a[144:147]
s_waitcnt lgkmcnt(3)
ldt a[198:199],v5 offset:25728
cvt v153,v34,v35
mma a[144:147],a[236:239],a[20:23],a[144:147]
mma a[148:151],a[236:239],a[44:47],a[148:151]
ldt a[200:201],v5 offset:30848
ard v36,a140
mma a[148:151],a[232:235],a[40:43],a[148:151]
ldt a[202:203],v5 offset:35968
ard v37,a141
mma a[148:151],a[228:231],a[36:39],a[148:151]
ard v38,a142
ard v39,a143
mma a[148:151],a[224:227],a[32:35],a[148:151]
ldt a[204:205],v5 offset:41088
cvt v156,v36,v37
mma a[148:151],a[220:223],a[28:31],a[148:151]
cvt v157,v38,v39
mma a[148:151],a[216:219],a[24:27],a[148:151]
ldt a[206:207],v5 offset:46208
mma a[152:155],a[216:219],a[48:51],a[152:155]
ldt a[208:209],v5 offset:51328
ard v32,a144
mma a[152:155],a[220:223],a[52:55],a[152:155]
ard v33,a145
ard v34,a146
mma a[152:155],a[224:227],a[56:59],a[152:155]
ldt a[210:211],v5 offset:56448
ard v35,a147
mma a[152:155],a[228:231],a[60:63],a[152:155]
s_add_u32 s42, s27, 1024
ldt a[212:213],v5 offset:128
cvt v146,v32,v33
mma a[152:155],a[232:235],a[64:67],a[152:155]
cvt v147,v34,v35
mma a[152:155],a[236:239],a[68:71],a[152:155]
ldt a[214:215],v5 offset:5248
mma a[156:159],a[236:239],a[92:95],a[156:159]
buffer_store_dwordx4 v[144:147], v12, s[20:23], s42 offen sc1
mma a[156:159],a[232:235],a[88:91],a[156:159]
ard v36,a148
ard v37,a149
mma a[156:159],a[228:231],a[84:87],a[156:159]
ard v38,a150
ard v39,a151
mma a[156:159],a[224:227],a[80:83],a[156:159]
s_add_u32 s42, s27, 6144
cvt v150,v36,v37
cvt v151,v38,v39
mma a[156:159],a[220:223],a[76:79],a[156:159]
buffer_store_dwordx4 v[148:151], v12, s[20:23], s42 offen sc1
mma a[156:159],a[216:219],a[72:75],a[156:159]
s_waitcnt lgkmcnt(10)
mma v[160:163],a[192:195],a[0:3],v[160:163]
s_waitcnt lgkmcnt(8)
ldt a[216:217],v6 offset:10368
ard v32,a152
mma v[160:163],a[196:199],a[4:7],v[160:163]
s_waitcnt lgkmcnt(7)
ldt a[218:219],v6 offset:15488
ard v33,a153
mma v[160:163],a[200:203],a[8:11],v[160:163]
s_waitcnt lgkmcnt(6)
ard v34,a154
ard v35,a155
mma v[160:163],a[204:207],a[12:15],v[160:163]
s_add_u32 s42, s28, 11264
s_waitcnt lgkmcnt(4)
ldt a[220:221],v6 offset:20608
cvt v154,v32,v33
mma v[160:163],a[208:211],a[16:19],v[160:163]
s_waitcnt lgkmcnt(3)
ldt a[222:223],v6 offset:25728
cvt v155,v34,v35
mma v[160:163],a[212:215],a[20:23],v[160:163]
buffer_store_dwordx4 v[152:155], v12, s[20:23], s42 offen sc1
mma v[164:167],a[212:215],a[44:47],v[164:167]
ldt a[224:225],v6 offset:30848
ard v36,a156
mma v[164:167],a[208:211],a[40:43],v[164:167]
ldt a[226:227],v6 offset:35968
ard v37,a157
mma v[164:167],a[204:207],a[36:39],v[164:167]
ard v38,a158
ard v39,a159
mma v[164:167],a[200:203],a[32:35],v[164:167]
s_add_u32 s42, s28, 16384
ldt a[228:229],v6 offset:41088
cvt v158,v36,v37
mma v[164:167],a[196:199],a[28:31],v[164:167]
cvt v159,v38,v39
mma v[164:167],a[192:195],a[24:27],v[164:167]
ldt a[230:231],v6 offset:46208
mma v[168:171],a[192:195],a[48:51],v[168:171]
ldt a[232:233],v6 offset:51328
mma v[168:171],a[196:199],a[52:55],v[168:171]
buffer_store_dwordx4 v[156:159], v12, s[20:23], s42 offen sc1
mma v[168:171],a[200:203],a[56:59],v[168:171]
ldt a[234:235],v6 offset:56448
cvt v160,v160,v161
mma v[168:171],a[204:207],a[60:63],v[168:171]
ldt a[236:237],v6 offset:128
cvt v161,v162,v163
mma v[168:171],a[208:211],a[64:67],v[168:171]
mma v[168:171],a[212:215],a[68:71],v[168:171]
ldt a[238:239],v6 offset:5248
mma v[172:175],a[212:215],a[92:95],v[172:175]
cvt v164,v164,v165
cvt v165,v166,v167
mma v[172:175],a[208:211],a[88:91],v[172:175]
mma v[172:175],a[204:207],a[84:87],v[172:175]
mma v[172:175],a[200:203],a[80:83],v[172:175]
mma v[172:175],a[196:199],a[76:79],v[172:175]
mma v[172:175],a[192:195],a[72:75],v[172:175]
s_waitcnt lgkmcnt(10)
mma v[176:179],a[216:219],a[0:3],v[176:179]
s_waitcnt lgkmcnt(8)
ldt a[192:193],v5 offset:10432
cvt v168,v168,v169
mma v[176:179],a[220:223],a[4:7],v[176:179]
s_waitcnt lgkmcnt(7)
ldt a[194:195],v5 offset:15552
cvt v169,v170,v171
mma v[176:179],a[224:227],a[8:11],v[176:179]
s_waitcnt lgkmcnt(6)
mma v[176:179],a[228:231],a[12:15],v[176:179]
s_waitcnt lgkmcnt(4)
ldt a[196:197],v5 offset:20672
mma v[176:179],a[232:235],a[16:19],v[176:179]
s_waitcnt lgkmcnt(3)
ldt a[198:199],v5 offset:25792
mma v[176:179],a[236:239],a[20:23],v[176:179]
mma v[180:183],a[236:239],a[44:47],v[180:183]
ldt a[200:201],v5 offset:30912
cvt v172,v172,v173
mma v[180:183],a[232:235],a[40:43],v[180:183]
ldt a[202:203],v5 offset:36032
cvt v173,v174,v175
mma v[180:183],a[228:231],a[36:39],v[180:183]
s_add_u32 s42, s27, 2048
mma v[180:183],a[224:227],a[32:35],v[180:183]
ldt a[204:205],v5 offset:41152
mma v[180:183],a[220:223],a[28:31],v[180:183]
mma v[180:183],a[216:219],a[24:27],v[180:183]
ldt a[206:207],v5 offset:46272
mma v[184:187],a[216:219],a[48:51],v[184:187]
ldt a[208:209],v5 offset:51392
cvt v162,v176,v177
mma v[184:187],a[220:223],a[52:55],v[184:187]
cvt v163,v178,v179
mma v[184:187],a[224:227],a[56:59],v[184:187]
ldt a[210:211],v5 offset:56512
mma v[184:187],a[228:231],a[60:63],v[184:187]
ldt a[212:213],v5 offset:192
mma v[184:187],a[232:235],a[64:67],v[184:187]
buffer_store_dwordx4 v[160:163], v12, s[20:23], s42 offen sc1
mma v[184:187],a[236:239],a[68:71],v[184:187]
s_add_u32 s42, s27, 7168
ldt a[214:215],v5 offset:5312
mma v[188:191],a[236:239],a[92:95],v[188:191]
cvt v166,v180,v181
cvt v167,v182,v183
mma v[188:191],a[232:235],a[88:91],v[188:191]
buffer_store_dwordx4 v[164:167], v12, s[20:23], s42 offen sc1
mma v[188:191],a[228:231],a[84:87],v[188:191]
s_add_u32 s42, s28, 12288
mma v[188:191],a[224:227],a[80:83],v[188:191]
mma v[188:191],a[220:223],a[76:79],v[188:191]
mma v[188:191],a[216:219],a[72:75],v[188:191]
s_waitcnt lgkmcnt(10)
mma v[192:195],a[192:195],a[0:3],v[192:195]
s_waitcnt lgkmcnt(8)
ldt a[216:217],v6 offset:10432
cvt v170,v184,v185
mma v[192:195],a[196:199],a[4:7],v[192:195]
s_waitcnt lgkmcnt(7)
ldt a[218:219],v6 offset:15552
cvt v171,v186,v187
mma v[192:195],a[200:203],a[8:11],v[192:195]
s_waitcnt lgkmcnt(6)
buffer_store_dwordx4 v[168:171], v12, s[20:23], s42 offen sc1
mma v[192:195],a[204:207],a[12:15],v[192:195]
s_add_u32 s42, s28, 17408
s_waitcnt lgkmcnt(4)
ldt a[220:221],v6 offset:20672
mma v[192:195],a[208:211],a[16:19],v[192:195]
s_waitcnt lgkmcnt(3)
ldt a[222:223],v6 offset:25792
mma v[192:195],a[212:215],a[20:23],v[192:195]
mma v[196:199],a[212:215],a[44:47],v[196:199]
ldt a[224:225],v6 offset:30912
cvt v174,v188,v189
mma v[196:199],a[208:211],a[40:43],v[196:199]
ldt a[226:227],v6 offset:36032
cvt v175,v190,v191
mma v[196:199],a[204:207],a[36:39],v[196:199]
buffer_store_dwordx4 v[172:175], v12, s[20:23], s42 offen sc1
mma v[196:199],a[200:203],a[32:35],v[196:199]
ldt a[228:229],v6 offset:41152
mma v[196:199],a[196:199],a[28:31],v[196:199]
mma v[196:199],a[192:195],a[24:27],v[196:199]
ldt a[230:231],v6 offset:46272
mma v[200:203],a[192:195],a[48:51],v[200:203]
ldt a[232:233],v6 offset:51392
cvt v192,v192,v193
mma v[200:203],a[196:199],a[52:55],v[200:203]
cvt v193,v194,v195
mma v[200:203],a[200:203],a[56:59],v[200:203]
ldt a[234:235],v6 offset:56512
mma v[200:203],a[204:207],a[60:63],v[200:203]
ldt a[236:237],v6 offset:192
mma v[200:203],a[208:211],a[64:67],v[200:203]
mma v[200:203],a[212:215],a[68:71],v[200:203]
ldt a[238:239],v6 offset:5312
mma v[204:207],a[212:215],a[92:95],v[204:207]
cvt v196,v196,v197
cvt v197,v198,v199
mma v[204:207],a[208:211],a[88:91],v[204:207]
mma v[204:207],a[204:207],a[84:87],v[204:207]
mma v[204:207],a[200:203],a[80:83],v[204:207]
mma v[204:207],a[196:199],a[76:79],v[204:207]
mma v[204:207],a[192:195],a[72:75],v[204:207]
s_waitcnt lgkmcnt(10)
mma v[208:211],a[216:219],a[0:3],v[208:211]
s_waitcnt lgkmcnt(8)
ldt a[192:193],v5 offset:10496
cvt v200,v200,v201
mma v[208:211],a[220:223],a[4:7],v[208:211]
s_waitcnt lgkmcnt(7)
ldt a[194:195],v5 offset:15616
cvt v201,v202,v203
mma v[208:211],a[224:227],a[8:11],v[208:211]
s_waitcnt lgkmcnt(6)
mma v[208:211],a[228:231],a[12:15],v[208:211]
s_waitcnt lgkmcnt(4)
ldt a[196:197],v5 offset:20736
mma v[208:211],a[232:235],a[16:19],v[208:211]
s_waitcnt lgkmcnt(3)
ldt a[198:199],v5 offset:25856
mma v[208:211],a[236:239],a[20:23],v[208:211]
mma v[212:215],a[236:239],a[44:47],v[212:215]
ldt a[200:201],v5 offset:30976
cvt v204,v204,v205
mma v[212:215],a[232:235],a[40:43],v[212:215]
ldt a[202:203],v5 offset:36096
cvt v205,v206,v207
mma v[212:215],a[228:231],a[36:39],v[212:215]
s_add_u32 s42, s27, 3072
mma v[212:215],a[224:227],a[32:35],v[212:215]
ldt a[204:205],v5 offset:41216
mma v[212:215],a[220:223],a[28:31],v[212:215]
mma v[212:215],a[216:219],a[24:27],v[212:215]
ldt a[206:207],v5 offset:46336
mma v[216:219],a[216:219],a[48:51],v[216:219]
ldt a[208:209],v5 offset:51456
cvt v194,v208,v209
mma v[216:219],a[220:223],a[52:55],v[216:219]
cvt v195,v210,v211
mma v[216:219],a[224:227],a[56:59],v[216:219]
ldt a[210:211],v5 offset:56576
mma v[216:219],a[228:231],a[60:63],v[216:219]
ldt a[212:213],v5 offset:256
mma v[216:219],a[232:235],a[64:67],v[216:219]
buffer_store_dwordx4 v[192:195], v12, s[20:23], s42 offen sc1
mma v[216:219],a[236:239],a[68:71],v[216:219]
s_add_u32 s42, s27, 8192
ldt a[214:215],v5 offset:5376
mma v[220:223],a[236:239],a[92:95],v[220:223]
cvt v198,v212,v213
cvt v199,v214,v215
mma v[220:223],a[232:235],a[88:91],v[220:223]
buffer_store_dwordx4 v[196:199], v12, s[20:23], s42 offen sc1
mma v[220:223],a[228:231],a[84:87],v[220:223]
s_add_u32 s42, s28, 13312
mma v[220:223],a[224:227],a[80:83],v[220:223]
mma v[220:223],a[220:223],a[76:79],v[220:223]
mma v[220:223],a[216:219],a[72:75],v[220:223]
s_waitcnt lgkmcnt(10)
mma v[224:227],a[192:195],a[0:3],v[224:227]
s_waitcnt lgkmcnt(8)
ldt a[216:217],v6 offset:10496
cvt v202,v216,v217
mma v[224:227],a[196:199],a[4:7],v[224:227]
s_waitcnt lgkmcnt(7)
ldt a[218:219],v6 offset:15616
cvt v203,v218,v219
mma v[224:227],a[200:203],a[8:11],v[224:227]
s_waitcnt lgkmcnt(6)
buffer_store_dwordx4 v[200:203], v12, s[20:23], s42 offen sc1
mma v[224:227],a[204:207],a[12:15],v[224:227]
s_add_u32 s42, s28, 18432
s_waitcnt lgkmcnt(4)
ldt a[220:221],v6 offset:20736
mma v[224:227],a[208:211],a[16:19],v[224:227]
s_waitcnt lgkmcnt(3)
ldt a[222:223],v6 offset:25856
mma v[224:227],a[212:215],a[20:23],v[224:227]
mma v[228:231],a[212:215],a[44:47],v[228:231]
ldt a[224:225],v6 offset:30976
cvt v206,v220,v221
mma v[228:231],a[208:211],a[40:43],v[228:231]
ldt a[226:227],v6 offset:36096
cvt v207,v222,v223
mma v[228:231],a[204:207],a[36:39],v[228:231]
buffer_store_dwordx4 v[204:207], v12, s[20:23], s42 offen sc1
mma v[228:231],a[200:203],a[32:35],v[228:231]
ldt a[228:229],v6 offset:41216
mma v[228:231],a[196:199],a[28:31],v[228:231]
mma v[228:231],a[192:195],a[24:27],v[228:231]
ldt a[230:231],v6 offset:46336
mma v[232:235],a[192:195],a[48:51],v[232:235]
ldt a[232:233],v6 offset:51456
cvt v224,v224,v225
mma v[232:235],a[196:199],a[52:55],v[232:235]
cvt v225,v226,v227
mma v[232:235],a[200:203],a[56:59],v[232:235]
ldt a[234:235],v6 offset:56576
mma v[232:235],a[204:207],a[60:63],v[232:235]
ldt a[236:237],v6 offset:256
mma v[232:235],a[208:211],a[64:67],v[232:235]
mma v[232:235],a[212:215],a[68:71],v[232:235]
ldt a[238:239],v6 offset:5376
mma v[236:239],a[212:215],a[92:95],v[236:239]
cvt v228,v228,v229
cvt v229,v230,v231
mma v[236:239],a[208:211],a[88:91],v[236:239]
mma v[236:239],a[204:207],a[84:87],v[236:239]
mma v[236:239],a[200:203],a[80:83],v[236:239]
mma v[236:239],a[196:199],a[76:79],v[236:239]
mma v[236:239],a[192:195],a[72:75],v[236:239]
s_waitcnt lgkmcnt(10)
mma v[240:243],a[216:219],a[0:3],v[240:243]
s_waitcnt vmcnt(8)
s_waitcnt lgkmcnt(8)
buffer_store_dword v47, v11, s[20:23], 0 offen sc1
mma v[240:243],a[220:223],a[4:7],v[240:243]
s_waitcnt lgkmcnt(6)
cvt v232,v232,v233
cvt v233,v234,v235
mma v[240:243],a[224:227],a[8:11],v[240:243]
s_waitcnt lgkmcnt(4)
mma v[240:243],a[228:231],a[12:15],v[240:243]
s_waitcnt lgkmcnt(2)
mma v[240:243],a[232:235],a[16:19],v[240:243]
s_waitcnt lgkmcnt(0)
mma v[240:243],a[236:239],a[20:23],v[240:243]
mma v[244:247],a[236:239],a[44:47],v[244:247]
cvt v236,v236,v237
cvt v237,v238,v239
mma v[244:247],a[232:235],a[40:43],v[244:247]
s_add_u32 s42, s27, 4096
mma v[244:247],a[228:231],a[36:39],v[244:247]
mma v[244:247],a[224:227],a[32:35],v[244:247]
mma v[244:247],a[220:223],a[28:31],v[244:247]
mma v[244:247],a[216:219],a[24:27],v[244:247]
mma v[248:251],a[216:219],a[48:51],v[248:251]
cvt v226,v240,v241
cvt v227,v242,v243
mma v[248:251],a[220:223],a[52:55],v[248:251]
buffer_store_dwordx4 v[224:227], v12, s[20:23], s42 offen sc1
mma v[248:251],a[224:227],a[56:59],v[248:251]
s_add_u32 s42, s27, 9216
mma v[248:251],a[228:231],a[60:63],v[248:251]
mma v[248:251],a[232:235],a[64:67],v[248:251]
mma v[248:251],a[236:239],a[68:71],v[248:251]
mma v[252:255],a[236:239],a[92:95],v[252:255]
cvt v230,v244,v245
cvt v231,v246,v247
mma v[252:255],a[232:235],a[88:91],v[252:255]
buffer_store_dwordx4 v[228:231], v12, s[20:23], s42 offen sc1
mma v[252:255],a[228:231],a[84:87],v[252:255]
s_add_u32 s42, s28, 14336
mma v[252:255],a[224:227],a[80:83],v[252:255]
mma v[252:255],a[220:223],a[76:79],v[252:255]
mma v[252:255],a[216:219],a[72:75],v[252:255]
cvt v234,v248,v249
cvt v235,v250,v251
buffer_store_dwordx4 v[232:235], v12, s[20:23], s42 offen sc1
s_add_u32 s42, s28, 19456
s_nop 3
cvt v238,v252,v253
cvt v239,v254,v255
buffer_store_dwordx4 v[236:239], v12, s[20:23], s42 offen sc1
s_cmp_lg_u32 s27, s46
s_cbranch_scc1 L_w0_own0
s_cmp_lg_u32 s28, s46
s_cbranch_scc1 L_w0_own1
L_w0_own_ret:
s_waitcnt lgkmcnt(0)
s_barrier
s_mov_b64 exec, s[32:33]
ldq v[64:67],v4
ldq v[80:83],v4 offset:1024
ldq v[96:99],v4 offset:2048
ldq v[112:115],v4 offset:3072
ldq v[128:131],v4 offset:4096
s_mov_b64 exec, -1
s_buffer_load_dwordx8 s[88:95], s[20:23], s87 offset:384 glc
s_waitcnt vmcnt(5)
buffer_store_dword v47, v11, s[20:23], 0 offen offset:128 sc1
s_waitcnt vmcnt(1)
buffer_store_dword v47, v11, s[20:23], 0 offen offset:256 sc1
s_cmp_eq_u32 s97, -1
s_cbranch_scc1 L_w0_done
s_waitcnt lgkmcnt(0)
s_add_u32 s88, s88, s89
s_add_u32 s88, s88, s90
s_add_u32 s88, s88, s91
s_add_u32 s88, s88, s92
s_add_u32 s88, s88, s93
s_add_u32 s88, s88, s94
s_add_u32 s88, s88, s95
s_cmp_eq_u32 s88, 8
s_cbranch_scc0 L_w0_rp0
L_w0_rp0_ret:
s_add_u32 s42, s16, 0
s_not_b64 exec, s[32:33]
bld v[64:67],v13,s[20:23],s42 offen sc1
s_mov_b64 exec, -1
s_add_u32 s42, s17, 0
bld v[68:71],v13,s[20:23],s42 offen sc1
s_add_u32 s42, s18, 0
bld v[72:75],v13,s[20:23],s42 offen sc1
s_add_u32 s42, s19, 0
bld v[76:79],v13,s[20:23],s42 offen sc1
s_add_u32 s42, s16, 1024
s_not_b64 exec, s[32:33]
bld v[80:83],v13,s[20:23],s42 offen sc1
s_mov_b64 exec, -1
s_add_u32 s42, s17, 1024
bld v[84:87],v13,s[20:23],s42 offen sc1
s_add_u32 s42, s18, 1024
bld v[88:91],v13,s[20:23],s42 offen sc1
s_add_u32 s42, s19, 1024
bld v[92:95],v13,s[20:23],s42 offen sc1
L_w0_join:
s_buffer_load_dwordx8 s[88:95], s[20:23], s87 offset:512 glc
s_waitcnt lgkmcnt(0)
s_add_u32 s88, s88, s89
s_add_u32 s88, s88, s90
s_add_u32 s88, s88, s91
s_add_u32 s88, s88, s92
s_add_u32 s88, s88, s93
s_add_u32 s88, s88, s94
s_add_u32 s88, s88, s95
s_cmp_eq_u32 s88, 8
s_cbranch_scc0 L_w0_rp1
L_w0_rp1_ret:
s_add_u32 s42, s16, 2048
s_not_b64 exec, s[32:33]
bld v[96:99],v13,s[20:23],s42 offen sc1
s_mov_b64 exec, -1
s_add_u32 s42, s17, 2048
bld v[100:103],v13,s[20:23],s42 offen sc1
s_add_u32 s42, s18, 2048
bld v[104:107],v13,s[20:23],s42 offen sc1
s_add_u32 s42, s19, 2048
bld v[108:111],v13,s[20:23],s42 offen sc1
s_add_u32 s42, s16, 3072
s_not_b64 exec, s[32:33]
bld v[112:115],v13,s[20:23],s42 offen sc1
s_mov_b64 exec, -1
s_add_u32 s42, s17, 3072
bld v[116:119],v13,s[20:23],s42 offen sc1
s_add_u32 s42, s18, 3072
bld v[120:123],v13,s[20:23],s42 offen sc1
s_add_u32 s42, s19, 3072
bld v[124:127],v13,s[20:23],s42 offen sc1
s_buffer_load_dwordx8 s[88:95], s[20:23], s87 offset:640 glc
s_waitcnt vmcnt(15)
v_lshlrev_b32 v144, 16, v64
v_and_b32 v145, s43, v64
v_lshlrev_b32 v146, 16, v65
v_and_b32 v147, s43, v65
v_lshlrev_b32 v148, 16, v66
v_and_b32 v149, s43, v66
v_lshlrev_b32 v150, 16, v67
v_and_b32 v151, s43, v67
s_waitcnt vmcnt(14)
v_lshlrev_b32 v152, 16, v68
v_and_b32 v153, s43, v68
v_lshlrev_b32 v154, 16, v69
v_and_b32 v155, s43, v69
v_lshlrev_b32 v156, 16, v70
v_and_b32 v157, s43, v70
v_lshlrev_b32 v158, 16, v71
v_and_b32 v159, s43, v71
v_add_f32 v144, v144, v152
v_add_f32 v145, v145, v153
v_add_f32 v146, v146, v154
v_add_f32 v147, v147, v155
v_add_f32 v148, v148, v156
v_add_f32 v149, v149, v157
v_add_f32 v150, v150, v158
v_add_f32 v151, v151, v159
s_waitcnt vmcnt(13)
v_lshlrev_b32 v152, 16, v72
v_and_b32 v153, s43, v72
v_lshlrev_b32 v154, 16, v73
v_and_b32 v155, s43, v73
v_lshlrev_b32 v156, 16, v74
v_and_b32 v157, s43, v74
v_lshlrev_b32 v158, 16, v75
v_and_b32 v159, s43, v75
v_add_f32 v144, v144, v152
v_add_f32 v145, v145, v153
v_add_f32 v146, v146, v154
v_add_f32 v147, v147, v155
v_add_f32 v148, v148, v156
v_add_f32 v149, v149, v157
v_add_f32 v150, v150, v158
v_add_f32 v151, v151, v159
s_waitcnt vmcnt(12)
v_lshlrev_b32 v152, 16, v76
v_and_b32 v153, s43, v76
v_lshlrev_b32 v154, 16, v77
v_and_b32 v155, s43, v77
v_lshlrev_b32 v156, 16, v78
v_and_b32 v157, s43, v78
v_lshlrev_b32 v158, 16, v79
v_and_b32 v159, s43, v79
v_add_f32 v144, v144, v152
v_add_f32 v145, v145, v153
v_add_f32 v146, v146, v154
v_add_f32 v147, v147, v155
v_add_f32 v148, v148, v156
v_add_f32 v149, v149, v157
v_add_f32 v150, v150, v158
v_add_f32 v151, v151, v159
v_add_f32_dpp v152, v144, v144 row_ror:8 row_mask:0xf bank_mask:0xf
v_add_f32_dpp v153, v145, v145 row_ror:8 row_mask:0xf bank_mask:0xf
v_add_f32_dpp v154, v146, v146 row_ror:8 row_mask:0xf bank_mask:0xf
v_add_f32_dpp v155, v147, v147 row_ror:8 row_mask:0xf bank_mask:0xf
v_add_f32_dpp v156, v148, v148 row_ror:8 row_mask:0xf bank_mask:0xf
v_add_f32_dpp v157, v149, v149 row_ror:8 row_mask:0xf bank_mask:0xf
v_add_f32_dpp v158, v150, v150 row_ror:8 row_mask:0xf bank_mask:0xf
v_add_f32_dpp v159, v151, v151 row_ror:8 row_mask:0xf bank_mask:0xf
cvt v48,v152,v153
cvt v49,v154,v155
cvt v50,v156,v157
cvt v51,v158,v159
s_nop 0
v_permlane32_swap_b32 v48, v50
v_permlane32_swap_b32 v49, v51
s_nop 0
v_permlane16_swap_b32 v48, v50
v_permlane16_swap_b32 v49, v51
buffer_store_dwordx4 v[48:51], v14, s[4:7], s97 offen
s_waitcnt vmcnt(12)
v_lshlrev_b32 v144, 16, v80
v_and_b32 v145, s43, v80
v_lshlrev_b32 v146, 16, v81
v_and_b32 v147, s43, v81
v_lshlrev_b32 v148, 16, v82
v_and_b32 v149, s43, v82
v_lshlrev_b32 v150, 16, v83
v_and_b32 v151, s43, v83
s_waitcnt vmcnt(11)
v_lshlrev_b32 v152, 16, v84
v_and_b32 v153, s43, v84
v_lshlrev_b32 v154, 16, v85
v_and_b32 v155, s43, v85
v_lshlrev_b32 v156, 16, v86
v_and_b32 v157, s43, v86
v_lshlrev_b32 v158, 16, v87
v_and_b32 v159, s43, v87
v_add_f32 v144, v144, v152
v_add_f32 v145, v145, v153
v_add_f32 v146, v146, v154
v_add_f32 v147, v147, v155
v_add_f32 v148, v148, v156
v_add_f32 v149, v149, v157
v_add_f32 v150, v150, v158
v_add_f32 v151, v151, v159
s_waitcnt vmcnt(10)
v_lshlrev_b32 v152, 16, v88
v_and_b32 v153, s43, v88
v_lshlrev_b32 v154, 16, v89
v_and_b32 v155, s43, v89
v_lshlrev_b32 v156, 16, v90
v_and_b32 v157, s43, v90
v_lshlrev_b32 v158, 16, v91
v_and_b32 v159, s43, v91
v_add_f32 v144, v144, v152
v_add_f32 v145, v145, v153
v_add_f32 v146, v146, v154
v_add_f32 v147, v147, v155
v_add_f32 v148, v148, v156
v_add_f32 v149, v149, v157
v_add_f32 v150, v150, v158
v_add_f32 v151, v151, v159
s_waitcnt vmcnt(9)
v_lshlrev_b32 v152, 16, v92
v_and_b32 v153, s43, v92
v_lshlrev_b32 v154, 16, v93
v_and_b32 v155, s43, v93
v_lshlrev_b32 v156, 16, v94
v_and_b32 v157, s43, v94
v_lshlrev_b32 v158, 16, v95
v_and_b32 v159, s43, v95
v_add_f32 v144, v144, v152
v_add_f32 v145, v145, v153
v_add_f32 v146, v146, v154
v_add_f32 v147, v147, v155
v_add_f32 v148, v148, v156
v_add_f32 v149, v149, v157
v_add_f32 v150, v150, v158
v_add_f32 v151, v151, v159
v_add_f32_dpp v152, v144, v144 row_ror:8 row_mask:0xf bank_mask:0xf
v_add_f32_dpp v153, v145, v145 row_ror:8 row_mask:0xf bank_mask:0xf
v_add_f32_dpp v154, v146, v146 row_ror:8 row_mask:0xf bank_mask:0xf
v_add_f32_dpp v155, v147, v147 row_ror:8 row_mask:0xf bank_mask:0xf
v_add_f32_dpp v156, v148, v148 row_ror:8 row_mask:0xf bank_mask:0xf
v_add_f32_dpp v157, v149, v149 row_ror:8 row_mask:0xf bank_mask:0xf
v_add_f32_dpp v158, v150, v150 row_ror:8 row_mask:0xf bank_mask:0xf
v_add_f32_dpp v159, v151, v151 row_ror:8 row_mask:0xf bank_mask:0xf
cvt v52,v152,v153
cvt v53,v154,v155
cvt v54,v156,v157
cvt v55,v158,v159
s_nop 0
v_permlane32_swap_b32 v52, v54
v_permlane32_swap_b32 v53, v55
s_nop 0
v_permlane16_swap_b32 v52, v54
v_permlane16_swap_b32 v53, v55
buffer_store_dwordx4 v[52:55], v14, s[4:7], s97 offen offset:64
s_waitcnt lgkmcnt(0)
s_add_u32 s88, s88, s89
s_add_u32 s88, s88, s90
s_add_u32 s88, s88, s91
s_add_u32 s88, s88, s92
s_add_u32 s88, s88, s93
s_add_u32 s88, s88, s94
s_add_u32 s88, s88, s95
s_cmp_eq_u32 s88, 8
s_cbranch_scc0 L_w0_rp2
L_w0_rp2_ret:
s_add_u32 s42, s16, 4096
s_not_b64 exec, s[32:33]
bld v[128:131],v13,s[20:23],s42 offen sc1
s_mov_b64 exec, -1
s_add_u32 s42, s17, 4096
bld v[132:135],v13,s[20:23],s42 offen sc1
s_add_u32 s42, s18, 4096
bld v[136:139],v13,s[20:23],s42 offen sc1
s_add_u32 s42, s19, 4096
s_waitcnt vmcnt(12)
bld v[140:143],v13,s[20:23],s42 offen sc1
v_lshlrev_b32 v144, 16, v96
v_and_b32 v145, s43, v96
v_lshlrev_b32 v146, 16, v97
v_and_b32 v147, s43, v97
v_lshlrev_b32 v148, 16, v98
v_and_b32 v149, s43, v98
v_lshlrev_b32 v150, 16, v99
v_and_b32 v151, s43, v99
s_waitcnt vmcnt(12)
v_lshlrev_b32 v152, 16, v100
v_and_b32 v153, s43, v100
v_lshlrev_b32 v154, 16, v101
v_and_b32 v155, s43, v101
v_lshlrev_b32 v156, 16, v102
v_and_b32 v157, s43, v102
v_lshlrev_b32 v158, 16, v103
v_and_b32 v159, s43, v103
v_add_f32 v144, v144, v152
v_add_f32 v145, v145, v153
v_add_f32 v146, v146, v154
v_add_f32 v147, v147, v155
v_add_f32 v148, v148, v156
v_add_f32 v149, v149, v157
v_add_f32 v150, v150, v158
v_add_f32 v151, v151, v159
s_waitcnt vmcnt(11)
v_lshlrev_b32 v152, 16, v104
v_and_b32 v153, s43, v104
v_lshlrev_b32 v154, 16, v105
v_and_b32 v155, s43, v105
v_lshlrev_b32 v156, 16, v106
v_and_b32 v157, s43, v106
v_lshlrev_b32 v158, 16, v107
v_and_b32 v159, s43, v107
v_add_f32 v144, v144, v152
v_add_f32 v145, v145, v153
v_add_f32 v146, v146, v154
v_add_f32 v147, v147, v155
v_add_f32 v148, v148, v156
v_add_f32 v149, v149, v157
v_add_f32 v150, v150, v158
v_add_f32 v151, v151, v159
s_waitcnt vmcnt(10)
v_lshlrev_b32 v152, 16, v108
v_and_b32 v153, s43, v108
v_lshlrev_b32 v154, 16, v109
v_and_b32 v155, s43, v109
v_lshlrev_b32 v156, 16, v110
v_and_b32 v157, s43, v110
v_lshlrev_b32 v158, 16, v111
v_and_b32 v159, s43, v111
v_add_f32 v144, v144, v152
v_add_f32 v145, v145, v153
v_add_f32 v146, v146, v154
v_add_f32 v147, v147, v155
v_add_f32 v148, v148, v156
v_add_f32 v149, v149, v157
v_add_f32 v150, v150, v158
v_add_f32 v151, v151, v159
v_add_f32_dpp v152, v144, v144 row_ror:8 row_mask:0xf bank_mask:0xf
v_add_f32_dpp v153, v145, v145 row_ror:8 row_mask:0xf bank_mask:0xf
v_add_f32_dpp v154, v146, v146 row_ror:8 row_mask:0xf bank_mask:0xf
v_add_f32_dpp v155, v147, v147 row_ror:8 row_mask:0xf bank_mask:0xf
v_add_f32_dpp v156, v148, v148 row_ror:8 row_mask:0xf bank_mask:0xf
v_add_f32_dpp v157, v149, v149 row_ror:8 row_mask:0xf bank_mask:0xf
v_add_f32_dpp v158, v150, v150 row_ror:8 row_mask:0xf bank_mask:0xf
v_add_f32_dpp v159, v151, v151 row_ror:8 row_mask:0xf bank_mask:0xf
cvt v48,v152,v153
cvt v49,v154,v155
cvt v50,v156,v157
cvt v51,v158,v159
s_nop 0
v_permlane32_swap_b32 v48, v50
v_permlane32_swap_b32 v49, v51
s_nop 0
v_permlane16_swap_b32 v48, v50
v_permlane16_swap_b32 v49, v51
buffer_store_dwordx4 v[48:51], v14, s[4:7], s97 offen offset:128
s_waitcnt vmcnt(10)
v_lshlrev_b32 v144, 16, v112
v_and_b32 v145, s43, v112
v_lshlrev_b32 v146, 16, v113
v_and_b32 v147, s43, v113
v_lshlrev_b32 v148, 16, v114
v_and_b32 v149, s43, v114
v_lshlrev_b32 v150, 16, v115
v_and_b32 v151, s43, v115
s_waitcnt vmcnt(9)
v_lshlrev_b32 v152, 16, v116
v_and_b32 v153, s43, v116
v_lshlrev_b32 v154, 16, v117
v_and_b32 v155, s43, v117
v_lshlrev_b32 v156, 16, v118
v_and_b32 v157, s43, v118
v_lshlrev_b32 v158, 16, v119
v_and_b32 v159, s43, v119
v_add_f32 v144, v144, v152
v_add_f32 v145, v145, v153
v_add_f32 v146, v146, v154
v_add_f32 v147, v147, v155
v_add_f32 v148, v148, v156
v_add_f32 v149, v149, v157
v_add_f32 v150, v150, v158
v_add_f32 v151, v151, v159
s_waitcnt vmcnt(8)
v_lshlrev_b32 v152, 16, v120
v_and_b32 v153, s43, v120
v_lshlrev_b32 v154, 16, v121
v_and_b32 v155, s43, v121
v_lshlrev_b32 v156, 16, v122
v_and_b32 v157, s43, v122
v_lshlrev_b32 v158, 16, v123
v_and_b32 v159, s43, v123
v_add_f32 v144, v144, v152
v_add_f32 v145, v145, v153
v_add_f32 v146, v146, v154
v_add_f32 v147, v147, v155
v_add_f32 v148, v148, v156
v_add_f32 v149, v149, v157
v_add_f32 v150, v150, v158
v_add_f32 v151, v151, v159
s_waitcnt vmcnt(7)
v_lshlrev_b32 v152, 16, v124
v_and_b32 v153, s43, v124
v_lshlrev_b32 v154, 16, v125
v_and_b32 v155, s43, v125
v_lshlrev_b32 v156, 16, v126
v_and_b32 v157, s43, v126
v_lshlrev_b32 v158, 16, v127
v_and_b32 v159, s43, v127
v_add_f32 v144, v144, v152
v_add_f32 v145, v145, v153
v_add_f32 v146, v146, v154
v_add_f32 v147, v147, v155
v_add_f32 v148, v148, v156
v_add_f32 v149, v149, v157
v_add_f32 v150, v150, v158
v_add_f32 v151, v151, v159
v_add_f32_dpp v152, v144, v144 row_ror:8 row_mask:0xf bank_mask:0xf
v_add_f32_dpp v153, v145, v145 row_ror:8 row_mask:0xf bank_mask:0xf
v_add_f32_dpp v154, v146, v146 row_ror:8 row_mask:0xf bank_mask:0xf
v_add_f32_dpp v155, v147, v147 row_ror:8 row_mask:0xf bank_mask:0xf
v_add_f32_dpp v156, v148, v148 row_ror:8 row_mask:0xf bank_mask:0xf
v_add_f32_dpp v157, v149, v149 row_ror:8 row_mask:0xf bank_mask:0xf
v_add_f32_dpp v158, v150, v150 row_ror:8 row_mask:0xf bank_mask:0xf
v_add_f32_dpp v159, v151, v151 row_ror:8 row_mask:0xf bank_mask:0xf
cvt v52,v152,v153
cvt v53,v154,v155
cvt v54,v156,v157
cvt v55,v158,v159
s_nop 0
v_permlane32_swap_b32 v52, v54
v_permlane32_swap_b32 v53, v55
s_nop 0
v_permlane16_swap_b32 v52, v54
v_permlane16_swap_b32 v53, v55
buffer_store_dwordx4 v[52:55], v14, s[4:7], s97 offen offset:192
s_waitcnt vmcnt(5)
v_lshlrev_b32 v144, 16, v128
v_and_b32 v145, s43, v128
v_lshlrev_b32 v146, 16, v129
v_and_b32 v147, s43, v129
v_lshlrev_b32 v148, 16, v130
v_and_b32 v149, s43, v130
v_lshlrev_b32 v150, 16, v131
v_and_b32 v151, s43, v131
s_waitcnt vmcnt(4)
v_lshlrev_b32 v152, 16, v132
v_and_b32 v153, s43, v132
v_lshlrev_b32 v154, 16, v133
v_and_b32 v155, s43, v133
v_lshlrev_b32 v156, 16, v134
v_and_b32 v157, s43, v134
v_lshlrev_b32 v158, 16, v135
v_and_b32 v159, s43, v135
v_add_f32 v144, v144, v152
v_add_f32 v145, v145, v153
v_add_f32 v146, v146, v154
v_add_f32 v147, v147, v155
v_add_f32 v148, v148, v156
v_add_f32 v149, v149, v157
v_add_f32 v150, v150, v158
v_add_f32 v151, v151, v159
s_waitcnt vmcnt(3)
v_lshlrev_b32 v152, 16, v136
v_and_b32 v153, s43, v136
v_lshlrev_b32 v154, 16, v137
v_and_b32 v155, s43, v137
v_lshlrev_b32 v156, 16, v138
v_and_b32 v157, s43, v138
v_lshlrev_b32 v158, 16, v139
v_and_b32 v159, s43, v139
v_add_f32 v144, v144, v152
v_add_f32 v145, v145, v153
v_add_f32 v146, v146, v154
v_add_f32 v147, v147, v155
v_add_f32 v148, v148, v156
v_add_f32 v149, v149, v157
v_add_f32 v150, v150, v158
v_add_f32 v151, v151, v159
s_waitcnt vmcnt(2)
v_lshlrev_b32 v152, 16, v140
v_and_b32 v153, s43, v140
v_lshlrev_b32 v154, 16, v141
v_and_b32 v155, s43, v141
v_lshlrev_b32 v156, 16, v142
v_and_b32 v157, s43, v142
v_lshlrev_b32 v158, 16, v143
v_and_b32 v159, s43, v143
v_add_f32 v144, v144, v152
v_add_f32 v145, v145, v153
v_add_f32 v146, v146, v154
v_add_f32 v147, v147, v155
v_add_f32 v148, v148, v156
v_add_f32 v149, v149, v157
v_add_f32 v150, v150, v158
v_add_f32 v151, v151, v159
v_add_f32_dpp v152, v144, v144 row_ror:8 row_mask:0xf bank_mask:0xf
v_add_f32_dpp v153, v145, v145 row_ror:8 row_mask:0xf bank_mask:0xf
v_add_f32_dpp v154, v146, v146 row_ror:8 row_mask:0xf bank_mask:0xf
v_add_f32_dpp v155, v147, v147 row_ror:8 row_mask:0xf bank_mask:0xf
v_add_f32_dpp v156, v148, v148 row_ror:8 row_mask:0xf bank_mask:0xf
v_add_f32_dpp v157, v149, v149 row_ror:8 row_mask:0xf bank_mask:0xf
v_add_f32_dpp v158, v150, v150 row_ror:8 row_mask:0xf bank_mask:0xf
v_add_f32_dpp v159, v151, v151 row_ror:8 row_mask:0xf bank_mask:0xf
cvt v48,v152,v153
cvt v49,v154,v155
cvt v50,v156,v157
cvt v51,v158,v159
s_nop 0
v_permlane32_swap_b32 v48, v50
v_permlane32_swap_b32 v49, v51
s_nop 0
v_permlane16_swap_b32 v48, v50
v_permlane16_swap_b32 v49, v51
buffer_store_dwordx4 v[48:51], v14, s[4:7], s97 offen offset:256
L_w0_done:
s_endpgm
L_w0_poll0:
s_mov_b32 s47, 4096
L_w0_poll0_s:
s_buffer_load_dwordx4 s[88:91], s[20:23], s87 glc
s_waitcnt lgkmcnt(0)
s_add_u32 s88, s88, s89
s_add_u32 s88, s88, s90
s_add_u32 s88, s88, s91
s_cmp_eq_u32 s88, 3
s_cbranch_scc1 L_w0_poll0_ret
s_sub_u32 s47, s47, 1
s_cmp_lg_u32 s47, 0
s_cbranch_scc1 L_w0_poll0_s
s_mov_b32 s47, 65536
L_w0_poll0_loop:
buffer_load_dword v19, v18, s[20:23], 0 offen sc1
s_waitcnt vmcnt(0)
v_cmp_le_u32 vcc, 1, v19
s_nop 1
s_bcnt1_i32_b64 s88, vcc
s_cmp_eq_u32 s88, 3
s_cbranch_scc1 L_w0_poll0_ret
s_sub_u32 s47, s47, 1
s_cmp_lg_u32 s47, 0
s_cbranch_scc1 L_w0_poll0_loop
s_branch L_w0_poll0_ret
L_w0_poll1:
s_mov_b32 s47, 4096
L_w0_poll1_s:
s_buffer_load_dwordx4 s[88:91], s[20:23], s87 offset:128 glc
s_waitcnt lgkmcnt(0)
s_add_u32 s88, s88, s89
s_add_u32 s88, s88, s90
s_add_u32 s88, s88, s91
s_cmp_eq_u32 s88, 3
s_cbranch_scc1 L_w0_poll1_ret
s_sub_u32 s47, s47, 1
s_cmp_lg_u32 s47, 0
s_cbranch_scc1 L_w0_poll1_s
s_mov_b32 s47, 65536
L_w0_poll1_loop:
buffer_load_dword v19, v18, s[20:23], 0 offen offset:128 sc1
s_waitcnt vmcnt(0)
v_cmp_le_u32 vcc, 1, v19
s_nop 1
s_bcnt1_i32_b64 s88, vcc
s_cmp_eq_u32 s88, 3
s_cbranch_scc1 L_w0_poll1_ret
s_sub_u32 s47, s47, 1
s_cmp_lg_u32 s47, 0
s_cbranch_scc1 L_w0_poll1_loop
s_branch L_w0_poll1_ret
L_w0_poll2:
s_mov_b32 s47, 4096
L_w0_poll2_s:
s_buffer_load_dwordx4 s[88:91], s[20:23], s87 offset:256 glc
s_waitcnt lgkmcnt(0)
s_add_u32 s88, s88, s89
s_add_u32 s88, s88, s90
s_add_u32 s88, s88, s91
s_cmp_eq_u32 s88, 3
s_cbranch_scc1 L_w0_poll2_ret
s_sub_u32 s47, s47, 1
s_cmp_lg_u32 s47, 0
s_cbranch_scc1 L_w0_poll2_s
s_mov_b32 s47, 65536
L_w0_poll2_loop:
buffer_load_dword v19, v18, s[20:23], 0 offen offset:256 sc1
s_waitcnt vmcnt(0)
v_cmp_le_u32 vcc, 1, v19
s_nop 1
s_bcnt1_i32_b64 s88, vcc
s_cmp_eq_u32 s88, 3
s_cbranch_scc1 L_w0_poll2_ret
s_sub_u32 s47, s47, 1
s_cmp_lg_u32 s47, 0
s_cbranch_scc1 L_w0_poll2_loop
s_branch L_w0_poll2_ret
L_w0_poll6:
s_mov_b32 s47, 4096
L_w0_poll6_s:
s_buffer_load_dwordx4 s[88:91], s[20:23], s87 offset:768 glc
s_waitcnt lgkmcnt(0)
s_add_u32 s88, s88, s89
s_add_u32 s88, s88, s90
s_add_u32 s88, s88, s91
s_cmp_eq_u32 s88, 3
s_cbranch_scc1 L_w0_poll6_ret
s_sub_u32 s47, s47, 1
s_cmp_lg_u32 s47, 0
s_cbranch_scc1 L_w0_poll6_s
s_mov_b32 s47, 65536
L_w0_poll6_loop:
buffer_load_dword v19, v18, s[20:23], 0 offen offset:768 sc1
s_waitcnt vmcnt(0)
v_cmp_le_u32 vcc, 1, v19
s_nop 1
s_bcnt1_i32_b64 s88, vcc
s_cmp_eq_u32 s88, 3
s_cbranch_scc1 L_w0_poll6_ret
s_sub_u32 s47, s47, 1
s_cmp_lg_u32 s47, 0
s_cbranch_scc1 L_w0_poll6_loop
s_branch L_w0_poll6_ret
L_w0_own0:
ds_write_b128 v2, v[48:51]
ds_write_b128 v2, v[52:55] offset:5120
ds_write_b128 v2, v[144:147] offset:1024
ds_write_b128 v2, v[148:151] offset:6144
ds_write_b128 v2, v[160:163] offset:2048
ds_write_b128 v2, v[164:167] offset:7168
ds_write_b128 v2, v[192:195] offset:3072
ds_write_b128 v2, v[196:199] offset:8192
ds_write_b128 v2, v[224:227] offset:4096
ds_write_b128 v2, v[228:231] offset:9216
s_branch L_w0_own_ret
L_w0_own1:
ds_write_b128 v3, v[56:59]
ds_write_b128 v3, v[60:63] offset:5120
ds_write_b128 v3, v[152:155] offset:1024
ds_write_b128 v3, v[156:159] offset:6144
ds_write_b128 v3, v[168:171] offset:2048
ds_write_b128 v3, v[172:175] offset:7168
ds_write_b128 v3, v[200:203] offset:3072
ds_write_b128 v3, v[204:207] offset:8192
ds_write_b128 v3, v[232:235] offset:4096
ds_write_b128 v3, v[236:239] offset:9216
s_branch L_w0_own_ret
L_w0_rp0:
s_mov_b32 s47, 4096
L_w0_rp0_s:
s_buffer_load_dwordx8 s[88:95], s[20:23], s87 offset:384 glc
s_waitcnt lgkmcnt(0)
s_add_u32 s88, s88, s89
s_add_u32 s88, s88, s90
s_add_u32 s88, s88, s91
s_add_u32 s88, s88, s92
s_add_u32 s88, s88, s93
s_add_u32 s88, s88, s94
s_add_u32 s88, s88, s95
s_cmp_eq_u32 s88, 8
s_cbranch_scc1 L_w0_rp0_ret
s_sub_u32 s47, s47, 1
s_cmp_lg_u32 s47, 0
s_cbranch_scc1 L_w0_rp0_s
s_mov_b32 s47, 65536
L_w0_rp0_loop:
buffer_load_dword v19, v18, s[20:23], 0 offen offset:384 sc1
s_waitcnt vmcnt(0)
v_cmp_le_u32 vcc, 1, v19
s_nop 1
s_bcnt1_i32_b64 s88, vcc
s_cmp_eq_u32 s88, 8
s_cbranch_scc1 L_w0_rp0_ret
s_sub_u32 s47, s47, 1
s_cmp_lg_u32 s47, 0
s_cbranch_scc1 L_w0_rp0_loop
s_branch L_w0_rp0_ret
L_w0_rp1:
s_mov_b32 s47, 4096
L_w0_rp1_s:
s_buffer_load_dwordx8 s[88:95], s[20:23], s87 offset:512 glc
s_waitcnt lgkmcnt(0)
s_add_u32 s88, s88, s89
s_add_u32 s88, s88, s90
s_add_u32 s88, s88, s91
s_add_u32 s88, s88, s92
s_add_u32 s88, s88, s93
s_add_u32 s88, s88, s94
s_add_u32 s88, s88, s95
s_cmp_eq_u32 s88, 8
s_cbranch_scc1 L_w0_rp1_ret
s_sub_u32 s47, s47, 1
s_cmp_lg_u32 s47, 0
s_cbranch_scc1 L_w0_rp1_s
s_mov_b32 s47, 65536
L_w0_rp1_loop:
buffer_load_dword v19, v18, s[20:23], 0 offen offset:512 sc1
s_waitcnt vmcnt(0)
v_cmp_le_u32 vcc, 1, v19
s_nop 1
s_bcnt1_i32_b64 s88, vcc
s_cmp_eq_u32 s88, 8
s_cbranch_scc1 L_w0_rp1_ret
s_sub_u32 s47, s47, 1
s_cmp_lg_u32 s47, 0
s_cbranch_scc1 L_w0_rp1_loop
s_branch L_w0_rp1_ret
L_w0_rp2:
s_mov_b32 s47, 4096
L_w0_rp2_s:
s_buffer_load_dwordx8 s[88:95], s[20:23], s87 offset:640 glc
s_waitcnt lgkmcnt(0)
s_add_u32 s88, s88, s89
s_add_u32 s88, s88, s90
s_add_u32 s88, s88, s91
s_add_u32 s88, s88, s92
s_add_u32 s88, s88, s93
s_add_u32 s88, s88, s94
s_add_u32 s88, s88, s95
s_cmp_eq_u32 s88, 8
s_cbranch_scc1 L_w0_rp2_ret
s_sub_u32 s47, s47, 1
s_cmp_lg_u32 s47, 0
s_cbranch_scc1 L_w0_rp2_s
s_mov_b32 s47, 65536
L_w0_rp2_loop:
buffer_load_dword v19, v18, s[20:23], 0 offen offset:640 sc1
s_waitcnt vmcnt(0)
v_cmp_le_u32 vcc, 1, v19
s_nop 1
s_bcnt1_i32_b64 s88, vcc
s_cmp_eq_u32 s88, 8
s_cbranch_scc1 L_w0_rp2_ret
s_sub_u32 s47, s47, 1
s_cmp_lg_u32 s47, 0
s_cbranch_scc1 L_w0_rp2_loop
s_branch L_w0_rp2_ret
L_w3b:
s_waitcnt vmcnt(3)
s_barrier
ldq a[112:115],v52 offset:36864
ldt a[0:1],v54
ldq a[116:119],v52 offset:38912
ldt a[2:3],v54 offset:6144
ldq a[120:123],v52 offset:40960
ldt a[4:5],v54 offset:8
ldq a[128:131],v53 offset:36864
ldt a[6:7],v54 offset:6152
ldq a[132:135],v53 offset:38912
ldt a[8:9],v55
ldq a[136:139],v53 offset:40960
ldt a[10:11],v55 offset:6144
s_waitcnt lgkmcnt(8)
mma v[64:67],a[0:3],a[112:115],0
ldt a[12:13],v55 offset:8
ldt a[14:15],v55 offset:6152
s_add_u32 m0, s30, 24576
s_add_u32 s31, s29, 786432
bld v48,s[16:19],s31 offen lds
mma v[160:163],a[0:3],a[116:119],0
s_waitcnt lgkmcnt(9)
ldt a[16:17],v54 offset:128
ldt a[18:19],v54 offset:6272
mma v[112:115],a[0:3],a[120:123],0
s_waitcnt lgkmcnt(8)
ldt a[20:21],v54 offset:136
ldt a[22:23],v54 offset:6280
bld v49,s[16:19],s31 offen offset:1024 lds
mma v[116:119],a[4:7],a[120:123],0
ldt a[24:25],v55 offset:128
ldt a[26:27],v55 offset:6272
mma v[164:167],a[4:7],a[116:119],0
ldt a[28:29],v55 offset:136
ldt a[30:31],v55 offset:6280
mma v[68:71],a[4:7],a[112:115],0
s_waitcnt lgkmcnt(10)
ldt a[32:33],v54 offset:256
ldt a[34:35],v54 offset:6400
bld v50,s[16:19],s31 offen offset:2048 lds
mma v[72:75],a[8:11],a[112:115],0
ldt a[36:37],v54 offset:264
ldt a[38:39],v54 offset:6408
mma v[168:171],a[8:11],a[116:119],0
ldt a[40:41],v55 offset:256
ldt a[42:43],v55 offset:6400
mma v[120:123],a[8:11],a[120:123],0
s_add_u32 m0, s30, 36864
s_waitcnt lgkmcnt(14)
ldt a[44:45],v55 offset:264
ldt a[46:47],v55 offset:6408
mma v[124:127],a[12:15],a[120:123],0
s_add_u32 s31, s29, 1179648
bld v48,s[16:19],s31 offen lds
mma v[172:175],a[12:15],a[116:119],0
bld v49,s[16:19],s31 offen offset:1024 lds
mma v[76:79],a[12:15],a[112:115],0
s_waitcnt lgkmcnt(14)
mma v[80:83],a[16:19],a[112:115],0
bld v50,s[16:19],s31 offen offset:2048 lds
mma v[176:179],a[16:19],a[116:119],0
mma v[128:131],a[16:19],a[120:123],0
s_waitcnt vmcnt(6)
s_barrier
s_waitcnt lgkmcnt(12)
mma v[132:135],a[20:23],a[120:123],0
ldt a[48:49],v54 offset:12288
ldt a[50:51],v54 offset:18432
s_add_u32 m0, s27, 0
s_add_u32 s31, s28, 128
bld v51,s[4:7],s31 offen lds
mma v[180:183],a[20:23],a[116:119],0
ldt a[52:53],v54 offset:12296
ldt a[54:55],v54 offset:18440
mma v[84:87],a[20:23],a[112:115],0
ldt a[56:57],v55 offset:12288
ldt a[58:59],v55 offset:18432
s_add_u32 s31, s28, 9344
s_waitcnt lgkmcnt(14)
bld v51,s[4:7],s31 offen offset:1024 lds
mma v[88:91],a[24:27],a[112:115],0
ldt a[60:61],v55 offset:12296
ldt a[62:63],v55 offset:18440
mma v[184:187],a[24:27],a[116:119],0
ldt a[64:65],v54 offset:12416
ldt a[66:67],v54 offset:18560
mma v[136:139],a[24:27],a[120:123],0
ldt a[68:69],v54 offset:12424
ldt a[70:71],v54 offset:18568
s_add_u32 m0, s27, 2048
s_add_u32 s31, s28, 20608
bld v51,s[4:7],s31 offen lds
mma v[140:143],a[28:31],a[120:123],0
ldt a[72:73],v55 offset:12416
ldt a[74:75],v55 offset:18560
mma v[188:191],a[28:31],a[116:119],0
ldt a[76:77],v55 offset:12424
ldt a[78:79],v55 offset:18568
s_add_u32 s31, s28, 29824
bld v51,s[4:7],s31 offen offset:1024 lds
mma v[92:95],a[28:31],a[112:115],0
s_waitcnt lgkmcnt(14)
ldt a[80:81],v54 offset:12544
ldt a[82:83],v54 offset:18688
mma v[96:99],a[32:35],a[112:115],0
ldt a[84:85],v54 offset:12552
ldt a[86:87],v54 offset:18696
mma v[192:195],a[32:35],a[116:119],0
ldt a[88:89],v55 offset:12544
ldt a[90:91],v55 offset:18688
mma v[144:147],a[32:35],a[120:123],0
s_add_u32 m0, s27, 4096
ldt a[92:93],v55 offset:12552
ldt a[94:95],v55 offset:18696
mma v[148:151],a[36:39],a[120:123],0
s_add_u32 s31, s28, 41088
bld v51,s[4:7],s31 offen lds
mma v[196:199],a[36:39],a[116:119],0
s_add_u32 s31, s28, 50304
bld v51,s[4:7],s31 offen offset:1024 lds
mma v[100:103],a[36:39],a[112:115],0
mma v[104:107],a[40:43],a[112:115],0
mma v[200:203],a[40:43],a[116:119],0
mma v[152:155],a[40:43],a[120:123],0
mma v[156:159],a[44:47],a[120:123],0
mma v[204:207],a[44:47],a[116:119],0
mma v[108:111],a[44:47],a[112:115],0
mma v[64:67],a[48:51],a[128:131],v[64:67]
mma v[160:163],a[48:51],a[132:135],v[160:163]
mma v[112:115],a[48:51],a[136:139],v[112:115]
s_waitcnt lgkmcnt(14)
mma v[116:119],a[52:55],a[136:139],v[116:119]
mma v[164:167],a[52:55],a[132:135],v[164:167]
mma v[68:71],a[52:55],a[128:131],v[68:71]
mma v[72:75],a[56:59],a[128:131],v[72:75]
mma v[168:171],a[56:59],a[132:135],v[168:171]
mma v[120:123],a[56:59],a[136:139],v[120:123]
mma v[124:127],a[60:63],a[136:139],v[124:127]
mma v[172:175],a[60:63],a[132:135],v[172:175]
s_waitcnt vmcnt(6) lgkmcnt(0)
s_barrier
mma v[76:79],a[60:63],a[128:131],v[76:79]
s_mov_b32 s20, s78
ldt a[96:97],v54 offset:24576
s_mov_b32 s21, s79
s_mov_b32 s22, 50331648
s_mov_b32 s23, 131072
s_mov_b32 s52, s76
s_mov_b32 s53, s77
s_mov_b32 s54, 256
s_mov_b32 s55, 131072
s_lshl_b32 s87, s2, 2
s_add_u32 s87, s87, s24
s_lshl_b32 s87, s87, 11
s_add_u32 s87, s87, 48234496
v_lshlrev_b32 v21, 4, v1
v_mov_b32 v61, 2147483632
mma v[80:83],a[64:67],a[128:131],v[80:83]
ldt a[98:99],v54 offset:30720
v_mov_b32 v32, 0
v_mov_b32 v33, 0
mma v[176:179],a[64:67],a[132:135],v[176:179]
ldt a[100:101],v54 offset:36864
v_mov_b32 v34, 0
v_mov_b32 v35, 0
mma v[128:131],a[64:67],a[136:139],v[128:131]
s_lshl_b32 s3, s25, 5
ldt a[102:103],v54 offset:43008
v_mov_b32 v60, s3
v_cmp_eq_u32 vcc, 0, v1
mma v[132:135],a[68:71],a[136:139],v[132:135]
ldt a[104:105],v54 offset:24584
v_mov_b32 v47, 1
v_xor_b32 v3, 64, v2
mma v[180:183],a[68:71],a[132:135],v[180:183]
ldt a[106:107],v54 offset:30728
v_cndmask_b32 v20, v61, v60, vcc
v_xor_b32 v5, 32, v4
mma v[84:87],a[68:71],a[128:131],v[84:87]
ldt a[108:109],v54 offset:36872
v_xor_b32 v6, 64, v4
v_xor_b32 v7, 96, v4
mma v[88:91],a[72:75],a[128:131],v[88:91]
ldt a[110:111],v54 offset:43016
v_lshrrev_b32 v60, 2, v1
v_and_b32 v61, 3, v1
mma v[184:187],a[72:75],a[132:135],v[184:187]
ldt a[0:1],v55 offset:24576
v_lshlrev_b32 v61, 3, v61
v_mul_u32_u24 v62, 320, v60
mma v[136:139],a[72:75],a[136:139],v[136:139]
ldt a[2:3],v55 offset:30720
v_and_b32 v63, 4, v60
v_lshlrev_b32 v63, 3, v63
mma v[140:143],a[76:79],a[136:139],v[140:143]
s_add_u32 m0, s30, 0
s_add_u32 s31, s29, 1572864
bld v48,s[16:19],s31 offen lds
ldt a[4:5],v55 offset:36864
mma v[188:191],a[76:79],a[132:135],v[188:191]
ldt a[6:7],v55 offset:43008
v_add3_u32 v15, v61, v62, v63
v_xor_b32 v16, 32, v15
mma v[92:95],a[76:79],a[128:131],v[92:95]
v_add_u32 v60, 0, v1
v_mul_u32_u24 v61, 3277, v60
v_lshrrev_b32 v61, 16, v61
mma v[96:99],a[80:83],a[128:131],v[96:99]
ldt a[8:9],v55 offset:24584
v_and_b32 v62, 4, v61
v_lshrrev_b32 v62, 1, v62
mma v[192:195],a[80:83],a[132:135],v[192:195]
bld v49,s[16:19],s31 offen offset:1024 lds
ldt a[10:11],v55 offset:30728
mma v[144:147],a[80:83],a[136:139],v[144:147]
s_waitcnt vmcnt(2)
ldq a[144:147],v52
v_xor_b32 v60, v1, v62
v_lshlrev_b32 v60, 4, v60
mma v[148:151],a[84:87],a[136:139],v[148:151]
ldq a[148:151],v52 offset:2048
v_mul_u32_u24 v61, 960, v61
v_add_u32 v236, v60, v61
mma v[196:199],a[84:87],a[132:135],v[196:199]
ldq a[152:155],v52 offset:4096
v_add_u32 v60, 64, v1
v_mul_u32_u24 v61, 3277, v60
mma v[100:103],a[84:87],a[128:131],v[100:103]
ldq a[160:163],v53
bld v50,s[16:19],s31 offen offset:2048 lds
mma v[104:107],a[88:91],a[128:131],v[104:107]
ldq a[164:167],v53 offset:2048
v_lshrrev_b32 v61, 16, v61
v_and_b32 v62, 4, v61
mma v[200:203],a[88:91],a[132:135],v[200:203]
ldq a[168:171],v53 offset:4096
v_lshrrev_b32 v62, 1, v62
v_xor_b32 v60, v1, v62
mma v[152:155],a[88:91],a[136:139],v[152:155]
ldt a[12:13],v55 offset:36872
v_lshlrev_b32 v60, 4, v60
v_mul_u32_u24 v61, 960, v61
mma v[156:159],a[92:95],a[136:139],v[156:159]
s_add_u32 m0, s30, 12288
ldt a[14:15],v55 offset:43016
v_add_u32 v237, v60, v61
v_add_u32 v60, 128, v1
mma v[204:207],a[92:95],a[132:135],v[204:207]
s_add_u32 s31, s29, 1966080
bld v48,s[16:19],s31 offen lds
ldt a[16:17],v54 offset:24704
mma v[108:111],a[92:95],a[128:131],v[108:111]
s_waitcnt lgkmcnt(8)
ldt a[18:19],v54 offset:30848
v_mul_u32_u24 v61, 3277, v60
v_lshrrev_b32 v61, 16, v61
mma v[64:67],a[96:99],a[144:147],v[64:67]
s_waitcnt lgkmcnt(6)
ldt a[20:21],v54 offset:36992
v_and_b32 v62, 4, v61
v_lshrrev_b32 v62, 1, v62
mma v[64:67],a[100:103],a[160:163],v[64:67]
s_waitcnt lgkmcnt(6)
ldt a[22:23],v54 offset:43136
v_xor_b32 v60, v1, v62
v_lshlrev_b32 v60, 4, v60
mma v[160:163],a[100:103],a[164:167],v[160:163]
bld v49,s[16:19],s31 offen offset:1024 lds
ldt a[24:25],v54 offset:24712
mma v[160:163],a[96:99],a[148:151],v[160:163]
ldt a[26:27],v54 offset:30856
v_mul_u32_u24 v61, 960, v61
v_add_u32 v238, v60, v61
mma v[112:115],a[96:99],a[152:155],v[112:115]
s_waitcnt lgkmcnt(8)
ldt a[28:29],v54 offset:37000
v_add_u32 v60, 192, v1
v_mul_u32_u24 v61, 3277, v60
mma v[112:115],a[100:103],a[168:171],v[112:115]
ldt a[30:31],v54 offset:43144
v_lshrrev_b32 v61, 16, v61
v_and_b32 v62, 4, v61
mma v[116:119],a[104:107],a[152:155],v[116:119]
bld v50,s[16:19],s31 offen offset:2048 lds
ldt a[32:33],v55 offset:24704
mma v[116:119],a[108:111],a[168:171],v[116:119]
ldt a[34:35],v55 offset:30848
v_lshrrev_b32 v62, 1, v62
v_xor_b32 v60, v1, v62
mma v[164:167],a[108:111],a[164:167],v[164:167]
ldt a[36:37],v55 offset:36992
v_lshlrev_b32 v60, 4, v60
v_mul_u32_u24 v61, 960, v61
mma v[164:167],a[104:107],a[148:151],v[164:167]
ldt a[38:39],v55 offset:43136
v_add_u32 v239, v60, v61
v_add_u32 v60, 256, v1
mma v[68:71],a[104:107],a[144:147],v[68:71]
ldt a[40:41],v55 offset:24712
v_mul_u32_u24 v61, 3277, v60
v_lshrrev_b32 v61, 16, v61
mma v[68:71],a[108:111],a[160:163],v[68:71]
ldt a[42:43],v55 offset:30856
v_and_b32 v62, 4, v61
v_lshrrev_b32 v62, 1, v62
mma v[72:75],a[0:3],a[144:147],v[72:75]
ldt a[44:45],v55 offset:37000
v_xor_b32 v60, v60, v62
v_lshlrev_b32 v60, 4, v60
mma v[72:75],a[4:7],a[160:163],v[72:75]
ldt a[46:47],v55 offset:43144
v_mul_u32_u24 v61, 960, v61
v_add_u32 v44, v60, v61
mma v[168:171],a[4:7],a[164:167],v[168:171]
s_add_u32 m0, s27, 36864
s_add_u32 s31, s28, 256
bld v51,s[4:7],s31 offen lds
ldt a[48:49],v54 offset:24832
mma v[168:171],a[0:3],a[148:151],v[168:171]
ldt a[50:51],v54 offset:30976
v_mov_b32 v61, 2147483632
v_lshl_add_u32 v60, v1, 2, s87
mma v[120:123],a[0:3],a[152:155],v[120:123]
ldt a[52:53],v54 offset:37120
v_cmp_gt_u32 vcc, 8, v1
v_add_u32 v62, 1, v1
mma v[120:123],a[4:7],a[168:171],v[120:123]
s_add_u32 s31, s28, 9472
bld v51,s[4:7],s31 offen offset:1024 lds
ldt a[54:55],v54 offset:43264
mma v[124:127],a[8:11],a[152:155],v[124:127]
s_waitcnt lgkmcnt(14)
ldt a[56:57],v54 offset:24840
v_lshlrev_b32 v62, 6, v62
v_cndmask_b32 v18, v61, v60, vcc
mma v[124:127],a[12:15],a[168:171],v[124:127]
s_add_u32 m0, s27, 38912
ldt a[58:59],v54 offset:30984
v_add_u32 v60, s2, v62
v_and_b32 v60, 255, v60
mma v[172:175],a[12:15],a[164:167],v[172:175]
s_add_u32 s31, s28, 20736
bld v51,s[4:7],s31 offen lds
ldt a[60:61],v54 offset:37128
mma v[172:175],a[8:11],a[148:151],v[172:175]
s_lshl_b32 s3, s24, 11
ldt a[62:63],v54 offset:43272
v_lshlrev_b32 v60, 13, v60
s_add_u32 s3, s3, 48234496
s_and_b32 s47, s26, 3
s_mul_i32 s33, s47, 320
s_lshl_b32 s47, s47, 2
s_add_u32 s3, s3, s47
v_cmp_gt_u32 vcc, 3, v1
mma v[76:79],a[8:11],a[144:147],v[76:79]
ldt a[64:65],v55 offset:24832
v_add_u32 v60, s3, v60
v_cndmask_b32 v17, v61, v60, vcc
mma v[76:79],a[12:15],a[160:163],v[76:79]
s_mul_i32 s47, s24, 24576
ldt a[66:67],v55 offset:30976
s_mul_i32 s41, s2, 92160
s_add_u32 s41, s41, s47
s_mul_i32 s59, s26, 245760
s_add_u32 s59, s59, s33
s_add_u32 s3, s2, 64
s_and_b32 s3, s3, 255
s_mul_i32 s56, s3, 92160
s_add_u32 s56, s56, s47
s_lshr_b32 s3, s3, 6
s_and_b32 s60, s26, 28
s_add_u32 s3, s3, s60
s_mul_i32 s60, s3, 245760
s_add_u32 s60, s60, s33
s_add_u32 s3, s2, 128
s_and_b32 s3, s3, 255
s_mul_i32 s57, s3, 92160
s_add_u32 s57, s57, s47
s_lshr_b32 s3, s3, 6
s_and_b32 s61, s26, 28
s_add_u32 s3, s3, s61
s_mul_i32 s61, s3, 245760
s_add_u32 s61, s61, s33
s_add_u32 s3, s2, 192
s_and_b32 s3, s3, 255
s_mul_i32 s58, s3, 92160
s_add_u32 s58, s58, s47
s_lshr_b32 s3, s3, 6
s_and_b32 s62, s26, 28
s_add_u32 s3, s3, s62
s_mul_i32 s62, s3, 245760
s_add_u32 s62, s62, s33
s_lshl_b32 s3, s25, 2
s_and_b32 s47, s26, 3
s_add_u32 s3, s3, s47
s_mul_i32 s3, s3, 614400
s_add_u32 s3, s3, 25165824
s_lshr_b32 s47, s26, 2
s_mul_i32 s46, s47, 76800
s_add_u32 s46, s46, s3
s_mul_i32 s47, s24, 20480
s_add_u32 s46, s46, s47
s_and_b32 s47, s26, 28
s_add_u32 s47, s47, s24
s_lshr_b32 s96, s47, 1
s_mul_i32 s96, s96, 5120
s_add_u32 s96, s96, s3
s_and_b32 s3, s47, 1
s_lshl_b32 s3, s3, 9
s_add_u32 s96, s96, s3
s_mul_i32 s97, s25, 30
s_add_u32 s97, s97, s47
s_mul_i32 s97, s97, 10240
s_add_u32 s97, s97, s33
s_cmp_ge_u32 s47, 30
s_cselect_b32 s97, -1, s97
s_mov_b32 s32, 0x3dd53b95
s_mov_b32 s34, 0x47800000
s_mov_b32 s63, 0
s_mov_b32 s37, 0
s_mov_b32 s36, 0
v_mov_b32 v28, 0
v_mov_b32 v29, 0
mma v[80:83],a[16:19],a[144:147],v[80:83]
s_add_u32 s31, s28, 29952
bld v51,s[4:7],s31 offen offset:1024 lds
ldt a[68:69],v55 offset:37120
mma v[80:83],a[20:23],a[160:163],v[80:83]
s_and_b32 s92, s2, 248
ldt a[70:71],v55 offset:43264
v_mov_b32 v30, 0
s_lshl_b32 s92, s92, 2
s_lshl_b32 s93, s24, 3
s_add_u32 s92, s92, s93
s_lshl_b32 s92, s92, 11
s_and_b32 s94, s26, 28
s_add_u32 s92, s92, s94
s_add_u32 s92, s92, 48234880
s_sub_u32 s93, 30, s93
s_mov_b32 s94, 9600
v_and_b32 v60, 7, v1
mma v[176:179],a[20:23],a[164:167],v[176:179]
s_add_u32 m0, s27, 40960
ldt a[72:73],v55 offset:24840
v_lshrrev_b32 v62, 3, v1
v_lshlrev_b32 v63, 11, v60
mma v[176:179],a[16:19],a[148:151],v[176:179]
s_add_u32 s31, s28, 41216
bld v51,s[4:7],s31 offen lds
ldt a[74:75],v55 offset:30984
mma v[128:131],a[16:19],a[152:155],v[128:131]
ldt a[76:77],v55 offset:37128
v_lshl_add_u32 v63, v62, 7, v63
v_add_u32 v63, s92, v63
mma v[128:131],a[20:23],a[168:171],v[128:131]
ldt a[78:79],v55 offset:43272
v_mov_b32 v61, 2147483632
v_cmp_gt_u32 vcc, s93, v60
mma v[132:135],a[24:27],a[152:155],v[132:135]
s_add_u32 s31, s28, 50432
s_waitcnt lgkmcnt(14)
bld v51,s[4:7],s31 offen offset:1024 lds
v_lshlrev_b32 v62, 4, v60
mma v[132:135],a[28:31],a[168:171],v[132:135]
v_mul_u32_u24 v60, 1280, v60
v_cndmask_b32 v63, v61, v63, vcc
v_cmp_gt_u32 vcc, 8, v1
mma v[180:183],a[28:31],a[164:167],v[180:183]
v_and_b32 v14, 48, v1
v_lshl_add_u32 v62, v14, 3, v62
v_cndmask_b32 v11, v61, v63, vcc
mma v[180:183],a[24:27],a[148:151],v[180:183]
v_add_u32 v14, v14, v60
v_and_b32 v60, 8, v1
v_cmp_eq_u32 vcc, 0, v60
mma v[84:87],a[24:27],a[144:147],v[84:87]
v_lshl_add_u32 v12, v60, 6, v62
v_mad_u32_u24 v13, v60, s94, v62
v_cndmask_b32 v14, v61, v14, vcc
mma v[84:87],a[28:31],a[160:163],v[84:87]
v_add_u32 v60, 73728, v2
v_add_u32 v61, 73728, v3
mma v[88:91],a[32:35],a[144:147],v[88:91]
s_waitcnt vmcnt(6) lgkmcnt(0)
s_barrier
mma v[88:91],a[36:39],a[160:163],v[88:91]
s_mov_b32 s31, 3133440
buffer_load_dword v45, v58, s[16:19], s31 offen
ldt a[80:81],v54
mma v[184:187],a[36:39],a[164:167],v[184:187]
s_mov_b32 s31, 512
buffer_load_dword v45, v59, s[4:7], s31 offen
ldt a[82:83],v54 offset:6144
mma v[184:187],a[32:35],a[148:151],v[184:187]
s_mov_b32 s31, 0
buffer_load_dword v45, v31, s[48:51], s31 offen
ldt a[84:85],v54 offset:12288
mma v[136:139],a[32:35],a[152:155],v[136:139]
s_mov_b32 m0, 73728
s_mov_b32 s31, 0
bld v8,s[8:11],s31 offen nt lds
ldt a[86:87],v54 offset:18432
mma v[136:139],a[36:39],a[168:171],v[136:139]
bld v9,s[8:11],s31 offen offset:1024 nt lds
mma v[140:143],a[40:43],a[152:155],v[140:143]
bld v10,s[8:11],s31 offen offset:2048 nt lds
ldt a[88:89],v54 offset:8
mma v[140:143],a[44:47],a[168:171],v[140:143]
s_mov_b32 m0, 76800
s_mov_b32 s31, 33792
bld v8,s[8:11],s31 offen nt lds
ldt a[90:91],v54 offset:6152
mma v[188:191],a[44:47],a[164:167],v[188:191]
bld v9,s[8:11],s31 offen offset:1024 nt lds
ldt a[92:93],v54 offset:12296
mma v[188:191],a[40:43],a[148:151],v[188:191]
bld v10,s[8:11],s31 offen offset:2048 nt lds
ldt a[94:95],v54 offset:18440
mma v[92:95],a[40:43],a[144:147],v[92:95]
s_mov_b32 m0, 0
s_mov_b32 s31, 3072
bld v8,s[8:11],s31 offen nt lds
mma v[92:95],a[44:47],a[160:163],v[92:95]
bld v9,s[8:11],s31 offen offset:1024 nt lds
ldt a[96:97],v55
mma v[96:99],a[48:51],a[144:147],v[96:99]
bld v10,s[8:11],s31 offen offset:2048 nt lds
ldt a[98:99],v55 offset:6144
mma v[96:99],a[52:55],a[160:163],v[96:99]
s_add_u32 m0, s30, 24576
s_add_u32 s31, s29, 2359296
bld v48,s[16:19],s31 offen lds
ldt a[100:101],v55 offset:12288
mma v[192:195],a[52:55],a[164:167],v[192:195]
ldt a[102:103],v55 offset:18432
mma v[192:195],a[48:51],a[148:151],v[192:195]
mma v[144:147],a[48:51],a[152:155],v[144:147]
ldt a[104:105],v55 offset:8
mma v[144:147],a[52:55],a[168:171],v[144:147]
ldt a[106:107],v55 offset:6152
mma v[148:151],a[56:59],a[152:155],v[148:151]
bld v49,s[16:19],s31 offen offset:1024 lds
mma v[148:151],a[60:63],a[168:171],v[148:151]
ldt a[108:109],v55 offset:12296
mma v[196:199],a[60:63],a[164:167],v[196:199]
ldt a[110:111],v55 offset:18440
mma v[196:199],a[56:59],a[148:151],v[196:199]
ldt a[0:1],v54 offset:128
mma v[100:103],a[56:59],a[144:147],v[100:103]
ldt a[2:3],v54 offset:6272
mma v[100:103],a[60:63],a[160:163],v[100:103]
mma v[104:107],a[64:67],a[144:147],v[104:107]
bld v50,s[16:19],s31 offen offset:2048 lds
ldt a[4:5],v54 offset:12416
mma v[104:107],a[68:71],a[160:163],v[104:107]
ldt a[6:7],v54 offset:18560
mma v[200:203],a[68:71],a[164:167],v[200:203]
s_waitcnt vmcnt(15)
ldq a[112:115],v52 offset:36864
mma v[200:203],a[64:67],a[148:151],v[200:203]
ldq a[116:119],v52 offset:38912
mma v[152:155],a[64:67],a[152:155],v[152:155]
ldq a[120:123],v52 offset:40960
mma v[152:155],a[68:71],a[168:171],v[152:155]
s_add_u32 m0, s30, 36864
ldq a[128:131],v53 offset:36864
mma v[156:159],a[72:75],a[152:155],v[156:159]
s_add_u32 s31, s29, 2752512
ldq a[132:135],v53 offset:38912
bld v48,s[16:19],s31 offen lds
mma v[156:159],a[76:79],a[168:171],v[156:159]
ldq a[136:139],v53 offset:40960
mma v[204:207],a[76:79],a[164:167],v[204:207]
ldt a[8:9],v54 offset:136
mma v[204:207],a[72:75],a[148:151],v[204:207]
ldt a[10:11],v54 offset:6280
mma v[108:111],a[72:75],a[144:147],v[108:111]
ldt a[12:13],v54 offset:12424
mma v[108:111],a[76:79],a[160:163],v[108:111]
s_waitcnt lgkmcnt(8)
bld v49,s[16:19],s31 offen offset:1024 lds
ldt a[14:15],v54 offset:18568
mma v[64:67],a[80:83],a[112:115],v[64:67]
s_waitcnt lgkmcnt(6)
ldt a[16:17],v55 offset:128
mma v[64:67],a[84:87],a[128:131],v[64:67]
s_waitcnt lgkmcnt(6)
ldt a[18:19],v55 offset:6272
mma v[160:163],a[84:87],a[132:135],v[160:163]
ldt a[20:21],v55 offset:12416
mma v[160:163],a[80:83],a[116:119],v[160:163]
ldt a[22:23],v55 offset:18560
mma v[112:115],a[80:83],a[120:123],v[112:115]
s_waitcnt lgkmcnt(8)
ldt a[24:25],v55 offset:136
mma v[112:115],a[84:87],a[136:139],v[112:115]
bld v50,s[16:19],s31 offen offset:2048 lds
ldt a[26:27],v55 offset:6280
mma v[116:119],a[88:91],a[120:123],v[116:119]
ldt a[28:29],v55 offset:12424
mma v[116:119],a[92:95],a[136:139],v[116:119]
ldt a[30:31],v55 offset:18568
mma v[164:167],a[92:95],a[132:135],v[164:167]
ldt a[32:33],v54 offset:256
mma v[164:167],a[88:91],a[116:119],v[164:167]
ldt a[34:35],v54 offset:6400
mma v[68:71],a[88:91],a[112:115],v[68:71]
ldt a[36:37],v54 offset:12544
mma v[68:71],a[92:95],a[128:131],v[68:71]
ldt a[38:39],v54 offset:18688
mma v[72:75],a[96:99],a[112:115],v[72:75]
ldt a[40:41],v54 offset:264
mma v[72:75],a[100:103],a[128:131],v[72:75]
ldt a[42:43],v54 offset:6408
mma v[168:171],a[100:103],a[132:135],v[168:171]
s_add_u32 m0, s27, 36864
s_add_u32 s31, s28, 384
bld v51,s[4:7],s31 offen lds
ldt a[44:45],v54 offset:12552
mma v[168:171],a[96:99],a[116:119],v[168:171]
ldt a[46:47],v54 offset:18696
mma v[120:123],a[96:99],a[120:123],v[120:123]
ldt a[48:49],v55 offset:256
mma v[120:123],a[100:103],a[136:139],v[120:123]
s_add_u32 s31, s28, 9600
bld v51,s[4:7],s31 offen offset:1024 lds
ldt a[50:51],v55 offset:6400
mma v[124:127],a[104:107],a[120:123],v[124:127]
mma v[124:127],a[108:111],a[136:139],v[124:127]
s_add_u32 m0, s27, 38912
ldt a[52:53],v55 offset:12544
mma v[172:175],a[108:111],a[132:135],v[172:175]
s_add_u32 s31, s28, 20864
bld v51,s[4:7],s31 offen lds
ldt a[54:55],v55 offset:18688
mma v[172:175],a[104:107],a[116:119],v[172:175]
ldt a[56:57],v55 offset:264
mma v[76:79],a[104:107],a[112:115],v[76:79]
ldt a[58:59],v55 offset:6408
mma v[76:79],a[108:111],a[128:131],v[76:79]
mma v[80:83],a[0:3],a[112:115],v[80:83]
s_add_u32 s31, s28, 30080
bld v51,s[4:7],s31 offen offset:1024 lds
ldt a[60:61],v55 offset:12552
mma v[80:83],a[4:7],a[128:131],v[80:83]
ldt a[62:63],v55 offset:18696
mma v[176:179],a[4:7],a[132:135],v[176:179]
s_add_u32 m0, s27, 40960
mma v[176:179],a[0:3],a[116:119],v[176:179]
s_add_u32 s31, s28, 41344
bld v51,s[4:7],s31 offen lds
mma v[128:131],a[0:3],a[120:123],v[128:131]
mma v[128:131],a[4:7],a[136:139],v[128:131]
s_waitcnt lgkmcnt(14)
mma v[132:135],a[8:11],a[120:123],v[132:135]
s_add_u32 s31, s28, 50560
bld v51,s[4:7],s31 offen offset:1024 lds
mma v[132:135],a[12:15],a[136:139],v[132:135]
mma v[180:183],a[12:15],a[132:135],v[180:183]
mma v[180:183],a[8:11],a[116:119],v[180:183]
mma v[84:87],a[8:11],a[112:115],v[84:87]
mma v[84:87],a[12:15],a[128:131],v[84:87]
mma v[88:91],a[16:19],a[112:115],v[88:91]
s_waitcnt vmcnt(6) lgkmcnt(0)
s_barrier
mma v[88:91],a[20:23],a[128:131],v[88:91]
s_mov_b32 s31, 3919872
buffer_load_dword v45, v58, s[16:19], s31 offen
ldt a[64:65],v54 offset:24576
mma v[184:187],a[20:23],a[132:135],v[184:187]
s_mov_b32 s31, 640
buffer_load_dword v45, v59, s[4:7], s31 offen
ldt a[66:67],v54 offset:30720
mma v[184:187],a[16:19],a[116:119],v[184:187]
s_mov_b32 s31, 3840
buffer_load_dword v45, v31, s[48:51], s31 offen
ldt a[68:69],v54 offset:36864
mma v[136:139],a[16:19],a[120:123],v[136:139]
s_mov_b32 m0, 3072
s_mov_b32 s31, 36864
bld v8,s[8:11],s31 offen nt lds
ldt a[70:71],v54 offset:43008
mma v[136:139],a[20:23],a[136:139],v[136:139]
bld v9,s[8:11],s31 offen offset:1024 nt lds
mma v[140:143],a[24:27],a[120:123],v[140:143]
bld v10,s[8:11],s31 offen offset:2048 nt lds
ldt a[72:73],v54 offset:24584
mma v[140:143],a[28:31],a[136:139],v[140:143]
s_mov_b32 m0, 6144
s_mov_b32 s31, 6144
bld v8,s[8:11],s31 offen nt lds
ldt a[74:75],v54 offset:30728
mma v[188:191],a[28:31],a[132:135],v[188:191]
bld v9,s[8:11],s31 offen offset:1024 nt lds
ldt a[76:77],v54 offset:36872
mma v[188:191],a[24:27],a[116:119],v[188:191]
bld v10,s[8:11],s31 offen offset:2048 nt lds
ldt a[78:79],v54 offset:43016
mma v[92:95],a[24:27],a[112:115],v[92:95]
s_mov_b32 m0, 9216
s_mov_b32 s31, 39936
bld v8,s[8:11],s31 offen nt lds
mma v[92:95],a[28:31],a[128:131],v[92:95]
bld v9,s[8:11],s31 offen offset:1024 nt lds
ldt a[80:81],v55 offset:24576
mma v[96:99],a[32:35],a[112:115],v[96:99]
bld v10,s[8:11],s31 offen offset:2048 nt lds
ldt a[82:83],v55 offset:30720
mma v[96:99],a[36:39],a[128:131],v[96:99]
s_mov_b32 m0, 12288
s_mov_b32 s31, 9216
bld v8,s[8:11],s31 offen nt lds
ldt a[84:85],v55 offset:36864
mma v[192:195],a[36:39],a[132:135],v[192:195]
s_add_u32 m0, s30, 0
s_add_u32 s31, s29, 3145728
bld v48,s[16:19],s31 offen lds
ldt a[86:87],v55 offset:43008
mma v[192:195],a[32:35],a[116:119],v[192:195]
mma v[144:147],a[32:35],a[120:123],v[144:147]
ldt a[88:89],v55 offset:24584
mma v[144:147],a[36:39],a[136:139],v[144:147]
ldt a[90:91],v55 offset:30728
mma v[148:151],a[40:43],a[120:123],v[148:151]
mma v[148:151],a[44:47],a[136:139],v[148:151]
bld v49,s[16:19],s31 offen offset:1024 lds
ldt a[92:93],v55 offset:36872
mma v[196:199],a[44:47],a[132:135],v[196:199]
ldt a[94:95],v55 offset:43016
mma v[196:199],a[40:43],a[116:119],v[196:199]
ldt a[96:97],v54 offset:24704
mma v[100:103],a[40:43],a[112:115],v[100:103]
ldt a[98:99],v54 offset:30848
mma v[100:103],a[44:47],a[128:131],v[100:103]
mma v[104:107],a[48:51],a[112:115],v[104:107]
ldt a[100:101],v54 offset:36992
mma v[104:107],a[52:55],a[128:131],v[104:107]
bld v50,s[16:19],s31 offen offset:2048 lds
ldt a[102:103],v54 offset:43136
mma v[200:203],a[52:55],a[132:135],v[200:203]
s_waitcnt vmcnt(16)
ldq a[144:147],v52 offset:36864
mma v[200:203],a[48:51],a[116:119],v[200:203]
ldq a[148:151],v52 offset:38912
mma v[152:155],a[48:51],a[120:123],v[152:155]
ldq a[152:155],v52 offset:40960
mma v[152:155],a[52:55],a[136:139],v[152:155]
s_add_u32 m0, s30, 12288
ldq a[160:163],v53 offset:36864
mma v[156:159],a[56:59],a[120:123],v[156:159]
s_add_u32 s31, s29, 3538944
ldq a[164:167],v53 offset:38912
bld v48,s[16:19],s31 offen lds
mma v[156:159],a[60:63],a[136:139],v[156:159]
ldq a[168:171],v53 offset:40960
mma v[204:207],a[60:63],a[132:135],v[204:207]
ldt a[104:105],v54 offset:24712
mma v[204:207],a[56:59],a[116:119],v[204:207]
ldt a[106:107],v54 offset:30856
mma v[108:111],a[56:59],a[112:115],v[108:111]
ldt a[108:109],v54 offset:37000
mma v[108:111],a[60:63],a[128:131],v[108:111]
s_waitcnt lgkmcnt(8)
ldt a[110:111],v54 offset:43144
mma v[64:67],a[64:67],a[144:147],v[64:67]
s_waitcnt lgkmcnt(6)
bld v49,s[16:19],s31 offen offset:1024 lds
ldt a[0:1],v55 offset:24704
mma v[64:67],a[68:71],a[160:163],v[64:67]
s_waitcnt lgkmcnt(6)
ldt a[2:3],v55 offset:30848
mma v[160:163],a[68:71],a[164:167],v[160:163]
ldt a[4:5],v55 offset:36992
mma v[160:163],a[64:67],a[148:151],v[160:163]
ldt a[6:7],v55 offset:43136
mma v[112:115],a[64:67],a[152:155],v[112:115]
s_waitcnt lgkmcnt(8)
ldt a[8:9],v55 offset:24712
mma v[112:115],a[68:71],a[168:171],v[112:115]
bld v50,s[16:19],s31 offen offset:2048 lds
ldt a[10:11],v55 offset:30856
mma v[116:119],a[72:75],a[152:155],v[116:119]
ldt a[12:13],v55 offset:37000
mma v[116:119],a[76:79],a[168:171],v[116:119]
ldt a[14:15],v55 offset:43144
mma v[164:167],a[76:79],a[164:167],v[164:167]
ldt a[16:17],v54 offset:24832
mma v[164:167],a[72:75],a[148:151],v[164:167]
ldt a[18:19],v54 offset:30976
mma v[68:71],a[72:75],a[144:147],v[68:71]
ldt a[20:21],v54 offset:37120
mma v[68:71],a[76:79],a[160:163],v[68:71]
ldt a[22:23],v54 offset:43264
mma v[72:75],a[80:83],a[144:147],v[72:75]
ldt a[24:25],v54 offset:24840
mma v[72:75],a[84:87],a[160:163],v[72:75]
ldt a[26:27],v54 offset:30984
mma v[168:171],a[84:87],a[164:167],v[168:171]
s_add_u32 m0, s27, 36864
s_add_u32 s31, s28, 512
bld v51,s[4:7],s31 offen lds
ldt a[28:29],v54 offset:37128
mma v[168:171],a[80:83],a[148:151],v[168:171]
ldt a[30:31],v54 offset:43272
mma v[120:123],a[80:83],a[152:155],v[120:123]
ldt a[32:33],v55 offset:24832
mma v[120:123],a[84:87],a[168:171],v[120:123]
s_add_u32 s31, s28, 9728
bld v51,s[4:7],s31 offen offset:1024 lds
ldt a[34:35],v55 offset:30976
mma v[124:127],a[88:91],a[152:155],v[124:127]
mma v[124:127],a[92:95],a[168:171],v[124:127]
s_add_u32 m0, s27, 38912
ldt a[36:37],v55 offset:37120
mma v[172:175],a[92:95],a[164:167],v[172:175]
s_add_u32 s31, s28, 20992
bld v51,s[4:7],s31 offen lds
ldt a[38:39],v55 offset:43264
mma v[172:175],a[88:91],a[148:151],v[172:175]
ldt a[40:41],v55 offset:24840
mma v[76:79],a[88:91],a[144:147],v[76:79]
ldt a[42:43],v55 offset:30984
mma v[76:79],a[92:95],a[160:163],v[76:79]
mma v[80:83],a[96:99],a[144:147],v[80:83]
s_add_u32 s31, s28, 30208
bld v51,s[4:7],s31 offen offset:1024 lds
ldt a[44:45],v55 offset:37128
mma v[80:83],a[100:103],a[160:163],v[80:83]
ldt a[46:47],v55 offset:43272
mma v[176:179],a[100:103],a[164:167],v[176:179]
s_add_u32 m0, s27, 40960
mma v[176:179],a[96:99],a[148:151],v[176:179]
s_add_u32 s31, s28, 41472
bld v51,s[4:7],s31 offen lds
mma v[128:131],a[96:99],a[152:155],v[128:131]
mma v[128:131],a[100:103],a[168:171],v[128:131]
s_waitcnt lgkmcnt(14)
mma v[132:135],a[104:107],a[152:155],v[132:135]
s_add_u32 s31, s28, 50688
bld v51,s[4:7],s31 offen offset:1024 lds
mma v[132:135],a[108:111],a[168:171],v[132:135]
mma v[180:183],a[108:111],a[164:167],v[180:183]
mma v[180:183],a[104:107],a[148:151],v[180:183]
mma v[84:87],a[104:107],a[144:147],v[84:87]
mma v[84:87],a[108:111],a[160:163],v[84:87]
mma v[88:91],a[0:3],a[144:147],v[88:91]
s_waitcnt vmcnt(6) lgkmcnt(0)
s_barrier
mma v[88:91],a[4:7],a[160:163],v[88:91]
s_mov_b32 s31, 4706304
buffer_load_dword v45, v58, s[16:19], s31 offen
ldt a[48:49],v54
mma v[184:187],a[4:7],a[164:167],v[184:187]
s_mov_b32 s31, 768
buffer_load_dword v45, v59, s[4:7], s31 offen
ldt a[50:51],v54 offset:6144
mma v[184:187],a[0:3],a[148:151],v[184:187]
s_mov_b32 s31, 7680
buffer_load_dword v45, v31, s[48:51], s31 offen
ldt a[52:53],v54 offset:12288
mma v[136:139],a[0:3],a[152:155],v[136:139]
s_mov_b32 m0, 12288
s_mov_b32 s31, 9216
bld v9,s[8:11],s31 offen offset:1024 nt lds
ldt a[54:55],v54 offset:18432
mma v[136:139],a[4:7],a[168:171],v[136:139]
bld v10,s[8:11],s31 offen offset:2048 nt lds
mma v[140:143],a[8:11],a[152:155],v[140:143]
s_mov_b32 m0, 15360
s_mov_b32 s31, 43008
bld v8,s[8:11],s31 offen nt lds
ldt a[56:57],v54 offset:8
mma v[140:143],a[12:15],a[168:171],v[140:143]
bld v9,s[8:11],s31 offen offset:1024 nt lds
ldt a[58:59],v54 offset:6152
mma v[188:191],a[12:15],a[164:167],v[188:191]
bld v10,s[8:11],s31 offen offset:2048 nt lds
ldt a[60:61],v54 offset:12296
mma v[188:191],a[8:11],a[148:151],v[188:191]
s_mov_b32 m0, 18432
s_mov_b32 s31, 12288
bld v8,s[8:11],s31 offen nt lds
ldt a[62:63],v54 offset:18440
mma v[92:95],a[8:11],a[144:147],v[92:95]
bld v9,s[8:11],s31 offen offset:1024 nt lds
mma v[92:95],a[12:15],a[160:163],v[92:95]
bld v10,s[8:11],s31 offen offset:2048 nt lds
ldt a[64:65],v55
mma v[96:99],a[16:19],a[144:147],v[96:99]
s_mov_b32 m0, 21504
s_mov_b32 s31, 46080
bld v8,s[8:11],s31 offen nt lds
ldt a[66:67],v55 offset:6144
mma v[96:99],a[20:23],a[160:163],v[96:99]
bld v9,s[8:11],s31 offen offset:1024 nt lds
ldt a[68:69],v55 offset:12288
mma v[192:195],a[20:23],a[164:167],v[192:195]
s_add_u32 m0, s30, 24576
s_add_u32 s31, s29, 3932160
bld v48,s[16:19],s31 offen lds
ldt a[70:71],v55 offset:18432
mma v[192:195],a[16:19],a[148:151],v[192:195]
mma v[144:147],a[16:19],a[152:155],v[144:147]
ldt a[72:73],v55 offset:8
mma v[144:147],a[20:23],a[168:171],v[144:147]
ldt a[74:75],v55 offset:6152
mma v[148:151],a[24:27],a[152:155],v[148:151]
mma v[148:151],a[28:31],a[168:171],v[148:151]
bld v49,s[16:19],s31 offen offset:1024 lds
ldt a[76:77],v55 offset:12296
mma v[196:199],a[28:31],a[164:167],v[196:199]
ldt a[78:79],v55 offset:18440
mma v[196:199],a[24:27],a[148:151],v[196:199]
ldt a[80:81],v54 offset:128
mma v[100:103],a[24:27],a[144:147],v[100:103]
ldt a[82:83],v54 offset:6272
mma v[100:103],a[28:31],a[160:163],v[100:103]
mma v[104:107],a[32:35],a[144:147],v[104:107]
ldt a[84:85],v54 offset:12416
mma v[104:107],a[36:39],a[160:163],v[104:107]
bld v50,s[16:19],s31 offen offset:2048 lds
ldt a[86:87],v54 offset:18560
mma v[200:203],a[36:39],a[164:167],v[200:203]
s_waitcnt vmcnt(16)
ldq a[112:115],v52 offset:36864
mma v[200:203],a[32:35],a[148:151],v[200:203]
ldq a[116:119],v52 offset:38912
mma v[152:155],a[32:35],a[152:155],v[152:155]
ldq a[120:123],v52 offset:40960
mma v[152:155],a[36:39],a[168:171],v[152:155]
s_add_u32 m0, s30, 36864
ldq a[128:131],v53 offset:36864
mma v[156:159],a[40:43],a[152:155],v[156:159]
s_add_u32 s31, s29, 4325376
ldq a[132:135],v53 offset:38912
bld v48,s[16:19],s31 offen lds
mma v[156:159],a[44:47],a[168:171],v[156:159]
ldq a[136:139],v53 offset:40960
mma v[204:207],a[44:47],a[164:167],v[204:207]
ldt a[88:89],v54 offset:136
mma v[204:207],a[40:43],a[148:151],v[204:207]
ldt a[90:91],v54 offset:6280
mma v[108:111],a[40:43],a[144:147],v[108:111]
ldt a[92:93],v54 offset:12424
mma v[108:111],a[44:47],a[160:163],v[108:111]
s_waitcnt lgkmcnt(8)
ldt a[94:95],v54 offset:18568
mma v[64:67],a[48:51],a[112:115],v[64:67]
s_waitcnt lgkmcnt(6)
bld v49,s[16:19],s31 offen offset:1024 lds
ldt a[96:97],v55 offset:128
mma v[64:67],a[52:55],a[128:131],v[64:67]
s_waitcnt lgkmcnt(6)
ldt a[98:99],v55 offset:6272
mma v[160:163],a[52:55],a[132:135],v[160:163]
ldt a[100:101],v55 offset:12416
mma v[160:163],a[48:51],a[116:119],v[160:163]
ldt a[102:103],v55 offset:18560
mma v[112:115],a[48:51],a[120:123],v[112:115]
s_waitcnt lgkmcnt(8)
ldt a[104:105],v55 offset:136
mma v[112:115],a[52:55],a[136:139],v[112:115]
bld v50,s[16:19],s31 offen offset:2048 lds
ldt a[106:107],v55 offset:6280
mma v[116:119],a[56:59],a[120:123],v[116:119]
ldt a[108:109],v55 offset:12424
mma v[116:119],a[60:63],a[136:139],v[116:119]
ldt a[110:111],v55 offset:18568
mma v[164:167],a[60:63],a[132:135],v[164:167]
ldt a[0:1],v54 offset:256
mma v[164:167],a[56:59],a[116:119],v[164:167]
ldt a[2:3],v54 offset:6400
mma v[68:71],a[56:59],a[112:115],v[68:71]
ldt a[4:5],v54 offset:12544
mma v[68:71],a[60:63],a[128:131],v[68:71]
ldt a[6:7],v54 offset:18688
mma v[72:75],a[64:67],a[112:115],v[72:75]
ldt a[8:9],v54 offset:264
mma v[72:75],a[68:71],a[128:131],v[72:75]
ldt a[10:11],v54 offset:6408
mma v[168:171],a[68:71],a[132:135],v[168:171]
s_add_u32 m0, s27, 36864
s_add_u32 s31, s28, 640
bld v51,s[4:7],s31 offen lds
ldt a[12:13],v54 offset:12552
mma v[168:171],a[64:67],a[116:119],v[168:171]
ldt a[14:15],v54 offset:18696
mma v[120:123],a[64:67],a[120:123],v[120:123]
ldt a[16:17],v55 offset:256
mma v[120:123],a[68:71],a[136:139],v[120:123]
s_add_u32 s31, s28, 9856
bld v51,s[4:7],s31 offen offset:1024 lds
ldt a[18:19],v55 offset:6400
mma v[124:127],a[72:75],a[120:123],v[124:127]
mma v[124:127],a[76:79],a[136:139],v[124:127]
s_add_u32 m0, s27, 38912
ldt a[20:21],v55 offset:12544
mma v[172:175],a[76:79],a[132:135],v[172:175]
s_add_u32 s31, s28, 21120
bld v51,s[4:7],s31 offen lds
ldt a[22:23],v55 offset:18688
mma v[172:175],a[72:75],a[116:119],v[172:175]
ldt a[24:25],v55 offset:264
mma v[76:79],a[72:75],a[112:115],v[76:79]
ldt a[26:27],v55 offset:6408
mma v[76:79],a[76:79],a[128:131],v[76:79]
mma v[80:83],a[80:83],a[112:115],v[80:83]
s_add_u32 s31, s28, 30336
bld v51,s[4:7],s31 offen offset:1024 lds
ldt a[28:29],v55 offset:12552
mma v[80:83],a[84:87],a[128:131],v[80:83]
ldt a[30:31],v55 offset:18696
mma v[176:179],a[84:87],a[132:135],v[176:179]
s_add_u32 m0, s27, 40960
mma v[176:179],a[80:83],a[116:119],v[176:179]
s_add_u32 s31, s28, 41600
bld v51,s[4:7],s31 offen lds
mma v[128:131],a[80:83],a[120:123],v[128:131]
mma v[128:131],a[84:87],a[136:139],v[128:131]
s_waitcnt lgkmcnt(14)
mma v[132:135],a[88:91],a[120:123],v[132:135]
s_add_u32 s31, s28, 50816
bld v51,s[4:7],s31 offen offset:1024 lds
mma v[132:135],a[92:95],a[136:139],v[132:135]
mma v[180:183],a[92:95],a[132:135],v[180:183]
mma v[180:183],a[88:91],a[116:119],v[180:183]
mma v[84:87],a[88:91],a[112:115],v[84:87]
mma v[84:87],a[92:95],a[128:131],v[84:87]
mma v[88:91],a[96:99],a[112:115],v[88:91]
s_waitcnt vmcnt(6) lgkmcnt(0)
s_barrier
mma v[88:91],a[100:103],a[128:131],v[88:91]
s_mov_b32 s31, 5492736
buffer_load_dword v45, v58, s[16:19], s31 offen
ldt a[32:33],v54 offset:24576
mma v[184:187],a[100:103],a[132:135],v[184:187]
s_mov_b32 s31, 896
buffer_load_dword v45, v59, s[4:7], s31 offen
ldt a[34:35],v54 offset:30720
mma v[184:187],a[96:99],a[116:119],v[184:187]
s_mov_b32 s31, 11520
buffer_load_dword v45, v31, s[48:51], s31 offen
ldt a[36:37],v54 offset:36864
mma v[136:139],a[96:99],a[120:123],v[136:139]
s_mov_b32 m0, 21504
s_mov_b32 s31, 46080
bld v10,s[8:11],s31 offen offset:2048 nt lds
ldt a[38:39],v54 offset:43008
mma v[136:139],a[100:103],a[136:139],v[136:139]
s_mov_b32 m0, 24576
s_mov_b32 s31, 15360
bld v8,s[8:11],s31 offen nt lds
mma v[140:143],a[104:107],a[120:123],v[140:143]
bld v9,s[8:11],s31 offen offset:1024 nt lds
ldt a[40:41],v54 offset:24584
mma v[140:143],a[108:111],a[136:139],v[140:143]
s_mov_b32 m0, 86016
s_mov_b32 s31, 0
bld v8,s[12:15],s31 offen nt lds
ldt a[42:43],v54 offset:30728
mma v[188:191],a[108:111],a[132:135],v[188:191]
bld v9,s[12:15],s31 offen offset:1024 nt lds
ldt a[44:45],v54 offset:36872
mma v[188:191],a[104:107],a[116:119],v[188:191]
bld v10,s[12:15],s31 offen offset:2048 nt lds
ldt a[46:47],v54 offset:43016
mma v[92:95],a[104:107],a[112:115],v[92:95]
s_mov_b32 m0, 89088
s_mov_b32 s31, 33792
bld v8,s[12:15],s31 offen nt lds
mma v[92:95],a[108:111],a[128:131],v[92:95]
bld v9,s[12:15],s31 offen offset:1024 nt lds
ldt a[48:49],v55 offset:24576
mma v[96:99],a[0:3],a[112:115],v[96:99]
bld v10,s[12:15],s31 offen offset:2048 nt lds
ldt a[50:51],v55 offset:30720
mma v[96:99],a[4:7],a[128:131],v[96:99]
s_mov_b32 m0, 92160
s_mov_b32 s31, 3072
bld v8,s[12:15],s31 offen nt lds
ldt a[52:53],v55 offset:36864
mma v[192:195],a[4:7],a[132:135],v[192:195]
s_add_u32 m0, s30, 0
s_add_u32 s31, s29, 4718592
bld v48,s[16:19],s31 offen lds
ldt a[54:55],v55 offset:43008
mma v[192:195],a[0:3],a[116:119],v[192:195]
mma v[144:147],a[0:3],a[120:123],v[144:147]
ldt a[56:57],v55 offset:24584
mma v[144:147],a[4:7],a[136:139],v[144:147]
ldt a[58:59],v55 offset:30728
mma v[148:151],a[8:11],a[120:123],v[148:151]
mma v[148:151],a[12:15],a[136:139],v[148:151]
bld v49,s[16:19],s31 offen offset:1024 lds
ldt a[60:61],v55 offset:36872
mma v[196:199],a[12:15],a[132:135],v[196:199]
ldt a[62:63],v55 offset:43016
mma v[196:199],a[8:11],a[116:119],v[196:199]
ldt a[64:65],v54 offset:24704
mma v[100:103],a[8:11],a[112:115],v[100:103]
ldt a[66:67],v54 offset:30848
mma v[100:103],a[12:15],a[128:131],v[100:103]
mma v[104:107],a[16:19],a[112:115],v[104:107]
ldt a[68:69],v54 offset:36992
mma v[104:107],a[20:23],a[128:131],v[104:107]
bld v50,s[16:19],s31 offen offset:2048 lds
ldt a[70:71],v54 offset:43136
mma v[200:203],a[20:23],a[132:135],v[200:203]
s_waitcnt vmcnt(16)
ldq a[144:147],v52 offset:36864
mma v[200:203],a[16:19],a[116:119],v[200:203]
ldq a[148:151],v52 offset:38912
mma v[152:155],a[16:19],a[120:123],v[152:155]
ldq a[152:155],v52 offset:40960
mma v[152:155],a[20:23],a[136:139],v[152:155]
s_add_u32 m0, s30, 12288
ldq a[160:163],v53 offset:36864
mma v[156:159],a[24:27],a[120:123],v[156:159]
s_add_u32 s31, s29, 5111808
ldq a[164:167],v53 offset:38912
bld v48,s[16:19],s31 offen lds
mma v[156:159],a[28:31],a[136:139],v[156:159]
ldq a[168:171],v53 offset:40960
mma v[204:207],a[28:31],a[132:135],v[204:207]
ldt a[72:73],v54 offset:24712
mma v[204:207],a[24:27],a[116:119],v[204:207]
ldt a[74:75],v54 offset:30856
mma v[108:111],a[24:27],a[112:115],v[108:111]
ldt a[76:77],v54 offset:37000
mma v[108:111],a[28:31],a[128:131],v[108:111]
s_waitcnt lgkmcnt(8)
ldt a[78:79],v54 offset:43144
mma v[64:67],a[32:35],a[144:147],v[64:67]
s_waitcnt lgkmcnt(6)
bld v49,s[16:19],s31 offen offset:1024 lds
ldt a[80:81],v55 offset:24704
mma v[64:67],a[36:39],a[160:163],v[64:67]
s_waitcnt lgkmcnt(6)
ldt a[82:83],v55 offset:30848
mma v[160:163],a[36:39],a[164:167],v[160:163]
ldt a[84:85],v55 offset:36992
mma v[160:163],a[32:35],a[148:151],v[160:163]
ldt a[86:87],v55 offset:43136
mma v[112:115],a[32:35],a[152:155],v[112:115]
s_waitcnt lgkmcnt(8)
ldt a[88:89],v55 offset:24712
mma v[112:115],a[36:39],a[168:171],v[112:115]
bld v50,s[16:19],s31 offen offset:2048 lds
ldt a[90:91],v55 offset:30856
mma v[116:119],a[40:43],a[152:155],v[116:119]
ldt a[92:93],v55 offset:37000
mma v[116:119],a[44:47],a[168:171],v[116:119]
ldt a[94:95],v55 offset:43144
mma v[164:167],a[44:47],a[164:167],v[164:167]
ldt a[96:97],v54 offset:24832
mma v[164:167],a[40:43],a[148:151],v[164:167]
ldt a[98:99],v54 offset:30976
mma v[68:71],a[40:43],a[144:147],v[68:71]
ldt a[100:101],v54 offset:37120
mma v[68:71],a[44:47],a[160:163],v[68:71]
ldt a[102:103],v54 offset:43264
mma v[72:75],a[48:51],a[144:147],v[72:75]
ldt a[104:105],v54 offset:24840
mma v[72:75],a[52:55],a[160:163],v[72:75]
ldt a[106:107],v54 offset:30984
mma v[168:171],a[52:55],a[164:167],v[168:171]
s_add_u32 m0, s27, 36864
s_add_u32 s31, s28, 768
bld v51,s[4:7],s31 offen lds
ldt a[108:109],v54 offset:37128
mma v[168:171],a[48:51],a[148:151],v[168:171]
ldt a[110:111],v54 offset:43272
mma v[120:123],a[48:51],a[152:155],v[120:123]
ldt a[0:1],v55 offset:24832
mma v[120:123],a[52:55],a[168:171],v[120:123]
s_add_u32 s31, s28, 9984
bld v51,s[4:7],s31 offen offset:1024 lds
ldt a[2:3],v55 offset:30976
mma v[124:127],a[56:59],a[152:155],v[124:127]
mma v[124:127],a[60:63],a[168:171],v[124:127]
s_add_u32 m0, s27, 38912
ldt a[4:5],v55 offset:37120
mma v[172:175],a[60:63],a[164:167],v[172:175]
s_add_u32 s31, s28, 21248
bld v51,s[4:7],s31 offen lds
ldt a[6:7],v55 offset:43264
mma v[172:175],a[56:59],a[148:151],v[172:175]
ldt a[8:9],v55 offset:24840
mma v[76:79],a[56:59],a[144:147],v[76:79]
ldt a[10:11],v55 offset:30984
mma v[76:79],a[60:63],a[160:163],v[76:79]
mma v[80:83],a[64:67],a[144:147],v[80:83]
s_add_u32 s31, s28, 30464
bld v51,s[4:7],s31 offen offset:1024 lds
ldt a[12:13],v55 offset:37128
mma v[80:83],a[68:71],a[160:163],v[80:83]
ldt a[14:15],v55 offset:43272
mma v[176:179],a[68:71],a[164:167],v[176:179]
s_add_u32 m0, s27, 40960
mma v[176:179],a[64:67],a[148:151],v[176:179]
s_add_u32 s31, s28, 41728
bld v51,s[4:7],s31 offen lds
mma v[128:131],a[64:67],a[152:155],v[128:131]
mma v[128:131],a[68:71],a[168:171],v[128:131]
s_waitcnt lgkmcnt(14)
mma v[132:135],a[72:75],a[152:155],v[132:135]
s_add_u32 s31, s28, 50944
bld v51,s[4:7],s31 offen offset:1024 lds
mma v[132:135],a[76:79],a[168:171],v[132:135]
mma v[180:183],a[76:79],a[164:167],v[180:183]
mma v[180:183],a[72:75],a[148:151],v[180:183]
mma v[84:87],a[72:75],a[144:147],v[84:87]
mma v[84:87],a[76:79],a[160:163],v[84:87]
mma v[88:91],a[80:83],a[144:147],v[88:91]
s_waitcnt vmcnt(6) lgkmcnt(0)
s_barrier
mma v[88:91],a[84:87],a[160:163],v[88:91]
s_mov_b32 s31, 6279168
buffer_load_dword v45, v58, s[16:19], s31 offen
ldt a[16:17],v54
mma v[184:187],a[84:87],a[164:167],v[184:187]
s_mov_b32 s31, 1024
buffer_load_dword v45, v59, s[4:7], s31 offen
ldt a[18:19],v54 offset:6144
mma v[184:187],a[80:83],a[148:151],v[184:187]
s_mov_b32 s31, 15360
buffer_load_dword v45, v31, s[48:51], s31 offen
ldt a[20:21],v54 offset:12288
mma v[136:139],a[80:83],a[152:155],v[136:139]
s_mov_b32 m0, 92160
s_mov_b32 s31, 3072
bld v9,s[12:15],s31 offen offset:1024 nt lds
ldt a[22:23],v54 offset:18432
mma v[136:139],a[84:87],a[168:171],v[136:139]
bld v10,s[12:15],s31 offen offset:2048 nt lds
mma v[140:143],a[88:91],a[152:155],v[140:143]
s_mov_b32 m0, 95232
s_mov_b32 s31, 36864
bld v8,s[12:15],s31 offen nt lds
ldt a[24:25],v54 offset:8
mma v[140:143],a[92:95],a[168:171],v[140:143]
bld v9,s[12:15],s31 offen offset:1024 nt lds
ldt a[26:27],v54 offset:6152
mma v[188:191],a[92:95],a[164:167],v[188:191]
bld v10,s[12:15],s31 offen offset:2048 nt lds
ldt a[28:29],v54 offset:12296
mma v[188:191],a[88:91],a[148:151],v[188:191]
s_mov_b32 m0, 98304
s_mov_b32 s31, 6144
bld v8,s[12:15],s31 offen nt lds
ldt a[30:31],v54 offset:18440
mma v[92:95],a[88:91],a[144:147],v[92:95]
bld v9,s[12:15],s31 offen offset:1024 nt lds
mma v[92:95],a[92:95],a[160:163],v[92:95]
bld v10,s[12:15],s31 offen offset:2048 nt lds
ldt a[32:33],v55
mma v[96:99],a[96:99],a[144:147],v[96:99]
s_mov_b32 m0, 101376
s_mov_b32 s31, 39936
bld v8,s[12:15],s31 offen nt lds
ldt a[34:35],v55 offset:6144
mma v[96:99],a[100:103],a[160:163],v[96:99]
bld v9,s[12:15],s31 offen offset:1024 nt lds
ldt a[36:37],v55 offset:12288
mma v[192:195],a[100:103],a[164:167],v[192:195]
s_add_u32 m0, s30, 24576
s_add_u32 s31, s29, 5505024
bld v48,s[16:19],s31 offen lds
ldt a[38:39],v55 offset:18432
mma v[192:195],a[96:99],a[148:151],v[192:195]
mma v[144:147],a[96:99],a[152:155],v[144:147]
ldt a[40:41],v55 offset:8
mma v[144:147],a[100:103],a[168:171],v[144:147]
ldt a[42:43],v55 offset:6152
mma v[148:151],a[104:107],a[152:155],v[148:151]
mma v[148:151],a[108:111],a[168:171],v[148:151]
bld v49,s[16:19],s31 offen offset:1024 lds
ldt a[44:45],v55 offset:12296
mma v[196:199],a[108:111],a[164:167],v[196:199]
ldt a[46:47],v55 offset:18440
mma v[196:199],a[104:107],a[148:151],v[196:199]
ldt a[48:49],v54 offset:128
mma v[100:103],a[104:107],a[144:147],v[100:103]
ldt a[50:51],v54 offset:6272
mma v[100:103],a[108:111],a[160:163],v[100:103]
mma v[104:107],a[0:3],a[144:147],v[104:107]
ldt a[52:53],v54 offset:12416
mma v[104:107],a[4:7],a[160:163],v[104:107]
bld v50,s[16:19],s31 offen offset:2048 lds
ldt a[54:55],v54 offset:18560
mma v[200:203],a[4:7],a[164:167],v[200:203]
s_waitcnt vmcnt(16)
ldq a[112:115],v52 offset:36864
mma v[200:203],a[0:3],a[148:151],v[200:203]
ldq a[116:119],v52 offset:38912
mma v[152:155],a[0:3],a[152:155],v[152:155]
ldq a[120:123],v52 offset:40960
mma v[152:155],a[4:7],a[168:171],v[152:155]
s_add_u32 m0, s30, 36864
ldq a[128:131],v53 offset:36864
mma v[156:159],a[8:11],a[152:155],v[156:159]
s_add_u32 s31, s29, 5898240
ldq a[132:135],v53 offset:38912
bld v48,s[16:19],s31 offen lds
mma v[156:159],a[12:15],a[168:171],v[156:159]
ldq a[136:139],v53 offset:40960
mma v[204:207],a[12:15],a[164:167],v[204:207]
ldt a[56:57],v54 offset:136
mma v[204:207],a[8:11],a[148:151],v[204:207]
ldt a[58:59],v54 offset:6280
mma v[108:111],a[8:11],a[144:147],v[108:111]
ldt a[60:61],v54 offset:12424
mma v[108:111],a[12:15],a[160:163],v[108:111]
s_waitcnt lgkmcnt(8)
ldt a[62:63],v54 offset:18568
mma v[64:67],a[16:19],a[112:115],v[64:67]
s_waitcnt lgkmcnt(6)
bld v49,s[16:19],s31 offen offset:1024 lds
ldt a[64:65],v55 offset:128
mma v[64:67],a[20:23],a[128:131],v[64:67]
s_waitcnt lgkmcnt(6)
ldt a[66:67],v55 offset:6272
mma v[160:163],a[20:23],a[132:135],v[160:163]
ldt a[68:69],v55 offset:12416
mma v[160:163],a[16:19],a[116:119],v[160:163]
ldt a[70:71],v55 offset:18560
mma v[112:115],a[16:19],a[120:123],v[112:115]
s_waitcnt lgkmcnt(8)
ldt a[72:73],v55 offset:136
mma v[112:115],a[20:23],a[136:139],v[112:115]
bld v50,s[16:19],s31 offen offset:2048 lds
ldt a[74:75],v55 offset:6280
mma v[116:119],a[24:27],a[120:123],v[116:119]
ldt a[76:77],v55 offset:12424
mma v[116:119],a[28:31],a[136:139],v[116:119]
ldt a[78:79],v55 offset:18568
mma v[164:167],a[28:31],a[132:135],v[164:167]
ldt a[80:81],v54 offset:256
mma v[164:167],a[24:27],a[116:119],v[164:167]
ldt a[82:83],v54 offset:6400
mma v[68:71],a[24:27],a[112:115],v[68:71]
ldt a[84:85],v54 offset:12544
mma v[68:71],a[28:31],a[128:131],v[68:71]
ldt a[86:87],v54 offset:18688
mma v[72:75],a[32:35],a[112:115],v[72:75]
ldt a[88:89],v54 offset:264
mma v[72:75],a[36:39],a[128:131],v[72:75]
ldt a[90:91],v54 offset:6408
mma v[168:171],a[36:39],a[132:135],v[168:171]
s_add_u32 m0, s27, 36864
s_add_u32 s31, s28, 896
bld v51,s[4:7],s31 offen lds
ldt a[92:93],v54 offset:12552
mma v[168:171],a[32:35],a[116:119],v[168:171]
ldt a[94:95],v54 offset:18696
mma v[120:123],a[32:35],a[120:123],v[120:123]
ldt a[96:97],v55 offset:256
mma v[120:123],a[36:39],a[136:139],v[120:123]
s_add_u32 s31, s28, 10112
bld v51,s[4:7],s31 offen offset:1024 lds
ldt a[98:99],v55 offset:6400
mma v[124:127],a[40:43],a[120:123],v[124:127]
mma v[124:127],a[44:47],a[136:139],v[124:127]
s_add_u32 m0, s27, 38912
ldt a[100:101],v55 offset:12544
mma v[172:175],a[44:47],a[132:135],v[172:175]
s_add_u32 s31, s28, 21376
bld v51,s[4:7],s31 offen lds
ldt a[102:103],v55 offset:18688
mma v[172:175],a[40:43],a[116:119],v[172:175]
ldt a[104:105],v55 offset:264
mma v[76:79],a[40:43],a[112:115],v[76:79]
ldt a[106:107],v55 offset:6408
mma v[76:79],a[44:47],a[128:131],v[76:79]
mma v[80:83],a[48:51],a[112:115],v[80:83]
s_add_u32 s31, s28, 30592
bld v51,s[4:7],s31 offen offset:1024 lds
ldt a[108:109],v55 offset:12552
mma v[80:83],a[52:55],a[128:131],v[80:83]
ldt a[110:111],v55 offset:18696
mma v[176:179],a[52:55],a[132:135],v[176:179]
s_add_u32 m0, s27, 40960
mma v[176:179],a[48:51],a[116:119],v[176:179]
s_add_u32 s31, s28, 41856
bld v51,s[4:7],s31 offen lds
mma v[128:131],a[48:51],a[120:123],v[128:131]
mma v[128:131],a[52:55],a[136:139],v[128:131]
s_waitcnt lgkmcnt(14)
mma v[132:135],a[56:59],a[120:123],v[132:135]
s_add_u32 s31, s28, 51072
bld v51,s[4:7],s31 offen offset:1024 lds
mma v[132:135],a[60:63],a[136:139],v[132:135]
mma v[180:183],a[60:63],a[132:135],v[180:183]
mma v[180:183],a[56:59],a[116:119],v[180:183]
mma v[84:87],a[56:59],a[112:115],v[84:87]
mma v[84:87],a[60:63],a[128:131],v[84:87]
mma v[88:91],a[64:67],a[112:115],v[88:91]
s_waitcnt vmcnt(6) lgkmcnt(0)
s_barrier
mma v[88:91],a[68:71],a[128:131],v[88:91]
s_mov_b32 s31, 7065600
buffer_load_dword v45, v58, s[16:19], s31 offen
ldt a[0:1],v54 offset:24576
mma v[184:187],a[68:71],a[132:135],v[184:187]
s_mov_b32 s31, 1152
buffer_load_dword v45, v59, s[4:7], s31 offen
ldt a[2:3],v54 offset:30720
mma v[184:187],a[64:67],a[116:119],v[184:187]
s_mov_b32 s31, 19200
buffer_load_dword v45, v31, s[48:51], s31 offen
ldt a[4:5],v54 offset:36864
mma v[136:139],a[64:67],a[120:123],v[136:139]
s_mov_b32 m0, 101376
s_mov_b32 s31, 39936
bld v10,s[12:15],s31 offen offset:2048 nt lds
ldt a[6:7],v54 offset:43008
mma v[136:139],a[68:71],a[136:139],v[136:139]
s_mov_b32 m0, 104448
s_mov_b32 s31, 9216
bld v8,s[12:15],s31 offen nt lds
mma v[140:143],a[72:75],a[120:123],v[140:143]
bld v9,s[12:15],s31 offen offset:1024 nt lds
ldt a[8:9],v54 offset:24584
mma v[140:143],a[76:79],a[136:139],v[140:143]
bld v10,s[12:15],s31 offen offset:2048 nt lds
ldt a[10:11],v54 offset:30728
mma v[188:191],a[76:79],a[132:135],v[188:191]
s_mov_b32 m0, 107520
s_mov_b32 s31, 43008
bld v8,s[12:15],s31 offen nt lds
ldt a[12:13],v54 offset:36872
mma v[188:191],a[72:75],a[116:119],v[188:191]
bld v9,s[12:15],s31 offen offset:1024 nt lds
ldt a[14:15],v54 offset:43016
mma v[92:95],a[72:75],a[112:115],v[92:95]
bld v10,s[12:15],s31 offen offset:2048 nt lds
mma v[92:95],a[76:79],a[128:131],v[92:95]
s_mov_b32 m0, 24576
s_mov_b32 s31, 15360
bld v10,s[8:11],s31 offen offset:2048 nt lds
ldt a[16:17],v55 offset:24576
mma v[96:99],a[80:83],a[112:115],v[96:99]
s_mov_b32 m0, 27648
s_mov_b32 s31, 49152
bld v8,s[8:11],s31 offen nt lds
ldt a[18:19],v55 offset:30720
mma v[96:99],a[84:87],a[128:131],v[96:99]
bld v9,s[8:11],s31 offen offset:1024 nt lds
ldt a[20:21],v55 offset:36864
mma v[192:195],a[84:87],a[132:135],v[192:195]
s_add_u32 m0, s30, 0
s_add_u32 s31, s29, 6291456
bld v48,s[16:19],s31 offen lds
ldt a[22:23],v55 offset:43008
mma v[192:195],a[80:83],a[116:119],v[192:195]
mma v[144:147],a[80:83],a[120:123],v[144:147]
ldt a[24:25],v55 offset:24584
mma v[144:147],a[84:87],a[136:139],v[144:147]
ldt a[26:27],v55 offset:30728
mma v[148:151],a[88:91],a[120:123],v[148:151]
mma v[148:151],a[92:95],a[136:139],v[148:151]
bld v49,s[16:19],s31 offen offset:1024 lds
ldt a[28:29],v55 offset:36872
mma v[196:199],a[92:95],a[132:135],v[196:199]
ldt a[30:31],v55 offset:43016
mma v[196:199],a[88:91],a[116:119],v[196:199]
ldt a[32:33],v54 offset:24704
mma v[100:103],a[88:91],a[112:115],v[100:103]
ldt a[34:35],v54 offset:30848
mma v[100:103],a[92:95],a[128:131],v[100:103]
mma v[104:107],a[96:99],a[112:115],v[104:107]
ldt a[36:37],v54 offset:36992
mma v[104:107],a[100:103],a[128:131],v[104:107]
bld v50,s[16:19],s31 offen offset:2048 lds
ldt a[38:39],v54 offset:43136
mma v[200:203],a[100:103],a[132:135],v[200:203]
s_waitcnt vmcnt(16)
ldq a[144:147],v52 offset:36864
mma v[200:203],a[96:99],a[116:119],v[200:203]
ldq a[148:151],v52 offset:38912
mma v[152:155],a[96:99],a[120:123],v[152:155]
ldq a[152:155],v52 offset:40960
mma v[152:155],a[100:103],a[136:139],v[152:155]
s_add_u32 m0, s30, 12288
ldq a[160:163],v53 offset:36864
mma v[156:159],a[104:107],a[120:123],v[156:159]
s_add_u32 s31, s29, 6684672
ldq a[164:167],v53 offset:38912
bld v48,s[16:19],s31 offen lds
mma v[156:159],a[108:111],a[136:139],v[156:159]
ldq a[168:171],v53 offset:40960
mma v[204:207],a[108:111],a[132:135],v[204:207]
ldt a[40:41],v54 offset:24712
mma v[204:207],a[104:107],a[116:119],v[204:207]
ldt a[42:43],v54 offset:30856
mma v[108:111],a[104:107],a[112:115],v[108:111]
ldt a[44:45],v54 offset:37000
mma v[108:111],a[108:111],a[128:131],v[108:111]
s_waitcnt lgkmcnt(8)
ldt a[46:47],v54 offset:43144
mma v[64:67],a[0:3],a[144:147],v[64:67]
s_waitcnt lgkmcnt(6)
bld v49,s[16:19],s31 offen offset:1024 lds
ldt a[48:49],v55 offset:24704
mma v[64:67],a[4:7],a[160:163],v[64:67]
s_waitcnt lgkmcnt(6)
ldt a[50:51],v55 offset:30848
mma v[160:163],a[4:7],a[164:167],v[160:163]
ldt a[52:53],v55 offset:36992
mma v[160:163],a[0:3],a[148:151],v[160:163]
ldt a[54:55],v55 offset:43136
mma v[112:115],a[0:3],a[152:155],v[112:115]
s_waitcnt lgkmcnt(8)
ldt a[56:57],v55 offset:24712
mma v[112:115],a[4:7],a[168:171],v[112:115]
bld v50,s[16:19],s31 offen offset:2048 lds
ldt a[58:59],v55 offset:30856
mma v[116:119],a[8:11],a[152:155],v[116:119]
ldt a[60:61],v55 offset:37000
mma v[116:119],a[12:15],a[168:171],v[116:119]
ldt a[62:63],v55 offset:43144
mma v[164:167],a[12:15],a[164:167],v[164:167]
ldt a[64:65],v54 offset:24832
mma v[164:167],a[8:11],a[148:151],v[164:167]
ldt a[66:67],v54 offset:30976
mma v[68:71],a[8:11],a[144:147],v[68:71]
ldt a[68:69],v54 offset:37120
mma v[68:71],a[12:15],a[160:163],v[68:71]
ldt a[70:71],v54 offset:43264
mma v[72:75],a[16:19],a[144:147],v[72:75]
ldt a[72:73],v54 offset:24840
mma v[72:75],a[20:23],a[160:163],v[72:75]
ldt a[74:75],v54 offset:30984
mma v[168:171],a[20:23],a[164:167],v[168:171]
s_add_u32 m0, s27, 36864
s_add_u32 s31, s28, 1024
bld v51,s[4:7],s31 offen lds
ldt a[76:77],v54 offset:37128
mma v[168:171],a[16:19],a[148:151],v[168:171]
ldt a[78:79],v54 offset:43272
mma v[120:123],a[16:19],a[152:155],v[120:123]
ldt a[80:81],v55 offset:24832
mma v[120:123],a[20:23],a[168:171],v[120:123]
s_add_u32 s31, s28, 10240
bld v51,s[4:7],s31 offen offset:1024 lds
ldt a[82:83],v55 offset:30976
mma v[124:127],a[24:27],a[152:155],v[124:127]
mma v[124:127],a[28:31],a[168:171],v[124:127]
s_add_u32 m0, s27, 38912
ldt a[84:85],v55 offset:37120
mma v[172:175],a[28:31],a[164:167],v[172:175]
s_add_u32 s31, s28, 21504
bld v51,s[4:7],s31 offen lds
ldt a[86:87],v55 offset:43264
mma v[172:175],a[24:27],a[148:151],v[172:175]
ldt a[88:89],v55 offset:24840
mma v[76:79],a[24:27],a[144:147],v[76:79]
ldt a[90:91],v55 offset:30984
mma v[76:79],a[28:31],a[160:163],v[76:79]
mma v[80:83],a[32:35],a[144:147],v[80:83]
s_add_u32 s31, s28, 30720
bld v51,s[4:7],s31 offen offset:1024 lds
ldt a[92:93],v55 offset:37128
mma v[80:83],a[36:39],a[160:163],v[80:83]
ldt a[94:95],v55 offset:43272
mma v[176:179],a[36:39],a[164:167],v[176:179]
s_add_u32 m0, s27, 40960
mma v[176:179],a[32:35],a[148:151],v[176:179]
s_add_u32 s31, s28, 41984
bld v51,s[4:7],s31 offen lds
mma v[128:131],a[32:35],a[152:155],v[128:131]
mma v[128:131],a[36:39],a[168:171],v[128:131]
s_waitcnt lgkmcnt(14)
mma v[132:135],a[40:43],a[152:155],v[132:135]
s_add_u32 s31, s28, 51200
bld v51,s[4:7],s31 offen offset:1024 lds
mma v[132:135],a[44:47],a[168:171],v[132:135]
mma v[180:183],a[44:47],a[164:167],v[180:183]
mma v[180:183],a[40:43],a[148:151],v[180:183]
mma v[84:87],a[40:43],a[144:147],v[84:87]
mma v[84:87],a[44:47],a[160:163],v[84:87]
mma v[88:91],a[48:51],a[144:147],v[88:91]
s_waitcnt vmcnt(6) lgkmcnt(0)
s_barrier
mma v[88:91],a[52:55],a[160:163],v[88:91]
s_mov_b32 s31, 23040
buffer_load_dword v45, v31, s[48:51], s31 offen
ldt a[96:97],v54
mma v[184:187],a[52:55],a[164:167],v[184:187]
global_load_dword v45, v27, s[44:45]
ldt a[98:99],v54 offset:6144
mma v[184:187],a[48:51],a[148:151],v[184:187]
s_mov_b32 m0, 27648
s_mov_b32 s31, 49152
bld v10,s[8:11],s31 offen offset:2048 nt lds
ldt a[100:101],v54 offset:12288
mma v[136:139],a[48:51],a[152:155],v[136:139]
s_mov_b32 m0, 30720
s_mov_b32 s31, 18432
bld v8,s[8:11],s31 offen nt lds
ldt a[102:103],v54 offset:18432
mma v[136:139],a[52:55],a[168:171],v[136:139]
bld v9,s[8:11],s31 offen offset:1024 nt lds
mma v[140:143],a[56:59],a[152:155],v[140:143]
bld v10,s[8:11],s31 offen offset:2048 nt lds
ldt a[104:105],v54 offset:8
mma v[140:143],a[60:63],a[168:171],v[140:143]
s_mov_b32 m0, 33792
s_mov_b32 s31, 52224
bld v8,s[8:11],s31 offen nt lds
ldt a[106:107],v54 offset:6152
mma v[188:191],a[60:63],a[164:167],v[188:191]
bld v9,s[8:11],s31 offen offset:1024 nt lds
ldt a[108:109],v54 offset:12296
mma v[188:191],a[56:59],a[148:151],v[188:191]
bld v10,s[8:11],s31 offen offset:2048 nt lds
ldt a[110:111],v54 offset:18440
mma v[92:95],a[56:59],a[144:147],v[92:95]
s_mov_b32 m0, 36864
s_mov_b32 s31, 21504
bld v8,s[8:11],s31 offen nt lds
mma v[92:95],a[60:63],a[160:163],v[92:95]
bld v9,s[8:11],s31 offen offset:1024 nt lds
ldt a[0:1],v55
mma v[96:99],a[64:67],a[144:147],v[96:99]
bld v10,s[8:11],s31 offen offset:2048 nt lds
ldt a[2:3],v55 offset:6144
mma v[96:99],a[68:71],a[160:163],v[96:99]
s_mov_b32 m0, 39936
s_mov_b32 s31, 55296
bld v8,s[8:11],s31 offen nt lds
ldt a[4:5],v55 offset:12288
mma v[192:195],a[68:71],a[164:167],v[192:195]
bld v9,s[8:11],s31 offen offset:1024 nt lds
ldt a[6:7],v55 offset:18432
mma v[192:195],a[64:67],a[148:151],v[192:195]
s_add_u32 m0, s30, 24576
s_add_u32 s31, s29, 7077888
bld v48,s[16:19],s31 offen lds
mma v[144:147],a[64:67],a[152:155],v[144:147]
ldt a[8:9],v55 offset:8
mma v[144:147],a[68:71],a[168:171],v[144:147]
ldt a[10:11],v55 offset:6152
mma v[148:151],a[72:75],a[152:155],v[148:151]
mma v[148:151],a[76:79],a[168:171],v[148:151]
ldt a[12:13],v55 offset:12296
mma v[196:199],a[76:79],a[164:167],v[196:199]
bld v49,s[16:19],s31 offen offset:1024 lds
ldt a[14:15],v55 offset:18440
mma v[196:199],a[72:75],a[148:151],v[196:199]
ldt a[16:17],v54 offset:128
mma v[100:103],a[72:75],a[144:147],v[100:103]
ldt a[18:19],v54 offset:6272
mma v[100:103],a[76:79],a[160:163],v[100:103]
mma v[104:107],a[80:83],a[144:147],v[104:107]
ldt a[20:21],v54 offset:12416
mma v[104:107],a[84:87],a[160:163],v[104:107]
bld v50,s[16:19],s31 offen offset:2048 lds
ldt a[22:23],v54 offset:18560
mma v[200:203],a[84:87],a[164:167],v[200:203]
s_waitcnt vmcnt(17)
ldq a[112:115],v52 offset:36864
mma v[200:203],a[80:83],a[148:151],v[200:203]
ldq a[116:119],v52 offset:38912
mma v[152:155],a[80:83],a[152:155],v[152:155]
ldq a[120:123],v52 offset:40960
mma v[152:155],a[84:87],a[168:171],v[152:155]
ldq a[128:131],v53 offset:36864
mma v[156:159],a[88:91],a[152:155],v[156:159]
s_add_u32 m0, s30, 36864
ldq a[132:135],v53 offset:38912
mma v[156:159],a[92:95],a[168:171],v[156:159]
s_add_u32 s31, s29, 7471104
ldq a[136:139],v53 offset:40960
bld v48,s[16:19],s31 offen lds
mma v[204:207],a[92:95],a[164:167],v[204:207]
ldt a[24:25],v54 offset:136
mma v[204:207],a[88:91],a[148:151],v[204:207]
ldt a[26:27],v54 offset:6280
mma v[108:111],a[88:91],a[144:147],v[108:111]
ldt a[28:29],v54 offset:12424
mma v[108:111],a[92:95],a[160:163],v[108:111]
s_waitcnt lgkmcnt(8)
ldt a[30:31],v54 offset:18568
mma v[64:67],a[96:99],a[112:115],v[64:67]
s_waitcnt lgkmcnt(6)
bld v49,s[16:19],s31 offen offset:1024 lds
ldt a[32:33],v55 offset:128
mma v[64:67],a[100:103],a[128:131],v[64:67]
s_waitcnt lgkmcnt(6)
ldt a[34:35],v55 offset:6272
mma v[160:163],a[100:103],a[132:135],v[160:163]
ldt a[36:37],v55 offset:12416
mma v[160:163],a[96:99],a[116:119],v[160:163]
ldt a[38:39],v55 offset:18560
mma v[112:115],a[96:99],a[120:123],v[112:115]
s_waitcnt lgkmcnt(8)
ldt a[40:41],v55 offset:136
mma v[112:115],a[100:103],a[136:139],v[112:115]
bld v50,s[16:19],s31 offen offset:2048 lds
ldt a[42:43],v55 offset:6280
mma v[116:119],a[104:107],a[120:123],v[116:119]
ldt a[44:45],v55 offset:12424
mma v[116:119],a[108:111],a[136:139],v[116:119]
ldt a[46:47],v55 offset:18568
mma v[164:167],a[108:111],a[132:135],v[164:167]
ldt a[48:49],v54 offset:256
mma v[164:167],a[104:107],a[116:119],v[164:167]
ldt a[50:51],v54 offset:6400
mma v[68:71],a[104:107],a[112:115],v[68:71]
ldt a[52:53],v54 offset:12544
mma v[68:71],a[108:111],a[128:131],v[68:71]
ldt a[54:55],v54 offset:18688
mma v[72:75],a[0:3],a[112:115],v[72:75]
ldt a[56:57],v54 offset:264
mma v[72:75],a[4:7],a[128:131],v[72:75]
ldt a[58:59],v54 offset:6408
mma v[168:171],a[4:7],a[132:135],v[168:171]
s_add_u32 m0, s27, 36864
s_add_u32 s31, s28, 1152
bld v51,s[4:7],s31 offen lds
ldt a[60:61],v54 offset:12552
mma v[168:171],a[0:3],a[116:119],v[168:171]
ldt a[62:63],v54 offset:18696
mma v[120:123],a[0:3],a[120:123],v[120:123]
ldt a[64:65],v55 offset:256
mma v[120:123],a[4:7],a[136:139],v[120:123]
s_add_u32 s31, s28, 10368
bld v51,s[4:7],s31 offen offset:1024 lds
ldt a[66:67],v55 offset:6400
mma v[124:127],a[8:11],a[120:123],v[124:127]
mma v[124:127],a[12:15],a[136:139],v[124:127]
s_add_u32 m0, s27, 38912
ldt a[68:69],v55 offset:12544
mma v[172:175],a[12:15],a[132:135],v[172:175]
s_add_u32 s31, s28, 21632
bld v51,s[4:7],s31 offen lds
ldt a[70:71],v55 offset:18688
mma v[172:175],a[8:11],a[116:119],v[172:175]
ldt a[72:73],v55 offset:264
mma v[76:79],a[8:11],a[112:115],v[76:79]
ldt a[74:75],v55 offset:6408
mma v[76:79],a[12:15],a[128:131],v[76:79]
mma v[80:83],a[16:19],a[112:115],v[80:83]
s_add_u32 s31, s28, 30848
bld v51,s[4:7],s31 offen offset:1024 lds
ldt a[76:77],v55 offset:12552
mma v[80:83],a[20:23],a[128:131],v[80:83]
ldt a[78:79],v55 offset:18696
mma v[176:179],a[20:23],a[132:135],v[176:179]
s_add_u32 m0, s27, 40960
mma v[176:179],a[16:19],a[116:119],v[176:179]
s_add_u32 s31, s28, 42112
bld v51,s[4:7],s31 offen lds
mma v[128:131],a[16:19],a[120:123],v[128:131]
mma v[128:131],a[20:23],a[136:139],v[128:131]
s_waitcnt lgkmcnt(14)
mma v[132:135],a[24:27],a[120:123],v[132:135]
s_add_u32 s31, s28, 51328
bld v51,s[4:7],s31 offen offset:1024 lds
mma v[132:135],a[28:31],a[136:139],v[132:135]
mma v[180:183],a[28:31],a[132:135],v[180:183]
mma v[180:183],a[24:27],a[116:119],v[180:183]
mma v[84:87],a[24:27],a[112:115],v[84:87]
mma v[84:87],a[28:31],a[128:131],v[84:87]
mma v[88:91],a[32:35],a[112:115],v[88:91]
s_waitcnt vmcnt(6) lgkmcnt(0)
s_barrier
mma v[88:91],a[36:39],a[128:131],v[88:91]
ldt a[80:81],v54 offset:24576
ldt a[82:83],v54 offset:30720
s_mov_b32 s31, 26880
buffer_load_dword v45, v31, s[48:51], s31 offen
mma v[184:187],a[36:39],a[132:135],v[184:187]
ldt a[84:85],v54 offset:36864
ldt a[86:87],v54 offset:43008
s_mov_b32 m0, 39936
s_mov_b32 s31, 55296
bld v10,s[8:11],s31 offen offset:2048 nt lds
mma v[184:187],a[32:35],a[116:119],v[184:187]
ldt a[88:89],v54 offset:24584
ldt a[90:91],v54 offset:30728
s_mov_b32 m0, 43008
s_mov_b32 s31, 24576
bld v8,s[8:11],s31 offen nt lds
mma v[136:139],a[32:35],a[120:123],v[136:139]
ldt a[92:93],v54 offset:36872
ldt a[94:95],v54 offset:43016
mma v[136:139],a[36:39],a[136:139],v[136:139]
ldt a[96:97],v55 offset:24576
ldt a[98:99],v55 offset:30720
bld v9,s[8:11],s31 offen offset:1024 nt lds
mma v[140:143],a[40:43],a[120:123],v[140:143]
ldt a[100:101],v55 offset:36864
ldt a[102:103],v55 offset:43008
bld v10,s[8:11],s31 offen offset:2048 nt lds
mma v[140:143],a[44:47],a[136:139],v[140:143]
ldt a[104:105],v55 offset:24584
ldt a[106:107],v55 offset:30728
mma v[188:191],a[44:47],a[132:135],v[188:191]
ldt a[108:109],v55 offset:36872
ldt a[110:111],v55 offset:43016
s_mov_b32 m0, 46080
s_mov_b32 s31, 58368
bld v8,s[8:11],s31 offen nt lds
mma v[188:191],a[40:43],a[116:119],v[188:191]
ldt a[0:1],v54 offset:24704
ldt a[2:3],v54 offset:30848
bld v9,s[8:11],s31 offen offset:1024 nt lds
mma v[92:95],a[40:43],a[112:115],v[92:95]
ldt a[4:5],v54 offset:36992
ldt a[6:7],v54 offset:43136
mma v[92:95],a[44:47],a[128:131],v[92:95]
ldt a[8:9],v54 offset:24712
ldt a[10:11],v54 offset:30856
mma v[96:99],a[48:51],a[112:115],v[96:99]
ldt a[12:13],v54 offset:37000
ldt a[14:15],v54 offset:43144
mma v[96:99],a[52:55],a[128:131],v[96:99]
bld v10,s[8:11],s31 offen offset:2048 nt lds
s_mov_b32 m0, 110592
s_mov_b32 s31, 12288
bld v8,s[12:15],s31 offen nt lds
bld v9,s[12:15],s31 offen offset:1024 nt lds
mma v[192:195],a[52:55],a[132:135],v[192:195]
ldt a[16:17],v55 offset:24704
ldt a[18:19],v55 offset:30848
mma v[192:195],a[48:51],a[116:119],v[192:195]
ldt a[20:21],v55 offset:36992
ldt a[22:23],v55 offset:43136
bld v10,s[12:15],s31 offen offset:2048 nt lds
mma v[144:147],a[48:51],a[120:123],v[144:147]
ldt a[24:25],v55 offset:24712
ldt a[26:27],v55 offset:30856
s_mov_b32 m0, 113664
s_mov_b32 s31, 46080
bld v8,s[12:15],s31 offen nt lds
mma v[144:147],a[52:55],a[136:139],v[144:147]
ldt a[28:29],v55 offset:37000
ldt a[30:31],v55 offset:43144
bld v9,s[12:15],s31 offen offset:1024 nt lds
mma v[148:151],a[56:59],a[120:123],v[148:151]
ldt a[32:33],v54 offset:24832
ldt a[34:35],v54 offset:30976
mma v[148:151],a[60:63],a[136:139],v[148:151]
ldt a[36:37],v54 offset:37120
ldt a[38:39],v54 offset:43264
bld v10,s[12:15],s31 offen offset:2048 nt lds
mma v[196:199],a[60:63],a[132:135],v[196:199]
ldt a[40:41],v54 offset:24840
ldt a[42:43],v54 offset:30984
s_mov_b32 m0, 116736
s_mov_b32 s31, 15360
bld v8,s[12:15],s31 offen nt lds
mma v[196:199],a[56:59],a[116:119],v[196:199]
ldt a[44:45],v54 offset:37128
ldt a[46:47],v54 offset:43272
mma v[100:103],a[56:59],a[112:115],v[100:103]
ldt a[48:49],v55 offset:24832
ldt a[50:51],v55 offset:30976
bld v9,s[12:15],s31 offen offset:1024 nt lds
mma v[100:103],a[60:63],a[128:131],v[100:103]
ldt a[52:53],v55 offset:37120
ldt a[54:55],v55 offset:43264
mma v[104:107],a[64:67],a[112:115],v[104:107]
ldt a[56:57],v55 offset:24840
ldt a[58:59],v55 offset:30984
mma v[104:107],a[68:71],a[128:131],v[104:107]
ldt a[60:61],v55 offset:37128
ldt a[62:63],v55 offset:43272
mma v[200:203],a[68:71],a[132:135],v[200:203]
s_waitcnt vmcnt(16)
ldq a[144:147],v52 offset:36864
bld v10,s[12:15],s31 offen offset:2048 nt lds
mma v[200:203],a[64:67],a[116:119],v[200:203]
s_mov_b32 m0, 119808
s_mov_b32 s31, 49152
ldq a[148:151],v52 offset:38912
bld v8,s[12:15],s31 offen nt lds
mma v[152:155],a[64:67],a[120:123],v[152:155]
ldq a[152:155],v52 offset:40960
bld v9,s[12:15],s31 offen offset:1024 nt lds
mma v[152:155],a[68:71],a[136:139],v[152:155]
ldq a[160:163],v53 offset:36864
bld v10,s[12:15],s31 offen offset:2048 nt lds
mma v[156:159],a[72:75],a[120:123],v[156:159]
s_mov_b32 m0, 122880
s_mov_b32 s31, 18432
ldq a[164:167],v53 offset:38912
bld v8,s[12:15],s31 offen nt lds
mma v[156:159],a[76:79],a[136:139],v[156:159]
ldq a[168:171],v53 offset:40960
bld v9,s[12:15],s31 offen offset:1024 nt lds
mma v[204:207],a[76:79],a[132:135],v[204:207]
buffer_store_dwordx4 v[32:35], v21, s[20:23], s87 offen sc1
mma v[204:207],a[72:75],a[116:119],v[204:207]
mma v[108:111],a[72:75],a[112:115],v[108:111]
s_waitcnt lgkmcnt(0)
s_barrier
mma v[108:111],a[76:79],a[128:131],v[108:111]
mma v[64:67],a[80:83],a[144:147],v[64:67]
mma v[64:67],a[84:87],a[160:163],v[64:67]
ldq a[192:195],v60
mma v[68:71],a[92:95],a[160:163],v[68:71]
ldq a[196:199],v61
mma v[68:71],a[88:91],a[144:147],v[68:71]
s_mov_b32 m0, 122880
s_mov_b32 s31, 18432
bld v10,s[12:15],s31 offen offset:2048 nt lds
mma v[72:75],a[96:99],a[144:147],v[72:75]
mma v[72:75],a[100:103],a[160:163],v[72:75]
ldq a[200:203],v60 offset:128
mma v[76:79],a[108:111],a[160:163],v[76:79]
ldq a[204:207],v61 offset:128
mma v[76:79],a[104:107],a[144:147],v[76:79]
s_mov_b32 m0, 125952
s_mov_b32 s31, 52224
bld v8,s[12:15],s31 offen nt lds
mma v[80:83],a[0:3],a[144:147],v[80:83]
ldq a[208:211],v60 offset:256
mma v[80:83],a[4:7],a[160:163],v[80:83]
mma v[84:87],a[12:15],a[160:163],v[84:87]
ldq a[212:215],v61 offset:256
mma v[84:87],a[8:11],a[144:147],v[84:87]
bld v9,s[12:15],s31 offen offset:1024 nt lds
mma v[88:91],a[16:19],a[144:147],v[88:91]
ldq a[216:219],v2
mma v[88:91],a[20:23],a[160:163],v[88:91]
bld v10,s[12:15],s31 offen offset:2048 nt lds
mma v[92:95],a[28:31],a[160:163],v[92:95]
mma v[92:95],a[24:27],a[144:147],v[92:95]
ldq a[220:223],v3
mma v[96:99],a[32:35],a[144:147],v[96:99]
ldq a[224:227],v2 offset:128
mma v[96:99],a[36:39],a[160:163],v[96:99]
s_mov_b32 m0, 129024
s_mov_b32 s31, 21504
bld v8,s[12:15],s31 offen nt lds
mma v[100:103],a[44:47],a[160:163],v[100:103]
ldq a[228:231],v3 offset:128
mma v[100:103],a[40:43],a[144:147],v[100:103]
mma v[104:107],a[48:51],a[144:147],v[104:107]
ldq a[232:235],v2 offset:256
mma v[104:107],a[52:55],a[160:163],v[104:107]
bld v9,s[12:15],s31 offen offset:1024 nt lds
mma v[108:111],a[60:63],a[160:163],v[108:111]
ldq a[236:239],v3 offset:256
mma v[108:111],a[56:59],a[144:147],v[108:111]
bld v10,s[12:15],s31 offen offset:2048 nt lds
mma v[160:163],a[80:83],a[148:151],v[160:163]
v_mul_f32 v64, s32, v64
v_mul_f32 v65, s32, v65
v_mul_f32 v66, s32, v66
mma v[160:163],a[84:87],a[164:167],v[160:163]
v_mul_f32 v67, s32, v67
v_mul_f32 v68, s32, v68
v_mul_f32 v69, s32, v69
mma v[164:167],a[92:95],a[164:167],v[164:167]
v_mul_f32 v70, s32, v70
v_mul_f32 v71, s32, v71
s_mov_b32 m0, 132096
s_mov_b32 s31, 55296
bld v8,s[12:15],s31 offen nt lds
cvt v64,v64,v65
mma v[164:167],a[88:91],a[148:151],v[164:167]
cvt v65,v66,v67
cvt v66,v68,v69
cvt v67,v70,v71
mma v[168:171],a[96:99],a[148:151],v[168:171]
v_mul_f32 v72, s32, v72
v_mul_f32 v73, s32, v73
v_mul_f32 v74, s32, v74
mma v[168:171],a[100:103],a[164:167],v[168:171]
v_mul_f32 v75, s32, v75
bld v9,s[12:15],s31 offen offset:1024 nt lds
v_mul_f32 v76, s32, v76
v_mul_f32 v77, s32, v77
mma v[172:175],a[108:111],a[164:167],v[172:175]
v_mul_f32 v78, s32, v78
v_mul_f32 v79, s32, v79
cvt v68,v72,v73
mma v[172:175],a[104:107],a[148:151],v[172:175]
cvt v69,v74,v75
cvt v70,v76,v77
cvt v71,v78,v79
bld v10,s[12:15],s31 offen offset:2048 nt lds
mma v[176:179],a[0:3],a[148:151],v[176:179]
v_mul_f32 v80, s32, v80
v_mul_f32 v81, s32, v81
v_mul_f32 v82, s32, v82
mma v[176:179],a[4:7],a[164:167],v[176:179]
v_mul_f32 v83, s32, v83
v_mul_f32 v84, s32, v84
v_mul_f32 v85, s32, v85
mma v[180:183],a[12:15],a[164:167],v[180:183]
v_mul_f32 v86, s32, v86
v_mul_f32 v87, s32, v87
s_mov_b32 m0, 49152
s_mov_b32 s31, 27648
bld v8,s[8:11],s31 offen nt lds
cvt v72,v80,v81
mma v[180:183],a[8:11],a[148:151],v[180:183]
cvt v73,v82,v83
cvt v74,v84,v85
cvt v75,v86,v87
mma v[184:187],a[16:19],a[148:151],v[184:187]
v_mul_f32 v88, s32, v88
v_mul_f32 v89, s32, v89
v_mul_f32 v90, s32, v90
mma v[184:187],a[20:23],a[164:167],v[184:187]
v_mul_f32 v91, s32, v91
bld v9,s[8:11],s31 offen offset:1024 nt lds
v_mul_f32 v92, s32, v92
v_mul_f32 v93, s32, v93
mma v[188:191],a[28:31],a[164:167],v[188:191]
v_mul_f32 v94, s32, v94
v_mul_f32 v95, s32, v95
cvt v76,v88,v89
mma v[188:191],a[24:27],a[148:151],v[188:191]
cvt v77,v90,v91
cvt v78,v92,v93
cvt v79,v94,v95
bld v10,s[8:11],s31 offen offset:2048 nt lds
mma v[192:195],a[32:35],a[148:151],v[192:195]
v_mul_f32 v96, s32, v96
v_mul_f32 v97, s32, v97
v_mul_f32 v98, s32, v98
mma v[192:195],a[36:39],a[164:167],v[192:195]
v_mul_f32 v99, s32, v99
v_mul_f32 v100, s32, v100
v_mul_f32 v101, s32, v101
mma v[196:199],a[44:47],a[164:167],v[196:199]
v_mul_f32 v102, s32, v102
v_mul_f32 v103, s32, v103
s_mov_b32 m0, 52224
s_mov_b32 s31, 61440
bld v8,s[8:11],s31 offen nt lds
cvt v80,v96,v97
mma v[196:199],a[40:43],a[148:151],v[196:199]
cvt v81,v98,v99
cvt v82,v100,v101
cvt v83,v102,v103
mma v[200:203],a[48:51],a[148:151],v[200:203]
v_mul_f32 v104, s32, v104
v_mul_f32 v105, s32, v105
v_mul_f32 v106, s32, v106
mma v[200:203],a[52:55],a[164:167],v[200:203]
v_mul_f32 v107, s32, v107
bld v9,s[8:11],s31 offen offset:1024 nt lds
v_mul_f32 v108, s32, v108
v_mul_f32 v109, s32, v109
mma v[204:207],a[60:63],a[164:167],v[204:207]
v_mul_f32 v110, s32, v110
v_mul_f32 v111, s32, v111
cvt v84,v104,v105
mma v[204:207],a[56:59],a[148:151],v[204:207]
cvt v85,v106,v107
cvt v86,v108,v109
cvt v87,v110,v111
bld v10,s[8:11],s31 offen offset:2048 nt lds
mma v[112:115],a[80:83],a[152:155],v[112:115]
v_mul_f32 v160, s32, v160
v_mul_f32 v161, s32, v161
v_mul_f32 v162, s32, v162
mma v[112:115],a[84:87],a[168:171],v[112:115]
v_mul_f32 v163, s32, v163
v_mul_f32 v164, s32, v164
v_mul_f32 v165, s32, v165
s_mov_b32 m0, 55296
s_mov_b32 s31, 30720
bld v8,s[8:11],s31 offen nt lds
mma v[116:119],a[92:95],a[168:171],v[116:119]
v_mul_f32 v166, s32, v166
v_mul_f32 v167, s32, v167
cvt v88,v160,v161
mma v[116:119],a[88:91],a[152:155],v[116:119]
cvt v89,v162,v163
cvt v90,v164,v165
cvt v91,v166,v167
bld v9,s[8:11],s31 offen offset:1024 nt lds
mma v[120:123],a[96:99],a[152:155],v[120:123]
v_mul_f32 v168, s32, v168
v_mul_f32 v169, s32, v169
v_mul_f32 v170, s32, v170
mma v[120:123],a[100:103],a[168:171],v[120:123]
v_mul_f32 v171, s32, v171
v_mul_f32 v172, s32, v172
v_mul_f32 v173, s32, v173
bld v10,s[8:11],s31 offen offset:2048 nt lds
mma v[124:127],a[108:111],a[168:171],v[124:127]
v_mul_f32 v174, s32, v174
v_mul_f32 v175, s32, v175
cvt v92,v168,v169
mma v[124:127],a[104:107],a[152:155],v[124:127]
cvt v93,v170,v171
cvt v94,v172,v173
cvt v95,v174,v175
s_mov_b32 m0, 58368
s_mov_b32 s31, 64512
bld v8,s[8:11],s31 offen nt lds
mma v[128:131],a[0:3],a[152:155],v[128:131]
v_mul_f32 v176, s32, v176
v_mul_f32 v177, s32, v177
v_mul_f32 v178, s32, v178
mma v[128:131],a[4:7],a[168:171],v[128:131]
v_mul_f32 v179, s32, v179
v_mul_f32 v180, s32, v180
v_mul_f32 v181, s32, v181
bld v9,s[8:11],s31 offen offset:1024 nt lds
mma v[132:135],a[12:15],a[168:171],v[132:135]
v_mul_f32 v182, s32, v182
v_mul_f32 v183, s32, v183
cvt v96,v176,v177
mma v[132:135],a[8:11],a[152:155],v[132:135]
cvt v97,v178,v179
cvt v98,v180,v181
cvt v99,v182,v183
bld v10,s[8:11],s31 offen offset:2048 nt lds
mma v[136:139],a[16:19],a[152:155],v[136:139]
v_mul_f32 v184, s32, v184
v_mul_f32 v185, s32, v185
v_mul_f32 v186, s32, v186
mma v[136:139],a[20:23],a[168:171],v[136:139]
v_mul_f32 v187, s32, v187
v_mul_f32 v188, s32, v188
v_mul_f32 v189, s32, v189
s_mov_b32 m0, 61440
s_mov_b32 s31, 98304
bld v8,s[8:11],s31 offen nt lds
mma v[140:143],a[28:31],a[168:171],v[140:143]
v_mul_f32 v190, s32, v190
v_mul_f32 v191, s32, v191
cvt v100,v184,v185
mma v[140:143],a[24:27],a[152:155],v[140:143]
cvt v101,v186,v187
cvt v102,v188,v189
cvt v103,v190,v191
bld v9,s[8:11],s31 offen offset:1024 nt lds
mma v[144:147],a[32:35],a[152:155],v[144:147]
v_mul_f32 v192, s32, v192
v_mul_f32 v193, s32, v193
v_mul_f32 v194, s32, v194
mma v[144:147],a[36:39],a[168:171],v[144:147]
v_mul_f32 v195, s32, v195
v_mul_f32 v196, s32, v196
v_mul_f32 v197, s32, v197
bld v10,s[8:11],s31 offen offset:2048 nt lds
mma v[148:151],a[44:47],a[168:171],v[148:151]
v_mul_f32 v198, s32, v198
v_mul_f32 v199, s32, v199
cvt v104,v192,v193
mma v[148:151],a[40:43],a[152:155],v[148:151]
cvt v105,v194,v195
cvt v106,v196,v197
cvt v107,v198,v199
s_mov_b32 m0, 64512
s_mov_b32 s31, 67584
bld v8,s[8:11],s31 offen nt lds
mma v[152:155],a[48:51],a[152:155],v[152:155]
v_mul_f32 v200, s32, v200
v_mul_f32 v201, s32, v201
v_mul_f32 v202, s32, v202
mma v[152:155],a[52:55],a[168:171],v[152:155]
v_mul_f32 v203, s32, v203
v_mul_f32 v204, s32, v204
v_mul_f32 v205, s32, v205
bld v9,s[8:11],s31 offen offset:1024 nt lds
mma v[156:159],a[60:63],a[168:171],v[156:159]
v_mul_f32 v206, s32, v206
v_mul_f32 v207, s32, v207
cvt v108,v200,v201
mma v[156:159],a[56:59],a[152:155],v[156:159]
cvt v109,v202,v203
cvt v110,v204,v205
cvt v111,v206,v207
bld v10,s[8:11],s31 offen offset:2048 nt lds
s_waitcnt lgkmcnt(11)
mma v[160:163],a[192:195],v[64:67],0
s_waitcnt lgkmcnt(10)
v_mul_f32 v112, s32, v112
v_mul_f32 v113, s32, v113
v_mul_f32 v114, s32, v114
mma v[160:163],a[196:199],v[68:71],v[160:163]
s_waitcnt lgkmcnt(9)
v_mul_f32 v115, s32, v115
v_mul_f32 v116, s32, v116
v_mul_f32 v117, s32, v117
mma v[160:163],a[200:203],v[72:75],v[160:163]
v_mul_f32 v118, s32, v118
v_mul_f32 v119, s32, v119
s_mov_b32 m0, 67584
s_mov_b32 s31, 101376
s_waitcnt lgkmcnt(8)
bld v8,s[8:11],s31 offen nt lds
cvt v112,v112,v113
mma v[160:163],a[204:207],v[76:79],v[160:163]
s_waitcnt lgkmcnt(7)
cvt v113,v114,v115
cvt v114,v116,v117
cvt v115,v118,v119
mma v[160:163],a[208:211],v[80:83],v[160:163]
s_waitcnt lgkmcnt(6)
v_mul_f32 v120, s32, v120
v_mul_f32 v121, s32, v121
v_mul_f32 v122, s32, v122
mma v[160:163],a[212:215],v[84:87],v[160:163]
v_mul_f32 v123, s32, v123
bld v9,s[8:11],s31 offen offset:1024 nt lds
v_mul_f32 v124, s32, v124
v_mul_f32 v125, s32, v125
s_waitcnt lgkmcnt(5)
mma v[176:179],a[216:219],v[64:67],0
s_waitcnt lgkmcnt(4)
v_mul_f32 v126, s32, v126
v_mul_f32 v127, s32, v127
cvt v116,v120,v121
mma v[176:179],a[220:223],v[68:71],v[176:179]
cvt v117,v122,v123
cvt v118,v124,v125
cvt v119,v126,v127
bld v10,s[8:11],s31 offen offset:2048 nt lds
s_waitcnt lgkmcnt(3)
mma v[176:179],a[224:227],v[72:75],v[176:179]
s_waitcnt lgkmcnt(2)
v_mul_f32 v128, s32, v128
v_mul_f32 v129, s32, v129
v_mul_f32 v130, s32, v130
mma v[176:179],a[228:231],v[76:79],v[176:179]
s_waitcnt lgkmcnt(1)
v_mul_f32 v131, s32, v131
v_mul_f32 v132, s32, v132
v_mul_f32 v133, s32, v133
mma v[176:179],a[232:235],v[80:83],v[176:179]
v_mul_f32 v134, s32, v134
v_mul_f32 v135, s32, v135
s_mov_b32 m0, 70656
s_mov_b32 s31, 70656
s_waitcnt lgkmcnt(0)
bld v8,s[8:11],s31 offen nt lds
cvt v120,v128,v129
mma v[176:179],a[236:239],v[84:87],v[176:179]
cvt v121,v130,v131
cvt v122,v132,v133
cvt v123,v134,v135
mma v[164:167],a[192:195],v[88:91],0
v_mul_f32 v136, s32, v136
v_mul_f32 v137, s32, v137
v_mul_f32 v138, s32, v138
mma v[164:167],a[196:199],v[92:95],v[164:167]
v_mul_f32 v139, s32, v139
bld v9,s[8:11],s31 offen offset:1024 nt lds
v_mul_f32 v140, s32, v140
v_mul_f32 v141, s32, v141
mma v[164:167],a[200:203],v[96:99],v[164:167]
v_mul_f32 v142, s32, v142
v_mul_f32 v143, s32, v143
cvt v124,v136,v137
mma v[164:167],a[204:207],v[100:103],v[164:167]
cvt v125,v138,v139
cvt v126,v140,v141
cvt v127,v142,v143
bld v10,s[8:11],s31 offen offset:2048 nt lds
mma v[164:167],a[208:211],v[104:107],v[164:167]
v_mul_f32 v144, s32, v144
v_mul_f32 v145, s32, v145
v_mul_f32 v146, s32, v146
mma v[164:167],a[212:215],v[108:111],v[164:167]
v_mul_f32 v147, s32, v147
v_mul_f32 v148, s32, v148
v_mul_f32 v149, s32, v149
mma v[180:183],a[216:219],v[88:91],0
v_mul_f32 v150, s32, v150
v_mul_f32 v151, s32, v151
s_mov_b32 m0, 135168
s_mov_b32 s31, 24576
bld v8,s[12:15],s31 offen nt lds
cvt v128,v144,v145
mma v[180:183],a[220:223],v[92:95],v[180:183]
cvt v129,v146,v147
cvt v130,v148,v149
cvt v131,v150,v151
mma v[180:183],a[224:227],v[96:99],v[180:183]
v_mul_f32 v152, s32, v152
v_mul_f32 v153, s32, v153
v_mul_f32 v154, s32, v154
mma v[180:183],a[228:231],v[100:103],v[180:183]
v_mul_f32 v155, s32, v155
bld v9,s[12:15],s31 offen offset:1024 nt lds
v_mul_f32 v156, s32, v156
v_mul_f32 v157, s32, v157
mma v[180:183],a[232:235],v[104:107],v[180:183]
v_mul_f32 v158, s32, v158
v_mul_f32 v159, s32, v159
cvt v132,v152,v153
mma v[180:183],a[236:239],v[108:111],v[180:183]
cvt v133,v154,v155
cvt v134,v156,v157
cvt v135,v158,v159
bld v10,s[12:15],s31 offen offset:2048 nt lds
mma v[168:171],a[192:195],v[112:115],0
v_max3_f32 v41, v160, v161, v162
v_max3_f32 v41, v41, v163, v176
v_max3_f32 v41, v41, v177, v178
v_max_f32 v41, v41, v179
mma v[168:171],a[196:199],v[116:119],v[168:171]
v_mov_b32 v40, v41
s_nop 1
v_permlane32_swap_b32 v41, v40
s_mov_b32 m0, 138240
s_mov_b32 s31, 58368
bld v8,s[12:15],s31 offen nt lds
v_max_f32 v41, v41, v40
v_mov_b32 v40, v41
mma v[168:171],a[200:203],v[120:123],v[168:171]
s_nop 0
v_permlane16_swap_b32 v41, v40
v_max_f32 v41, v41, v40
v_sub_f32 v160, v160, v41
bld v9,s[12:15],s31 offen offset:1024 nt lds
v_sub_f32 v161, v161, v41
mma v[168:171],a[204:207],v[124:127],v[168:171]
v_sub_f32 v162, v162, v41
v_max3_f32 v42, v164, v165, v166
v_sub_f32 v163, v163, v41
v_sub_f32 v176, v176, v41
mma v[168:171],a[208:211],v[128:131],v[168:171]
bld v10,s[12:15],s31 offen offset:2048 nt lds
v_sub_f32 v177, v177, v41
v_max3_f32 v42, v42, v167, v180
v_sub_f32 v178, v178, v41
v_sub_f32 v179, v179, v41
mma v[168:171],a[212:215],v[132:135],v[168:171]
v_exp_f32 v32, v160
s_mov_b32 m0, 141312
s_mov_b32 s31, 27648
bld v8,s[12:15],s31 offen nt lds
v_max3_f32 v42, v42, v181, v182
v_exp_f32 v33, v161
v_exp_f32 v34, v162
mma v[184:187],a[216:219],v[112:115],0
v_max_f32 v42, v42, v183
v_exp_f32 v35, v163
v_add_f32 v24, v32, v33
bld v9,s[12:15],s31 offen offset:1024 nt lds
mma v[184:187],a[220:223],v[116:119],v[184:187]
cvt v192,v32,v33
v_mov_b32 v40, v42
v_add_f32 v24, v24, v34
cvt v193,v34,v35
v_add_f32 v24, v24, v35
mma v[184:187],a[224:227],v[120:123],v[184:187]
bld v10,s[12:15],s31 offen offset:2048 nt lds
v_permlane32_swap_b32 v42, v40
v_exp_f32 v36, v176
v_exp_f32 v37, v177
v_max_f32 v42, v42, v40
mma v[184:187],a[228:231],v[124:127],v[184:187]
v_exp_f32 v38, v178
s_mov_b32 m0, 144384
s_mov_b32 s31, 61440
bld v8,s[12:15],s31 offen nt lds
v_exp_f32 v39, v179
v_add_f32 v24, v24, v36
mma v[184:187],a[232:235],v[128:131],v[184:187]
v_mov_b32 v40, v42
cvt v194,v36,v37
v_add_f32 v24, v24, v37
bld v9,s[12:15],s31 offen offset:1024 nt lds
v_add_f32 v24, v24, v38
mma v[184:187],a[236:239],v[132:135],v[184:187]
v_permlane16_swap_b32 v42, v40
cvt v195,v38,v39
v_add_f32 v24, v24, v39
v_max_f32 v42, v42, v40
bld v10,s[12:15],s31 offen offset:2048 nt lds
v_sub_f32 v164, v164, v42
v_sub_f32 v165, v165, v42
v_sub_f32 v166, v166, v42
v_max3_f32 v43, v168, v169, v170
v_sub_f32 v167, v167, v42
v_sub_f32 v180, v180, v42
v_sub_f32 v181, v181, v42
v_max3_f32 v43, v43, v171, v184
v_sub_f32 v182, v182, v42
s_mov_b32 m0, 147456
s_mov_b32 s31, 30720
bld v8,s[12:15],s31 offen nt lds
v_sub_f32 v183, v183, v42
v_exp_f32 v32, v164
v_max3_f32 v43, v43, v185, v186
v_exp_f32 v33, v165
v_exp_f32 v34, v166
v_max_f32 v43, v43, v187
v_exp_f32 v35, v167
v_add_f32 v25, v32, v33
bld v9,s[12:15],s31 offen offset:1024 nt lds
cvt v196,v32,v33
v_mov_b32 v40, v43
v_add_f32 v25, v25, v34
cvt v197,v34,v35
v_add_f32 v25, v25, v35
v_permlane32_swap_b32 v43, v40
v_exp_f32 v36, v180
v_exp_f32 v37, v181
bld v10,s[12:15],s31 offen offset:2048 nt lds
v_max_f32 v43, v43, v40
v_exp_f32 v38, v182
v_exp_f32 v39, v183
v_add_f32 v25, v25, v36
v_mov_b32 v40, v43
cvt v198,v36,v37
v_add_f32 v25, v25, v37
v_add_f32 v25, v25, v38
s_mov_b32 m0, 150528
s_mov_b32 s31, 64512
bld v8,s[12:15],s31 offen nt lds
v_permlane16_swap_b32 v43, v40
cvt v199,v38,v39
v_add_f32 v25, v25, v39
v_max_f32 v43, v43, v40
ldq a[192:195],v2 offset:6144
ldq a[196:199],v3 offset:6144
ldq a[200:203],v2 offset:6272
ldq a[204:207],v3 offset:6272
bld v9,s[12:15],s31 offen offset:1024 nt lds
ldq a[208:211],v2 offset:6400
ldq a[212:215],v3 offset:6400
v_sub_f32 v168, v168, v43
v_sub_f32 v169, v169, v43
v_sub_f32 v170, v170, v43
v_sub_f32 v224, 0, v41
v_sub_f32 v171, v171, v43
v_sub_f32 v184, v184, v43
v_sub_f32 v225, 0, v41
bld v10,s[12:15],s31 offen offset:2048 nt lds
v_sub_f32 v185, v185, v43
v_sub_f32 v186, v186, v43
v_sub_f32 v226, 0, v41
v_sub_f32 v187, v187, v43
v_exp_f32 v32, v168
v_sub_f32 v227, 0, v41
v_exp_f32 v33, v169
v_exp_f32 v34, v170
s_mov_b32 m0, 153600
s_mov_b32 s31, 98304
bld v8,s[12:15],s31 offen nt lds
v_exp_f32 v35, v171
v_sub_f32 v228, 0, v42
v_add_f32 v26, v32, v33
cvt v200,v32,v33
v_sub_f32 v229, 0, v42
v_add_f32 v26, v26, v34
cvt v201,v34,v35
v_sub_f32 v230, 0, v42
bld v9,s[12:15],s31 offen offset:1024 nt lds
v_add_f32 v26, v26, v35
v_exp_f32 v36, v184
v_sub_f32 v231, 0, v42
v_exp_f32 v37, v185
v_exp_f32 v38, v186
v_exp_f32 v39, v187
v_sub_f32 v232, 0, v43
v_add_f32 v26, v26, v36
bld v10,s[12:15],s31 offen offset:2048 nt lds
cvt v202,v36,v37
v_sub_f32 v233, 0, v43
v_add_f32 v26, v26, v37
v_add_f32 v26, v26, v38
v_sub_f32 v234, 0, v43
cvt v203,v38,v39
v_add_f32 v26, v26, v39
v_sub_f32 v235, 0, v43
s_mov_b32 m0, 156672
s_mov_b32 s31, 67584
bld v8,s[12:15],s31 offen nt lds
v_add_u32 v2, 12288, v2
v_add_u32 v3, 12288, v3
s_mov_b32 s37, 1
s_mov_b32 s40, 0
s_mov_b32 s43, 12288
s_mov_b32 s42, 24576
s_mov_b32 s35, 7
s_waitcnt vmcnt(56) lgkmcnt(0)
s_barrier
mma v[160:163],a[192:195],v[64:67],v[224:227]
s_mov_b32 m0, 156672
s_mov_b32 s31, 67584
ldq a[216:219],v2
bld v9,s[12:15],s31 offen offset:1024 nt lds
v_add_f32 v28, v28, v24
mma v[160:163],a[196:199],v[68:71],v[160:163]
ldq a[220:223],v3
bld v10,s[12:15],s31 offen offset:2048 nt lds
v_add_f32 v29, v29, v25
mma v[160:163],a[200:203],v[72:75],v[160:163]
s_mov_b32 m0, 73728
ldq a[224:227],v2 offset:128
v_add_f32 v30, v30, v26
mma v[160:163],a[204:207],v[76:79],v[160:163]
s_mov_b32 s31, 104448
ldq a[228:231],v3 offset:128
bld v8,s[8:11],s31 offen nt lds
mma v[160:163],a[208:211],v[80:83],v[160:163]
ldq a[232:235],v2 offset:256
mma v[160:163],a[212:215],v[84:87],v[160:163]
ldq a[236:239],v3 offset:256
bld v9,s[8:11],s31 offen offset:1024 nt lds
mma v[164:167],a[212:215],v[108:111],v[228:231]
bld v10,s[8:11],s31 offen offset:2048 nt lds
mma v[164:167],a[208:211],v[104:107],v[164:167]
s_add_u32 s37, s37, 1
mma v[164:167],a[204:207],v[100:103],v[164:167]
s_cmp_eq_u32 s37, 7
s_cselect_b32 s36, 4294893568, s43
s_cselect_b32 s37, 0, s37
s_mov_b32 m0, 76800
s_mov_b32 s31, 73728
bld v8,s[8:11],s31 offen nt lds
mma v[164:167],a[200:203],v[96:99],v[164:167]
v_exp_f32 v32, v160
v_exp_f32 v33, v161
mma v[164:167],a[196:199],v[92:95],v[164:167]
bld v9,s[8:11],s31 offen offset:1024 nt lds
v_exp_f32 v34, v162
mma v[164:167],a[192:195],v[88:91],v[164:167]
v_exp_f32 v35, v163
v_add_f32 v24, v32, v33
cvt v208,v32,v33
mma v[168:171],a[192:195],v[112:115],v[232:235]
bld v10,s[8:11],s31 offen offset:2048 nt lds
v_add_f32 v24, v24, v34
cvt v209,v34,v35
mma v[168:171],a[196:199],v[116:119],v[168:171]
s_mov_b32 m0, 79872
s_mov_b32 s31, 107520
bld v8,s[8:11],s31 offen nt lds
v_add_f32 v24, v24, v35
mma v[168:171],a[200:203],v[120:123],v[168:171]
mma v[168:171],a[204:207],v[124:127],v[168:171]
bld v9,s[8:11],s31 offen offset:1024 nt lds
v_exp_f32 v36, v164
mma v[168:171],a[208:211],v[128:131],v[168:171]
v_exp_f32 v37, v165
v_exp_f32 v38, v166
mma v[168:171],a[212:215],v[132:135],v[168:171]
s_waitcnt lgkmcnt(5)
bld v10,s[8:11],s31 offen offset:2048 nt lds
v_exp_f32 v39, v167
mma v[176:179],a[216:219],v[64:67],v[224:227]
s_mov_b32 m0, 82944
s_mov_b32 s31, 76800
s_waitcnt lgkmcnt(4)
bld v8,s[8:11],s31 offen nt lds
v_add_f32 v25, v36, v37
cvt v212,v36,v37
mma v[176:179],a[220:223],v[68:71],v[176:179]
ldq a[192:195],v2 offset:6144
v_add_f32 v25, v25, v38
cvt v213,v38,v39
v_add_f32 v25, v25, v39
s_waitcnt lgkmcnt(4)
mma v[176:179],a[224:227],v[72:75],v[176:179]
s_waitcnt lgkmcnt(3)
ldq a[196:199],v3 offset:6144
bld v9,s[8:11],s31 offen offset:1024 nt lds
mma v[176:179],a[228:231],v[76:79],v[176:179]
s_waitcnt lgkmcnt(3)
ldq a[200:203],v2 offset:6272
v_exp_f32 v32, v168
mma v[176:179],a[232:235],v[80:83],v[176:179]
s_waitcnt lgkmcnt(3)
ldq a[204:207],v3 offset:6272
bld v10,s[8:11],s31 offen offset:2048 nt lds
mma v[176:179],a[236:239],v[84:87],v[176:179]
s_mov_b32 m0, 0
ldq a[208:211],v2 offset:6400
v_exp_f32 v33, v169
mma v[180:183],a[236:239],v[108:111],v[228:231]
s_mov_b32 s31, 110592
ldq a[212:215],v3 offset:6400
bld v8,s[8:11],s31 offen nt lds
v_add_f32 v26, v32, v33
mma v[180:183],a[232:235],v[104:107],v[180:183]
bld v9,s[8:11],s31 offen offset:1024 nt lds
v_exp_f32 v34, v170
mma v[180:183],a[228:231],v[100:103],v[180:183]
v_exp_f32 v35, v171
cvt v216,v32,v33
v_add_f32 v26, v26, v34
mma v[180:183],a[224:227],v[96:99],v[180:183]
bld v10,s[8:11],s31 offen offset:2048 nt lds
v_exp_f32 v36, v176
mma v[180:183],a[220:223],v[92:95],v[180:183]
s_mov_b32 m0, 3072
v_exp_f32 v37, v177
v_exp_f32 v38, v178
mma v[180:183],a[216:219],v[88:91],v[180:183]
s_mov_b32 s31, 79872
bld v8,s[8:11],s31 offen nt lds
v_exp_f32 v39, v179
mma v[184:187],a[216:219],v[112:115],v[232:235]
v_add_u32 v2, s36, v2
cvt v217,v34,v35
v_add_f32 v26, v26, v35
v_add_f32 v24, v24, v36
mma v[184:187],a[220:223],v[116:119],v[184:187]
v_add_u32 v3, s36, v3
cvt v210,v36,v37
v_add_f32 v24, v24, v37
v_add_f32 v24, v24, v38
mma v[184:187],a[224:227],v[120:123],v[184:187]
cvt v211,v38,v39
v_add_f32 v24, v24, v39
mma v[184:187],a[228:231],v[124:127],v[184:187]
v_exp_f32 v32, v180
v_exp_f32 v33, v181
mma v[184:187],a[232:235],v[128:131],v[184:187]
s_waitcnt lgkmcnt(0)
s_barrier
mma v[184:187],a[236:239],v[132:135],v[184:187]
v_exp_f32 v34, v182
v_exp_f32 v35, v183
v_add_f32 v25, v25, v32
cvt v214,v32,v33
v_add_f32 v25, v25, v33
v_add_f32 v25, v25, v34
cvt v215,v34,v35
v_add_f32 v25, v25, v35
v_exp_f32 v36, v184
v_exp_f32 v37, v185
v_exp_f32 v38, v186
v_exp_f32 v39, v187
v_add_f32 v26, v26, v36
cvt v218,v36,v37
v_add_f32 v26, v26, v37
v_add_f32 v26, v26, v38
cvt v219,v38,v39
v_add_f32 v26, v26, v39
v_max3_f32 v40, v24, v25, v26
v_cmp_nge_f32 vcc, s34, v40
s_nop 4
s_cbranch_vccnz L_w3_tr1
L_w3_tr1_ret:
mma v[160:163],a[192:195],v[64:67],v[224:227]
s_mov_b32 m0, 3072
s_mov_b32 s31, 79872
ldq a[216:219],v2
bld v9,s[8:11],s31 offen offset:1024 nt lds
mma v[160:163],a[196:199],v[68:71],v[160:163]
ldq a[220:223],v3
v_add_f32 v28, v28, v24
v_add_f32 v29, v29, v25
mma v[160:163],a[200:203],v[72:75],v[160:163]
ldq a[224:227],v2 offset:128
v_add_f32 v30, v30, v26
mma v[160:163],a[204:207],v[76:79],v[160:163]
ldq a[228:231],v3 offset:128
mma v[160:163],a[208:211],v[80:83],v[160:163]
ldq a[232:235],v2 offset:256
bld v10,s[8:11],s31 offen offset:2048 nt lds
mma v[160:163],a[212:215],v[84:87],v[160:163]
ldq a[236:239],v3 offset:256
mma v[164:167],a[212:215],v[108:111],v[228:231]
mma v[164:167],a[208:211],v[104:107],v[164:167]
s_add_u32 s37, s37, 1
mma v[164:167],a[204:207],v[100:103],v[164:167]
s_cmp_eq_u32 s37, 7
s_cselect_b32 s36, 4294893568, s43
s_cselect_b32 s37, 0, s37
mma v[164:167],a[200:203],v[96:99],v[164:167]
s_mov_b32 m0, 6144
s_mov_b32 s31, 113664
bld v8,s[8:11],s31 offen nt lds
mma v[164:167],a[196:199],v[92:95],v[164:167]
v_exp_f32 v32, v160
mma v[164:167],a[192:195],v[88:91],v[164:167]
v_exp_f32 v33, v161
mma v[168:171],a[192:195],v[112:115],v[232:235]
v_exp_f32 v34, v162
v_add_f32 v24, v32, v33
mma v[168:171],a[196:199],v[116:119],v[168:171]
bld v9,s[8:11],s31 offen offset:1024 nt lds
cvt v240,v32,v33
mma v[168:171],a[200:203],v[120:123],v[168:171]
v_exp_f32 v35, v163
v_add_f32 v24, v24, v34
mma v[168:171],a[204:207],v[124:127],v[168:171]
v_exp_f32 v36, v164
cvt v241,v34,v35
mma v[168:171],a[208:211],v[128:131],v[168:171]
v_exp_f32 v37, v165
v_add_f32 v24, v24, v35
mma v[168:171],a[212:215],v[132:135],v[168:171]
s_waitcnt lgkmcnt(5)
v_exp_f32 v38, v166
v_add_f32 v25, v36, v37
mma v[176:179],a[216:219],v[64:67],v[224:227]
s_waitcnt lgkmcnt(4)
bld v10,s[8:11],s31 offen offset:2048 nt lds
cvt v244,v36,v37
mma v[176:179],a[220:223],v[68:71],v[176:179]
s_waitcnt lgkmcnt(3)
ldq a[192:195],v2 offset:6144
v_exp_f32 v39, v167
mma v[176:179],a[224:227],v[72:75],v[176:179]
s_waitcnt lgkmcnt(3)
ldq a[196:199],v3 offset:6144
v_add_f32 v25, v25, v38
cvt v245,v38,v39
mma v[176:179],a[228:231],v[76:79],v[176:179]
s_waitcnt lgkmcnt(3)
ldq a[200:203],v2 offset:6272
v_exp_f32 v32, v168
mma v[176:179],a[232:235],v[80:83],v[176:179]
s_mov_b32 m0, 9216
s_waitcnt lgkmcnt(3)
ldq a[204:207],v3 offset:6272
v_exp_f32 v33, v169
mma v[176:179],a[236:239],v[84:87],v[176:179]
s_mov_b32 s31, 82944
ldq a[208:211],v2 offset:6400
bld v8,s[8:11],s31 offen nt lds
mma v[180:183],a[236:239],v[108:111],v[228:231]
ldq a[212:215],v3 offset:6400
ldt a[240:241],v4
v_add_f32 v25, v25, v39
mma v[180:183],a[232:235],v[104:107],v[180:183]
ldt a[242:243],v4 offset:6144
v_exp_f32 v34, v170
mma v[180:183],a[228:231],v[100:103],v[180:183]
v_exp_f32 v35, v171
v_add_f32 v26, v32, v33
mma v[180:183],a[224:227],v[96:99],v[180:183]
ldt a[244:245],v4 offset:12288
bld v9,s[8:11],s31 offen offset:1024 nt lds
mma v[180:183],a[220:223],v[92:95],v[180:183]
ldt a[246:247],v4 offset:18432
v_exp_f32 v36, v176
mma v[180:183],a[216:219],v[88:91],v[180:183]
v_exp_f32 v37, v177
cvt v248,v32,v33
mma v[184:187],a[216:219],v[112:115],v[232:235]
ldt a[248:249],v5
v_exp_f32 v38, v178
mma v[184:187],a[220:223],v[116:119],v[184:187]
ldt a[250:251],v5 offset:6144
v_exp_f32 v39, v179
mma v[184:187],a[224:227],v[120:123],v[184:187]
bld v10,s[8:11],s31 offen offset:2048 nt lds
v_add_f32 v26, v26, v34
mma v[184:187],a[228:231],v[124:127],v[184:187]
ldt a[252:253],v5 offset:12288
v_exp_f32 v32, v180
mma v[184:187],a[232:235],v[128:131],v[184:187]
ldt a[254:255],v5 offset:18432
v_exp_f32 v33, v181
mma v[184:187],a[236:239],v[132:135],v[184:187]
s_waitcnt lgkmcnt(6)
mma a[0:3],a[240:243],v[192:195],0
s_mov_b32 m0, 12288
s_waitcnt lgkmcnt(4)
ldt a[216:217],v6
cvt v249,v34,v35
mma a[0:3],a[244:247],v[208:211],a[0:3]
s_mov_b32 s31, 116736
ldt a[218:219],v6 offset:6144
bld v8,s[8:11],s31 offen nt lds
mma a[4:7],a[244:247],v[212:215],0
v_exp_f32 v34, v182
mma a[4:7],a[240:243],v[196:199],a[4:7]
ldt a[220:221],v6 offset:12288
v_add_f32 v26, v26, v35
v_add_f32 v24, v24, v36
mma a[8:11],a[240:243],v[200:203],0
ldt a[222:223],v6 offset:18432
v_exp_f32 v35, v183
mma a[8:11],a[244:247],v[216:219],a[8:11]
s_waitcnt lgkmcnt(6)
bld v9,s[8:11],s31 offen offset:1024 nt lds
mma a[24:27],a[248:251],v[200:203],0
s_waitcnt lgkmcnt(4)
ldt a[224:225],v7
cvt v242,v36,v37
mma a[24:27],a[252:255],v[216:219],a[24:27]
ldt a[226:227],v7 offset:6144
v_exp_f32 v36, v184
mma a[20:23],a[252:255],v[212:215],0
v_add_f32 v24, v24, v37
mma a[20:23],a[248:251],v[196:199],a[20:23]
ldt a[228:229],v7 offset:12288
v_exp_f32 v37, v185
mma a[16:19],a[248:251],v[192:195],0
ldt a[230:231],v7 offset:18432
bld v10,s[8:11],s31 offen offset:2048 nt lds
mma a[16:19],a[252:255],v[208:211],a[16:19]
s_waitcnt lgkmcnt(6)
v_add_f32 v24, v24, v38
mma a[32:35],a[216:219],v[192:195],0
s_waitcnt lgkmcnt(4)
ldt a[232:233],v4 offset:128
cvt v243,v38,v39
mma a[32:35],a[220:223],v[208:211],a[32:35]
ldt a[234:235],v4 offset:6272
v_exp_f32 v38, v186
mma a[36:39],a[220:223],v[212:215],0
s_mov_b32 m0, 15360
v_add_f32 v24, v24, v39
mma a[36:39],a[216:219],v[196:199],a[36:39]
s_mov_b32 s31, 86016
ldt a[236:237],v4 offset:12416
bld v8,s[8:11],s31 offen nt lds
mma a[40:43],a[216:219],v[200:203],0
ldt a[238:239],v4 offset:18560
v_exp_f32 v39, v187
mma a[40:43],a[220:223],v[216:219],a[40:43]
s_waitcnt lgkmcnt(6)
v_add_f32 v25, v25, v32
mma a[56:59],a[224:227],v[200:203],0
s_waitcnt lgkmcnt(4)
ldt a[240:241],v5 offset:128
cvt v246,v32,v33
v_add_f32 v25, v25, v33
mma a[56:59],a[228:231],v[216:219],a[56:59]
ldt a[242:243],v5 offset:6272
bld v9,s[8:11],s31 offen offset:1024 nt lds
mma a[52:55],a[228:231],v[212:215],0
v_add_f32 v25, v25, v34
cvt v247,v34,v35
mma a[52:55],a[224:227],v[196:199],a[52:55]
ldt a[244:245],v5 offset:12416
v_add_f32 v25, v25, v35
mma a[48:51],a[224:227],v[192:195],0
ldt a[246:247],v5 offset:18560
v_add_f32 v26, v26, v36
mma a[48:51],a[228:231],v[208:211],a[48:51]
s_waitcnt lgkmcnt(6)
cvt v250,v36,v37
v_add_f32 v26, v26, v37
mma a[64:67],a[232:235],v[192:195],0
s_waitcnt lgkmcnt(4)
bld v10,s[8:11],s31 offen offset:2048 nt lds
v_add_f32 v26, v26, v38
mma a[64:67],a[236:239],v[208:211],a[64:67]
cvt v251,v38,v39
mma a[68:71],a[236:239],v[212:215],0
v_add_f32 v26, v26, v39
mma a[68:71],a[232:235],v[196:199],a[68:71]
v_max3_f32 v40, v24, v25, v26
mma a[72:75],a[232:235],v[200:203],0
v_cmp_nge_f32 vcc, s34, v40
mma a[72:75],a[236:239],v[216:219],a[72:75]
s_waitcnt lgkmcnt(2)
mma a[88:91],a[240:243],v[200:203],0
s_waitcnt lgkmcnt(0)
v_add_u32 v2, s36, v2
mma a[88:91],a[244:247],v[216:219],a[88:91]
v_add_u32 v3, s36, v3
mma a[84:87],a[244:247],v[212:215],0
s_barrier
mma a[84:87],a[240:243],v[196:199],a[84:87]
mma a[80:83],a[240:243],v[192:195],0
mma a[80:83],a[244:247],v[208:211],a[80:83]
s_cbranch_vccnz L_w3_tr2
L_w3_tr2_ret:
mma v[160:163],a[192:195],v[64:67],v[224:227]
s_mov_b32 m0, 18432
s_mov_b32 s31, 119808
ldq a[216:219],v2
bld v8,s[8:11],s31 offen nt lds
mma v[160:163],a[196:199],v[68:71],v[160:163]
ldq a[220:223],v3
v_add_f32 v28, v28, v24
v_add_f32 v29, v29, v25
mma v[160:163],a[200:203],v[72:75],v[160:163]
ldq a[224:227],v2 offset:128
v_add_f32 v30, v30, v26
mma v[160:163],a[204:207],v[76:79],v[160:163]
ldq a[228:231],v3 offset:128
mma v[160:163],a[208:211],v[80:83],v[160:163]
ldq a[232:235],v2 offset:256
mma v[160:163],a[212:215],v[84:87],v[160:163]
ldq a[236:239],v3 offset:256
bld v9,s[8:11],s31 offen offset:1024 nt lds
mma v[164:167],a[212:215],v[108:111],v[228:231]
mma v[164:167],a[208:211],v[104:107],v[164:167]
s_add_u32 s37, s37, 1
mma v[164:167],a[204:207],v[100:103],v[164:167]
s_cmp_eq_u32 s37, 7
s_cselect_b32 s36, 4294893568, s43
s_cselect_b32 s37, 0, s37
mma v[164:167],a[200:203],v[96:99],v[164:167]
v_exp_f32 v32, v160
mma v[164:167],a[196:199],v[92:95],v[164:167]
bld v10,s[8:11],s31 offen offset:2048 nt lds
mma v[164:167],a[192:195],v[88:91],v[164:167]
v_exp_f32 v33, v161
mma v[168:171],a[192:195],v[112:115],v[232:235]
v_exp_f32 v34, v162
v_add_f32 v24, v32, v33
mma v[168:171],a[196:199],v[116:119],v[168:171]
v_exp_f32 v35, v163
cvt v48,v32,v33
mma v[168:171],a[200:203],v[120:123],v[168:171]
v_add_f32 v24, v24, v34
cvt v49,v34,v35
v_add_f32 v24, v24, v35
mma v[168:171],a[204:207],v[124:127],v[168:171]
s_mov_b32 m0, 21504
v_exp_f32 v36, v164
mma v[168:171],a[208:211],v[128:131],v[168:171]
s_mov_b32 s31, 89088
bld v8,s[8:11],s31 offen nt lds
mma v[168:171],a[212:215],v[132:135],v[168:171]
s_waitcnt lgkmcnt(5)
v_exp_f32 v37, v165
mma v[176:179],a[216:219],v[64:67],v[224:227]
s_waitcnt lgkmcnt(4)
v_exp_f32 v38, v166
v_add_f32 v25, v36, v37
mma v[176:179],a[220:223],v[68:71],v[176:179]
s_waitcnt lgkmcnt(3)
ldq a[192:195],v2 offset:6144
v_exp_f32 v39, v167
mma v[176:179],a[224:227],v[72:75],v[176:179]
s_waitcnt lgkmcnt(3)
ldq a[196:199],v3 offset:6144
cvt v52,v36,v37
v_add_f32 v25, v25, v38
mma v[176:179],a[228:231],v[76:79],v[176:179]
s_waitcnt lgkmcnt(3)
ldq a[200:203],v2 offset:6272
bld v9,s[8:11],s31 offen offset:1024 nt lds
mma v[176:179],a[232:235],v[80:83],v[176:179]
s_waitcnt lgkmcnt(3)
ldq a[204:207],v3 offset:6272
v_exp_f32 v32, v168
mma v[176:179],a[236:239],v[84:87],v[176:179]
ldq a[208:211],v2 offset:6400
v_exp_f32 v33, v169
mma v[180:183],a[236:239],v[108:111],v[228:231]
ldq a[212:215],v3 offset:6400
ldt a[240:241],v6 offset:128
cvt v53,v38,v39
mma v[180:183],a[232:235],v[104:107],v[180:183]
ldt a[242:243],v6 offset:6272
v_exp_f32 v34, v170
mma v[180:183],a[228:231],v[100:103],v[180:183]
v_exp_f32 v35, v171
v_add_f32 v25, v25, v39
mma v[180:183],a[224:227],v[96:99],v[180:183]
ldt a[244:245],v6 offset:12416
bld v10,s[8:11],s31 offen offset:2048 nt lds
mma v[180:183],a[220:223],v[92:95],v[180:183]
ldt a[246:247],v6 offset:18560
v_exp_f32 v36, v176
mma v[180:183],a[216:219],v[88:91],v[180:183]
v_exp_f32 v37, v177
v_add_f32 v26, v32, v33
mma v[184:187],a[216:219],v[112:115],v[232:235]
ldt a[248:249],v7 offset:128
v_exp_f32 v38, v178
mma v[184:187],a[220:223],v[116:119],v[184:187]
s_mov_b32 m0, 24576
ldt a[250:251],v7 offset:6272
v_exp_f32 v39, v179
mma v[184:187],a[224:227],v[120:123],v[184:187]
s_mov_b32 s31, 122880
bld v8,s[8:11],s31 offen nt lds
cvt v56,v32,v33
mma v[184:187],a[228:231],v[124:127],v[184:187]
ldt a[252:253],v7 offset:12416
v_exp_f32 v32, v180
mma v[184:187],a[232:235],v[128:131],v[184:187]
ldt a[254:255],v7 offset:18560
v_exp_f32 v33, v181
mma v[184:187],a[236:239],v[132:135],v[184:187]
s_waitcnt lgkmcnt(6)
v_add_f32 v26, v26, v34
mma a[96:99],a[240:243],v[192:195],0
s_waitcnt lgkmcnt(4)
ldt a[216:217],v4 offset:256
cvt v57,v34,v35
mma a[96:99],a[244:247],v[208:211],a[96:99]
ldt a[218:219],v4 offset:6400
bld v9,s[8:11],s31 offen offset:1024 nt lds
mma a[100:103],a[244:247],v[212:215],0
v_exp_f32 v34, v182
mma a[100:103],a[240:243],v[196:199],a[100:103]
ldt a[220:221],v4 offset:12544
v_add_f32 v26, v26, v35
v_add_f32 v24, v24, v36
mma a[104:107],a[240:243],v[200:203],0
ldt a[222:223],v4 offset:18688
v_exp_f32 v35, v183
mma a[104:107],a[244:247],v[216:219],a[104:107]
s_waitcnt lgkmcnt(6)
mma a[120:123],a[248:251],v[200:203],0
s_waitcnt lgkmcnt(4)
ldt a[224:225],v5 offset:256
cvt v50,v36,v37
mma a[120:123],a[252:255],v[216:219],a[120:123]
ldt a[226:227],v5 offset:6400
bld v10,s[8:11],s31 offen offset:2048 nt lds
mma a[116:119],a[252:255],v[212:215],0
v_exp_f32 v36, v184
v_add_f32 v24, v24, v37
mma a[116:119],a[248:251],v[196:199],a[116:119]
ldt a[228:229],v5 offset:12544
v_exp_f32 v37, v185
mma a[112:115],a[248:251],v[192:195],0
ldt a[230:231],v5 offset:18688
mma a[112:115],a[252:255],v[208:211],a[112:115]
s_mov_b32 m0, 27648
s_waitcnt lgkmcnt(6)
v_add_f32 v24, v24, v38
mma a[128:131],a[216:219],v[192:195],0
s_mov_b32 s31, 92160
s_waitcnt lgkmcnt(4)
ldt a[232:233],v6 offset:256
bld v8,s[8:11],s31 offen nt lds
mma a[128:131],a[220:223],v[208:211],a[128:131]
ldt a[234:235],v6 offset:6400
cvt v51,v38,v39
v_add_f32 v24, v24, v39
mma a[132:135],a[220:223],v[212:215],0
v_exp_f32 v38, v186
mma a[132:135],a[216:219],v[196:199],a[132:135]
ldt a[236:237],v6 offset:12544
v_exp_f32 v39, v187
mma a[136:139],a[216:219],v[200:203],0
ldt a[238:239],v6 offset:18688
mma a[136:139],a[220:223],v[216:219],a[136:139]
s_waitcnt lgkmcnt(6)
v_add_f32 v25, v25, v32
mma a[152:155],a[224:227],v[200:203],0
s_waitcnt lgkmcnt(4)
ldt a[240:241],v7 offset:256
bld v9,s[8:11],s31 offen offset:1024 nt lds
mma a[152:155],a[228:231],v[216:219],a[152:155]
ldt a[242:243],v7 offset:6400
cvt v54,v32,v33
v_add_f32 v25, v25, v33
mma a[148:151],a[228:231],v[212:215],0
v_add_f32 v25, v25, v34
cvt v55,v34,v35
mma a[148:151],a[224:227],v[196:199],a[148:151]
ldt a[244:245],v7 offset:12544
v_add_f32 v25, v25, v35
mma a[144:147],a[224:227],v[192:195],0
ldt a[246:247],v7 offset:18688
v_add_f32 v26, v26, v36
mma a[144:147],a[228:231],v[208:211],a[144:147]
s_waitcnt lgkmcnt(6)
bld v10,s[8:11],s31 offen offset:2048 nt lds
cvt v58,v36,v37
mma a[160:163],a[232:235],v[192:195],0
s_waitcnt lgkmcnt(4)
v_add_f32 v26, v26, v37
v_add_f32 v26, v26, v38
mma a[160:163],a[236:239],v[208:211],a[160:163]
cvt v59,v38,v39
mma a[164:167],a[236:239],v[212:215],0
v_add_f32 v26, v26, v39
mma a[164:167],a[232:235],v[196:199],a[164:167]
v_max3_f32 v40, v24, v25, v26
mma a[168:171],a[232:235],v[200:203],0
v_cmp_nge_f32 vcc, s34, v40
mma a[168:171],a[236:239],v[216:219],a[168:171]
s_waitcnt lgkmcnt(2)
mma a[184:187],a[240:243],v[200:203],0
s_waitcnt lgkmcnt(0)
v_add_u32 v2, s36, v2
mma a[184:187],a[244:247],v[216:219],a[184:187]
v_add_u32 v3, s36, v3
mma a[180:183],a[244:247],v[212:215],0
s_waitcnt vmcnt(62)
s_barrier
mma a[180:183],a[240:243],v[196:199],a[180:183]
s_add_u32 s40, s40, 1
mma a[176:179],a[240:243],v[192:195],0
s_cmp_eq_u32 s40, 3
s_cselect_b32 s39, 4294918144, s42
s_cselect_b32 s40, 0, s40
mma a[176:179],a[244:247],v[208:211],a[176:179]
s_cbranch_vccnz L_w3_tr3
L_w3_tr3_ret:
mma v[160:163],a[192:195],v[64:67],v[224:227]
s_mov_b32 m0, 86016
s_mov_b32 s31, 101376
ldq a[216:219],v2
bld v8,s[12:15],s31 offen nt lds
mma v[160:163],a[196:199],v[68:71],v[160:163]
ldq a[220:223],v3
v_add_f32 v28, v28, v24
v_add_f32 v29, v29, v25
mma v[160:163],a[200:203],v[72:75],v[160:163]
ldq a[224:227],v2 offset:128
bld v9,s[12:15],s31 offen offset:1024 nt lds
mma v[160:163],a[204:207],v[76:79],v[160:163]
ldq a[228:231],v3 offset:128
v_add_f32 v30, v30, v26
v_add_u32 v4, s39, v4
mma v[160:163],a[208:211],v[80:83],v[160:163]
ldq a[232:235],v2 offset:256
v_add_u32 v5, s39, v5
v_add_u32 v6, s39, v6
mma v[160:163],a[212:215],v[84:87],v[160:163]
ldq a[236:239],v3 offset:256
bld v10,s[12:15],s31 offen offset:2048 nt lds
mma v[164:167],a[212:215],v[108:111],v[228:231]
v_add_u32 v7, s39, v7
mma v[164:167],a[208:211],v[104:107],v[164:167]
s_add_u32 s37, s37, 1
mma v[164:167],a[204:207],v[100:103],v[164:167]
s_cmp_eq_u32 s37, 7
s_cselect_b32 s36, 4294893568, s43
s_cselect_b32 s37, 0, s37
s_mov_b32 m0, 89088
s_mov_b32 s31, 70656
bld v8,s[12:15],s31 offen nt lds
mma v[164:167],a[200:203],v[96:99],v[164:167]
v_exp_f32 v32, v160
mma v[164:167],a[196:199],v[92:95],v[164:167]
v_exp_f32 v33, v161
mma v[164:167],a[192:195],v[88:91],v[164:167]
bld v9,s[12:15],s31 offen offset:1024 nt lds
v_add_f32 v24, v32, v33
mma v[168:171],a[192:195],v[112:115],v[232:235]
v_exp_f32 v34, v162
cvt v192,v32,v33
mma v[168:171],a[196:199],v[116:119],v[168:171]
v_exp_f32 v35, v163
v_add_f32 v24, v24, v34
mma v[168:171],a[200:203],v[120:123],v[168:171]
bld v10,s[12:15],s31 offen offset:2048 nt lds
cvt v193,v34,v35
mma v[168:171],a[204:207],v[124:127],v[168:171]
v_exp_f32 v36, v164
v_add_f32 v24, v24, v35
mma v[168:171],a[208:211],v[128:131],v[168:171]
s_mov_b32 m0, 92160
v_exp_f32 v37, v165
mma v[168:171],a[212:215],v[132:135],v[168:171]
s_mov_b32 s31, 104448
s_waitcnt lgkmcnt(5)
bld v8,s[12:15],s31 offen nt lds
v_add_f32 v25, v36, v37
mma v[176:179],a[216:219],v[64:67],v[224:227]
s_waitcnt lgkmcnt(4)
v_exp_f32 v38, v166
cvt v196,v36,v37
mma v[176:179],a[220:223],v[68:71],v[176:179]
s_waitcnt lgkmcnt(3)
ldq a[192:195],v2 offset:6144
v_exp_f32 v39, v167
mma v[176:179],a[224:227],v[72:75],v[176:179]
s_waitcnt lgkmcnt(3)
ldq a[196:199],v3 offset:6144
bld v9,s[12:15],s31 offen offset:1024 nt lds
mma v[176:179],a[228:231],v[76:79],v[176:179]
s_waitcnt lgkmcnt(3)
ldq a[200:203],v2 offset:6272
v_exp_f32 v32, v168
mma v[176:179],a[232:235],v[80:83],v[176:179]
s_waitcnt lgkmcnt(3)
ldq a[204:207],v3 offset:6272
v_exp_f32 v33, v169
mma v[176:179],a[236:239],v[84:87],v[176:179]
ldq a[208:211],v2 offset:6400
bld v10,s[12:15],s31 offen offset:2048 nt lds
mma v[180:183],a[236:239],v[108:111],v[228:231]
ldq a[212:215],v3 offset:6400
ldt a[240:241],v4
v_add_f32 v25, v25, v38
mma v[180:183],a[232:235],v[104:107],v[180:183]
s_mov_b32 m0, 95232
ldt a[242:243],v4 offset:6144
v_exp_f32 v34, v170
mma v[180:183],a[228:231],v[100:103],v[180:183]
s_mov_b32 s31, 73728
bld v8,s[12:15],s31 offen nt lds
cvt v197,v38,v39
mma v[180:183],a[224:227],v[96:99],v[180:183]
ldt a[244:245],v4 offset:12288
v_exp_f32 v35, v171
mma v[180:183],a[220:223],v[92:95],v[180:183]
ldt a[246:247],v4 offset:18432
v_exp_f32 v36, v176
mma v[180:183],a[216:219],v[88:91],v[180:183]
bld v9,s[12:15],s31 offen offset:1024 nt lds
v_add_f32 v25, v25, v39
mma v[184:187],a[216:219],v[112:115],v[232:235]
ldt a[248:249],v5
v_exp_f32 v37, v177
mma v[184:187],a[220:223],v[116:119],v[184:187]
ldt a[250:251],v5 offset:6144
v_exp_f32 v38, v178
mma v[184:187],a[224:227],v[120:123],v[184:187]
bld v10,s[12:15],s31 offen offset:2048 nt lds
v_add_f32 v26, v32, v33
mma v[184:187],a[228:231],v[124:127],v[184:187]
ldt a[252:253],v5 offset:12288
v_exp_f32 v39, v179
mma v[184:187],a[232:235],v[128:131],v[184:187]
s_mov_b32 m0, 98304
ldt a[254:255],v5 offset:18432
cvt v200,v32,v33
v_add_f32 v26, v26, v34
mma v[184:187],a[236:239],v[132:135],v[184:187]
s_mov_b32 s31, 107520
s_waitcnt lgkmcnt(6)
bld v8,s[12:15],s31 offen nt lds
cvt v201,v34,v35
mma a[0:3],a[240:243],v[240:243],a[0:3]
s_waitcnt lgkmcnt(4)
ldt a[216:217],v6
v_exp_f32 v32, v180
mma a[0:3],a[244:247],v[48:51],a[0:3]
ldt a[218:219],v6 offset:6144
v_exp_f32 v33, v181
mma a[4:7],a[244:247],v[52:55],a[4:7]
bld v9,s[12:15],s31 offen offset:1024 nt lds
v_add_f32 v26, v26, v35
mma a[4:7],a[240:243],v[244:247],a[4:7]
ldt a[220:221],v6 offset:12288
v_exp_f32 v34, v182
mma a[8:11],a[240:243],v[248:251],a[8:11]
ldt a[222:223],v6 offset:18432
v_exp_f32 v35, v183
mma a[8:11],a[244:247],v[56:59],a[8:11]
s_waitcnt lgkmcnt(6)
bld v10,s[12:15],s31 offen offset:2048 nt lds
mma a[24:27],a[248:251],v[248:251],a[24:27]
s_waitcnt lgkmcnt(4)
ldt a[224:225],v7
v_add_f32 v24, v24, v36
mma a[24:27],a[252:255],v[56:59],a[24:27]
s_mov_b32 m0, 101376
ldt a[226:227],v7 offset:6144
cvt v194,v36,v37
mma a[20:23],a[252:255],v[52:55],a[20:23]
s_mov_b32 s31, 76800
bld v8,s[12:15],s31 offen nt lds
v_add_f32 v24, v24, v37
mma a[20:23],a[248:251],v[244:247],a[20:23]
ldt a[228:229],v7 offset:12288
v_exp_f32 v36, v184
mma a[16:19],a[248:251],v[240:243],a[16:19]
ldt a[230:231],v7 offset:18432
v_exp_f32 v37, v185
mma a[16:19],a[252:255],v[48:51],a[16:19]
s_waitcnt lgkmcnt(6)
bld v9,s[12:15],s31 offen offset:1024 nt lds
mma a[32:35],a[216:219],v[240:243],a[32:35]
s_waitcnt lgkmcnt(4)
ldt a[232:233],v4 offset:128
v_add_f32 v24, v24, v38
cvt v195,v38,v39
mma a[32:35],a[220:223],v[48:51],a[32:35]
ldt a[234:235],v4 offset:6272
v_exp_f32 v38, v186
mma a[36:39],a[220:223],v[52:55],a[36:39]
bld v10,s[12:15],s31 offen offset:2048 nt lds
mma a[36:39],a[216:219],v[244:247],a[36:39]
ldt a[236:237],v4 offset:12416
v_add_f32 v24, v24, v39
mma a[40:43],a[216:219],v[248:251],a[40:43]
s_mov_b32 m0, 104448
ldt a[238:239],v4 offset:18560
v_exp_f32 v39, v187
mma a[40:43],a[220:223],v[56:59],a[40:43]
s_mov_b32 s31, 110592
s_waitcnt lgkmcnt(6)
bld v8,s[12:15],s31 offen nt lds
v_add_f32 v25, v25, v32
mma a[56:59],a[224:227],v[248:251],a[56:59]
s_waitcnt lgkmcnt(4)
ldt a[240:241],v5 offset:128
cvt v198,v32,v33
mma a[56:59],a[228:231],v[56:59],a[56:59]
ldt a[242:243],v5 offset:6272
v_add_f32 v25, v25, v33
mma a[52:55],a[228:231],v[52:55],a[52:55]
bld v9,s[12:15],s31 offen offset:1024 nt lds
v_add_f32 v25, v25, v34
mma a[52:55],a[224:227],v[244:247],a[52:55]
ldt a[244:245],v5 offset:12416
cvt v199,v34,v35
v_add_f32 v25, v25, v35
mma a[48:51],a[224:227],v[240:243],a[48:51]
ldt a[246:247],v5 offset:18560
v_add_f32 v26, v26, v36
mma a[48:51],a[228:231],v[48:51],a[48:51]
s_waitcnt lgkmcnt(6)
bld v10,s[12:15],s31 offen offset:2048 nt lds
cvt v202,v36,v37
mma a[64:67],a[232:235],v[240:243],a[64:67]
s_waitcnt lgkmcnt(4)
v_add_f32 v26, v26, v37
v_add_f32 v26, v26, v38
mma a[64:67],a[236:239],v[48:51],a[64:67]
s_mov_b32 m0, 107520
cvt v203,v38,v39
mma a[68:71],a[236:239],v[52:55],a[68:71]
s_mov_b32 s31, 79872
bld v8,s[12:15],s31 offen nt lds
v_add_f32 v26, v26, v39
mma a[68:71],a[232:235],v[244:247],a[68:71]
v_max3_f32 v40, v24, v25, v26
mma a[72:75],a[232:235],v[248:251],a[72:75]
v_cmp_nge_f32 vcc, s34, v40
mma a[72:75],a[236:239],v[56:59],a[72:75]
s_waitcnt lgkmcnt(2)
mma a[88:91],a[240:243],v[248:251],a[88:91]
s_waitcnt lgkmcnt(0)
v_add_u32 v2, s36, v2
mma a[88:91],a[244:247],v[56:59],a[88:91]
v_add_u32 v3, s36, v3
mma a[84:87],a[244:247],v[52:55],a[84:87]
s_barrier
mma a[84:87],a[240:243],v[244:247],a[84:87]
mma a[80:83],a[240:243],v[240:243],a[80:83]
mma a[80:83],a[244:247],v[48:51],a[80:83]
s_cbranch_vccnz L_w3_tr4
L_w3_tr4_ret:
mma v[160:163],a[192:195],v[64:67],v[224:227]
s_mov_b32 m0, 107520
s_mov_b32 s31, 79872
ldq a[216:219],v2
bld v9,s[12:15],s31 offen offset:1024 nt lds
mma v[160:163],a[196:199],v[68:71],v[160:163]
ldq a[220:223],v3
v_add_f32 v28, v28, v24
v_add_f32 v29, v29, v25
mma v[160:163],a[200:203],v[72:75],v[160:163]
ldq a[224:227],v2 offset:128
bld v10,s[12:15],s31 offen offset:2048 nt lds
mma v[160:163],a[204:207],v[76:79],v[160:163]
ldq a[228:231],v3 offset:128
v_add_f32 v30, v30, v26
mma v[160:163],a[208:211],v[80:83],v[160:163]
s_mov_b32 m0, 30720
ldq a[232:235],v2 offset:256
mma v[160:163],a[212:215],v[84:87],v[160:163]
s_mov_b32 s31, 125952
ldq a[236:239],v3 offset:256
bld v8,s[8:11],s31 offen nt lds
mma v[164:167],a[212:215],v[108:111],v[228:231]
mma v[164:167],a[208:211],v[104:107],v[164:167]
s_add_u32 s37, s37, 1
mma v[164:167],a[204:207],v[100:103],v[164:167]
s_cmp_eq_u32 s37, 7
s_cselect_b32 s36, 4294893568, s43
s_cselect_b32 s37, 0, s37
bld v9,s[8:11],s31 offen offset:1024 nt lds
mma v[164:167],a[200:203],v[96:99],v[164:167]
v_exp_f32 v32, v160
mma v[164:167],a[196:199],v[92:95],v[164:167]
v_exp_f32 v33, v161
mma v[164:167],a[192:195],v[88:91],v[164:167]
bld v10,s[8:11],s31 offen offset:2048 nt lds
v_add_f32 v24, v32, v33
mma v[168:171],a[192:195],v[112:115],v[232:235]
v_exp_f32 v34, v162
cvt v208,v32,v33
mma v[168:171],a[196:199],v[116:119],v[168:171]
s_mov_b32 m0, 33792
v_exp_f32 v35, v163
v_add_f32 v24, v24, v34
mma v[168:171],a[200:203],v[120:123],v[168:171]
s_mov_b32 s31, 95232
bld v8,s[8:11],s31 offen nt lds
cvt v209,v34,v35
mma v[168:171],a[204:207],v[124:127],v[168:171]
v_exp_f32 v36, v164
v_add_f32 v24, v24, v35
mma v[168:171],a[208:211],v[128:131],v[168:171]
v_exp_f32 v37, v165
mma v[168:171],a[212:215],v[132:135],v[168:171]
s_waitcnt lgkmcnt(5)
bld v9,s[8:11],s31 offen offset:1024 nt lds
v_add_f32 v25, v36, v37
mma v[176:179],a[216:219],v[64:67],v[224:227]
s_waitcnt lgkmcnt(4)
v_exp_f32 v38, v166
cvt v212,v36,v37
mma v[176:179],a[220:223],v[68:71],v[176:179]
s_waitcnt lgkmcnt(3)
ldq a[192:195],v2 offset:6144
v_exp_f32 v39, v167
mma v[176:179],a[224:227],v[72:75],v[176:179]
s_waitcnt lgkmcnt(3)
ldq a[196:199],v3 offset:6144
bld v10,s[8:11],s31 offen offset:2048 nt lds
mma v[176:179],a[228:231],v[76:79],v[176:179]
s_waitcnt lgkmcnt(3)
ldq a[200:203],v2 offset:6272
v_exp_f32 v32, v168
mma v[176:179],a[232:235],v[80:83],v[176:179]
s_mov_b32 m0, 36864
s_waitcnt lgkmcnt(3)
ldq a[204:207],v3 offset:6272
v_exp_f32 v33, v169
mma v[176:179],a[236:239],v[84:87],v[176:179]
s_mov_b32 s31, 129024
ldq a[208:211],v2 offset:6400
bld v8,s[8:11],s31 offen nt lds
mma v[180:183],a[236:239],v[108:111],v[228:231]
ldq a[212:215],v3 offset:6400
ldt a[240:241],v6 offset:128
v_add_f32 v25, v25, v38
mma v[180:183],a[232:235],v[104:107],v[180:183]
ldt a[242:243],v6 offset:6272
v_exp_f32 v34, v170
mma v[180:183],a[228:231],v[100:103],v[180:183]
bld v9,s[8:11],s31 offen offset:1024 nt lds
cvt v213,v38,v39
mma v[180:183],a[224:227],v[96:99],v[180:183]
ldt a[244:245],v6 offset:12416
v_exp_f32 v35, v171
mma v[180:183],a[220:223],v[92:95],v[180:183]
ldt a[246:247],v6 offset:18560
v_exp_f32 v36, v176
mma v[180:183],a[216:219],v[88:91],v[180:183]
bld v10,s[8:11],s31 offen offset:2048 nt lds
v_add_f32 v25, v25, v39
mma v[184:187],a[216:219],v[112:115],v[232:235]
ldt a[248:249],v7 offset:128
v_exp_f32 v37, v177
mma v[184:187],a[220:223],v[116:119],v[184:187]
s_mov_b32 m0, 39936
ldt a[250:251],v7 offset:6272
v_exp_f32 v38, v178
mma v[184:187],a[224:227],v[120:123],v[184:187]
s_mov_b32 s31, 132096
bld v8,s[8:11],s31 offen nt lds
v_add_f32 v26, v32, v33
mma v[184:187],a[228:231],v[124:127],v[184:187]
ldt a[252:253],v7 offset:12416
v_exp_f32 v39, v179
mma v[184:187],a[232:235],v[128:131],v[184:187]
ldt a[254:255],v7 offset:18560
cvt v216,v32,v33
v_add_f32 v26, v26, v34
mma v[184:187],a[236:239],v[132:135],v[184:187]
s_waitcnt lgkmcnt(6)
bld v9,s[8:11],s31 offen offset:1024 nt lds
cvt v217,v34,v35
mma a[96:99],a[240:243],v[240:243],a[96:99]
s_waitcnt lgkmcnt(4)
ldt a[216:217],v4 offset:256
v_exp_f32 v32, v180
mma a[96:99],a[244:247],v[48:51],a[96:99]
ldt a[218:219],v4 offset:6400
v_exp_f32 v33, v181
mma a[100:103],a[244:247],v[52:55],a[100:103]
bld v10,s[8:11],s31 offen offset:2048 nt lds
v_add_f32 v26, v26, v35
mma a[100:103],a[240:243],v[244:247],a[100:103]
ldt a[220:221],v4 offset:12544
v_exp_f32 v34, v182
mma a[104:107],a[240:243],v[248:251],a[104:107]
s_mov_b32 m0, 43008
ldt a[222:223],v4 offset:18688
v_exp_f32 v35, v183
mma a[104:107],a[244:247],v[56:59],a[104:107]
s_mov_b32 s31, 165888
s_waitcnt lgkmcnt(6)
bld v8,s[8:11],s31 offen nt lds
v_add_f32 v24, v24, v36
mma a[120:123],a[248:251],v[248:251],a[120:123]
s_waitcnt lgkmcnt(4)
ldt a[224:225],v5 offset:256
cvt v210,v36,v37
mma a[120:123],a[252:255],v[56:59],a[120:123]
ldt a[226:227],v5 offset:6400
v_exp_f32 v36, v184
mma a[116:119],a[252:255],v[52:55],a[116:119]
bld v9,s[8:11],s31 offen offset:1024 nt lds
v_add_f32 v24, v24, v37
mma a[116:119],a[248:251],v[244:247],a[116:119]
ldt a[228:229],v5 offset:12544
v_exp_f32 v37, v185
mma a[112:115],a[248:251],v[240:243],a[112:115]
ldt a[230:231],v5 offset:18688
mma a[112:115],a[252:255],v[48:51],a[112:115]
s_waitcnt lgkmcnt(6)
bld v10,s[8:11],s31 offen offset:2048 nt lds
v_add_f32 v24, v24, v38
mma a[128:131],a[216:219],v[240:243],a[128:131]
s_waitcnt lgkmcnt(4)
ldt a[232:233],v6 offset:256
cvt v211,v38,v39
mma a[128:131],a[220:223],v[48:51],a[128:131]
s_mov_b32 m0, 46080
ldt a[234:235],v6 offset:6400
v_exp_f32 v38, v186
mma a[132:135],a[220:223],v[52:55],a[132:135]
s_mov_b32 s31, 135168
bld v8,s[8:11],s31 offen nt lds
v_add_f32 v24, v24, v39
mma a[132:135],a[216:219],v[244:247],a[132:135]
ldt a[236:237],v6 offset:12544
v_exp_f32 v39, v187
mma a[136:139],a[216:219],v[248:251],a[136:139]
ldt a[238:239],v6 offset:18688
mma a[136:139],a[220:223],v[56:59],a[136:139]
s_waitcnt lgkmcnt(6)
bld v9,s[8:11],s31 offen offset:1024 nt lds
v_add_f32 v25, v25, v32
mma a[152:155],a[224:227],v[248:251],a[152:155]
s_waitcnt lgkmcnt(4)
ldt a[240:241],v7 offset:256
cvt v214,v32,v33
v_add_f32 v25, v25, v33
mma a[152:155],a[228:231],v[56:59],a[152:155]
ldt a[242:243],v7 offset:6400
v_add_f32 v25, v25, v34
mma a[148:151],a[228:231],v[52:55],a[148:151]
bld v10,s[8:11],s31 offen offset:2048 nt lds
cvt v215,v34,v35
mma a[148:151],a[224:227],v[244:247],a[148:151]
ldt a[244:245],v7 offset:12544
v_add_f32 v25, v25, v35
mma a[144:147],a[224:227],v[240:243],a[144:147]
s_mov_b32 m0, 49152
ldt a[246:247],v7 offset:18688
v_add_f32 v26, v26, v36
mma a[144:147],a[228:231],v[48:51],a[144:147]
s_mov_b32 s31, 168960
s_waitcnt lgkmcnt(6)
bld v8,s[8:11],s31 offen nt lds
cvt v218,v36,v37
mma a[160:163],a[232:235],v[240:243],a[160:163]
s_waitcnt lgkmcnt(4)
v_add_f32 v26, v26, v37
v_add_f32 v26, v26, v38
mma a[160:163],a[236:239],v[48:51],a[160:163]
cvt v219,v38,v39
mma a[164:167],a[236:239],v[52:55],a[164:167]
bld v9,s[8:11],s31 offen offset:1024 nt lds
v_add_f32 v26, v26, v39
mma a[164:167],a[232:235],v[244:247],a[164:167]
v_max3_f32 v40, v24, v25, v26
mma a[168:171],a[232:235],v[248:251],a[168:171]
v_cmp_nge_f32 vcc, s34, v40
mma a[168:171],a[236:239],v[56:59],a[168:171]
s_waitcnt lgkmcnt(2)
mma a[184:187],a[240:243],v[248:251],a[184:187]
s_waitcnt lgkmcnt(0)
v_add_u32 v2, s36, v2
mma a[184:187],a[244:247],v[56:59],a[184:187]
v_add_u32 v3, s36, v3
mma a[180:183],a[244:247],v[52:55],a[180:183]
s_waitcnt vmcnt(62)
s_barrier
mma a[180:183],a[240:243],v[244:247],a[180:183]
s_add_u32 s40, s40, 1
mma a[176:179],a[240:243],v[240:243],a[176:179]
s_cmp_eq_u32 s40, 3
s_cselect_b32 s39, 4294918144, s42
s_cselect_b32 s40, 0, s40
mma a[176:179],a[244:247],v[48:51],a[176:179]
s_cbranch_vccnz L_w3_tr5
L_w3_tr5_ret:
mma v[160:163],a[192:195],v[64:67],v[224:227]
s_mov_b32 m0, 110592
s_mov_b32 s31, 113664
ldq a[216:219],v2
bld v8,s[12:15],s31 offen nt lds
mma v[160:163],a[196:199],v[68:71],v[160:163]
ldq a[220:223],v3
v_add_f32 v28, v28, v24
v_add_f32 v29, v29, v25
mma v[160:163],a[200:203],v[72:75],v[160:163]
ldq a[224:227],v2 offset:128
bld v9,s[12:15],s31 offen offset:1024 nt lds
mma v[160:163],a[204:207],v[76:79],v[160:163]
ldq a[228:231],v3 offset:128
v_add_f32 v30, v30, v26
v_add_u32 v4, s39, v4
mma v[160:163],a[208:211],v[80:83],v[160:163]
ldq a[232:235],v2 offset:256
v_add_u32 v5, s39, v5
v_add_u32 v6, s39, v6
mma v[160:163],a[212:215],v[84:87],v[160:163]
ldq a[236:239],v3 offset:256
bld v10,s[12:15],s31 offen offset:2048 nt lds
mma v[164:167],a[212:215],v[108:111],v[228:231]
v_add_u32 v7, s39, v7
mma v[164:167],a[208:211],v[104:107],v[164:167]
s_add_u32 s37, s37, 1
mma v[164:167],a[204:207],v[100:103],v[164:167]
s_cmp_eq_u32 s37, 7
s_cselect_b32 s36, 4294893568, s43
s_cselect_b32 s37, 0, s37
s_mov_b32 m0, 113664
s_mov_b32 s31, 82944
bld v8,s[12:15],s31 offen nt lds
mma v[164:167],a[200:203],v[96:99],v[164:167]
v_exp_f32 v32, v160
mma v[164:167],a[196:199],v[92:95],v[164:167]
v_exp_f32 v33, v161
mma v[164:167],a[192:195],v[88:91],v[164:167]
bld v9,s[12:15],s31 offen offset:1024 nt lds
v_add_f32 v24, v32, v33
mma v[168:171],a[192:195],v[112:115],v[232:235]
v_exp_f32 v34, v162
cvt v240,v32,v33
mma v[168:171],a[196:199],v[116:119],v[168:171]
v_exp_f32 v35, v163
v_add_f32 v24, v24, v34
mma v[168:171],a[200:203],v[120:123],v[168:171]
bld v10,s[12:15],s31 offen offset:2048 nt lds
cvt v241,v34,v35
mma v[168:171],a[204:207],v[124:127],v[168:171]
v_exp_f32 v36, v164
v_add_f32 v24, v24, v35
mma v[168:171],a[208:211],v[128:131],v[168:171]
s_mov_b32 m0, 116736
v_exp_f32 v37, v165
mma v[168:171],a[212:215],v[132:135],v[168:171]
s_mov_b32 s31, 116736
s_waitcnt lgkmcnt(5)
bld v8,s[12:15],s31 offen nt lds
v_add_f32 v25, v36, v37
mma v[176:179],a[216:219],v[64:67],v[224:227]
s_waitcnt lgkmcnt(4)
v_exp_f32 v38, v166
cvt v244,v36,v37
mma v[176:179],a[220:223],v[68:71],v[176:179]
s_waitcnt lgkmcnt(3)
ldq a[192:195],v2 offset:6144
v_exp_f32 v39, v167
mma v[176:179],a[224:227],v[72:75],v[176:179]
s_waitcnt lgkmcnt(3)
ldq a[196:199],v3 offset:6144
bld v9,s[12:15],s31 offen offset:1024 nt lds
mma v[176:179],a[228:231],v[76:79],v[176:179]
s_waitcnt lgkmcnt(3)
ldq a[200:203],v2 offset:6272
v_exp_f32 v32, v168
mma v[176:179],a[232:235],v[80:83],v[176:179]
s_waitcnt lgkmcnt(3)
ldq a[204:207],v3 offset:6272
v_exp_f32 v33, v169
mma v[176:179],a[236:239],v[84:87],v[176:179]
ldq a[208:211],v2 offset:6400
bld v10,s[12:15],s31 offen offset:2048 nt lds
mma v[180:183],a[236:239],v[108:111],v[228:231]
ldq a[212:215],v3 offset:6400
ldt a[240:241],v4
v_add_f32 v25, v25, v38
mma v[180:183],a[232:235],v[104:107],v[180:183]
s_mov_b32 m0, 119808
ldt a[242:243],v4 offset:6144
v_exp_f32 v34, v170
mma v[180:183],a[228:231],v[100:103],v[180:183]
s_mov_b32 s31, 86016
bld v8,s[12:15],s31 offen nt lds
cvt v245,v38,v39
mma v[180:183],a[224:227],v[96:99],v[180:183]
ldt a[244:245],v4 offset:12288
v_exp_f32 v35, v171
mma v[180:183],a[220:223],v[92:95],v[180:183]
ldt a[246:247],v4 offset:18432
v_exp_f32 v36, v176
mma v[180:183],a[216:219],v[88:91],v[180:183]
bld v9,s[12:15],s31 offen offset:1024 nt lds
v_add_f32 v25, v25, v39
mma v[184:187],a[216:219],v[112:115],v[232:235]
ldt a[248:249],v5
v_exp_f32 v37, v177
mma v[184:187],a[220:223],v[116:119],v[184:187]
ldt a[250:251],v5 offset:6144
v_exp_f32 v38, v178
mma v[184:187],a[224:227],v[120:123],v[184:187]
bld v10,s[12:15],s31 offen offset:2048 nt lds
v_add_f32 v26, v32, v33
mma v[184:187],a[228:231],v[124:127],v[184:187]
ldt a[252:253],v5 offset:12288
v_exp_f32 v39, v179
mma v[184:187],a[232:235],v[128:131],v[184:187]
s_mov_b32 m0, 122880
ldt a[254:255],v5 offset:18432
cvt v248,v32,v33
v_add_f32 v26, v26, v34
mma v[184:187],a[236:239],v[132:135],v[184:187]
s_mov_b32 s31, 119808
s_waitcnt lgkmcnt(6)
bld v8,s[12:15],s31 offen nt lds
cvt v249,v34,v35
mma a[0:3],a[240:243],v[192:195],a[0:3]
s_waitcnt lgkmcnt(4)
ldt a[216:217],v6
v_exp_f32 v32, v180
mma a[0:3],a[244:247],v[208:211],a[0:3]
ldt a[218:219],v6 offset:6144
v_exp_f32 v33, v181
mma a[4:7],a[244:247],v[212:215],a[4:7]
bld v9,s[12:15],s31 offen offset:1024 nt lds
v_add_f32 v26, v26, v35
mma a[4:7],a[240:243],v[196:199],a[4:7]
ldt a[220:221],v6 offset:12288
v_exp_f32 v34, v182
mma a[8:11],a[240:243],v[200:203],a[8:11]
ldt a[222:223],v6 offset:18432
v_exp_f32 v35, v183
mma a[8:11],a[244:247],v[216:219],a[8:11]
s_waitcnt lgkmcnt(6)
bld v10,s[12:15],s31 offen offset:2048 nt lds
mma a[24:27],a[248:251],v[200:203],a[24:27]
s_waitcnt lgkmcnt(4)
ldt a[224:225],v7
v_add_f32 v24, v24, v36
mma a[24:27],a[252:255],v[216:219],a[24:27]
s_mov_b32 m0, 125952
ldt a[226:227],v7 offset:6144
cvt v242,v36,v37
mma a[20:23],a[252:255],v[212:215],a[20:23]
s_mov_b32 s31, 89088
bld v8,s[12:15],s31 offen nt lds
v_add_f32 v24, v24, v37
mma a[20:23],a[248:251],v[196:199],a[20:23]
ldt a[228:229],v7 offset:12288
v_exp_f32 v36, v184
mma a[16:19],a[248:251],v[192:195],a[16:19]
ldt a[230:231],v7 offset:18432
v_exp_f32 v37, v185
mma a[16:19],a[252:255],v[208:211],a[16:19]
s_waitcnt lgkmcnt(6)
bld v9,s[12:15],s31 offen offset:1024 nt lds
mma a[32:35],a[216:219],v[192:195],a[32:35]
s_waitcnt lgkmcnt(4)
ldt a[232:233],v4 offset:128
v_add_f32 v24, v24, v38
cvt v243,v38,v39
mma a[32:35],a[220:223],v[208:211],a[32:35]
ldt a[234:235],v4 offset:6272
v_exp_f32 v38, v186
mma a[36:39],a[220:223],v[212:215],a[36:39]
bld v10,s[12:15],s31 offen offset:2048 nt lds
mma a[36:39],a[216:219],v[196:199],a[36:39]
ldt a[236:237],v4 offset:12416
v_add_f32 v24, v24, v39
mma a[40:43],a[216:219],v[200:203],a[40:43]
s_mov_b32 m0, 129024
ldt a[238:239],v4 offset:18560
v_exp_f32 v39, v187
mma a[40:43],a[220:223],v[216:219],a[40:43]
s_mov_b32 s31, 122880
s_waitcnt lgkmcnt(6)
bld v8,s[12:15],s31 offen nt lds
v_add_f32 v25, v25, v32
mma a[56:59],a[224:227],v[200:203],a[56:59]
s_waitcnt lgkmcnt(4)
ldt a[240:241],v5 offset:128
cvt v246,v32,v33
mma a[56:59],a[228:231],v[216:219],a[56:59]
ldt a[242:243],v5 offset:6272
v_add_f32 v25, v25, v33
mma a[52:55],a[228:231],v[212:215],a[52:55]
bld v9,s[12:15],s31 offen offset:1024 nt lds
v_add_f32 v25, v25, v34
mma a[52:55],a[224:227],v[196:199],a[52:55]
ldt a[244:245],v5 offset:12416
cvt v247,v34,v35
v_add_f32 v25, v25, v35
mma a[48:51],a[224:227],v[192:195],a[48:51]
ldt a[246:247],v5 offset:18560
v_add_f32 v26, v26, v36
mma a[48:51],a[228:231],v[208:211],a[48:51]
s_waitcnt lgkmcnt(6)
bld v10,s[12:15],s31 offen offset:2048 nt lds
cvt v250,v36,v37
mma a[64:67],a[232:235],v[192:195],a[64:67]
s_waitcnt lgkmcnt(4)
v_add_f32 v26, v26, v37
v_add_f32 v26, v26, v38
mma a[64:67],a[236:239],v[208:211],a[64:67]
s_mov_b32 m0, 132096
cvt v251,v38,v39
mma a[68:71],a[236:239],v[212:215],a[68:71]
s_mov_b32 s31, 92160
bld v8,s[12:15],s31 offen nt lds
v_add_f32 v26, v26, v39
mma a[68:71],a[232:235],v[196:199],a[68:71]
v_max3_f32 v40, v24, v25, v26
mma a[72:75],a[232:235],v[200:203],a[72:75]
v_cmp_nge_f32 vcc, s34, v40
mma a[72:75],a[236:239],v[216:219],a[72:75]
s_waitcnt lgkmcnt(2)
mma a[88:91],a[240:243],v[200:203],a[88:91]
s_waitcnt lgkmcnt(0)
v_add_u32 v2, s36, v2
mma a[88:91],a[244:247],v[216:219],a[88:91]
v_add_u32 v3, s36, v3
mma a[84:87],a[244:247],v[212:215],a[84:87]
s_barrier
mma a[84:87],a[240:243],v[196:199],a[84:87]
mma a[80:83],a[240:243],v[192:195],a[80:83]
mma a[80:83],a[244:247],v[208:211],a[80:83]
s_cbranch_vccnz L_w3_tr6
L_w3_tr6_ret:
mma v[160:163],a[192:195],v[64:67],v[224:227]
s_mov_b32 m0, 132096
s_mov_b32 s31, 92160
ldq a[216:219],v2
bld v9,s[12:15],s31 offen offset:1024 nt lds
mma v[160:163],a[196:199],v[68:71],v[160:163]
ldq a[220:223],v3
v_add_f32 v28, v28, v24
v_add_f32 v29, v29, v25
mma v[160:163],a[200:203],v[72:75],v[160:163]
ldq a[224:227],v2 offset:128
bld v10,s[12:15],s31 offen offset:2048 nt lds
mma v[160:163],a[204:207],v[76:79],v[160:163]
ldq a[228:231],v3 offset:128
v_add_f32 v30, v30, v26
mma v[160:163],a[208:211],v[80:83],v[160:163]
s_mov_b32 m0, 49152
ldq a[232:235],v2 offset:256
mma v[160:163],a[212:215],v[84:87],v[160:163]
s_mov_b32 s31, 168960
ldq a[236:239],v3 offset:256
bld v10,s[8:11],s31 offen offset:2048 nt lds
mma v[164:167],a[212:215],v[108:111],v[228:231]
mma v[164:167],a[208:211],v[104:107],v[164:167]
s_add_u32 s37, s37, 1
mma v[164:167],a[204:207],v[100:103],v[164:167]
s_cmp_eq_u32 s37, 7
s_cselect_b32 s36, 4294893568, s43
s_cselect_b32 s37, 0, s37
s_mov_b32 m0, 52224
s_mov_b32 s31, 138240
bld v8,s[8:11],s31 offen nt lds
mma v[164:167],a[200:203],v[96:99],v[164:167]
v_exp_f32 v32, v160
mma v[164:167],a[196:199],v[92:95],v[164:167]
v_exp_f32 v33, v161
mma v[164:167],a[192:195],v[88:91],v[164:167]
bld v9,s[8:11],s31 offen offset:1024 nt lds
v_add_f32 v24, v32, v33
mma v[168:171],a[192:195],v[112:115],v[232:235]
v_exp_f32 v34, v162
cvt v48,v32,v33
mma v[168:171],a[196:199],v[116:119],v[168:171]
v_exp_f32 v35, v163
v_add_f32 v24, v24, v34
mma v[168:171],a[200:203],v[120:123],v[168:171]
bld v10,s[8:11],s31 offen offset:2048 nt lds
cvt v49,v34,v35
mma v[168:171],a[204:207],v[124:127],v[168:171]
v_exp_f32 v36, v164
v_add_f32 v24, v24, v35
mma v[168:171],a[208:211],v[128:131],v[168:171]
s_mov_b32 m0, 55296
v_exp_f32 v37, v165
mma v[168:171],a[212:215],v[132:135],v[168:171]
s_mov_b32 s31, 172032
s_waitcnt lgkmcnt(5)
bld v8,s[8:11],s31 offen nt lds
v_add_f32 v25, v36, v37
mma v[176:179],a[216:219],v[64:67],v[224:227]
s_waitcnt lgkmcnt(4)
v_exp_f32 v38, v166
cvt v52,v36,v37
mma v[176:179],a[220:223],v[68:71],v[176:179]
s_waitcnt lgkmcnt(3)
ldq a[192:195],v2 offset:6144
v_exp_f32 v39, v167
mma v[176:179],a[224:227],v[72:75],v[176:179]
s_waitcnt lgkmcnt(3)
ldq a[196:199],v3 offset:6144
bld v9,s[8:11],s31 offen offset:1024 nt lds
mma v[176:179],a[228:231],v[76:79],v[176:179]
s_waitcnt lgkmcnt(3)
ldq a[200:203],v2 offset:6272
v_exp_f32 v32, v168
mma v[176:179],a[232:235],v[80:83],v[176:179]
s_waitcnt lgkmcnt(3)
ldq a[204:207],v3 offset:6272
v_exp_f32 v33, v169
mma v[176:179],a[236:239],v[84:87],v[176:179]
ldq a[208:211],v2 offset:6400
bld v10,s[8:11],s31 offen offset:2048 nt lds
mma v[180:183],a[236:239],v[108:111],v[228:231]
ldq a[212:215],v3 offset:6400
ldt a[240:241],v6 offset:128
v_add_f32 v25, v25, v38
mma v[180:183],a[232:235],v[104:107],v[180:183]
s_mov_b32 m0, 58368
ldt a[242:243],v6 offset:6272
v_exp_f32 v34, v170
mma v[180:183],a[228:231],v[100:103],v[180:183]
s_mov_b32 s31, 141312
bld v8,s[8:11],s31 offen nt lds
cvt v53,v38,v39
mma v[180:183],a[224:227],v[96:99],v[180:183]
ldt a[244:245],v6 offset:12416
v_exp_f32 v35, v171
mma v[180:183],a[220:223],v[92:95],v[180:183]
ldt a[246:247],v6 offset:18560
v_exp_f32 v36, v176
mma v[180:183],a[216:219],v[88:91],v[180:183]
bld v9,s[8:11],s31 offen offset:1024 nt lds
v_add_f32 v25, v25, v39
mma v[184:187],a[216:219],v[112:115],v[232:235]
ldt a[248:249],v7 offset:128
v_exp_f32 v37, v177
mma v[184:187],a[220:223],v[116:119],v[184:187]
ldt a[250:251],v7 offset:6272
v_exp_f32 v38, v178
mma v[184:187],a[224:227],v[120:123],v[184:187]
bld v10,s[8:11],s31 offen offset:2048 nt lds
v_add_f32 v26, v32, v33
mma v[184:187],a[228:231],v[124:127],v[184:187]
ldt a[252:253],v7 offset:12416
v_exp_f32 v39, v179
mma v[184:187],a[232:235],v[128:131],v[184:187]
s_mov_b32 m0, 61440
ldt a[254:255],v7 offset:18560
cvt v56,v32,v33
v_add_f32 v26, v26, v34
mma v[184:187],a[236:239],v[132:135],v[184:187]
s_mov_b32 s31, 175104
s_waitcnt lgkmcnt(6)
bld v8,s[8:11],s31 offen nt lds
cvt v57,v34,v35
mma a[96:99],a[240:243],v[192:195],a[96:99]
s_waitcnt lgkmcnt(4)
ldt a[216:217],v4 offset:256
v_exp_f32 v32, v180
mma a[96:99],a[244:247],v[208:211],a[96:99]
ldt a[218:219],v4 offset:6400
v_exp_f32 v33, v181
mma a[100:103],a[244:247],v[212:215],a[100:103]
bld v9,s[8:11],s31 offen offset:1024 nt lds
v_add_f32 v26, v26, v35
mma a[100:103],a[240:243],v[196:199],a[100:103]
ldt a[220:221],v4 offset:12544
v_exp_f32 v34, v182
mma a[104:107],a[240:243],v[200:203],a[104:107]
ldt a[222:223],v4 offset:18688
v_exp_f32 v35, v183
mma a[104:107],a[244:247],v[216:219],a[104:107]
s_waitcnt lgkmcnt(6)
bld v10,s[8:11],s31 offen offset:2048 nt lds
v_add_f32 v24, v24, v36
mma a[120:123],a[248:251],v[200:203],a[120:123]
s_waitcnt lgkmcnt(4)
ldt a[224:225],v5 offset:256
cvt v50,v36,v37
mma a[120:123],a[252:255],v[216:219],a[120:123]
s_mov_b32 m0, 64512
ldt a[226:227],v5 offset:6400
v_exp_f32 v36, v184
mma a[116:119],a[252:255],v[212:215],a[116:119]
s_mov_b32 s31, 144384
bld v8,s[8:11],s31 offen nt lds
v_add_f32 v24, v24, v37
mma a[116:119],a[248:251],v[196:199],a[116:119]
ldt a[228:229],v5 offset:12544
v_exp_f32 v37, v185
mma a[112:115],a[248:251],v[192:195],a[112:115]
ldt a[230:231],v5 offset:18688
mma a[112:115],a[252:255],v[208:211],a[112:115]
s_waitcnt lgkmcnt(6)
bld v9,s[8:11],s31 offen offset:1024 nt lds
v_add_f32 v24, v24, v38
mma a[128:131],a[216:219],v[192:195],a[128:131]
s_waitcnt lgkmcnt(4)
ldt a[232:233],v6 offset:256
cvt v51,v38,v39
mma a[128:131],a[220:223],v[208:211],a[128:131]
ldt a[234:235],v6 offset:6400
v_exp_f32 v38, v186
mma a[132:135],a[220:223],v[212:215],a[132:135]
bld v10,s[8:11],s31 offen offset:2048 nt lds
v_add_f32 v24, v24, v39
mma a[132:135],a[216:219],v[196:199],a[132:135]
ldt a[236:237],v6 offset:12544
v_exp_f32 v39, v187
mma a[136:139],a[216:219],v[200:203],a[136:139]
s_mov_b32 m0, 67584
ldt a[238:239],v6 offset:18688
mma a[136:139],a[220:223],v[216:219],a[136:139]
s_mov_b32 s31, 178176
s_waitcnt lgkmcnt(6)
bld v8,s[8:11],s31 offen nt lds
v_add_f32 v25, v25, v32
mma a[152:155],a[224:227],v[200:203],a[152:155]
s_waitcnt lgkmcnt(4)
ldt a[240:241],v7 offset:256
cvt v54,v32,v33
v_add_f32 v25, v25, v33
mma a[152:155],a[228:231],v[216:219],a[152:155]
ldt a[242:243],v7 offset:6400
v_add_f32 v25, v25, v34
mma a[148:151],a[228:231],v[212:215],a[148:151]
bld v9,s[8:11],s31 offen offset:1024 nt lds
cvt v55,v34,v35
mma a[148:151],a[224:227],v[196:199],a[148:151]
ldt a[244:245],v7 offset:12544
v_add_f32 v25, v25, v35
mma a[144:147],a[224:227],v[192:195],a[144:147]
ldt a[246:247],v7 offset:18688
v_add_f32 v26, v26, v36
mma a[144:147],a[228:231],v[208:211],a[144:147]
s_waitcnt lgkmcnt(6)
bld v10,s[8:11],s31 offen offset:2048 nt lds
cvt v58,v36,v37
mma a[160:163],a[232:235],v[192:195],a[160:163]
s_waitcnt lgkmcnt(4)
v_add_f32 v26, v26, v37
v_add_f32 v26, v26, v38
mma a[160:163],a[236:239],v[208:211],a[160:163]
s_mov_b32 m0, 70656
cvt v59,v38,v39
mma a[164:167],a[236:239],v[212:215],a[164:167]
s_mov_b32 s31, 147456
bld v8,s[8:11],s31 offen nt lds
v_add_f32 v26, v26, v39
mma a[164:167],a[232:235],v[196:199],a[164:167]
v_max3_f32 v40, v24, v25, v26
mma a[168:171],a[232:235],v[200:203],a[168:171]
v_cmp_nge_f32 vcc, s34, v40
mma a[168:171],a[236:239],v[216:219],a[168:171]
s_waitcnt lgkmcnt(2)
mma a[184:187],a[240:243],v[200:203],a[184:187]
s_waitcnt lgkmcnt(0)
v_add_u32 v2, s36, v2
mma a[184:187],a[244:247],v[216:219],a[184:187]
v_add_u32 v3, s36, v3
mma a[180:183],a[244:247],v[212:215],a[180:183]
s_waitcnt vmcnt(62)
s_barrier
mma a[180:183],a[240:243],v[196:199],a[180:183]
s_add_u32 s40, s40, 1
mma a[176:179],a[240:243],v[192:195],a[176:179]
s_cmp_eq_u32 s40, 3
s_cselect_b32 s39, 4294918144, s42
s_cselect_b32 s40, 0, s40
mma a[176:179],a[244:247],v[208:211],a[176:179]
s_cbranch_vccnz L_w3_tr7
L_w3_tr7_ret:
mma v[160:163],a[192:195],v[64:67],v[224:227]
s_mov_b32 m0, 135168
s_mov_b32 s31, 125952
ldq a[216:219],v2
bld v8,s[12:15],s31 offen nt lds
mma v[160:163],a[196:199],v[68:71],v[160:163]
ldq a[220:223],v3
v_add_f32 v28, v28, v24
v_add_f32 v29, v29, v25
mma v[160:163],a[200:203],v[72:75],v[160:163]
ldq a[224:227],v2 offset:128
v_add_f32 v30, v30, v26
v_add_u32 v4, s39, v4
mma v[160:163],a[204:207],v[76:79],v[160:163]
ldq a[228:231],v3 offset:128
bld v9,s[12:15],s31 offen offset:1024 nt lds
mma v[160:163],a[208:211],v[80:83],v[160:163]
ldq a[232:235],v2 offset:256
v_add_u32 v5, s39, v5
v_add_u32 v6, s39, v6
mma v[160:163],a[212:215],v[84:87],v[160:163]
ldq a[236:239],v3 offset:256
v_add_u32 v7, s39, v7
mma v[164:167],a[212:215],v[108:111],v[228:231]
bld v10,s[12:15],s31 offen offset:2048 nt lds
mma v[164:167],a[208:211],v[104:107],v[164:167]
s_add_u32 s37, s37, 1
mma v[164:167],a[204:207],v[100:103],v[164:167]
s_cmp_eq_u32 s37, 7
s_cselect_b32 s36, 4294893568, s43
s_cselect_b32 s37, 0, s37
mma v[164:167],a[200:203],v[96:99],v[164:167]
s_mov_b32 m0, 138240
s_mov_b32 s31, 95232
bld v8,s[12:15],s31 offen nt lds
mma v[164:167],a[196:199],v[92:95],v[164:167]
v_exp_f32 v32, v160
mma v[164:167],a[192:195],v[88:91],v[164:167]
v_exp_f32 v33, v161
mma v[168:171],a[192:195],v[112:115],v[232:235]
bld v9,s[12:15],s31 offen offset:1024 nt lds
v_add_f32 v24, v32, v33
mma v[168:171],a[196:199],v[116:119],v[168:171]
v_exp_f32 v34, v162
cvt v192,v32,v33
mma v[168:171],a[200:203],v[120:123],v[168:171]
v_exp_f32 v35, v163
v_add_f32 v24, v24, v34
mma v[168:171],a[204:207],v[124:127],v[168:171]
bld v10,s[12:15],s31 offen offset:2048 nt lds
cvt v193,v34,v35
mma v[168:171],a[208:211],v[128:131],v[168:171]
v_exp_f32 v36, v164
v_add_f32 v24, v24, v35
mma v[168:171],a[212:215],v[132:135],v[168:171]
s_mov_b32 m0, 141312
s_waitcnt lgkmcnt(5)
v_exp_f32 v37, v165
mma v[176:179],a[216:219],v[64:67],v[224:227]
s_mov_b32 s31, 129024
s_waitcnt lgkmcnt(4)
bld v8,s[12:15],s31 offen nt lds
v_add_f32 v25, v36, v37
mma v[176:179],a[220:223],v[68:71],v[176:179]
s_waitcnt lgkmcnt(3)
ldq a[192:195],v2 offset:6144
v_exp_f32 v38, v166
mma v[176:179],a[224:227],v[72:75],v[176:179]
s_waitcnt lgkmcnt(3)
ldq a[196:199],v3 offset:6144
v_exp_f32 v39, v167
mma v[176:179],a[228:231],v[76:79],v[176:179]
s_waitcnt lgkmcnt(3)
ldq a[200:203],v2 offset:6272
bld v9,s[12:15],s31 offen offset:1024 nt lds
mma v[176:179],a[232:235],v[80:83],v[176:179]
s_waitcnt lgkmcnt(3)
ldq a[204:207],v3 offset:6272
v_exp_f32 v32, v168
mma v[176:179],a[236:239],v[84:87],v[176:179]
ldq a[208:211],v2 offset:6400
v_exp_f32 v33, v169
mma v[180:183],a[236:239],v[108:111],v[228:231]
ldq a[212:215],v3 offset:6400
ldt a[240:241],v4
cvt v196,v36,v37
mma v[180:183],a[232:235],v[104:107],v[180:183]
ldt a[242:243],v4 offset:6144
bld v10,s[12:15],s31 offen offset:2048 nt lds
mma v[180:183],a[228:231],v[100:103],v[180:183]
s_mov_b32 m0, 144384
v_exp_f32 v34, v170
v_add_f32 v25, v25, v38
mma v[180:183],a[224:227],v[96:99],v[180:183]
s_mov_b32 s31, 132096
ldt a[244:245],v4 offset:12288
bld v8,s[12:15],s31 offen nt lds
mma v[180:183],a[220:223],v[92:95],v[180:183]
ldt a[246:247],v4 offset:18432
v_exp_f32 v35, v171
mma v[180:183],a[216:219],v[88:91],v[180:183]
v_exp_f32 v36, v176
cvt v197,v38,v39
mma v[184:187],a[216:219],v[112:115],v[232:235]
ldt a[248:249],v5
bld v9,s[12:15],s31 offen offset:1024 nt lds
mma v[184:187],a[220:223],v[116:119],v[184:187]
ldt a[250:251],v5 offset:6144
v_exp_f32 v37, v177
mma v[184:187],a[224:227],v[120:123],v[184:187]
v_exp_f32 v38, v178
v_add_f32 v25, v25, v39
mma v[184:187],a[228:231],v[124:127],v[184:187]
ldt a[252:253],v5 offset:12288
v_exp_f32 v39, v179
mma v[184:187],a[232:235],v[128:131],v[184:187]
ldt a[254:255],v5 offset:18432
bld v10,s[12:15],s31 offen offset:2048 nt lds
mma v[184:187],a[236:239],v[132:135],v[184:187]
s_waitcnt lgkmcnt(6)
v_add_f32 v26, v32, v33
cvt v200,v32,v33
v_add_f32 v26, v26, v34
mma a[0:3],a[240:243],v[240:243],a[0:3]
s_mov_b32 m0, 147456
s_waitcnt lgkmcnt(4)
ldt a[216:217],v6
v_exp_f32 v32, v180
mma a[0:3],a[244:247],v[48:51],a[0:3]
s_mov_b32 s31, 165888
ldt a[218:219],v6 offset:6144
bld v8,s[12:15],s31 offen nt lds
mma a[4:7],a[244:247],v[52:55],a[4:7]
v_exp_f32 v33, v181
cvt v201,v34,v35
mma a[4:7],a[240:243],v[244:247],a[4:7]
ldt a[220:221],v6 offset:12288
v_exp_f32 v34, v182
mma a[8:11],a[240:243],v[248:251],a[8:11]
ldt a[222:223],v6 offset:18432
bld v9,s[12:15],s31 offen offset:1024 nt lds
mma a[8:11],a[244:247],v[56:59],a[8:11]
s_waitcnt lgkmcnt(6)
v_add_f32 v26, v26, v35
v_exp_f32 v35, v183
mma a[24:27],a[248:251],v[248:251],a[24:27]
s_waitcnt lgkmcnt(4)
ldt a[224:225],v7
v_add_f32 v24, v24, v36
mma a[24:27],a[252:255],v[56:59],a[24:27]
ldt a[226:227],v7 offset:6144
bld v10,s[12:15],s31 offen offset:2048 nt lds
mma a[20:23],a[252:255],v[52:55],a[20:23]
cvt v194,v36,v37
v_exp_f32 v36, v184
mma a[20:23],a[248:251],v[244:247],a[20:23]
s_mov_b32 m0, 150528
ldt a[228:229],v7 offset:12288
v_add_f32 v24, v24, v37
mma a[16:19],a[248:251],v[240:243],a[16:19]
s_mov_b32 s31, 135168
ldt a[230:231],v7 offset:18432
bld v8,s[12:15],s31 offen nt lds
mma a[16:19],a[252:255],v[48:51],a[16:19]
s_waitcnt lgkmcnt(6)
v_exp_f32 v37, v185
mma a[32:35],a[216:219],v[240:243],a[32:35]
s_waitcnt lgkmcnt(4)
ldt a[232:233],v4 offset:128
v_add_f32 v24, v24, v38
cvt v195,v38,v39
mma a[32:35],a[220:223],v[48:51],a[32:35]
ldt a[234:235],v4 offset:6272
bld v9,s[12:15],s31 offen offset:1024 nt lds
mma a[36:39],a[220:223],v[52:55],a[36:39]
v_exp_f32 v38, v186
mma a[36:39],a[216:219],v[244:247],a[36:39]
ldt a[236:237],v4 offset:12416
v_add_f32 v24, v24, v39
mma a[40:43],a[216:219],v[248:251],a[40:43]
ldt a[238:239],v4 offset:18560
bld v10,s[12:15],s31 offen offset:2048 nt lds
mma a[40:43],a[220:223],v[56:59],a[40:43]
s_waitcnt lgkmcnt(6)
v_exp_f32 v39, v187
v_add_f32 v25, v25, v32
mma a[56:59],a[224:227],v[248:251],a[56:59]
s_mov_b32 m0, 153600
s_waitcnt lgkmcnt(4)
ldt a[240:241],v5 offset:128
cvt v198,v32,v33
mma a[56:59],a[228:231],v[56:59],a[56:59]
s_mov_b32 s31, 168960
ldt a[242:243],v5 offset:6272
bld v8,s[12:15],s31 offen nt lds
mma a[52:55],a[228:231],v[52:55],a[52:55]
v_add_f32 v25, v25, v33
v_add_f32 v25, v25, v34
cvt v199,v34,v35
mma a[52:55],a[224:227],v[244:247],a[52:55]
ldt a[244:245],v5 offset:12416
v_add_f32 v25, v25, v35
mma a[48:51],a[224:227],v[240:243],a[48:51]
ldt a[246:247],v5 offset:18560
bld v9,s[12:15],s31 offen offset:1024 nt lds
mma a[48:51],a[228:231],v[48:51],a[48:51]
s_waitcnt lgkmcnt(6)
v_add_f32 v26, v26, v36
cvt v202,v36,v37
mma a[64:67],a[232:235],v[240:243],a[64:67]
s_waitcnt lgkmcnt(4)
v_add_f32 v26, v26, v37
v_add_f32 v26, v26, v38
mma a[64:67],a[236:239],v[48:51],a[64:67]
bld v10,s[12:15],s31 offen offset:2048 nt lds
cvt v203,v38,v39
mma a[68:71],a[236:239],v[52:55],a[68:71]
v_add_f32 v26, v26, v39
mma a[68:71],a[232:235],v[244:247],a[68:71]
v_max3_f32 v40, v24, v25, v26
mma a[72:75],a[232:235],v[248:251],a[72:75]
v_cmp_nge_f32 vcc, s34, v40
mma a[72:75],a[236:239],v[56:59],a[72:75]
s_waitcnt lgkmcnt(2)
mma a[88:91],a[240:243],v[248:251],a[88:91]
s_waitcnt lgkmcnt(0)
v_add_u32 v2, s36, v2
mma a[88:91],a[244:247],v[56:59],a[88:91]
v_add_u32 v3, s36, v3
mma a[84:87],a[244:247],v[52:55],a[84:87]
s_waitcnt vmcnt(62)
s_barrier
mma a[84:87],a[240:243],v[244:247],a[84:87]
mma a[80:83],a[240:243],v[240:243],a[80:83]
mma a[80:83],a[244:247],v[48:51],a[80:83]
s_cbranch_vccnz L_w3_tr8
L_w3_tr8_ret:
mma v[160:163],a[192:195],v[64:67],v[224:227]
s_mov_b32 m0, 156672
s_mov_b32 s31, 138240
ldq a[216:219],v2
bld v8,s[12:15],s31 offen nt lds
mma v[160:163],a[196:199],v[68:71],v[160:163]
ldq a[220:223],v3
v_add_f32 v28, v28, v24
v_add_f32 v29, v29, v25
mma v[160:163],a[200:203],v[72:75],v[160:163]
ldq a[224:227],v2 offset:128
v_add_f32 v30, v30, v26
mma v[160:163],a[204:207],v[76:79],v[160:163]
ldq a[228:231],v3 offset:128
bld v9,s[12:15],s31 offen offset:1024 nt lds
mma v[160:163],a[208:211],v[80:83],v[160:163]
ldq a[232:235],v2 offset:256
mma v[160:163],a[212:215],v[84:87],v[160:163]
ldq a[236:239],v3 offset:256
mma v[164:167],a[212:215],v[108:111],v[228:231]
bld v10,s[12:15],s31 offen offset:2048 nt lds
mma v[164:167],a[208:211],v[104:107],v[164:167]
s_add_u32 s37, s37, 1
mma v[164:167],a[204:207],v[100:103],v[164:167]
s_cmp_eq_u32 s37, 7
s_cselect_b32 s36, 4294893568, s43
s_cselect_b32 s37, 0, s37
mma v[164:167],a[200:203],v[96:99],v[164:167]
s_mov_b32 m0, 70656
s_mov_b32 s31, 147456
bld v9,s[8:11],s31 offen offset:1024 nt lds
mma v[164:167],a[196:199],v[92:95],v[164:167]
v_exp_f32 v32, v160
mma v[164:167],a[192:195],v[88:91],v[164:167]
v_exp_f32 v33, v161
mma v[168:171],a[192:195],v[112:115],v[232:235]
bld v10,s[8:11],s31 offen offset:2048 nt lds
v_add_f32 v24, v32, v33
mma v[168:171],a[196:199],v[116:119],v[168:171]
v_exp_f32 v34, v162
cvt v208,v32,v33
mma v[168:171],a[200:203],v[120:123],v[168:171]
s_mov_b32 m0, 73728
v_exp_f32 v35, v163
v_add_f32 v24, v24, v34
mma v[168:171],a[204:207],v[124:127],v[168:171]
s_mov_b32 s31, 181248
bld v8,s[8:11],s31 offen nt lds
cvt v209,v34,v35
mma v[168:171],a[208:211],v[128:131],v[168:171]
v_exp_f32 v36, v164
v_add_f32 v24, v24, v35
mma v[168:171],a[212:215],v[132:135],v[168:171]
s_waitcnt lgkmcnt(5)
v_exp_f32 v37, v165
mma v[176:179],a[216:219],v[64:67],v[224:227]
s_waitcnt lgkmcnt(4)
bld v9,s[8:11],s31 offen offset:1024 nt lds
v_add_f32 v25, v36, v37
mma v[176:179],a[220:223],v[68:71],v[176:179]
s_waitcnt lgkmcnt(3)
ldq a[192:195],v2 offset:6144
v_exp_f32 v38, v166
mma v[176:179],a[224:227],v[72:75],v[176:179]
s_waitcnt lgkmcnt(3)
ldq a[196:199],v3 offset:6144
v_exp_f32 v39, v167
mma v[176:179],a[228:231],v[76:79],v[176:179]
s_waitcnt lgkmcnt(3)
ldq a[200:203],v2 offset:6272
bld v10,s[8:11],s31 offen offset:2048 nt lds
mma v[176:179],a[232:235],v[80:83],v[176:179]
s_waitcnt lgkmcnt(3)
ldq a[204:207],v3 offset:6272
v_exp_f32 v32, v168
mma v[176:179],a[236:239],v[84:87],v[176:179]
ldq a[208:211],v2 offset:6400
v_exp_f32 v33, v169
mma v[180:183],a[236:239],v[108:111],v[228:231]
s_mov_b32 m0, 76800
ldq a[212:215],v3 offset:6400
ldt a[240:241],v6 offset:128
cvt v212,v36,v37
mma v[180:183],a[232:235],v[104:107],v[180:183]
s_mov_b32 s31, 150528
ldt a[242:243],v6 offset:6272
bld v8,s[8:11],s31 offen nt lds
mma v[180:183],a[228:231],v[100:103],v[180:183]
v_exp_f32 v34, v170
v_add_f32 v25, v25, v38
mma v[180:183],a[224:227],v[96:99],v[180:183]
ldt a[244:245],v6 offset:12416
bld v9,s[8:11],s31 offen offset:1024 nt lds
mma v[180:183],a[220:223],v[92:95],v[180:183]
ldt a[246:247],v6 offset:18560
v_exp_f32 v35, v171
mma v[180:183],a[216:219],v[88:91],v[180:183]
v_exp_f32 v36, v176
cvt v213,v38,v39
mma v[184:187],a[216:219],v[112:115],v[232:235]
ldt a[248:249],v7 offset:128
bld v10,s[8:11],s31 offen offset:2048 nt lds
mma v[184:187],a[220:223],v[116:119],v[184:187]
ldt a[250:251],v7 offset:6272
v_exp_f32 v37, v177
mma v[184:187],a[224:227],v[120:123],v[184:187]
v_exp_f32 v38, v178
v_add_f32 v25, v25, v39
mma v[184:187],a[228:231],v[124:127],v[184:187]
s_mov_b32 m0, 79872
ldt a[252:253],v7 offset:12416
v_exp_f32 v39, v179
mma v[184:187],a[232:235],v[128:131],v[184:187]
s_mov_b32 s31, 184320
ldt a[254:255],v7 offset:18560
bld v8,s[8:11],s31 offen nt lds
mma v[184:187],a[236:239],v[132:135],v[184:187]
s_waitcnt lgkmcnt(6)
v_add_f32 v26, v32, v33
cvt v216,v32,v33
v_add_f32 v26, v26, v34
mma a[96:99],a[240:243],v[240:243],a[96:99]
s_waitcnt lgkmcnt(4)
ldt a[216:217],v4 offset:256
v_exp_f32 v32, v180
mma a[96:99],a[244:247],v[48:51],a[96:99]
ldt a[218:219],v4 offset:6400
bld v9,s[8:11],s31 offen offset:1024 nt lds
mma a[100:103],a[244:247],v[52:55],a[100:103]
v_exp_f32 v33, v181
cvt v217,v34,v35
mma a[100:103],a[240:243],v[244:247],a[100:103]
ldt a[220:221],v4 offset:12544
v_exp_f32 v34, v182
mma a[104:107],a[240:243],v[248:251],a[104:107]
ldt a[222:223],v4 offset:18688
bld v10,s[8:11],s31 offen offset:2048 nt lds
mma a[104:107],a[244:247],v[56:59],a[104:107]
s_waitcnt lgkmcnt(6)
v_add_f32 v26, v26, v35
v_exp_f32 v35, v183
mma a[120:123],a[248:251],v[248:251],a[120:123]
s_mov_b32 m0, 82944
s_waitcnt lgkmcnt(4)
ldt a[224:225],v5 offset:256
v_add_f32 v24, v24, v36
cvt v210,v36,v37
mma a[120:123],a[252:255],v[56:59],a[120:123]
s_mov_b32 s31, 153600
ldt a[226:227],v5 offset:6400
bld v8,s[8:11],s31 offen nt lds
mma a[116:119],a[252:255],v[52:55],a[116:119]
v_exp_f32 v36, v184
v_add_f32 v24, v24, v37
mma a[116:119],a[248:251],v[244:247],a[116:119]
ldt a[228:229],v5 offset:12544
v_exp_f32 v37, v185
mma a[112:115],a[248:251],v[240:243],a[112:115]
ldt a[230:231],v5 offset:18688
bld v9,s[8:11],s31 offen offset:1024 nt lds
mma a[112:115],a[252:255],v[48:51],a[112:115]
s_waitcnt lgkmcnt(6)
v_add_f32 v24, v24, v38
mma a[128:131],a[216:219],v[240:243],a[128:131]
s_waitcnt lgkmcnt(4)
ldt a[232:233],v6 offset:256
cvt v211,v38,v39
mma a[128:131],a[220:223],v[48:51],a[128:131]
ldt a[234:235],v6 offset:6400
bld v10,s[8:11],s31 offen offset:2048 nt lds
mma a[132:135],a[220:223],v[52:55],a[132:135]
v_exp_f32 v38, v186
v_add_f32 v24, v24, v39
mma a[132:135],a[216:219],v[244:247],a[132:135]
s_mov_b32 m0, 0
ldt a[236:237],v6 offset:12544
v_exp_f32 v39, v187
mma a[136:139],a[216:219],v[248:251],a[136:139]
s_mov_b32 s31, 187392
ldt a[238:239],v6 offset:18688
bld v8,s[8:11],s31 offen nt lds
mma a[136:139],a[220:223],v[56:59],a[136:139]
s_waitcnt lgkmcnt(6)
v_add_f32 v25, v25, v32
mma a[152:155],a[224:227],v[248:251],a[152:155]
s_waitcnt lgkmcnt(4)
ldt a[240:241],v7 offset:256
cvt v214,v32,v33
v_add_f32 v25, v25, v33
mma a[152:155],a[228:231],v[56:59],a[152:155]
ldt a[242:243],v7 offset:6400
bld v9,s[8:11],s31 offen offset:1024 nt lds
mma a[148:151],a[228:231],v[52:55],a[148:151]
v_add_f32 v25, v25, v34
cvt v215,v34,v35
mma a[148:151],a[224:227],v[244:247],a[148:151]
ldt a[244:245],v7 offset:12544
v_add_f32 v25, v25, v35
mma a[144:147],a[224:227],v[240:243],a[144:147]
ldt a[246:247],v7 offset:18688
bld v10,s[8:11],s31 offen offset:2048 nt lds
mma a[144:147],a[228:231],v[48:51],a[144:147]
s_waitcnt lgkmcnt(6)
v_add_f32 v26, v26, v36
cvt v218,v36,v37
v_add_f32 v26, v26, v37
mma a[160:163],a[232:235],v[240:243],a[160:163]
s_mov_b32 m0, 3072
s_waitcnt lgkmcnt(4)
v_add_f32 v26, v26, v38
mma a[160:163],a[236:239],v[48:51],a[160:163]
s_mov_b32 s31, 156672
bld v8,s[8:11],s31 offen nt lds
cvt v219,v38,v39
mma a[164:167],a[236:239],v[52:55],a[164:167]
v_add_f32 v26, v26, v39
mma a[164:167],a[232:235],v[244:247],a[164:167]
v_max3_f32 v40, v24, v25, v26
mma a[168:171],a[232:235],v[248:251],a[168:171]
v_cmp_nge_f32 vcc, s34, v40
mma a[168:171],a[236:239],v[56:59],a[168:171]
s_waitcnt lgkmcnt(2)
mma a[184:187],a[240:243],v[248:251],a[184:187]
s_waitcnt lgkmcnt(0)
v_add_u32 v2, s36, v2
mma a[184:187],a[244:247],v[56:59],a[184:187]
v_add_u32 v3, s36, v3
mma a[180:183],a[244:247],v[52:55],a[180:183]
s_waitcnt vmcnt(62)
s_barrier
mma a[180:183],a[240:243],v[244:247],a[180:183]
s_add_u32 s40, s40, 1
mma a[176:179],a[240:243],v[240:243],a[176:179]
s_cmp_eq_u32 s40, 3
s_cselect_b32 s39, 4294918144, s42
s_cselect_b32 s40, 0, s40
mma a[176:179],a[244:247],v[48:51],a[176:179]
s_cbranch_vccnz L_w3_tr9
L_w3_tr9_ret:
mma v[160:163],a[192:195],v[64:67],v[224:227]
s_mov_b32 m0, 86016
s_mov_b32 s31, 172032
ldq a[216:219],v2
bld v8,s[12:15],s31 offen nt lds
mma v[160:163],a[196:199],v[68:71],v[160:163]
ldq a[220:223],v3
v_add_f32 v28, v28, v24
v_add_f32 v29, v29, v25
mma v[160:163],a[200:203],v[72:75],v[160:163]
ldq a[224:227],v2 offset:128
v_add_f32 v30, v30, v26
v_add_u32 v4, s39, v4
mma v[160:163],a[204:207],v[76:79],v[160:163]
ldq a[228:231],v3 offset:128
bld v9,s[12:15],s31 offen offset:1024 nt lds
mma v[160:163],a[208:211],v[80:83],v[160:163]
ldq a[232:235],v2 offset:256
v_add_u32 v5, s39, v5
v_add_u32 v6, s39, v6
mma v[160:163],a[212:215],v[84:87],v[160:163]
ldq a[236:239],v3 offset:256
v_add_u32 v7, s39, v7
mma v[164:167],a[212:215],v[108:111],v[228:231]
bld v10,s[12:15],s31 offen offset:2048 nt lds
mma v[164:167],a[208:211],v[104:107],v[164:167]
s_add_u32 s37, s37, 1
mma v[164:167],a[204:207],v[100:103],v[164:167]
s_cmp_eq_u32 s37, 7
s_cselect_b32 s36, 4294893568, s43
s_cselect_b32 s37, 0, s37
mma v[164:167],a[200:203],v[96:99],v[164:167]
s_mov_b32 m0, 89088
s_mov_b32 s31, 141312
bld v8,s[12:15],s31 offen nt lds
mma v[164:167],a[196:199],v[92:95],v[164:167]
v_exp_f32 v32, v160
mma v[164:167],a[192:195],v[88:91],v[164:167]
v_exp_f32 v33, v161
mma v[168:171],a[192:195],v[112:115],v[232:235]
bld v9,s[12:15],s31 offen offset:1024 nt lds
v_add_f32 v24, v32, v33
mma v[168:171],a[196:199],v[116:119],v[168:171]
v_exp_f32 v34, v162
cvt v240,v32,v33
mma v[168:171],a[200:203],v[120:123],v[168:171]
v_exp_f32 v35, v163
v_add_f32 v24, v24, v34
mma v[168:171],a[204:207],v[124:127],v[168:171]
bld v10,s[12:15],s31 offen offset:2048 nt lds
cvt v241,v34,v35
mma v[168:171],a[208:211],v[128:131],v[168:171]
v_exp_f32 v36, v164
v_add_f32 v24, v24, v35
mma v[168:171],a[212:215],v[132:135],v[168:171]
s_mov_b32 m0, 92160
s_waitcnt lgkmcnt(5)
v_exp_f32 v37, v165
mma v[176:179],a[216:219],v[64:67],v[224:227]
s_mov_b32 s31, 175104
s_waitcnt lgkmcnt(4)
bld v8,s[12:15],s31 offen nt lds
v_add_f32 v25, v36, v37
mma v[176:179],a[220:223],v[68:71],v[176:179]
s_waitcnt lgkmcnt(3)
ldq a[192:195],v2 offset:6144
v_exp_f32 v38, v166
mma v[176:179],a[224:227],v[72:75],v[176:179]
s_waitcnt lgkmcnt(3)
ldq a[196:199],v3 offset:6144
v_exp_f32 v39, v167
mma v[176:179],a[228:231],v[76:79],v[176:179]
s_waitcnt lgkmcnt(3)
ldq a[200:203],v2 offset:6272
bld v9,s[12:15],s31 offen offset:1024 nt lds
mma v[176:179],a[232:235],v[80:83],v[176:179]
s_waitcnt lgkmcnt(3)
ldq a[204:207],v3 offset:6272
v_exp_f32 v32, v168
mma v[176:179],a[236:239],v[84:87],v[176:179]
ldq a[208:211],v2 offset:6400
v_exp_f32 v33, v169
mma v[180:183],a[236:239],v[108:111],v[228:231]
ldq a[212:215],v3 offset:6400
ldt a[240:241],v4
cvt v244,v36,v37
mma v[180:183],a[232:235],v[104:107],v[180:183]
ldt a[242:243],v4 offset:6144
bld v10,s[12:15],s31 offen offset:2048 nt lds
mma v[180:183],a[228:231],v[100:103],v[180:183]
s_mov_b32 m0, 95232
v_exp_f32 v34, v170
v_add_f32 v25, v25, v38
mma v[180:183],a[224:227],v[96:99],v[180:183]
s_mov_b32 s31, 144384
ldt a[244:245],v4 offset:12288
bld v8,s[12:15],s31 offen nt lds
mma v[180:183],a[220:223],v[92:95],v[180:183]
ldt a[246:247],v4 offset:18432
v_exp_f32 v35, v171
mma v[180:183],a[216:219],v[88:91],v[180:183]
v_exp_f32 v36, v176
cvt v245,v38,v39
mma v[184:187],a[216:219],v[112:115],v[232:235]
ldt a[248:249],v5
bld v9,s[12:15],s31 offen offset:1024 nt lds
mma v[184:187],a[220:223],v[116:119],v[184:187]
ldt a[250:251],v5 offset:6144
v_exp_f32 v37, v177
mma v[184:187],a[224:227],v[120:123],v[184:187]
v_exp_f32 v38, v178
v_add_f32 v25, v25, v39
mma v[184:187],a[228:231],v[124:127],v[184:187]
ldt a[252:253],v5 offset:12288
v_exp_f32 v39, v179
mma v[184:187],a[232:235],v[128:131],v[184:187]
ldt a[254:255],v5 offset:18432
bld v10,s[12:15],s31 offen offset:2048 nt lds
mma v[184:187],a[236:239],v[132:135],v[184:187]
s_waitcnt lgkmcnt(6)
v_add_f32 v26, v32, v33
cvt v248,v32,v33
v_add_f32 v26, v26, v34
mma a[0:3],a[240:243],v[192:195],a[0:3]
s_mov_b32 m0, 98304
s_waitcnt lgkmcnt(4)
ldt a[216:217],v6
v_exp_f32 v32, v180
mma a[0:3],a[244:247],v[208:211],a[0:3]
s_mov_b32 s31, 178176
ldt a[218:219],v6 offset:6144
bld v8,s[12:15],s31 offen nt lds
mma a[4:7],a[244:247],v[212:215],a[4:7]
v_exp_f32 v33, v181
cvt v249,v34,v35
mma a[4:7],a[240:243],v[196:199],a[4:7]
ldt a[220:221],v6 offset:12288
v_exp_f32 v34, v182
mma a[8:11],a[240:243],v[200:203],a[8:11]
ldt a[222:223],v6 offset:18432
bld v9,s[12:15],s31 offen offset:1024 nt lds
mma a[8:11],a[244:247],v[216:219],a[8:11]
s_waitcnt lgkmcnt(6)
v_add_f32 v26, v26, v35
v_exp_f32 v35, v183
mma a[24:27],a[248:251],v[200:203],a[24:27]
s_waitcnt lgkmcnt(4)
ldt a[224:225],v7
v_add_f32 v24, v24, v36
mma a[24:27],a[252:255],v[216:219],a[24:27]
ldt a[226:227],v7 offset:6144
bld v10,s[12:15],s31 offen offset:2048 nt lds
mma a[20:23],a[252:255],v[212:215],a[20:23]
cvt v242,v36,v37
v_exp_f32 v36, v184
mma a[20:23],a[248:251],v[196:199],a[20:23]
s_mov_b32 m0, 101376
ldt a[228:229],v7 offset:12288
v_add_f32 v24, v24, v37
mma a[16:19],a[248:251],v[192:195],a[16:19]
s_mov_b32 s31, 147456
ldt a[230:231],v7 offset:18432
bld v8,s[12:15],s31 offen nt lds
mma a[16:19],a[252:255],v[208:211],a[16:19]
s_waitcnt lgkmcnt(6)
v_exp_f32 v37, v185
mma a[32:35],a[216:219],v[192:195],a[32:35]
s_waitcnt lgkmcnt(4)
ldt a[232:233],v4 offset:128
v_add_f32 v24, v24, v38
cvt v243,v38,v39
mma a[32:35],a[220:223],v[208:211],a[32:35]
ldt a[234:235],v4 offset:6272
bld v9,s[12:15],s31 offen offset:1024 nt lds
mma a[36:39],a[220:223],v[212:215],a[36:39]
v_exp_f32 v38, v186
mma a[36:39],a[216:219],v[196:199],a[36:39]
ldt a[236:237],v4 offset:12416
v_add_f32 v24, v24, v39
mma a[40:43],a[216:219],v[200:203],a[40:43]
ldt a[238:239],v4 offset:18560
bld v10,s[12:15],s31 offen offset:2048 nt lds
mma a[40:43],a[220:223],v[216:219],a[40:43]
s_waitcnt lgkmcnt(6)
v_exp_f32 v39, v187
v_add_f32 v25, v25, v32
mma a[56:59],a[224:227],v[200:203],a[56:59]
s_mov_b32 m0, 104448
s_waitcnt lgkmcnt(4)
ldt a[240:241],v5 offset:128
cvt v246,v32,v33
mma a[56:59],a[228:231],v[216:219],a[56:59]
s_mov_b32 s31, 181248
ldt a[242:243],v5 offset:6272
bld v8,s[12:15],s31 offen nt lds
mma a[52:55],a[228:231],v[212:215],a[52:55]
v_add_f32 v25, v25, v33
v_add_f32 v25, v25, v34
cvt v247,v34,v35
mma a[52:55],a[224:227],v[196:199],a[52:55]
ldt a[244:245],v5 offset:12416
v_add_f32 v25, v25, v35
mma a[48:51],a[224:227],v[192:195],a[48:51]
ldt a[246:247],v5 offset:18560
bld v9,s[12:15],s31 offen offset:1024 nt lds
mma a[48:51],a[228:231],v[208:211],a[48:51]
s_waitcnt lgkmcnt(6)
v_add_f32 v26, v26, v36
cvt v250,v36,v37
mma a[64:67],a[232:235],v[192:195],a[64:67]
s_waitcnt lgkmcnt(4)
v_add_f32 v26, v26, v37
v_add_f32 v26, v26, v38
mma a[64:67],a[236:239],v[208:211],a[64:67]
bld v10,s[12:15],s31 offen offset:2048 nt lds
cvt v251,v38,v39
mma a[68:71],a[236:239],v[212:215],a[68:71]
v_add_f32 v26, v26, v39
mma a[68:71],a[232:235],v[196:199],a[68:71]
v_max3_f32 v40, v24, v25, v26
mma a[72:75],a[232:235],v[200:203],a[72:75]
v_cmp_nge_f32 vcc, s34, v40
mma a[72:75],a[236:239],v[216:219],a[72:75]
s_waitcnt lgkmcnt(2)
mma a[88:91],a[240:243],v[200:203],a[88:91]
s_waitcnt lgkmcnt(0)
v_add_u32 v2, s36, v2
mma a[88:91],a[244:247],v[216:219],a[88:91]
v_add_u32 v3, s36, v3
mma a[84:87],a[244:247],v[212:215],a[84:87]
s_waitcnt vmcnt(62)
s_barrier
mma a[84:87],a[240:243],v[196:199],a[84:87]
mma a[80:83],a[240:243],v[192:195],a[80:83]
mma a[80:83],a[244:247],v[208:211],a[80:83]
s_cbranch_vccnz L_w3_tr10
L_w3_tr10_ret:
mma v[160:163],a[192:195],v[64:67],v[224:227]
s_mov_b32 m0, 107520
s_mov_b32 s31, 150528
ldq a[216:219],v2
bld v8,s[12:15],s31 offen nt lds
mma v[160:163],a[196:199],v[68:71],v[160:163]
ldq a[220:223],v3
v_add_f32 v28, v28, v24
v_add_f32 v29, v29, v25
mma v[160:163],a[200:203],v[72:75],v[160:163]
ldq a[224:227],v2 offset:128
v_add_f32 v30, v30, v26
mma v[160:163],a[204:207],v[76:79],v[160:163]
ldq a[228:231],v3 offset:128
bld v9,s[12:15],s31 offen offset:1024 nt lds
mma v[160:163],a[208:211],v[80:83],v[160:163]
ldq a[232:235],v2 offset:256
mma v[160:163],a[212:215],v[84:87],v[160:163]
ldq a[236:239],v3 offset:256
mma v[164:167],a[212:215],v[108:111],v[228:231]
bld v10,s[12:15],s31 offen offset:2048 nt lds
mma v[164:167],a[208:211],v[104:107],v[164:167]
s_add_u32 s37, s37, 1
mma v[164:167],a[204:207],v[100:103],v[164:167]
s_cmp_eq_u32 s37, 7
s_cselect_b32 s36, 4294893568, s43
s_cselect_b32 s37, 0, s37
mma v[164:167],a[200:203],v[96:99],v[164:167]
s_mov_b32 m0, 3072
s_mov_b32 s31, 156672
bld v9,s[8:11],s31 offen offset:1024 nt lds
mma v[164:167],a[196:199],v[92:95],v[164:167]
v_exp_f32 v32, v160
mma v[164:167],a[192:195],v[88:91],v[164:167]
v_exp_f32 v33, v161
mma v[168:171],a[192:195],v[112:115],v[232:235]
bld v10,s[8:11],s31 offen offset:2048 nt lds
v_add_f32 v24, v32, v33
mma v[168:171],a[196:199],v[116:119],v[168:171]
v_exp_f32 v34, v162
cvt v48,v32,v33
mma v[168:171],a[200:203],v[120:123],v[168:171]
s_mov_b32 m0, 6144
v_exp_f32 v35, v163
v_add_f32 v24, v24, v34
mma v[168:171],a[204:207],v[124:127],v[168:171]
s_mov_b32 s31, 190464
bld v8,s[8:11],s31 offen nt lds
cvt v49,v34,v35
mma v[168:171],a[208:211],v[128:131],v[168:171]
v_exp_f32 v36, v164
v_add_f32 v24, v24, v35
mma v[168:171],a[212:215],v[132:135],v[168:171]
s_waitcnt lgkmcnt(5)
v_exp_f32 v37, v165
mma v[176:179],a[216:219],v[64:67],v[224:227]
s_waitcnt lgkmcnt(4)
bld v9,s[8:11],s31 offen offset:1024 nt lds
v_add_f32 v25, v36, v37
mma v[176:179],a[220:223],v[68:71],v[176:179]
s_waitcnt lgkmcnt(3)
ldq a[192:195],v2 offset:6144
v_exp_f32 v38, v166
mma v[176:179],a[224:227],v[72:75],v[176:179]
s_waitcnt lgkmcnt(3)
ldq a[196:199],v3 offset:6144
v_exp_f32 v39, v167
mma v[176:179],a[228:231],v[76:79],v[176:179]
s_waitcnt lgkmcnt(3)
ldq a[200:203],v2 offset:6272
bld v10,s[8:11],s31 offen offset:2048 nt lds
mma v[176:179],a[232:235],v[80:83],v[176:179]
s_waitcnt lgkmcnt(3)
ldq a[204:207],v3 offset:6272
v_exp_f32 v32, v168
mma v[176:179],a[236:239],v[84:87],v[176:179]
ldq a[208:211],v2 offset:6400
v_exp_f32 v33, v169
mma v[180:183],a[236:239],v[108:111],v[228:231]
s_mov_b32 m0, 9216
ldq a[212:215],v3 offset:6400
ldt a[240:241],v6 offset:128
cvt v52,v36,v37
mma v[180:183],a[232:235],v[104:107],v[180:183]
s_mov_b32 s31, 159744
ldt a[242:243],v6 offset:6272
bld v8,s[8:11],s31 offen nt lds
mma v[180:183],a[228:231],v[100:103],v[180:183]
v_exp_f32 v34, v170
v_add_f32 v25, v25, v38
mma v[180:183],a[224:227],v[96:99],v[180:183]
ldt a[244:245],v6 offset:12416
bld v9,s[8:11],s31 offen offset:1024 nt lds
mma v[180:183],a[220:223],v[92:95],v[180:183]
ldt a[246:247],v6 offset:18560
v_exp_f32 v35, v171
mma v[180:183],a[216:219],v[88:91],v[180:183]
v_exp_f32 v36, v176
cvt v53,v38,v39
mma v[184:187],a[216:219],v[112:115],v[232:235]
ldt a[248:249],v7 offset:128
bld v10,s[8:11],s31 offen offset:2048 nt lds
mma v[184:187],a[220:223],v[116:119],v[184:187]
ldt a[250:251],v7 offset:6272
v_exp_f32 v37, v177
mma v[184:187],a[224:227],v[120:123],v[184:187]
v_exp_f32 v38, v178
v_add_f32 v25, v25, v39
mma v[184:187],a[228:231],v[124:127],v[184:187]
s_mov_b32 m0, 12288
ldt a[252:253],v7 offset:12416
v_exp_f32 v39, v179
mma v[184:187],a[232:235],v[128:131],v[184:187]
s_mov_b32 s31, 193536
ldt a[254:255],v7 offset:18560
bld v8,s[8:11],s31 offen nt lds
mma v[184:187],a[236:239],v[132:135],v[184:187]
s_waitcnt lgkmcnt(6)
v_add_f32 v26, v32, v33
cvt v56,v32,v33
v_add_f32 v26, v26, v34
mma a[96:99],a[240:243],v[192:195],a[96:99]
s_waitcnt lgkmcnt(4)
ldt a[216:217],v4 offset:256
v_exp_f32 v32, v180
mma a[96:99],a[244:247],v[208:211],a[96:99]
ldt a[218:219],v4 offset:6400
bld v9,s[8:11],s31 offen offset:1024 nt lds
mma a[100:103],a[244:247],v[212:215],a[100:103]
v_exp_f32 v33, v181
cvt v57,v34,v35
mma a[100:103],a[240:243],v[196:199],a[100:103]
ldt a[220:221],v4 offset:12544
v_exp_f32 v34, v182
mma a[104:107],a[240:243],v[200:203],a[104:107]
ldt a[222:223],v4 offset:18688
bld v10,s[8:11],s31 offen offset:2048 nt lds
mma a[104:107],a[244:247],v[216:219],a[104:107]
s_waitcnt lgkmcnt(6)
v_add_f32 v26, v26, v35
v_exp_f32 v35, v183
mma a[120:123],a[248:251],v[200:203],a[120:123]
s_mov_b32 m0, 15360
s_waitcnt lgkmcnt(4)
ldt a[224:225],v5 offset:256
v_add_f32 v24, v24, v36
cvt v50,v36,v37
mma a[120:123],a[252:255],v[216:219],a[120:123]
s_mov_b32 s31, 162816
ldt a[226:227],v5 offset:6400
bld v8,s[8:11],s31 offen nt lds
mma a[116:119],a[252:255],v[212:215],a[116:119]
v_exp_f32 v36, v184
v_add_f32 v24, v24, v37
mma a[116:119],a[248:251],v[196:199],a[116:119]
ldt a[228:229],v5 offset:12544
v_exp_f32 v37, v185
mma a[112:115],a[248:251],v[192:195],a[112:115]
ldt a[230:231],v5 offset:18688
bld v9,s[8:11],s31 offen offset:1024 nt lds
mma a[112:115],a[252:255],v[208:211],a[112:115]
s_waitcnt lgkmcnt(6)
v_add_f32 v24, v24, v38
mma a[128:131],a[216:219],v[192:195],a[128:131]
s_waitcnt lgkmcnt(4)
ldt a[232:233],v6 offset:256
cvt v51,v38,v39
mma a[128:131],a[220:223],v[208:211],a[128:131]
ldt a[234:235],v6 offset:6400
bld v10,s[8:11],s31 offen offset:2048 nt lds
mma a[132:135],a[220:223],v[212:215],a[132:135]
v_exp_f32 v38, v186
v_add_f32 v24, v24, v39
mma a[132:135],a[216:219],v[196:199],a[132:135]
s_mov_b32 m0, 18432
ldt a[236:237],v6 offset:12544
v_exp_f32 v39, v187
mma a[136:139],a[216:219],v[200:203],a[136:139]
s_mov_b32 s31, 196608
ldt a[238:239],v6 offset:18688
bld v8,s[8:11],s31 offen nt lds
mma a[136:139],a[220:223],v[216:219],a[136:139]
s_waitcnt lgkmcnt(6)
v_add_f32 v25, v25, v32
mma a[152:155],a[224:227],v[200:203],a[152:155]
s_waitcnt lgkmcnt(4)
ldt a[240:241],v7 offset:256
cvt v54,v32,v33
v_add_f32 v25, v25, v33
mma a[152:155],a[228:231],v[216:219],a[152:155]
ldt a[242:243],v7 offset:6400
bld v9,s[8:11],s31 offen offset:1024 nt lds
mma a[148:151],a[228:231],v[212:215],a[148:151]
v_add_f32 v25, v25, v34
cvt v55,v34,v35
mma a[148:151],a[224:227],v[196:199],a[148:151]
ldt a[244:245],v7 offset:12544
v_add_f32 v25, v25, v35
mma a[144:147],a[224:227],v[192:195],a[144:147]
ldt a[246:247],v7 offset:18688
bld v10,s[8:11],s31 offen offset:2048 nt lds
mma a[144:147],a[228:231],v[208:211],a[144:147]
s_waitcnt lgkmcnt(6)
v_add_f32 v26, v26, v36
cvt v58,v36,v37
v_add_f32 v26, v26, v37
mma a[160:163],a[232:235],v[192:195],a[160:163]
s_mov_b32 m0, 21504
s_waitcnt lgkmcnt(4)
v_add_f32 v26, v26, v38
mma a[160:163],a[236:239],v[208:211],a[160:163]
s_mov_b32 s31, 230400
bld v8,s[8:11],s31 offen nt lds
cvt v59,v38,v39
mma a[164:167],a[236:239],v[212:215],a[164:167]
v_add_f32 v26, v26, v39
mma a[164:167],a[232:235],v[196:199],a[164:167]
v_max3_f32 v40, v24, v25, v26
mma a[168:171],a[232:235],v[200:203],a[168:171]
v_cmp_nge_f32 vcc, s34, v40
mma a[168:171],a[236:239],v[216:219],a[168:171]
s_waitcnt lgkmcnt(2)
mma a[184:187],a[240:243],v[200:203],a[184:187]
s_waitcnt lgkmcnt(0)
v_add_u32 v2, s36, v2
mma a[184:187],a[244:247],v[216:219],a[184:187]
v_add_u32 v3, s36, v3
mma a[180:183],a[244:247],v[212:215],a[180:183]
s_waitcnt vmcnt(58)
s_barrier
mma a[180:183],a[240:243],v[196:199],a[180:183]
s_add_u32 s40, s40, 1
mma a[176:179],a[240:243],v[192:195],a[176:179]
s_cmp_eq_u32 s40, 3
s_cselect_b32 s39, 4294918144, s42
s_cselect_b32 s40, 0, s40
mma a[176:179],a[244:247],v[208:211],a[176:179]
s_cbranch_vccnz L_w3_tr11
L_w3_tr11_ret:
mma v[160:163],a[192:195],v[64:67],v[224:227]
ldq a[216:219],v2
buffer_load_dword v46, v20, s[52:55], 0 offen sc1
mma v[160:163],a[196:199],v[68:71],v[160:163]
s_mov_b32 m0, 21504
ldq a[220:223],v3
v_add_f32 v28, v28, v24
v_add_f32 v29, v29, v25
mma v[160:163],a[200:203],v[72:75],v[160:163]
s_mov_b32 s31, 230400
ldq a[224:227],v2 offset:128
bld v9,s[8:11],s31 offen offset:1024 nt lds
mma v[160:163],a[204:207],v[76:79],v[160:163]
ldq a[228:231],v3 offset:128
v_add_f32 v30, v30, v26
v_add_u32 v4, s39, v4
mma v[160:163],a[208:211],v[80:83],v[160:163]
ldq a[232:235],v2 offset:256
v_add_u32 v5, s39, v5
v_add_u32 v6, s39, v6
mma v[160:163],a[212:215],v[84:87],v[160:163]
ldq a[236:239],v3 offset:256
bld v10,s[8:11],s31 offen offset:2048 nt lds
mma v[164:167],a[212:215],v[108:111],v[228:231]
v_add_u32 v7, s39, v7
mma v[164:167],a[208:211],v[104:107],v[164:167]
s_add_u32 s37, s37, 1
mma v[164:167],a[204:207],v[100:103],v[164:167]
s_cmp_eq_u32 s37, 7
s_cselect_b32 s36, 4294893568, s43
s_cselect_b32 s37, 0, s37
s_mov_b32 m0, 24576
s_mov_b32 s31, 199680
bld v8,s[8:11],s31 offen nt lds
mma v[164:167],a[200:203],v[96:99],v[164:167]
v_exp_f32 v32, v160
mma v[164:167],a[196:199],v[92:95],v[164:167]
v_exp_f32 v33, v161
mma v[164:167],a[192:195],v[88:91],v[164:167]
bld v9,s[8:11],s31 offen offset:1024 nt lds
v_add_f32 v24, v32, v33
mma v[168:171],a[192:195],v[112:115],v[232:235]
v_exp_f32 v34, v162
cvt v192,v32,v33
mma v[168:171],a[196:199],v[116:119],v[168:171]
s_mov_b32 m0, 110592
v_exp_f32 v35, v163
v_add_f32 v24, v24, v34
mma v[168:171],a[200:203],v[120:123],v[168:171]
s_mov_b32 s31, 184320
bld v8,s[12:15],s31 offen nt lds
cvt v193,v34,v35
mma v[168:171],a[204:207],v[124:127],v[168:171]
v_exp_f32 v36, v164
v_add_f32 v24, v24, v35
mma v[168:171],a[208:211],v[128:131],v[168:171]
v_exp_f32 v37, v165
mma v[168:171],a[212:215],v[132:135],v[168:171]
s_waitcnt lgkmcnt(5)
bld v9,s[12:15],s31 offen offset:1024 nt lds
v_add_f32 v25, v36, v37
mma v[176:179],a[216:219],v[64:67],v[224:227]
s_waitcnt lgkmcnt(4)
v_exp_f32 v38, v166
cvt v196,v36,v37
mma v[176:179],a[220:223],v[68:71],v[176:179]
s_waitcnt lgkmcnt(3)
ldq a[192:195],v2 offset:6144
v_exp_f32 v39, v167
mma v[176:179],a[224:227],v[72:75],v[176:179]
s_waitcnt lgkmcnt(3)
ldq a[196:199],v3 offset:6144
bld v10,s[12:15],s31 offen offset:2048 nt lds
mma v[176:179],a[228:231],v[76:79],v[176:179]
s_waitcnt lgkmcnt(3)
ldq a[200:203],v2 offset:6272
v_exp_f32 v32, v168
mma v[176:179],a[232:235],v[80:83],v[176:179]
s_mov_b32 m0, 113664
s_waitcnt lgkmcnt(3)
ldq a[204:207],v3 offset:6272
v_exp_f32 v33, v169
mma v[176:179],a[236:239],v[84:87],v[176:179]
s_mov_b32 s31, 153600
ldq a[208:211],v2 offset:6400
bld v8,s[12:15],s31 offen nt lds
mma v[180:183],a[236:239],v[108:111],v[228:231]
ldq a[212:215],v3 offset:6400
ldt a[240:241],v4
v_add_f32 v25, v25, v38
mma v[180:183],a[232:235],v[104:107],v[180:183]
ldt a[242:243],v4 offset:6144
v_exp_f32 v34, v170
mma v[180:183],a[228:231],v[100:103],v[180:183]
bld v9,s[12:15],s31 offen offset:1024 nt lds
cvt v197,v38,v39
mma v[180:183],a[224:227],v[96:99],v[180:183]
ldt a[244:245],v4 offset:12288
v_exp_f32 v35, v171
mma v[180:183],a[220:223],v[92:95],v[180:183]
ldt a[246:247],v4 offset:18432
v_exp_f32 v36, v176
mma v[180:183],a[216:219],v[88:91],v[180:183]
bld v10,s[12:15],s31 offen offset:2048 nt lds
v_add_f32 v25, v25, v39
mma v[184:187],a[216:219],v[112:115],v[232:235]
ldt a[248:249],v5
v_exp_f32 v37, v177
mma v[184:187],a[220:223],v[116:119],v[184:187]
s_mov_b32 m0, 116736
ldt a[250:251],v5 offset:6144
v_exp_f32 v38, v178
mma v[184:187],a[224:227],v[120:123],v[184:187]
s_mov_b32 s31, 187392
bld v8,s[12:15],s31 offen nt lds
v_add_f32 v26, v32, v33
mma v[184:187],a[228:231],v[124:127],v[184:187]
ldt a[252:253],v5 offset:12288
v_exp_f32 v39, v179
mma v[184:187],a[232:235],v[128:131],v[184:187]
ldt a[254:255],v5 offset:18432
cvt v200,v32,v33
v_add_f32 v26, v26, v34
mma v[184:187],a[236:239],v[132:135],v[184:187]
s_waitcnt lgkmcnt(6)
bld v9,s[12:15],s31 offen offset:1024 nt lds
cvt v201,v34,v35
mma a[0:3],a[240:243],v[240:243],a[0:3]
s_waitcnt lgkmcnt(4)
ldt a[216:217],v6
v_exp_f32 v32, v180
mma a[0:3],a[244:247],v[48:51],a[0:3]
ldt a[218:219],v6 offset:6144
v_exp_f32 v33, v181
mma a[4:7],a[244:247],v[52:55],a[4:7]
bld v10,s[12:15],s31 offen offset:2048 nt lds
v_add_f32 v26, v26, v35
mma a[4:7],a[240:243],v[244:247],a[4:7]
ldt a[220:221],v6 offset:12288
v_exp_f32 v34, v182
mma a[8:11],a[240:243],v[248:251],a[8:11]
s_mov_b32 m0, 119808
ldt a[222:223],v6 offset:18432
v_exp_f32 v35, v183
mma a[8:11],a[244:247],v[56:59],a[8:11]
s_mov_b32 s31, 156672
s_waitcnt lgkmcnt(6)
bld v8,s[12:15],s31 offen nt lds
mma a[24:27],a[248:251],v[248:251],a[24:27]
s_waitcnt lgkmcnt(4)
ldt a[224:225],v7
v_add_f32 v24, v24, v36
mma a[24:27],a[252:255],v[56:59],a[24:27]
ldt a[226:227],v7 offset:6144
cvt v194,v36,v37
mma a[20:23],a[252:255],v[52:55],a[20:23]
bld v9,s[12:15],s31 offen offset:1024 nt lds
v_add_f32 v24, v24, v37
mma a[20:23],a[248:251],v[244:247],a[20:23]
ldt a[228:229],v7 offset:12288
v_exp_f32 v36, v184
mma a[16:19],a[248:251],v[240:243],a[16:19]
ldt a[230:231],v7 offset:18432
v_exp_f32 v37, v185
mma a[16:19],a[252:255],v[48:51],a[16:19]
s_waitcnt lgkmcnt(6)
bld v10,s[12:15],s31 offen offset:2048 nt lds
mma a[32:35],a[216:219],v[240:243],a[32:35]
s_waitcnt lgkmcnt(4)
ldt a[232:233],v4 offset:128
v_add_f32 v24, v24, v38
cvt v195,v38,v39
mma a[32:35],a[220:223],v[48:51],a[32:35]
s_mov_b32 m0, 122880
ldt a[234:235],v4 offset:6272
v_exp_f32 v38, v186
mma a[36:39],a[220:223],v[52:55],a[36:39]
s_mov_b32 s31, 190464
bld v8,s[12:15],s31 offen nt lds
mma a[36:39],a[216:219],v[244:247],a[36:39]
ldt a[236:237],v4 offset:12416
v_add_f32 v24, v24, v39
mma a[40:43],a[216:219],v[248:251],a[40:43]
ldt a[238:239],v4 offset:18560
v_exp_f32 v39, v187
mma a[40:43],a[220:223],v[56:59],a[40:43]
s_waitcnt lgkmcnt(6)
bld v9,s[12:15],s31 offen offset:1024 nt lds
v_add_f32 v25, v25, v32
mma a[56:59],a[224:227],v[248:251],a[56:59]
s_waitcnt lgkmcnt(4)
ldt a[240:241],v5 offset:128
cvt v198,v32,v33
mma a[56:59],a[228:231],v[56:59],a[56:59]
ldt a[242:243],v5 offset:6272
v_add_f32 v25, v25, v33
mma a[52:55],a[228:231],v[52:55],a[52:55]
bld v10,s[12:15],s31 offen offset:2048 nt lds
v_add_f32 v25, v25, v34
mma a[52:55],a[224:227],v[244:247],a[52:55]
ldt a[244:245],v5 offset:12416
cvt v199,v34,v35
v_add_f32 v25, v25, v35
mma a[48:51],a[224:227],v[240:243],a[48:51]
s_mov_b32 m0, 125952
ldt a[246:247],v5 offset:18560
v_add_f32 v26, v26, v36
mma a[48:51],a[228:231],v[48:51],a[48:51]
s_mov_b32 s31, 159744
s_waitcnt lgkmcnt(6)
bld v8,s[12:15],s31 offen nt lds
cvt v202,v36,v37
mma a[64:67],a[232:235],v[240:243],a[64:67]
s_waitcnt lgkmcnt(4)
v_add_f32 v26, v26, v37
v_add_f32 v26, v26, v38
mma a[64:67],a[236:239],v[48:51],a[64:67]
cvt v203,v38,v39
mma a[68:71],a[236:239],v[52:55],a[68:71]
bld v9,s[12:15],s31 offen offset:1024 nt lds
v_add_f32 v26, v26, v39
mma a[68:71],a[232:235],v[244:247],a[68:71]
v_max3_f32 v40, v24, v25, v26
mma a[72:75],a[232:235],v[248:251],a[72:75]
v_cmp_nge_f32 vcc, s34, v40
mma a[72:75],a[236:239],v[56:59],a[72:75]
s_waitcnt lgkmcnt(2)
mma a[88:91],a[240:243],v[248:251],a[88:91]
s_waitcnt lgkmcnt(0)
v_add_u32 v2, s36, v2
mma a[88:91],a[244:247],v[56:59],a[88:91]
v_add_u32 v3, s36, v3
mma a[84:87],a[244:247],v[52:55],a[84:87]
s_waitcnt vmcnt(62)
s_barrier
mma a[84:87],a[240:243],v[244:247],a[84:87]
mma a[80:83],a[240:243],v[240:243],a[80:83]
mma a[80:83],a[244:247],v[48:51],a[80:83]
s_cbranch_vccnz L_w3_tr12
L_w3_tr12_ret:
mma v[160:163],a[192:195],v[64:67],v[224:227]
s_mov_b32 m0, 125952
s_mov_b32 s31, 159744
ldq a[216:219],v2
bld v10,s[12:15],s31 offen offset:2048 nt lds
mma v[160:163],a[196:199],v[68:71],v[160:163]
ldq a[220:223],v3
v_add_f32 v28, v28, v24
v_add_f32 v29, v29, v25
mma v[160:163],a[200:203],v[72:75],v[160:163]
s_mov_b32 m0, 129024
ldq a[224:227],v2 offset:128
v_add_f32 v30, v30, v26
mma v[160:163],a[204:207],v[76:79],v[160:163]
s_mov_b32 s31, 193536
ldq a[228:231],v3 offset:128
bld v8,s[12:15],s31 offen nt lds
mma v[160:163],a[208:211],v[80:83],v[160:163]
ldq a[232:235],v2 offset:256
mma v[160:163],a[212:215],v[84:87],v[160:163]
ldq a[236:239],v3 offset:256
mma v[164:167],a[212:215],v[108:111],v[228:231]
bld v9,s[12:15],s31 offen offset:1024 nt lds
mma v[164:167],a[208:211],v[104:107],v[164:167]
s_add_u32 s37, s37, 1
mma v[164:167],a[204:207],v[100:103],v[164:167]
s_cmp_eq_u32 s37, 7
s_cselect_b32 s36, 4294893568, s43
s_cselect_b32 s37, 0, s37
mma v[164:167],a[200:203],v[96:99],v[164:167]
bld v10,s[12:15],s31 offen offset:2048 nt lds
mma v[164:167],a[196:199],v[92:95],v[164:167]
v_exp_f32 v32, v160
mma v[164:167],a[192:195],v[88:91],v[164:167]
s_mov_b32 m0, 132096
v_exp_f32 v33, v161
mma v[168:171],a[192:195],v[112:115],v[232:235]
s_mov_b32 s31, 162816
bld v8,s[12:15],s31 offen nt lds
v_add_f32 v24, v32, v33
mma v[168:171],a[196:199],v[116:119],v[168:171]
v_exp_f32 v34, v162
cvt v208,v32,v33
mma v[168:171],a[200:203],v[120:123],v[168:171]
v_exp_f32 v35, v163
v_add_f32 v24, v24, v34
mma v[168:171],a[204:207],v[124:127],v[168:171]
bld v9,s[12:15],s31 offen offset:1024 nt lds
cvt v209,v34,v35
mma v[168:171],a[208:211],v[128:131],v[168:171]
v_exp_f32 v36, v164
v_add_f32 v24, v24, v35
mma v[168:171],a[212:215],v[132:135],v[168:171]
s_waitcnt lgkmcnt(5)
v_exp_f32 v37, v165
mma v[176:179],a[216:219],v[64:67],v[224:227]
s_waitcnt lgkmcnt(4)
bld v10,s[12:15],s31 offen offset:2048 nt lds
v_add_f32 v25, v36, v37
mma v[176:179],a[220:223],v[68:71],v[176:179]
s_waitcnt lgkmcnt(3)
ldq a[192:195],v2 offset:6144
v_exp_f32 v38, v166
mma v[176:179],a[224:227],v[72:75],v[176:179]
s_mov_b32 m0, 24576
s_waitcnt lgkmcnt(3)
ldq a[196:199],v3 offset:6144
v_exp_f32 v39, v167
mma v[176:179],a[228:231],v[76:79],v[176:179]
s_mov_b32 s31, 199680
s_waitcnt lgkmcnt(3)
ldq a[200:203],v2 offset:6272
bld v10,s[8:11],s31 offen offset:2048 nt lds
mma v[176:179],a[232:235],v[80:83],v[176:179]
s_waitcnt lgkmcnt(3)
ldq a[204:207],v3 offset:6272
v_exp_f32 v32, v168
mma v[176:179],a[236:239],v[84:87],v[176:179]
ldq a[208:211],v2 offset:6400
v_exp_f32 v33, v169
mma v[180:183],a[236:239],v[108:111],v[228:231]
s_mov_b32 m0, 27648
ldq a[212:215],v3 offset:6400
ldt a[240:241],v6 offset:128
cvt v212,v36,v37
mma v[180:183],a[232:235],v[104:107],v[180:183]
s_mov_b32 s31, 233472
ldt a[242:243],v6 offset:6272
bld v8,s[8:11],s31 offen nt lds
mma v[180:183],a[228:231],v[100:103],v[180:183]
v_exp_f32 v34, v170
v_add_f32 v25, v25, v38
mma v[180:183],a[224:227],v[96:99],v[180:183]
ldt a[244:245],v6 offset:12416
bld v9,s[8:11],s31 offen offset:1024 nt lds
mma v[180:183],a[220:223],v[92:95],v[180:183]
ldt a[246:247],v6 offset:18560
v_exp_f32 v35, v171
mma v[180:183],a[216:219],v[88:91],v[180:183]
v_exp_f32 v36, v176
cvt v213,v38,v39
mma v[184:187],a[216:219],v[112:115],v[232:235]
ldt a[248:249],v7 offset:128
bld v10,s[8:11],s31 offen offset:2048 nt lds
mma v[184:187],a[220:223],v[116:119],v[184:187]
ldt a[250:251],v7 offset:6272
v_exp_f32 v37, v177
mma v[184:187],a[224:227],v[120:123],v[184:187]
v_exp_f32 v38, v178
v_add_f32 v25, v25, v39
mma v[184:187],a[228:231],v[124:127],v[184:187]
s_mov_b32 m0, 30720
ldt a[252:253],v7 offset:12416
v_exp_f32 v39, v179
mma v[184:187],a[232:235],v[128:131],v[184:187]
s_mov_b32 s31, 202752
ldt a[254:255],v7 offset:18560
bld v8,s[8:11],s31 offen nt lds
mma v[184:187],a[236:239],v[132:135],v[184:187]
s_waitcnt lgkmcnt(6)
v_add_f32 v26, v32, v33
cvt v216,v32,v33
v_add_f32 v26, v26, v34
mma a[96:99],a[240:243],v[240:243],a[96:99]
s_waitcnt lgkmcnt(4)
ldt a[216:217],v4 offset:256
v_exp_f32 v32, v180
mma a[96:99],a[244:247],v[48:51],a[96:99]
ldt a[218:219],v4 offset:6400
bld v9,s[8:11],s31 offen offset:1024 nt lds
mma a[100:103],a[244:247],v[52:55],a[100:103]
v_exp_f32 v33, v181
cvt v217,v34,v35
mma a[100:103],a[240:243],v[244:247],a[100:103]
ldt a[220:221],v4 offset:12544
v_exp_f32 v34, v182
mma a[104:107],a[240:243],v[248:251],a[104:107]
ldt a[222:223],v4 offset:18688
bld v10,s[8:11],s31 offen offset:2048 nt lds
mma a[104:107],a[244:247],v[56:59],a[104:107]
s_waitcnt lgkmcnt(6)
v_add_f32 v26, v26, v35
v_exp_f32 v35, v183
mma a[120:123],a[248:251],v[248:251],a[120:123]
s_mov_b32 m0, 33792
s_waitcnt lgkmcnt(4)
ldt a[224:225],v5 offset:256
v_add_f32 v24, v24, v36
cvt v210,v36,v37
mma a[120:123],a[252:255],v[56:59],a[120:123]
s_mov_b32 s31, 236544
ldt a[226:227],v5 offset:6400
bld v8,s[8:11],s31 offen nt lds
mma a[116:119],a[252:255],v[52:55],a[116:119]
v_exp_f32 v36, v184
v_add_f32 v24, v24, v37
mma a[116:119],a[248:251],v[244:247],a[116:119]
ldt a[228:229],v5 offset:12544
v_exp_f32 v37, v185
mma a[112:115],a[248:251],v[240:243],a[112:115]
ldt a[230:231],v5 offset:18688
bld v9,s[8:11],s31 offen offset:1024 nt lds
mma a[112:115],a[252:255],v[48:51],a[112:115]
s_waitcnt lgkmcnt(6)
v_add_f32 v24, v24, v38
mma a[128:131],a[216:219],v[240:243],a[128:131]
s_waitcnt lgkmcnt(4)
ldt a[232:233],v6 offset:256
cvt v211,v38,v39
mma a[128:131],a[220:223],v[48:51],a[128:131]
ldt a[234:235],v6 offset:6400
bld v10,s[8:11],s31 offen offset:2048 nt lds
mma a[132:135],a[220:223],v[52:55],a[132:135]
v_exp_f32 v38, v186
v_add_f32 v24, v24, v39
mma a[132:135],a[216:219],v[244:247],a[132:135]
s_mov_b32 m0, 36864
ldt a[236:237],v6 offset:12544
v_exp_f32 v39, v187
mma a[136:139],a[216:219],v[248:251],a[136:139]
s_mov_b32 s31, 205824
ldt a[238:239],v6 offset:18688
bld v8,s[8:11],s31 offen nt lds
mma a[136:139],a[220:223],v[56:59],a[136:139]
s_waitcnt lgkmcnt(6)
v_add_f32 v25, v25, v32
mma a[152:155],a[224:227],v[248:251],a[152:155]
s_waitcnt lgkmcnt(4)
ldt a[240:241],v7 offset:256
cvt v214,v32,v33
v_add_f32 v25, v25, v33
mma a[152:155],a[228:231],v[56:59],a[152:155]
ldt a[242:243],v7 offset:6400
bld v9,s[8:11],s31 offen offset:1024 nt lds
mma a[148:151],a[228:231],v[52:55],a[148:151]
v_add_f32 v25, v25, v34
cvt v215,v34,v35
mma a[148:151],a[224:227],v[244:247],a[148:151]
ldt a[244:245],v7 offset:12544
v_add_f32 v25, v25, v35
mma a[144:147],a[224:227],v[240:243],a[144:147]
ldt a[246:247],v7 offset:18688
bld v10,s[8:11],s31 offen offset:2048 nt lds
mma a[144:147],a[228:231],v[48:51],a[144:147]
s_waitcnt lgkmcnt(6)
v_add_f32 v26, v26, v36
cvt v218,v36,v37
v_add_f32 v26, v26, v37
mma a[160:163],a[232:235],v[240:243],a[160:163]
s_mov_b32 m0, 39936
s_waitcnt lgkmcnt(4)
v_add_f32 v26, v26, v38
mma a[160:163],a[236:239],v[48:51],a[160:163]
s_mov_b32 s31, 239616
bld v8,s[8:11],s31 offen nt lds
cvt v219,v38,v39
mma a[164:167],a[236:239],v[52:55],a[164:167]
v_add_f32 v26, v26, v39
mma a[164:167],a[232:235],v[244:247],a[164:167]
v_max3_f32 v40, v24, v25, v26
mma a[168:171],a[232:235],v[248:251],a[168:171]
v_cmp_nge_f32 vcc, s34, v40
mma a[168:171],a[236:239],v[56:59],a[168:171]
s_waitcnt lgkmcnt(2)
mma a[184:187],a[240:243],v[248:251],a[184:187]
s_waitcnt lgkmcnt(0)
v_add_u32 v2, s36, v2
mma a[184:187],a[244:247],v[56:59],a[184:187]
v_add_u32 v3, s36, v3
mma a[180:183],a[244:247],v[52:55],a[180:183]
s_waitcnt vmcnt(53)
s_barrier
mma a[180:183],a[240:243],v[244:247],a[180:183]
s_add_u32 s40, s40, 1
mma a[176:179],a[240:243],v[240:243],a[176:179]
s_cmp_eq_u32 s40, 3
s_cselect_b32 s39, 4294918144, s42
s_cselect_b32 s40, 0, s40
mma a[176:179],a[244:247],v[48:51],a[176:179]
s_cbranch_vccnz L_w3_tr13
L_w3_tr13_ret:
mma v[160:163],a[192:195],v[64:67],v[224:227]
s_mov_b32 m0, 39936
s_mov_b32 s31, 239616
ldq a[216:219],v2
bld v9,s[8:11],s31 offen offset:1024 nt lds
mma v[160:163],a[196:199],v[68:71],v[160:163]
ldq a[220:223],v3
v_add_f32 v28, v28, v24
v_add_f32 v29, v29, v25
mma v[160:163],a[200:203],v[72:75],v[160:163]
ldq a[224:227],v2 offset:128
v_add_f32 v30, v30, v26
v_add_u32 v4, s39, v4
mma v[160:163],a[204:207],v[76:79],v[160:163]
ldq a[228:231],v3 offset:128
bld v10,s[8:11],s31 offen offset:2048 nt lds
mma v[160:163],a[208:211],v[80:83],v[160:163]
ldq a[232:235],v2 offset:256
v_add_u32 v5, s39, v5
v_add_u32 v6, s39, v6
mma v[160:163],a[212:215],v[84:87],v[160:163]
s_mov_b32 m0, 43008
ldq a[236:239],v3 offset:256
v_add_u32 v7, s39, v7
mma v[164:167],a[212:215],v[108:111],v[228:231]
s_mov_b32 s31, 208896
bld v8,s[8:11],s31 offen nt lds
mma v[164:167],a[208:211],v[104:107],v[164:167]
s_add_u32 s37, s37, 1
mma v[164:167],a[204:207],v[100:103],v[164:167]
s_cmp_eq_u32 s37, 7
s_cselect_b32 s36, 4294893568, s43
s_cselect_b32 s37, 0, s37
mma v[164:167],a[200:203],v[96:99],v[164:167]
bld v9,s[8:11],s31 offen offset:1024 nt lds
mma v[164:167],a[196:199],v[92:95],v[164:167]
v_exp_f32 v32, v160
mma v[164:167],a[192:195],v[88:91],v[164:167]
v_exp_f32 v33, v161
mma v[168:171],a[192:195],v[112:115],v[232:235]
bld v10,s[8:11],s31 offen offset:2048 nt lds
v_add_f32 v24, v32, v33
mma v[168:171],a[196:199],v[116:119],v[168:171]
v_exp_f32 v34, v162
cvt v240,v32,v33
mma v[168:171],a[200:203],v[120:123],v[168:171]
s_mov_b32 m0, 46080
v_exp_f32 v35, v163
v_add_f32 v24, v24, v34
mma v[168:171],a[204:207],v[124:127],v[168:171]
s_mov_b32 s31, 242688
bld v8,s[8:11],s31 offen nt lds
cvt v241,v34,v35
mma v[168:171],a[208:211],v[128:131],v[168:171]
v_exp_f32 v36, v164
v_add_f32 v24, v24, v35
mma v[168:171],a[212:215],v[132:135],v[168:171]
s_waitcnt lgkmcnt(5)
v_exp_f32 v37, v165
mma v[176:179],a[216:219],v[64:67],v[224:227]
s_waitcnt lgkmcnt(4)
bld v9,s[8:11],s31 offen offset:1024 nt lds
v_add_f32 v25, v36, v37
mma v[176:179],a[220:223],v[68:71],v[176:179]
s_waitcnt lgkmcnt(3)
ldq a[192:195],v2 offset:6144
v_exp_f32 v38, v166
mma v[176:179],a[224:227],v[72:75],v[176:179]
s_waitcnt lgkmcnt(3)
ldq a[196:199],v3 offset:6144
v_exp_f32 v39, v167
mma v[176:179],a[228:231],v[76:79],v[176:179]
s_waitcnt lgkmcnt(3)
ldq a[200:203],v2 offset:6272
bld v10,s[8:11],s31 offen offset:2048 nt lds
mma v[176:179],a[232:235],v[80:83],v[176:179]
s_waitcnt lgkmcnt(3)
ldq a[204:207],v3 offset:6272
v_exp_f32 v32, v168
mma v[176:179],a[236:239],v[84:87],v[176:179]
ldq a[208:211],v2 offset:6400
v_exp_f32 v33, v169
mma v[180:183],a[236:239],v[108:111],v[228:231]
s_mov_b32 m0, 49152
ldq a[212:215],v3 offset:6400
ldt a[240:241],v4
cvt v244,v36,v37
mma v[180:183],a[232:235],v[104:107],v[180:183]
s_mov_b32 s31, 211968
ldt a[242:243],v4 offset:6144
bld v8,s[8:11],s31 offen nt lds
mma v[180:183],a[228:231],v[100:103],v[180:183]
v_exp_f32 v34, v170
v_add_f32 v25, v25, v38
mma v[180:183],a[224:227],v[96:99],v[180:183]
ldt a[244:245],v4 offset:12288
bld v9,s[8:11],s31 offen offset:1024 nt lds
mma v[180:183],a[220:223],v[92:95],v[180:183]
ldt a[246:247],v4 offset:18432
v_exp_f32 v35, v171
mma v[180:183],a[216:219],v[88:91],v[180:183]
s_mov_b32 m0, 135168
v_exp_f32 v36, v176
cvt v245,v38,v39
mma v[184:187],a[216:219],v[112:115],v[232:235]
s_mov_b32 s31, 196608
ldt a[248:249],v5
bld v8,s[12:15],s31 offen nt lds
mma v[184:187],a[220:223],v[116:119],v[184:187]
ldt a[250:251],v5 offset:6144
v_exp_f32 v37, v177
mma v[184:187],a[224:227],v[120:123],v[184:187]
v_exp_f32 v38, v178
v_add_f32 v25, v25, v39
mma v[184:187],a[228:231],v[124:127],v[184:187]
ldt a[252:253],v5 offset:12288
v_exp_f32 v39, v179
mma v[184:187],a[232:235],v[128:131],v[184:187]
ldt a[254:255],v5 offset:18432
bld v9,s[12:15],s31 offen offset:1024 nt lds
mma v[184:187],a[236:239],v[132:135],v[184:187]
s_waitcnt lgkmcnt(6)
v_add_f32 v26, v32, v33
cvt v248,v32,v33
v_add_f32 v26, v26, v34
mma a[0:3],a[240:243],v[192:195],a[0:3]
s_waitcnt lgkmcnt(4)
ldt a[216:217],v6
v_exp_f32 v32, v180
mma a[0:3],a[244:247],v[208:211],a[0:3]
ldt a[218:219],v6 offset:6144
bld v10,s[12:15],s31 offen offset:2048 nt lds
mma a[4:7],a[244:247],v[212:215],a[4:7]
v_exp_f32 v33, v181
cvt v249,v34,v35
mma a[4:7],a[240:243],v[196:199],a[4:7]
s_mov_b32 m0, 138240
ldt a[220:221],v6 offset:12288
v_exp_f32 v34, v182
mma a[8:11],a[240:243],v[200:203],a[8:11]
s_mov_b32 s31, 230400
ldt a[222:223],v6 offset:18432
bld v8,s[12:15],s31 offen nt lds
mma a[8:11],a[244:247],v[216:219],a[8:11]
s_waitcnt lgkmcnt(6)
v_add_f32 v26, v26, v35
v_exp_f32 v35, v183
mma a[24:27],a[248:251],v[200:203],a[24:27]
s_waitcnt lgkmcnt(4)
ldt a[224:225],v7
v_add_f32 v24, v24, v36
mma a[24:27],a[252:255],v[216:219],a[24:27]
ldt a[226:227],v7 offset:6144
bld v9,s[12:15],s31 offen offset:1024 nt lds
mma a[20:23],a[252:255],v[212:215],a[20:23]
cvt v242,v36,v37
v_exp_f32 v36, v184
mma a[20:23],a[248:251],v[196:199],a[20:23]
ldt a[228:229],v7 offset:12288
v_add_f32 v24, v24, v37
mma a[16:19],a[248:251],v[192:195],a[16:19]
ldt a[230:231],v7 offset:18432
bld v10,s[12:15],s31 offen offset:2048 nt lds
mma a[16:19],a[252:255],v[208:211],a[16:19]
s_waitcnt lgkmcnt(6)
v_exp_f32 v37, v185
mma a[32:35],a[216:219],v[192:195],a[32:35]
s_mov_b32 m0, 141312
s_waitcnt lgkmcnt(4)
ldt a[232:233],v4 offset:128
v_add_f32 v24, v24, v38
cvt v243,v38,v39
mma a[32:35],a[220:223],v[208:211],a[32:35]
s_mov_b32 s31, 199680
ldt a[234:235],v4 offset:6272
bld v8,s[12:15],s31 offen nt lds
mma a[36:39],a[220:223],v[212:215],a[36:39]
v_exp_f32 v38, v186
mma a[36:39],a[216:219],v[196:199],a[36:39]
ldt a[236:237],v4 offset:12416
v_add_f32 v24, v24, v39
mma a[40:43],a[216:219],v[200:203],a[40:43]
ldt a[238:239],v4 offset:18560
bld v9,s[12:15],s31 offen offset:1024 nt lds
mma a[40:43],a[220:223],v[216:219],a[40:43]
s_waitcnt lgkmcnt(6)
v_exp_f32 v39, v187
v_add_f32 v25, v25, v32
mma a[56:59],a[224:227],v[200:203],a[56:59]
s_waitcnt lgkmcnt(4)
ldt a[240:241],v5 offset:128
cvt v246,v32,v33
mma a[56:59],a[228:231],v[216:219],a[56:59]
ldt a[242:243],v5 offset:6272
bld v10,s[12:15],s31 offen offset:2048 nt lds
mma a[52:55],a[228:231],v[212:215],a[52:55]
v_add_f32 v25, v25, v33
v_add_f32 v25, v25, v34
cvt v247,v34,v35
mma a[52:55],a[224:227],v[196:199],a[52:55]
s_mov_b32 m0, 144384
ldt a[244:245],v5 offset:12416
v_add_f32 v25, v25, v35
mma a[48:51],a[224:227],v[192:195],a[48:51]
s_mov_b32 s31, 233472
ldt a[246:247],v5 offset:18560
bld v8,s[12:15],s31 offen nt lds
mma a[48:51],a[228:231],v[208:211],a[48:51]
s_waitcnt lgkmcnt(6)
v_add_f32 v26, v26, v36
cvt v250,v36,v37
mma a[64:67],a[232:235],v[192:195],a[64:67]
s_waitcnt lgkmcnt(4)
v_add_f32 v26, v26, v37
v_add_f32 v26, v26, v38
mma a[64:67],a[236:239],v[208:211],a[64:67]
bld v9,s[12:15],s31 offen offset:1024 nt lds
cvt v251,v38,v39
mma a[68:71],a[236:239],v[212:215],a[68:71]
v_add_f32 v26, v26, v39
mma a[68:71],a[232:235],v[196:199],a[68:71]
v_max3_f32 v40, v24, v25, v26
mma a[72:75],a[232:235],v[200:203],a[72:75]
v_cmp_nge_f32 vcc, s34, v40
mma a[72:75],a[236:239],v[216:219],a[72:75]
s_waitcnt lgkmcnt(2)
mma a[88:91],a[240:243],v[200:203],a[88:91]
s_waitcnt lgkmcnt(0)
v_add_u32 v2, s36, v2
mma a[88:91],a[244:247],v[216:219],a[88:91]
v_add_u32 v3, s36, v3
mma a[84:87],a[244:247],v[212:215],a[84:87]
s_waitcnt vmcnt(61)
s_barrier
mma a[84:87],a[240:243],v[196:199],a[84:87]
mma a[80:83],a[240:243],v[192:195],a[80:83]
mma a[80:83],a[244:247],v[208:211],a[80:83]
s_cbranch_vccnz L_w3_tr14
L_w3_tr14_ret:
v_cmp_le_u32 vcc, 32, v46
s_cmp_eq_u32 vcc_lo, 1
s_cbranch_scc0 L_w3_cnt
L_w3_cnt_ret:
mma v[160:163],a[192:195],v[64:67],v[224:227]
s_mov_b32 m0, 144384
s_mov_b32 s31, 233472
ldq a[216:219],v2
bld v10,s[12:15],s31 offen offset:2048 nt lds
mma v[160:163],a[196:199],v[68:71],v[160:163]
ldq a[220:223],v3
v_add_f32 v28, v28, v24
v_add_f32 v29, v29, v25
mma v[160:163],a[200:203],v[72:75],v[160:163]
s_mov_b32 m0, 147456
ldq a[224:227],v2 offset:128
v_add_f32 v30, v30, v26
mma v[160:163],a[204:207],v[76:79],v[160:163]
s_mov_b32 s31, 202752
ldq a[228:231],v3 offset:128
bld v8,s[12:15],s31 offen nt lds
mma v[160:163],a[208:211],v[80:83],v[160:163]
ldq a[232:235],v2 offset:256
mma v[160:163],a[212:215],v[84:87],v[160:163]
ldq a[236:239],v3 offset:256
mma v[164:167],a[212:215],v[108:111],v[228:231]
bld v9,s[12:15],s31 offen offset:1024 nt lds
mma v[164:167],a[208:211],v[104:107],v[164:167]
s_add_u32 s37, s37, 1
mma v[164:167],a[204:207],v[100:103],v[164:167]
s_cmp_eq_u32 s37, 7
s_cselect_b32 s36, 4294893568, s43
s_cselect_b32 s37, 0, s37
mma v[164:167],a[200:203],v[96:99],v[164:167]
bld v10,s[12:15],s31 offen offset:2048 nt lds
mma v[164:167],a[196:199],v[92:95],v[164:167]
v_exp_f32 v32, v160
mma v[164:167],a[192:195],v[88:91],v[164:167]
s_mov_b32 m0, 150528
v_exp_f32 v33, v161
mma v[168:171],a[192:195],v[112:115],v[232:235]
s_mov_b32 s31, 236544
bld v8,s[12:15],s31 offen nt lds
v_add_f32 v24, v32, v33
mma v[168:171],a[196:199],v[116:119],v[168:171]
v_exp_f32 v34, v162
cvt v48,v32,v33
mma v[168:171],a[200:203],v[120:123],v[168:171]
v_exp_f32 v35, v163
v_add_f32 v24, v24, v34
mma v[168:171],a[204:207],v[124:127],v[168:171]
bld v9,s[12:15],s31 offen offset:1024 nt lds
cvt v49,v34,v35
mma v[168:171],a[208:211],v[128:131],v[168:171]
v_exp_f32 v36, v164
v_add_f32 v24, v24, v35
mma v[168:171],a[212:215],v[132:135],v[168:171]
s_waitcnt lgkmcnt(5)
v_exp_f32 v37, v165
mma v[176:179],a[216:219],v[64:67],v[224:227]
s_waitcnt lgkmcnt(4)
bld v10,s[12:15],s31 offen offset:2048 nt lds
v_add_f32 v25, v36, v37
mma v[176:179],a[220:223],v[68:71],v[176:179]
s_waitcnt lgkmcnt(3)
ldq a[192:195],v2 offset:6144
v_exp_f32 v38, v166
mma v[176:179],a[224:227],v[72:75],v[176:179]
s_mov_b32 m0, 153600
s_waitcnt lgkmcnt(3)
ldq a[196:199],v3 offset:6144
v_exp_f32 v39, v167
mma v[176:179],a[228:231],v[76:79],v[176:179]
s_mov_b32 s31, 205824
s_waitcnt lgkmcnt(3)
ldq a[200:203],v2 offset:6272
bld v8,s[12:15],s31 offen nt lds
mma v[176:179],a[232:235],v[80:83],v[176:179]
s_waitcnt lgkmcnt(3)
ldq a[204:207],v3 offset:6272
v_exp_f32 v32, v168
mma v[176:179],a[236:239],v[84:87],v[176:179]
ldq a[208:211],v2 offset:6400
v_exp_f32 v33, v169
mma v[180:183],a[236:239],v[108:111],v[228:231]
ldq a[212:215],v3 offset:6400
ldt a[240:241],v6 offset:128
cvt v52,v36,v37
mma v[180:183],a[232:235],v[104:107],v[180:183]
ldt a[242:243],v6 offset:6272
bld v9,s[12:15],s31 offen offset:1024 nt lds
mma v[180:183],a[228:231],v[100:103],v[180:183]
v_exp_f32 v34, v170
v_add_f32 v25, v25, v38
mma v[180:183],a[224:227],v[96:99],v[180:183]
ldt a[244:245],v6 offset:12416
bld v10,s[12:15],s31 offen offset:2048 nt lds
mma v[180:183],a[220:223],v[92:95],v[180:183]
ldt a[246:247],v6 offset:18560
v_exp_f32 v35, v171
mma v[180:183],a[216:219],v[88:91],v[180:183]
s_mov_b32 m0, 156672
v_exp_f32 v36, v176
cvt v53,v38,v39
mma v[184:187],a[216:219],v[112:115],v[232:235]
s_mov_b32 s31, 239616
ldt a[248:249],v7 offset:128
bld v8,s[12:15],s31 offen nt lds
mma v[184:187],a[220:223],v[116:119],v[184:187]
ldt a[250:251],v7 offset:6272
v_exp_f32 v37, v177
mma v[184:187],a[224:227],v[120:123],v[184:187]
v_exp_f32 v38, v178
v_add_f32 v25, v25, v39
mma v[184:187],a[228:231],v[124:127],v[184:187]
ldt a[252:253],v7 offset:12416
v_exp_f32 v39, v179
mma v[184:187],a[232:235],v[128:131],v[184:187]
ldt a[254:255],v7 offset:18560
bld v9,s[12:15],s31 offen offset:1024 nt lds
mma v[184:187],a[236:239],v[132:135],v[184:187]
s_waitcnt lgkmcnt(6)
v_add_f32 v26, v32, v33
cvt v56,v32,v33
v_add_f32 v26, v26, v34
mma a[96:99],a[240:243],v[192:195],a[96:99]
s_waitcnt lgkmcnt(4)
ldt a[216:217],v4 offset:256
v_exp_f32 v32, v180
mma a[96:99],a[244:247],v[208:211],a[96:99]
ldt a[218:219],v4 offset:6400
bld v10,s[12:15],s31 offen offset:2048 nt lds
mma a[100:103],a[244:247],v[212:215],a[100:103]
v_exp_f32 v33, v181
cvt v57,v34,v35
mma a[100:103],a[240:243],v[196:199],a[100:103]
s_mov_b32 m0, 49152
ldt a[220:221],v4 offset:12544
v_exp_f32 v34, v182
mma a[104:107],a[240:243],v[200:203],a[104:107]
s_mov_b32 s31, 211968
ldt a[222:223],v4 offset:18688
bld v10,s[8:11],s31 offen offset:2048 nt lds
mma a[104:107],a[244:247],v[216:219],a[104:107]
s_waitcnt lgkmcnt(6)
v_add_f32 v26, v26, v35
v_exp_f32 v35, v183
mma a[120:123],a[248:251],v[200:203],a[120:123]
s_mov_b32 m0, 52224
s_waitcnt lgkmcnt(4)
ldt a[224:225],v5 offset:256
v_add_f32 v24, v24, v36
cvt v50,v36,v37
mma a[120:123],a[252:255],v[216:219],a[120:123]
s_mov_b32 s31, 245760
ldt a[226:227],v5 offset:6400
bld v8,s[8:11],s31 offen nt lds
mma a[116:119],a[252:255],v[212:215],a[116:119]
v_exp_f32 v36, v184
v_add_f32 v24, v24, v37
mma a[116:119],a[248:251],v[196:199],a[116:119]
ldt a[228:229],v5 offset:12544
v_exp_f32 v37, v185
mma a[112:115],a[248:251],v[192:195],a[112:115]
ldt a[230:231],v5 offset:18688
bld v9,s[8:11],s31 offen offset:1024 nt lds
mma a[112:115],a[252:255],v[208:211],a[112:115]
s_waitcnt lgkmcnt(6)
v_add_f32 v24, v24, v38
mma a[128:131],a[216:219],v[192:195],a[128:131]
s_waitcnt lgkmcnt(4)
ldt a[232:233],v6 offset:256
cvt v51,v38,v39
mma a[128:131],a[220:223],v[208:211],a[128:131]
ldt a[234:235],v6 offset:6400
bld v10,s[8:11],s31 offen offset:2048 nt lds
mma a[132:135],a[220:223],v[212:215],a[132:135]
v_exp_f32 v38, v186
v_add_f32 v24, v24, v39
mma a[132:135],a[216:219],v[196:199],a[132:135]
s_mov_b32 m0, 55296
ldt a[236:237],v6 offset:12544
v_exp_f32 v39, v187
mma a[136:139],a[216:219],v[200:203],a[136:139]
s_mov_b32 s31, 215040
ldt a[238:239],v6 offset:18688
bld v8,s[8:11],s31 offen nt lds
mma a[136:139],a[220:223],v[216:219],a[136:139]
s_waitcnt lgkmcnt(6)
v_add_f32 v25, v25, v32
mma a[152:155],a[224:227],v[200:203],a[152:155]
s_waitcnt lgkmcnt(4)
ldt a[240:241],v7 offset:256
cvt v54,v32,v33
v_add_f32 v25, v25, v33
mma a[152:155],a[228:231],v[216:219],a[152:155]
ldt a[242:243],v7 offset:6400
bld v9,s[8:11],s31 offen offset:1024 nt lds
mma a[148:151],a[228:231],v[212:215],a[148:151]
v_add_f32 v25, v25, v34
cvt v55,v34,v35
mma a[148:151],a[224:227],v[196:199],a[148:151]
ldt a[244:245],v7 offset:12544
v_add_f32 v25, v25, v35
mma a[144:147],a[224:227],v[192:195],a[144:147]
ldt a[246:247],v7 offset:18688
bld v10,s[8:11],s31 offen offset:2048 nt lds
mma a[144:147],a[228:231],v[208:211],a[144:147]
s_waitcnt lgkmcnt(6)
v_add_f32 v26, v26, v36
cvt v58,v36,v37
v_add_f32 v26, v26, v37
mma a[160:163],a[232:235],v[192:195],a[160:163]
s_mov_b32 m0, 58368
s_waitcnt lgkmcnt(4)
v_add_f32 v26, v26, v38
mma a[160:163],a[236:239],v[208:211],a[160:163]
s_mov_b32 s31, 248832
bld v8,s[8:11],s31 offen nt lds
cvt v59,v38,v39
mma a[164:167],a[236:239],v[212:215],a[164:167]
v_add_f32 v26, v26, v39
mma a[164:167],a[232:235],v[196:199],a[164:167]
v_max3_f32 v40, v24, v25, v26
mma a[168:171],a[232:235],v[200:203],a[168:171]
v_cmp_nge_f32 vcc, s34, v40
mma a[168:171],a[236:239],v[216:219],a[168:171]
s_waitcnt lgkmcnt(2)
mma a[184:187],a[240:243],v[200:203],a[184:187]
s_waitcnt lgkmcnt(0)
v_add_u32 v2, s36, v2
mma a[184:187],a[244:247],v[216:219],a[184:187]
v_add_u32 v3, s36, v3
mma a[180:183],a[244:247],v[212:215],a[180:183]
s_waitcnt vmcnt(46)
s_barrier
mma a[180:183],a[240:243],v[196:199],a[180:183]
s_add_u32 s40, s40, 1
mma a[176:179],a[240:243],v[192:195],a[176:179]
s_cmp_eq_u32 s40, 3
s_cselect_b32 s39, 4294918144, s42
s_cselect_b32 s40, 0, s40
mma a[176:179],a[244:247],v[208:211],a[176:179]
s_cbranch_vccnz L_w3_tr15
L_w3_tr15_ret:
mma v[160:163],a[192:195],v[64:67],v[224:227]
s_mov_b32 m0, 58368
s_mov_b32 s31, 248832
ldq a[216:219],v2
bld v9,s[8:11],s31 offen offset:1024 nt lds
mma v[160:163],a[196:199],v[68:71],v[160:163]
ldq a[220:223],v3
v_add_f32 v28, v28, v24
v_add_f32 v29, v29, v25
mma v[160:163],a[200:203],v[72:75],v[160:163]
ldq a[224:227],v2 offset:128
v_add_f32 v30, v30, v26
v_add_u32 v4, s39, v4
mma v[160:163],a[204:207],v[76:79],v[160:163]
ldq a[228:231],v3 offset:128
bld v10,s[8:11],s31 offen offset:2048 nt lds
mma v[160:163],a[208:211],v[80:83],v[160:163]
ldq a[232:235],v2 offset:256
v_add_u32 v5, s39, v5
v_add_u32 v6, s39, v6
mma v[160:163],a[212:215],v[84:87],v[160:163]
s_mov_b32 m0, 61440
ldq a[236:239],v3 offset:256
v_add_u32 v7, s39, v7
mma v[164:167],a[212:215],v[108:111],v[228:231]
s_mov_b32 s31, 218112
bld v8,s[8:11],s31 offen nt lds
mma v[164:167],a[208:211],v[104:107],v[164:167]
s_add_u32 s37, s37, 1
mma v[164:167],a[204:207],v[100:103],v[164:167]
s_cmp_eq_u32 s37, 7
s_cselect_b32 s36, 4294893568, s43
s_cselect_b32 s37, 0, s37
mma v[164:167],a[200:203],v[96:99],v[164:167]
bld v9,s[8:11],s31 offen offset:1024 nt lds
mma v[164:167],a[196:199],v[92:95],v[164:167]
v_exp_f32 v32, v160
mma v[164:167],a[192:195],v[88:91],v[164:167]
v_exp_f32 v33, v161
mma v[168:171],a[192:195],v[112:115],v[232:235]
bld v10,s[8:11],s31 offen offset:2048 nt lds
v_add_f32 v24, v32, v33
mma v[168:171],a[196:199],v[116:119],v[168:171]
v_exp_f32 v34, v162
cvt v192,v32,v33
mma v[168:171],a[200:203],v[120:123],v[168:171]
s_mov_b32 m0, 64512
v_exp_f32 v35, v163
v_add_f32 v24, v24, v34
mma v[168:171],a[204:207],v[124:127],v[168:171]
s_mov_b32 s31, 251904
bld v8,s[8:11],s31 offen nt lds
cvt v193,v34,v35
mma v[168:171],a[208:211],v[128:131],v[168:171]
v_exp_f32 v36, v164
v_add_f32 v24, v24, v35
mma v[168:171],a[212:215],v[132:135],v[168:171]
s_waitcnt lgkmcnt(5)
v_exp_f32 v37, v165
mma v[176:179],a[216:219],v[64:67],v[224:227]
s_waitcnt lgkmcnt(4)
bld v9,s[8:11],s31 offen offset:1024 nt lds
v_add_f32 v25, v36, v37
mma v[176:179],a[220:223],v[68:71],v[176:179]
s_waitcnt lgkmcnt(3)
ldq a[192:195],v2 offset:6144
v_exp_f32 v38, v166
mma v[176:179],a[224:227],v[72:75],v[176:179]
s_waitcnt lgkmcnt(3)
ldq a[196:199],v3 offset:6144
v_exp_f32 v39, v167
mma v[176:179],a[228:231],v[76:79],v[176:179]
s_waitcnt lgkmcnt(3)
ldq a[200:203],v2 offset:6272
bld v10,s[8:11],s31 offen offset:2048 nt lds
mma v[176:179],a[232:235],v[80:83],v[176:179]
s_waitcnt lgkmcnt(3)
ldq a[204:207],v3 offset:6272
v_exp_f32 v32, v168
mma v[176:179],a[236:239],v[84:87],v[176:179]
ldq a[208:211],v2 offset:6400
v_exp_f32 v33, v169
mma v[180:183],a[236:239],v[108:111],v[228:231]
s_mov_b32 m0, 67584
ldq a[212:215],v3 offset:6400
ldt a[240:241],v4
cvt v196,v36,v37
mma v[180:183],a[232:235],v[104:107],v[180:183]
s_mov_b32 s31, 221184
ldt a[242:243],v4 offset:6144
bld v8,s[8:11],s31 offen nt lds
mma v[180:183],a[228:231],v[100:103],v[180:183]
v_exp_f32 v34, v170
v_add_f32 v25, v25, v38
mma v[180:183],a[224:227],v[96:99],v[180:183]
ldt a[244:245],v4 offset:12288
bld v9,s[8:11],s31 offen offset:1024 nt lds
mma v[180:183],a[220:223],v[92:95],v[180:183]
ldt a[246:247],v4 offset:18432
v_exp_f32 v35, v171
mma v[180:183],a[216:219],v[88:91],v[180:183]
v_exp_f32 v36, v176
cvt v197,v38,v39
mma v[184:187],a[216:219],v[112:115],v[232:235]
ldt a[248:249],v5
bld v10,s[8:11],s31 offen offset:2048 nt lds
mma v[184:187],a[220:223],v[116:119],v[184:187]
ldt a[250:251],v5 offset:6144
v_exp_f32 v37, v177
mma v[184:187],a[224:227],v[120:123],v[184:187]
v_exp_f32 v38, v178
v_add_f32 v25, v25, v39
mma v[184:187],a[228:231],v[124:127],v[184:187]
s_mov_b32 m0, 70656
ldt a[252:253],v5 offset:12288
v_exp_f32 v39, v179
mma v[184:187],a[232:235],v[128:131],v[184:187]
s_mov_b32 s31, 254976
ldt a[254:255],v5 offset:18432
bld v8,s[8:11],s31 offen nt lds
mma v[184:187],a[236:239],v[132:135],v[184:187]
s_waitcnt lgkmcnt(6)
v_add_f32 v26, v32, v33
cvt v200,v32,v33
v_add_f32 v26, v26, v34
mma a[0:3],a[240:243],v[240:243],a[0:3]
s_waitcnt lgkmcnt(4)
ldt a[216:217],v6
v_exp_f32 v32, v180
mma a[0:3],a[244:247],v[48:51],a[0:3]
ldt a[218:219],v6 offset:6144
bld v9,s[8:11],s31 offen offset:1024 nt lds
mma a[4:7],a[244:247],v[52:55],a[4:7]
v_exp_f32 v33, v181
cvt v201,v34,v35
mma a[4:7],a[240:243],v[244:247],a[4:7]
ldt a[220:221],v6 offset:12288
v_exp_f32 v34, v182
mma a[8:11],a[240:243],v[248:251],a[8:11]
ldt a[222:223],v6 offset:18432
bld v10,s[8:11],s31 offen offset:2048 nt lds
mma a[8:11],a[244:247],v[56:59],a[8:11]
s_waitcnt lgkmcnt(6)
v_add_f32 v26, v26, v35
v_exp_f32 v35, v183
mma a[24:27],a[248:251],v[248:251],a[24:27]
s_mov_b32 m0, 73728
s_waitcnt lgkmcnt(4)
ldt a[224:225],v7
v_add_f32 v24, v24, v36
mma a[24:27],a[252:255],v[56:59],a[24:27]
s_mov_b32 s31, 224256
ldt a[226:227],v7 offset:6144
bld v8,s[8:11],s31 offen nt lds
mma a[20:23],a[252:255],v[52:55],a[20:23]
cvt v194,v36,v37
v_exp_f32 v36, v184
mma a[20:23],a[248:251],v[244:247],a[20:23]
ldt a[228:229],v7 offset:12288
v_add_f32 v24, v24, v37
mma a[16:19],a[248:251],v[240:243],a[16:19]
ldt a[230:231],v7 offset:18432
bld v9,s[8:11],s31 offen offset:1024 nt lds
mma a[16:19],a[252:255],v[48:51],a[16:19]
s_waitcnt lgkmcnt(6)
v_exp_f32 v37, v185
mma a[32:35],a[216:219],v[240:243],a[32:35]
s_mov_b32 m0, 86016
s_waitcnt lgkmcnt(4)
ldt a[232:233],v4 offset:128
v_add_f32 v24, v24, v38
cvt v195,v38,v39
mma a[32:35],a[220:223],v[48:51],a[32:35]
s_mov_b32 s31, 208896
ldt a[234:235],v4 offset:6272
bld v8,s[12:15],s31 offen nt lds
mma a[36:39],a[220:223],v[52:55],a[36:39]
v_exp_f32 v38, v186
mma a[36:39],a[216:219],v[244:247],a[36:39]
ldt a[236:237],v4 offset:12416
v_add_f32 v24, v24, v39
mma a[40:43],a[216:219],v[248:251],a[40:43]
ldt a[238:239],v4 offset:18560
bld v9,s[12:15],s31 offen offset:1024 nt lds
mma a[40:43],a[220:223],v[56:59],a[40:43]
s_waitcnt lgkmcnt(6)
v_exp_f32 v39, v187
v_add_f32 v25, v25, v32
mma a[56:59],a[224:227],v[248:251],a[56:59]
s_waitcnt lgkmcnt(4)
ldt a[240:241],v5 offset:128
cvt v198,v32,v33
mma a[56:59],a[228:231],v[56:59],a[56:59]
ldt a[242:243],v5 offset:6272
bld v10,s[12:15],s31 offen offset:2048 nt lds
mma a[52:55],a[228:231],v[52:55],a[52:55]
v_add_f32 v25, v25, v33
v_add_f32 v25, v25, v34
cvt v199,v34,v35
mma a[52:55],a[224:227],v[244:247],a[52:55]
s_mov_b32 m0, 89088
ldt a[244:245],v5 offset:12416
v_add_f32 v25, v25, v35
mma a[48:51],a[224:227],v[240:243],a[48:51]
s_mov_b32 s31, 242688
ldt a[246:247],v5 offset:18560
bld v8,s[12:15],s31 offen nt lds
mma a[48:51],a[228:231],v[48:51],a[48:51]
s_waitcnt lgkmcnt(6)
v_add_f32 v26, v26, v36
cvt v202,v36,v37
mma a[64:67],a[232:235],v[240:243],a[64:67]
s_waitcnt lgkmcnt(4)
v_add_f32 v26, v26, v37
v_add_f32 v26, v26, v38
mma a[64:67],a[236:239],v[48:51],a[64:67]
bld v9,s[12:15],s31 offen offset:1024 nt lds
cvt v203,v38,v39
mma a[68:71],a[236:239],v[52:55],a[68:71]
v_add_f32 v26, v26, v39
mma a[68:71],a[232:235],v[244:247],a[68:71]
v_max3_f32 v40, v24, v25, v26
mma a[72:75],a[232:235],v[248:251],a[72:75]
v_cmp_nge_f32 vcc, s34, v40
mma a[72:75],a[236:239],v[56:59],a[72:75]
s_waitcnt lgkmcnt(2)
mma a[88:91],a[240:243],v[248:251],a[88:91]
s_waitcnt lgkmcnt(0)
v_add_u32 v2, s36, v2
mma a[88:91],a[244:247],v[56:59],a[88:91]
v_add_u32 v3, s36, v3
mma a[84:87],a[244:247],v[52:55],a[84:87]
s_waitcnt vmcnt(55)
s_barrier
mma a[84:87],a[240:243],v[244:247],a[84:87]
mma a[80:83],a[240:243],v[240:243],a[80:83]
mma a[80:83],a[244:247],v[48:51],a[80:83]
s_cbranch_vccnz L_w3_tr16
L_w3_tr16_ret:
mma v[160:163],a[192:195],v[64:67],v[224:227]
s_mov_b32 m0, 89088
s_mov_b32 s31, 242688
ldq a[216:219],v2
bld v10,s[12:15],s31 offen offset:2048 nt lds
mma v[160:163],a[196:199],v[68:71],v[160:163]
ldq a[220:223],v3
v_add_f32 v28, v28, v24
v_add_f32 v29, v29, v25
mma v[160:163],a[200:203],v[72:75],v[160:163]
s_mov_b32 m0, 92160
ldq a[224:227],v2 offset:128
v_add_f32 v30, v30, v26
mma v[160:163],a[204:207],v[76:79],v[160:163]
s_mov_b32 s31, 211968
ldq a[228:231],v3 offset:128
bld v8,s[12:15],s31 offen nt lds
mma v[160:163],a[208:211],v[80:83],v[160:163]
ldq a[232:235],v2 offset:256
mma v[160:163],a[212:215],v[84:87],v[160:163]
ldq a[236:239],v3 offset:256
mma v[164:167],a[212:215],v[108:111],v[228:231]
bld v9,s[12:15],s31 offen offset:1024 nt lds
mma v[164:167],a[208:211],v[104:107],v[164:167]
s_add_u32 s37, s37, 1
mma v[164:167],a[204:207],v[100:103],v[164:167]
s_cmp_eq_u32 s37, 7
s_cselect_b32 s36, 4294893568, s43
s_cselect_b32 s37, 0, s37
mma v[164:167],a[200:203],v[96:99],v[164:167]
bld v10,s[12:15],s31 offen offset:2048 nt lds
mma v[164:167],a[196:199],v[92:95],v[164:167]
v_exp_f32 v32, v160
mma v[164:167],a[192:195],v[88:91],v[164:167]
s_mov_b32 m0, 95232
v_exp_f32 v33, v161
mma v[168:171],a[192:195],v[112:115],v[232:235]
s_mov_b32 s31, 245760
bld v8,s[12:15],s31 offen nt lds
v_add_f32 v24, v32, v33
mma v[168:171],a[196:199],v[116:119],v[168:171]
v_exp_f32 v34, v162
cvt v208,v32,v33
mma v[168:171],a[200:203],v[120:123],v[168:171]
v_exp_f32 v35, v163
v_add_f32 v24, v24, v34
mma v[168:171],a[204:207],v[124:127],v[168:171]
bld v9,s[12:15],s31 offen offset:1024 nt lds
cvt v209,v34,v35
mma v[168:171],a[208:211],v[128:131],v[168:171]
v_exp_f32 v36, v164
v_add_f32 v24, v24, v35
mma v[168:171],a[212:215],v[132:135],v[168:171]
s_waitcnt lgkmcnt(5)
v_exp_f32 v37, v165
mma v[176:179],a[216:219],v[64:67],v[224:227]
s_waitcnt lgkmcnt(4)
bld v10,s[12:15],s31 offen offset:2048 nt lds
v_add_f32 v25, v36, v37
mma v[176:179],a[220:223],v[68:71],v[176:179]
s_waitcnt lgkmcnt(3)
ldq a[192:195],v2 offset:6144
v_exp_f32 v38, v166
mma v[176:179],a[224:227],v[72:75],v[176:179]
s_mov_b32 m0, 98304
s_waitcnt lgkmcnt(3)
ldq a[196:199],v3 offset:6144
v_exp_f32 v39, v167
mma v[176:179],a[228:231],v[76:79],v[176:179]
s_mov_b32 s31, 215040
s_waitcnt lgkmcnt(3)
ldq a[200:203],v2 offset:6272
bld v8,s[12:15],s31 offen nt lds
mma v[176:179],a[232:235],v[80:83],v[176:179]
s_waitcnt lgkmcnt(3)
ldq a[204:207],v3 offset:6272
v_exp_f32 v32, v168
mma v[176:179],a[236:239],v[84:87],v[176:179]
ldq a[208:211],v2 offset:6400
v_exp_f32 v33, v169
mma v[180:183],a[236:239],v[108:111],v[228:231]
ldq a[212:215],v3 offset:6400
ldt a[240:241],v6 offset:128
cvt v212,v36,v37
mma v[180:183],a[232:235],v[104:107],v[180:183]
ldt a[242:243],v6 offset:6272
bld v9,s[12:15],s31 offen offset:1024 nt lds
mma v[180:183],a[228:231],v[100:103],v[180:183]
v_exp_f32 v34, v170
v_add_f32 v25, v25, v38
mma v[180:183],a[224:227],v[96:99],v[180:183]
ldt a[244:245],v6 offset:12416
bld v10,s[12:15],s31 offen offset:2048 nt lds
mma v[180:183],a[220:223],v[92:95],v[180:183]
ldt a[246:247],v6 offset:18560
v_exp_f32 v35, v171
mma v[180:183],a[216:219],v[88:91],v[180:183]
s_mov_b32 m0, 101376
v_exp_f32 v36, v176
cvt v213,v38,v39
mma v[184:187],a[216:219],v[112:115],v[232:235]
s_mov_b32 s31, 248832
ldt a[248:249],v7 offset:128
bld v8,s[12:15],s31 offen nt lds
mma v[184:187],a[220:223],v[116:119],v[184:187]
ldt a[250:251],v7 offset:6272
v_exp_f32 v37, v177
mma v[184:187],a[224:227],v[120:123],v[184:187]
v_exp_f32 v38, v178
v_add_f32 v25, v25, v39
mma v[184:187],a[228:231],v[124:127],v[184:187]
ldt a[252:253],v7 offset:12416
v_exp_f32 v39, v179
mma v[184:187],a[232:235],v[128:131],v[184:187]
ldt a[254:255],v7 offset:18560
bld v9,s[12:15],s31 offen offset:1024 nt lds
mma v[184:187],a[236:239],v[132:135],v[184:187]
s_waitcnt lgkmcnt(6)
v_add_f32 v26, v32, v33
cvt v216,v32,v33
v_add_f32 v26, v26, v34
mma a[96:99],a[240:243],v[240:243],a[96:99]
s_waitcnt lgkmcnt(4)
ldt a[216:217],v4 offset:256
v_exp_f32 v32, v180
mma a[96:99],a[244:247],v[48:51],a[96:99]
ldt a[218:219],v4 offset:6400
bld v10,s[12:15],s31 offen offset:2048 nt lds
mma a[100:103],a[244:247],v[52:55],a[100:103]
v_exp_f32 v33, v181
cvt v217,v34,v35
mma a[100:103],a[240:243],v[244:247],a[100:103]
s_mov_b32 m0, 104448
ldt a[220:221],v4 offset:12544
v_exp_f32 v34, v182
mma a[104:107],a[240:243],v[248:251],a[104:107]
s_mov_b32 s31, 218112
ldt a[222:223],v4 offset:18688
bld v8,s[12:15],s31 offen nt lds
mma a[104:107],a[244:247],v[56:59],a[104:107]
s_waitcnt lgkmcnt(6)
v_add_f32 v26, v26, v35
v_exp_f32 v35, v183
mma a[120:123],a[248:251],v[248:251],a[120:123]
s_waitcnt lgkmcnt(4)
ldt a[224:225],v5 offset:256
v_add_f32 v24, v24, v36
cvt v210,v36,v37
mma a[120:123],a[252:255],v[56:59],a[120:123]
ldt a[226:227],v5 offset:6400
bld v9,s[12:15],s31 offen offset:1024 nt lds
mma a[116:119],a[252:255],v[52:55],a[116:119]
v_exp_f32 v36, v184
v_add_f32 v24, v24, v37
mma a[116:119],a[248:251],v[244:247],a[116:119]
ldt a[228:229],v5 offset:12544
v_exp_f32 v37, v185
mma a[112:115],a[248:251],v[240:243],a[112:115]
ldt a[230:231],v5 offset:18688
bld v10,s[12:15],s31 offen offset:2048 nt lds
mma a[112:115],a[252:255],v[48:51],a[112:115]
s_waitcnt lgkmcnt(6)
v_add_f32 v24, v24, v38
mma a[128:131],a[216:219],v[240:243],a[128:131]
s_mov_b32 m0, 107520
s_waitcnt lgkmcnt(4)
ldt a[232:233],v6 offset:256
cvt v211,v38,v39
mma a[128:131],a[220:223],v[48:51],a[128:131]
s_mov_b32 s31, 251904
ldt a[234:235],v6 offset:6400
bld v8,s[12:15],s31 offen nt lds
mma a[132:135],a[220:223],v[52:55],a[132:135]
v_exp_f32 v38, v186
v_add_f32 v24, v24, v39
mma a[132:135],a[216:219],v[244:247],a[132:135]
ldt a[236:237],v6 offset:12544
v_exp_f32 v39, v187
mma a[136:139],a[216:219],v[248:251],a[136:139]
ldt a[238:239],v6 offset:18688
bld v9,s[12:15],s31 offen offset:1024 nt lds
mma a[136:139],a[220:223],v[56:59],a[136:139]
s_waitcnt lgkmcnt(6)
v_add_f32 v25, v25, v32
mma a[152:155],a[224:227],v[248:251],a[152:155]
s_waitcnt lgkmcnt(4)
ldt a[240:241],v7 offset:256
cvt v214,v32,v33
v_add_f32 v25, v25, v33
mma a[152:155],a[228:231],v[56:59],a[152:155]
ldt a[242:243],v7 offset:6400
bld v10,s[12:15],s31 offen offset:2048 nt lds
mma a[148:151],a[228:231],v[52:55],a[148:151]
v_add_f32 v25, v25, v34
cvt v215,v34,v35
mma a[148:151],a[224:227],v[244:247],a[148:151]
s_mov_b32 m0, 73728
ldt a[244:245],v7 offset:12544
v_add_f32 v25, v25, v35
mma a[144:147],a[224:227],v[240:243],a[144:147]
s_mov_b32 s31, 224256
ldt a[246:247],v7 offset:18688
bld v10,s[8:11],s31 offen offset:2048 nt lds
mma a[144:147],a[228:231],v[48:51],a[144:147]
s_waitcnt lgkmcnt(6)
v_add_f32 v26, v26, v36
cvt v218,v36,v37
v_add_f32 v26, v26, v37
mma a[160:163],a[232:235],v[240:243],a[160:163]
s_mov_b32 m0, 76800
s_waitcnt lgkmcnt(4)
v_add_f32 v26, v26, v38
mma a[160:163],a[236:239],v[48:51],a[160:163]
s_mov_b32 s31, 258048
bld v8,s[8:11],s31 offen nt lds
cvt v219,v38,v39
mma a[164:167],a[236:239],v[52:55],a[164:167]
v_add_f32 v26, v26, v39
mma a[164:167],a[232:235],v[244:247],a[164:167]
v_max3_f32 v40, v24, v25, v26
mma a[168:171],a[232:235],v[248:251],a[168:171]
v_cmp_nge_f32 vcc, s34, v40
mma a[168:171],a[236:239],v[56:59],a[168:171]
s_waitcnt lgkmcnt(2)
mma a[184:187],a[240:243],v[248:251],a[184:187]
s_waitcnt lgkmcnt(0)
v_add_u32 v2, s36, v2
mma a[184:187],a[244:247],v[56:59],a[184:187]
v_add_u32 v3, s36, v3
mma a[180:183],a[244:247],v[52:55],a[180:183]
s_waitcnt vmcnt(40)
s_barrier
mma a[180:183],a[240:243],v[244:247],a[180:183]
s_add_u32 s40, s40, 1
mma a[176:179],a[240:243],v[240:243],a[176:179]
s_cmp_eq_u32 s40, 3
s_cselect_b32 s39, 4294918144, s42
s_cselect_b32 s40, 0, s40
mma a[176:179],a[244:247],v[48:51],a[176:179]
s_cbranch_vccnz L_w3_tr17
L_w3_tr17_ret:
mma v[160:163],a[192:195],v[64:67],v[224:227]
s_mov_b32 m0, 76800
s_mov_b32 s31, 258048
ldq a[216:219],v2
bld v9,s[8:11],s31 offen offset:1024 nt lds
mma v[160:163],a[196:199],v[68:71],v[160:163]
ldq a[220:223],v3
v_add_f32 v28, v28, v24
v_add_f32 v29, v29, v25
mma v[160:163],a[200:203],v[72:75],v[160:163]
ldq a[224:227],v2 offset:128
bld v10,s[8:11],s31 offen offset:2048 nt lds
mma v[160:163],a[204:207],v[76:79],v[160:163]
ldq a[228:231],v3 offset:128
v_add_f32 v30, v30, v26
v_add_u32 v4, s39, v4
mma v[160:163],a[208:211],v[80:83],v[160:163]
s_mov_b32 m0, 79872
ldq a[232:235],v2 offset:256
v_add_u32 v5, s39, v5
v_add_u32 v6, s39, v6
mma v[160:163],a[212:215],v[84:87],v[160:163]
s_mov_b32 s31, 227328
ldq a[236:239],v3 offset:256
bld v8,s[8:11],s31 offen nt lds
mma v[164:167],a[212:215],v[108:111],v[228:231]
v_add_u32 v7, s39, v7
mma v[164:167],a[208:211],v[104:107],v[164:167]
s_add_u32 s37, s37, 1
mma v[164:167],a[204:207],v[100:103],v[164:167]
s_cmp_eq_u32 s37, 7
s_cselect_b32 s36, 4294893568, s43
s_cselect_b32 s37, 0, s37
bld v9,s[8:11],s31 offen offset:1024 nt lds
mma v[164:167],a[200:203],v[96:99],v[164:167]
v_exp_f32 v32, v160
mma v[164:167],a[196:199],v[92:95],v[164:167]
v_exp_f32 v33, v161
mma v[164:167],a[192:195],v[88:91],v[164:167]
bld v10,s[8:11],s31 offen offset:2048 nt lds
v_add_f32 v24, v32, v33
mma v[168:171],a[192:195],v[112:115],v[232:235]
v_exp_f32 v34, v162
cvt v240,v32,v33
mma v[168:171],a[196:199],v[116:119],v[168:171]
s_mov_b32 m0, 82944
v_exp_f32 v35, v163
v_add_f32 v24, v24, v34
mma v[168:171],a[200:203],v[120:123],v[168:171]
s_mov_b32 s31, 261120
bld v8,s[8:11],s31 offen nt lds
cvt v241,v34,v35
mma v[168:171],a[204:207],v[124:127],v[168:171]
v_exp_f32 v36, v164
v_add_f32 v24, v24, v35
mma v[168:171],a[208:211],v[128:131],v[168:171]
v_exp_f32 v37, v165
mma v[168:171],a[212:215],v[132:135],v[168:171]
s_waitcnt lgkmcnt(5)
bld v9,s[8:11],s31 offen offset:1024 nt lds
v_add_f32 v25, v36, v37
mma v[176:179],a[216:219],v[64:67],v[224:227]
s_waitcnt lgkmcnt(4)
v_exp_f32 v38, v166
cvt v244,v36,v37
mma v[176:179],a[220:223],v[68:71],v[176:179]
s_waitcnt lgkmcnt(3)
ldq a[192:195],v2 offset:6144
v_exp_f32 v39, v167
mma v[176:179],a[224:227],v[72:75],v[176:179]
s_waitcnt lgkmcnt(3)
ldq a[196:199],v3 offset:6144
bld v10,s[8:11],s31 offen offset:2048 nt lds
mma v[176:179],a[228:231],v[76:79],v[176:179]
s_waitcnt lgkmcnt(3)
ldq a[200:203],v2 offset:6272
v_exp_f32 v32, v168
mma v[176:179],a[232:235],v[80:83],v[176:179]
s_mov_b32 m0, 0
s_waitcnt lgkmcnt(3)
ldq a[204:207],v3 offset:6272
v_exp_f32 v33, v169
mma v[176:179],a[236:239],v[84:87],v[176:179]
s_mov_b32 s31, 294912
ldq a[208:211],v2 offset:6400
bld v8,s[8:11],s31 offen nt lds
mma v[180:183],a[236:239],v[108:111],v[228:231]
ldq a[212:215],v3 offset:6400
ldt a[240:241],v4
v_add_f32 v25, v25, v38
mma v[180:183],a[232:235],v[104:107],v[180:183]
ldt a[242:243],v4 offset:6144
v_exp_f32 v34, v170
mma v[180:183],a[228:231],v[100:103],v[180:183]
bld v9,s[8:11],s31 offen offset:1024 nt lds
cvt v245,v38,v39
mma v[180:183],a[224:227],v[96:99],v[180:183]
ldt a[244:245],v4 offset:12288
v_exp_f32 v35, v171
mma v[180:183],a[220:223],v[92:95],v[180:183]
ldt a[246:247],v4 offset:18432
v_exp_f32 v36, v176
mma v[180:183],a[216:219],v[88:91],v[180:183]
bld v10,s[8:11],s31 offen offset:2048 nt lds
v_add_f32 v25, v25, v39
mma v[184:187],a[216:219],v[112:115],v[232:235]
ldt a[248:249],v5
v_exp_f32 v37, v177
mma v[184:187],a[220:223],v[116:119],v[184:187]
s_mov_b32 m0, 3072
ldt a[250:251],v5 offset:6144
v_exp_f32 v38, v178
mma v[184:187],a[224:227],v[120:123],v[184:187]
s_mov_b32 s31, 264192
bld v8,s[8:11],s31 offen nt lds
v_add_f32 v26, v32, v33
mma v[184:187],a[228:231],v[124:127],v[184:187]
ldt a[252:253],v5 offset:12288
v_exp_f32 v39, v179
mma v[184:187],a[232:235],v[128:131],v[184:187]
ldt a[254:255],v5 offset:18432
cvt v248,v32,v33
v_add_f32 v26, v26, v34
mma v[184:187],a[236:239],v[132:135],v[184:187]
s_waitcnt lgkmcnt(6)
bld v9,s[8:11],s31 offen offset:1024 nt lds
cvt v249,v34,v35
mma a[0:3],a[240:243],v[192:195],a[0:3]
s_waitcnt lgkmcnt(4)
ldt a[216:217],v6
v_exp_f32 v32, v180
mma a[0:3],a[244:247],v[208:211],a[0:3]
ldt a[218:219],v6 offset:6144
v_exp_f32 v33, v181
mma a[4:7],a[244:247],v[212:215],a[4:7]
bld v10,s[8:11],s31 offen offset:2048 nt lds
v_add_f32 v26, v26, v35
mma a[4:7],a[240:243],v[196:199],a[4:7]
ldt a[220:221],v6 offset:12288
v_exp_f32 v34, v182
mma a[8:11],a[240:243],v[200:203],a[8:11]
s_mov_b32 m0, 6144
ldt a[222:223],v6 offset:18432
v_exp_f32 v35, v183
mma a[8:11],a[244:247],v[216:219],a[8:11]
s_mov_b32 s31, 297984
s_waitcnt lgkmcnt(6)
bld v8,s[8:11],s31 offen nt lds
mma a[24:27],a[248:251],v[200:203],a[24:27]
s_waitcnt lgkmcnt(4)
ldt a[224:225],v7
v_add_f32 v24, v24, v36
mma a[24:27],a[252:255],v[216:219],a[24:27]
ldt a[226:227],v7 offset:6144
cvt v242,v36,v37
mma a[20:23],a[252:255],v[212:215],a[20:23]
bld v9,s[8:11],s31 offen offset:1024 nt lds
v_add_f32 v24, v24, v37
mma a[20:23],a[248:251],v[196:199],a[20:23]
ldt a[228:229],v7 offset:12288
v_exp_f32 v36, v184
mma a[16:19],a[248:251],v[192:195],a[16:19]
ldt a[230:231],v7 offset:18432
v_exp_f32 v37, v185
mma a[16:19],a[252:255],v[208:211],a[16:19]
s_waitcnt lgkmcnt(6)
bld v10,s[8:11],s31 offen offset:2048 nt lds
mma a[32:35],a[216:219],v[192:195],a[32:35]
s_waitcnt lgkmcnt(4)
ldt a[232:233],v4 offset:128
v_add_f32 v24, v24, v38
cvt v243,v38,v39
mma a[32:35],a[220:223],v[208:211],a[32:35]
s_mov_b32 m0, 9216
ldt a[234:235],v4 offset:6272
v_exp_f32 v38, v186
mma a[36:39],a[220:223],v[212:215],a[36:39]
s_mov_b32 s31, 267264
bld v8,s[8:11],s31 offen nt lds
mma a[36:39],a[216:219],v[196:199],a[36:39]
ldt a[236:237],v4 offset:12416
v_add_f32 v24, v24, v39
mma a[40:43],a[216:219],v[200:203],a[40:43]
ldt a[238:239],v4 offset:18560
v_exp_f32 v39, v187
mma a[40:43],a[220:223],v[216:219],a[40:43]
s_waitcnt lgkmcnt(6)
bld v9,s[8:11],s31 offen offset:1024 nt lds
v_add_f32 v25, v25, v32
mma a[56:59],a[224:227],v[200:203],a[56:59]
s_waitcnt lgkmcnt(4)
ldt a[240:241],v5 offset:128
cvt v246,v32,v33
mma a[56:59],a[228:231],v[216:219],a[56:59]
ldt a[242:243],v5 offset:6272
v_add_f32 v25, v25, v33
mma a[52:55],a[228:231],v[212:215],a[52:55]
bld v10,s[8:11],s31 offen offset:2048 nt lds
v_add_f32 v25, v25, v34
mma a[52:55],a[224:227],v[196:199],a[52:55]
ldt a[244:245],v5 offset:12416
cvt v247,v34,v35
v_add_f32 v25, v25, v35
mma a[48:51],a[224:227],v[192:195],a[48:51]
s_mov_b32 m0, 12288
ldt a[246:247],v5 offset:18560
v_add_f32 v26, v26, v36
mma a[48:51],a[228:231],v[208:211],a[48:51]
s_mov_b32 s31, 301056
s_waitcnt lgkmcnt(6)
bld v8,s[8:11],s31 offen nt lds
cvt v250,v36,v37
mma a[64:67],a[232:235],v[192:195],a[64:67]
s_waitcnt lgkmcnt(4)
v_add_f32 v26, v26, v37
v_add_f32 v26, v26, v38
mma a[64:67],a[236:239],v[208:211],a[64:67]
cvt v251,v38,v39
mma a[68:71],a[236:239],v[212:215],a[68:71]
bld v9,s[8:11],s31 offen offset:1024 nt lds
v_add_f32 v26, v26, v39
mma a[68:71],a[232:235],v[196:199],a[68:71]
v_max3_f32 v40, v24, v25, v26
mma a[72:75],a[232:235],v[200:203],a[72:75]
v_cmp_nge_f32 vcc, s34, v40
mma a[72:75],a[236:239],v[216:219],a[72:75]
s_waitcnt lgkmcnt(2)
mma a[88:91],a[240:243],v[200:203],a[88:91]
s_waitcnt lgkmcnt(0)
v_add_u32 v2, s36, v2
mma a[88:91],a[244:247],v[216:219],a[88:91]
v_add_u32 v3, s36, v3
mma a[84:87],a[244:247],v[212:215],a[84:87]
s_waitcnt vmcnt(50)
s_barrier
mma a[84:87],a[240:243],v[196:199],a[84:87]
mma a[80:83],a[240:243],v[192:195],a[80:83]
mma a[80:83],a[244:247],v[208:211],a[80:83]
s_cbranch_vccnz L_w3_tr18
L_w3_tr18_ret:
mma v[160:163],a[192:195],v[64:67],v[224:227]
s_mov_b32 m0, 110592
s_mov_b32 s31, 221184
ldq a[216:219],v2
bld v8,s[12:15],s31 offen nt lds
mma v[160:163],a[196:199],v[68:71],v[160:163]
ldq a[220:223],v3
v_add_f32 v28, v28, v24
v_add_f32 v29, v29, v25
mma v[160:163],a[200:203],v[72:75],v[160:163]
ldq a[224:227],v2 offset:128
bld v9,s[12:15],s31 offen offset:1024 nt lds
mma v[160:163],a[204:207],v[76:79],v[160:163]
ldq a[228:231],v3 offset:128
v_add_f32 v30, v30, v26
mma v[160:163],a[208:211],v[80:83],v[160:163]
ldq a[232:235],v2 offset:256
mma v[160:163],a[212:215],v[84:87],v[160:163]
ldq a[236:239],v3 offset:256
bld v10,s[12:15],s31 offen offset:2048 nt lds
mma v[164:167],a[212:215],v[108:111],v[228:231]
mma v[164:167],a[208:211],v[104:107],v[164:167]
s_add_u32 s37, s37, 1
mma v[164:167],a[204:207],v[100:103],v[164:167]
s_cmp_eq_u32 s37, 7
s_cselect_b32 s36, 4294893568, s43
s_cselect_b32 s37, 0, s37
s_mov_b32 m0, 113664
s_mov_b32 s31, 254976
bld v8,s[12:15],s31 offen nt lds
mma v[164:167],a[200:203],v[96:99],v[164:167]
v_exp_f32 v32, v160
mma v[164:167],a[196:199],v[92:95],v[164:167]
v_exp_f32 v33, v161
mma v[164:167],a[192:195],v[88:91],v[164:167]
bld v9,s[12:15],s31 offen offset:1024 nt lds
v_add_f32 v24, v32, v33
mma v[168:171],a[192:195],v[112:115],v[232:235]
v_exp_f32 v34, v162
cvt v48,v32,v33
mma v[168:171],a[196:199],v[116:119],v[168:171]
v_exp_f32 v35, v163
v_add_f32 v24, v24, v34
mma v[168:171],a[200:203],v[120:123],v[168:171]
bld v10,s[12:15],s31 offen offset:2048 nt lds
cvt v49,v34,v35
mma v[168:171],a[204:207],v[124:127],v[168:171]
v_exp_f32 v36, v164
v_add_f32 v24, v24, v35
mma v[168:171],a[208:211],v[128:131],v[168:171]
s_mov_b32 m0, 116736
v_exp_f32 v37, v165
mma v[168:171],a[212:215],v[132:135],v[168:171]
s_mov_b32 s31, 224256
s_waitcnt lgkmcnt(5)
bld v8,s[12:15],s31 offen nt lds
v_add_f32 v25, v36, v37
mma v[176:179],a[216:219],v[64:67],v[224:227]
s_waitcnt lgkmcnt(4)
v_exp_f32 v38, v166
cvt v52,v36,v37
mma v[176:179],a[220:223],v[68:71],v[176:179]
s_waitcnt lgkmcnt(3)
ldq a[192:195],v2 offset:6144
v_exp_f32 v39, v167
mma v[176:179],a[224:227],v[72:75],v[176:179]
s_waitcnt lgkmcnt(3)
ldq a[196:199],v3 offset:6144
bld v9,s[12:15],s31 offen offset:1024 nt lds
mma v[176:179],a[228:231],v[76:79],v[176:179]
s_waitcnt lgkmcnt(3)
ldq a[200:203],v2 offset:6272
v_exp_f32 v32, v168
mma v[176:179],a[232:235],v[80:83],v[176:179]
s_waitcnt lgkmcnt(3)
ldq a[204:207],v3 offset:6272
v_exp_f32 v33, v169
mma v[176:179],a[236:239],v[84:87],v[176:179]
ldq a[208:211],v2 offset:6400
bld v10,s[12:15],s31 offen offset:2048 nt lds
mma v[180:183],a[236:239],v[108:111],v[228:231]
ldq a[212:215],v3 offset:6400
ldt a[240:241],v6 offset:128
v_add_f32 v25, v25, v38
mma v[180:183],a[232:235],v[104:107],v[180:183]
s_mov_b32 m0, 119808
ldt a[242:243],v6 offset:6272
v_exp_f32 v34, v170
mma v[180:183],a[228:231],v[100:103],v[180:183]
s_mov_b32 s31, 258048
bld v8,s[12:15],s31 offen nt lds
cvt v53,v38,v39
mma v[180:183],a[224:227],v[96:99],v[180:183]
ldt a[244:245],v6 offset:12416
v_exp_f32 v35, v171
mma v[180:183],a[220:223],v[92:95],v[180:183]
ldt a[246:247],v6 offset:18560
v_exp_f32 v36, v176
mma v[180:183],a[216:219],v[88:91],v[180:183]
bld v9,s[12:15],s31 offen offset:1024 nt lds
v_add_f32 v25, v25, v39
mma v[184:187],a[216:219],v[112:115],v[232:235]
ldt a[248:249],v7 offset:128
v_exp_f32 v37, v177
mma v[184:187],a[220:223],v[116:119],v[184:187]
ldt a[250:251],v7 offset:6272
v_exp_f32 v38, v178
mma v[184:187],a[224:227],v[120:123],v[184:187]
bld v10,s[12:15],s31 offen offset:2048 nt lds
v_add_f32 v26, v32, v33
mma v[184:187],a[228:231],v[124:127],v[184:187]
ldt a[252:253],v7 offset:12416
v_exp_f32 v39, v179
mma v[184:187],a[232:235],v[128:131],v[184:187]
s_mov_b32 m0, 122880
ldt a[254:255],v7 offset:18560
cvt v56,v32,v33
v_add_f32 v26, v26, v34
mma v[184:187],a[236:239],v[132:135],v[184:187]
s_mov_b32 s31, 227328
s_waitcnt lgkmcnt(6)
bld v8,s[12:15],s31 offen nt lds
cvt v57,v34,v35
mma a[96:99],a[240:243],v[192:195],a[96:99]
s_waitcnt lgkmcnt(4)
ldt a[216:217],v4 offset:256
v_exp_f32 v32, v180
mma a[96:99],a[244:247],v[208:211],a[96:99]
ldt a[218:219],v4 offset:6400
v_exp_f32 v33, v181
mma a[100:103],a[244:247],v[212:215],a[100:103]
bld v9,s[12:15],s31 offen offset:1024 nt lds
v_add_f32 v26, v26, v35
mma a[100:103],a[240:243],v[196:199],a[100:103]
ldt a[220:221],v4 offset:12544
v_exp_f32 v34, v182
mma a[104:107],a[240:243],v[200:203],a[104:107]
ldt a[222:223],v4 offset:18688
v_exp_f32 v35, v183
mma a[104:107],a[244:247],v[216:219],a[104:107]
s_waitcnt lgkmcnt(6)
bld v10,s[12:15],s31 offen offset:2048 nt lds
v_add_f32 v24, v24, v36
mma a[120:123],a[248:251],v[200:203],a[120:123]
s_waitcnt lgkmcnt(4)
ldt a[224:225],v5 offset:256
cvt v50,v36,v37
mma a[120:123],a[252:255],v[216:219],a[120:123]
s_mov_b32 m0, 125952
ldt a[226:227],v5 offset:6400
v_exp_f32 v36, v184
mma a[116:119],a[252:255],v[212:215],a[116:119]
s_mov_b32 s31, 261120
bld v8,s[12:15],s31 offen nt lds
v_add_f32 v24, v24, v37
mma a[116:119],a[248:251],v[196:199],a[116:119]
ldt a[228:229],v5 offset:12544
v_exp_f32 v37, v185
mma a[112:115],a[248:251],v[192:195],a[112:115]
ldt a[230:231],v5 offset:18688
mma a[112:115],a[252:255],v[208:211],a[112:115]
s_waitcnt lgkmcnt(6)
bld v9,s[12:15],s31 offen offset:1024 nt lds
v_add_f32 v24, v24, v38
mma a[128:131],a[216:219],v[192:195],a[128:131]
s_waitcnt lgkmcnt(4)
ldt a[232:233],v6 offset:256
cvt v51,v38,v39
mma a[128:131],a[220:223],v[208:211],a[128:131]
ldt a[234:235],v6 offset:6400
v_exp_f32 v38, v186
mma a[132:135],a[220:223],v[212:215],a[132:135]
bld v10,s[12:15],s31 offen offset:2048 nt lds
v_add_f32 v24, v24, v39
mma a[132:135],a[216:219],v[196:199],a[132:135]
ldt a[236:237],v6 offset:12544
v_exp_f32 v39, v187
mma a[136:139],a[216:219],v[200:203],a[136:139]
s_mov_b32 m0, 129024
ldt a[238:239],v6 offset:18688
mma a[136:139],a[220:223],v[216:219],a[136:139]
s_mov_b32 s31, 294912
s_waitcnt lgkmcnt(6)
bld v8,s[12:15],s31 offen nt lds
v_add_f32 v25, v25, v32
mma a[152:155],a[224:227],v[200:203],a[152:155]
s_waitcnt lgkmcnt(4)
ldt a[240:241],v7 offset:256
cvt v54,v32,v33
v_add_f32 v25, v25, v33
mma a[152:155],a[228:231],v[216:219],a[152:155]
ldt a[242:243],v7 offset:6400
v_add_f32 v25, v25, v34
mma a[148:151],a[228:231],v[212:215],a[148:151]
bld v9,s[12:15],s31 offen offset:1024 nt lds
cvt v55,v34,v35
mma a[148:151],a[224:227],v[196:199],a[148:151]
ldt a[244:245],v7 offset:12544
v_add_f32 v25, v25, v35
mma a[144:147],a[224:227],v[192:195],a[144:147]
ldt a[246:247],v7 offset:18688
v_add_f32 v26, v26, v36
mma a[144:147],a[228:231],v[208:211],a[144:147]
s_waitcnt lgkmcnt(6)
bld v10,s[12:15],s31 offen offset:2048 nt lds
cvt v58,v36,v37
mma a[160:163],a[232:235],v[192:195],a[160:163]
s_waitcnt lgkmcnt(4)
v_add_f32 v26, v26, v37
v_add_f32 v26, v26, v38
mma a[160:163],a[236:239],v[208:211],a[160:163]
s_mov_b32 m0, 132096
cvt v59,v38,v39
mma a[164:167],a[236:239],v[212:215],a[164:167]
s_mov_b32 s31, 264192
bld v8,s[12:15],s31 offen nt lds
v_add_f32 v26, v26, v39
mma a[164:167],a[232:235],v[196:199],a[164:167]
v_max3_f32 v40, v24, v25, v26
mma a[168:171],a[232:235],v[200:203],a[168:171]
v_cmp_nge_f32 vcc, s34, v40
mma a[168:171],a[236:239],v[216:219],a[168:171]
s_waitcnt lgkmcnt(2)
mma a[184:187],a[240:243],v[200:203],a[184:187]
s_waitcnt lgkmcnt(0)
v_add_u32 v2, s36, v2
mma a[184:187],a[244:247],v[216:219],a[184:187]
v_add_u32 v3, s36, v3
mma a[180:183],a[244:247],v[212:215],a[180:183]
s_waitcnt vmcnt(36)
s_barrier
mma a[180:183],a[240:243],v[196:199],a[180:183]
s_add_u32 s40, s40, 1
mma a[176:179],a[240:243],v[192:195],a[176:179]
s_cmp_eq_u32 s40, 3
s_cselect_b32 s39, 4294918144, s42
s_cselect_b32 s40, 0, s40
mma a[176:179],a[244:247],v[208:211],a[176:179]
s_cbranch_vccnz L_w3_tr19
L_w3_tr19_ret:
mma v[160:163],a[192:195],v[64:67],v[224:227]
s_mov_b32 m0, 132096
s_mov_b32 s31, 264192
ldq a[216:219],v2
bld v9,s[12:15],s31 offen offset:1024 nt lds
mma v[160:163],a[196:199],v[68:71],v[160:163]
ldq a[220:223],v3
v_add_f32 v28, v28, v24
v_add_f32 v29, v29, v25
mma v[160:163],a[200:203],v[72:75],v[160:163]
ldq a[224:227],v2 offset:128
bld v10,s[12:15],s31 offen offset:2048 nt lds
mma v[160:163],a[204:207],v[76:79],v[160:163]
ldq a[228:231],v3 offset:128
v_add_f32 v30, v30, v26
v_add_u32 v4, s39, v4
mma v[160:163],a[208:211],v[80:83],v[160:163]
s_mov_b32 m0, 12288
ldq a[232:235],v2 offset:256
v_add_u32 v5, s39, v5
v_add_u32 v6, s39, v6
mma v[160:163],a[212:215],v[84:87],v[160:163]
s_mov_b32 s31, 301056
ldq a[236:239],v3 offset:256
bld v10,s[8:11],s31 offen offset:2048 nt lds
mma v[164:167],a[212:215],v[108:111],v[228:231]
v_add_u32 v7, s39, v7
mma v[164:167],a[208:211],v[104:107],v[164:167]
s_add_u32 s37, s37, 1
mma v[164:167],a[204:207],v[100:103],v[164:167]
s_cmp_eq_u32 s37, 7
s_cselect_b32 s36, 4294893568, s43
s_cselect_b32 s37, 0, s37
s_mov_b32 m0, 15360
s_mov_b32 s31, 270336
bld v8,s[8:11],s31 offen nt lds
mma v[164:167],a[200:203],v[96:99],v[164:167]
v_exp_f32 v32, v160
mma v[164:167],a[196:199],v[92:95],v[164:167]
v_exp_f32 v33, v161
mma v[164:167],a[192:195],v[88:91],v[164:167]
bld v9,s[8:11],s31 offen offset:1024 nt lds
v_add_f32 v24, v32, v33
mma v[168:171],a[192:195],v[112:115],v[232:235]
v_exp_f32 v34, v162
cvt v192,v32,v33
mma v[168:171],a[196:199],v[116:119],v[168:171]
v_exp_f32 v35, v163
v_add_f32 v24, v24, v34
mma v[168:171],a[200:203],v[120:123],v[168:171]
bld v10,s[8:11],s31 offen offset:2048 nt lds
cvt v193,v34,v35
mma v[168:171],a[204:207],v[124:127],v[168:171]
s_mov_b32 m0, 18432
v_exp_f32 v36, v164
v_add_f32 v24, v24, v35
mma v[168:171],a[208:211],v[128:131],v[168:171]
s_mov_b32 s31, 304128
bld v8,s[8:11],s31 offen nt lds
mma v[168:171],a[212:215],v[132:135],v[168:171]
s_waitcnt lgkmcnt(5)
v_exp_f32 v37, v165
mma v[176:179],a[216:219],v[64:67],v[224:227]
s_waitcnt lgkmcnt(4)
v_exp_f32 v38, v166
v_add_f32 v25, v36, v37
mma v[176:179],a[220:223],v[68:71],v[176:179]
s_waitcnt lgkmcnt(3)
ldq a[192:195],v2 offset:6144
bld v9,s[8:11],s31 offen offset:1024 nt lds
mma v[176:179],a[224:227],v[72:75],v[176:179]
s_waitcnt lgkmcnt(3)
ldq a[196:199],v3 offset:6144
v_exp_f32 v39, v167
mma v[176:179],a[228:231],v[76:79],v[176:179]
s_waitcnt lgkmcnt(3)
ldq a[200:203],v2 offset:6272
v_exp_f32 v32, v168
mma v[176:179],a[232:235],v[80:83],v[176:179]
s_waitcnt lgkmcnt(3)
ldq a[204:207],v3 offset:6272
bld v10,s[8:11],s31 offen offset:2048 nt lds
mma v[176:179],a[236:239],v[84:87],v[176:179]
ldq a[208:211],v2 offset:6400
v_exp_f32 v33, v169
mma v[180:183],a[236:239],v[108:111],v[228:231]
s_mov_b32 m0, 21504
ldq a[212:215],v3 offset:6400
ldt a[240:241],v4
cvt v196,v36,v37
mma v[180:183],a[232:235],v[104:107],v[180:183]
s_mov_b32 s31, 273408
ldt a[242:243],v4 offset:6144
bld v8,s[8:11],s31 offen nt lds
mma v[180:183],a[228:231],v[100:103],v[180:183]
v_exp_f32 v34, v170
v_add_f32 v25, v25, v38
mma v[180:183],a[224:227],v[96:99],v[180:183]
ldt a[244:245],v4 offset:12288
v_exp_f32 v35, v171
mma v[180:183],a[220:223],v[92:95],v[180:183]
ldt a[246:247],v4 offset:18432
bld v9,s[8:11],s31 offen offset:1024 nt lds
mma v[180:183],a[216:219],v[88:91],v[180:183]
v_exp_f32 v36, v176
cvt v197,v38,v39
mma v[184:187],a[216:219],v[112:115],v[232:235]
ldt a[248:249],v5
v_exp_f32 v37, v177
mma v[184:187],a[220:223],v[116:119],v[184:187]
ldt a[250:251],v5 offset:6144
bld v10,s[8:11],s31 offen offset:2048 nt lds
mma v[184:187],a[224:227],v[120:123],v[184:187]
s_mov_b32 m0, 24576
v_exp_f32 v38, v178
v_add_f32 v25, v25, v39
mma v[184:187],a[228:231],v[124:127],v[184:187]
s_mov_b32 s31, 307200
ldt a[252:253],v5 offset:12288
bld v8,s[8:11],s31 offen nt lds
mma v[184:187],a[232:235],v[128:131],v[184:187]
ldt a[254:255],v5 offset:18432
v_exp_f32 v39, v179
mma v[184:187],a[236:239],v[132:135],v[184:187]
s_waitcnt lgkmcnt(6)
v_add_f32 v26, v32, v33
cvt v200,v32,v33
v_add_f32 v26, v26, v34
mma a[0:3],a[240:243],v[240:243],a[0:3]
s_waitcnt lgkmcnt(4)
ldt a[216:217],v6
bld v9,s[8:11],s31 offen offset:1024 nt lds
mma a[0:3],a[244:247],v[48:51],a[0:3]
ldt a[218:219],v6 offset:6144
v_exp_f32 v32, v180
mma a[4:7],a[244:247],v[52:55],a[4:7]
v_exp_f32 v33, v181
cvt v201,v34,v35
mma a[4:7],a[240:243],v[244:247],a[4:7]
ldt a[220:221],v6 offset:12288
bld v10,s[8:11],s31 offen offset:2048 nt lds
mma a[8:11],a[240:243],v[248:251],a[8:11]
ldt a[222:223],v6 offset:18432
v_exp_f32 v34, v182
mma a[8:11],a[244:247],v[56:59],a[8:11]
s_mov_b32 m0, 27648
s_waitcnt lgkmcnt(6)
v_add_f32 v26, v26, v35
v_exp_f32 v35, v183
mma a[24:27],a[248:251],v[248:251],a[24:27]
s_mov_b32 s31, 276480
s_waitcnt lgkmcnt(4)
ldt a[224:225],v7
bld v8,s[8:11],s31 offen nt lds
mma a[24:27],a[252:255],v[56:59],a[24:27]
ldt a[226:227],v7 offset:6144
v_add_f32 v24, v24, v36
cvt v194,v36,v37
mma a[20:23],a[252:255],v[52:55],a[20:23]
v_exp_f32 v36, v184
mma a[20:23],a[248:251],v[244:247],a[20:23]
ldt a[228:229],v7 offset:12288
bld v9,s[8:11],s31 offen offset:1024 nt lds
mma a[16:19],a[248:251],v[240:243],a[16:19]
ldt a[230:231],v7 offset:18432
v_add_f32 v24, v24, v37
v_add_f32 v24, v24, v38
mma a[16:19],a[252:255],v[48:51],a[16:19]
s_waitcnt lgkmcnt(6)
v_exp_f32 v37, v185
mma a[32:35],a[216:219],v[240:243],a[32:35]
s_waitcnt lgkmcnt(4)
ldt a[232:233],v4 offset:128
bld v10,s[8:11],s31 offen offset:2048 nt lds
mma a[32:35],a[220:223],v[48:51],a[32:35]
s_mov_b32 m0, 30720
ldt a[234:235],v4 offset:6272
cvt v195,v38,v39
v_add_f32 v24, v24, v39
mma a[36:39],a[220:223],v[52:55],a[36:39]
s_mov_b32 s31, 310272
bld v8,s[8:11],s31 offen nt lds
v_add_f32 v25, v25, v32
mma a[36:39],a[216:219],v[244:247],a[36:39]
ldt a[236:237],v4 offset:12416
v_exp_f32 v38, v186
mma a[40:43],a[216:219],v[248:251],a[40:43]
ldt a[238:239],v4 offset:18560
v_exp_f32 v39, v187
mma a[40:43],a[220:223],v[56:59],a[40:43]
s_waitcnt lgkmcnt(6)
bld v9,s[8:11],s31 offen offset:1024 nt lds
mma a[56:59],a[224:227],v[248:251],a[56:59]
s_waitcnt lgkmcnt(4)
ldt a[240:241],v5 offset:128
cvt v198,v32,v33
mma a[56:59],a[228:231],v[56:59],a[56:59]
ldt a[242:243],v5 offset:6272
v_add_f32 v25, v25, v33
mma a[52:55],a[228:231],v[52:55],a[52:55]
bld v10,s[8:11],s31 offen offset:2048 nt lds
v_add_f32 v25, v25, v34
mma a[52:55],a[224:227],v[244:247],a[52:55]
ldt a[244:245],v5 offset:12416
cvt v199,v34,v35
v_add_f32 v25, v25, v35
mma a[48:51],a[224:227],v[240:243],a[48:51]
s_mov_b32 m0, 33792
ldt a[246:247],v5 offset:18560
v_add_f32 v26, v26, v36
mma a[48:51],a[228:231],v[48:51],a[48:51]
s_mov_b32 s31, 279552
s_waitcnt lgkmcnt(6)
bld v8,s[8:11],s31 offen nt lds
cvt v202,v36,v37
mma a[64:67],a[232:235],v[240:243],a[64:67]
s_waitcnt lgkmcnt(4)
v_add_f32 v26, v26, v37
v_add_f32 v26, v26, v38
mma a[64:67],a[236:239],v[48:51],a[64:67]
cvt v203,v38,v39
mma a[68:71],a[236:239],v[52:55],a[68:71]
bld v9,s[8:11],s31 offen offset:1024 nt lds
v_add_f32 v26, v26, v39
mma a[68:71],a[232:235],v[244:247],a[68:71]
v_max3_f32 v40, v24, v25, v26
mma a[72:75],a[232:235],v[248:251],a[72:75]
v_cmp_nge_f32 vcc, s34, v40
mma a[72:75],a[236:239],v[56:59],a[72:75]
s_waitcnt lgkmcnt(2)
mma a[88:91],a[240:243],v[248:251],a[88:91]
s_waitcnt lgkmcnt(0)
v_add_u32 v2, s36, v2
mma a[88:91],a[244:247],v[56:59],a[88:91]
v_add_u32 v3, s36, v3
mma a[84:87],a[244:247],v[52:55],a[84:87]
s_waitcnt vmcnt(47)
s_barrier
mma a[84:87],a[240:243],v[244:247],a[84:87]
mma a[80:83],a[240:243],v[240:243],a[80:83]
mma a[80:83],a[244:247],v[48:51],a[80:83]
s_cbranch_vccnz L_w3_tr20
L_w3_tr20_ret:
mma v[160:163],a[192:195],v[64:67],v[224:227]
s_mov_b32 m0, 33792
s_mov_b32 s31, 279552
ldq a[216:219],v2
bld v10,s[8:11],s31 offen offset:2048 nt lds
mma v[160:163],a[196:199],v[68:71],v[160:163]
s_mov_b32 m0, 36864
ldq a[220:223],v3
v_add_f32 v28, v28, v24
v_add_f32 v29, v29, v25
mma v[160:163],a[200:203],v[72:75],v[160:163]
s_mov_b32 s31, 313344
ldq a[224:227],v2 offset:128
bld v8,s[8:11],s31 offen nt lds
mma v[160:163],a[204:207],v[76:79],v[160:163]
ldq a[228:231],v3 offset:128
v_add_f32 v30, v30, v26
mma v[160:163],a[208:211],v[80:83],v[160:163]
ldq a[232:235],v2 offset:256
mma v[160:163],a[212:215],v[84:87],v[160:163]
ldq a[236:239],v3 offset:256
bld v9,s[8:11],s31 offen offset:1024 nt lds
mma v[164:167],a[212:215],v[108:111],v[228:231]
mma v[164:167],a[208:211],v[104:107],v[164:167]
s_add_u32 s37, s37, 1
mma v[164:167],a[204:207],v[100:103],v[164:167]
s_cmp_eq_u32 s37, 7
s_cselect_b32 s36, 4294893568, s43
s_cselect_b32 s37, 0, s37
s_mov_b32 m0, 135168
s_mov_b32 s31, 297984
bld v8,s[12:15],s31 offen nt lds
mma v[164:167],a[200:203],v[96:99],v[164:167]
v_exp_f32 v32, v160
mma v[164:167],a[196:199],v[92:95],v[164:167]
v_exp_f32 v33, v161
mma v[164:167],a[192:195],v[88:91],v[164:167]
bld v9,s[12:15],s31 offen offset:1024 nt lds
v_add_f32 v24, v32, v33
mma v[168:171],a[192:195],v[112:115],v[232:235]
v_exp_f32 v34, v162
cvt v208,v32,v33
mma v[168:171],a[196:199],v[116:119],v[168:171]
v_exp_f32 v35, v163
v_add_f32 v24, v24, v34
mma v[168:171],a[200:203],v[120:123],v[168:171]
bld v10,s[12:15],s31 offen offset:2048 nt lds
cvt v209,v34,v35
mma v[168:171],a[204:207],v[124:127],v[168:171]
v_exp_f32 v36, v164
v_add_f32 v24, v24, v35
mma v[168:171],a[208:211],v[128:131],v[168:171]
s_mov_b32 m0, 138240
v_exp_f32 v37, v165
mma v[168:171],a[212:215],v[132:135],v[168:171]
s_mov_b32 s31, 267264
s_waitcnt lgkmcnt(5)
bld v8,s[12:15],s31 offen nt lds
v_add_f32 v25, v36, v37
mma v[176:179],a[216:219],v[64:67],v[224:227]
s_waitcnt lgkmcnt(4)
v_exp_f32 v38, v166
cvt v212,v36,v37
mma v[176:179],a[220:223],v[68:71],v[176:179]
s_waitcnt lgkmcnt(3)
ldq a[192:195],v2 offset:6144
v_exp_f32 v39, v167
mma v[176:179],a[224:227],v[72:75],v[176:179]
s_waitcnt lgkmcnt(3)
ldq a[196:199],v3 offset:6144
bld v9,s[12:15],s31 offen offset:1024 nt lds
mma v[176:179],a[228:231],v[76:79],v[176:179]
s_waitcnt lgkmcnt(3)
ldq a[200:203],v2 offset:6272
v_exp_f32 v32, v168
mma v[176:179],a[232:235],v[80:83],v[176:179]
s_waitcnt lgkmcnt(3)
ldq a[204:207],v3 offset:6272
v_exp_f32 v33, v169
mma v[176:179],a[236:239],v[84:87],v[176:179]
ldq a[208:211],v2 offset:6400
bld v10,s[12:15],s31 offen offset:2048 nt lds
mma v[180:183],a[236:239],v[108:111],v[228:231]
ldq a[212:215],v3 offset:6400
ldt a[240:241],v6 offset:128
v_add_f32 v25, v25, v38
mma v[180:183],a[232:235],v[104:107],v[180:183]
s_mov_b32 m0, 141312
ldt a[242:243],v6 offset:6272
v_exp_f32 v34, v170
mma v[180:183],a[228:231],v[100:103],v[180:183]
s_mov_b32 s31, 301056
bld v8,s[12:15],s31 offen nt lds
cvt v213,v38,v39
mma v[180:183],a[224:227],v[96:99],v[180:183]
ldt a[244:245],v6 offset:12416
v_exp_f32 v35, v171
mma v[180:183],a[220:223],v[92:95],v[180:183]
ldt a[246:247],v6 offset:18560
v_exp_f32 v36, v176
mma v[180:183],a[216:219],v[88:91],v[180:183]
bld v9,s[12:15],s31 offen offset:1024 nt lds
v_add_f32 v25, v25, v39
mma v[184:187],a[216:219],v[112:115],v[232:235]
ldt a[248:249],v7 offset:128
v_exp_f32 v37, v177
mma v[184:187],a[220:223],v[116:119],v[184:187]
ldt a[250:251],v7 offset:6272
v_exp_f32 v38, v178
mma v[184:187],a[224:227],v[120:123],v[184:187]
bld v10,s[12:15],s31 offen offset:2048 nt lds
v_add_f32 v26, v32, v33
mma v[184:187],a[228:231],v[124:127],v[184:187]
ldt a[252:253],v7 offset:12416
v_exp_f32 v39, v179
mma v[184:187],a[232:235],v[128:131],v[184:187]
s_mov_b32 m0, 144384
ldt a[254:255],v7 offset:18560
cvt v216,v32,v33
v_add_f32 v26, v26, v34
mma v[184:187],a[236:239],v[132:135],v[184:187]
s_mov_b32 s31, 270336
s_waitcnt lgkmcnt(6)
bld v8,s[12:15],s31 offen nt lds
cvt v217,v34,v35
mma a[96:99],a[240:243],v[240:243],a[96:99]
s_waitcnt lgkmcnt(4)
ldt a[216:217],v4 offset:256
v_exp_f32 v32, v180
mma a[96:99],a[244:247],v[48:51],a[96:99]
ldt a[218:219],v4 offset:6400
v_exp_f32 v33, v181
mma a[100:103],a[244:247],v[52:55],a[100:103]
bld v9,s[12:15],s31 offen offset:1024 nt lds
v_add_f32 v26, v26, v35
mma a[100:103],a[240:243],v[244:247],a[100:103]
ldt a[220:221],v4 offset:12544
v_exp_f32 v34, v182
mma a[104:107],a[240:243],v[248:251],a[104:107]
ldt a[222:223],v4 offset:18688
v_exp_f32 v35, v183
mma a[104:107],a[244:247],v[56:59],a[104:107]
s_waitcnt lgkmcnt(6)
bld v10,s[12:15],s31 offen offset:2048 nt lds
v_add_f32 v24, v24, v36
mma a[120:123],a[248:251],v[248:251],a[120:123]
s_waitcnt lgkmcnt(4)
ldt a[224:225],v5 offset:256
cvt v210,v36,v37
mma a[120:123],a[252:255],v[56:59],a[120:123]
s_mov_b32 m0, 147456
ldt a[226:227],v5 offset:6400
v_exp_f32 v36, v184
mma a[116:119],a[252:255],v[52:55],a[116:119]
s_mov_b32 s31, 304128
bld v8,s[12:15],s31 offen nt lds
v_add_f32 v24, v24, v37
mma a[116:119],a[248:251],v[244:247],a[116:119]
ldt a[228:229],v5 offset:12544
v_exp_f32 v37, v185
mma a[112:115],a[248:251],v[240:243],a[112:115]
ldt a[230:231],v5 offset:18688
mma a[112:115],a[252:255],v[48:51],a[112:115]
s_waitcnt lgkmcnt(6)
bld v9,s[12:15],s31 offen offset:1024 nt lds
v_add_f32 v24, v24, v38
mma a[128:131],a[216:219],v[240:243],a[128:131]
s_waitcnt lgkmcnt(4)
ldt a[232:233],v6 offset:256
cvt v211,v38,v39
mma a[128:131],a[220:223],v[48:51],a[128:131]
ldt a[234:235],v6 offset:6400
v_exp_f32 v38, v186
mma a[132:135],a[220:223],v[52:55],a[132:135]
bld v10,s[12:15],s31 offen offset:2048 nt lds
v_add_f32 v24, v24, v39
mma a[132:135],a[216:219],v[244:247],a[132:135]
ldt a[236:237],v6 offset:12544
v_exp_f32 v39, v187
mma a[136:139],a[216:219],v[248:251],a[136:139]
s_mov_b32 m0, 150528
ldt a[238:239],v6 offset:18688
mma a[136:139],a[220:223],v[56:59],a[136:139]
s_mov_b32 s31, 273408
s_waitcnt lgkmcnt(6)
bld v8,s[12:15],s31 offen nt lds
v_add_f32 v25, v25, v32
mma a[152:155],a[224:227],v[248:251],a[152:155]
s_waitcnt lgkmcnt(4)
ldt a[240:241],v7 offset:256
cvt v214,v32,v33
v_add_f32 v25, v25, v33
mma a[152:155],a[228:231],v[56:59],a[152:155]
ldt a[242:243],v7 offset:6400
v_add_f32 v25, v25, v34
mma a[148:151],a[228:231],v[52:55],a[148:151]
bld v9,s[12:15],s31 offen offset:1024 nt lds
cvt v215,v34,v35
mma a[148:151],a[224:227],v[244:247],a[148:151]
ldt a[244:245],v7 offset:12544
v_add_f32 v25, v25, v35
mma a[144:147],a[224:227],v[240:243],a[144:147]
ldt a[246:247],v7 offset:18688
v_add_f32 v26, v26, v36
mma a[144:147],a[228:231],v[48:51],a[144:147]
s_waitcnt lgkmcnt(6)
bld v10,s[12:15],s31 offen offset:2048 nt lds
cvt v218,v36,v37
mma a[160:163],a[232:235],v[240:243],a[160:163]
s_waitcnt lgkmcnt(4)
v_add_f32 v26, v26, v37
v_add_f32 v26, v26, v38
mma a[160:163],a[236:239],v[48:51],a[160:163]
s_mov_b32 m0, 153600
cvt v219,v38,v39
mma a[164:167],a[236:239],v[52:55],a[164:167]
s_mov_b32 s31, 307200
bld v8,s[12:15],s31 offen nt lds
v_add_f32 v26, v26, v39
mma a[164:167],a[232:235],v[244:247],a[164:167]
v_max3_f32 v40, v24, v25, v26
mma a[168:171],a[232:235],v[248:251],a[168:171]
v_cmp_nge_f32 vcc, s34, v40
mma a[168:171],a[236:239],v[56:59],a[168:171]
s_waitcnt lgkmcnt(2)
mma a[184:187],a[240:243],v[248:251],a[184:187]
s_waitcnt lgkmcnt(0)
v_add_u32 v2, s36, v2
mma a[184:187],a[244:247],v[56:59],a[184:187]
v_add_u32 v3, s36, v3
mma a[180:183],a[244:247],v[52:55],a[180:183]
s_waitcnt vmcnt(33)
s_barrier
mma a[180:183],a[240:243],v[244:247],a[180:183]
s_add_u32 s40, s40, 1
mma a[176:179],a[240:243],v[240:243],a[176:179]
s_cmp_eq_u32 s40, 3
s_cselect_b32 s39, 4294918144, s42
s_cselect_b32 s40, 0, s40
mma a[176:179],a[244:247],v[48:51],a[176:179]
s_cbranch_vccnz L_w3_tr21
L_w3_tr21_ret:
mma v[160:163],a[192:195],v[64:67],v[224:227]
s_mov_b32 m0, 153600
s_mov_b32 s31, 307200
ldq a[216:219],v2
bld v9,s[12:15],s31 offen offset:1024 nt lds
mma v[160:163],a[196:199],v[68:71],v[160:163]
ldq a[220:223],v3
v_add_f32 v28, v28, v24
v_add_f32 v29, v29, v25
mma v[160:163],a[200:203],v[72:75],v[160:163]
ldq a[224:227],v2 offset:128
bld v10,s[12:15],s31 offen offset:2048 nt lds
mma v[160:163],a[204:207],v[76:79],v[160:163]
ldq a[228:231],v3 offset:128
v_add_f32 v30, v30, v26
v_add_u32 v4, s39, v4
mma v[160:163],a[208:211],v[80:83],v[160:163]
s_mov_b32 m0, 156672
ldq a[232:235],v2 offset:256
v_add_u32 v5, s39, v5
v_add_u32 v6, s39, v6
mma v[160:163],a[212:215],v[84:87],v[160:163]
s_mov_b32 s31, 276480
ldq a[236:239],v3 offset:256
bld v8,s[12:15],s31 offen nt lds
mma v[164:167],a[212:215],v[108:111],v[228:231]
v_add_u32 v7, s39, v7
mma v[164:167],a[208:211],v[104:107],v[164:167]
s_add_u32 s37, s37, 1
mma v[164:167],a[204:207],v[100:103],v[164:167]
s_cmp_eq_u32 s37, 7
s_cselect_b32 s36, 4294893568, s43
s_cselect_b32 s37, 0, s37
bld v9,s[12:15],s31 offen offset:1024 nt lds
mma v[164:167],a[200:203],v[96:99],v[164:167]
v_exp_f32 v32, v160
mma v[164:167],a[196:199],v[92:95],v[164:167]
v_exp_f32 v33, v161
mma v[164:167],a[192:195],v[88:91],v[164:167]
bld v10,s[12:15],s31 offen offset:2048 nt lds
v_add_f32 v24, v32, v33
mma v[168:171],a[192:195],v[112:115],v[232:235]
v_exp_f32 v34, v162
cvt v240,v32,v33
mma v[168:171],a[196:199],v[116:119],v[168:171]
s_mov_b32 m0, 36864
v_exp_f32 v35, v163
v_add_f32 v24, v24, v34
mma v[168:171],a[200:203],v[120:123],v[168:171]
s_mov_b32 s31, 313344
bld v10,s[8:11],s31 offen offset:2048 nt lds
cvt v241,v34,v35
mma v[168:171],a[204:207],v[124:127],v[168:171]
s_mov_b32 m0, 39936
v_exp_f32 v36, v164
v_add_f32 v24, v24, v35
mma v[168:171],a[208:211],v[128:131],v[168:171]
s_mov_b32 s31, 282624
bld v8,s[8:11],s31 offen nt lds
mma v[168:171],a[212:215],v[132:135],v[168:171]
s_waitcnt lgkmcnt(5)
v_exp_f32 v37, v165
mma v[176:179],a[216:219],v[64:67],v[224:227]
s_waitcnt lgkmcnt(4)
v_exp_f32 v38, v166
v_add_f32 v25, v36, v37
mma v[176:179],a[220:223],v[68:71],v[176:179]
s_waitcnt lgkmcnt(3)
ldq a[192:195],v2 offset:6144
bld v9,s[8:11],s31 offen offset:1024 nt lds
mma v[176:179],a[224:227],v[72:75],v[176:179]
s_waitcnt lgkmcnt(3)
ldq a[196:199],v3 offset:6144
v_exp_f32 v39, v167
mma v[176:179],a[228:231],v[76:79],v[176:179]
s_waitcnt lgkmcnt(3)
ldq a[200:203],v2 offset:6272
v_exp_f32 v32, v168
mma v[176:179],a[232:235],v[80:83],v[176:179]
s_waitcnt lgkmcnt(3)
ldq a[204:207],v3 offset:6272
bld v10,s[8:11],s31 offen offset:2048 nt lds
mma v[176:179],a[236:239],v[84:87],v[176:179]
ldq a[208:211],v2 offset:6400
v_exp_f32 v33, v169
mma v[180:183],a[236:239],v[108:111],v[228:231]
s_mov_b32 m0, 43008
ldq a[212:215],v3 offset:6400
ldt a[240:241],v4
cvt v244,v36,v37
mma v[180:183],a[232:235],v[104:107],v[180:183]
s_mov_b32 s31, 316416
ldt a[242:243],v4 offset:6144
bld v8,s[8:11],s31 offen nt lds
mma v[180:183],a[228:231],v[100:103],v[180:183]
v_exp_f32 v34, v170
v_add_f32 v25, v25, v38
mma v[180:183],a[224:227],v[96:99],v[180:183]
ldt a[244:245],v4 offset:12288
v_exp_f32 v35, v171
mma v[180:183],a[220:223],v[92:95],v[180:183]
ldt a[246:247],v4 offset:18432
bld v9,s[8:11],s31 offen offset:1024 nt lds
mma v[180:183],a[216:219],v[88:91],v[180:183]
v_exp_f32 v36, v176
cvt v245,v38,v39
mma v[184:187],a[216:219],v[112:115],v[232:235]
ldt a[248:249],v5
v_exp_f32 v37, v177
mma v[184:187],a[220:223],v[116:119],v[184:187]
ldt a[250:251],v5 offset:6144
bld v10,s[8:11],s31 offen offset:2048 nt lds
mma v[184:187],a[224:227],v[120:123],v[184:187]
s_mov_b32 m0, 46080
v_exp_f32 v38, v178
v_add_f32 v25, v25, v39
mma v[184:187],a[228:231],v[124:127],v[184:187]
s_mov_b32 s31, 285696
ldt a[252:253],v5 offset:12288
bld v8,s[8:11],s31 offen nt lds
mma v[184:187],a[232:235],v[128:131],v[184:187]
ldt a[254:255],v5 offset:18432
v_exp_f32 v39, v179
mma v[184:187],a[236:239],v[132:135],v[184:187]
s_waitcnt lgkmcnt(6)
v_add_f32 v26, v32, v33
cvt v248,v32,v33
v_add_f32 v26, v26, v34
mma a[0:3],a[240:243],v[192:195],a[0:3]
s_waitcnt lgkmcnt(4)
ldt a[216:217],v6
bld v9,s[8:11],s31 offen offset:1024 nt lds
mma a[0:3],a[244:247],v[208:211],a[0:3]
ldt a[218:219],v6 offset:6144
v_exp_f32 v32, v180
mma a[4:7],a[244:247],v[212:215],a[4:7]
v_exp_f32 v33, v181
cvt v249,v34,v35
mma a[4:7],a[240:243],v[196:199],a[4:7]
ldt a[220:221],v6 offset:12288
bld v10,s[8:11],s31 offen offset:2048 nt lds
mma a[8:11],a[240:243],v[200:203],a[8:11]
ldt a[222:223],v6 offset:18432
v_exp_f32 v34, v182
mma a[8:11],a[244:247],v[216:219],a[8:11]
s_mov_b32 m0, 49152
s_waitcnt lgkmcnt(6)
v_add_f32 v26, v26, v35
v_exp_f32 v35, v183
mma a[24:27],a[248:251],v[200:203],a[24:27]
s_mov_b32 s31, 319488
s_waitcnt lgkmcnt(4)
ldt a[224:225],v7
bld v8,s[8:11],s31 offen nt lds
mma a[24:27],a[252:255],v[216:219],a[24:27]
ldt a[226:227],v7 offset:6144
v_add_f32 v24, v24, v36
cvt v242,v36,v37
mma a[20:23],a[252:255],v[212:215],a[20:23]
v_exp_f32 v36, v184
mma a[20:23],a[248:251],v[196:199],a[20:23]
ldt a[228:229],v7 offset:12288
bld v9,s[8:11],s31 offen offset:1024 nt lds
mma a[16:19],a[248:251],v[192:195],a[16:19]
ldt a[230:231],v7 offset:18432
v_add_f32 v24, v24, v37
v_add_f32 v24, v24, v38
mma a[16:19],a[252:255],v[208:211],a[16:19]
s_waitcnt lgkmcnt(6)
v_exp_f32 v37, v185
mma a[32:35],a[216:219],v[192:195],a[32:35]
s_waitcnt lgkmcnt(4)
ldt a[232:233],v4 offset:128
bld v10,s[8:11],s31 offen offset:2048 nt lds
mma a[32:35],a[220:223],v[208:211],a[32:35]
s_mov_b32 m0, 52224
ldt a[234:235],v4 offset:6272
cvt v243,v38,v39
v_add_f32 v24, v24, v39
mma a[36:39],a[220:223],v[212:215],a[36:39]
s_mov_b32 s31, 288768
bld v8,s[8:11],s31 offen nt lds
v_add_f32 v25, v25, v32
mma a[36:39],a[216:219],v[196:199],a[36:39]
ldt a[236:237],v4 offset:12416
v_exp_f32 v38, v186
mma a[40:43],a[216:219],v[200:203],a[40:43]
ldt a[238:239],v4 offset:18560
v_exp_f32 v39, v187
mma a[40:43],a[220:223],v[216:219],a[40:43]
s_waitcnt lgkmcnt(6)
bld v9,s[8:11],s31 offen offset:1024 nt lds
mma a[56:59],a[224:227],v[200:203],a[56:59]
s_waitcnt lgkmcnt(4)
ldt a[240:241],v5 offset:128
cvt v246,v32,v33
mma a[56:59],a[228:231],v[216:219],a[56:59]
ldt a[242:243],v5 offset:6272
v_add_f32 v25, v25, v33
mma a[52:55],a[228:231],v[212:215],a[52:55]
bld v10,s[8:11],s31 offen offset:2048 nt lds
v_add_f32 v25, v25, v34
mma a[52:55],a[224:227],v[196:199],a[52:55]
ldt a[244:245],v5 offset:12416
cvt v247,v34,v35
v_add_f32 v25, v25, v35
mma a[48:51],a[224:227],v[192:195],a[48:51]
s_mov_b32 m0, 55296
ldt a[246:247],v5 offset:18560
v_add_f32 v26, v26, v36
mma a[48:51],a[228:231],v[208:211],a[48:51]
s_mov_b32 s31, 322560
s_waitcnt lgkmcnt(6)
bld v8,s[8:11],s31 offen nt lds
cvt v250,v36,v37
mma a[64:67],a[232:235],v[192:195],a[64:67]
s_waitcnt lgkmcnt(4)
v_add_f32 v26, v26, v37
v_add_f32 v26, v26, v38
mma a[64:67],a[236:239],v[208:211],a[64:67]
cvt v251,v38,v39
mma a[68:71],a[236:239],v[212:215],a[68:71]
bld v9,s[8:11],s31 offen offset:1024 nt lds
v_add_f32 v26, v26, v39
mma a[68:71],a[232:235],v[196:199],a[68:71]
v_max3_f32 v40, v24, v25, v26
mma a[72:75],a[232:235],v[200:203],a[72:75]
v_cmp_nge_f32 vcc, s34, v40
mma a[72:75],a[236:239],v[216:219],a[72:75]
s_waitcnt lgkmcnt(2)
mma a[88:91],a[240:243],v[200:203],a[88:91]
s_waitcnt lgkmcnt(0)
v_add_u32 v2, s36, v2
mma a[88:91],a[244:247],v[216:219],a[88:91]
v_add_u32 v3, s36, v3
mma a[84:87],a[244:247],v[212:215],a[84:87]
s_waitcnt vmcnt(44)
s_barrier
mma a[84:87],a[240:243],v[196:199],a[84:87]
mma a[80:83],a[240:243],v[192:195],a[80:83]
mma a[80:83],a[244:247],v[208:211],a[80:83]
s_cbranch_vccnz L_w3_tr22
L_w3_tr22_ret:
mma v[160:163],a[192:195],v[64:67],v[224:227]
s_mov_b32 m0, 55296
s_mov_b32 s31, 322560
ldq a[216:219],v2
bld v10,s[8:11],s31 offen offset:2048 nt lds
mma v[160:163],a[196:199],v[68:71],v[160:163]
s_mov_b32 m0, 58368
ldq a[220:223],v3
v_add_f32 v28, v28, v24
v_add_f32 v29, v29, v25
mma v[160:163],a[200:203],v[72:75],v[160:163]
s_mov_b32 s31, 291840
ldq a[224:227],v2 offset:128
bld v8,s[8:11],s31 offen nt lds
mma v[160:163],a[204:207],v[76:79],v[160:163]
ldq a[228:231],v3 offset:128
v_add_f32 v30, v30, v26
mma v[160:163],a[208:211],v[80:83],v[160:163]
ldq a[232:235],v2 offset:256
mma v[160:163],a[212:215],v[84:87],v[160:163]
ldq a[236:239],v3 offset:256
bld v9,s[8:11],s31 offen offset:1024 nt lds
mma v[164:167],a[212:215],v[108:111],v[228:231]
mma v[164:167],a[208:211],v[104:107],v[164:167]
s_add_u32 s37, s37, 1
mma v[164:167],a[204:207],v[100:103],v[164:167]
s_cmp_eq_u32 s37, 7
s_cselect_b32 s36, 4294893568, s43
s_cselect_b32 s37, 0, s37
bld v10,s[8:11],s31 offen offset:2048 nt lds
mma v[164:167],a[200:203],v[96:99],v[164:167]
v_exp_f32 v32, v160
mma v[164:167],a[196:199],v[92:95],v[164:167]
s_mov_b32 m0, 61440
v_exp_f32 v33, v161
mma v[164:167],a[192:195],v[88:91],v[164:167]
s_mov_b32 s31, 325632
bld v8,s[8:11],s31 offen nt lds
v_add_f32 v24, v32, v33
mma v[168:171],a[192:195],v[112:115],v[232:235]
v_exp_f32 v34, v162
cvt v48,v32,v33
mma v[168:171],a[196:199],v[116:119],v[168:171]
v_exp_f32 v35, v163
v_add_f32 v24, v24, v34
mma v[168:171],a[200:203],v[120:123],v[168:171]
bld v9,s[8:11],s31 offen offset:1024 nt lds
cvt v49,v34,v35
mma v[168:171],a[204:207],v[124:127],v[168:171]
v_exp_f32 v36, v164
v_add_f32 v24, v24, v35
mma v[168:171],a[208:211],v[128:131],v[168:171]
s_mov_b32 m0, 86016
v_exp_f32 v37, v165
mma v[168:171],a[212:215],v[132:135],v[168:171]
s_mov_b32 s31, 310272
s_waitcnt lgkmcnt(5)
bld v8,s[12:15],s31 offen nt lds
v_add_f32 v25, v36, v37
mma v[176:179],a[216:219],v[64:67],v[224:227]
s_waitcnt lgkmcnt(4)
v_exp_f32 v38, v166
cvt v52,v36,v37
mma v[176:179],a[220:223],v[68:71],v[176:179]
s_waitcnt lgkmcnt(3)
ldq a[192:195],v2 offset:6144
v_exp_f32 v39, v167
mma v[176:179],a[224:227],v[72:75],v[176:179]
s_waitcnt lgkmcnt(3)
ldq a[196:199],v3 offset:6144
bld v9,s[12:15],s31 offen offset:1024 nt lds
mma v[176:179],a[228:231],v[76:79],v[176:179]
s_waitcnt lgkmcnt(3)
ldq a[200:203],v2 offset:6272
v_exp_f32 v32, v168
mma v[176:179],a[232:235],v[80:83],v[176:179]
s_waitcnt lgkmcnt(3)
ldq a[204:207],v3 offset:6272
v_exp_f32 v33, v169
mma v[176:179],a[236:239],v[84:87],v[176:179]
ldq a[208:211],v2 offset:6400
bld v10,s[12:15],s31 offen offset:2048 nt lds
mma v[180:183],a[236:239],v[108:111],v[228:231]
ldq a[212:215],v3 offset:6400
ldt a[240:241],v6 offset:128
v_add_f32 v25, v25, v38
mma v[180:183],a[232:235],v[104:107],v[180:183]
s_mov_b32 m0, 89088
ldt a[242:243],v6 offset:6272
v_exp_f32 v34, v170
mma v[180:183],a[228:231],v[100:103],v[180:183]
s_mov_b32 s31, 279552
bld v8,s[12:15],s31 offen nt lds
cvt v53,v38,v39
mma v[180:183],a[224:227],v[96:99],v[180:183]
ldt a[244:245],v6 offset:12416
v_exp_f32 v35, v171
mma v[180:183],a[220:223],v[92:95],v[180:183]
ldt a[246:247],v6 offset:18560
v_exp_f32 v36, v176
mma v[180:183],a[216:219],v[88:91],v[180:183]
bld v9,s[12:15],s31 offen offset:1024 nt lds
v_add_f32 v25, v25, v39
mma v[184:187],a[216:219],v[112:115],v[232:235]
ldt a[248:249],v7 offset:128
v_exp_f32 v37, v177
mma v[184:187],a[220:223],v[116:119],v[184:187]
ldt a[250:251],v7 offset:6272
v_exp_f32 v38, v178
mma v[184:187],a[224:227],v[120:123],v[184:187]
bld v10,s[12:15],s31 offen offset:2048 nt lds
v_add_f32 v26, v32, v33
mma v[184:187],a[228:231],v[124:127],v[184:187]
ldt a[252:253],v7 offset:12416
v_exp_f32 v39, v179
mma v[184:187],a[232:235],v[128:131],v[184:187]
s_mov_b32 m0, 92160
ldt a[254:255],v7 offset:18560
cvt v56,v32,v33
v_add_f32 v26, v26, v34
mma v[184:187],a[236:239],v[132:135],v[184:187]
s_mov_b32 s31, 313344
s_waitcnt lgkmcnt(6)
bld v8,s[12:15],s31 offen nt lds
cvt v57,v34,v35
mma a[96:99],a[240:243],v[192:195],a[96:99]
s_waitcnt lgkmcnt(4)
ldt a[216:217],v4 offset:256
v_exp_f32 v32, v180
mma a[96:99],a[244:247],v[208:211],a[96:99]
ldt a[218:219],v4 offset:6400
v_exp_f32 v33, v181
mma a[100:103],a[244:247],v[212:215],a[100:103]
bld v9,s[12:15],s31 offen offset:1024 nt lds
v_add_f32 v26, v26, v35
mma a[100:103],a[240:243],v[196:199],a[100:103]
ldt a[220:221],v4 offset:12544
v_exp_f32 v34, v182
mma a[104:107],a[240:243],v[200:203],a[104:107]
ldt a[222:223],v4 offset:18688
v_exp_f32 v35, v183
mma a[104:107],a[244:247],v[216:219],a[104:107]
s_waitcnt lgkmcnt(6)
bld v10,s[12:15],s31 offen offset:2048 nt lds
v_add_f32 v24, v24, v36
mma a[120:123],a[248:251],v[200:203],a[120:123]
s_waitcnt lgkmcnt(4)
ldt a[224:225],v5 offset:256
cvt v50,v36,v37
mma a[120:123],a[252:255],v[216:219],a[120:123]
s_mov_b32 m0, 95232
ldt a[226:227],v5 offset:6400
v_exp_f32 v36, v184
mma a[116:119],a[252:255],v[212:215],a[116:119]
s_mov_b32 s31, 282624
bld v8,s[12:15],s31 offen nt lds
v_add_f32 v24, v24, v37
mma a[116:119],a[248:251],v[196:199],a[116:119]
ldt a[228:229],v5 offset:12544
v_exp_f32 v37, v185
mma a[112:115],a[248:251],v[192:195],a[112:115]
ldt a[230:231],v5 offset:18688
mma a[112:115],a[252:255],v[208:211],a[112:115]
s_waitcnt lgkmcnt(6)
bld v9,s[12:15],s31 offen offset:1024 nt lds
v_add_f32 v24, v24, v38
mma a[128:131],a[216:219],v[192:195],a[128:131]
s_waitcnt lgkmcnt(4)
ldt a[232:233],v6 offset:256
cvt v51,v38,v39
mma a[128:131],a[220:223],v[208:211],a[128:131]
ldt a[234:235],v6 offset:6400
v_exp_f32 v38, v186
mma a[132:135],a[220:223],v[212:215],a[132:135]
bld v10,s[12:15],s31 offen offset:2048 nt lds
v_add_f32 v24, v24, v39
mma a[132:135],a[216:219],v[196:199],a[132:135]
ldt a[236:237],v6 offset:12544
v_exp_f32 v39, v187
mma a[136:139],a[216:219],v[200:203],a[136:139]
s_mov_b32 m0, 98304
ldt a[238:239],v6 offset:18688
mma a[136:139],a[220:223],v[216:219],a[136:139]
s_mov_b32 s31, 316416
s_waitcnt lgkmcnt(6)
bld v8,s[12:15],s31 offen nt lds
v_add_f32 v25, v25, v32
mma a[152:155],a[224:227],v[200:203],a[152:155]
s_waitcnt lgkmcnt(4)
ldt a[240:241],v7 offset:256
cvt v54,v32,v33
v_add_f32 v25, v25, v33
mma a[152:155],a[228:231],v[216:219],a[152:155]
ldt a[242:243],v7 offset:6400
v_add_f32 v25, v25, v34
mma a[148:151],a[228:231],v[212:215],a[148:151]
bld v9,s[12:15],s31 offen offset:1024 nt lds
cvt v55,v34,v35
mma a[148:151],a[224:227],v[196:199],a[148:151]
ldt a[244:245],v7 offset:12544
v_add_f32 v25, v25, v35
mma a[144:147],a[224:227],v[192:195],a[144:147]
ldt a[246:247],v7 offset:18688
v_add_f32 v26, v26, v36
mma a[144:147],a[228:231],v[208:211],a[144:147]
s_waitcnt lgkmcnt(6)
bld v10,s[12:15],s31 offen offset:2048 nt lds
cvt v58,v36,v37
mma a[160:163],a[232:235],v[192:195],a[160:163]
s_waitcnt lgkmcnt(4)
v_add_f32 v26, v26, v37
v_add_f32 v26, v26, v38
mma a[160:163],a[236:239],v[208:211],a[160:163]
s_mov_b32 m0, 101376
cvt v59,v38,v39
mma a[164:167],a[236:239],v[212:215],a[164:167]
s_mov_b32 s31, 285696
bld v8,s[12:15],s31 offen nt lds
v_add_f32 v26, v26, v39
mma a[164:167],a[232:235],v[196:199],a[164:167]
v_max3_f32 v40, v24, v25, v26
mma a[168:171],a[232:235],v[200:203],a[168:171]
v_cmp_nge_f32 vcc, s34, v40
mma a[168:171],a[236:239],v[216:219],a[168:171]
s_waitcnt lgkmcnt(2)
mma a[184:187],a[240:243],v[200:203],a[184:187]
s_waitcnt lgkmcnt(0)
v_add_u32 v2, s36, v2
mma a[184:187],a[244:247],v[216:219],a[184:187]
v_add_u32 v3, s36, v3
mma a[180:183],a[244:247],v[212:215],a[180:183]
s_waitcnt vmcnt(30)
s_barrier
mma a[180:183],a[240:243],v[196:199],a[180:183]
s_add_u32 s40, s40, 1
mma a[176:179],a[240:243],v[192:195],a[176:179]
s_cmp_eq_u32 s40, 3
s_cselect_b32 s39, 4294918144, s42
s_cselect_b32 s40, 0, s40
mma a[176:179],a[244:247],v[208:211],a[176:179]
s_cbranch_vccnz L_w3_tr23
L_w3_tr23_ret:
mma v[160:163],a[192:195],v[64:67],v[224:227]
s_mov_b32 m0, 101376
s_mov_b32 s31, 285696
ldq a[216:219],v2
bld v9,s[12:15],s31 offen offset:1024 nt lds
mma v[160:163],a[196:199],v[68:71],v[160:163]
ldq a[220:223],v3
v_add_f32 v28, v28, v24
v_add_f32 v29, v29, v25
mma v[160:163],a[200:203],v[72:75],v[160:163]
ldq a[224:227],v2 offset:128
bld v10,s[12:15],s31 offen offset:2048 nt lds
mma v[160:163],a[204:207],v[76:79],v[160:163]
ldq a[228:231],v3 offset:128
v_add_f32 v30, v30, v26
v_add_u32 v4, s39, v4
mma v[160:163],a[208:211],v[80:83],v[160:163]
s_mov_b32 m0, 104448
ldq a[232:235],v2 offset:256
v_add_u32 v5, s39, v5
v_add_u32 v6, s39, v6
mma v[160:163],a[212:215],v[84:87],v[160:163]
s_mov_b32 s31, 319488
ldq a[236:239],v3 offset:256
bld v8,s[12:15],s31 offen nt lds
mma v[164:167],a[212:215],v[108:111],v[228:231]
v_add_u32 v7, s39, v7
mma v[164:167],a[208:211],v[104:107],v[164:167]
s_add_u32 s37, s37, 1
mma v[164:167],a[204:207],v[100:103],v[164:167]
s_cmp_eq_u32 s37, 7
s_cselect_b32 s36, 4294893568, s43
s_cselect_b32 s37, 0, s37
bld v9,s[12:15],s31 offen offset:1024 nt lds
mma v[164:167],a[200:203],v[96:99],v[164:167]
v_exp_f32 v32, v160
mma v[164:167],a[196:199],v[92:95],v[164:167]
v_exp_f32 v33, v161
mma v[164:167],a[192:195],v[88:91],v[164:167]
bld v10,s[12:15],s31 offen offset:2048 nt lds
v_add_f32 v24, v32, v33
mma v[168:171],a[192:195],v[112:115],v[232:235]
v_exp_f32 v34, v162
cvt v192,v32,v33
mma v[168:171],a[196:199],v[116:119],v[168:171]
s_mov_b32 m0, 107520
v_exp_f32 v35, v163
v_add_f32 v24, v24, v34
mma v[168:171],a[200:203],v[120:123],v[168:171]
s_mov_b32 s31, 288768
bld v8,s[12:15],s31 offen nt lds
cvt v193,v34,v35
mma v[168:171],a[204:207],v[124:127],v[168:171]
v_exp_f32 v36, v164
v_add_f32 v24, v24, v35
mma v[168:171],a[208:211],v[128:131],v[168:171]
v_exp_f32 v37, v165
mma v[168:171],a[212:215],v[132:135],v[168:171]
s_waitcnt lgkmcnt(5)
bld v9,s[12:15],s31 offen offset:1024 nt lds
v_add_f32 v25, v36, v37
mma v[176:179],a[216:219],v[64:67],v[224:227]
s_waitcnt lgkmcnt(4)
v_exp_f32 v38, v166
cvt v196,v36,v37
mma v[176:179],a[220:223],v[68:71],v[176:179]
s_waitcnt lgkmcnt(3)
ldq a[192:195],v2 offset:6144
v_exp_f32 v39, v167
mma v[176:179],a[224:227],v[72:75],v[176:179]
s_waitcnt lgkmcnt(3)
ldq a[196:199],v3 offset:6144
bld v10,s[12:15],s31 offen offset:2048 nt lds
mma v[176:179],a[228:231],v[76:79],v[176:179]
s_waitcnt lgkmcnt(3)
ldq a[200:203],v2 offset:6272
v_exp_f32 v32, v168
mma v[176:179],a[232:235],v[80:83],v[176:179]
s_mov_b32 m0, 61440
s_waitcnt lgkmcnt(3)
ldq a[204:207],v3 offset:6272
v_exp_f32 v33, v169
mma v[176:179],a[236:239],v[84:87],v[176:179]
s_mov_b32 s31, 325632
ldq a[208:211],v2 offset:6400
bld v10,s[8:11],s31 offen offset:2048 nt lds
mma v[180:183],a[236:239],v[108:111],v[228:231]
ldq a[212:215],v3 offset:6400
ldt a[240:241],v4
v_add_f32 v25, v25, v38
mma v[180:183],a[232:235],v[104:107],v[180:183]
s_mov_b32 m0, 64512
ldt a[242:243],v4 offset:6144
v_exp_f32 v34, v170
mma v[180:183],a[228:231],v[100:103],v[180:183]
s_mov_b32 s31, 328704
bld v8,s[8:11],s31 offen nt lds
cvt v197,v38,v39
mma v[180:183],a[224:227],v[96:99],v[180:183]
ldt a[244:245],v4 offset:12288
v_exp_f32 v35, v171
mma v[180:183],a[220:223],v[92:95],v[180:183]
ldt a[246:247],v4 offset:18432
v_exp_f32 v36, v176
mma v[180:183],a[216:219],v[88:91],v[180:183]
bld v9,s[8:11],s31 offen offset:1024 nt lds
v_add_f32 v25, v25, v39
mma v[184:187],a[216:219],v[112:115],v[232:235]
ldt a[248:249],v5
v_exp_f32 v37, v177
mma v[184:187],a[220:223],v[116:119],v[184:187]
ldt a[250:251],v5 offset:6144
v_exp_f32 v38, v178
mma v[184:187],a[224:227],v[120:123],v[184:187]
bld v10,s[8:11],s31 offen offset:2048 nt lds
v_add_f32 v26, v32, v33
mma v[184:187],a[228:231],v[124:127],v[184:187]
ldt a[252:253],v5 offset:12288
v_exp_f32 v39, v179
mma v[184:187],a[232:235],v[128:131],v[184:187]
s_mov_b32 m0, 67584
ldt a[254:255],v5 offset:18432
cvt v200,v32,v33
v_add_f32 v26, v26, v34
mma v[184:187],a[236:239],v[132:135],v[184:187]
s_mov_b32 s31, 362496
s_waitcnt lgkmcnt(6)
bld v8,s[8:11],s31 offen nt lds
cvt v201,v34,v35
mma a[0:3],a[240:243],v[240:243],a[0:3]
s_waitcnt lgkmcnt(4)
ldt a[216:217],v6
v_exp_f32 v32, v180
mma a[0:3],a[244:247],v[48:51],a[0:3]
ldt a[218:219],v6 offset:6144
v_exp_f32 v33, v181
mma a[4:7],a[244:247],v[52:55],a[4:7]
bld v9,s[8:11],s31 offen offset:1024 nt lds
v_add_f32 v26, v26, v35
mma a[4:7],a[240:243],v[244:247],a[4:7]
ldt a[220:221],v6 offset:12288
v_exp_f32 v34, v182
mma a[8:11],a[240:243],v[248:251],a[8:11]
ldt a[222:223],v6 offset:18432
v_exp_f32 v35, v183
mma a[8:11],a[244:247],v[56:59],a[8:11]
s_waitcnt lgkmcnt(6)
bld v10,s[8:11],s31 offen offset:2048 nt lds
mma a[24:27],a[248:251],v[248:251],a[24:27]
s_waitcnt lgkmcnt(4)
ldt a[224:225],v7
v_add_f32 v24, v24, v36
mma a[24:27],a[252:255],v[56:59],a[24:27]
s_mov_b32 m0, 70656
ldt a[226:227],v7 offset:6144
cvt v194,v36,v37
mma a[20:23],a[252:255],v[52:55],a[20:23]
s_mov_b32 s31, 331776
bld v8,s[8:11],s31 offen nt lds
v_add_f32 v24, v24, v37
mma a[20:23],a[248:251],v[244:247],a[20:23]
ldt a[228:229],v7 offset:12288
v_exp_f32 v36, v184
mma a[16:19],a[248:251],v[240:243],a[16:19]
ldt a[230:231],v7 offset:18432
v_exp_f32 v37, v185
mma a[16:19],a[252:255],v[48:51],a[16:19]
s_waitcnt lgkmcnt(6)
bld v9,s[8:11],s31 offen offset:1024 nt lds
mma a[32:35],a[216:219],v[240:243],a[32:35]
s_waitcnt lgkmcnt(4)
ldt a[232:233],v4 offset:128
v_add_f32 v24, v24, v38
cvt v195,v38,v39
mma a[32:35],a[220:223],v[48:51],a[32:35]
ldt a[234:235],v4 offset:6272
v_exp_f32 v38, v186
mma a[36:39],a[220:223],v[52:55],a[36:39]
bld v10,s[8:11],s31 offen offset:2048 nt lds
mma a[36:39],a[216:219],v[244:247],a[36:39]
ldt a[236:237],v4 offset:12416
v_add_f32 v24, v24, v39
mma a[40:43],a[216:219],v[248:251],a[40:43]
s_mov_b32 m0, 73728
ldt a[238:239],v4 offset:18560
v_exp_f32 v39, v187
mma a[40:43],a[220:223],v[56:59],a[40:43]
s_mov_b32 s31, 365568
s_waitcnt lgkmcnt(6)
bld v8,s[8:11],s31 offen nt lds
v_add_f32 v25, v25, v32
mma a[56:59],a[224:227],v[248:251],a[56:59]
s_waitcnt lgkmcnt(4)
ldt a[240:241],v5 offset:128
cvt v198,v32,v33
mma a[56:59],a[228:231],v[56:59],a[56:59]
ldt a[242:243],v5 offset:6272
v_add_f32 v25, v25, v33
mma a[52:55],a[228:231],v[52:55],a[52:55]
bld v9,s[8:11],s31 offen offset:1024 nt lds
v_add_f32 v25, v25, v34
mma a[52:55],a[224:227],v[244:247],a[52:55]
ldt a[244:245],v5 offset:12416
cvt v199,v34,v35
v_add_f32 v25, v25, v35
mma a[48:51],a[224:227],v[240:243],a[48:51]
ldt a[246:247],v5 offset:18560
v_add_f32 v26, v26, v36
mma a[48:51],a[228:231],v[48:51],a[48:51]
s_waitcnt lgkmcnt(6)
bld v10,s[8:11],s31 offen offset:2048 nt lds
cvt v202,v36,v37
mma a[64:67],a[232:235],v[240:243],a[64:67]
s_waitcnt lgkmcnt(4)
v_add_f32 v26, v26, v37
v_add_f32 v26, v26, v38
mma a[64:67],a[236:239],v[48:51],a[64:67]
s_mov_b32 m0, 76800
cvt v203,v38,v39
mma a[68:71],a[236:239],v[52:55],a[68:71]
s_mov_b32 s31, 334848
bld v8,s[8:11],s31 offen nt lds
v_add_f32 v26, v26, v39
mma a[68:71],a[232:235],v[244:247],a[68:71]
v_max3_f32 v40, v24, v25, v26
mma a[72:75],a[232:235],v[248:251],a[72:75]
v_cmp_nge_f32 vcc, s34, v40
mma a[72:75],a[236:239],v[56:59],a[72:75]
s_waitcnt lgkmcnt(2)
mma a[88:91],a[240:243],v[248:251],a[88:91]
s_waitcnt lgkmcnt(0)
v_add_u32 v2, s36, v2
mma a[88:91],a[244:247],v[56:59],a[88:91]
v_add_u32 v3, s36, v3
mma a[84:87],a[244:247],v[52:55],a[84:87]
s_waitcnt vmcnt(40)
s_barrier
mma a[84:87],a[240:243],v[244:247],a[84:87]
mma a[80:83],a[240:243],v[240:243],a[80:83]
mma a[80:83],a[244:247],v[48:51],a[80:83]
s_cbranch_vccnz L_w3_tr24
L_w3_tr24_ret:
mma v[160:163],a[192:195],v[64:67],v[224:227]
s_mov_b32 m0, 76800
s_mov_b32 s31, 334848
ldq a[216:219],v2
bld v9,s[8:11],s31 offen offset:1024 nt lds
mma v[160:163],a[196:199],v[68:71],v[160:163]
ldq a[220:223],v3
v_add_f32 v28, v28, v24
v_add_f32 v29, v29, v25
mma v[160:163],a[200:203],v[72:75],v[160:163]
ldq a[224:227],v2 offset:128
bld v10,s[8:11],s31 offen offset:2048 nt lds
mma v[160:163],a[204:207],v[76:79],v[160:163]
ldq a[228:231],v3 offset:128
v_add_f32 v30, v30, v26
mma v[160:163],a[208:211],v[80:83],v[160:163]
s_mov_b32 m0, 79872
ldq a[232:235],v2 offset:256
mma v[160:163],a[212:215],v[84:87],v[160:163]
s_mov_b32 s31, 368640
ldq a[236:239],v3 offset:256
bld v8,s[8:11],s31 offen nt lds
mma v[164:167],a[212:215],v[108:111],v[228:231]
mma v[164:167],a[208:211],v[104:107],v[164:167]
s_add_u32 s37, s37, 1
mma v[164:167],a[204:207],v[100:103],v[164:167]
s_cmp_eq_u32 s37, 7
s_cselect_b32 s36, 4294893568, s43
s_cselect_b32 s37, 0, s37
bld v9,s[8:11],s31 offen offset:1024 nt lds
mma v[164:167],a[200:203],v[96:99],v[164:167]
v_exp_f32 v32, v160
mma v[164:167],a[196:199],v[92:95],v[164:167]
v_exp_f32 v33, v161
mma v[164:167],a[192:195],v[88:91],v[164:167]
bld v10,s[8:11],s31 offen offset:2048 nt lds
v_add_f32 v24, v32, v33
mma v[168:171],a[192:195],v[112:115],v[232:235]
v_exp_f32 v34, v162
cvt v208,v32,v33
mma v[168:171],a[196:199],v[116:119],v[168:171]
s_mov_b32 m0, 82944
v_exp_f32 v35, v163
v_add_f32 v24, v24, v34
mma v[168:171],a[200:203],v[120:123],v[168:171]
s_mov_b32 s31, 337920
bld v8,s[8:11],s31 offen nt lds
cvt v209,v34,v35
mma v[168:171],a[204:207],v[124:127],v[168:171]
v_exp_f32 v36, v164
v_add_f32 v24, v24, v35
mma v[168:171],a[208:211],v[128:131],v[168:171]
bld v9,s[8:11],s31 offen offset:1024 nt lds
mma v[168:171],a[212:215],v[132:135],v[168:171]
s_waitcnt lgkmcnt(5)
v_exp_f32 v37, v165
mma v[176:179],a[216:219],v[64:67],v[224:227]
s_waitcnt lgkmcnt(4)
v_exp_f32 v38, v166
v_add_f32 v25, v36, v37
mma v[176:179],a[220:223],v[68:71],v[176:179]
s_waitcnt lgkmcnt(3)
ldq a[192:195],v2 offset:6144
bld v10,s[8:11],s31 offen offset:2048 nt lds
mma v[176:179],a[224:227],v[72:75],v[176:179]
s_waitcnt lgkmcnt(3)
ldq a[196:199],v3 offset:6144
v_exp_f32 v39, v167
mma v[176:179],a[228:231],v[76:79],v[176:179]
s_mov_b32 m0, 0
s_waitcnt lgkmcnt(3)
ldq a[200:203],v2 offset:6272
v_exp_f32 v32, v168
mma v[176:179],a[232:235],v[80:83],v[176:179]
s_mov_b32 s31, 371712
s_waitcnt lgkmcnt(3)
ldq a[204:207],v3 offset:6272
bld v8,s[8:11],s31 offen nt lds
mma v[176:179],a[236:239],v[84:87],v[176:179]
ldq a[208:211],v2 offset:6400
v_exp_f32 v33, v169
mma v[180:183],a[236:239],v[108:111],v[228:231]
ldq a[212:215],v3 offset:6400
ldt a[240:241],v6 offset:128
cvt v212,v36,v37
mma v[180:183],a[232:235],v[104:107],v[180:183]
ldt a[242:243],v6 offset:6272
bld v9,s[8:11],s31 offen offset:1024 nt lds
mma v[180:183],a[228:231],v[100:103],v[180:183]
v_exp_f32 v34, v170
v_add_f32 v25, v25, v38
mma v[180:183],a[224:227],v[96:99],v[180:183]
s_mov_b32 m0, 110592
ldt a[244:245],v6 offset:12416
v_exp_f32 v35, v171
mma v[180:183],a[220:223],v[92:95],v[180:183]
s_mov_b32 s31, 322560
ldt a[246:247],v6 offset:18560
bld v8,s[12:15],s31 offen nt lds
mma v[180:183],a[216:219],v[88:91],v[180:183]
v_exp_f32 v36, v176
cvt v213,v38,v39
mma v[184:187],a[216:219],v[112:115],v[232:235]
ldt a[248:249],v7 offset:128
v_exp_f32 v37, v177
mma v[184:187],a[220:223],v[116:119],v[184:187]
ldt a[250:251],v7 offset:6272
bld v9,s[12:15],s31 offen offset:1024 nt lds
mma v[184:187],a[224:227],v[120:123],v[184:187]
v_exp_f32 v38, v178
v_add_f32 v25, v25, v39
mma v[184:187],a[228:231],v[124:127],v[184:187]
ldt a[252:253],v7 offset:12416
bld v10,s[12:15],s31 offen offset:2048 nt lds
mma v[184:187],a[232:235],v[128:131],v[184:187]
ldt a[254:255],v7 offset:18560
v_exp_f32 v39, v179
mma v[184:187],a[236:239],v[132:135],v[184:187]
s_mov_b32 m0, 113664
s_waitcnt lgkmcnt(6)
v_add_f32 v26, v32, v33
cvt v216,v32,v33
v_add_f32 v26, v26, v34
mma a[96:99],a[240:243],v[240:243],a[96:99]
s_mov_b32 s31, 291840
s_waitcnt lgkmcnt(4)
ldt a[216:217],v4 offset:256
bld v8,s[12:15],s31 offen nt lds
mma a[96:99],a[244:247],v[48:51],a[96:99]
ldt a[218:219],v4 offset:6400
v_exp_f32 v32, v180
mma a[100:103],a[244:247],v[52:55],a[100:103]
v_exp_f32 v33, v181
cvt v217,v34,v35
mma a[100:103],a[240:243],v[244:247],a[100:103]
ldt a[220:221],v4 offset:12544
bld v9,s[12:15],s31 offen offset:1024 nt lds
mma a[104:107],a[240:243],v[248:251],a[104:107]
ldt a[222:223],v4 offset:18688
v_exp_f32 v34, v182
mma a[104:107],a[244:247],v[56:59],a[104:107]
s_waitcnt lgkmcnt(6)
v_add_f32 v26, v26, v35
v_exp_f32 v35, v183
mma a[120:123],a[248:251],v[248:251],a[120:123]
s_waitcnt lgkmcnt(4)
ldt a[224:225],v5 offset:256
bld v10,s[12:15],s31 offen offset:2048 nt lds
mma a[120:123],a[252:255],v[56:59],a[120:123]
ldt a[226:227],v5 offset:6400
v_add_f32 v24, v24, v36
cvt v210,v36,v37
mma a[116:119],a[252:255],v[52:55],a[116:119]
s_mov_b32 m0, 116736
v_exp_f32 v36, v184
v_add_f32 v24, v24, v37
mma a[116:119],a[248:251],v[244:247],a[116:119]
s_mov_b32 s31, 325632
ldt a[228:229],v5 offset:12544
bld v8,s[12:15],s31 offen nt lds
mma a[112:115],a[248:251],v[240:243],a[112:115]
ldt a[230:231],v5 offset:18688
v_exp_f32 v37, v185
mma a[112:115],a[252:255],v[48:51],a[112:115]
s_waitcnt lgkmcnt(6)
v_add_f32 v24, v24, v38
mma a[128:131],a[216:219],v[240:243],a[128:131]
s_waitcnt lgkmcnt(4)
ldt a[232:233],v6 offset:256
bld v9,s[12:15],s31 offen offset:1024 nt lds
mma a[128:131],a[220:223],v[48:51],a[128:131]
ldt a[234:235],v6 offset:6400
cvt v211,v38,v39
v_add_f32 v24, v24, v39
mma a[132:135],a[220:223],v[52:55],a[132:135]
bld v10,s[12:15],s31 offen offset:2048 nt lds
v_add_f32 v25, v25, v32
mma a[132:135],a[216:219],v[244:247],a[132:135]
ldt a[236:237],v6 offset:12544
v_exp_f32 v38, v186
mma a[136:139],a[216:219],v[248:251],a[136:139]
s_mov_b32 m0, 119808
ldt a[238:239],v6 offset:18688
v_exp_f32 v39, v187
mma a[136:139],a[220:223],v[56:59],a[136:139]
s_mov_b32 s31, 328704
s_waitcnt lgkmcnt(6)
bld v8,s[12:15],s31 offen nt lds
mma a[152:155],a[224:227],v[248:251],a[152:155]
s_waitcnt lgkmcnt(4)
ldt a[240:241],v7 offset:256
cvt v214,v32,v33
v_add_f32 v25, v25, v33
mma a[152:155],a[228:231],v[56:59],a[152:155]
ldt a[242:243],v7 offset:6400
v_add_f32 v25, v25, v34
mma a[148:151],a[228:231],v[52:55],a[148:151]
bld v9,s[12:15],s31 offen offset:1024 nt lds
cvt v215,v34,v35
mma a[148:151],a[224:227],v[244:247],a[148:151]
ldt a[244:245],v7 offset:12544
v_add_f32 v25, v25, v35
mma a[144:147],a[224:227],v[240:243],a[144:147]
ldt a[246:247],v7 offset:18688
v_add_f32 v26, v26, v36
mma a[144:147],a[228:231],v[48:51],a[144:147]
s_waitcnt lgkmcnt(6)
bld v10,s[12:15],s31 offen offset:2048 nt lds
cvt v218,v36,v37
mma a[160:163],a[232:235],v[240:243],a[160:163]
s_waitcnt lgkmcnt(4)
v_add_f32 v26, v26, v37
v_add_f32 v26, v26, v38
mma a[160:163],a[236:239],v[48:51],a[160:163]
s_mov_b32 m0, 122880
cvt v219,v38,v39
mma a[164:167],a[236:239],v[52:55],a[164:167]
s_mov_b32 s31, 362496
bld v8,s[12:15],s31 offen nt lds
v_add_f32 v26, v26, v39
mma a[164:167],a[232:235],v[244:247],a[164:167]
v_max3_f32 v40, v24, v25, v26
mma a[168:171],a[232:235],v[248:251],a[168:171]
v_cmp_nge_f32 vcc, s34, v40
mma a[168:171],a[236:239],v[56:59],a[168:171]
s_waitcnt lgkmcnt(2)
mma a[184:187],a[240:243],v[248:251],a[184:187]
s_waitcnt lgkmcnt(0)
v_add_u32 v2, s36, v2
mma a[184:187],a[244:247],v[56:59],a[184:187]
v_add_u32 v3, s36, v3
mma a[180:183],a[244:247],v[52:55],a[180:183]
s_waitcnt vmcnt(27)
s_barrier
mma a[180:183],a[240:243],v[244:247],a[180:183]
s_add_u32 s40, s40, 1
mma a[176:179],a[240:243],v[240:243],a[176:179]
s_cmp_eq_u32 s40, 3
s_cselect_b32 s39, 4294918144, s42
s_cselect_b32 s40, 0, s40
mma a[176:179],a[244:247],v[48:51],a[176:179]
s_cbranch_vccnz L_w3_tr25
L_w3_tr25_ret:
mma v[160:163],a[192:195],v[64:67],v[224:227]
s_mov_b32 m0, 122880
s_mov_b32 s31, 362496
ldq a[216:219],v2
bld v9,s[12:15],s31 offen offset:1024 nt lds
mma v[160:163],a[196:199],v[68:71],v[160:163]
ldq a[220:223],v3
v_add_f32 v28, v28, v24
v_add_f32 v29, v29, v25
mma v[160:163],a[200:203],v[72:75],v[160:163]
ldq a[224:227],v2 offset:128
bld v10,s[12:15],s31 offen offset:2048 nt lds
mma v[160:163],a[204:207],v[76:79],v[160:163]
ldq a[228:231],v3 offset:128
v_add_f32 v30, v30, v26
v_add_u32 v4, s39, v4
mma v[160:163],a[208:211],v[80:83],v[160:163]
s_mov_b32 m0, 125952
ldq a[232:235],v2 offset:256
v_add_u32 v5, s39, v5
v_add_u32 v6, s39, v6
mma v[160:163],a[212:215],v[84:87],v[160:163]
s_mov_b32 s31, 331776
ldq a[236:239],v3 offset:256
bld v8,s[12:15],s31 offen nt lds
mma v[164:167],a[212:215],v[108:111],v[228:231]
v_add_u32 v7, s39, v7
mma v[164:167],a[208:211],v[104:107],v[164:167]
s_add_u32 s37, s37, 1
mma v[164:167],a[204:207],v[100:103],v[164:167]
s_cmp_eq_u32 s37, 7
s_cselect_b32 s36, 4294893568, s43
s_cselect_b32 s37, 0, s37
bld v9,s[12:15],s31 offen offset:1024 nt lds
mma v[164:167],a[200:203],v[96:99],v[164:167]
v_exp_f32 v32, v160
mma v[164:167],a[196:199],v[92:95],v[164:167]
v_exp_f32 v33, v161
mma v[164:167],a[192:195],v[88:91],v[164:167]
bld v10,s[12:15],s31 offen offset:2048 nt lds
v_add_f32 v24, v32, v33
mma v[168:171],a[192:195],v[112:115],v[232:235]
v_exp_f32 v34, v162
cvt v240,v32,v33
mma v[168:171],a[196:199],v[116:119],v[168:171]
s_mov_b32 m0, 129024
v_exp_f32 v35, v163
v_add_f32 v24, v24, v34
mma v[168:171],a[200:203],v[120:123],v[168:171]
s_mov_b32 s31, 365568
bld v8,s[12:15],s31 offen nt lds
cvt v241,v34,v35
mma v[168:171],a[204:207],v[124:127],v[168:171]
v_exp_f32 v36, v164
v_add_f32 v24, v24, v35
mma v[168:171],a[208:211],v[128:131],v[168:171]
v_exp_f32 v37, v165
mma v[168:171],a[212:215],v[132:135],v[168:171]
s_waitcnt lgkmcnt(5)
bld v9,s[12:15],s31 offen offset:1024 nt lds
v_add_f32 v25, v36, v37
mma v[176:179],a[216:219],v[64:67],v[224:227]
s_waitcnt lgkmcnt(4)
v_exp_f32 v38, v166
cvt v244,v36,v37
mma v[176:179],a[220:223],v[68:71],v[176:179]
s_waitcnt lgkmcnt(3)
ldq a[192:195],v2 offset:6144
v_exp_f32 v39, v167
mma v[176:179],a[224:227],v[72:75],v[176:179]
s_waitcnt lgkmcnt(3)
ldq a[196:199],v3 offset:6144
bld v10,s[12:15],s31 offen offset:2048 nt lds
mma v[176:179],a[228:231],v[76:79],v[176:179]
s_waitcnt lgkmcnt(3)
ldq a[200:203],v2 offset:6272
v_exp_f32 v32, v168
mma v[176:179],a[232:235],v[80:83],v[176:179]
s_mov_b32 m0, 132096
s_waitcnt lgkmcnt(3)
ldq a[204:207],v3 offset:6272
v_exp_f32 v33, v169
mma v[176:179],a[236:239],v[84:87],v[176:179]
s_mov_b32 s31, 334848
ldq a[208:211],v2 offset:6400
bld v8,s[12:15],s31 offen nt lds
mma v[180:183],a[236:239],v[108:111],v[228:231]
ldq a[212:215],v3 offset:6400
ldt a[240:241],v4
v_add_f32 v25, v25, v38
mma v[180:183],a[232:235],v[104:107],v[180:183]
ldt a[242:243],v4 offset:6144
v_exp_f32 v34, v170
mma v[180:183],a[228:231],v[100:103],v[180:183]
bld v9,s[12:15],s31 offen offset:1024 nt lds
cvt v245,v38,v39
mma v[180:183],a[224:227],v[96:99],v[180:183]
ldt a[244:245],v4 offset:12288
v_exp_f32 v35, v171
mma v[180:183],a[220:223],v[92:95],v[180:183]
ldt a[246:247],v4 offset:18432
v_exp_f32 v36, v176
mma v[180:183],a[216:219],v[88:91],v[180:183]
bld v10,s[12:15],s31 offen offset:2048 nt lds
v_add_f32 v25, v25, v39
mma v[184:187],a[216:219],v[112:115],v[232:235]
ldt a[248:249],v5
v_exp_f32 v37, v177
mma v[184:187],a[220:223],v[116:119],v[184:187]
s_mov_b32 m0, 0
ldt a[250:251],v5 offset:6144
v_exp_f32 v38, v178
mma v[184:187],a[224:227],v[120:123],v[184:187]
s_mov_b32 s31, 371712
bld v10,s[8:11],s31 offen offset:2048 nt lds
v_add_f32 v26, v32, v33
mma v[184:187],a[228:231],v[124:127],v[184:187]
ldt a[252:253],v5 offset:12288
v_exp_f32 v39, v179
mma v[184:187],a[232:235],v[128:131],v[184:187]
s_mov_b32 m0, 3072
ldt a[254:255],v5 offset:18432
cvt v248,v32,v33
v_add_f32 v26, v26, v34
mma v[184:187],a[236:239],v[132:135],v[184:187]
s_mov_b32 s31, 340992
s_waitcnt lgkmcnt(6)
bld v8,s[8:11],s31 offen nt lds
cvt v249,v34,v35
mma a[0:3],a[240:243],v[192:195],a[0:3]
s_waitcnt lgkmcnt(4)
ldt a[216:217],v6
v_exp_f32 v32, v180
mma a[0:3],a[244:247],v[208:211],a[0:3]
ldt a[218:219],v6 offset:6144
v_exp_f32 v33, v181
mma a[4:7],a[244:247],v[212:215],a[4:7]
bld v9,s[8:11],s31 offen offset:1024 nt lds
v_add_f32 v26, v26, v35
mma a[4:7],a[240:243],v[196:199],a[4:7]
ldt a[220:221],v6 offset:12288
v_exp_f32 v34, v182
mma a[8:11],a[240:243],v[200:203],a[8:11]
ldt a[222:223],v6 offset:18432
v_exp_f32 v35, v183
mma a[8:11],a[244:247],v[216:219],a[8:11]
s_waitcnt lgkmcnt(6)
bld v10,s[8:11],s31 offen offset:2048 nt lds
mma a[24:27],a[248:251],v[200:203],a[24:27]
s_waitcnt lgkmcnt(4)
ldt a[224:225],v7
v_add_f32 v24, v24, v36
mma a[24:27],a[252:255],v[216:219],a[24:27]
s_mov_b32 m0, 6144
ldt a[226:227],v7 offset:6144
cvt v242,v36,v37
mma a[20:23],a[252:255],v[212:215],a[20:23]
s_mov_b32 s31, 374784
bld v8,s[8:11],s31 offen nt lds
v_add_f32 v24, v24, v37
mma a[20:23],a[248:251],v[196:199],a[20:23]
ldt a[228:229],v7 offset:12288
v_exp_f32 v36, v184
mma a[16:19],a[248:251],v[192:195],a[16:19]
ldt a[230:231],v7 offset:18432
v_exp_f32 v37, v185
mma a[16:19],a[252:255],v[208:211],a[16:19]
s_waitcnt lgkmcnt(6)
bld v9,s[8:11],s31 offen offset:1024 nt lds
mma a[32:35],a[216:219],v[192:195],a[32:35]
s_waitcnt lgkmcnt(4)
ldt a[232:233],v4 offset:128
v_add_f32 v24, v24, v38
cvt v243,v38,v39
mma a[32:35],a[220:223],v[208:211],a[32:35]
ldt a[234:235],v4 offset:6272
v_exp_f32 v38, v186
mma a[36:39],a[220:223],v[212:215],a[36:39]
bld v10,s[8:11],s31 offen offset:2048 nt lds
mma a[36:39],a[216:219],v[196:199],a[36:39]
ldt a[236:237],v4 offset:12416
v_add_f32 v24, v24, v39
mma a[40:43],a[216:219],v[200:203],a[40:43]
s_mov_b32 m0, 9216
ldt a[238:239],v4 offset:18560
v_exp_f32 v39, v187
mma a[40:43],a[220:223],v[216:219],a[40:43]
s_mov_b32 s31, 344064
s_waitcnt lgkmcnt(6)
bld v8,s[8:11],s31 offen nt lds
v_add_f32 v25, v25, v32
mma a[56:59],a[224:227],v[200:203],a[56:59]
s_waitcnt lgkmcnt(4)
ldt a[240:241],v5 offset:128
cvt v246,v32,v33
mma a[56:59],a[228:231],v[216:219],a[56:59]
ldt a[242:243],v5 offset:6272
v_add_f32 v25, v25, v33
mma a[52:55],a[228:231],v[212:215],a[52:55]
bld v9,s[8:11],s31 offen offset:1024 nt lds
v_add_f32 v25, v25, v34
mma a[52:55],a[224:227],v[196:199],a[52:55]
ldt a[244:245],v5 offset:12416
cvt v247,v34,v35
v_add_f32 v25, v25, v35
mma a[48:51],a[224:227],v[192:195],a[48:51]
ldt a[246:247],v5 offset:18560
v_add_f32 v26, v26, v36
mma a[48:51],a[228:231],v[208:211],a[48:51]
s_waitcnt lgkmcnt(6)
bld v10,s[8:11],s31 offen offset:2048 nt lds
cvt v250,v36,v37
mma a[64:67],a[232:235],v[192:195],a[64:67]
s_waitcnt lgkmcnt(4)
v_add_f32 v26, v26, v37
v_add_f32 v26, v26, v38
mma a[64:67],a[236:239],v[208:211],a[64:67]
s_mov_b32 m0, 12288
cvt v251,v38,v39
mma a[68:71],a[236:239],v[212:215],a[68:71]
s_mov_b32 s31, 377856
bld v8,s[8:11],s31 offen nt lds
v_add_f32 v26, v26, v39
mma a[68:71],a[232:235],v[196:199],a[68:71]
v_max3_f32 v40, v24, v25, v26
mma a[72:75],a[232:235],v[200:203],a[72:75]
v_cmp_nge_f32 vcc, s34, v40
mma a[72:75],a[236:239],v[216:219],a[72:75]
s_waitcnt lgkmcnt(2)
mma a[88:91],a[240:243],v[200:203],a[88:91]
s_waitcnt lgkmcnt(0)
v_add_u32 v2, s36, v2
mma a[88:91],a[244:247],v[216:219],a[88:91]
v_add_u32 v3, s36, v3
mma a[84:87],a[244:247],v[212:215],a[84:87]
s_waitcnt vmcnt(37)
s_barrier
mma a[84:87],a[240:243],v[196:199],a[84:87]
mma a[80:83],a[240:243],v[192:195],a[80:83]
mma a[80:83],a[244:247],v[208:211],a[80:83]
s_cbranch_vccnz L_w3_tr26
L_w3_tr26_ret:
mma v[160:163],a[192:195],v[64:67],v[224:227]
s_mov_b32 m0, 12288
s_mov_b32 s31, 377856
ldq a[216:219],v2
bld v9,s[8:11],s31 offen offset:1024 nt lds
mma v[160:163],a[196:199],v[68:71],v[160:163]
ldq a[220:223],v3
v_add_f32 v28, v28, v24
v_add_f32 v29, v29, v25
mma v[160:163],a[200:203],v[72:75],v[160:163]
ldq a[224:227],v2 offset:128
bld v10,s[8:11],s31 offen offset:2048 nt lds
mma v[160:163],a[204:207],v[76:79],v[160:163]
ldq a[228:231],v3 offset:128
v_add_f32 v30, v30, v26
mma v[160:163],a[208:211],v[80:83],v[160:163]
s_mov_b32 m0, 15360
ldq a[232:235],v2 offset:256
mma v[160:163],a[212:215],v[84:87],v[160:163]
s_mov_b32 s31, 347136
ldq a[236:239],v3 offset:256
bld v8,s[8:11],s31 offen nt lds
mma v[164:167],a[212:215],v[108:111],v[228:231]
mma v[164:167],a[208:211],v[104:107],v[164:167]
s_add_u32 s37, s37, 1
mma v[164:167],a[204:207],v[100:103],v[164:167]
s_cmp_eq_u32 s37, 7
s_cselect_b32 s36, 4294893568, s43
s_cselect_b32 s37, 0, s37
bld v9,s[8:11],s31 offen offset:1024 nt lds
mma v[164:167],a[200:203],v[96:99],v[164:167]
v_exp_f32 v32, v160
mma v[164:167],a[196:199],v[92:95],v[164:167]
v_exp_f32 v33, v161
mma v[164:167],a[192:195],v[88:91],v[164:167]
bld v10,s[8:11],s31 offen offset:2048 nt lds
v_add_f32 v24, v32, v33
mma v[168:171],a[192:195],v[112:115],v[232:235]
v_exp_f32 v34, v162
cvt v48,v32,v33
mma v[168:171],a[196:199],v[116:119],v[168:171]
s_mov_b32 m0, 18432
v_exp_f32 v35, v163
v_add_f32 v24, v24, v34
mma v[168:171],a[200:203],v[120:123],v[168:171]
s_mov_b32 s31, 380928
bld v8,s[8:11],s31 offen nt lds
cvt v49,v34,v35
mma v[168:171],a[204:207],v[124:127],v[168:171]
v_exp_f32 v36, v164
v_add_f32 v24, v24, v35
mma v[168:171],a[208:211],v[128:131],v[168:171]
bld v9,s[8:11],s31 offen offset:1024 nt lds
mma v[168:171],a[212:215],v[132:135],v[168:171]
s_waitcnt lgkmcnt(5)
v_exp_f32 v37, v165
mma v[176:179],a[216:219],v[64:67],v[224:227]
s_waitcnt lgkmcnt(4)
v_exp_f32 v38, v166
v_add_f32 v25, v36, v37
mma v[176:179],a[220:223],v[68:71],v[176:179]
s_waitcnt lgkmcnt(3)
ldq a[192:195],v2 offset:6144
bld v10,s[8:11],s31 offen offset:2048 nt lds
mma v[176:179],a[224:227],v[72:75],v[176:179]
s_waitcnt lgkmcnt(3)
ldq a[196:199],v3 offset:6144
v_exp_f32 v39, v167
mma v[176:179],a[228:231],v[76:79],v[176:179]
s_mov_b32 m0, 21504
s_waitcnt lgkmcnt(3)
ldq a[200:203],v2 offset:6272
v_exp_f32 v32, v168
mma v[176:179],a[232:235],v[80:83],v[176:179]
s_mov_b32 s31, 350208
s_waitcnt lgkmcnt(3)
ldq a[204:207],v3 offset:6272
bld v8,s[8:11],s31 offen nt lds
mma v[176:179],a[236:239],v[84:87],v[176:179]
ldq a[208:211],v2 offset:6400
v_exp_f32 v33, v169
mma v[180:183],a[236:239],v[108:111],v[228:231]
ldq a[212:215],v3 offset:6400
ldt a[240:241],v6 offset:128
cvt v52,v36,v37
mma v[180:183],a[232:235],v[104:107],v[180:183]
ldt a[242:243],v6 offset:6272
bld v9,s[8:11],s31 offen offset:1024 nt lds
mma v[180:183],a[228:231],v[100:103],v[180:183]
v_exp_f32 v34, v170
v_add_f32 v25, v25, v38
mma v[180:183],a[224:227],v[96:99],v[180:183]
ldt a[244:245],v6 offset:12416
v_exp_f32 v35, v171
mma v[180:183],a[220:223],v[92:95],v[180:183]
ldt a[246:247],v6 offset:18560
bld v10,s[8:11],s31 offen offset:2048 nt lds
mma v[180:183],a[216:219],v[88:91],v[180:183]
v_exp_f32 v36, v176
cvt v53,v38,v39
mma v[184:187],a[216:219],v[112:115],v[232:235]
s_mov_b32 m0, 24576
ldt a[248:249],v7 offset:128
v_exp_f32 v37, v177
mma v[184:187],a[220:223],v[116:119],v[184:187]
s_mov_b32 s31, 384000
ldt a[250:251],v7 offset:6272
bld v8,s[8:11],s31 offen nt lds
mma v[184:187],a[224:227],v[120:123],v[184:187]
v_exp_f32 v38, v178
v_add_f32 v25, v25, v39
mma v[184:187],a[228:231],v[124:127],v[184:187]
ldt a[252:253],v7 offset:12416
bld v9,s[8:11],s31 offen offset:1024 nt lds
mma v[184:187],a[232:235],v[128:131],v[184:187]
ldt a[254:255],v7 offset:18560
v_exp_f32 v39, v179
mma v[184:187],a[236:239],v[132:135],v[184:187]
s_mov_b32 m0, 135168
s_waitcnt lgkmcnt(6)
v_add_f32 v26, v32, v33
cvt v56,v32,v33
v_add_f32 v26, v26, v34
mma a[96:99],a[240:243],v[192:195],a[96:99]
s_mov_b32 s31, 368640
s_waitcnt lgkmcnt(4)
ldt a[216:217],v4 offset:256
bld v8,s[12:15],s31 offen nt lds
mma a[96:99],a[244:247],v[208:211],a[96:99]
ldt a[218:219],v4 offset:6400
v_exp_f32 v32, v180
mma a[100:103],a[244:247],v[212:215],a[100:103]
v_exp_f32 v33, v181
cvt v57,v34,v35
mma a[100:103],a[240:243],v[196:199],a[100:103]
ldt a[220:221],v4 offset:12544
bld v9,s[12:15],s31 offen offset:1024 nt lds
mma a[104:107],a[240:243],v[200:203],a[104:107]
ldt a[222:223],v4 offset:18688
v_exp_f32 v34, v182
mma a[104:107],a[244:247],v[216:219],a[104:107]
s_waitcnt lgkmcnt(6)
v_add_f32 v26, v26, v35
v_exp_f32 v35, v183
mma a[120:123],a[248:251],v[200:203],a[120:123]
s_waitcnt lgkmcnt(4)
ldt a[224:225],v5 offset:256
bld v10,s[12:15],s31 offen offset:2048 nt lds
mma a[120:123],a[252:255],v[216:219],a[120:123]
ldt a[226:227],v5 offset:6400
v_add_f32 v24, v24, v36
cvt v50,v36,v37
mma a[116:119],a[252:255],v[212:215],a[116:119]
s_mov_b32 m0, 138240
v_exp_f32 v36, v184
v_add_f32 v24, v24, v37
mma a[116:119],a[248:251],v[196:199],a[116:119]
s_mov_b32 s31, 337920
ldt a[228:229],v5 offset:12544
bld v8,s[12:15],s31 offen nt lds
mma a[112:115],a[248:251],v[192:195],a[112:115]
ldt a[230:231],v5 offset:18688
v_exp_f32 v37, v185
mma a[112:115],a[252:255],v[208:211],a[112:115]
s_waitcnt lgkmcnt(6)
v_add_f32 v24, v24, v38
mma a[128:131],a[216:219],v[192:195],a[128:131]
s_waitcnt lgkmcnt(4)
ldt a[232:233],v6 offset:256
bld v9,s[12:15],s31 offen offset:1024 nt lds
mma a[128:131],a[220:223],v[208:211],a[128:131]
ldt a[234:235],v6 offset:6400
cvt v51,v38,v39
v_add_f32 v24, v24, v39
mma a[132:135],a[220:223],v[212:215],a[132:135]
bld v10,s[12:15],s31 offen offset:2048 nt lds
v_add_f32 v25, v25, v32
mma a[132:135],a[216:219],v[196:199],a[132:135]
ldt a[236:237],v6 offset:12544
v_exp_f32 v38, v186
mma a[136:139],a[216:219],v[200:203],a[136:139]
s_mov_b32 m0, 141312
ldt a[238:239],v6 offset:18688
v_exp_f32 v39, v187
mma a[136:139],a[220:223],v[216:219],a[136:139]
s_mov_b32 s31, 371712
s_waitcnt lgkmcnt(6)
bld v8,s[12:15],s31 offen nt lds
mma a[152:155],a[224:227],v[200:203],a[152:155]
s_waitcnt lgkmcnt(4)
ldt a[240:241],v7 offset:256
cvt v54,v32,v33
v_add_f32 v25, v25, v33
mma a[152:155],a[228:231],v[216:219],a[152:155]
ldt a[242:243],v7 offset:6400
v_add_f32 v25, v25, v34
mma a[148:151],a[228:231],v[212:215],a[148:151]
bld v9,s[12:15],s31 offen offset:1024 nt lds
cvt v55,v34,v35
mma a[148:151],a[224:227],v[196:199],a[148:151]
ldt a[244:245],v7 offset:12544
v_add_f32 v25, v25, v35
mma a[144:147],a[224:227],v[192:195],a[144:147]
ldt a[246:247],v7 offset:18688
v_add_f32 v26, v26, v36
mma a[144:147],a[228:231],v[208:211],a[144:147]
s_waitcnt lgkmcnt(6)
bld v10,s[12:15],s31 offen offset:2048 nt lds
cvt v58,v36,v37
mma a[160:163],a[232:235],v[192:195],a[160:163]
s_waitcnt lgkmcnt(4)
v_add_f32 v26, v26, v37
v_add_f32 v26, v26, v38
mma a[160:163],a[236:239],v[208:211],a[160:163]
s_mov_b32 m0, 144384
cvt v59,v38,v39
mma a[164:167],a[236:239],v[212:215],a[164:167]
s_mov_b32 s31, 340992
bld v8,s[12:15],s31 offen nt lds
v_add_f32 v26, v26, v39
mma a[164:167],a[232:235],v[196:199],a[164:167]
v_max3_f32 v40, v24, v25, v26
mma a[168:171],a[232:235],v[200:203],a[168:171]
v_cmp_nge_f32 vcc, s34, v40
mma a[168:171],a[236:239],v[216:219],a[168:171]
s_waitcnt lgkmcnt(2)
mma a[184:187],a[240:243],v[200:203],a[184:187]
s_waitcnt lgkmcnt(0)
v_add_u32 v2, s36, v2
mma a[184:187],a[244:247],v[216:219],a[184:187]
v_add_u32 v3, s36, v3
mma a[180:183],a[244:247],v[212:215],a[180:183]
s_waitcnt vmcnt(24)
s_barrier
mma a[180:183],a[240:243],v[196:199],a[180:183]
s_add_u32 s40, s40, 1
mma a[176:179],a[240:243],v[192:195],a[176:179]
s_cmp_eq_u32 s40, 3
s_cselect_b32 s39, 4294918144, s42
s_cselect_b32 s40, 0, s40
mma a[176:179],a[244:247],v[208:211],a[176:179]
s_cbranch_vccnz L_w3_tr27
L_w3_tr27_ret:
mma v[160:163],a[192:195],v[64:67],v[224:227]
s_mov_b32 m0, 144384
s_mov_b32 s31, 340992
ldq a[216:219],v2
bld v9,s[12:15],s31 offen offset:1024 nt lds
mma v[160:163],a[196:199],v[68:71],v[160:163]
ldq a[220:223],v3
v_add_f32 v28, v28, v24
v_add_f32 v29, v29, v25
mma v[160:163],a[200:203],v[72:75],v[160:163]
ldq a[224:227],v2 offset:128
bld v10,s[12:15],s31 offen offset:2048 nt lds
mma v[160:163],a[204:207],v[76:79],v[160:163]
ldq a[228:231],v3 offset:128
v_add_f32 v30, v30, v26
v_add_u32 v4, s39, v4
mma v[160:163],a[208:211],v[80:83],v[160:163]
s_mov_b32 m0, 147456
ldq a[232:235],v2 offset:256
v_add_u32 v5, s39, v5
v_add_u32 v6, s39, v6
mma v[160:163],a[212:215],v[84:87],v[160:163]
s_mov_b32 s31, 374784
ldq a[236:239],v3 offset:256
bld v8,s[12:15],s31 offen nt lds
mma v[164:167],a[212:215],v[108:111],v[228:231]
v_add_u32 v7, s39, v7
mma v[164:167],a[208:211],v[104:107],v[164:167]
s_add_u32 s37, s37, 1
mma v[164:167],a[204:207],v[100:103],v[164:167]
s_cmp_eq_u32 s37, 7
s_cselect_b32 s36, 4294893568, s43
s_cselect_b32 s37, 0, s37
bld v9,s[12:15],s31 offen offset:1024 nt lds
mma v[164:167],a[200:203],v[96:99],v[164:167]
v_exp_f32 v32, v160
mma v[164:167],a[196:199],v[92:95],v[164:167]
v_exp_f32 v33, v161
mma v[164:167],a[192:195],v[88:91],v[164:167]
bld v10,s[12:15],s31 offen offset:2048 nt lds
v_add_f32 v24, v32, v33
mma v[168:171],a[192:195],v[112:115],v[232:235]
v_exp_f32 v34, v162
cvt v192,v32,v33
mma v[168:171],a[196:199],v[116:119],v[168:171]
s_mov_b32 m0, 150528
v_exp_f32 v35, v163
v_add_f32 v24, v24, v34
mma v[168:171],a[200:203],v[120:123],v[168:171]
s_mov_b32 s31, 344064
bld v8,s[12:15],s31 offen nt lds
cvt v193,v34,v35
mma v[168:171],a[204:207],v[124:127],v[168:171]
v_exp_f32 v36, v164
v_add_f32 v24, v24, v35
mma v[168:171],a[208:211],v[128:131],v[168:171]
v_exp_f32 v37, v165
mma v[168:171],a[212:215],v[132:135],v[168:171]
s_waitcnt lgkmcnt(5)
bld v9,s[12:15],s31 offen offset:1024 nt lds
v_add_f32 v25, v36, v37
mma v[176:179],a[216:219],v[64:67],v[224:227]
s_waitcnt lgkmcnt(4)
v_exp_f32 v38, v166
cvt v196,v36,v37
mma v[176:179],a[220:223],v[68:71],v[176:179]
s_waitcnt lgkmcnt(3)
ldq a[192:195],v2 offset:6144
v_exp_f32 v39, v167
mma v[176:179],a[224:227],v[72:75],v[176:179]
s_waitcnt lgkmcnt(3)
ldq a[196:199],v3 offset:6144
bld v10,s[12:15],s31 offen offset:2048 nt lds
mma v[176:179],a[228:231],v[76:79],v[176:179]
s_waitcnt lgkmcnt(3)
ldq a[200:203],v2 offset:6272
v_exp_f32 v32, v168
mma v[176:179],a[232:235],v[80:83],v[176:179]
s_mov_b32 m0, 153600
s_waitcnt lgkmcnt(3)
ldq a[204:207],v3 offset:6272
v_exp_f32 v33, v169
mma v[176:179],a[236:239],v[84:87],v[176:179]
s_mov_b32 s31, 377856
ldq a[208:211],v2 offset:6400
bld v8,s[12:15],s31 offen nt lds
mma v[180:183],a[236:239],v[108:111],v[228:231]
ldq a[212:215],v3 offset:6400
ldt a[240:241],v4
v_add_f32 v25, v25, v38
mma v[180:183],a[232:235],v[104:107],v[180:183]
ldt a[242:243],v4 offset:6144
v_exp_f32 v34, v170
mma v[180:183],a[228:231],v[100:103],v[180:183]
bld v9,s[12:15],s31 offen offset:1024 nt lds
cvt v197,v38,v39
mma v[180:183],a[224:227],v[96:99],v[180:183]
ldt a[244:245],v4 offset:12288
v_exp_f32 v35, v171
mma v[180:183],a[220:223],v[92:95],v[180:183]
ldt a[246:247],v4 offset:18432
v_exp_f32 v36, v176
mma v[180:183],a[216:219],v[88:91],v[180:183]
bld v10,s[12:15],s31 offen offset:2048 nt lds
v_add_f32 v25, v25, v39
mma v[184:187],a[216:219],v[112:115],v[232:235]
ldt a[248:249],v5
v_exp_f32 v37, v177
mma v[184:187],a[220:223],v[116:119],v[184:187]
s_mov_b32 m0, 156672
ldt a[250:251],v5 offset:6144
v_exp_f32 v38, v178
mma v[184:187],a[224:227],v[120:123],v[184:187]
s_mov_b32 s31, 347136
bld v8,s[12:15],s31 offen nt lds
v_add_f32 v26, v32, v33
mma v[184:187],a[228:231],v[124:127],v[184:187]
ldt a[252:253],v5 offset:12288
v_exp_f32 v39, v179
mma v[184:187],a[232:235],v[128:131],v[184:187]
ldt a[254:255],v5 offset:18432
cvt v200,v32,v33
v_add_f32 v26, v26, v34
mma v[184:187],a[236:239],v[132:135],v[184:187]
s_waitcnt lgkmcnt(6)
bld v9,s[12:15],s31 offen offset:1024 nt lds
cvt v201,v34,v35
mma a[0:3],a[240:243],v[240:243],a[0:3]
s_waitcnt lgkmcnt(4)
ldt a[216:217],v6
v_exp_f32 v32, v180
mma a[0:3],a[244:247],v[48:51],a[0:3]
ldt a[218:219],v6 offset:6144
v_exp_f32 v33, v181
mma a[4:7],a[244:247],v[52:55],a[4:7]
bld v10,s[12:15],s31 offen offset:2048 nt lds
v_add_f32 v26, v26, v35
mma a[4:7],a[240:243],v[244:247],a[4:7]
ldt a[220:221],v6 offset:12288
v_exp_f32 v34, v182
mma a[8:11],a[240:243],v[248:251],a[8:11]
s_mov_b32 m0, 24576
ldt a[222:223],v6 offset:18432
v_exp_f32 v35, v183
mma a[8:11],a[244:247],v[56:59],a[8:11]
s_mov_b32 s31, 384000
s_waitcnt lgkmcnt(6)
bld v10,s[8:11],s31 offen offset:2048 nt lds
mma a[24:27],a[248:251],v[248:251],a[24:27]
s_waitcnt lgkmcnt(4)
ldt a[224:225],v7
v_add_f32 v24, v24, v36
mma a[24:27],a[252:255],v[56:59],a[24:27]
s_mov_b32 m0, 27648
ldt a[226:227],v7 offset:6144
cvt v194,v36,v37
mma a[20:23],a[252:255],v[52:55],a[20:23]
s_mov_b32 s31, 353280
bld v8,s[8:11],s31 offen nt lds
v_add_f32 v24, v24, v37
mma a[20:23],a[248:251],v[244:247],a[20:23]
ldt a[228:229],v7 offset:12288
v_exp_f32 v36, v184
mma a[16:19],a[248:251],v[240:243],a[16:19]
ldt a[230:231],v7 offset:18432
v_exp_f32 v37, v185
mma a[16:19],a[252:255],v[48:51],a[16:19]
s_waitcnt lgkmcnt(6)
bld v9,s[8:11],s31 offen offset:1024 nt lds
mma a[32:35],a[216:219],v[240:243],a[32:35]
s_waitcnt lgkmcnt(4)
ldt a[232:233],v4 offset:128
v_add_f32 v24, v24, v38
cvt v195,v38,v39
mma a[32:35],a[220:223],v[48:51],a[32:35]
ldt a[234:235],v4 offset:6272
v_exp_f32 v38, v186
mma a[36:39],a[220:223],v[52:55],a[36:39]
bld v10,s[8:11],s31 offen offset:2048 nt lds
mma a[36:39],a[216:219],v[244:247],a[36:39]
ldt a[236:237],v4 offset:12416
v_add_f32 v24, v24, v39
mma a[40:43],a[216:219],v[248:251],a[40:43]
s_mov_b32 m0, 30720
ldt a[238:239],v4 offset:18560
v_exp_f32 v39, v187
mma a[40:43],a[220:223],v[56:59],a[40:43]
s_mov_b32 s31, 387072
s_waitcnt lgkmcnt(6)
bld v8,s[8:11],s31 offen nt lds
v_add_f32 v25, v25, v32
mma a[56:59],a[224:227],v[248:251],a[56:59]
s_waitcnt lgkmcnt(4)
ldt a[240:241],v5 offset:128
cvt v198,v32,v33
mma a[56:59],a[228:231],v[56:59],a[56:59]
ldt a[242:243],v5 offset:6272
v_add_f32 v25, v25, v33
mma a[52:55],a[228:231],v[52:55],a[52:55]
bld v9,s[8:11],s31 offen offset:1024 nt lds
v_add_f32 v25, v25, v34
mma a[52:55],a[224:227],v[244:247],a[52:55]
ldt a[244:245],v5 offset:12416
cvt v199,v34,v35
v_add_f32 v25, v25, v35
mma a[48:51],a[224:227],v[240:243],a[48:51]
ldt a[246:247],v5 offset:18560
v_add_f32 v26, v26, v36
mma a[48:51],a[228:231],v[48:51],a[48:51]
s_waitcnt lgkmcnt(6)
bld v10,s[8:11],s31 offen offset:2048 nt lds
cvt v202,v36,v37
mma a[64:67],a[232:235],v[240:243],a[64:67]
s_waitcnt lgkmcnt(4)
v_add_f32 v26, v26, v37
v_add_f32 v26, v26, v38
mma a[64:67],a[236:239],v[48:51],a[64:67]
s_mov_b32 m0, 33792
cvt v203,v38,v39
mma a[68:71],a[236:239],v[52:55],a[68:71]
s_mov_b32 s31, 356352
bld v8,s[8:11],s31 offen nt lds
v_add_f32 v26, v26, v39
mma a[68:71],a[232:235],v[244:247],a[68:71]
v_max3_f32 v40, v24, v25, v26
mma a[72:75],a[232:235],v[248:251],a[72:75]
v_cmp_nge_f32 vcc, s34, v40
mma a[72:75],a[236:239],v[56:59],a[72:75]
s_waitcnt lgkmcnt(2)
mma a[88:91],a[240:243],v[248:251],a[88:91]
s_waitcnt lgkmcnt(0)
v_add_u32 v2, s36, v2
mma a[88:91],a[244:247],v[56:59],a[88:91]
v_add_u32 v3, s36, v3
mma a[84:87],a[244:247],v[52:55],a[84:87]
s_waitcnt vmcnt(34)
s_barrier
mma a[84:87],a[240:243],v[244:247],a[84:87]
mma a[80:83],a[240:243],v[240:243],a[80:83]
mma a[80:83],a[244:247],v[48:51],a[80:83]
s_cbranch_vccnz L_w3_tr28
L_w3_tr28_ret:
mma v[160:163],a[192:195],v[64:67],v[224:227]
s_mov_b32 m0, 33792
s_mov_b32 s31, 356352
ldq a[216:219],v2
bld v9,s[8:11],s31 offen offset:1024 nt lds
mma v[160:163],a[196:199],v[68:71],v[160:163]
ldq a[220:223],v3
v_add_f32 v28, v28, v24
v_add_f32 v29, v29, v25
mma v[160:163],a[200:203],v[72:75],v[160:163]
ldq a[224:227],v2 offset:128
bld v10,s[8:11],s31 offen offset:2048 nt lds
mma v[160:163],a[204:207],v[76:79],v[160:163]
ldq a[228:231],v3 offset:128
v_add_f32 v30, v30, v26
mma v[160:163],a[208:211],v[80:83],v[160:163]
s_mov_b32 m0, 36864
ldq a[232:235],v2 offset:256
mma v[160:163],a[212:215],v[84:87],v[160:163]
s_mov_b32 s31, 390144
ldq a[236:239],v3 offset:256
bld v8,s[8:11],s31 offen nt lds
mma v[164:167],a[212:215],v[108:111],v[228:231]
mma v[164:167],a[208:211],v[104:107],v[164:167]
s_add_u32 s37, s37, 1
mma v[164:167],a[204:207],v[100:103],v[164:167]
s_cmp_eq_u32 s37, 7
s_cselect_b32 s36, 4294893568, s43
s_cselect_b32 s37, 0, s37
bld v9,s[8:11],s31 offen offset:1024 nt lds
mma v[164:167],a[200:203],v[96:99],v[164:167]
v_exp_f32 v32, v160
mma v[164:167],a[196:199],v[92:95],v[164:167]
v_exp_f32 v33, v161
mma v[164:167],a[192:195],v[88:91],v[164:167]
bld v10,s[8:11],s31 offen offset:2048 nt lds
v_add_f32 v24, v32, v33
mma v[168:171],a[192:195],v[112:115],v[232:235]
v_exp_f32 v34, v162
cvt v208,v32,v33
mma v[168:171],a[196:199],v[116:119],v[168:171]
s_mov_b32 m0, 39936
v_exp_f32 v35, v163
v_add_f32 v24, v24, v34
mma v[168:171],a[200:203],v[120:123],v[168:171]
s_mov_b32 s31, 359424
bld v8,s[8:11],s31 offen nt lds
cvt v209,v34,v35
mma v[168:171],a[204:207],v[124:127],v[168:171]
v_exp_f32 v36, v164
v_add_f32 v24, v24, v35
mma v[168:171],a[208:211],v[128:131],v[168:171]
v_exp_f32 v37, v165
mma v[168:171],a[212:215],v[132:135],v[168:171]
s_waitcnt lgkmcnt(5)
bld v9,s[8:11],s31 offen offset:1024 nt lds
v_add_f32 v25, v36, v37
mma v[176:179],a[216:219],v[64:67],v[224:227]
s_waitcnt lgkmcnt(4)
v_exp_f32 v38, v166
cvt v212,v36,v37
mma v[176:179],a[220:223],v[68:71],v[176:179]
s_waitcnt lgkmcnt(3)
ldq a[192:195],v2 offset:6144
v_exp_f32 v39, v167
mma v[176:179],a[224:227],v[72:75],v[176:179]
s_waitcnt lgkmcnt(3)
ldq a[196:199],v3 offset:6144
bld v10,s[8:11],s31 offen offset:2048 nt lds
mma v[176:179],a[228:231],v[76:79],v[176:179]
s_waitcnt lgkmcnt(3)
ldq a[200:203],v2 offset:6272
v_exp_f32 v32, v168
mma v[176:179],a[232:235],v[80:83],v[176:179]
s_mov_b32 m0, 86016
s_waitcnt lgkmcnt(3)
ldq a[204:207],v3 offset:6272
v_exp_f32 v33, v169
mma v[176:179],a[236:239],v[84:87],v[176:179]
s_mov_b32 s31, 380928
ldq a[208:211],v2 offset:6400
bld v8,s[12:15],s31 offen nt lds
mma v[180:183],a[236:239],v[108:111],v[228:231]
ldq a[212:215],v3 offset:6400
ldt a[240:241],v6 offset:128
v_add_f32 v25, v25, v38
mma v[180:183],a[232:235],v[104:107],v[180:183]
ldt a[242:243],v6 offset:6272
v_exp_f32 v34, v170
mma v[180:183],a[228:231],v[100:103],v[180:183]
bld v9,s[12:15],s31 offen offset:1024 nt lds
cvt v213,v38,v39
mma v[180:183],a[224:227],v[96:99],v[180:183]
ldt a[244:245],v6 offset:12416
v_exp_f32 v35, v171
mma v[180:183],a[220:223],v[92:95],v[180:183]
ldt a[246:247],v6 offset:18560
v_exp_f32 v36, v176
mma v[180:183],a[216:219],v[88:91],v[180:183]
bld v10,s[12:15],s31 offen offset:2048 nt lds
v_add_f32 v25, v25, v39
mma v[184:187],a[216:219],v[112:115],v[232:235]
ldt a[248:249],v7 offset:128
v_exp_f32 v37, v177
mma v[184:187],a[220:223],v[116:119],v[184:187]
s_mov_b32 m0, 89088
ldt a[250:251],v7 offset:6272
v_exp_f32 v38, v178
mma v[184:187],a[224:227],v[120:123],v[184:187]
s_mov_b32 s31, 350208
bld v8,s[12:15],s31 offen nt lds
v_add_f32 v26, v32, v33
mma v[184:187],a[228:231],v[124:127],v[184:187]
ldt a[252:253],v7 offset:12416
v_exp_f32 v39, v179
mma v[184:187],a[232:235],v[128:131],v[184:187]
ldt a[254:255],v7 offset:18560
cvt v216,v32,v33
v_add_f32 v26, v26, v34
mma v[184:187],a[236:239],v[132:135],v[184:187]
s_waitcnt lgkmcnt(6)
bld v9,s[12:15],s31 offen offset:1024 nt lds
cvt v217,v34,v35
mma a[96:99],a[240:243],v[240:243],a[96:99]
s_waitcnt lgkmcnt(4)
ldt a[216:217],v4 offset:256
v_exp_f32 v32, v180
mma a[96:99],a[244:247],v[48:51],a[96:99]
ldt a[218:219],v4 offset:6400
v_exp_f32 v33, v181
mma a[100:103],a[244:247],v[52:55],a[100:103]
bld v10,s[12:15],s31 offen offset:2048 nt lds
v_add_f32 v26, v26, v35
mma a[100:103],a[240:243],v[244:247],a[100:103]
ldt a[220:221],v4 offset:12544
v_exp_f32 v34, v182
mma a[104:107],a[240:243],v[248:251],a[104:107]
s_mov_b32 m0, 92160
ldt a[222:223],v4 offset:18688
v_exp_f32 v35, v183
mma a[104:107],a[244:247],v[56:59],a[104:107]
s_mov_b32 s31, 384000
s_waitcnt lgkmcnt(6)
bld v8,s[12:15],s31 offen nt lds
v_add_f32 v24, v24, v36
mma a[120:123],a[248:251],v[248:251],a[120:123]
s_waitcnt lgkmcnt(4)
ldt a[224:225],v5 offset:256
cvt v210,v36,v37
mma a[120:123],a[252:255],v[56:59],a[120:123]
ldt a[226:227],v5 offset:6400
v_exp_f32 v36, v184
mma a[116:119],a[252:255],v[52:55],a[116:119]
bld v9,s[12:15],s31 offen offset:1024 nt lds
v_add_f32 v24, v24, v37
mma a[116:119],a[248:251],v[244:247],a[116:119]
ldt a[228:229],v5 offset:12544
v_exp_f32 v37, v185
mma a[112:115],a[248:251],v[240:243],a[112:115]
ldt a[230:231],v5 offset:18688
mma a[112:115],a[252:255],v[48:51],a[112:115]
s_waitcnt lgkmcnt(6)
bld v10,s[12:15],s31 offen offset:2048 nt lds
v_add_f32 v24, v24, v38
mma a[128:131],a[216:219],v[240:243],a[128:131]
s_waitcnt lgkmcnt(4)
ldt a[232:233],v6 offset:256
cvt v211,v38,v39
mma a[128:131],a[220:223],v[48:51],a[128:131]
s_mov_b32 m0, 95232
ldt a[234:235],v6 offset:6400
v_exp_f32 v38, v186
mma a[132:135],a[220:223],v[52:55],a[132:135]
s_mov_b32 s31, 353280
bld v8,s[12:15],s31 offen nt lds
v_add_f32 v24, v24, v39
mma a[132:135],a[216:219],v[244:247],a[132:135]
ldt a[236:237],v6 offset:12544
v_exp_f32 v39, v187
mma a[136:139],a[216:219],v[248:251],a[136:139]
ldt a[238:239],v6 offset:18688
mma a[136:139],a[220:223],v[56:59],a[136:139]
s_waitcnt lgkmcnt(6)
bld v9,s[12:15],s31 offen offset:1024 nt lds
v_add_f32 v25, v25, v32
mma a[152:155],a[224:227],v[248:251],a[152:155]
s_waitcnt lgkmcnt(4)
ldt a[240:241],v7 offset:256
cvt v214,v32,v33
v_add_f32 v25, v25, v33
mma a[152:155],a[228:231],v[56:59],a[152:155]
ldt a[242:243],v7 offset:6400
v_add_f32 v25, v25, v34
mma a[148:151],a[228:231],v[52:55],a[148:151]
bld v10,s[12:15],s31 offen offset:2048 nt lds
cvt v215,v34,v35
mma a[148:151],a[224:227],v[244:247],a[148:151]
ldt a[244:245],v7 offset:12544
v_add_f32 v25, v25, v35
mma a[144:147],a[224:227],v[240:243],a[144:147]
s_mov_b32 m0, 98304
ldt a[246:247],v7 offset:18688
v_add_f32 v26, v26, v36
mma a[144:147],a[228:231],v[48:51],a[144:147]
s_mov_b32 s31, 387072
s_waitcnt lgkmcnt(6)
bld v8,s[12:15],s31 offen nt lds
cvt v218,v36,v37
mma a[160:163],a[232:235],v[240:243],a[160:163]
s_waitcnt lgkmcnt(4)
v_add_f32 v26, v26, v37
v_add_f32 v26, v26, v38
mma a[160:163],a[236:239],v[48:51],a[160:163]
cvt v219,v38,v39
mma a[164:167],a[236:239],v[52:55],a[164:167]
bld v9,s[12:15],s31 offen offset:1024 nt lds
v_add_f32 v26, v26, v39
mma a[164:167],a[232:235],v[244:247],a[164:167]
v_max3_f32 v40, v24, v25, v26
mma a[168:171],a[232:235],v[248:251],a[168:171]
v_cmp_nge_f32 vcc, s34, v40
mma a[168:171],a[236:239],v[56:59],a[168:171]
s_waitcnt lgkmcnt(2)
mma a[184:187],a[240:243],v[248:251],a[184:187]
s_waitcnt lgkmcnt(0)
v_add_u32 v2, s36, v2
mma a[184:187],a[244:247],v[56:59],a[184:187]
v_add_u32 v3, s36, v3
mma a[180:183],a[244:247],v[52:55],a[180:183]
s_waitcnt vmcnt(20)
s_barrier
mma a[180:183],a[240:243],v[244:247],a[180:183]
s_add_u32 s40, s40, 1
mma a[176:179],a[240:243],v[240:243],a[176:179]
s_cmp_eq_u32 s40, 3
s_cselect_b32 s39, 4294918144, s42
s_cselect_b32 s40, 0, s40
mma a[176:179],a[244:247],v[48:51],a[176:179]
s_cbranch_vccnz L_w3_tr29
L_w3_tr29_ret:
mma v[160:163],a[192:195],v[64:67],v[224:227]
s_mov_b32 m0, 98304
s_mov_b32 s31, 387072
ldq a[216:219],v2
bld v10,s[12:15],s31 offen offset:2048 nt lds
v_add_f32 v28, v28, v24
mma v[160:163],a[196:199],v[68:71],v[160:163]
s_mov_b32 m0, 101376
s_mov_b32 s31, 356352
ldq a[220:223],v3
bld v8,s[12:15],s31 offen nt lds
v_add_f32 v29, v29, v25
mma v[160:163],a[200:203],v[72:75],v[160:163]
ldq a[224:227],v2 offset:128
v_add_f32 v30, v30, v26
v_add_u32 v4, s39, v4
v_add_u32 v5, s39, v5
mma v[160:163],a[204:207],v[76:79],v[160:163]
ldq a[228:231],v3 offset:128
bld v9,s[12:15],s31 offen offset:1024 nt lds
v_add_u32 v6, s39, v6
mma v[160:163],a[208:211],v[80:83],v[160:163]
ldq a[232:235],v2 offset:256
v_add_u32 v7, s39, v7
mma v[160:163],a[212:215],v[84:87],v[160:163]
ldq a[236:239],v3 offset:256
bld v10,s[12:15],s31 offen offset:2048 nt lds
mma v[164:167],a[212:215],v[108:111],v[228:231]
mma v[164:167],a[208:211],v[104:107],v[164:167]
s_add_u32 s37, s37, 1
s_mov_b32 m0, 104448
s_mov_b32 s31, 390144
bld v8,s[12:15],s31 offen nt lds
mma v[164:167],a[204:207],v[100:103],v[164:167]
s_cmp_eq_u32 s37, 7
s_cselect_b32 s36, 4294893568, s43
s_cselect_b32 s37, 0, s37
mma v[164:167],a[200:203],v[96:99],v[164:167]
bld v9,s[12:15],s31 offen offset:1024 nt lds
v_exp_f32 v32, v160
mma v[164:167],a[196:199],v[92:95],v[164:167]
v_exp_f32 v33, v161
v_exp_f32 v34, v162
mma v[164:167],a[192:195],v[88:91],v[164:167]
bld v10,s[12:15],s31 offen offset:2048 nt lds
v_exp_f32 v35, v163
mma v[168:171],a[192:195],v[112:115],v[232:235]
s_mov_b32 m0, 107520
v_add_f32 v24, v32, v33
cvt v240,v32,v33
v_add_f32 v24, v24, v34
cvt v241,v34,v35
mma v[168:171],a[196:199],v[116:119],v[168:171]
s_mov_b32 s31, 359424
bld v8,s[12:15],s31 offen nt lds
v_add_f32 v24, v24, v35
mma v[168:171],a[200:203],v[120:123],v[168:171]
bld v9,s[12:15],s31 offen offset:1024 nt lds
mma v[168:171],a[204:207],v[124:127],v[168:171]
v_exp_f32 v36, v164
v_exp_f32 v37, v165
mma v[168:171],a[208:211],v[128:131],v[168:171]
bld v10,s[12:15],s31 offen offset:2048 nt lds
v_exp_f32 v38, v166
mma v[168:171],a[212:215],v[132:135],v[168:171]
s_mov_b32 m0, 0
s_waitcnt lgkmcnt(5)
v_exp_f32 v39, v167
v_add_f32 v25, v36, v37
cvt v244,v36,v37
mma v[176:179],a[216:219],v[64:67],v[224:227]
s_add_u32 s31, s59, 0
s_waitcnt lgkmcnt(4)
bld v236,s[48:51],s31 offen lds
v_add_f32 v25, v25, v38
cvt v245,v38,v39
mma v[176:179],a[220:223],v[68:71],v[176:179]
s_waitcnt lgkmcnt(3)
ldq a[192:195],v2 offset:6144
v_add_f32 v25, v25, v39
mma v[176:179],a[224:227],v[72:75],v[176:179]
s_waitcnt lgkmcnt(3)
ldq a[196:199],v3 offset:6144
bld v237,s[48:51],s31 offen offset:1024 lds
mma v[176:179],a[228:231],v[76:79],v[176:179]
s_waitcnt lgkmcnt(3)
ldq a[200:203],v2 offset:6272
v_exp_f32 v32, v168
mma v[176:179],a[232:235],v[80:83],v[176:179]
s_waitcnt lgkmcnt(3)
ldq a[204:207],v3 offset:6272
bld v238,s[48:51],s31 offen offset:2048 lds
mma v[176:179],a[236:239],v[84:87],v[176:179]
ldq a[208:211],v2 offset:6400
v_exp_f32 v33, v169
mma v[180:183],a[236:239],v[108:111],v[228:231]
ldq a[212:215],v3 offset:6400
ldt a[240:241],v4
bld v239,s[48:51],s31 offen offset:3072 lds
mma v[180:183],a[232:235],v[104:107],v[180:183]
ldt a[242:243],v4 offset:6144
v_exp_f32 v34, v170
v_add_f32 v26, v32, v33
mma v[180:183],a[228:231],v[100:103],v[180:183]
s_mov_b32 m0, 4096
s_nop 0
bld v44,s[48:51],s31 offen lds
v_exp_f32 v35, v171
mma v[180:183],a[224:227],v[96:99],v[180:183]
s_mov_b32 m0, 5120
s_add_u32 s31, s59, 20480
ldt a[244:245],v4 offset:12288
bld v236,s[48:51],s31 offen lds
cvt v248,v32,v33
mma v[180:183],a[220:223],v[92:95],v[180:183]
ldt a[246:247],v4 offset:18432
v_exp_f32 v36, v176
v_add_f32 v26, v26, v34
mma v[180:183],a[216:219],v[88:91],v[180:183]
bld v237,s[48:51],s31 offen offset:1024 lds
v_exp_f32 v37, v177
mma v[184:187],a[216:219],v[112:115],v[232:235]
ldt a[248:249],v5
mma v[184:187],a[220:223],v[116:119],v[184:187]
ldt a[250:251],v5 offset:6144
bld v238,s[48:51],s31 offen offset:2048 lds
cvt v249,v34,v35
mma v[184:187],a[224:227],v[120:123],v[184:187]
v_exp_f32 v38, v178
mma v[184:187],a[228:231],v[124:127],v[184:187]
ldt a[252:253],v5 offset:12288
bld v239,s[48:51],s31 offen offset:3072 lds
v_add_f32 v26, v26, v35
mma v[184:187],a[232:235],v[128:131],v[184:187]
ldt a[254:255],v5 offset:18432
v_exp_f32 v39, v179
mma v[184:187],a[236:239],v[132:135],v[184:187]
s_mov_b32 m0, 9216
s_waitcnt lgkmcnt(6)
bld v44,s[48:51],s31 offen lds
mma a[0:3],a[240:243],v[192:195],a[0:3]
s_mov_b32 m0, 10240
s_waitcnt lgkmcnt(4)
ldt a[216:217],v6
v_exp_f32 v32, v180
mma a[0:3],a[244:247],v[208:211],a[0:3]
s_add_u32 s31, s59, 40960
ldt a[218:219],v6 offset:6144
bld v236,s[48:51],s31 offen lds
v_add_f32 v24, v24, v36
mma a[4:7],a[244:247],v[212:215],a[4:7]
v_exp_f32 v33, v181
mma a[4:7],a[240:243],v[196:199],a[4:7]
ldt a[220:221],v6 offset:12288
bld v237,s[48:51],s31 offen offset:1024 lds
mma a[8:11],a[240:243],v[200:203],a[8:11]
ldt a[222:223],v6 offset:18432
bld v238,s[48:51],s31 offen offset:2048 lds
cvt v242,v36,v37
mma a[8:11],a[244:247],v[216:219],a[8:11]
s_waitcnt lgkmcnt(6)
v_exp_f32 v34, v182
mma a[24:27],a[248:251],v[200:203],a[24:27]
s_waitcnt lgkmcnt(4)
ldt a[224:225],v7
bld v239,s[48:51],s31 offen offset:3072 lds
v_add_f32 v24, v24, v37
mma a[24:27],a[252:255],v[216:219],a[24:27]
ldt a[226:227],v7 offset:6144
v_exp_f32 v35, v183
mma a[20:23],a[252:255],v[212:215],a[20:23]
s_mov_b32 m0, 14336
s_nop 0
bld v44,s[48:51],s31 offen lds
v_exp_f32 v36, v184
mma a[20:23],a[248:251],v[196:199],a[20:23]
s_mov_b32 m0, 15360
ldt a[228:229],v7 offset:12288
mma a[16:19],a[248:251],v[192:195],a[16:19]
s_add_u32 s31, s59, 61440
ldt a[230:231],v7 offset:18432
bld v236,s[48:51],s31 offen lds
v_add_f32 v24, v24, v38
mma a[16:19],a[252:255],v[208:211],a[16:19]
s_waitcnt lgkmcnt(6)
v_exp_f32 v37, v185
mma a[32:35],a[216:219],v[192:195],a[32:35]
s_waitcnt lgkmcnt(4)
ldt a[232:233],v4 offset:128
bld v237,s[48:51],s31 offen offset:1024 lds
cvt v243,v38,v39
mma a[32:35],a[220:223],v[208:211],a[32:35]
ldt a[234:235],v4 offset:6272
v_exp_f32 v38, v186
mma a[36:39],a[220:223],v[212:215],a[36:39]
bld v238,s[48:51],s31 offen offset:2048 lds
mma a[36:39],a[216:219],v[196:199],a[36:39]
ldt a[236:237],v4 offset:12416
v_add_f32 v24, v24, v39
mma a[40:43],a[216:219],v[200:203],a[40:43]
ldt a[238:239],v4 offset:18560
bld v239,s[48:51],s31 offen offset:3072 lds
v_add_f32 v25, v25, v32
mma a[40:43],a[220:223],v[216:219],a[40:43]
s_mov_b32 m0, 19456
s_waitcnt lgkmcnt(6)
bld v44,s[48:51],s31 offen lds
v_exp_f32 v39, v187
mma a[56:59],a[224:227],v[200:203],a[56:59]
s_mov_b32 m0, 49152
s_waitcnt lgkmcnt(4)
ldt a[240:241],v5 offset:128
cvt v246,v32,v33
mma a[56:59],a[228:231],v[216:219],a[56:59]
s_add_u32 s31, s59, 81920
ldt a[242:243],v5 offset:6272
bld v236,s[48:51],s31 offen lds
v_add_f32 v25, v25, v33
mma a[52:55],a[228:231],v[212:215],a[52:55]
v_add_f32 v25, v25, v34
cvt v247,v34,v35
mma a[52:55],a[224:227],v[196:199],a[52:55]
ldt a[244:245],v5 offset:12416
bld v237,s[48:51],s31 offen offset:1024 lds
v_add_f32 v25, v25, v35
mma a[48:51],a[224:227],v[192:195],a[48:51]
ldt a[246:247],v5 offset:18560
v_add_f32 v26, v26, v36
mma a[48:51],a[228:231],v[208:211],a[48:51]
s_waitcnt lgkmcnt(6)
bld v238,s[48:51],s31 offen offset:2048 lds
cvt v250,v36,v37
mma a[64:67],a[232:235],v[192:195],a[64:67]
s_waitcnt lgkmcnt(4)
v_add_f32 v26, v26, v37
v_add_f32 v26, v26, v38
mma a[64:67],a[236:239],v[208:211],a[64:67]
bld v239,s[48:51],s31 offen offset:3072 lds
cvt v251,v38,v39
mma a[68:71],a[236:239],v[212:215],a[68:71]
v_add_f32 v26, v26, v39
mma a[68:71],a[232:235],v[196:199],a[68:71]
s_mov_b32 m0, 53248
s_nop 0
bld v44,s[48:51],s31 offen lds
v_max3_f32 v40, v24, v25, v26
mma a[72:75],a[232:235],v[200:203],a[72:75]
v_cmp_nge_f32 vcc, s34, v40
mma a[72:75],a[236:239],v[216:219],a[72:75]
s_waitcnt lgkmcnt(2)
mma a[88:91],a[240:243],v[200:203],a[88:91]
s_waitcnt lgkmcnt(0)
v_add_u32 v2, s36, v2
mma a[88:91],a[244:247],v[216:219],a[88:91]
v_add_u32 v3, s36, v3
mma a[84:87],a[244:247],v[212:215],a[84:87]
s_waitcnt vmcnt(49)
s_barrier
mma a[84:87],a[240:243],v[196:199],a[84:87]
mma a[80:83],a[240:243],v[192:195],a[80:83]
mma a[80:83],a[244:247],v[208:211],a[80:83]
s_cbranch_vccnz L_w3_tr30
L_w3_tr30_ret:
mma v[160:163],a[192:195],v[64:67],v[224:227]
s_mov_b32 m0, 54272
s_add_u32 s31, s59, 102400
ldq a[216:219],v2
bld v236,s[48:51],s31 offen lds
v_add_f32 v28, v28, v24
mma v[160:163],a[196:199],v[68:71],v[160:163]
ldq a[220:223],v3
bld v237,s[48:51],s31 offen offset:1024 lds
v_add_f32 v29, v29, v25
mma v[160:163],a[200:203],v[72:75],v[160:163]
ldq a[224:227],v2 offset:128
v_add_f32 v30, v30, v26
mma v[160:163],a[204:207],v[76:79],v[160:163]
ldq a[228:231],v3 offset:128
bld v238,s[48:51],s31 offen offset:2048 lds
mma v[160:163],a[208:211],v[80:83],v[160:163]
ldq a[232:235],v2 offset:256
mma v[160:163],a[212:215],v[84:87],v[160:163]
ldq a[236:239],v3 offset:256
bld v239,s[48:51],s31 offen offset:3072 lds
mma v[164:167],a[212:215],v[108:111],v[228:231]
mma v[164:167],a[208:211],v[104:107],v[164:167]
s_add_u32 s37, s37, 1
s_mov_b32 m0, 58368
s_nop 0
bld v44,s[48:51],s31 offen lds
mma v[164:167],a[204:207],v[100:103],v[164:167]
s_cmp_eq_u32 s37, 7
s_cselect_b32 s36, 4294893568, s43
s_cselect_b32 s37, 0, s37
mma v[164:167],a[200:203],v[96:99],v[164:167]
s_mov_b32 m0, 59392
s_add_u32 s31, s59, 122880
bld v236,s[48:51],s31 offen lds
v_exp_f32 v32, v160
mma v[164:167],a[196:199],v[92:95],v[164:167]
v_exp_f32 v33, v161
v_exp_f32 v34, v162
mma v[164:167],a[192:195],v[88:91],v[164:167]
bld v237,s[48:51],s31 offen offset:1024 lds
v_exp_f32 v35, v163
mma v[168:171],a[192:195],v[112:115],v[232:235]
v_add_f32 v24, v32, v33
cvt v48,v32,v33
v_add_f32 v24, v24, v34
cvt v49,v34,v35
mma v[168:171],a[196:199],v[116:119],v[168:171]
bld v238,s[48:51],s31 offen offset:2048 lds
v_add_f32 v24, v24, v35
mma v[168:171],a[200:203],v[120:123],v[168:171]
bld v239,s[48:51],s31 offen offset:3072 lds
mma v[168:171],a[204:207],v[124:127],v[168:171]
v_exp_f32 v36, v164
v_exp_f32 v37, v165
mma v[168:171],a[208:211],v[128:131],v[168:171]
s_mov_b32 m0, 63488
s_nop 0
bld v44,s[48:51],s31 offen lds
v_exp_f32 v38, v166
mma v[168:171],a[212:215],v[132:135],v[168:171]
s_mov_b32 m0, 64512
s_waitcnt lgkmcnt(5)
v_exp_f32 v39, v167
v_add_f32 v25, v36, v37
cvt v52,v36,v37
mma v[176:179],a[216:219],v[64:67],v[224:227]
s_add_u32 s31, s59, 143360
s_waitcnt lgkmcnt(4)
bld v236,s[48:51],s31 offen lds
v_add_f32 v25, v25, v38
cvt v53,v38,v39
mma v[176:179],a[220:223],v[68:71],v[176:179]
s_waitcnt lgkmcnt(3)
ldq a[192:195],v2 offset:6144
v_add_f32 v25, v25, v39
mma v[176:179],a[224:227],v[72:75],v[176:179]
s_waitcnt lgkmcnt(3)
ldq a[196:199],v3 offset:6144
bld v237,s[48:51],s31 offen offset:1024 lds
mma v[176:179],a[228:231],v[76:79],v[176:179]
s_waitcnt lgkmcnt(3)
ldq a[200:203],v2 offset:6272
v_exp_f32 v32, v168
mma v[176:179],a[232:235],v[80:83],v[176:179]
s_waitcnt lgkmcnt(3)
ldq a[204:207],v3 offset:6272
bld v238,s[48:51],s31 offen offset:2048 lds
mma v[176:179],a[236:239],v[84:87],v[176:179]
ldq a[208:211],v2 offset:6400
v_exp_f32 v33, v169
mma v[180:183],a[236:239],v[108:111],v[228:231]
ldq a[212:215],v3 offset:6400
ldt a[240:241],v6 offset:128
bld v239,s[48:51],s31 offen offset:3072 lds
mma v[180:183],a[232:235],v[104:107],v[180:183]
ldt a[242:243],v6 offset:6272
v_exp_f32 v34, v170
v_add_f32 v26, v32, v33
mma v[180:183],a[228:231],v[100:103],v[180:183]
s_mov_b32 m0, 68608
s_nop 0
bld v44,s[48:51],s31 offen lds
v_exp_f32 v35, v171
mma v[180:183],a[224:227],v[96:99],v[180:183]
s_mov_b32 m0, 110592
s_add_u32 s31, s60, 0
ldt a[244:245],v6 offset:12416
bld v236,s[48:51],s31 offen lds
cvt v56,v32,v33
mma v[180:183],a[220:223],v[92:95],v[180:183]
ldt a[246:247],v6 offset:18560
v_exp_f32 v36, v176
v_add_f32 v26, v26, v34
mma v[180:183],a[216:219],v[88:91],v[180:183]
bld v237,s[48:51],s31 offen offset:1024 lds
v_exp_f32 v37, v177
mma v[184:187],a[216:219],v[112:115],v[232:235]
ldt a[248:249],v7 offset:128
v_exp_f32 v38, v178
mma v[184:187],a[220:223],v[116:119],v[184:187]
ldt a[250:251],v7 offset:6272
bld v238,s[48:51],s31 offen offset:2048 lds
cvt v57,v34,v35
mma v[184:187],a[224:227],v[120:123],v[184:187]
v_exp_f32 v39, v179
mma v[184:187],a[228:231],v[124:127],v[184:187]
ldt a[252:253],v7 offset:12416
bld v239,s[48:51],s31 offen offset:3072 lds
mma v[184:187],a[232:235],v[128:131],v[184:187]
ldt a[254:255],v7 offset:18560
v_exp_f32 v32, v180
mma v[184:187],a[236:239],v[132:135],v[184:187]
s_mov_b32 m0, 114688
s_waitcnt lgkmcnt(6)
bld v44,s[48:51],s31 offen lds
v_exp_f32 v33, v181
mma a[96:99],a[240:243],v[192:195],a[96:99]
s_mov_b32 m0, 115712
s_waitcnt lgkmcnt(4)
ldt a[216:217],v4 offset:256
mma a[96:99],a[244:247],v[208:211],a[96:99]
s_add_u32 s31, s60, 20480
ldt a[218:219],v4 offset:6400
bld v236,s[48:51],s31 offen lds
v_add_f32 v26, v26, v35
mma a[100:103],a[244:247],v[212:215],a[100:103]
v_exp_f32 v34, v182
mma a[100:103],a[240:243],v[196:199],a[100:103]
ldt a[220:221],v4 offset:12544
bld v237,s[48:51],s31 offen offset:1024 lds
v_add_f32 v24, v24, v36
mma a[104:107],a[240:243],v[200:203],a[104:107]
ldt a[222:223],v4 offset:18688
bld v238,s[48:51],s31 offen offset:2048 lds
cvt v50,v36,v37
mma a[104:107],a[244:247],v[216:219],a[104:107]
s_waitcnt lgkmcnt(6)
v_exp_f32 v35, v183
mma a[120:123],a[248:251],v[200:203],a[120:123]
s_waitcnt lgkmcnt(4)
ldt a[224:225],v5 offset:256
bld v239,s[48:51],s31 offen offset:3072 lds
mma a[120:123],a[252:255],v[216:219],a[120:123]
ldt a[226:227],v5 offset:6400
v_exp_f32 v36, v184
mma a[116:119],a[252:255],v[212:215],a[116:119]
s_mov_b32 m0, 119808
s_nop 0
bld v44,s[48:51],s31 offen lds
v_add_f32 v24, v24, v37
mma a[116:119],a[248:251],v[196:199],a[116:119]
s_mov_b32 m0, 120832
ldt a[228:229],v5 offset:12544
v_exp_f32 v37, v185
mma a[112:115],a[248:251],v[192:195],a[112:115]
s_add_u32 s31, s60, 40960
ldt a[230:231],v5 offset:18688
bld v236,s[48:51],s31 offen lds
mma a[112:115],a[252:255],v[208:211],a[112:115]
s_waitcnt lgkmcnt(6)
v_add_f32 v24, v24, v38
mma a[128:131],a[216:219],v[192:195],a[128:131]
s_waitcnt lgkmcnt(4)
ldt a[232:233],v6 offset:256
bld v237,s[48:51],s31 offen offset:1024 lds
cvt v51,v38,v39
mma a[128:131],a[220:223],v[208:211],a[128:131]
ldt a[234:235],v6 offset:6400
v_exp_f32 v38, v186
mma a[132:135],a[220:223],v[212:215],a[132:135]
bld v238,s[48:51],s31 offen offset:2048 lds
v_add_f32 v24, v24, v39
mma a[132:135],a[216:219],v[196:199],a[132:135]
ldt a[236:237],v6 offset:12544
v_exp_f32 v39, v187
mma a[136:139],a[216:219],v[200:203],a[136:139]
ldt a[238:239],v6 offset:18688
bld v239,s[48:51],s31 offen offset:3072 lds
mma a[136:139],a[220:223],v[216:219],a[136:139]
s_mov_b32 m0, 124928
s_waitcnt lgkmcnt(6)
bld v44,s[48:51],s31 offen lds
v_add_f32 v25, v25, v32
mma a[152:155],a[224:227],v[200:203],a[152:155]
s_mov_b32 m0, 125952
s_waitcnt lgkmcnt(4)
ldt a[240:241],v7 offset:256
cvt v54,v32,v33
v_add_f32 v25, v25, v33
mma a[152:155],a[228:231],v[216:219],a[152:155]
s_add_u32 s31, s60, 61440
ldt a[242:243],v7 offset:6400
bld v236,s[48:51],s31 offen lds
v_add_f32 v25, v25, v34
mma a[148:151],a[228:231],v[212:215],a[148:151]
cvt v55,v34,v35
mma a[148:151],a[224:227],v[196:199],a[148:151]
ldt a[244:245],v7 offset:12544
bld v237,s[48:51],s31 offen offset:1024 lds
v_add_f32 v25, v25, v35
mma a[144:147],a[224:227],v[192:195],a[144:147]
ldt a[246:247],v7 offset:18688
v_add_f32 v26, v26, v36
mma a[144:147],a[228:231],v[208:211],a[144:147]
s_waitcnt lgkmcnt(6)
bld v238,s[48:51],s31 offen offset:2048 lds
cvt v58,v36,v37
v_add_f32 v26, v26, v37
mma a[160:163],a[232:235],v[192:195],a[160:163]
s_waitcnt lgkmcnt(4)
v_add_f32 v26, v26, v38
mma a[160:163],a[236:239],v[208:211],a[160:163]
bld v239,s[48:51],s31 offen offset:3072 lds
cvt v59,v38,v39
mma a[164:167],a[236:239],v[212:215],a[164:167]
v_add_f32 v26, v26, v39
mma a[164:167],a[232:235],v[196:199],a[164:167]
s_mov_b32 m0, 130048
s_nop 0
bld v44,s[48:51],s31 offen lds
v_max3_f32 v40, v24, v25, v26
mma a[168:171],a[232:235],v[200:203],a[168:171]
v_cmp_nge_f32 vcc, s34, v40
mma a[168:171],a[236:239],v[216:219],a[168:171]
s_waitcnt lgkmcnt(2)
mma a[184:187],a[240:243],v[200:203],a[184:187]
s_waitcnt lgkmcnt(0)
v_add_u32 v2, s36, v2
mma a[184:187],a[244:247],v[216:219],a[184:187]
v_add_u32 v3, s36, v3
mma a[180:183],a[244:247],v[212:215],a[180:183]
s_waitcnt vmcnt(60)
s_barrier
mma a[180:183],a[240:243],v[196:199],a[180:183]
s_add_u32 s40, s40, 1
mma a[176:179],a[240:243],v[192:195],a[176:179]
s_cmp_eq_u32 s40, 3
s_cselect_b32 s39, 4294918144, s42
s_cselect_b32 s40, 0, s40
mma a[176:179],a[244:247],v[208:211],a[176:179]
s_cbranch_vccnz L_w3_tr31
L_w3_tr31_ret:
v_add_u32 v4, s39, v4
v_add_u32 v5, s39, v5
v_add_u32 v6, s39, v6
v_add_u32 v7, s39, v7
ldt a[240:241],v4
ldt a[242:243],v4 offset:6144
ldt a[244:245],v4 offset:12288
ldt a[246:247],v4 offset:18432
ldt a[248:249],v5
ldt a[250:251],v5 offset:6144
ldt a[252:253],v5 offset:12288
ldt a[254:255],v5 offset:18432
v_add_f32 v28, v28, v24
v_add_f32 v29, v29, v25
v_add_f32 v30, v30, v26
v_mov_b32 v32, v28
v_mov_b32 v33, v29
v_mov_b32 v34, v30
v_permlane32_swap_b32 v28, v32
v_permlane32_swap_b32 v29, v33
v_permlane32_swap_b32 v30, v34
v_add_f32 v28, v28, v32
v_add_f32 v29, v29, v33
v_add_f32 v30, v30, v34
v_mov_b32 v32, v28
v_mov_b32 v33, v29
v_mov_b32 v34, v30
s_waitcnt lgkmcnt(6)
mma a[0:3],a[240:243],v[240:243],a[0:3]
s_mov_b32 m0, 24576
s_add_u32 s31, s59, 163840
s_waitcnt lgkmcnt(4)
ldt a[216:217],v6
bld v236,s[48:51],s31 offen lds
mma a[0:3],a[244:247],v[48:51],a[0:3]
ldt a[218:219],v6 offset:6144
bld v237,s[48:51],s31 offen offset:1024 lds
mma a[4:7],a[244:247],v[52:55],a[4:7]
bld v238,s[48:51],s31 offen offset:2048 lds
v_permlane16_swap_b32 v28, v32
mma a[4:7],a[240:243],v[244:247],a[4:7]
ldt a[220:221],v6 offset:12288
bld v239,s[48:51],s31 offen offset:3072 lds
mma a[8:11],a[240:243],v[248:251],a[8:11]
s_mov_b32 m0, 28672
ldt a[222:223],v6 offset:18432
bld v44,s[48:51],s31 offen lds
mma a[8:11],a[244:247],v[56:59],a[8:11]
s_mov_b32 m0, 29696
s_add_u32 s31, s59, 184320
s_waitcnt lgkmcnt(6)
bld v236,s[48:51],s31 offen lds
v_permlane16_swap_b32 v29, v33
mma a[24:27],a[248:251],v[248:251],a[24:27]
s_waitcnt lgkmcnt(4)
ldt a[224:225],v7
bld v237,s[48:51],s31 offen offset:1024 lds
mma a[24:27],a[252:255],v[56:59],a[24:27]
ldt a[226:227],v7 offset:6144
bld v238,s[48:51],s31 offen offset:2048 lds
mma a[20:23],a[252:255],v[52:55],a[20:23]
bld v239,s[48:51],s31 offen offset:3072 lds
v_permlane16_swap_b32 v30, v34
mma a[20:23],a[248:251],v[244:247],a[20:23]
ldt a[228:229],v7 offset:12288
v_add_f32 v28, v28, v32
v_add_f32 v29, v29, v33
mma a[16:19],a[248:251],v[240:243],a[16:19]
s_mov_b32 m0, 33792
ldt a[230:231],v7 offset:18432
bld v44,s[48:51],s31 offen lds
mma a[16:19],a[252:255],v[48:51],a[16:19]
s_mov_b32 m0, 34816
s_add_u32 s31, s59, 204800
s_waitcnt lgkmcnt(6)
bld v236,s[48:51],s31 offen lds
v_add_f32 v30, v30, v34
mma a[32:35],a[216:219],v[240:243],a[32:35]
s_waitcnt lgkmcnt(4)
ldt a[232:233],v4 offset:128
bld v237,s[48:51],s31 offen offset:1024 lds
mma a[32:35],a[220:223],v[48:51],a[32:35]
ldt a[234:235],v4 offset:6272
bld v238,s[48:51],s31 offen offset:2048 lds
mma a[36:39],a[220:223],v[52:55],a[36:39]
bld v239,s[48:51],s31 offen offset:3072 lds
mma a[36:39],a[216:219],v[244:247],a[36:39]
s_mov_b32 m0, 38912
ldt a[236:237],v4 offset:12416
bld v44,s[48:51],s31 offen lds
mma a[40:43],a[216:219],v[248:251],a[40:43]
s_mov_b32 m0, 39936
s_add_u32 s31, s59, 225280
ldt a[238:239],v4 offset:18560
bld v236,s[48:51],s31 offen lds
mma a[40:43],a[220:223],v[56:59],a[40:43]
s_waitcnt lgkmcnt(6)
bld v237,s[48:51],s31 offen offset:1024 lds
mma a[56:59],a[224:227],v[248:251],a[56:59]
s_waitcnt lgkmcnt(4)
ldt a[240:241],v5 offset:128
v_rcp_f32 v28, v28
mma a[56:59],a[228:231],v[56:59],a[56:59]
ldt a[242:243],v5 offset:6272
bld v238,s[48:51],s31 offen offset:2048 lds
mma a[52:55],a[228:231],v[52:55],a[52:55]
bld v239,s[48:51],s31 offen offset:3072 lds
mma a[52:55],a[224:227],v[244:247],a[52:55]
s_mov_b32 m0, 44032
ldt a[244:245],v5 offset:12416
bld v44,s[48:51],s31 offen lds
mma a[48:51],a[224:227],v[240:243],a[48:51]
s_mov_b32 m0, 131072
s_add_u32 s31, s61, 0
ldt a[246:247],v5 offset:18560
bld v236,s[48:51],s31 offen lds
mma a[48:51],a[228:231],v[48:51],a[48:51]
s_waitcnt lgkmcnt(6)
bld v237,s[48:51],s31 offen offset:1024 lds
mma a[64:67],a[232:235],v[240:243],a[64:67]
s_waitcnt lgkmcnt(4)
ldt a[248:249],v6 offset:128
bld v238,s[48:51],s31 offen offset:2048 lds
mma a[64:67],a[236:239],v[48:51],a[64:67]
ldt a[250:251],v6 offset:6272
bld v239,s[48:51],s31 offen offset:3072 lds
mma a[68:71],a[236:239],v[52:55],a[68:71]
s_mov_b32 m0, 135168
s_nop 0
bld v44,s[48:51],s31 offen lds
mma a[68:71],a[232:235],v[244:247],a[68:71]
s_mov_b32 m0, 136192
ldt a[252:253],v6 offset:12416
v_rcp_f32 v29, v29
mma a[72:75],a[232:235],v[248:251],a[72:75]
s_add_u32 s31, s61, 20480
ldt a[254:255],v6 offset:18560
bld v236,s[48:51],s31 offen lds
mma a[72:75],a[236:239],v[56:59],a[72:75]
s_waitcnt lgkmcnt(6)
bld v237,s[48:51],s31 offen offset:1024 lds
mma a[88:91],a[240:243],v[248:251],a[88:91]
s_waitcnt lgkmcnt(4)
ldt a[216:217],v7 offset:128
bld v238,s[48:51],s31 offen offset:2048 lds
mma a[88:91],a[244:247],v[56:59],a[88:91]
ldt a[218:219],v7 offset:6272
bld v239,s[48:51],s31 offen offset:3072 lds
mma a[84:87],a[244:247],v[52:55],a[84:87]
s_mov_b32 m0, 140288
s_nop 0
bld v44,s[48:51],s31 offen lds
mma a[84:87],a[240:243],v[244:247],a[84:87]
s_mov_b32 m0, 141312
s_add_u32 s31, s61, 40960
ldt a[220:221],v7 offset:12416
bld v236,s[48:51],s31 offen lds
mma a[80:83],a[240:243],v[240:243],a[80:83]
ldt a[222:223],v7 offset:18560
bld v237,s[48:51],s31 offen offset:1024 lds
mma a[80:83],a[244:247],v[48:51],a[80:83]
s_waitcnt lgkmcnt(6)
bld v238,s[48:51],s31 offen offset:2048 lds
mma a[96:99],a[248:251],v[240:243],a[96:99]
s_waitcnt lgkmcnt(4)
ldt a[224:225],v4 offset:256
bld v239,s[48:51],s31 offen offset:3072 lds
mma a[96:99],a[252:255],v[48:51],a[96:99]
ldt a[226:227],v4 offset:6400
v_rcp_f32 v30, v30
mma a[100:103],a[252:255],v[52:55],a[100:103]
s_mov_b32 m0, 145408
s_nop 0
bld v44,s[48:51],s31 offen lds
ard v160,a0
mma a[100:103],a[248:251],v[244:247],a[100:103]
s_mov_b32 m0, 146432
s_add_u32 s31, s61, 61440
ldt a[228:229],v4 offset:12544
bld v236,s[48:51],s31 offen lds
mma a[104:107],a[248:251],v[248:251],a[104:107]
ldt a[230:231],v4 offset:18688
bld v237,s[48:51],s31 offen offset:1024 lds
mma a[104:107],a[252:255],v[56:59],a[104:107]
s_waitcnt lgkmcnt(6)
bld v238,s[48:51],s31 offen offset:2048 lds
ard v161,a1
mma a[120:123],a[216:219],v[248:251],a[120:123]
s_waitcnt lgkmcnt(4)
ldt a[232:233],v5 offset:256
bld v239,s[48:51],s31 offen offset:3072 lds
mma a[120:123],a[220:223],v[56:59],a[120:123]
s_mov_b32 m0, 150528
ldt a[234:235],v5 offset:6400
bld v44,s[48:51],s31 offen lds
mma a[116:119],a[220:223],v[52:55],a[116:119]
s_mov_b32 m0, 151552
s_add_u32 s31, s62, 0
bld v236,s[48:51],s31 offen lds
ard v162,a2
mma a[116:119],a[216:219],v[244:247],a[116:119]
ldt a[236:237],v5 offset:12544
bld v237,s[48:51],s31 offen offset:1024 lds
mma a[112:115],a[216:219],v[240:243],a[112:115]
ldt a[238:239],v5 offset:18688
ard v163,a3
ard v164,a16
mma a[112:115],a[220:223],v[48:51],a[112:115]
s_waitcnt lgkmcnt(6)
bld v238,s[48:51],s31 offen offset:2048 lds
ard v165,a17
mma a[128:131],a[224:227],v[240:243],a[128:131]
s_waitcnt lgkmcnt(4)
ldt a[240:241],v6 offset:256
bld v239,s[48:51],s31 offen offset:3072 lds
mma a[128:131],a[228:231],v[48:51],a[128:131]
s_mov_b32 m0, 155648
ldt a[242:243],v6 offset:6400
bld v44,s[48:51],s31 offen lds
mma a[132:135],a[228:231],v[52:55],a[132:135]
s_mov_b32 m0, 156672
s_add_u32 s31, s62, 20480
bld v236,s[48:51],s31 offen lds
ard v166,a18
mma a[132:135],a[224:227],v[244:247],a[132:135]
ldt a[244:245],v6 offset:12544
bld v237,s[48:51],s31 offen offset:1024 lds
mma a[136:139],a[224:227],v[248:251],a[136:139]
ldt a[246:247],v6 offset:18688
bld v238,s[48:51],s31 offen offset:2048 lds
mma a[136:139],a[228:231],v[56:59],a[136:139]
s_waitcnt lgkmcnt(6)
bld v239,s[48:51],s31 offen offset:3072 lds
ard v167,a19
mma a[152:155],a[232:235],v[248:251],a[152:155]
s_mov_b32 m0, 160768
s_waitcnt lgkmcnt(4)
ldt a[248:249],v7 offset:256
bld v44,s[48:51],s31 offen lds
mma a[152:155],a[236:239],v[56:59],a[152:155]
ldt a[250:251],v7 offset:6400
v_mul_f32 v160, v160, v28
v_mul_f32 v161, v161, v28
mma a[148:151],a[236:239],v[52:55],a[148:151]
v_mul_f32 v162, v162, v28
v_mul_f32 v163, v163, v28
v_mul_f32 v164, v164, v28
mma a[148:151],a[232:235],v[244:247],a[148:151]
ldt a[252:253],v7 offset:12544
v_mul_f32 v165, v165, v28
v_mul_f32 v166, v166, v28
mma a[144:147],a[232:235],v[240:243],a[144:147]
ldt a[254:255],v7 offset:18688
v_mul_f32 v167, v167, v28
cvt v64,v160,v161
mma a[144:147],a[236:239],v[48:51],a[144:147]
s_waitcnt lgkmcnt(6)
cvt v65,v162,v163
cvt v66,v164,v165
cvt v67,v166,v167
mma a[160:163],a[240:243],v[240:243],a[160:163]
s_add_u32 s42, s41, 0
s_waitcnt lgkmcnt(4)
buffer_store_dwordx4 v[64:67], v21, s[20:23], s42 offen sc1
ard v168,a4
mma a[160:163],a[244:247],v[48:51],a[160:163]
ard v169,a5
ard v170,a6
ard v171,a7
mma a[164:167],a[244:247],v[52:55],a[164:167]
ard v172,a20
ard v173,a21
ard v174,a22
mma a[164:167],a[240:243],v[244:247],a[164:167]
ard v175,a23
v_mul_f32 v168, v168, v29
v_mul_f32 v169, v169, v29
mma a[168:171],a[240:243],v[248:251],a[168:171]
v_mul_f32 v170, v170, v29
v_mul_f32 v171, v171, v29
v_mul_f32 v172, v172, v29
mma a[168:171],a[244:247],v[56:59],a[168:171]
s_waitcnt lgkmcnt(2)
v_mul_f32 v173, v173, v29
v_mul_f32 v174, v174, v29
v_mul_f32 v175, v175, v29
mma a[184:187],a[248:251],v[248:251],a[184:187]
s_waitcnt lgkmcnt(0)
cvt v88,v168,v169
cvt v89,v170,v171
cvt v90,v172,v173
mma a[184:187],a[252:255],v[56:59],a[184:187]
s_add_u32 s42, s41, 6144
cvt v91,v174,v175
buffer_store_dwordx4 v[88:91], v21, s[20:23], s42 offen sc1
mma a[180:183],a[252:255],v[52:55],a[180:183]
ard v176,a8
ard v177,a9
ard v178,a10
mma a[180:183],a[248:251],v[244:247],a[180:183]
ard v179,a11
ard v180,a24
ard v181,a25
mma a[176:179],a[248:251],v[240:243],a[176:179]
ard v182,a26
ard v183,a27
v_mul_f32 v176, v176, v30
mma a[176:179],a[252:255],v[48:51],a[176:179]
v_mul_f32 v177, v177, v30
v_mul_f32 v178, v178, v30
v_mul_f32 v179, v179, v30
v_mul_f32 v180, v180, v30
v_mul_f32 v181, v181, v30
v_mul_f32 v182, v182, v30
v_mul_f32 v183, v183, v30
cvt v112,v176,v177
cvt v113,v178,v179
cvt v114,v180,v181
cvt v115,v182,v183
s_add_u32 s42, s41, 12288
buffer_store_dwordx4 v[112:115], v21, s[20:23], s42 offen sc1
ard v184,a32
ard v185,a33
ard v186,a34
ard v187,a35
ard v188,a48
ard v189,a49
ard v190,a50
ard v191,a51
v_mul_f32 v184, v184, v28
v_mul_f32 v185, v185, v28
v_mul_f32 v186, v186, v28
v_mul_f32 v187, v187, v28
v_mul_f32 v188, v188, v28
v_mul_f32 v189, v189, v28
v_mul_f32 v190, v190, v28
v_mul_f32 v191, v191, v28
cvt v68,v184,v185
cvt v69,v186,v187
cvt v70,v188,v189
cvt v71,v190,v191
s_add_u32 s42, s41, 1024
buffer_store_dwordx4 v[68:71], v21, s[20:23], s42 offen sc1
ard v160,a36
ard v161,a37
ard v162,a38
ard v163,a39
ard v164,a52
ard v165,a53
ard v166,a54
ard v167,a55
v_mul_f32 v160, v160, v29
v_mul_f32 v161, v161, v29
v_mul_f32 v162, v162, v29
v_mul_f32 v163, v163, v29
v_mul_f32 v164, v164, v29
v_mul_f32 v165, v165, v29
v_mul_f32 v166, v166, v29
v_mul_f32 v167, v167, v29
cvt v92,v160,v161
cvt v93,v162,v163
cvt v94,v164,v165
cvt v95,v166,v167
s_add_u32 s42, s41, 7168
buffer_store_dwordx4 v[92:95], v21, s[20:23], s42 offen sc1
ard v168,a40
ard v169,a41
ard v170,a42
ard v171,a43
ard v172,a56
ard v173,a57
ard v174,a58
ard v175,a59
v_mul_f32 v168, v168, v30
v_mul_f32 v169, v169, v30
v_mul_f32 v170, v170, v30
v_mul_f32 v171, v171, v30
v_mul_f32 v172, v172, v30
v_mul_f32 v173, v173, v30
v_mul_f32 v174, v174, v30
v_mul_f32 v175, v175, v30
cvt v116,v168,v169
cvt v117,v170,v171
cvt v118,v172,v173
cvt v119,v174,v175
s_add_u32 s42, s41, 13312
buffer_store_dwordx4 v[116:119], v21, s[20:23], s42 offen sc1
ard v176,a64
ard v177,a65
ard v178,a66
ard v179,a67
ard v180,a80
ard v181,a81
ard v182,a82
ard v183,a83
v_mul_f32 v176, v176, v28
v_mul_f32 v177, v177, v28
v_mul_f32 v178, v178, v28
v_mul_f32 v179, v179, v28
v_mul_f32 v180, v180, v28
v_mul_f32 v181, v181, v28
v_mul_f32 v182, v182, v28
v_mul_f32 v183, v183, v28
cvt v72,v176,v177
cvt v73,v178,v179
cvt v74,v180,v181
cvt v75,v182,v183
ard v184,a68
ard v185,a69
ard v186,a70
ard v187,a71
ard v188,a84
ard v189,a85
ard v190,a86
ard v191,a87
v_mul_f32 v184, v184, v29
v_mul_f32 v185, v185, v29
v_mul_f32 v186, v186, v29
v_mul_f32 v187, v187, v29
v_mul_f32 v188, v188, v29
v_mul_f32 v189, v189, v29
v_mul_f32 v190, v190, v29
v_mul_f32 v191, v191, v29
cvt v96,v184,v185
cvt v97,v186,v187
cvt v98,v188,v189
cvt v99,v190,v191
ard v160,a72
ard v161,a73
ard v162,a74
ard v163,a75
ard v164,a88
ard v165,a89
ard v166,a90
ard v167,a91
v_mul_f32 v160, v160, v30
v_mul_f32 v161, v161, v30
v_mul_f32 v162, v162, v30
v_mul_f32 v163, v163, v30
v_mul_f32 v164, v164, v30
v_mul_f32 v165, v165, v30
v_mul_f32 v166, v166, v30
v_mul_f32 v167, v167, v30
cvt v120,v160,v161
cvt v121,v162,v163
cvt v122,v164,v165
cvt v123,v166,v167
ard v168,a96
ard v169,a97
ard v170,a98
ard v171,a99
ard v172,a112
ard v173,a113
ard v174,a114
ard v175,a115
v_mul_f32 v168, v168, v28
v_mul_f32 v169, v169, v28
v_mul_f32 v170, v170, v28
v_mul_f32 v171, v171, v28
v_mul_f32 v172, v172, v28
v_mul_f32 v173, v173, v28
v_mul_f32 v174, v174, v28
v_mul_f32 v175, v175, v28
cvt v76,v168,v169
cvt v77,v170,v171
cvt v78,v172,v173
cvt v79,v174,v175
s_add_u32 s42, s41, 2048
buffer_store_dwordx4 v[72:75], v21, s[20:23], s42 offen sc1
ard v176,a100
ard v177,a101
ard v178,a102
ard v179,a103
ard v180,a116
ard v181,a117
ard v182,a118
ard v183,a119
v_mul_f32 v176, v176, v29
v_mul_f32 v177, v177, v29
v_mul_f32 v178, v178, v29
v_mul_f32 v179, v179, v29
v_mul_f32 v180, v180, v29
v_mul_f32 v181, v181, v29
v_mul_f32 v182, v182, v29
v_mul_f32 v183, v183, v29
cvt v100,v176,v177
cvt v101,v178,v179
cvt v102,v180,v181
cvt v103,v182,v183
ard v184,a104
ard v185,a105
ard v186,a106
ard v187,a107
ard v188,a120
ard v189,a121
ard v190,a122
ard v191,a123
v_mul_f32 v184, v184, v30
v_mul_f32 v185, v185, v30
v_mul_f32 v186, v186, v30
v_mul_f32 v187, v187, v30
v_mul_f32 v188, v188, v30
v_mul_f32 v189, v189, v30
v_mul_f32 v190, v190, v30
v_mul_f32 v191, v191, v30
cvt v124,v184,v185
cvt v125,v186,v187
cvt v126,v188,v189
cvt v127,v190,v191
s_waitcnt vmcnt(37)
s_barrier
ldt a[192:193],v15
ldt a[194:195],v15 offset:5120
ldt a[196:197],v15 offset:10240
ldt a[198:199],v15 offset:15360
ldt a[200:201],v15 offset:49152
ldt a[202:203],v15 offset:54272
ldt a[204:205],v15 offset:59392
ldt a[206:207],v15 offset:64512
ldt a[208:209],v15 offset:24576
ldt a[210:211],v15 offset:29696
ldt a[212:213],v15 offset:34816
ldt a[214:215],v15 offset:39936
ard v160,a128
ard v161,a129
ard v162,a130
ard v163,a131
ard v164,a144
ard v165,a145
ard v166,a146
ard v167,a147
v_mul_f32 v160, v160, v28
v_mul_f32 v161, v161, v28
v_mul_f32 v162, v162, v28
v_mul_f32 v163, v163, v28
v_mul_f32 v164, v164, v28
v_mul_f32 v165, v165, v28
v_mul_f32 v166, v166, v28
v_mul_f32 v167, v167, v28
cvt v80,v160,v161
cvt v81,v162,v163
cvt v82,v164,v165
cvt v83,v166,v167
ard v168,a132
ard v169,a133
ard v170,a134
ard v171,a135
ard v172,a148
ard v173,a149
ard v174,a150
ard v175,a151
v_mul_f32 v168, v168, v29
v_mul_f32 v169, v169, v29
v_mul_f32 v170, v170, v29
v_mul_f32 v171, v171, v29
v_mul_f32 v172, v172, v29
v_mul_f32 v173, v173, v29
v_mul_f32 v174, v174, v29
v_mul_f32 v175, v175, v29
cvt v104,v168,v169
cvt v105,v170,v171
cvt v106,v172,v173
cvt v107,v174,v175
s_add_u32 s42, s41, 8192
buffer_store_dwordx4 v[96:99], v21, s[20:23], s42 offen sc1
ard v176,a136
ard v177,a137
ard v178,a138
ard v179,a139
ard v180,a152
ard v181,a153
ard v182,a154
ard v183,a155
v_mul_f32 v176, v176, v30
v_mul_f32 v177, v177, v30
v_mul_f32 v178, v178, v30
v_mul_f32 v179, v179, v30
v_mul_f32 v180, v180, v30
v_mul_f32 v181, v181, v30
v_mul_f32 v182, v182, v30
v_mul_f32 v183, v183, v30
cvt v128,v176,v177
cvt v129,v178,v179
cvt v130,v180,v181
cvt v131,v182,v183
ard v184,a160
ard v185,a161
ard v186,a162
ard v187,a163
ard v188,a176
ard v189,a177
ard v190,a178
ard v191,a179
v_mul_f32 v184, v184, v28
v_mul_f32 v185, v185, v28
v_mul_f32 v186, v186, v28
v_mul_f32 v187, v187, v28
v_mul_f32 v188, v188, v28
v_mul_f32 v189, v189, v28
v_mul_f32 v190, v190, v28
v_mul_f32 v191, v191, v28
cvt v84,v184,v185
cvt v85,v186,v187
cvt v86,v188,v189
cvt v87,v190,v191
ard v160,a164
ard v161,a165
ard v162,a166
ard v163,a167
ard v164,a180
ard v165,a181
ard v166,a182
ard v167,a183
v_mul_f32 v160, v160, v29
v_mul_f32 v161, v161, v29
v_mul_f32 v162, v162, v29
v_mul_f32 v163, v163, v29
v_mul_f32 v164, v164, v29
v_mul_f32 v165, v165, v29
v_mul_f32 v166, v166, v29
v_mul_f32 v167, v167, v29
cvt v108,v160,v161
cvt v109,v162,v163
cvt v110,v164,v165
cvt v111,v166,v167
ard v168,a168
ard v169,a169
ard v170,a170
ard v171,a171
ard v172,a184
ard v173,a185
ard v174,a186
ard v175,a187
v_mul_f32 v168, v168, v30
v_mul_f32 v169, v169, v30
v_mul_f32 v170, v170, v30
v_mul_f32 v171, v171, v30
v_mul_f32 v172, v172, v30
v_mul_f32 v173, v173, v30
v_mul_f32 v174, v174, v30
v_mul_f32 v175, v175, v30
cvt v132,v168,v169
cvt v133,v170,v171
cvt v134,v172,v173
cvt v135,v174,v175
s_add_u32 s42, s41, 14336
s_waitcnt lgkmcnt(10)
buffer_store_dwordx4 v[120:123], v21, s[20:23], s42 offen sc1
mma a[96:99],a[192:195],v[64:67],0
s_waitcnt lgkmcnt(8)
ldt a[216:217],v16
mma a[96:99],a[196:199],v[68:71],a[96:99]
s_waitcnt lgkmcnt(7)
ldt a[218:219],v16 offset:5120
mma a[96:99],a[200:203],v[72:75],a[96:99]
s_waitcnt vmcnt(3)
s_waitcnt lgkmcnt(6)
buffer_store_dword v47, v17, s[20:23], 0 offen sc1
ldt a[220:221],v16 offset:10240
mma a[96:99],a[204:207],v[76:79],a[96:99]
s_waitcnt lgkmcnt(5)
ldt a[222:223],v16 offset:15360
mma a[96:99],a[208:211],v[80:83],a[96:99]
s_add_u32 s42, s41, 3072
s_waitcnt lgkmcnt(4)
ldt a[224:225],v16 offset:49152
buffer_store_dwordx4 v[76:79], v21, s[20:23], s42 offen sc1
mma a[96:99],a[212:215],v[84:87],a[96:99]
ldt a[226:227],v16 offset:54272
mma a[100:103],a[212:215],v[108:111],0
ldt a[228:229],v16 offset:59392
mma a[100:103],a[208:211],v[104:107],a[100:103]
v_add_u32 v5, 100352, v15
v_add_u32 v6, 100352, v16
ldt a[230:231],v16 offset:64512
mma a[100:103],a[204:207],v[100:103],a[100:103]
ldt a[232:233],v16 offset:24576
mma a[100:103],a[200:203],v[96:99],a[100:103]
ldt a[234:235],v16 offset:29696
mma a[100:103],a[196:199],v[92:95],a[100:103]
ldt a[236:237],v16 offset:34816
mma a[100:103],a[192:195],v[88:91],a[100:103]
ldt a[238:239],v16 offset:39936
mma a[104:107],a[192:195],v[112:115],0
mma a[104:107],a[196:199],v[116:119],a[104:107]
mma a[104:107],a[200:203],v[120:123],a[104:107]
mma a[104:107],a[204:207],v[124:127],a[104:107]
mma a[104:107],a[208:211],v[128:131],a[104:107]
mma a[104:107],a[212:215],v[132:135],a[104:107]
s_waitcnt lgkmcnt(10)
mma a[112:115],a[216:219],v[64:67],0
s_waitcnt lgkmcnt(8)
ldt a[192:193],v15 offset:64
awr a160,v84
mma a[112:115],a[220:223],v[68:71],a[112:115]
s_add_u32 s42, s41, 9216
s_waitcnt lgkmcnt(7)
ldt a[194:195],v15 offset:5184
buffer_store_dwordx4 v[100:103], v21, s[20:23], s42 offen sc1
mma a[112:115],a[224:227],v[72:75],a[112:115]
s_waitcnt lgkmcnt(6)
ldt a[196:197],v15 offset:10304
mma a[112:115],a[228:231],v[76:79],a[112:115]
s_waitcnt lgkmcnt(5)
ldt a[198:199],v15 offset:15424
awr a161,v85
mma a[112:115],a[232:235],v[80:83],a[112:115]
s_waitcnt lgkmcnt(4)
ldt a[200:201],v15 offset:49216
mma a[112:115],a[236:239],v[84:87],a[112:115]
ldt a[202:203],v15 offset:54336
mma a[116:119],a[236:239],v[108:111],0
ldt a[204:205],v15 offset:59456
awr a162,v86
mma a[116:119],a[232:235],v[104:107],a[116:119]
ldt a[206:207],v15 offset:64576
mma a[116:119],a[228:231],v[100:103],a[116:119]
ldt a[208:209],v15 offset:24640
mma a[116:119],a[224:227],v[96:99],a[116:119]
ldt a[210:211],v15 offset:29760
awr a163,v87
mma a[116:119],a[220:223],v[92:95],a[116:119]
ldt a[212:213],v15 offset:34880
mma a[116:119],a[216:219],v[88:91],a[116:119]
ldt a[214:215],v15 offset:40000
mma a[120:123],a[216:219],v[112:115],0
awr a164,v108
mma a[120:123],a[220:223],v[116:119],a[120:123]
mma a[120:123],a[224:227],v[120:123],a[120:123]
s_add_u32 s42, s41, 15360
buffer_store_dwordx4 v[124:127], v21, s[20:23], s42 offen sc1
mma a[120:123],a[228:231],v[124:127],a[120:123]
awr a165,v109
mma a[120:123],a[232:235],v[128:131],a[120:123]
mma a[120:123],a[236:239],v[132:135],a[120:123]
s_waitcnt lgkmcnt(10)
mma a[128:131],a[192:195],v[64:67],0
s_waitcnt lgkmcnt(8)
ldt a[216:217],v16 offset:64
awr a166,v110
mma a[128:131],a[196:199],v[68:71],a[128:131]
s_waitcnt lgkmcnt(7)
ldt a[218:219],v16 offset:5184
mma a[128:131],a[200:203],v[72:75],a[128:131]
s_waitcnt lgkmcnt(6)
ldt a[220:221],v16 offset:10304
mma a[128:131],a[204:207],v[76:79],a[128:131]
s_waitcnt lgkmcnt(5)
ldt a[222:223],v16 offset:15424
awr a167,v111
mma a[128:131],a[208:211],v[80:83],a[128:131]
s_waitcnt lgkmcnt(4)
ldt a[224:225],v16 offset:49216
mma a[128:131],a[212:215],v[84:87],a[128:131]
ldt a[226:227],v16 offset:54336
mma a[132:135],a[212:215],v[108:111],0
ldt a[228:229],v16 offset:59456
awr a168,v132
mma a[132:135],a[208:211],v[104:107],a[132:135]
ldt a[230:231],v16 offset:64576
mma a[132:135],a[204:207],v[100:103],a[132:135]
ldt a[232:233],v16 offset:24640
mma a[132:135],a[200:203],v[96:99],a[132:135]
ldt a[234:235],v16 offset:29760
awr a169,v133
mma a[132:135],a[196:199],v[92:95],a[132:135]
ldt a[236:237],v16 offset:34880
mma a[132:135],a[192:195],v[88:91],a[132:135]
s_add_u32 s42, s41, 4096
ldt a[238:239],v16 offset:40000
buffer_store_dwordx4 v[80:83], v21, s[20:23], s42 offen sc1
mma a[136:139],a[192:195],v[112:115],0
awr a170,v134
mma a[136:139],a[196:199],v[116:119],a[136:139]
mma a[136:139],a[200:203],v[120:123],a[136:139]
mma a[136:139],a[204:207],v[124:127],a[136:139]
awr a171,v135
mma a[136:139],a[208:211],v[128:131],a[136:139]
mma a[136:139],a[212:215],v[132:135],a[136:139]
s_waitcnt lgkmcnt(10)
mma a[144:147],a[216:219],v[64:67],0
s_buffer_load_dwordx4 s[88:91], s[20:23], s87 glc
ldt a[192:193],v15 offset:128
s_waitcnt lgkmcnt(9)
mma a[144:147],a[220:223],v[68:71],a[144:147]
s_waitcnt lgkmcnt(7)
ldt a[194:195],v15 offset:5248
mma a[144:147],a[224:227],v[72:75],a[144:147]
s_waitcnt lgkmcnt(6)
ldt a[196:197],v15 offset:10368
mma a[144:147],a[228:231],v[76:79],a[144:147]
s_waitcnt lgkmcnt(5)
ldt a[198:199],v15 offset:15488
mma a[144:147],a[232:235],v[80:83],a[144:147]
s_waitcnt lgkmcnt(4)
ldt a[200:201],v15 offset:49280
mma a[144:147],a[236:239],v[84:87],a[144:147]
ldt a[202:203],v15 offset:54400
mma a[148:151],a[236:239],v[108:111],0
ldt a[204:205],v15 offset:59520
mma a[148:151],a[232:235],v[104:107],a[148:151]
s_add_u32 s42, s41, 10240
ldt a[206:207],v15 offset:64640
buffer_store_dwordx4 v[104:107], v21, s[20:23], s42 offen sc1
mma a[148:151],a[228:231],v[100:103],a[148:151]
ldt a[208:209],v15 offset:24704
mma a[148:151],a[224:227],v[96:99],a[148:151]
ldt a[210:211],v15 offset:29824
mma a[148:151],a[220:223],v[92:95],a[148:151]
ldt a[212:213],v15 offset:34944
mma a[148:151],a[216:219],v[88:91],a[148:151]
ldt a[214:215],v15 offset:40064
mma a[152:155],a[216:219],v[112:115],0
mma a[152:155],a[220:223],v[116:119],a[152:155]
mma a[152:155],a[224:227],v[120:123],a[152:155]
mma a[152:155],a[228:231],v[124:127],a[152:155]
mma a[152:155],a[232:235],v[128:131],a[152:155]
mma a[152:155],a[236:239],v[132:135],a[152:155]
s_waitcnt lgkmcnt(10)
mma v[160:163],a[192:195],v[64:67],0
s_waitcnt lgkmcnt(8)
ldt a[216:217],v16 offset:128
mma v[160:163],a[196:199],v[68:71],v[160:163]
s_waitcnt lgkmcnt(7)
ldt a[218:219],v16 offset:5248
mma v[160:163],a[200:203],v[72:75],v[160:163]
s_waitcnt lgkmcnt(6)
ldt a[220:221],v16 offset:10368
mma v[160:163],a[204:207],v[76:79],v[160:163]
s_add_u32 s42, s41, 16384
s_waitcnt lgkmcnt(5)
ldt a[222:223],v16 offset:15488
buffer_store_dwordx4 v[128:131], v21, s[20:23], s42 offen sc1
mma v[160:163],a[208:211],v[80:83],v[160:163]
s_waitcnt lgkmcnt(4)
ldt a[224:225],v16 offset:49280
mma v[160:163],a[212:215],v[84:87],v[160:163]
ldt a[226:227],v16 offset:54400
mma v[164:167],a[212:215],v[108:111],0
ldt a[228:229],v16 offset:59520
mma v[164:167],a[208:211],v[104:107],v[164:167]
ldt a[230:231],v16 offset:64640
mma v[164:167],a[204:207],v[100:103],v[164:167]
ldt a[232:233],v16 offset:24704
mma v[164:167],a[200:203],v[96:99],v[164:167]
ldt a[234:235],v16 offset:29824
mma v[164:167],a[196:199],v[92:95],v[164:167]
ldt a[236:237],v16 offset:34944
mma v[164:167],a[192:195],v[88:91],v[164:167]
ldt a[238:239],v16 offset:40064
mma v[168:171],a[192:195],v[112:115],0
mma v[168:171],a[196:199],v[116:119],v[168:171]
mma v[168:171],a[200:203],v[120:123],v[168:171]
mma v[168:171],a[204:207],v[124:127],v[168:171]
mma v[168:171],a[208:211],v[128:131],v[168:171]
mma v[168:171],a[212:215],v[132:135],v[168:171]
s_waitcnt lgkmcnt(10)
mma v[176:179],a[216:219],v[64:67],0
s_mov_b32 m0, 100352
s_add_u32 s31, s62, 40960
s_waitcnt lgkmcnt(8)
ldt a[192:193],v15 offset:192
bld v236,s[48:51],s31 offen lds
mma v[176:179],a[220:223],v[68:71],v[176:179]
s_waitcnt lgkmcnt(7)
ldt a[194:195],v15 offset:5312
bld v237,s[48:51],s31 offen offset:1024 lds
mma v[176:179],a[224:227],v[72:75],v[176:179]
s_waitcnt lgkmcnt(6)
ldt a[196:197],v15 offset:10432
mma v[176:179],a[228:231],v[76:79],v[176:179]
s_waitcnt lgkmcnt(5)
ldt a[198:199],v15 offset:15552
bld v238,s[48:51],s31 offen offset:2048 lds
mma v[176:179],a[232:235],v[80:83],v[176:179]
s_waitcnt lgkmcnt(4)
ldt a[200:201],v15 offset:49344
mma v[176:179],a[236:239],v[84:87],v[176:179]
ldt a[202:203],v15 offset:54464
bld v239,s[48:51],s31 offen offset:3072 lds
mma v[180:183],a[236:239],v[108:111],0
ldt a[204:205],v15 offset:59584
mma v[180:183],a[232:235],v[104:107],v[180:183]
s_mov_b32 m0, 104448
ldt a[206:207],v15 offset:64704
bld v44,s[48:51],s31 offen lds
mma v[180:183],a[228:231],v[100:103],v[180:183]
s_mov_b32 m0, 105472
ldt a[208:209],v15 offset:24768
mma v[180:183],a[224:227],v[96:99],v[180:183]
s_add_u32 s31, s62, 61440
ldt a[210:211],v15 offset:29888
bld v236,s[48:51],s31 offen lds
mma v[180:183],a[220:223],v[92:95],v[180:183]
ldt a[212:213],v15 offset:35008
bld v237,s[48:51],s31 offen offset:1024 lds
mma v[180:183],a[216:219],v[88:91],v[180:183]
ldt a[214:215],v15 offset:40128
mma v[184:187],a[216:219],v[112:115],0
bld v238,s[48:51],s31 offen offset:2048 lds
mma v[184:187],a[220:223],v[116:119],v[184:187]
mma v[184:187],a[224:227],v[120:123],v[184:187]
bld v239,s[48:51],s31 offen offset:3072 lds
mma v[184:187],a[228:231],v[124:127],v[184:187]
mma v[184:187],a[232:235],v[128:131],v[184:187]
s_mov_b32 m0, 109568
s_nop 0
bld v44,s[48:51],s31 offen lds
mma v[184:187],a[236:239],v[132:135],v[184:187]
s_waitcnt lgkmcnt(0)
s_add_u32 s88, s88, s89
s_add_u32 s88, s88, s90
s_add_u32 s88, s88, s91
s_cmp_eq_u32 s88, 3
s_cbranch_scc0 L_w3_poll0
L_w3_poll0_ret:
mma v[192:195],a[192:195],v[64:67],0
s_add_u32 s38, s56, 0
ldt a[216:217],v16 offset:192
bld a[0:3],v21,s[20:23],s38 offen sc1
mma v[192:195],a[196:199],v[68:71],v[192:195]
ldt a[218:219],v16 offset:5312
mma v[192:195],a[200:203],v[72:75],v[192:195]
ldt a[220:221],v16 offset:10432
mma v[192:195],a[204:207],v[76:79],v[192:195]
ldt a[222:223],v16 offset:15552
bld a[4:7],v21,s[20:23],s38 offen offset:1024 sc1
mma v[192:195],a[208:211],v[80:83],v[192:195]
ldt a[224:225],v16 offset:49344
mma v[192:195],a[212:215],v[84:87],v[192:195]
ldt a[226:227],v16 offset:54464
mma v[196:199],a[212:215],v[108:111],0
ldt a[228:229],v16 offset:59584
mma v[196:199],a[208:211],v[104:107],v[196:199]
s_add_u32 s38, s57, 0
ldt a[230:231],v16 offset:64704
bld a[8:11],v21,s[20:23],s38 offen sc1
mma v[196:199],a[204:207],v[100:103],v[196:199]
ldt a[232:233],v16 offset:24768
mma v[196:199],a[200:203],v[96:99],v[196:199]
ldt a[234:235],v16 offset:29888
mma v[196:199],a[196:199],v[92:95],v[196:199]
ldt a[236:237],v16 offset:35008
bld a[12:15],v21,s[20:23],s38 offen offset:1024 sc1
mma v[196:199],a[192:195],v[88:91],v[196:199]
ldt a[238:239],v16 offset:40128
mma v[200:203],a[192:195],v[112:115],0
mma v[200:203],a[196:199],v[116:119],v[200:203]
mma v[200:203],a[200:203],v[120:123],v[200:203]
s_add_u32 s38, s58, 0
bld a[16:19],v21,s[20:23],s38 offen sc1
mma v[200:203],a[204:207],v[124:127],v[200:203]
mma v[200:203],a[208:211],v[128:131],v[200:203]
mma v[200:203],a[212:215],v[132:135],v[200:203]
s_waitcnt lgkmcnt(10)
bld a[20:23],v21,s[20:23],s38 offen offset:1024 sc1
mma v[208:211],a[216:219],v[64:67],0
s_waitcnt lgkmcnt(8)
ldt a[192:193],v15 offset:256
mma v[208:211],a[220:223],v[68:71],v[208:211]
s_waitcnt lgkmcnt(7)
ldt a[194:195],v15 offset:5376
mma v[208:211],a[224:227],v[72:75],v[208:211]
s_waitcnt lgkmcnt(6)
ldt a[196:197],v15 offset:10496
mma v[208:211],a[228:231],v[76:79],v[208:211]
s_add_u32 s38, s56, 6144
s_waitcnt lgkmcnt(5)
ldt a[198:199],v15 offset:15616
bld a[24:27],v21,s[20:23],s38 offen sc1
mma v[208:211],a[232:235],v[80:83],v[208:211]
s_waitcnt lgkmcnt(4)
ldt a[200:201],v15 offset:49408
mma v[208:211],a[236:239],v[84:87],v[208:211]
ldt a[202:203],v15 offset:54528
mma v[212:215],a[236:239],v[108:111],0
ldt a[204:205],v15 offset:59648
bld a[28:31],v21,s[20:23],s38 offen offset:1024 sc1
mma v[212:215],a[232:235],v[104:107],v[212:215]
ldt a[206:207],v15 offset:64768
mma v[212:215],a[228:231],v[100:103],v[212:215]
ldt a[208:209],v15 offset:24832
mma v[212:215],a[224:227],v[96:99],v[212:215]
ldt a[210:211],v15 offset:29952
mma v[212:215],a[220:223],v[92:95],v[212:215]
s_add_u32 s38, s57, 6144
ldt a[212:213],v15 offset:35072
bld a[32:35],v21,s[20:23],s38 offen sc1
mma v[212:215],a[216:219],v[88:91],v[212:215]
ldt a[214:215],v15 offset:40192
mma v[216:219],a[216:219],v[112:115],0
mma v[216:219],a[220:223],v[116:119],v[216:219]
bld a[36:39],v21,s[20:23],s38 offen offset:1024 sc1
mma v[216:219],a[224:227],v[120:123],v[216:219]
mma v[216:219],a[228:231],v[124:127],v[216:219]
mma v[216:219],a[232:235],v[128:131],v[216:219]
mma v[216:219],a[236:239],v[132:135],v[216:219]
s_add_u32 s38, s58, 6144
s_waitcnt lgkmcnt(10)
bld a[40:43],v21,s[20:23],s38 offen sc1
mma v[224:227],a[192:195],v[64:67],0
s_waitcnt vmcnt(24)
s_waitcnt lgkmcnt(8)
buffer_store_dword v47, v17, s[20:23], 0 offen offset:128 sc1
ldt a[216:217],v16 offset:256
mma v[224:227],a[196:199],v[68:71],v[224:227]
s_waitcnt lgkmcnt(7)
ldt a[218:219],v16 offset:5376
mma v[224:227],a[200:203],v[72:75],v[224:227]
s_waitcnt lgkmcnt(6)
ldt a[220:221],v16 offset:10496
bld a[44:47],v21,s[20:23],s38 offen offset:1024 sc1
mma v[224:227],a[204:207],v[76:79],v[224:227]
s_waitcnt lgkmcnt(5)
ldt a[222:223],v16 offset:15616
mma v[224:227],a[208:211],v[80:83],v[224:227]
s_waitcnt lgkmcnt(4)
ldt a[224:225],v16 offset:49408
mma v[224:227],a[212:215],v[84:87],v[224:227]
ldt a[226:227],v16 offset:54528
mma v[228:231],a[212:215],v[108:111],0
s_add_u32 s38, s56, 12288
ldt a[228:229],v16 offset:59648
bld a[48:51],v21,s[20:23],s38 offen sc1
mma v[228:231],a[208:211],v[104:107],v[228:231]
ldt a[230:231],v16 offset:64768
mma v[228:231],a[204:207],v[100:103],v[228:231]
ldt a[232:233],v16 offset:24832
mma v[228:231],a[200:203],v[96:99],v[228:231]
ldt a[234:235],v16 offset:29952
bld a[52:55],v21,s[20:23],s38 offen offset:1024 sc1
mma v[228:231],a[196:199],v[92:95],v[228:231]
ldt a[236:237],v16 offset:35072
mma v[228:231],a[192:195],v[88:91],v[228:231]
ldt a[238:239],v16 offset:40192
mma v[232:235],a[192:195],v[112:115],0
mma v[232:235],a[196:199],v[116:119],v[232:235]
s_add_u32 s38, s57, 12288
bld a[56:59],v21,s[20:23],s38 offen sc1
mma v[232:235],a[200:203],v[120:123],v[232:235]
mma v[232:235],a[204:207],v[124:127],v[232:235]
mma v[232:235],a[208:211],v[128:131],v[232:235]
bld a[60:63],v21,s[20:23],s38 offen offset:1024 sc1
mma v[232:235],a[212:215],v[132:135],v[232:235]
s_waitcnt lgkmcnt(10)
mma v[240:243],a[216:219],v[64:67],0
s_waitcnt vmcnt(17) lgkmcnt(0)
s_barrier
mma v[240:243],a[220:223],v[68:71],v[240:243]
ldt a[192:193],v5 offset:10240
mma v[240:243],a[224:227],v[72:75],v[240:243]
s_add_u32 s38, s58, 12288
ldt a[194:195],v5 offset:15360
bld a[64:67],v21,s[20:23],s38 offen sc1
mma v[240:243],a[228:231],v[76:79],v[240:243]
ldt a[196:197],v5 offset:20480
mma v[240:243],a[232:235],v[80:83],v[240:243]
ldt a[198:199],v5 offset:25600
mma v[240:243],a[236:239],v[84:87],v[240:243]
ldt a[200:201],v5 offset:30720
bld a[68:71],v21,s[20:23],s38 offen offset:1024 sc1
mma v[244:247],a[236:239],v[108:111],0
ldt a[202:203],v5 offset:35840
mma v[244:247],a[232:235],v[104:107],v[244:247]
ldt a[204:205],v5 offset:40960
mma v[244:247],a[228:231],v[100:103],v[244:247]
ldt a[206:207],v5 offset:46080
mma v[244:247],a[224:227],v[96:99],v[244:247]
ldt a[208:209],v5 offset:51200
mma v[244:247],a[220:223],v[92:95],v[244:247]
ldt a[210:211],v5 offset:56320
mma v[244:247],a[216:219],v[88:91],v[244:247]
ldt a[212:213],v5
mma v[248:251],a[216:219],v[112:115],0
ldt a[214:215],v5 offset:5120
mma v[248:251],a[220:223],v[116:119],v[248:251]
mma v[248:251],a[224:227],v[120:123],v[248:251]
mma v[248:251],a[228:231],v[124:127],v[248:251]
mma v[248:251],a[232:235],v[128:131],v[248:251]
mma v[248:251],a[236:239],v[132:135],v[248:251]
s_waitcnt vmcnt(18) lgkmcnt(10)
mma a[96:99],a[192:195],a[0:3],a[96:99]
s_waitcnt vmcnt(17) lgkmcnt(8)
ldt a[216:217],v6 offset:10240
mma a[96:99],a[196:199],a[4:7],a[96:99]
s_waitcnt vmcnt(16) lgkmcnt(7)
ldt a[218:219],v6 offset:15360
mma a[96:99],a[200:203],a[8:11],a[96:99]
s_waitcnt vmcnt(15) lgkmcnt(6)
ldt a[220:221],v6 offset:20480
mma a[96:99],a[204:207],a[12:15],a[96:99]
s_waitcnt vmcnt(14) lgkmcnt(5)
ldt a[222:223],v6 offset:25600
mma a[96:99],a[208:211],a[16:19],a[96:99]
s_buffer_load_dwordx4 s[88:91], s[20:23], s87 offset:128 glc
s_mov_b32 m0, 0
s_add_u32 s31, s60, 81920
s_waitcnt vmcnt(13) lgkmcnt(4)
ldt a[224:225],v6 offset:30720
bld v236,s[48:51],s31 offen lds
mma a[96:99],a[212:215],a[20:23],a[96:99]
s_waitcnt vmcnt(7)
ldt a[226:227],v6 offset:35840
bld v237,s[48:51],s31 offen offset:1024 lds
mma a[100:103],a[212:215],a[44:47],a[100:103]
ldt a[228:229],v6 offset:40960
bld v238,s[48:51],s31 offen offset:2048 lds
mma a[100:103],a[208:211],a[40:43],a[100:103]
ldt a[230:231],v6 offset:46080
bld v239,s[48:51],s31 offen offset:3072 lds
mma a[100:103],a[204:207],a[36:39],a[100:103]
s_mov_b32 m0, 4096
ldt a[232:233],v6 offset:51200
bld v44,s[48:51],s31 offen lds
mma a[100:103],a[200:203],a[32:35],a[100:103]
buffer_store_dword v47, v17, s[20:23], 0 offen offset:256 sc1
ldt a[234:235],v6 offset:56320
mma a[100:103],a[196:199],a[28:31],a[100:103]
s_mov_b32 m0, 5120
s_add_u32 s31, s60, 102400
ldt a[236:237],v6
bld v236,s[48:51],s31 offen lds
mma a[100:103],a[192:195],a[24:27],a[100:103]
s_waitcnt vmcnt(12)
ldt a[238:239],v6 offset:5120
bld v237,s[48:51],s31 offen offset:1024 lds
mma a[104:107],a[192:195],a[48:51],a[104:107]
s_waitcnt vmcnt(12)
bld v238,s[48:51],s31 offen offset:2048 lds
mma a[104:107],a[196:199],a[52:55],a[104:107]
s_waitcnt vmcnt(12)
bld v239,s[48:51],s31 offen offset:3072 lds
mma a[104:107],a[200:203],a[56:59],a[104:107]
s_mov_b32 m0, 9216
s_waitcnt vmcnt(12)
bld v44,s[48:51],s31 offen lds
mma a[104:107],a[204:207],a[60:63],a[104:107]
s_mov_b32 m0, 10240
s_add_u32 s31, s60, 122880
s_waitcnt vmcnt(12)
bld v236,s[48:51],s31 offen lds
mma a[104:107],a[208:211],a[64:67],a[104:107]
s_waitcnt vmcnt(12)
bld v237,s[48:51],s31 offen offset:1024 lds
mma a[104:107],a[212:215],a[68:71],a[104:107]
s_waitcnt lgkmcnt(10)
bld v238,s[48:51],s31 offen offset:2048 lds
mma a[112:115],a[216:219],a[0:3],a[112:115]
s_waitcnt lgkmcnt(8)
ldt a[192:193],v5 offset:10304
bld v239,s[48:51],s31 offen offset:3072 lds
mma a[112:115],a[220:223],a[4:7],a[112:115]
s_mov_b32 m0, 14336
s_waitcnt lgkmcnt(7)
ldt a[194:195],v5 offset:15424
bld v44,s[48:51],s31 offen lds
mma a[112:115],a[224:227],a[8:11],a[112:115]
s_mov_b32 m0, 15360
s_add_u32 s31, s60, 143360
s_waitcnt lgkmcnt(6)
ldt a[196:197],v5 offset:20544
bld v236,s[48:51],s31 offen lds
mma a[112:115],a[228:231],a[12:15],a[112:115]
s_waitcnt lgkmcnt(5)
ldt a[198:199],v5 offset:25664
bld v237,s[48:51],s31 offen offset:1024 lds
mma a[112:115],a[232:235],a[16:19],a[112:115]
s_waitcnt lgkmcnt(4)
ldt a[200:201],v5 offset:30784
bld v238,s[48:51],s31 offen offset:2048 lds
mma a[112:115],a[236:239],a[20:23],a[112:115]
ldt a[202:203],v5 offset:35904
bld v239,s[48:51],s31 offen offset:3072 lds
mma a[116:119],a[236:239],a[44:47],a[116:119]
s_mov_b32 m0, 19456
ldt a[204:205],v5 offset:41024
bld v44,s[48:51],s31 offen lds
mma a[116:119],a[232:235],a[40:43],a[116:119]
s_mov_b32 m0, 49152
s_add_u32 s31, s61, 81920
ldt a[206:207],v5 offset:46144
bld v236,s[48:51],s31 offen lds
mma a[116:119],a[228:231],a[36:39],a[116:119]
ldt a[208:209],v5 offset:51264
bld v237,s[48:51],s31 offen offset:1024 lds
mma a[116:119],a[224:227],a[32:35],a[116:119]
ldt a[210:211],v5 offset:56384
bld v238,s[48:51],s31 offen offset:2048 lds
mma a[116:119],a[220:223],a[28:31],a[116:119]
ldt a[212:213],v5 offset:64
bld v239,s[48:51],s31 offen offset:3072 lds
mma a[116:119],a[216:219],a[24:27],a[116:119]
s_mov_b32 m0, 53248
ldt a[214:215],v5 offset:5184
bld v44,s[48:51],s31 offen lds
mma a[120:123],a[216:219],a[48:51],a[120:123]
s_mov_b32 m0, 54272
s_add_u32 s31, s61, 102400
bld v236,s[48:51],s31 offen lds
mma a[120:123],a[220:223],a[52:55],a[120:123]
bld v237,s[48:51],s31 offen offset:1024 lds
mma a[120:123],a[224:227],a[56:59],a[120:123]
bld v238,s[48:51],s31 offen offset:2048 lds
mma a[120:123],a[228:231],a[60:63],a[120:123]
bld v239,s[48:51],s31 offen offset:3072 lds
mma a[120:123],a[232:235],a[64:67],a[120:123]
s_mov_b32 m0, 58368
s_nop 0
bld v44,s[48:51],s31 offen lds
mma a[120:123],a[236:239],a[68:71],a[120:123]
s_waitcnt lgkmcnt(0)
s_add_u32 s88, s88, s89
s_add_u32 s88, s88, s90
s_add_u32 s88, s88, s91
s_cmp_eq_u32 s88, 3
s_cbranch_scc0 L_w3_poll1
L_w3_poll1_ret:
mma a[128:131],a[192:195],a[0:3],a[128:131]
s_mov_b32 m0, 59392
s_add_u32 s31, s61, 122880
ldt a[216:217],v6 offset:10304
bld v236,s[48:51],s31 offen lds
mma a[128:131],a[196:199],a[4:7],a[128:131]
ldt a[218:219],v6 offset:15424
bld v237,s[48:51],s31 offen offset:1024 lds
mma a[128:131],a[200:203],a[8:11],a[128:131]
ldt a[220:221],v6 offset:20544
bld v238,s[48:51],s31 offen offset:2048 lds
mma a[128:131],a[204:207],a[12:15],a[128:131]
ldt a[222:223],v6 offset:25664
bld v239,s[48:51],s31 offen offset:3072 lds
mma a[128:131],a[208:211],a[16:19],a[128:131]
s_mov_b32 m0, 63488
ldt a[224:225],v6 offset:30784
bld v44,s[48:51],s31 offen lds
mma a[128:131],a[212:215],a[20:23],a[128:131]
s_mov_b32 m0, 64512
s_add_u32 s31, s61, 143360
ldt a[226:227],v6 offset:35904
bld v236,s[48:51],s31 offen lds
mma a[132:135],a[212:215],a[44:47],a[132:135]
ldt a[228:229],v6 offset:41024
bld v237,s[48:51],s31 offen offset:1024 lds
mma a[132:135],a[208:211],a[40:43],a[132:135]
ldt a[230:231],v6 offset:46144
bld v238,s[48:51],s31 offen offset:2048 lds
mma a[132:135],a[204:207],a[36:39],a[132:135]
ldt a[232:233],v6 offset:51264
bld v239,s[48:51],s31 offen offset:3072 lds
mma a[132:135],a[200:203],a[32:35],a[132:135]
s_mov_b32 m0, 68608
ldt a[234:235],v6 offset:56384
bld v44,s[48:51],s31 offen lds
mma a[132:135],a[196:199],a[28:31],a[132:135]
s_mov_b32 m0, 24576
s_add_u32 s31, s62, 81920
ldt a[236:237],v6 offset:64
bld v236,s[48:51],s31 offen lds
mma a[132:135],a[192:195],a[24:27],a[132:135]
ldt a[238:239],v6 offset:5184
bld v237,s[48:51],s31 offen offset:1024 lds
mma a[136:139],a[192:195],a[48:51],a[136:139]
bld v238,s[48:51],s31 offen offset:2048 lds
mma a[136:139],a[196:199],a[52:55],a[136:139]
bld v239,s[48:51],s31 offen offset:3072 lds
mma a[136:139],a[200:203],a[56:59],a[136:139]
s_mov_b32 m0, 28672
s_nop 0
bld v44,s[48:51],s31 offen lds
mma a[136:139],a[204:207],a[60:63],a[136:139]
s_mov_b32 m0, 29696
s_add_u32 s31, s62, 102400
bld v236,s[48:51],s31 offen lds
mma a[136:139],a[208:211],a[64:67],a[136:139]
bld v237,s[48:51],s31 offen offset:1024 lds
mma a[136:139],a[212:215],a[68:71],a[136:139]
s_waitcnt lgkmcnt(10)
bld v238,s[48:51],s31 offen offset:2048 lds
mma a[144:147],a[216:219],a[0:3],a[144:147]
s_add_u32 s38, s56, 2048
s_waitcnt lgkmcnt(8)
ldt a[192:193],v5 offset:10368
bld v[64:67],v21,s[20:23],s38 offen sc1
mma a[144:147],a[220:223],a[4:7],a[144:147]
s_waitcnt lgkmcnt(7)
ldt a[194:195],v5 offset:15488
bld v239,s[48:51],s31 offen offset:3072 lds
mma a[144:147],a[224:227],a[8:11],a[144:147]
s_mov_b32 m0, 33792
s_waitcnt lgkmcnt(6)
ldt a[196:197],v5 offset:20608
bld v44,s[48:51],s31 offen lds
mma a[144:147],a[228:231],a[12:15],a[144:147]
s_mov_b32 m0, 34816
s_add_u32 s31, s62, 122880
s_waitcnt lgkmcnt(5)
ldt a[198:199],v5 offset:25728
bld v236,s[48:51],s31 offen lds
mma a[144:147],a[232:235],a[16:19],a[144:147]
s_waitcnt lgkmcnt(4)
ldt a[200:201],v5 offset:30848
bld v237,s[48:51],s31 offen offset:1024 lds
mma a[144:147],a[236:239],a[20:23],a[144:147]
ldt a[202:203],v5 offset:35968
bld v[68:71],v21,s[20:23],s38 offen offset:1024 sc1
mma a[148:151],a[236:239],a[44:47],a[148:151]
ldt a[204:205],v5 offset:41088
bld v238,s[48:51],s31 offen offset:2048 lds
mma a[148:151],a[232:235],a[40:43],a[148:151]
ldt a[206:207],v5 offset:46208
bld v239,s[48:51],s31 offen offset:3072 lds
mma a[148:151],a[228:231],a[36:39],a[148:151]
s_mov_b32 m0, 38912
ldt a[208:209],v5 offset:51328
bld v44,s[48:51],s31 offen lds
mma a[148:151],a[224:227],a[32:35],a[148:151]
s_mov_b32 m0, 39936
s_add_u32 s31, s62, 143360
ldt a[210:211],v5 offset:56448
bld v236,s[48:51],s31 offen lds
mma a[148:151],a[220:223],a[28:31],a[148:151]
s_add_u32 s38, s57, 2048
ldt a[212:213],v5 offset:128
bld v[72:75],v21,s[20:23],s38 offen sc1
mma a[148:151],a[216:219],a[24:27],a[148:151]
ldt a[214:215],v5 offset:5248
bld v237,s[48:51],s31 offen offset:1024 lds
mma a[152:155],a[216:219],a[48:51],a[152:155]
bld v238,s[48:51],s31 offen offset:2048 lds
mma a[152:155],a[220:223],a[52:55],a[152:155]
bld v239,s[48:51],s31 offen offset:3072 lds
mma a[152:155],a[224:227],a[56:59],a[152:155]
s_mov_b32 m0, 44032
s_nop 0
bld v44,s[48:51],s31 offen lds
mma a[152:155],a[228:231],a[60:63],a[152:155]
bld v[76:79],v21,s[20:23],s38 offen offset:1024 sc1
mma a[152:155],a[232:235],a[64:67],a[152:155]
mma a[152:155],a[236:239],a[68:71],a[152:155]
s_waitcnt lgkmcnt(10)
mma v[160:163],a[192:195],a[0:3],v[160:163]
s_waitcnt lgkmcnt(8)
ldt a[216:217],v6 offset:10368
mma v[160:163],a[196:199],a[4:7],v[160:163]
s_waitcnt lgkmcnt(7)
ldt a[218:219],v6 offset:15488
mma v[160:163],a[200:203],a[8:11],v[160:163]
s_add_u32 s38, s56, 8192
s_waitcnt lgkmcnt(6)
ldt a[220:221],v6 offset:20608
bld v[88:91],v21,s[20:23],s38 offen sc1
mma v[160:163],a[204:207],a[12:15],v[160:163]
s_waitcnt lgkmcnt(5)
ldt a[222:223],v6 offset:25728
mma v[160:163],a[208:211],a[16:19],v[160:163]
s_waitcnt lgkmcnt(4)
ldt a[224:225],v6 offset:30848
mma v[160:163],a[212:215],a[20:23],v[160:163]
ldt a[226:227],v6 offset:35968
mma v[164:167],a[212:215],a[44:47],v[164:167]
ldt a[228:229],v6 offset:41088
mma v[164:167],a[208:211],a[40:43],v[164:167]
ldt a[230:231],v6 offset:46208
bld v[92:95],v21,s[20:23],s38 offen offset:1024 sc1
mma v[164:167],a[204:207],a[36:39],v[164:167]
ldt a[232:233],v6 offset:51328
mma v[164:167],a[200:203],a[32:35],v[164:167]
ldt a[234:235],v6 offset:56448
mma v[164:167],a[196:199],a[28:31],v[164:167]
ldt a[236:237],v6 offset:128
mma v[164:167],a[192:195],a[24:27],v[164:167]
ldt a[238:239],v6 offset:5248
mma v[168:171],a[192:195],a[48:51],v[168:171]
s_add_u32 s38, s57, 8192
bld v[96:99],v21,s[20:23],s38 offen sc1
mma v[168:171],a[196:199],a[52:55],v[168:171]
mma v[168:171],a[200:203],a[56:59],v[168:171]
mma v[168:171],a[204:207],a[60:63],v[168:171]
mma v[168:171],a[208:211],a[64:67],v[168:171]
mma v[168:171],a[212:215],a[68:71],v[168:171]
s_waitcnt lgkmcnt(10)
bld v[100:103],v21,s[20:23],s38 offen offset:1024 sc1
mma v[176:179],a[216:219],a[0:3],v[176:179]
s_waitcnt lgkmcnt(8)
ldt a[192:193],v5 offset:10432
mma v[176:179],a[220:223],a[4:7],v[176:179]
s_waitcnt lgkmcnt(7)
ldt a[194:195],v5 offset:15552
mma v[176:179],a[224:227],a[8:11],v[176:179]
s_waitcnt lgkmcnt(6)
ldt a[196:197],v5 offset:20672
mma v[176:179],a[228:231],a[12:15],v[176:179]
s_waitcnt lgkmcnt(5)
ldt a[198:199],v5 offset:25792
mma v[176:179],a[232:235],a[16:19],v[176:179]
s_add_u32 s38, s56, 14336
s_waitcnt lgkmcnt(4)
ldt a[200:201],v5 offset:30912
bld v[112:115],v21,s[20:23],s38 offen sc1
mma v[176:179],a[236:239],a[20:23],v[176:179]
ldt a[202:203],v5 offset:36032
mma v[180:183],a[236:239],a[44:47],v[180:183]
ldt a[204:205],v5 offset:41152
mma v[180:183],a[232:235],a[40:43],v[180:183]
ldt a[206:207],v5 offset:46272
mma v[180:183],a[228:231],a[36:39],v[180:183]
ldt a[208:209],v5 offset:51392
mma v[180:183],a[224:227],a[32:35],v[180:183]
ldt a[210:211],v5 offset:56512
bld v[116:119],v21,s[20:23],s38 offen offset:1024 sc1
mma v[180:183],a[220:223],a[28:31],v[180:183]
ldt a[212:213],v5 offset:192
mma v[180:183],a[216:219],a[24:27],v[180:183]
ldt a[214:215],v5 offset:5312
mma v[184:187],a[216:219],a[48:51],v[184:187]
mma v[184:187],a[220:223],a[52:55],v[184:187]
mma v[184:187],a[224:227],a[56:59],v[184:187]
s_add_u32 s38, s57, 14336
bld v[120:123],v21,s[20:23],s38 offen sc1
mma v[184:187],a[228:231],a[60:63],v[184:187]
mma v[184:187],a[232:235],a[64:67],v[184:187]
mma v[184:187],a[236:239],a[68:71],v[184:187]
s_waitcnt lgkmcnt(10)
mma v[192:195],a[192:195],a[0:3],v[192:195]
s_waitcnt lgkmcnt(8)
ldt a[216:217],v6 offset:10432
mma v[192:195],a[196:199],a[4:7],v[192:195]
s_waitcnt lgkmcnt(7)
ldt a[218:219],v6 offset:15552
bld v[124:127],v21,s[20:23],s38 offen offset:1024 sc1
mma v[192:195],a[200:203],a[8:11],v[192:195]
s_waitcnt lgkmcnt(6)
ldt a[220:221],v6 offset:20672
mma v[192:195],a[204:207],a[12:15],v[192:195]
s_waitcnt lgkmcnt(5)
ldt a[222:223],v6 offset:25792
mma v[192:195],a[208:211],a[16:19],v[192:195]
s_waitcnt lgkmcnt(4)
ldt a[224:225],v6 offset:30912
mma v[192:195],a[212:215],a[20:23],v[192:195]
ldt a[226:227],v6 offset:36032
mma v[196:199],a[212:215],a[44:47],v[196:199]
s_add_u32 s38, s58, 2048
ldt a[228:229],v6 offset:41152
bld v[80:83],v21,s[20:23],s38 offen sc1
mma v[196:199],a[208:211],a[40:43],v[196:199]
ldt a[230:231],v6 offset:46272
mma v[196:199],a[204:207],a[36:39],v[196:199]
ldt a[232:233],v6 offset:51392
mma v[196:199],a[200:203],a[32:35],v[196:199]
ldt a[234:235],v6 offset:56512
mma v[196:199],a[196:199],a[28:31],v[196:199]
ldt a[236:237],v6 offset:192
mma v[196:199],a[192:195],a[24:27],v[196:199]
ldt a[238:239],v6 offset:5312
bld v[84:87],v21,s[20:23],s38 offen offset:1024 sc1
mma v[200:203],a[192:195],a[48:51],v[200:203]
mma v[200:203],a[196:199],a[52:55],v[200:203]
mma v[200:203],a[200:203],a[56:59],v[200:203]
mma v[200:203],a[204:207],a[60:63],v[200:203]
mma v[200:203],a[208:211],a[64:67],v[200:203]
s_add_u32 s38, s58, 8192
bld v[104:107],v21,s[20:23],s38 offen sc1
mma v[200:203],a[212:215],a[68:71],v[200:203]
s_waitcnt lgkmcnt(10)
mma v[208:211],a[216:219],a[0:3],v[208:211]
s_buffer_load_dwordx4 s[88:91], s[20:23], s87 offset:256 glc
ldt a[192:193],v5 offset:10496
s_waitcnt lgkmcnt(9)
mma v[208:211],a[220:223],a[4:7],v[208:211]
s_waitcnt lgkmcnt(7)
ldt a[194:195],v5 offset:15616
mma v[208:211],a[224:227],a[8:11],v[208:211]
s_waitcnt lgkmcnt(6)
ldt a[196:197],v5 offset:20736
mma v[208:211],a[228:231],a[12:15],v[208:211]
s_waitcnt lgkmcnt(5)
ldt a[198:199],v5 offset:25856
bld v[108:111],v21,s[20:23],s38 offen offset:1024 sc1
mma v[208:211],a[232:235],a[16:19],v[208:211]
s_waitcnt lgkmcnt(4)
ldt a[200:201],v5 offset:30976
mma v[208:211],a[236:239],a[20:23],v[208:211]
ldt a[202:203],v5 offset:36096
mma v[212:215],a[236:239],a[44:47],v[212:215]
ldt a[204:205],v5 offset:41216
mma v[212:215],a[232:235],a[40:43],v[212:215]
ldt a[206:207],v5 offset:46336
mma v[212:215],a[228:231],a[36:39],v[212:215]
s_add_u32 s38, s58, 14336
ldt a[208:209],v5 offset:51456
bld v[128:131],v21,s[20:23],s38 offen sc1
mma v[212:215],a[224:227],a[32:35],v[212:215]
ldt a[210:211],v5 offset:56576
mma v[212:215],a[220:223],a[28:31],v[212:215]
ldt a[212:213],v5 offset:256
mma v[212:215],a[216:219],a[24:27],v[212:215]
ldt a[214:215],v5 offset:5376
mma v[216:219],a[216:219],a[48:51],v[216:219]
mma v[216:219],a[220:223],a[52:55],v[216:219]
bld v[132:135],v21,s[20:23],s38 offen offset:1024 sc1
mma v[216:219],a[224:227],a[56:59],v[216:219]
mma v[216:219],a[228:231],a[60:63],v[216:219]
mma v[216:219],a[232:235],a[64:67],v[216:219]
mma v[216:219],a[236:239],a[68:71],v[216:219]
s_waitcnt lgkmcnt(10)
mma v[224:227],a[192:195],a[0:3],v[224:227]
s_waitcnt lgkmcnt(8)
ldt a[216:217],v6 offset:10496
mma v[224:227],a[196:199],a[4:7],v[224:227]
s_waitcnt lgkmcnt(7)
ldt a[218:219],v6 offset:15616
mma v[224:227],a[200:203],a[8:11],v[224:227]
s_add_u32 s42, s41, 5120
s_waitcnt lgkmcnt(6)
ldt a[220:221],v6 offset:20736
buffer_store_dwordx4 a[160:163], v21, s[20:23], s42 offen sc1
mma v[224:227],a[204:207],a[12:15],v[224:227]
s_waitcnt lgkmcnt(5)
ldt a[222:223],v6 offset:25856
mma v[224:227],a[208:211],a[16:19],v[224:227]
s_waitcnt lgkmcnt(4)
ldt a[224:225],v6 offset:30976
mma v[224:227],a[212:215],a[20:23],v[224:227]
ldt a[226:227],v6 offset:36096
mma v[228:231],a[212:215],a[44:47],v[228:231]
ldt a[228:229],v6 offset:41216
mma v[228:231],a[208:211],a[40:43],v[228:231]
ldt a[230:231],v6 offset:46336
mma v[228:231],a[204:207],a[36:39],v[228:231]
ldt a[232:233],v6 offset:51456
mma v[228:231],a[200:203],a[32:35],v[228:231]
ldt a[234:235],v6 offset:56576
mma v[228:231],a[196:199],a[28:31],v[228:231]
ldt a[236:237],v6 offset:256
mma v[228:231],a[192:195],a[24:27],v[228:231]
ldt a[238:239],v6 offset:5376
mma v[232:235],a[192:195],a[48:51],v[232:235]
s_add_u32 s42, s41, 11264
buffer_store_dwordx4 a[164:167], v21, s[20:23], s42 offen sc1
mma v[232:235],a[196:199],a[52:55],v[232:235]
mma v[232:235],a[200:203],a[56:59],v[232:235]
mma v[232:235],a[204:207],a[60:63],v[232:235]
mma v[232:235],a[208:211],a[64:67],v[232:235]
mma v[232:235],a[212:215],a[68:71],v[232:235]
s_waitcnt lgkmcnt(10)
mma v[240:243],a[216:219],a[0:3],v[240:243]
s_waitcnt vmcnt(17) lgkmcnt(0)
s_barrier
mma v[240:243],a[220:223],a[4:7],v[240:243]
ldt a[192:193],v15
mma v[240:243],a[224:227],a[8:11],v[240:243]
ldt a[194:195],v15 offset:5120
mma v[240:243],a[228:231],a[12:15],v[240:243]
ldt a[196:197],v15 offset:10240
mma v[240:243],a[232:235],a[16:19],v[240:243]
ldt a[198:199],v15 offset:15360
mma v[240:243],a[236:239],a[20:23],v[240:243]
s_add_u32 s42, s41, 17408
ldt a[200:201],v15 offset:49152
buffer_store_dwordx4 a[168:171], v21, s[20:23], s42 offen sc1
mma v[244:247],a[236:239],a[44:47],v[244:247]
ldt a[202:203],v15 offset:54272
mma v[244:247],a[232:235],a[40:43],v[244:247]
ldt a[204:205],v15 offset:59392
mma v[244:247],a[228:231],a[36:39],v[244:247]
ldt a[206:207],v15 offset:64512
mma v[244:247],a[224:227],a[32:35],v[244:247]
ldt a[208:209],v15 offset:24576
mma v[244:247],a[220:223],a[28:31],v[244:247]
ldt a[210:211],v15 offset:29696
mma v[244:247],a[216:219],a[24:27],v[244:247]
ldt a[212:213],v15 offset:34816
mma v[248:251],a[216:219],a[48:51],v[248:251]
ldt a[214:215],v15 offset:39936
mma v[248:251],a[220:223],a[52:55],v[248:251]
mma v[248:251],a[224:227],a[56:59],v[248:251]
mma v[248:251],a[228:231],a[60:63],v[248:251]
mma v[248:251],a[232:235],a[64:67],v[248:251]
mma v[248:251],a[236:239],a[68:71],v[248:251]
s_waitcnt lgkmcnt(0)
s_add_u32 s88, s88, s89
s_add_u32 s88, s88, s90
s_add_u32 s88, s88, s91
s_cmp_eq_u32 s88, 3
s_cbranch_scc0 L_w3_poll2
L_w3_poll2_ret:
mma a[96:99],a[192:195],v[64:67],a[96:99]
ldt a[216:217],v16
mma a[96:99],a[196:199],v[68:71],a[96:99]
ldt a[218:219],v16 offset:5120
mma a[96:99],a[200:203],v[72:75],a[96:99]
s_waitcnt vmcnt(17)
ldt a[220:221],v16 offset:10240
mma a[96:99],a[204:207],v[76:79],a[96:99]
s_waitcnt vmcnt(8)
ldt a[222:223],v16 offset:15360
mma a[96:99],a[208:211],v[80:83],a[96:99]
s_waitcnt vmcnt(7)
ldt a[224:225],v16 offset:49152
mma a[96:99],a[212:215],v[84:87],a[96:99]
s_waitcnt vmcnt(5)
ldt a[226:227],v16 offset:54272
mma a[100:103],a[212:215],v[108:111],a[100:103]
ldt a[228:229],v16 offset:59392
mma a[100:103],a[208:211],v[104:107],a[100:103]
ldt a[230:231],v16 offset:64512
mma a[100:103],a[204:207],v[100:103],a[100:103]
ldt a[232:233],v16 offset:24576
mma a[100:103],a[200:203],v[96:99],a[100:103]
s_mov_b32 m0, 110592
s_add_u32 s31, s60, 163840
ldt a[234:235],v16 offset:29696
bld v236,s[48:51],s31 offen lds
mma a[100:103],a[196:199],v[92:95],a[100:103]
ldt a[236:237],v16 offset:34816
bld v237,s[48:51],s31 offen offset:1024 lds
mma a[100:103],a[192:195],v[88:91],a[100:103]
ldt a[238:239],v16 offset:39936
bld v238,s[48:51],s31 offen offset:2048 lds
mma a[104:107],a[192:195],v[112:115],a[104:107]
bld v239,s[48:51],s31 offen offset:3072 lds
mma a[104:107],a[196:199],v[116:119],a[104:107]
s_mov_b32 m0, 114688
s_nop 0
bld v44,s[48:51],s31 offen lds
mma a[104:107],a[200:203],v[120:123],a[104:107]
s_mov_b32 m0, 115712
s_add_u32 s31, s60, 184320
bld v236,s[48:51],s31 offen lds
mma a[104:107],a[204:207],v[124:127],a[104:107]
s_waitcnt vmcnt(10)
bld v237,s[48:51],s31 offen offset:1024 lds
mma a[104:107],a[208:211],v[128:131],a[104:107]
s_lshr_b32 s3, s26, 2
bld v238,s[48:51],s31 offen offset:2048 lds
s_lshl_b32 s35, s24, 1
s_cmp_eq_u32 s35, s3
s_cselect_b32 s27, 2146435072, s46
s_cselect_b32 s37, 0, 12288
s_add_u32 s37, s37, 73728
s_waitcnt vmcnt(11)
v_add_u32 v2, s37, v12
mma a[104:107],a[212:215],v[132:135],a[104:107]
s_add_u32 s35, s35, 1
bld v239,s[48:51],s31 offen offset:3072 lds
s_cmp_eq_u32 s35, s3
s_cselect_b32 s28, 2146435072, s46
s_cselect_b32 s37, 0, 12288
s_add_u32 s37, s37, 73728
s_waitcnt lgkmcnt(10)
v_add_u32 v3, s37, v12
mma a[112:115],a[216:219],v[64:67],a[112:115]
s_mov_b32 m0, 119808
s_waitcnt lgkmcnt(8)
ldt a[192:193],v15 offset:64
bld v44,s[48:51],s31 offen lds
mma a[112:115],a[220:223],v[68:71],a[112:115]
s_mov_b32 m0, 120832
s_add_u32 s31, s60, 204800
s_waitcnt lgkmcnt(7)
ldt a[194:195],v15 offset:5184
bld v236,s[48:51],s31 offen lds
mma a[112:115],a[224:227],v[72:75],a[112:115]
s_waitcnt lgkmcnt(6)
ldt a[196:197],v15 offset:10304
bld v237,s[48:51],s31 offen offset:1024 lds
mma a[112:115],a[228:231],v[76:79],a[112:115]
s_waitcnt lgkmcnt(5)
ldt a[198:199],v15 offset:15424
bld v238,s[48:51],s31 offen offset:2048 lds
mma a[112:115],a[232:235],v[80:83],a[112:115]
s_waitcnt lgkmcnt(4)
ldt a[200:201],v15 offset:49216
bld v239,s[48:51],s31 offen offset:3072 lds
mma a[112:115],a[236:239],v[84:87],a[112:115]
s_mov_b32 m0, 124928
ldt a[202:203],v15 offset:54336
bld v44,s[48:51],s31 offen lds
mma a[116:119],a[236:239],v[108:111],a[116:119]
s_mov_b32 m0, 125952
s_add_u32 s31, s60, 225280
ldt a[204:205],v15 offset:59456
bld v236,s[48:51],s31 offen lds
mma a[116:119],a[232:235],v[104:107],a[116:119]
ldt a[206:207],v15 offset:64576
bld v237,s[48:51],s31 offen offset:1024 lds
mma a[116:119],a[228:231],v[100:103],a[116:119]
ldt a[208:209],v15 offset:24640
bld v238,s[48:51],s31 offen offset:2048 lds
mma a[116:119],a[224:227],v[96:99],a[116:119]
ldt a[210:211],v15 offset:29760
bld v239,s[48:51],s31 offen offset:3072 lds
mma a[116:119],a[220:223],v[92:95],a[116:119]
s_mov_b32 m0, 130048
ldt a[212:213],v15 offset:34880
bld v44,s[48:51],s31 offen lds
mma a[116:119],a[216:219],v[88:91],a[116:119]
s_mov_b32 m0, 131072
ldt a[214:215],v15 offset:40000
s_add_u32 s35, s35, 1
s_mov_b32 s37, 16711935
s_and_b32 s35, s3, 1
s_cselect_b32 s32, 4278255360, s37
s_mov_b32 s33, s32
s_lshr_b32 s3, s3, 1
s_mul_i32 s16, s3, 153600
s_add_u32 s16, s16, s96
s_add_u32 s3, s3, 1
s_and_b32 s3, s3, 3
s_mul_i32 s17, s3, 153600
s_add_u32 s17, s17, s96
s_add_u32 s3, s3, 1
s_and_b32 s3, s3, 3
s_mul_i32 s18, s3, 153600
s_add_u32 s18, s18, s96
s_add_u32 s3, s3, 1
s_and_b32 s3, s3, 3
s_mul_i32 s19, s3, 153600
s_add_u32 s19, s19, s96
s_add_u32 s3, s3, 1
s_and_b32 s3, s3, 3
s_lshr_b32 s3, s24, 1
s_mul_i32 s3, s3, 5120
s_and_b32 s35, s24, 1
s_lshl_b32 s35, s35, 9
s_add_u32 s3, s3, s35
s_add_u32 s3, s3, 73728
v_and_b32 v4, 511, v12
v_add_u32 v4, s3, v4
mma a[120:123],a[216:219],v[112:115],a[120:123]
s_add_u32 s31, s61, 163840
bld v236,s[48:51],s31 offen lds
s_mov_b32 s4, s74
s_mov_b32 s5, s75
s_mov_b32 s6, 2457600
s_mov_b32 s7, 131072
s_mov_b32 s43, 4294901760
mma a[120:123],a[220:223],v[116:119],a[120:123]
bld v237,s[48:51],s31 offen offset:1024 lds
mma a[120:123],a[224:227],v[120:123],a[120:123]
bld v238,s[48:51],s31 offen offset:2048 lds
mma a[120:123],a[228:231],v[124:127],a[120:123]
bld v239,s[48:51],s31 offen offset:3072 lds
mma a[120:123],a[232:235],v[128:131],a[120:123]
s_mov_b32 m0, 135168
s_nop 0
bld v44,s[48:51],s31 offen lds
mma a[120:123],a[236:239],v[132:135],a[120:123]
s_mov_b32 m0, 136192
s_add_u32 s31, s61, 184320
s_waitcnt lgkmcnt(10)
bld v236,s[48:51],s31 offen lds
mma a[128:131],a[192:195],v[64:67],a[128:131]
s_waitcnt lgkmcnt(8)
ldt a[216:217],v16 offset:64
bld v237,s[48:51],s31 offen offset:1024 lds
mma a[128:131],a[196:199],v[68:71],a[128:131]
s_waitcnt lgkmcnt(7)
ldt a[218:219],v16 offset:5184
bld v238,s[48:51],s31 offen offset:2048 lds
mma a[128:131],a[200:203],v[72:75],a[128:131]
s_waitcnt lgkmcnt(6)
ldt a[220:221],v16 offset:10304
bld v239,s[48:51],s31 offen offset:3072 lds
mma a[128:131],a[204:207],v[76:79],a[128:131]
s_mov_b32 m0, 140288
s_waitcnt lgkmcnt(5)
ldt a[222:223],v16 offset:15424
bld v44,s[48:51],s31 offen lds
mma a[128:131],a[208:211],v[80:83],a[128:131]
s_mov_b32 m0, 141312
s_add_u32 s31, s61, 204800
s_waitcnt lgkmcnt(4)
ldt a[224:225],v16 offset:49216
bld v236,s[48:51],s31 offen lds
mma a[128:131],a[212:215],v[84:87],a[128:131]
ldt a[226:227],v16 offset:54336
bld v237,s[48:51],s31 offen offset:1024 lds
mma a[132:135],a[212:215],v[108:111],a[132:135]
ldt a[228:229],v16 offset:59456
bld v238,s[48:51],s31 offen offset:2048 lds
mma a[132:135],a[208:211],v[104:107],a[132:135]
ldt a[230:231],v16 offset:64576
bld v239,s[48:51],s31 offen offset:3072 lds
mma a[132:135],a[204:207],v[100:103],a[132:135]
s_mov_b32 m0, 145408
ldt a[232:233],v16 offset:24640
bld v44,s[48:51],s31 offen lds
mma a[132:135],a[200:203],v[96:99],a[132:135]
s_mov_b32 m0, 146432
s_add_u32 s31, s61, 225280
ldt a[234:235],v16 offset:29760
bld v236,s[48:51],s31 offen lds
mma a[132:135],a[196:199],v[92:95],a[132:135]
ldt a[236:237],v16 offset:34880
bld v237,s[48:51],s31 offen offset:1024 lds
mma a[132:135],a[192:195],v[88:91],a[132:135]
ldt a[238:239],v16 offset:40000
bld v238,s[48:51],s31 offen offset:2048 lds
mma a[136:139],a[192:195],v[112:115],a[136:139]
bld v239,s[48:51],s31 offen offset:3072 lds
mma a[136:139],a[196:199],v[116:119],a[136:139]
s_mov_b32 m0, 150528
s_nop 0
bld v44,s[48:51],s31 offen lds
mma a[136:139],a[200:203],v[120:123],a[136:139]
s_mov_b32 m0, 151552
mma a[136:139],a[204:207],v[124:127],a[136:139]
s_add_u32 s31, s62, 163840
bld v236,s[48:51],s31 offen lds
mma a[136:139],a[208:211],v[128:131],a[136:139]
bld v237,s[48:51],s31 offen offset:1024 lds
mma a[136:139],a[212:215],v[132:135],a[136:139]
s_waitcnt lgkmcnt(10)
bld v238,s[48:51],s31 offen offset:2048 lds
mma a[144:147],a[216:219],v[64:67],a[144:147]
s_waitcnt vmcnt(43)
s_waitcnt lgkmcnt(8)
buffer_store_dword v47, v17, s[20:23], 0 offen offset:768 sc1
ldt a[192:193],v15 offset:128
mma a[144:147],a[220:223],v[68:71],a[144:147]
s_waitcnt lgkmcnt(7)
ldt a[194:195],v15 offset:5248
bld v239,s[48:51],s31 offen offset:3072 lds
mma a[144:147],a[224:227],v[72:75],a[144:147]
s_mov_b32 m0, 155648
s_waitcnt lgkmcnt(6)
ldt a[196:197],v15 offset:10368
bld v44,s[48:51],s31 offen lds
mma a[144:147],a[228:231],v[76:79],a[144:147]
s_mov_b32 m0, 156672
s_add_u32 s31, s62, 184320
s_waitcnt lgkmcnt(5)
ldt a[198:199],v15 offset:15488
bld v236,s[48:51],s31 offen lds
mma a[144:147],a[232:235],v[80:83],a[144:147]
s_waitcnt lgkmcnt(4)
ldt a[200:201],v15 offset:49280
bld v237,s[48:51],s31 offen offset:1024 lds
mma a[144:147],a[236:239],v[84:87],a[144:147]
ldt a[202:203],v15 offset:54400
bld v238,s[48:51],s31 offen offset:2048 lds
mma a[148:151],a[236:239],v[108:111],a[148:151]
ldt a[204:205],v15 offset:59520
bld v239,s[48:51],s31 offen offset:3072 lds
mma a[148:151],a[232:235],v[104:107],a[148:151]
s_mov_b32 m0, 160768
ldt a[206:207],v15 offset:64640
bld v44,s[48:51],s31 offen lds
mma a[148:151],a[228:231],v[100:103],a[148:151]
s_mov_b32 m0, 100352
s_add_u32 s31, s62, 204800
ldt a[208:209],v15 offset:24704
bld v236,s[48:51],s31 offen lds
mma a[148:151],a[224:227],v[96:99],a[148:151]
ldt a[210:211],v15 offset:29824
bld v237,s[48:51],s31 offen offset:1024 lds
mma a[148:151],a[220:223],v[92:95],a[148:151]
ldt a[212:213],v15 offset:34944
bld v238,s[48:51],s31 offen offset:2048 lds
mma a[148:151],a[216:219],v[88:91],a[148:151]
ldt a[214:215],v15 offset:40064
bld v239,s[48:51],s31 offen offset:3072 lds
mma a[152:155],a[216:219],v[112:115],a[152:155]
s_mov_b32 m0, 104448
s_nop 0
bld v44,s[48:51],s31 offen lds
mma a[152:155],a[220:223],v[116:119],a[152:155]
s_mov_b32 m0, 105472
s_add_u32 s31, s62, 225280
bld v236,s[48:51],s31 offen lds
mma a[152:155],a[224:227],v[120:123],a[152:155]
bld v237,s[48:51],s31 offen offset:1024 lds
mma a[152:155],a[228:231],v[124:127],a[152:155]
bld v238,s[48:51],s31 offen offset:2048 lds
mma a[152:155],a[232:235],v[128:131],a[152:155]
bld v239,s[48:51],s31 offen offset:3072 lds
mma a[152:155],a[236:239],v[132:135],a[152:155]
s_mov_b32 m0, 109568
s_waitcnt lgkmcnt(10)
bld v44,s[48:51],s31 offen lds
mma v[160:163],a[192:195],v[64:67],v[160:163]
s_add_u32 s38, s56, 4096
s_waitcnt lgkmcnt(8)
ldt a[216:217],v16 offset:128
bld a[0:3],v21,s[20:23],s38 offen sc1
mma v[160:163],a[196:199],v[68:71],v[160:163]
s_waitcnt lgkmcnt(7)
ldt a[218:219],v16 offset:5248
mma v[160:163],a[200:203],v[72:75],v[160:163]
s_waitcnt lgkmcnt(6)
ldt a[220:221],v16 offset:10368
mma v[160:163],a[204:207],v[76:79],v[160:163]
s_waitcnt lgkmcnt(5)
ldt a[222:223],v16 offset:15488
mma v[160:163],a[208:211],v[80:83],v[160:163]
s_waitcnt lgkmcnt(4)
ldt a[224:225],v16 offset:49280
mma v[160:163],a[212:215],v[84:87],v[160:163]
s_add_u32 s38, s57, 4096
ldt a[226:227],v16 offset:54400
bld a[8:11],v21,s[20:23],s38 offen sc1
mma v[164:167],a[212:215],v[108:111],v[164:167]
ldt a[228:229],v16 offset:59520
mma v[164:167],a[208:211],v[104:107],v[164:167]
ldt a[230:231],v16 offset:64640
mma v[164:167],a[204:207],v[100:103],v[164:167]
ldt a[232:233],v16 offset:24704
mma v[164:167],a[200:203],v[96:99],v[164:167]
s_buffer_load_dwordx4 s[88:91], s[20:23], s87 offset:768 glc
ldt a[234:235],v16 offset:29824
mma v[164:167],a[196:199],v[92:95],v[164:167]
s_add_u32 s38, s58, 4096
ldt a[236:237],v16 offset:34944
bld a[16:19],v21,s[20:23],s38 offen sc1
mma v[164:167],a[192:195],v[88:91],v[164:167]
ldt a[238:239],v16 offset:40064
mma v[168:171],a[192:195],v[112:115],v[168:171]
mma v[168:171],a[196:199],v[116:119],v[168:171]
mma v[168:171],a[200:203],v[120:123],v[168:171]
mma v[168:171],a[204:207],v[124:127],v[168:171]
s_add_u32 s38, s56, 10240
bld a[24:27],v21,s[20:23],s38 offen sc1
mma v[168:171],a[208:211],v[128:131],v[168:171]
mma v[168:171],a[212:215],v[132:135],v[168:171]
s_waitcnt lgkmcnt(10)
mma v[176:179],a[216:219],v[64:67],v[176:179]
s_waitcnt lgkmcnt(8)
ldt a[192:193],v15 offset:192
mma v[176:179],a[220:223],v[68:71],v[176:179]
s_waitcnt lgkmcnt(7)
ldt a[194:195],v15 offset:5312
mma v[176:179],a[224:227],v[72:75],v[176:179]
s_add_u32 s38, s57, 10240
s_waitcnt lgkmcnt(6)
ldt a[196:197],v15 offset:10432
bld a[32:35],v21,s[20:23],s38 offen sc1
mma v[176:179],a[228:231],v[76:79],v[176:179]
s_waitcnt lgkmcnt(5)
ldt a[198:199],v15 offset:15552
mma v[176:179],a[232:235],v[80:83],v[176:179]
s_waitcnt lgkmcnt(4)
ldt a[200:201],v15 offset:49344
mma v[176:179],a[236:239],v[84:87],v[176:179]
ldt a[202:203],v15 offset:54464
mma v[180:183],a[236:239],v[108:111],v[180:183]
ldt a[204:205],v15 offset:59584
mma v[180:183],a[232:235],v[104:107],v[180:183]
s_add_u32 s38, s58, 10240
ldt a[206:207],v15 offset:64704
bld a[40:43],v21,s[20:23],s38 offen sc1
mma v[180:183],a[228:231],v[100:103],v[180:183]
ldt a[208:209],v15 offset:24768
mma v[180:183],a[224:227],v[96:99],v[180:183]
ldt a[210:211],v15 offset:29888
mma v[180:183],a[220:223],v[92:95],v[180:183]
ldt a[212:213],v15 offset:35008
mma v[180:183],a[216:219],v[88:91],v[180:183]
ldt a[214:215],v15 offset:40128
mma v[184:187],a[216:219],v[112:115],v[184:187]
s_add_u32 s38, s56, 16384
bld a[48:51],v21,s[20:23],s38 offen sc1
mma v[184:187],a[220:223],v[116:119],v[184:187]
mma v[184:187],a[224:227],v[120:123],v[184:187]
mma v[184:187],a[228:231],v[124:127],v[184:187]
mma v[184:187],a[232:235],v[128:131],v[184:187]
mma v[184:187],a[236:239],v[132:135],v[184:187]
s_add_u32 s38, s57, 16384
s_waitcnt lgkmcnt(10)
bld a[56:59],v21,s[20:23],s38 offen sc1
mma v[192:195],a[192:195],v[64:67],v[192:195]
s_waitcnt lgkmcnt(8)
ldt a[216:217],v16 offset:192
mma v[192:195],a[196:199],v[68:71],v[192:195]
s_waitcnt lgkmcnt(7)
ldt a[218:219],v16 offset:5312
mma v[192:195],a[200:203],v[72:75],v[192:195]
s_waitcnt lgkmcnt(6)
ldt a[220:221],v16 offset:10432
mma v[192:195],a[204:207],v[76:79],v[192:195]
s_waitcnt lgkmcnt(5)
ldt a[222:223],v16 offset:15552
mma v[192:195],a[208:211],v[80:83],v[192:195]
s_add_u32 s38, s58, 16384
s_waitcnt lgkmcnt(4)
ldt a[224:225],v16 offset:49344
bld a[64:67],v21,s[20:23],s38 offen sc1
mma v[192:195],a[212:215],v[84:87],v[192:195]
ldt a[226:227],v16 offset:54464
mma v[196:199],a[212:215],v[108:111],v[196:199]
ldt a[228:229],v16 offset:59584
mma v[196:199],a[208:211],v[104:107],v[196:199]
ldt a[230:231],v16 offset:64704
mma v[196:199],a[204:207],v[100:103],v[196:199]
ldt a[232:233],v16 offset:24768
mma v[196:199],a[200:203],v[96:99],v[196:199]
ldt a[234:235],v16 offset:29888
mma v[196:199],a[196:199],v[92:95],v[196:199]
ldt a[236:237],v16 offset:35008
mma v[196:199],a[192:195],v[88:91],v[196:199]
ldt a[238:239],v16 offset:40128
mma v[200:203],a[192:195],v[112:115],v[200:203]
mma v[200:203],a[196:199],v[116:119],v[200:203]
mma v[200:203],a[200:203],v[120:123],v[200:203]
mma v[200:203],a[204:207],v[124:127],v[200:203]
mma v[200:203],a[208:211],v[128:131],v[200:203]
mma v[200:203],a[212:215],v[132:135],v[200:203]
s_waitcnt lgkmcnt(0)
s_add_u32 s88, s88, s89
s_add_u32 s88, s88, s90
s_add_u32 s88, s88, s91
s_cmp_eq_u32 s88, 3
s_cbranch_scc0 L_w3_poll6
L_w3_poll6_ret:
mma v[208:211],a[216:219],v[64:67],v[208:211]
s_add_u32 s38, s56, 5120
ldt a[192:193],v15 offset:256
bld a[4:7],v21,s[20:23],s38 offen sc1
mma v[208:211],a[220:223],v[68:71],v[208:211]
ldt a[194:195],v15 offset:5376
mma v[208:211],a[224:227],v[72:75],v[208:211]
ldt a[196:197],v15 offset:10496
mma v[208:211],a[228:231],v[76:79],v[208:211]
ldt a[198:199],v15 offset:15616
mma v[208:211],a[232:235],v[80:83],v[208:211]
s_add_u32 s38, s57, 5120
ldt a[200:201],v15 offset:49408
bld a[12:15],v21,s[20:23],s38 offen sc1
mma v[208:211],a[236:239],v[84:87],v[208:211]
ldt a[202:203],v15 offset:54528
mma v[212:215],a[236:239],v[108:111],v[212:215]
ldt a[204:205],v15 offset:59648
mma v[212:215],a[232:235],v[104:107],v[212:215]
ldt a[206:207],v15 offset:64768
mma v[212:215],a[228:231],v[100:103],v[212:215]
ldt a[208:209],v15 offset:24832
mma v[212:215],a[224:227],v[96:99],v[212:215]
s_add_u32 s38, s58, 5120
ldt a[210:211],v15 offset:29952
bld a[20:23],v21,s[20:23],s38 offen sc1
mma v[212:215],a[220:223],v[92:95],v[212:215]
ldt a[212:213],v15 offset:35072
mma v[212:215],a[216:219],v[88:91],v[212:215]
ldt a[214:215],v15 offset:40192
mma v[216:219],a[216:219],v[112:115],v[216:219]
mma v[216:219],a[220:223],v[116:119],v[216:219]
s_add_u32 s38, s56, 11264
bld a[28:31],v21,s[20:23],s38 offen sc1
mma v[216:219],a[224:227],v[120:123],v[216:219]
mma v[216:219],a[228:231],v[124:127],v[216:219]
mma v[216:219],a[232:235],v[128:131],v[216:219]
mma v[216:219],a[236:239],v[132:135],v[216:219]
s_waitcnt lgkmcnt(10)
mma v[224:227],a[192:195],v[64:67],v[224:227]
s_add_u32 s38, s57, 11264
s_waitcnt lgkmcnt(8)
ldt a[216:217],v16 offset:256
bld a[36:39],v21,s[20:23],s38 offen sc1
mma v[224:227],a[196:199],v[68:71],v[224:227]
s_waitcnt lgkmcnt(7)
ldt a[218:219],v16 offset:5376
mma v[224:227],a[200:203],v[72:75],v[224:227]
s_waitcnt lgkmcnt(6)
ldt a[220:221],v16 offset:10496
mma v[224:227],a[204:207],v[76:79],v[224:227]
s_waitcnt lgkmcnt(5)
ldt a[222:223],v16 offset:15616
mma v[224:227],a[208:211],v[80:83],v[224:227]
s_add_u32 s38, s58, 11264
s_waitcnt lgkmcnt(4)
ldt a[224:225],v16 offset:49408
bld a[44:47],v21,s[20:23],s38 offen sc1
mma v[224:227],a[212:215],v[84:87],v[224:227]
ldt a[226:227],v16 offset:54528
mma v[228:231],a[212:215],v[108:111],v[228:231]
ldt a[228:229],v16 offset:59648
mma v[228:231],a[208:211],v[104:107],v[228:231]
ldt a[230:231],v16 offset:64768
mma v[228:231],a[204:207],v[100:103],v[228:231]
ldt a[232:233],v16 offset:24832
mma v[228:231],a[200:203],v[96:99],v[228:231]
s_add_u32 s38, s56, 17408
ldt a[234:235],v16 offset:29952
bld a[52:55],v21,s[20:23],s38 offen sc1
mma v[228:231],a[196:199],v[92:95],v[228:231]
ldt a[236:237],v16 offset:35072
mma v[228:231],a[192:195],v[88:91],v[228:231]
ldt a[238:239],v16 offset:40192
mma v[232:235],a[192:195],v[112:115],v[232:235]
mma v[232:235],a[196:199],v[116:119],v[232:235]
s_add_u32 s38, s57, 17408
bld a[60:63],v21,s[20:23],s38 offen sc1
mma v[232:235],a[200:203],v[120:123],v[232:235]
mma v[232:235],a[204:207],v[124:127],v[232:235]
mma v[232:235],a[208:211],v[128:131],v[232:235]
mma v[232:235],a[212:215],v[132:135],v[232:235]
s_waitcnt lgkmcnt(10)
mma v[240:243],a[216:219],v[64:67],v[240:243]
s_waitcnt vmcnt(17) lgkmcnt(0)
s_barrier
mma v[240:243],a[220:223],v[68:71],v[240:243]
s_add_u32 s38, s58, 17408
ldt a[192:193],v5 offset:10240
bld a[68:71],v21,s[20:23],s38 offen sc1
mma v[240:243],a[224:227],v[72:75],v[240:243]
ldt a[194:195],v5 offset:15360
mma v[240:243],a[228:231],v[76:79],v[240:243]
ldt a[196:197],v5 offset:20480
mma v[240:243],a[232:235],v[80:83],v[240:243]
ldt a[198:199],v5 offset:25600
mma v[240:243],a[236:239],v[84:87],v[240:243]
ldt a[200:201],v5 offset:30720
mma v[244:247],a[236:239],v[108:111],v[244:247]
ldt a[202:203],v5 offset:35840
mma v[244:247],a[232:235],v[104:107],v[244:247]
ldt a[204:205],v5 offset:40960
mma v[244:247],a[228:231],v[100:103],v[244:247]
ldt a[206:207],v5 offset:46080
mma v[244:247],a[224:227],v[96:99],v[244:247]
ldt a[208:209],v5 offset:51200
mma v[244:247],a[220:223],v[92:95],v[244:247]
ldt a[210:211],v5 offset:56320
mma v[244:247],a[216:219],v[88:91],v[244:247]
ldt a[212:213],v5
mma v[248:251],a[216:219],v[112:115],v[248:251]
ldt a[214:215],v5 offset:5120
mma v[248:251],a[220:223],v[116:119],v[248:251]
mma v[248:251],a[224:227],v[120:123],v[248:251]
mma v[248:251],a[228:231],v[124:127],v[248:251]
mma v[248:251],a[232:235],v[128:131],v[248:251]
mma v[248:251],a[236:239],v[132:135],v[248:251]
s_waitcnt vmcnt(17) lgkmcnt(10)
mma a[96:99],a[192:195],a[0:3],a[96:99]
s_waitcnt vmcnt(8) lgkmcnt(8)
ldt a[216:217],v6 offset:10240
mma a[96:99],a[196:199],a[4:7],a[96:99]
s_waitcnt lgkmcnt(7)
ldt a[218:219],v6 offset:15360
mma a[96:99],a[200:203],a[8:11],a[96:99]
s_waitcnt vmcnt(7) lgkmcnt(6)
ldt a[220:221],v6 offset:20480
mma a[96:99],a[204:207],a[12:15],a[96:99]
s_waitcnt lgkmcnt(5)
ldt a[222:223],v6 offset:25600
mma a[96:99],a[208:211],a[16:19],a[96:99]
s_waitcnt vmcnt(6) lgkmcnt(4)
ldt a[224:225],v6 offset:30720
mma a[96:99],a[212:215],a[20:23],a[96:99]
s_waitcnt vmcnt(3)
ldt a[226:227],v6 offset:35840
mma a[100:103],a[212:215],a[44:47],a[100:103]
ldt a[228:229],v6 offset:40960
mma a[100:103],a[208:211],a[40:43],a[100:103]
ldt a[230:231],v6 offset:46080
mma a[100:103],a[204:207],a[36:39],a[100:103]
ldt a[232:233],v6 offset:51200
mma a[100:103],a[200:203],a[32:35],a[100:103]
ldt a[234:235],v6 offset:56320
mma a[100:103],a[196:199],a[28:31],a[100:103]
ldt a[236:237],v6
mma a[100:103],a[192:195],a[24:27],a[100:103]
ldt a[238:239],v6 offset:5120
mma a[104:107],a[192:195],a[48:51],a[104:107]
s_waitcnt vmcnt(2)
ard v32,a96
ard v33,a97
ard v34,a98
mma a[104:107],a[196:199],a[52:55],a[104:107]
ard v35,a99
cvt v48,v32,v33
cvt v49,v34,v35
mma a[104:107],a[200:203],a[56:59],a[104:107]
s_waitcnt vmcnt(1)
mma a[104:107],a[204:207],a[60:63],a[104:107]
mma a[104:107],a[208:211],a[64:67],a[104:107]
s_waitcnt vmcnt(0)
mma a[104:107],a[212:215],a[68:71],a[104:107]
s_waitcnt lgkmcnt(10)
mma a[112:115],a[216:219],a[0:3],a[112:115]
s_waitcnt lgkmcnt(8)
ldt a[192:193],v5 offset:10304
ard v36,a100
ard v37,a101
mma a[112:115],a[220:223],a[4:7],a[112:115]
s_waitcnt lgkmcnt(7)
ldt a[194:195],v5 offset:15424
ard v38,a102
ard v39,a103
mma a[112:115],a[224:227],a[8:11],a[112:115]
s_waitcnt lgkmcnt(6)
ldt a[196:197],v5 offset:20544
cvt v52,v36,v37
cvt v53,v38,v39
mma a[112:115],a[228:231],a[12:15],a[112:115]
s_waitcnt lgkmcnt(5)
ldt a[198:199],v5 offset:25664
mma a[112:115],a[232:235],a[16:19],a[112:115]
s_waitcnt lgkmcnt(4)
ldt a[200:201],v5 offset:30784
mma a[112:115],a[236:239],a[20:23],a[112:115]
ldt a[202:203],v5 offset:35904
mma a[116:119],a[236:239],a[44:47],a[116:119]
ldt a[204:205],v5 offset:41024
ard v32,a104
ard v33,a105
mma a[116:119],a[232:235],a[40:43],a[116:119]
ldt a[206:207],v5 offset:46144
ard v34,a106
ard v35,a107
mma a[116:119],a[228:231],a[36:39],a[116:119]
ldt a[208:209],v5 offset:51264
cvt v56,v32,v33
cvt v57,v34,v35
mma a[116:119],a[224:227],a[32:35],a[116:119]
ldt a[210:211],v5 offset:56384
mma a[116:119],a[220:223],a[28:31],a[116:119]
ldt a[212:213],v5 offset:64
mma a[116:119],a[216:219],a[24:27],a[116:119]
ldt a[214:215],v5 offset:5184
mma a[120:123],a[216:219],a[48:51],a[120:123]
ard v32,a112
ard v33,a113
ard v34,a114
mma a[120:123],a[220:223],a[52:55],a[120:123]
s_add_u32 s42, s27, 0
ard v35,a115
cvt v50,v32,v33
cvt v51,v34,v35
mma a[120:123],a[224:227],a[56:59],a[120:123]
buffer_store_dwordx4 v[48:51], v12, s[20:23], s42 offen sc1
mma a[120:123],a[228:231],a[60:63],a[120:123]
mma a[120:123],a[232:235],a[64:67],a[120:123]
mma a[120:123],a[236:239],a[68:71],a[120:123]
s_waitcnt lgkmcnt(10)
mma a[128:131],a[192:195],a[0:3],a[128:131]
s_waitcnt lgkmcnt(8)
ldt a[216:217],v6 offset:10304
ard v36,a116
ard v37,a117
mma a[128:131],a[196:199],a[4:7],a[128:131]
s_waitcnt lgkmcnt(7)
ldt a[218:219],v6 offset:15424
ard v38,a118
ard v39,a119
mma a[128:131],a[200:203],a[8:11],a[128:131]
s_add_u32 s42, s27, 5120
s_waitcnt lgkmcnt(6)
ldt a[220:221],v6 offset:20544
cvt v54,v36,v37
cvt v55,v38,v39
mma a[128:131],a[204:207],a[12:15],a[128:131]
s_waitcnt lgkmcnt(5)
ldt a[222:223],v6 offset:25664
buffer_store_dwordx4 v[52:55], v12, s[20:23], s42 offen sc1
mma a[128:131],a[208:211],a[16:19],a[128:131]
s_waitcnt lgkmcnt(4)
ldt a[224:225],v6 offset:30784
mma a[128:131],a[212:215],a[20:23],a[128:131]
ldt a[226:227],v6 offset:35904
mma a[132:135],a[212:215],a[44:47],a[132:135]
ldt a[228:229],v6 offset:41024
ard v32,a120
ard v33,a121
mma a[132:135],a[208:211],a[40:43],a[132:135]
ldt a[230:231],v6 offset:46144
ard v34,a122
ard v35,a123
mma a[132:135],a[204:207],a[36:39],a[132:135]
s_add_u32 s42, s28, 10240
ldt a[232:233],v6 offset:51264
cvt v58,v32,v33
cvt v59,v34,v35
mma a[132:135],a[200:203],a[32:35],a[132:135]
ldt a[234:235],v6 offset:56384
buffer_store_dwordx4 v[56:59], v12, s[20:23], s42 offen sc1
mma a[132:135],a[196:199],a[28:31],a[132:135]
ldt a[236:237],v6 offset:64
mma a[132:135],a[192:195],a[24:27],a[132:135]
ldt a[238:239],v6 offset:5184
mma a[136:139],a[192:195],a[48:51],a[136:139]
ard v32,a128
ard v33,a129
ard v34,a130
mma a[136:139],a[196:199],a[52:55],a[136:139]
ard v35,a131
cvt v144,v32,v33
cvt v145,v34,v35
mma a[136:139],a[200:203],a[56:59],a[136:139]
mma a[136:139],a[204:207],a[60:63],a[136:139]
mma a[136:139],a[208:211],a[64:67],a[136:139]
mma a[136:139],a[212:215],a[68:71],a[136:139]
s_waitcnt lgkmcnt(10)
mma a[144:147],a[216:219],a[0:3],a[144:147]
s_waitcnt lgkmcnt(8)
ldt a[192:193],v5 offset:10368
ard v36,a132
ard v37,a133
mma a[144:147],a[220:223],a[4:7],a[144:147]
s_waitcnt lgkmcnt(7)
ldt a[194:195],v5 offset:15488
ard v38,a134
ard v39,a135
mma a[144:147],a[224:227],a[8:11],a[144:147]
s_waitcnt lgkmcnt(6)
ldt a[196:197],v5 offset:20608
cvt v148,v36,v37
cvt v149,v38,v39
mma a[144:147],a[228:231],a[12:15],a[144:147]
s_waitcnt lgkmcnt(5)
ldt a[198:199],v5 offset:25728
mma a[144:147],a[232:235],a[16:19],a[144:147]
s_waitcnt lgkmcnt(4)
ldt a[200:201],v5 offset:30848
mma a[144:147],a[236:239],a[20:23],a[144:147]
ldt a[202:203],v5 offset:35968
mma a[148:151],a[236:239],a[44:47],a[148:151]
ldt a[204:205],v5 offset:41088
ard v32,a136
ard v33,a137
mma a[148:151],a[232:235],a[40:43],a[148:151]
ldt a[206:207],v5 offset:46208
ard v34,a138
ard v35,a139
mma a[148:151],a[228:231],a[36:39],a[148:151]
ldt a[208:209],v5 offset:51328
cvt v152,v32,v33
cvt v153,v34,v35
mma a[148:151],a[224:227],a[32:35],a[148:151]
ldt a[210:211],v5 offset:56448
mma a[148:151],a[220:223],a[28:31],a[148:151]
ldt a[212:213],v5 offset:128
mma a[148:151],a[216:219],a[24:27],a[148:151]
ldt a[214:215],v5 offset:5248
mma a[152:155],a[216:219],a[48:51],a[152:155]
ard v32,a144
ard v33,a145
ard v34,a146
mma a[152:155],a[220:223],a[52:55],a[152:155]
s_add_u32 s42, s27, 1024
ard v35,a147
cvt v146,v32,v33
cvt v147,v34,v35
mma a[152:155],a[224:227],a[56:59],a[152:155]
buffer_store_dwordx4 v[144:147], v12, s[20:23], s42 offen sc1
mma a[152:155],a[228:231],a[60:63],a[152:155]
mma a[152:155],a[232:235],a[64:67],a[152:155]
mma a[152:155],a[236:239],a[68:71],a[152:155]
s_waitcnt lgkmcnt(10)
mma v[160:163],a[192:195],a[0:3],v[160:163]
s_waitcnt lgkmcnt(8)
ldt a[216:217],v6 offset:10368
ard v36,a148
ard v37,a149
mma v[160:163],a[196:199],a[4:7],v[160:163]
s_waitcnt lgkmcnt(7)
ldt a[218:219],v6 offset:15488
ard v38,a150
ard v39,a151
mma v[160:163],a[200:203],a[8:11],v[160:163]
s_add_u32 s42, s27, 6144
s_waitcnt lgkmcnt(6)
ldt a[220:221],v6 offset:20608
cvt v150,v36,v37
cvt v151,v38,v39
mma v[160:163],a[204:207],a[12:15],v[160:163]
s_waitcnt lgkmcnt(5)
ldt a[222:223],v6 offset:25728
buffer_store_dwordx4 v[148:151], v12, s[20:23], s42 offen sc1
mma v[160:163],a[208:211],a[16:19],v[160:163]
s_waitcnt lgkmcnt(4)
ldt a[224:225],v6 offset:30848
mma v[160:163],a[212:215],a[20:23],v[160:163]
ldt a[226:227],v6 offset:35968
mma v[164:167],a[212:215],a[44:47],v[164:167]
ldt a[228:229],v6 offset:41088
ard v32,a152
ard v33,a153
mma v[164:167],a[208:211],a[40:43],v[164:167]
ldt a[230:231],v6 offset:46208
ard v34,a154
ard v35,a155
mma v[164:167],a[204:207],a[36:39],v[164:167]
s_add_u32 s42, s28, 11264
ldt a[232:233],v6 offset:51328
cvt v154,v32,v33
cvt v155,v34,v35
mma v[164:167],a[200:203],a[32:35],v[164:167]
ldt a[234:235],v6 offset:56448
buffer_store_dwordx4 v[152:155], v12, s[20:23], s42 offen sc1
mma v[164:167],a[196:199],a[28:31],v[164:167]
ldt a[236:237],v6 offset:128
mma v[164:167],a[192:195],a[24:27],v[164:167]
ldt a[238:239],v6 offset:5248
mma v[168:171],a[192:195],a[48:51],v[168:171]
cvt v160,v160,v161
cvt v161,v162,v163
mma v[168:171],a[196:199],a[52:55],v[168:171]
mma v[168:171],a[200:203],a[56:59],v[168:171]
mma v[168:171],a[204:207],a[60:63],v[168:171]
mma v[168:171],a[208:211],a[64:67],v[168:171]
mma v[168:171],a[212:215],a[68:71],v[168:171]
s_waitcnt lgkmcnt(10)
mma v[176:179],a[216:219],a[0:3],v[176:179]
s_waitcnt lgkmcnt(8)
ldt a[192:193],v5 offset:10432
cvt v164,v164,v165
cvt v165,v166,v167
mma v[176:179],a[220:223],a[4:7],v[176:179]
s_waitcnt lgkmcnt(7)
ldt a[194:195],v5 offset:15552
mma v[176:179],a[224:227],a[8:11],v[176:179]
s_waitcnt lgkmcnt(6)
ldt a[196:197],v5 offset:20672
mma v[176:179],a[228:231],a[12:15],v[176:179]
s_waitcnt lgkmcnt(5)
ldt a[198:199],v5 offset:25792
mma v[176:179],a[232:235],a[16:19],v[176:179]
s_waitcnt lgkmcnt(4)
ldt a[200:201],v5 offset:30912
mma v[176:179],a[236:239],a[20:23],v[176:179]
ldt a[202:203],v5 offset:36032
mma v[180:183],a[236:239],a[44:47],v[180:183]
ldt a[204:205],v5 offset:41152
cvt v168,v168,v169
cvt v169,v170,v171
mma v[180:183],a[232:235],a[40:43],v[180:183]
s_add_u32 s42, s27, 2048
ldt a[206:207],v5 offset:46272
mma v[180:183],a[228:231],a[36:39],v[180:183]
ldt a[208:209],v5 offset:51392
mma v[180:183],a[224:227],a[32:35],v[180:183]
ldt a[210:211],v5 offset:56512
mma v[180:183],a[220:223],a[28:31],v[180:183]
ldt a[212:213],v5 offset:192
mma v[180:183],a[216:219],a[24:27],v[180:183]
ldt a[214:215],v5 offset:5312
mma v[184:187],a[216:219],a[48:51],v[184:187]
cvt v162,v176,v177
cvt v163,v178,v179
mma v[184:187],a[220:223],a[52:55],v[184:187]
buffer_store_dwordx4 v[160:163], v12, s[20:23], s42 offen sc1
s_add_u32 s42, s27, 7168
mma v[184:187],a[224:227],a[56:59],v[184:187]
mma v[184:187],a[228:231],a[60:63],v[184:187]
mma v[184:187],a[232:235],a[64:67],v[184:187]
mma v[184:187],a[236:239],a[68:71],v[184:187]
s_waitcnt lgkmcnt(10)
mma v[192:195],a[192:195],a[0:3],v[192:195]
s_waitcnt lgkmcnt(8)
ldt a[216:217],v6 offset:10432
cvt v166,v180,v181
cvt v167,v182,v183
mma v[192:195],a[196:199],a[4:7],v[192:195]
s_waitcnt lgkmcnt(7)
ldt a[218:219],v6 offset:15552
buffer_store_dwordx4 v[164:167], v12, s[20:23], s42 offen sc1
mma v[192:195],a[200:203],a[8:11],v[192:195]
s_add_u32 s42, s28, 12288
s_waitcnt lgkmcnt(6)
ldt a[220:221],v6 offset:20672
mma v[192:195],a[204:207],a[12:15],v[192:195]
s_waitcnt lgkmcnt(5)
ldt a[222:223],v6 offset:25792
mma v[192:195],a[208:211],a[16:19],v[192:195]
s_waitcnt lgkmcnt(4)
ldt a[224:225],v6 offset:30912
mma v[192:195],a[212:215],a[20:23],v[192:195]
ldt a[226:227],v6 offset:36032
mma v[196:199],a[212:215],a[44:47],v[196:199]
ldt a[228:229],v6 offset:41152
cvt v170,v184,v185
cvt v171,v186,v187
mma v[196:199],a[208:211],a[40:43],v[196:199]
ldt a[230:231],v6 offset:46272
buffer_store_dwordx4 v[168:171], v12, s[20:23], s42 offen sc1
mma v[196:199],a[204:207],a[36:39],v[196:199]
ldt a[232:233],v6 offset:51392
mma v[196:199],a[200:203],a[32:35],v[196:199]
ldt a[234:235],v6 offset:56512
mma v[196:199],a[196:199],a[28:31],v[196:199]
ldt a[236:237],v6 offset:192
mma v[196:199],a[192:195],a[24:27],v[196:199]
ldt a[238:239],v6 offset:5312
mma v[200:203],a[192:195],a[48:51],v[200:203]
cvt v192,v192,v193
cvt v193,v194,v195
mma v[200:203],a[196:199],a[52:55],v[200:203]
mma v[200:203],a[200:203],a[56:59],v[200:203]
mma v[200:203],a[204:207],a[60:63],v[200:203]
mma v[200:203],a[208:211],a[64:67],v[200:203]
mma v[200:203],a[212:215],a[68:71],v[200:203]
s_waitcnt lgkmcnt(10)
mma v[208:211],a[216:219],a[0:3],v[208:211]
s_waitcnt lgkmcnt(8)
ldt a[192:193],v5 offset:10496
cvt v196,v196,v197
cvt v197,v198,v199
mma v[208:211],a[220:223],a[4:7],v[208:211]
s_waitcnt lgkmcnt(7)
ldt a[194:195],v5 offset:15616
mma v[208:211],a[224:227],a[8:11],v[208:211]
s_waitcnt lgkmcnt(6)
ldt a[196:197],v5 offset:20736
mma v[208:211],a[228:231],a[12:15],v[208:211]
s_waitcnt lgkmcnt(5)
ldt a[198:199],v5 offset:25856
mma v[208:211],a[232:235],a[16:19],v[208:211]
s_waitcnt lgkmcnt(4)
ldt a[200:201],v5 offset:30976
mma v[208:211],a[236:239],a[20:23],v[208:211]
ldt a[202:203],v5 offset:36096
mma v[212:215],a[236:239],a[44:47],v[212:215]
ldt a[204:205],v5 offset:41216
cvt v200,v200,v201
cvt v201,v202,v203
mma v[212:215],a[232:235],a[40:43],v[212:215]
s_add_u32 s42, s27, 3072
ldt a[206:207],v5 offset:46336
mma v[212:215],a[228:231],a[36:39],v[212:215]
ldt a[208:209],v5 offset:51456
mma v[212:215],a[224:227],a[32:35],v[212:215]
ldt a[210:211],v5 offset:56576
mma v[212:215],a[220:223],a[28:31],v[212:215]
ldt a[212:213],v5 offset:256
mma v[212:215],a[216:219],a[24:27],v[212:215]
ldt a[214:215],v5 offset:5376
mma v[216:219],a[216:219],a[48:51],v[216:219]
cvt v194,v208,v209
cvt v195,v210,v211
mma v[216:219],a[220:223],a[52:55],v[216:219]
buffer_store_dwordx4 v[192:195], v12, s[20:23], s42 offen sc1
s_add_u32 s42, s27, 8192
mma v[216:219],a[224:227],a[56:59],v[216:219]
mma v[216:219],a[228:231],a[60:63],v[216:219]
mma v[216:219],a[232:235],a[64:67],v[216:219]
mma v[216:219],a[236:239],a[68:71],v[216:219]
s_waitcnt lgkmcnt(10)
mma v[224:227],a[192:195],a[0:3],v[224:227]
s_waitcnt lgkmcnt(8)
ldt a[216:217],v6 offset:10496
cvt v198,v212,v213
cvt v199,v214,v215
mma v[224:227],a[196:199],a[4:7],v[224:227]
s_waitcnt lgkmcnt(7)
ldt a[218:219],v6 offset:15616
buffer_store_dwordx4 v[196:199], v12, s[20:23], s42 offen sc1
mma v[224:227],a[200:203],a[8:11],v[224:227]
s_add_u32 s42, s28, 13312
s_waitcnt lgkmcnt(6)
ldt a[220:221],v6 offset:20736
mma v[224:227],a[204:207],a[12:15],v[224:227]
s_waitcnt lgkmcnt(5)
ldt a[222:223],v6 offset:25856
mma v[224:227],a[208:211],a[16:19],v[224:227]
s_waitcnt lgkmcnt(4)
ldt a[224:225],v6 offset:30976
mma v[224:227],a[212:215],a[20:23],v[224:227]
ldt a[226:227],v6 offset:36096
mma v[228:231],a[212:215],a[44:47],v[228:231]
ldt a[228:229],v6 offset:41216
cvt v202,v216,v217
cvt v203,v218,v219
mma v[228:231],a[208:211],a[40:43],v[228:231]
ldt a[230:231],v6 offset:46336
buffer_store_dwordx4 v[200:203], v12, s[20:23], s42 offen sc1
mma v[228:231],a[204:207],a[36:39],v[228:231]
ldt a[232:233],v6 offset:51456
mma v[228:231],a[200:203],a[32:35],v[228:231]
ldt a[234:235],v6 offset:56576
mma v[228:231],a[196:199],a[28:31],v[228:231]
ldt a[236:237],v6 offset:256
mma v[228:231],a[192:195],a[24:27],v[228:231]
ldt a[238:239],v6 offset:5376
mma v[232:235],a[192:195],a[48:51],v[232:235]
cvt v224,v224,v225
cvt v225,v226,v227
mma v[232:235],a[196:199],a[52:55],v[232:235]
mma v[232:235],a[200:203],a[56:59],v[232:235]
mma v[232:235],a[204:207],a[60:63],v[232:235]
mma v[232:235],a[208:211],a[64:67],v[232:235]
mma v[232:235],a[212:215],a[68:71],v[232:235]
s_waitcnt lgkmcnt(10)
mma v[240:243],a[216:219],a[0:3],v[240:243]
s_waitcnt vmcnt(6)
s_waitcnt lgkmcnt(8)
buffer_store_dword v47, v11, s[20:23], 0 offen sc1
cvt v228,v228,v229
mma v[240:243],a[220:223],a[4:7],v[240:243]
s_waitcnt lgkmcnt(6)
cvt v229,v230,v231
mma v[240:243],a[224:227],a[8:11],v[240:243]
s_waitcnt lgkmcnt(4)
mma v[240:243],a[228:231],a[12:15],v[240:243]
s_waitcnt lgkmcnt(2)
mma v[240:243],a[232:235],a[16:19],v[240:243]
s_waitcnt lgkmcnt(0)
mma v[240:243],a[236:239],a[20:23],v[240:243]
mma v[244:247],a[236:239],a[44:47],v[244:247]
s_add_u32 s42, s27, 4096
cvt v232,v232,v233
cvt v233,v234,v235
mma v[244:247],a[232:235],a[40:43],v[244:247]
mma v[244:247],a[228:231],a[36:39],v[244:247]
mma v[244:247],a[224:227],a[32:35],v[244:247]
mma v[244:247],a[220:223],a[28:31],v[244:247]
mma v[244:247],a[216:219],a[24:27],v[244:247]
mma v[248:251],a[216:219],a[48:51],v[248:251]
cvt v226,v240,v241
cvt v227,v242,v243
mma v[248:251],a[220:223],a[52:55],v[248:251]
buffer_store_dwordx4 v[224:227], v12, s[20:23], s42 offen sc1
s_add_u32 s42, s27, 9216
mma v[248:251],a[224:227],a[56:59],v[248:251]
mma v[248:251],a[228:231],a[60:63],v[248:251]
mma v[248:251],a[232:235],a[64:67],v[248:251]
mma v[248:251],a[236:239],a[68:71],v[248:251]
cvt v230,v244,v245
cvt v231,v246,v247
buffer_store_dwordx4 v[228:231], v12, s[20:23], s42 offen sc1
s_add_u32 s42, s28, 14336
s_nop 3
cvt v234,v248,v249
cvt v235,v250,v251
buffer_store_dwordx4 v[232:235], v12, s[20:23], s42 offen sc1
s_cmp_lg_u32 s27, s46
s_cbranch_scc1 L_w3_own0
s_cmp_lg_u32 s28, s46
s_cbranch_scc1 L_w3_own1
L_w3_own_ret:
s_waitcnt lgkmcnt(0)
s_barrier
s_mov_b64 exec, s[32:33]
ldq v[64:67],v4
ldq v[80:83],v4 offset:1024
ldq v[96:99],v4 offset:2048
ldq v[112:115],v4 offset:3072
ldq v[128:131],v4 offset:4096
s_mov_b64 exec, -1
s_buffer_load_dwordx8 s[88:95], s[20:23], s87 offset:384 glc
s_waitcnt vmcnt(4)
buffer_store_dword v47, v11, s[20:23], 0 offen offset:128 sc1
s_waitcnt vmcnt(1)
buffer_store_dword v47, v11, s[20:23], 0 offen offset:256 sc1
s_cmp_eq_u32 s97, -1
s_cbranch_scc1 L_w3_done
s_waitcnt lgkmcnt(0)
s_add_u32 s88, s88, s89
s_add_u32 s88, s88, s90
s_add_u32 s88, s88, s91
s_add_u32 s88, s88, s92
s_add_u32 s88, s88, s93
s_add_u32 s88, s88, s94
s_add_u32 s88, s88, s95
s_cmp_eq_u32 s88, 8
s_cbranch_scc0 L_w3_rp0
L_w3_rp0_ret:
s_add_u32 s42, s16, 0
s_not_b64 exec, s[32:33]
bld v[64:67],v13,s[20:23],s42 offen sc1
s_mov_b64 exec, -1
s_add_u32 s42, s17, 0
bld v[68:71],v13,s[20:23],s42 offen sc1
s_add_u32 s42, s18, 0
bld v[72:75],v13,s[20:23],s42 offen sc1
s_add_u32 s42, s19, 0
bld v[76:79],v13,s[20:23],s42 offen sc1
s_add_u32 s42, s16, 1024
s_not_b64 exec, s[32:33]
bld v[80:83],v13,s[20:23],s42 offen sc1
s_mov_b64 exec, -1
s_add_u32 s42, s17, 1024
bld v[84:87],v13,s[20:23],s42 offen sc1
s_add_u32 s42, s18, 1024
bld v[88:91],v13,s[20:23],s42 offen sc1
s_add_u32 s42, s19, 1024
bld v[92:95],v13,s[20:23],s42 offen sc1
L_w3_join:
s_buffer_load_dwordx8 s[88:95], s[20:23], s87 offset:512 glc
s_waitcnt lgkmcnt(0)
s_add_u32 s88, s88, s89
s_add_u32 s88, s88, s90
s_add_u32 s88, s88, s91
s_add_u32 s88, s88, s92
s_add_u32 s88, s88, s93
s_add_u32 s88, s88, s94
s_add_u32 s88, s88, s95
s_cmp_eq_u32 s88, 8
s_cbranch_scc0 L_w3_rp1
L_w3_rp1_ret:
s_add_u32 s42, s16, 2048
s_not_b64 exec, s[32:33]
bld v[96:99],v13,s[20:23],s42 offen sc1
s_mov_b64 exec, -1
s_add_u32 s42, s17, 2048
bld v[100:103],v13,s[20:23],s42 offen sc1
s_add_u32 s42, s18, 2048
bld v[104:107],v13,s[20:23],s42 offen sc1
s_add_u32 s42, s19, 2048
bld v[108:111],v13,s[20:23],s42 offen sc1
s_add_u32 s42, s16, 3072
s_not_b64 exec, s[32:33]
bld v[112:115],v13,s[20:23],s42 offen sc1
s_mov_b64 exec, -1
s_add_u32 s42, s17, 3072
bld v[116:119],v13,s[20:23],s42 offen sc1
s_add_u32 s42, s18, 3072
bld v[120:123],v13,s[20:23],s42 offen sc1
s_add_u32 s42, s19, 3072
bld v[124:127],v13,s[20:23],s42 offen sc1
s_buffer_load_dwordx8 s[88:95], s[20:23], s87 offset:640 glc
s_waitcnt vmcnt(15)
v_lshlrev_b32 v144, 16, v64
v_and_b32 v145, s43, v64
v_lshlrev_b32 v146, 16, v65
v_and_b32 v147, s43, v65
v_lshlrev_b32 v148, 16, v66
v_and_b32 v149, s43, v66
v_lshlrev_b32 v150, 16, v67
v_and_b32 v151, s43, v67
s_waitcnt vmcnt(14)
v_lshlrev_b32 v152, 16, v68
v_and_b32 v153, s43, v68
v_lshlrev_b32 v154, 16, v69
v_and_b32 v155, s43, v69
v_lshlrev_b32 v156, 16, v70
v_and_b32 v157, s43, v70
v_lshlrev_b32 v158, 16, v71
v_and_b32 v159, s43, v71
v_add_f32 v144, v144, v152
v_add_f32 v145, v145, v153
v_add_f32 v146, v146, v154
v_add_f32 v147, v147, v155
v_add_f32 v148, v148, v156
v_add_f32 v149, v149, v157
v_add_f32 v150, v150, v158
v_add_f32 v151, v151, v159
s_waitcnt vmcnt(13)
v_lshlrev_b32 v152, 16, v72
v_and_b32 v153, s43, v72
v_lshlrev_b32 v154, 16, v73
v_and_b32 v155, s43, v73
v_lshlrev_b32 v156, 16, v74
v_and_b32 v157, s43, v74
v_lshlrev_b32 v158, 16, v75
v_and_b32 v159, s43, v75
v_add_f32 v144, v144, v152
v_add_f32 v145, v145, v153
v_add_f32 v146, v146, v154
v_add_f32 v147, v147, v155
v_add_f32 v148, v148, v156
v_add_f32 v149, v149, v157
v_add_f32 v150, v150, v158
v_add_f32 v151, v151, v159
s_waitcnt vmcnt(12)
v_lshlrev_b32 v152, 16, v76
v_and_b32 v153, s43, v76
v_lshlrev_b32 v154, 16, v77
v_and_b32 v155, s43, v77
v_lshlrev_b32 v156, 16, v78
v_and_b32 v157, s43, v78
v_lshlrev_b32 v158, 16, v79
v_and_b32 v159, s43, v79
v_add_f32 v144, v144, v152
v_add_f32 v145, v145, v153
v_add_f32 v146, v146, v154
v_add_f32 v147, v147, v155
v_add_f32 v148, v148, v156
v_add_f32 v149, v149, v157
v_add_f32 v150, v150, v158
v_add_f32 v151, v151, v159
v_add_f32_dpp v152, v144, v144 row_ror:8 row_mask:0xf bank_mask:0xf
v_add_f32_dpp v153, v145, v145 row_ror:8 row_mask:0xf bank_mask:0xf
v_add_f32_dpp v154, v146, v146 row_ror:8 row_mask:0xf bank_mask:0xf
v_add_f32_dpp v155, v147, v147 row_ror:8 row_mask:0xf bank_mask:0xf
v_add_f32_dpp v156, v148, v148 row_ror:8 row_mask:0xf bank_mask:0xf
v_add_f32_dpp v157, v149, v149 row_ror:8 row_mask:0xf bank_mask:0xf
v_add_f32_dpp v158, v150, v150 row_ror:8 row_mask:0xf bank_mask:0xf
v_add_f32_dpp v159, v151, v151 row_ror:8 row_mask:0xf bank_mask:0xf
cvt v48,v152,v153
cvt v49,v154,v155
cvt v50,v156,v157
cvt v51,v158,v159
s_nop 0
v_permlane32_swap_b32 v48, v50
v_permlane32_swap_b32 v49, v51
s_nop 0
v_permlane16_swap_b32 v48, v50
v_permlane16_swap_b32 v49, v51
buffer_store_dwordx4 v[48:51], v14, s[4:7], s97 offen
s_waitcnt vmcnt(12)
v_lshlrev_b32 v144, 16, v80
v_and_b32 v145, s43, v80
v_lshlrev_b32 v146, 16, v81
v_and_b32 v147, s43, v81
v_lshlrev_b32 v148, 16, v82
v_and_b32 v149, s43, v82
v_lshlrev_b32 v150, 16, v83
v_and_b32 v151, s43, v83
s_waitcnt vmcnt(11)
v_lshlrev_b32 v152, 16, v84
v_and_b32 v153, s43, v84
v_lshlrev_b32 v154, 16, v85
v_and_b32 v155, s43, v85
v_lshlrev_b32 v156, 16, v86
v_and_b32 v157, s43, v86
v_lshlrev_b32 v158, 16, v87
v_and_b32 v159, s43, v87
v_add_f32 v144, v144, v152
v_add_f32 v145, v145, v153
v_add_f32 v146, v146, v154
v_add_f32 v147, v147, v155
v_add_f32 v148, v148, v156
v_add_f32 v149, v149, v157
v_add_f32 v150, v150, v158
v_add_f32 v151, v151, v159
s_waitcnt vmcnt(10)
v_lshlrev_b32 v152, 16, v88
v_and_b32 v153, s43, v88
v_lshlrev_b32 v154, 16, v89
v_and_b32 v155, s43, v89
v_lshlrev_b32 v156, 16, v90
v_and_b32 v157, s43, v90
v_lshlrev_b32 v158, 16, v91
v_and_b32 v159, s43, v91
v_add_f32 v144, v144, v152
v_add_f32 v145, v145, v153
v_add_f32 v146, v146, v154
v_add_f32 v147, v147, v155
v_add_f32 v148, v148, v156
v_add_f32 v149, v149, v157
v_add_f32 v150, v150, v158
v_add_f32 v151, v151, v159
s_waitcnt vmcnt(9)
v_lshlrev_b32 v152, 16, v92
v_and_b32 v153, s43, v92
v_lshlrev_b32 v154, 16, v93
v_and_b32 v155, s43, v93
v_lshlrev_b32 v156, 16, v94
v_and_b32 v157, s43, v94
v_lshlrev_b32 v158, 16, v95
v_and_b32 v159, s43, v95
v_add_f32 v144, v144, v152
v_add_f32 v145, v145, v153
v_add_f32 v146, v146, v154
v_add_f32 v147, v147, v155
v_add_f32 v148, v148, v156
v_add_f32 v149, v149, v157
v_add_f32 v150, v150, v158
v_add_f32 v151, v151, v159
v_add_f32_dpp v152, v144, v144 row_ror:8 row_mask:0xf bank_mask:0xf
v_add_f32_dpp v153, v145, v145 row_ror:8 row_mask:0xf bank_mask:0xf
v_add_f32_dpp v154, v146, v146 row_ror:8 row_mask:0xf bank_mask:0xf
v_add_f32_dpp v155, v147, v147 row_ror:8 row_mask:0xf bank_mask:0xf
v_add_f32_dpp v156, v148, v148 row_ror:8 row_mask:0xf bank_mask:0xf
v_add_f32_dpp v157, v149, v149 row_ror:8 row_mask:0xf bank_mask:0xf
v_add_f32_dpp v158, v150, v150 row_ror:8 row_mask:0xf bank_mask:0xf
v_add_f32_dpp v159, v151, v151 row_ror:8 row_mask:0xf bank_mask:0xf
cvt v52,v152,v153
cvt v53,v154,v155
cvt v54,v156,v157
cvt v55,v158,v159
s_nop 0
v_permlane32_swap_b32 v52, v54
v_permlane32_swap_b32 v53, v55
s_nop 0
v_permlane16_swap_b32 v52, v54
v_permlane16_swap_b32 v53, v55
buffer_store_dwordx4 v[52:55], v14, s[4:7], s97 offen offset:64
s_waitcnt lgkmcnt(0)
s_add_u32 s88, s88, s89
s_add_u32 s88, s88, s90
s_add_u32 s88, s88, s91
s_add_u32 s88, s88, s92
s_add_u32 s88, s88, s93
s_add_u32 s88, s88, s94
s_add_u32 s88, s88, s95
s_cmp_eq_u32 s88, 8
s_cbranch_scc0 L_w3_rp2
L_w3_rp2_ret:
s_add_u32 s42, s16, 4096
s_not_b64 exec, s[32:33]
bld v[128:131],v13,s[20:23],s42 offen sc1
s_mov_b64 exec, -1
s_add_u32 s42, s17, 4096
bld v[132:135],v13,s[20:23],s42 offen sc1
s_add_u32 s42, s18, 4096
bld v[136:139],v13,s[20:23],s42 offen sc1
s_add_u32 s42, s19, 4096
s_waitcnt vmcnt(12)
bld v[140:143],v13,s[20:23],s42 offen sc1
v_lshlrev_b32 v144, 16, v96
v_and_b32 v145, s43, v96
v_lshlrev_b32 v146, 16, v97
v_and_b32 v147, s43, v97
v_lshlrev_b32 v148, 16, v98
v_and_b32 v149, s43, v98
v_lshlrev_b32 v150, 16, v99
v_and_b32 v151, s43, v99
s_waitcnt vmcnt(12)
v_lshlrev_b32 v152, 16, v100
v_and_b32 v153, s43, v100
v_lshlrev_b32 v154, 16, v101
v_and_b32 v155, s43, v101
v_lshlrev_b32 v156, 16, v102
v_and_b32 v157, s43, v102
v_lshlrev_b32 v158, 16, v103
v_and_b32 v159, s43, v103
v_add_f32 v144, v144, v152
v_add_f32 v145, v145, v153
v_add_f32 v146, v146, v154
v_add_f32 v147, v147, v155
v_add_f32 v148, v148, v156
v_add_f32 v149, v149, v157
v_add_f32 v150, v150, v158
v_add_f32 v151, v151, v159
s_waitcnt vmcnt(11)
v_lshlrev_b32 v152, 16, v104
v_and_b32 v153, s43, v104
v_lshlrev_b32 v154, 16, v105
v_and_b32 v155, s43, v105
v_lshlrev_b32 v156, 16, v106
v_and_b32 v157, s43, v106
v_lshlrev_b32 v158, 16, v107
v_and_b32 v159, s43, v107
v_add_f32 v144, v144, v152
v_add_f32 v145, v145, v153
v_add_f32 v146, v146, v154
v_add_f32 v147, v147, v155
v_add_f32 v148, v148, v156
v_add_f32 v149, v149, v157
v_add_f32 v150, v150, v158
v_add_f32 v151, v151, v159
s_waitcnt vmcnt(10)
v_lshlrev_b32 v152, 16, v108
v_and_b32 v153, s43, v108
v_lshlrev_b32 v154, 16, v109
v_and_b32 v155, s43, v109
v_lshlrev_b32 v156, 16, v110
v_and_b32 v157, s43, v110
v_lshlrev_b32 v158, 16, v111
v_and_b32 v159, s43, v111
v_add_f32 v144, v144, v152
v_add_f32 v145, v145, v153
v_add_f32 v146, v146, v154
v_add_f32 v147, v147, v155
v_add_f32 v148, v148, v156
v_add_f32 v149, v149, v157
v_add_f32 v150, v150, v158
v_add_f32 v151, v151, v159
v_add_f32_dpp v152, v144, v144 row_ror:8 row_mask:0xf bank_mask:0xf
v_add_f32_dpp v153, v145, v145 row_ror:8 row_mask:0xf bank_mask:0xf
v_add_f32_dpp v154, v146, v146 row_ror:8 row_mask:0xf bank_mask:0xf
v_add_f32_dpp v155, v147, v147 row_ror:8 row_mask:0xf bank_mask:0xf
v_add_f32_dpp v156, v148, v148 row_ror:8 row_mask:0xf bank_mask:0xf
v_add_f32_dpp v157, v149, v149 row_ror:8 row_mask:0xf bank_mask:0xf
v_add_f32_dpp v158, v150, v150 row_ror:8 row_mask:0xf bank_mask:0xf
v_add_f32_dpp v159, v151, v151 row_ror:8 row_mask:0xf bank_mask:0xf
cvt v48,v152,v153
cvt v49,v154,v155
cvt v50,v156,v157
cvt v51,v158,v159
s_nop 0
v_permlane32_swap_b32 v48, v50
v_permlane32_swap_b32 v49, v51
s_nop 0
v_permlane16_swap_b32 v48, v50
v_permlane16_swap_b32 v49, v51
buffer_store_dwordx4 v[48:51], v14, s[4:7], s97 offen offset:128
s_waitcnt vmcnt(10)
v_lshlrev_b32 v144, 16, v112
v_and_b32 v145, s43, v112
v_lshlrev_b32 v146, 16, v113
v_and_b32 v147, s43, v113
v_lshlrev_b32 v148, 16, v114
v_and_b32 v149, s43, v114
v_lshlrev_b32 v150, 16, v115
v_and_b32 v151, s43, v115
s_waitcnt vmcnt(9)
v_lshlrev_b32 v152, 16, v116
v_and_b32 v153, s43, v116
v_lshlrev_b32 v154, 16, v117
v_and_b32 v155, s43, v117
v_lshlrev_b32 v156, 16, v118
v_and_b32 v157, s43, v118
v_lshlrev_b32 v158, 16, v119
v_and_b32 v159, s43, v119
v_add_f32 v144, v144, v152
v_add_f32 v145, v145, v153
v_add_f32 v146, v146, v154
v_add_f32 v147, v147, v155
v_add_f32 v148, v148, v156
v_add_f32 v149, v149, v157
v_add_f32 v150, v150, v158
v_add_f32 v151, v151, v159
s_waitcnt vmcnt(8)
v_lshlrev_b32 v152, 16, v120
v_and_b32 v153, s43, v120
v_lshlrev_b32 v154, 16, v121
v_and_b32 v155, s43, v121
v_lshlrev_b32 v156, 16, v122
v_and_b32 v157, s43, v122
v_lshlrev_b32 v158, 16, v123
v_and_b32 v159, s43, v123
v_add_f32 v144, v144, v152
v_add_f32 v145, v145, v153
v_add_f32 v146, v146, v154
v_add_f32 v147, v147, v155
v_add_f32 v148, v148, v156
v_add_f32 v149, v149, v157
v_add_f32 v150, v150, v158
v_add_f32 v151, v151, v159
s_waitcnt vmcnt(7)
v_lshlrev_b32 v152, 16, v124
v_and_b32 v153, s43, v124
v_lshlrev_b32 v154, 16, v125
v_and_b32 v155, s43, v125
v_lshlrev_b32 v156, 16, v126
v_and_b32 v157, s43, v126
v_lshlrev_b32 v158, 16, v127
v_and_b32 v159, s43, v127
v_add_f32 v144, v144, v152
v_add_f32 v145, v145, v153
v_add_f32 v146, v146, v154
v_add_f32 v147, v147, v155
v_add_f32 v148, v148, v156
v_add_f32 v149, v149, v157
v_add_f32 v150, v150, v158
v_add_f32 v151, v151, v159
v_add_f32_dpp v152, v144, v144 row_ror:8 row_mask:0xf bank_mask:0xf
v_add_f32_dpp v153, v145, v145 row_ror:8 row_mask:0xf bank_mask:0xf
v_add_f32_dpp v154, v146, v146 row_ror:8 row_mask:0xf bank_mask:0xf
v_add_f32_dpp v155, v147, v147 row_ror:8 row_mask:0xf bank_mask:0xf
v_add_f32_dpp v156, v148, v148 row_ror:8 row_mask:0xf bank_mask:0xf
v_add_f32_dpp v157, v149, v149 row_ror:8 row_mask:0xf bank_mask:0xf
v_add_f32_dpp v158, v150, v150 row_ror:8 row_mask:0xf bank_mask:0xf
v_add_f32_dpp v159, v151, v151 row_ror:8 row_mask:0xf bank_mask:0xf
cvt v52,v152,v153
cvt v53,v154,v155
cvt v54,v156,v157
cvt v55,v158,v159
s_nop 0
v_permlane32_swap_b32 v52, v54
v_permlane32_swap_b32 v53, v55
s_nop 0
v_permlane16_swap_b32 v52, v54
v_permlane16_swap_b32 v53, v55
buffer_store_dwordx4 v[52:55], v14, s[4:7], s97 offen offset:192
s_waitcnt vmcnt(5)
v_lshlrev_b32 v144, 16, v128
v_and_b32 v145, s43, v128
v_lshlrev_b32 v146, 16, v129
v_and_b32 v147, s43, v129
v_lshlrev_b32 v148, 16, v130
v_and_b32 v149, s43, v130
v_lshlrev_b32 v150, 16, v131
v_and_b32 v151, s43, v131
s_waitcnt vmcnt(4)
v_lshlrev_b32 v152, 16, v132
v_and_b32 v153, s43, v132
v_lshlrev_b32 v154, 16, v133
v_and_b32 v155, s43, v133
v_lshlrev_b32 v156, 16, v134
v_and_b32 v157, s43, v134
v_lshlrev_b32 v158, 16, v135
v_and_b32 v159, s43, v135
v_add_f32 v144, v144, v152
v_add_f32 v145, v145, v153
v_add_f32 v146, v146, v154
v_add_f32 v147, v147, v155
v_add_f32 v148, v148, v156
v_add_f32 v149, v149, v157
v_add_f32 v150, v150, v158
v_add_f32 v151, v151, v159
s_waitcnt vmcnt(3)
v_lshlrev_b32 v152, 16, v136
v_and_b32 v153, s43, v136
v_lshlrev_b32 v154, 16, v137
v_and_b32 v155, s43, v137
v_lshlrev_b32 v156, 16, v138
v_and_b32 v157, s43, v138
v_lshlrev_b32 v158, 16, v139
v_and_b32 v159, s43, v139
v_add_f32 v144, v144, v152
v_add_f32 v145, v145, v153
v_add_f32 v146, v146, v154
v_add_f32 v147, v147, v155
v_add_f32 v148, v148, v156
v_add_f32 v149, v149, v157
v_add_f32 v150, v150, v158
v_add_f32 v151, v151, v159
s_waitcnt vmcnt(2)
v_lshlrev_b32 v152, 16, v140
v_and_b32 v153, s43, v140
v_lshlrev_b32 v154, 16, v141
v_and_b32 v155, s43, v141
v_lshlrev_b32 v156, 16, v142
v_and_b32 v157, s43, v142
v_lshlrev_b32 v158, 16, v143
v_and_b32 v159, s43, v143
v_add_f32 v144, v144, v152
v_add_f32 v145, v145, v153
v_add_f32 v146, v146, v154
v_add_f32 v147, v147, v155
v_add_f32 v148, v148, v156
v_add_f32 v149, v149, v157
v_add_f32 v150, v150, v158
v_add_f32 v151, v151, v159
v_add_f32_dpp v152, v144, v144 row_ror:8 row_mask:0xf bank_mask:0xf
v_add_f32_dpp v153, v145, v145 row_ror:8 row_mask:0xf bank_mask:0xf
v_add_f32_dpp v154, v146, v146 row_ror:8 row_mask:0xf bank_mask:0xf
v_add_f32_dpp v155, v147, v147 row_ror:8 row_mask:0xf bank_mask:0xf
v_add_f32_dpp v156, v148, v148 row_ror:8 row_mask:0xf bank_mask:0xf
v_add_f32_dpp v157, v149, v149 row_ror:8 row_mask:0xf bank_mask:0xf
v_add_f32_dpp v158, v150, v150 row_ror:8 row_mask:0xf bank_mask:0xf
v_add_f32_dpp v159, v151, v151 row_ror:8 row_mask:0xf bank_mask:0xf
cvt v48,v152,v153
cvt v49,v154,v155
cvt v50,v156,v157
cvt v51,v158,v159
s_nop 0
v_permlane32_swap_b32 v48, v50
v_permlane32_swap_b32 v49, v51
s_nop 0
v_permlane16_swap_b32 v48, v50
v_permlane16_swap_b32 v49, v51
buffer_store_dwordx4 v[48:51], v14, s[4:7], s97 offen offset:256
L_w3_done:
s_endpgm
L_w3_cnt:
s_mov_b32 s47, 65536
L_w3_cnt_loop:
buffer_load_dword v46, v20, s[52:55], 0 offen sc1
s_waitcnt vmcnt(0)
v_cmp_le_u32 vcc, 32, v46
s_nop 1
s_bcnt1_i32_b64 s88, vcc
s_cmp_eq_u32 s88, 1
s_cbranch_scc1 L_w3_cnt_ret
s_sub_u32 s47, s47, 1
s_cmp_lg_u32 s47, 0
s_cbranch_scc1 L_w3_cnt_loop
s_branch L_w3_cnt_ret
L_w3_poll0:
s_mov_b32 s47, 4096
L_w3_poll0_s:
s_buffer_load_dwordx4 s[88:91], s[20:23], s87 glc
s_waitcnt lgkmcnt(0)
s_add_u32 s88, s88, s89
s_add_u32 s88, s88, s90
s_add_u32 s88, s88, s91
s_cmp_eq_u32 s88, 3
s_cbranch_scc1 L_w3_poll0_ret
s_sub_u32 s47, s47, 1
s_cmp_lg_u32 s47, 0
s_cbranch_scc1 L_w3_poll0_s
s_mov_b32 s47, 65536
L_w3_poll0_loop:
buffer_load_dword v19, v18, s[20:23], 0 offen sc1
s_waitcnt vmcnt(0)
v_cmp_le_u32 vcc, 1, v19
s_nop 1
s_bcnt1_i32_b64 s88, vcc
s_cmp_eq_u32 s88, 3
s_cbranch_scc1 L_w3_poll0_ret
s_sub_u32 s47, s47, 1
s_cmp_lg_u32 s47, 0
s_cbranch_scc1 L_w3_poll0_loop
s_branch L_w3_poll0_ret
L_w3_poll1:
s_mov_b32 s47, 4096
L_w3_poll1_s:
s_buffer_load_dwordx4 s[88:91], s[20:23], s87 offset:128 glc
s_waitcnt lgkmcnt(0)
s_add_u32 s88, s88, s89
s_add_u32 s88, s88, s90
s_add_u32 s88, s88, s91
s_cmp_eq_u32 s88, 3
s_cbranch_scc1 L_w3_poll1_ret
s_sub_u32 s47, s47, 1
s_cmp_lg_u32 s47, 0
s_cbranch_scc1 L_w3_poll1_s
s_mov_b32 s47, 65536
L_w3_poll1_loop:
buffer_load_dword v19, v18, s[20:23], 0 offen offset:128 sc1
s_waitcnt vmcnt(0)
v_cmp_le_u32 vcc, 1, v19
s_nop 1
s_bcnt1_i32_b64 s88, vcc
s_cmp_eq_u32 s88, 3
s_cbranch_scc1 L_w3_poll1_ret
s_sub_u32 s47, s47, 1
s_cmp_lg_u32 s47, 0
s_cbranch_scc1 L_w3_poll1_loop
s_branch L_w3_poll1_ret
L_w3_poll2:
s_mov_b32 s47, 4096
L_w3_poll2_s:
s_buffer_load_dwordx4 s[88:91], s[20:23], s87 offset:256 glc
s_waitcnt lgkmcnt(0)
s_add_u32 s88, s88, s89
s_add_u32 s88, s88, s90
s_add_u32 s88, s88, s91
s_cmp_eq_u32 s88, 3
s_cbranch_scc1 L_w3_poll2_ret
s_sub_u32 s47, s47, 1
s_cmp_lg_u32 s47, 0
s_cbranch_scc1 L_w3_poll2_s
s_mov_b32 s47, 65536
L_w3_poll2_loop:
buffer_load_dword v19, v18, s[20:23], 0 offen offset:256 sc1
s_waitcnt vmcnt(0)
v_cmp_le_u32 vcc, 1, v19
s_nop 1
s_bcnt1_i32_b64 s88, vcc
s_cmp_eq_u32 s88, 3
s_cbranch_scc1 L_w3_poll2_ret
s_sub_u32 s47, s47, 1
s_cmp_lg_u32 s47, 0
s_cbranch_scc1 L_w3_poll2_loop
s_branch L_w3_poll2_ret
L_w3_poll6:
s_mov_b32 s47, 4096
L_w3_poll6_s:
s_buffer_load_dwordx4 s[88:91], s[20:23], s87 offset:768 glc
s_waitcnt lgkmcnt(0)
s_add_u32 s88, s88, s89
s_add_u32 s88, s88, s90
s_add_u32 s88, s88, s91
s_cmp_eq_u32 s88, 3
s_cbranch_scc1 L_w3_poll6_ret
s_sub_u32 s47, s47, 1
s_cmp_lg_u32 s47, 0
s_cbranch_scc1 L_w3_poll6_s
s_mov_b32 s47, 65536
L_w3_poll6_loop:
buffer_load_dword v19, v18, s[20:23], 0 offen offset:768 sc1
s_waitcnt vmcnt(0)
v_cmp_le_u32 vcc, 1, v19
s_nop 1
s_bcnt1_i32_b64 s88, vcc
s_cmp_eq_u32 s88, 3
s_cbranch_scc1 L_w3_poll6_ret
s_sub_u32 s47, s47, 1
s_cmp_lg_u32 s47, 0
s_cbranch_scc1 L_w3_poll6_loop
s_branch L_w3_poll6_ret
L_w3_own0:
ds_write_b128 v2, v[48:51]
ds_write_b128 v2, v[52:55] offset:5120
ds_write_b128 v2, v[144:147] offset:1024
ds_write_b128 v2, v[148:151] offset:6144
ds_write_b128 v2, v[160:163] offset:2048
ds_write_b128 v2, v[164:167] offset:7168
ds_write_b128 v2, v[192:195] offset:3072
ds_write_b128 v2, v[196:199] offset:8192
ds_write_b128 v2, v[224:227] offset:4096
ds_write_b128 v2, v[228:231] offset:9216
s_branch L_w3_own_ret
L_w3_own1:
ds_write_b128 v3, v[56:59]
ds_write_b128 v3, v[152:155] offset:1024
ds_write_b128 v3, v[168:171] offset:2048
ds_write_b128 v3, v[200:203] offset:3072
ds_write_b128 v3, v[232:235] offset:4096
s_branch L_w3_own_ret
L_w3_rp0:
s_mov_b32 s47, 4096
L_w3_rp0_s:
s_buffer_load_dwordx8 s[88:95], s[20:23], s87 offset:384 glc
s_waitcnt lgkmcnt(0)
s_add_u32 s88, s88, s89
s_add_u32 s88, s88, s90
s_add_u32 s88, s88, s91
s_add_u32 s88, s88, s92
s_add_u32 s88, s88, s93
s_add_u32 s88, s88, s94
s_add_u32 s88, s88, s95
s_cmp_eq_u32 s88, 8
s_cbranch_scc1 L_w3_rp0_ret
s_sub_u32 s47, s47, 1
s_cmp_lg_u32 s47, 0
s_cbranch_scc1 L_w3_rp0_s
s_mov_b32 s47, 65536
L_w3_rp0_loop:
buffer_load_dword v19, v18, s[20:23], 0 offen offset:384 sc1
s_waitcnt vmcnt(0)
v_cmp_le_u32 vcc, 1, v19
s_nop 1
s_bcnt1_i32_b64 s88, vcc
s_cmp_eq_u32 s88, 8
s_cbranch_scc1 L_w3_rp0_ret
s_sub_u32 s47, s47, 1
s_cmp_lg_u32 s47, 0
s_cbranch_scc1 L_w3_rp0_loop
s_branch L_w3_rp0_ret
L_w3_rp1:
s_mov_b32 s47, 4096
L_w3_rp1_s:
s_buffer_load_dwordx8 s[88:95], s[20:23], s87 offset:512 glc
s_waitcnt lgkmcnt(0)
s_add_u32 s88, s88, s89
s_add_u32 s88, s88, s90
s_add_u32 s88, s88, s91
s_add_u32 s88, s88, s92
s_add_u32 s88, s88, s93
s_add_u32 s88, s88, s94
s_add_u32 s88, s88, s95
s_cmp_eq_u32 s88, 8
s_cbranch_scc1 L_w3_rp1_ret
s_sub_u32 s47, s47, 1
s_cmp_lg_u32 s47, 0
s_cbranch_scc1 L_w3_rp1_s
s_mov_b32 s47, 65536
L_w3_rp1_loop:
buffer_load_dword v19, v18, s[20:23], 0 offen offset:512 sc1
s_waitcnt vmcnt(0)
v_cmp_le_u32 vcc, 1, v19
s_nop 1
s_bcnt1_i32_b64 s88, vcc
s_cmp_eq_u32 s88, 8
s_cbranch_scc1 L_w3_rp1_ret
s_sub_u32 s47, s47, 1
s_cmp_lg_u32 s47, 0
s_cbranch_scc1 L_w3_rp1_loop
s_branch L_w3_rp1_ret
L_w3_rp2:
s_mov_b32 s47, 4096
L_w3_rp2_s:
s_buffer_load_dwordx8 s[88:95], s[20:23], s87 offset:640 glc
s_waitcnt lgkmcnt(0)
s_add_u32 s88, s88, s89
s_add_u32 s88, s88, s90
s_add_u32 s88, s88, s91
s_add_u32 s88, s88, s92
s_add_u32 s88, s88, s93
s_add_u32 s88, s88, s94
s_add_u32 s88, s88, s95
s_cmp_eq_u32 s88, 8
s_cbranch_scc1 L_w3_rp2_ret
s_sub_u32 s47, s47, 1
s_cmp_lg_u32 s47, 0
s_cbranch_scc1 L_w3_rp2_s
s_mov_b32 s47, 65536
L_w3_rp2_loop:
buffer_load_dword v19, v18, s[20:23], 0 offen offset:640 sc1
s_waitcnt vmcnt(0)
v_cmp_le_u32 vcc, 1, v19
s_nop 1
s_bcnt1_i32_b64 s88, vcc
s_cmp_eq_u32 s88, 8
s_cbranch_scc1 L_w3_rp2_ret
s_sub_u32 s47, s47, 1
s_cmp_lg_u32 s47, 0
s_cbranch_scc1 L_w3_rp2_loop
s_branch L_w3_rp2_ret
L_hot_end:
L_w3_tr1:
s_call_b64 s[0:1], L_w3_rare1
s_branch L_w3_tr1_ret
L_w3_tr2:
s_call_b64 s[0:1], L_w3_rare2
s_branch L_w3_tr2_ret
L_w3_tr3:
s_call_b64 s[0:1], L_w3_rare3
s_branch L_w3_tr3_ret
L_w3_tr4:
s_call_b64 s[0:1], L_w3_rare0
s_branch L_w3_tr4_ret
L_w3_tr5:
s_call_b64 s[0:1], L_w3_rare1
s_branch L_w3_tr5_ret
L_w3_tr6:
s_call_b64 s[0:1], L_w3_rare2
s_branch L_w3_tr6_ret
L_w3_tr7:
s_call_b64 s[0:1], L_w3_rare3
s_branch L_w3_tr7_ret
L_w3_tr8:
s_call_b64 s[0:1], L_w3_rare0
s_branch L_w3_tr8_ret
L_w3_tr9:
s_call_b64 s[0:1], L_w3_rare1
s_branch L_w3_tr9_ret
L_w3_tr10:
s_call_b64 s[0:1], L_w3_rare2
s_branch L_w3_tr10_ret
L_w3_tr11:
s_call_b64 s[0:1], L_w3_rare3
s_branch L_w3_tr11_ret
L_w3_tr12:
s_call_b64 s[0:1], L_w3_rare0
s_branch L_w3_tr12_ret
L_w3_tr13:
s_call_b64 s[0:1], L_w3_rare1
s_branch L_w3_tr13_ret
L_w3_tr14:
s_call_b64 s[0:1], L_w3_rare2
s_branch L_w3_tr14_ret
L_w3_tr15:
s_call_b64 s[0:1], L_w3_rare3
s_branch L_w3_tr15_ret
L_w3_tr16:
s_call_b64 s[0:1], L_w3_rare0
s_branch L_w3_tr16_ret
L_w3_tr17:
s_call_b64 s[0:1], L_w3_rare1
s_branch L_w3_tr17_ret
L_w3_tr18:
s_call_b64 s[0:1], L_w3_rare2
s_branch L_w3_tr18_ret
L_w3_tr19:
s_call_b64 s[0:1], L_w3_rare3
s_branch L_w3_tr19_ret
L_w3_tr20:
s_call_b64 s[0:1], L_w3_rare0
s_branch L_w3_tr20_ret
L_w3_tr21:
s_call_b64 s[0:1], L_w3_rare1
s_branch L_w3_tr21_ret
L_w3_tr22:
s_call_b64 s[0:1], L_w3_rare2
s_branch L_w3_tr22_ret
L_w3_tr23:
s_call_b64 s[0:1], L_w3_rare3
s_branch L_w3_tr23_ret
L_w3_tr24:
s_call_b64 s[0:1], L_w3_rare0
s_branch L_w3_tr24_ret
L_w3_tr25:
s_call_b64 s[0:1], L_w3_rare1
s_branch L_w3_tr25_ret
L_w3_tr26:
s_call_b64 s[0:1], L_w3_rare2
s_branch L_w3_tr26_ret
L_w3_tr27:
s_call_b64 s[0:1], L_w3_rare3
s_branch L_w3_tr27_ret
L_w3_tr28:
s_call_b64 s[0:1], L_w3_rare0
s_branch L_w3_tr28_ret
L_w3_tr29:
s_call_b64 s[0:1], L_w3_rare1
s_branch L_w3_tr29_ret
L_w3_tr30:
s_call_b64 s[0:1], L_w3_rare2
s_branch L_w3_tr30_ret
L_w3_tr31:
s_call_b64 s[0:1], L_w3_rare3
s_branch L_w3_tr31_ret
L_w3_rare0:
s_nop 15
s_mov_b32 s47, 4294901760
v_max3_f32 v41, v160, v161, v162
v_max3_f32 v42, v164, v165, v166
v_max3_f32 v43, v168, v169, v170
v_max3_f32 v41, v41, v163, v176
v_max3_f32 v42, v42, v167, v180
v_max3_f32 v43, v43, v171, v184
v_max3_f32 v41, v41, v177, v178
v_max3_f32 v42, v42, v181, v182
v_max3_f32 v43, v43, v185, v186
v_max_f32 v41, v41, v179
v_max_f32 v42, v42, v183
v_max_f32 v43, v43, v187
v_mov_b32 v32, v41
v_mov_b32 v33, v42
v_mov_b32 v34, v43
v_permlane32_swap_b32 v41, v32
v_permlane32_swap_b32 v42, v33
v_permlane32_swap_b32 v43, v34
v_max_f32 v41, v41, v32
v_max_f32 v42, v42, v33
v_max_f32 v43, v43, v34
v_mov_b32 v32, v41
v_mov_b32 v33, v42
v_mov_b32 v34, v43
v_permlane16_swap_b32 v41, v32
v_permlane16_swap_b32 v42, v33
v_permlane16_swap_b32 v43, v34
v_max_f32 v41, v41, v32
v_max_f32 v42, v42, v33
v_max_f32 v43, v43, v34
v_max_f32 v41, 0, v41
v_max_f32 v42, 0, v42
v_max_f32 v43, 0, v43
v_ceil_f32 v41, v41
v_ceil_f32 v42, v42
v_ceil_f32 v43, v43
v_exp_f32 v36, -v41
v_exp_f32 v37, -v42
v_exp_f32 v38, -v43
v_sub_f32 v160, v160, v41
v_sub_f32 v161, v161, v41
v_sub_f32 v162, v162, v41
v_sub_f32 v163, v163, v41
v_sub_f32 v176, v176, v41
v_sub_f32 v177, v177, v41
v_sub_f32 v178, v178, v41
v_sub_f32 v179, v179, v41
v_sub_f32 v224, v224, v41
v_sub_f32 v225, v225, v41
v_sub_f32 v226, v226, v41
v_sub_f32 v227, v227, v41
v_mul_f32 v28, v28, v36
ard v192,a0
ard v193,a1
ard v194,a2
ard v195,a3
ard v196,a16
ard v197,a17
ard v198,a18
ard v199,a19
v_mul_f32 v192, v192, v36
v_mul_f32 v193, v193, v36
v_mul_f32 v194, v194, v36
v_mul_f32 v195, v195, v36
v_mul_f32 v196, v196, v36
v_mul_f32 v197, v197, v36
v_mul_f32 v198, v198, v36
v_mul_f32 v199, v199, v36
awr a0,v192
awr a1,v193
awr a2,v194
awr a3,v195
awr a16,v196
awr a17,v197
awr a18,v198
awr a19,v199
ard v192,a32
ard v193,a33
ard v194,a34
ard v195,a35
ard v196,a48
ard v197,a49
ard v198,a50
ard v199,a51
v_mul_f32 v192, v192, v36
v_mul_f32 v193, v193, v36
v_mul_f32 v194, v194, v36
v_mul_f32 v195, v195, v36
v_mul_f32 v196, v196, v36
v_mul_f32 v197, v197, v36
v_mul_f32 v198, v198, v36
v_mul_f32 v199, v199, v36
awr a32,v192
awr a33,v193
awr a34,v194
awr a35,v195
awr a48,v196
awr a49,v197
awr a50,v198
awr a51,v199
ard v192,a64
ard v193,a65
ard v194,a66
ard v195,a67
ard v196,a80
ard v197,a81
ard v198,a82
ard v199,a83
v_mul_f32 v192, v192, v36
v_mul_f32 v193, v193, v36
v_mul_f32 v194, v194, v36
v_mul_f32 v195, v195, v36
v_mul_f32 v196, v196, v36
v_mul_f32 v197, v197, v36
v_mul_f32 v198, v198, v36
v_mul_f32 v199, v199, v36
awr a64,v192
awr a65,v193
awr a66,v194
awr a67,v195
awr a80,v196
awr a81,v197
awr a82,v198
awr a83,v199
ard v192,a96
ard v193,a97
ard v194,a98
ard v195,a99
ard v196,a112
ard v197,a113
ard v198,a114
ard v199,a115
v_mul_f32 v192, v192, v36
v_mul_f32 v193, v193, v36
v_mul_f32 v194, v194, v36
v_mul_f32 v195, v195, v36
v_mul_f32 v196, v196, v36
v_mul_f32 v197, v197, v36
v_mul_f32 v198, v198, v36
v_mul_f32 v199, v199, v36
awr a96,v192
awr a97,v193
awr a98,v194
awr a99,v195
awr a112,v196
awr a113,v197
awr a114,v198
awr a115,v199
ard v192,a128
ard v193,a129
ard v194,a130
ard v195,a131
ard v196,a144
ard v197,a145
ard v198,a146
ard v199,a147
v_mul_f32 v192, v192, v36
v_mul_f32 v193, v193, v36
v_mul_f32 v194, v194, v36
v_mul_f32 v195, v195, v36
v_mul_f32 v196, v196, v36
v_mul_f32 v197, v197, v36
v_mul_f32 v198, v198, v36
v_mul_f32 v199, v199, v36
awr a128,v192
awr a129,v193
awr a130,v194
awr a131,v195
awr a144,v196
awr a145,v197
awr a146,v198
awr a147,v199
ard v192,a160
ard v193,a161
ard v194,a162
ard v195,a163
ard v196,a176
ard v197,a177
ard v198,a178
ard v199,a179
v_mul_f32 v192, v192, v36
v_mul_f32 v193, v193, v36
v_mul_f32 v194, v194, v36
v_mul_f32 v195, v195, v36
v_mul_f32 v196, v196, v36
v_mul_f32 v197, v197, v36
v_mul_f32 v198, v198, v36
v_mul_f32 v199, v199, v36
awr a160,v192
awr a161,v193
awr a162,v194
awr a163,v195
awr a176,v196
awr a177,v197
awr a178,v198
awr a179,v199
v_lshlrev_b32 v192, 16, v240
v_and_b32 v193, s47, v240
v_lshlrev_b32 v194, 16, v241
v_and_b32 v195, s47, v241
v_lshlrev_b32 v196, 16, v242
v_and_b32 v197, s47, v242
v_lshlrev_b32 v198, 16, v243
v_and_b32 v199, s47, v243
v_mul_f32 v192, v192, v36
v_mul_f32 v193, v193, v36
v_mul_f32 v194, v194, v36
v_mul_f32 v195, v195, v36
v_mul_f32 v196, v196, v36
v_mul_f32 v197, v197, v36
v_mul_f32 v198, v198, v36
v_mul_f32 v199, v199, v36
cvt v240,v192,v193
cvt v241,v194,v195
cvt v242,v196,v197
cvt v243,v198,v199
v_lshlrev_b32 v192, 16, v48
v_and_b32 v193, s47, v48
v_lshlrev_b32 v194, 16, v49
v_and_b32 v195, s47, v49
v_lshlrev_b32 v196, 16, v50
v_and_b32 v197, s47, v50
v_lshlrev_b32 v198, 16, v51
v_and_b32 v199, s47, v51
v_mul_f32 v192, v192, v36
v_mul_f32 v193, v193, v36
v_mul_f32 v194, v194, v36
v_mul_f32 v195, v195, v36
v_mul_f32 v196, v196, v36
v_mul_f32 v197, v197, v36
v_mul_f32 v198, v198, v36
v_mul_f32 v199, v199, v36
cvt v48,v192,v193
cvt v49,v194,v195
cvt v50,v196,v197
cvt v51,v198,v199
v_sub_f32 v164, v164, v42
v_sub_f32 v165, v165, v42
v_sub_f32 v166, v166, v42
v_sub_f32 v167, v167, v42
v_sub_f32 v180, v180, v42
v_sub_f32 v181, v181, v42
v_sub_f32 v182, v182, v42
v_sub_f32 v183, v183, v42
v_sub_f32 v228, v228, v42
v_sub_f32 v229, v229, v42
v_sub_f32 v230, v230, v42
v_sub_f32 v231, v231, v42
v_mul_f32 v29, v29, v37
ard v192,a4
ard v193,a5
ard v194,a6
ard v195,a7
ard v196,a20
ard v197,a21
ard v198,a22
ard v199,a23
v_mul_f32 v192, v192, v37
v_mul_f32 v193, v193, v37
v_mul_f32 v194, v194, v37
v_mul_f32 v195, v195, v37
v_mul_f32 v196, v196, v37
v_mul_f32 v197, v197, v37
v_mul_f32 v198, v198, v37
v_mul_f32 v199, v199, v37
awr a4,v192
awr a5,v193
awr a6,v194
awr a7,v195
awr a20,v196
awr a21,v197
awr a22,v198
awr a23,v199
ard v192,a36
ard v193,a37
ard v194,a38
ard v195,a39
ard v196,a52
ard v197,a53
ard v198,a54
ard v199,a55
v_mul_f32 v192, v192, v37
v_mul_f32 v193, v193, v37
v_mul_f32 v194, v194, v37
v_mul_f32 v195, v195, v37
v_mul_f32 v196, v196, v37
v_mul_f32 v197, v197, v37
v_mul_f32 v198, v198, v37
v_mul_f32 v199, v199, v37
awr a36,v192
awr a37,v193
awr a38,v194
awr a39,v195
awr a52,v196
awr a53,v197
awr a54,v198
awr a55,v199
ard v192,a68
ard v193,a69
ard v194,a70
ard v195,a71
ard v196,a84
ard v197,a85
ard v198,a86
ard v199,a87
v_mul_f32 v192, v192, v37
v_mul_f32 v193, v193, v37
v_mul_f32 v194, v194, v37
v_mul_f32 v195, v195, v37
v_mul_f32 v196, v196, v37
v_mul_f32 v197, v197, v37
v_mul_f32 v198, v198, v37
v_mul_f32 v199, v199, v37
awr a68,v192
awr a69,v193
awr a70,v194
awr a71,v195
awr a84,v196
awr a85,v197
awr a86,v198
awr a87,v199
ard v192,a100
ard v193,a101
ard v194,a102
ard v195,a103
ard v196,a116
ard v197,a117
ard v198,a118
ard v199,a119
v_mul_f32 v192, v192, v37
v_mul_f32 v193, v193, v37
v_mul_f32 v194, v194, v37
v_mul_f32 v195, v195, v37
v_mul_f32 v196, v196, v37
v_mul_f32 v197, v197, v37
v_mul_f32 v198, v198, v37
v_mul_f32 v199, v199, v37
awr a100,v192
awr a101,v193
awr a102,v194
awr a103,v195
awr a116,v196
awr a117,v197
awr a118,v198
awr a119,v199
ard v192,a132
ard v193,a133
ard v194,a134
ard v195,a135
ard v196,a148
ard v197,a149
ard v198,a150
ard v199,a151
v_mul_f32 v192, v192, v37
v_mul_f32 v193, v193, v37
v_mul_f32 v194, v194, v37
v_mul_f32 v195, v195, v37
v_mul_f32 v196, v196, v37
v_mul_f32 v197, v197, v37
v_mul_f32 v198, v198, v37
v_mul_f32 v199, v199, v37
awr a132,v192
awr a133,v193
awr a134,v194
awr a135,v195
awr a148,v196
awr a149,v197
awr a150,v198
awr a151,v199
ard v192,a164
ard v193,a165
ard v194,a166
ard v195,a167
ard v196,a180
ard v197,a181
ard v198,a182
ard v199,a183
v_mul_f32 v192, v192, v37
v_mul_f32 v193, v193, v37
v_mul_f32 v194, v194, v37
v_mul_f32 v195, v195, v37
v_mul_f32 v196, v196, v37
v_mul_f32 v197, v197, v37
v_mul_f32 v198, v198, v37
v_mul_f32 v199, v199, v37
awr a164,v192
awr a165,v193
awr a166,v194
awr a167,v195
awr a180,v196
awr a181,v197
awr a182,v198
awr a183,v199
v_lshlrev_b32 v192, 16, v244
v_and_b32 v193, s47, v244
v_lshlrev_b32 v194, 16, v245
v_and_b32 v195, s47, v245
v_lshlrev_b32 v196, 16, v246
v_and_b32 v197, s47, v246
v_lshlrev_b32 v198, 16, v247
v_and_b32 v199, s47, v247
v_mul_f32 v192, v192, v37
v_mul_f32 v193, v193, v37
v_mul_f32 v194, v194, v37
v_mul_f32 v195, v195, v37
v_mul_f32 v196, v196, v37
v_mul_f32 v197, v197, v37
v_mul_f32 v198, v198, v37
v_mul_f32 v199, v199, v37
cvt v244,v192,v193
cvt v245,v194,v195
cvt v246,v196,v197
cvt v247,v198,v199
v_lshlrev_b32 v192, 16, v52
v_and_b32 v193, s47, v52
v_lshlrev_b32 v194, 16, v53
v_and_b32 v195, s47, v53
v_lshlrev_b32 v196, 16, v54
v_and_b32 v197, s47, v54
v_lshlrev_b32 v198, 16, v55
v_and_b32 v199, s47, v55
v_mul_f32 v192, v192, v37
v_mul_f32 v193, v193, v37
v_mul_f32 v194, v194, v37
v_mul_f32 v195, v195, v37
v_mul_f32 v196, v196, v37
v_mul_f32 v197, v197, v37
v_mul_f32 v198, v198, v37
v_mul_f32 v199, v199, v37
cvt v52,v192,v193
cvt v53,v194,v195
cvt v54,v196,v197
cvt v55,v198,v199
v_sub_f32 v168, v168, v43
v_sub_f32 v169, v169, v43
v_sub_f32 v170, v170, v43
v_sub_f32 v171, v171, v43
v_sub_f32 v184, v184, v43
v_sub_f32 v185, v185, v43
v_sub_f32 v186, v186, v43
v_sub_f32 v187, v187, v43
v_sub_f32 v232, v232, v43
v_sub_f32 v233, v233, v43
v_sub_f32 v234, v234, v43
v_sub_f32 v235, v235, v43
v_mul_f32 v30, v30, v38
ard v192,a8
ard v193,a9
ard v194,a10
ard v195,a11
ard v196,a24
ard v197,a25
ard v198,a26
ard v199,a27
v_mul_f32 v192, v192, v38
v_mul_f32 v193, v193, v38
v_mul_f32 v194, v194, v38
v_mul_f32 v195, v195, v38
v_mul_f32 v196, v196, v38
v_mul_f32 v197, v197, v38
v_mul_f32 v198, v198, v38
v_mul_f32 v199, v199, v38
awr a8,v192
awr a9,v193
awr a10,v194
awr a11,v195
awr a24,v196
awr a25,v197
awr a26,v198
awr a27,v199
ard v192,a40
ard v193,a41
ard v194,a42
ard v195,a43
ard v196,a56
ard v197,a57
ard v198,a58
ard v199,a59
v_mul_f32 v192, v192, v38
v_mul_f32 v193, v193, v38
v_mul_f32 v194, v194, v38
v_mul_f32 v195, v195, v38
v_mul_f32 v196, v196, v38
v_mul_f32 v197, v197, v38
v_mul_f32 v198, v198, v38
v_mul_f32 v199, v199, v38
awr a40,v192
awr a41,v193
awr a42,v194
awr a43,v195
awr a56,v196
awr a57,v197
awr a58,v198
awr a59,v199
ard v192,a72
ard v193,a73
ard v194,a74
ard v195,a75
ard v196,a88
ard v197,a89
ard v198,a90
ard v199,a91
v_mul_f32 v192, v192, v38
v_mul_f32 v193, v193, v38
v_mul_f32 v194, v194, v38
v_mul_f32 v195, v195, v38
v_mul_f32 v196, v196, v38
v_mul_f32 v197, v197, v38
v_mul_f32 v198, v198, v38
v_mul_f32 v199, v199, v38
awr a72,v192
awr a73,v193
awr a74,v194
awr a75,v195
awr a88,v196
awr a89,v197
awr a90,v198
awr a91,v199
ard v192,a104
ard v193,a105
ard v194,a106
ard v195,a107
ard v196,a120
ard v197,a121
ard v198,a122
ard v199,a123
v_mul_f32 v192, v192, v38
v_mul_f32 v193, v193, v38
v_mul_f32 v194, v194, v38
v_mul_f32 v195, v195, v38
v_mul_f32 v196, v196, v38
v_mul_f32 v197, v197, v38
v_mul_f32 v198, v198, v38
v_mul_f32 v199, v199, v38
awr a104,v192
awr a105,v193
awr a106,v194
awr a107,v195
awr a120,v196
awr a121,v197
awr a122,v198
awr a123,v199
ard v192,a136
ard v193,a137
ard v194,a138
ard v195,a139
ard v196,a152
ard v197,a153
ard v198,a154
ard v199,a155
v_mul_f32 v192, v192, v38
v_mul_f32 v193, v193, v38
v_mul_f32 v194, v194, v38
v_mul_f32 v195, v195, v38
v_mul_f32 v196, v196, v38
v_mul_f32 v197, v197, v38
v_mul_f32 v198, v198, v38
v_mul_f32 v199, v199, v38
awr a136,v192
awr a137,v193
awr a138,v194
awr a139,v195
awr a152,v196
awr a153,v197
awr a154,v198
awr a155,v199
ard v192,a168
ard v193,a169
ard v194,a170
ard v195,a171
ard v196,a184
ard v197,a185
ard v198,a186
ard v199,a187
v_mul_f32 v192, v192, v38
v_mul_f32 v193, v193, v38
v_mul_f32 v194, v194, v38
v_mul_f32 v195, v195, v38
v_mul_f32 v196, v196, v38
v_mul_f32 v197, v197, v38
v_mul_f32 v198, v198, v38
v_mul_f32 v199, v199, v38
awr a168,v192
awr a169,v193
awr a170,v194
awr a171,v195
awr a184,v196
awr a185,v197
awr a186,v198
awr a187,v199
v_lshlrev_b32 v192, 16, v248
v_and_b32 v193, s47, v248
v_lshlrev_b32 v194, 16, v249
v_and_b32 v195, s47, v249
v_lshlrev_b32 v196, 16, v250
v_and_b32 v197, s47, v250
v_lshlrev_b32 v198, 16, v251
v_and_b32 v199, s47, v251
v_mul_f32 v192, v192, v38
v_mul_f32 v193, v193, v38
v_mul_f32 v194, v194, v38
v_mul_f32 v195, v195, v38
v_mul_f32 v196, v196, v38
v_mul_f32 v197, v197, v38
v_mul_f32 v198, v198, v38
v_mul_f32 v199, v199, v38
cvt v248,v192,v193
cvt v249,v194,v195
cvt v250,v196,v197
cvt v251,v198,v199
v_lshlrev_b32 v192, 16, v56
v_and_b32 v193, s47, v56
v_lshlrev_b32 v194, 16, v57
v_and_b32 v195, s47, v57
v_lshlrev_b32 v196, 16, v58
v_and_b32 v197, s47, v58
v_lshlrev_b32 v198, 16, v59
v_and_b32 v199, s47, v59
v_mul_f32 v192, v192, v38
v_mul_f32 v193, v193, v38
v_mul_f32 v194, v194, v38
v_mul_f32 v195, v195, v38
v_mul_f32 v196, v196, v38
v_mul_f32 v197, v197, v38
v_mul_f32 v198, v198, v38
v_mul_f32 v199, v199, v38
cvt v56,v192,v193
cvt v57,v194,v195
cvt v58,v196,v197
cvt v59,v198,v199
v_exp_f32 v32, v160
v_exp_f32 v33, v161
v_exp_f32 v34, v162
v_exp_f32 v35, v163
v_add_f32 v24, v32, v33
cvt v192,v32,v33
v_add_f32 v24, v24, v34
cvt v193,v34,v35
v_add_f32 v24, v24, v35
v_exp_f32 v36, v164
v_exp_f32 v37, v165
v_exp_f32 v38, v166
v_exp_f32 v39, v167
v_add_f32 v25, v36, v37
cvt v196,v36,v37
v_add_f32 v25, v25, v38
cvt v197,v38,v39
v_add_f32 v25, v25, v39
v_exp_f32 v32, v168
v_exp_f32 v33, v169
v_exp_f32 v34, v170
v_exp_f32 v35, v171
v_add_f32 v26, v32, v33
cvt v200,v32,v33
v_add_f32 v26, v26, v34
cvt v201,v34,v35
v_add_f32 v26, v26, v35
v_exp_f32 v36, v176
v_exp_f32 v37, v177
v_exp_f32 v38, v178
v_exp_f32 v39, v179
v_add_f32 v24, v24, v36
cvt v194,v36,v37
v_add_f32 v24, v24, v37
v_add_f32 v24, v24, v38
cvt v195,v38,v39
v_add_f32 v24, v24, v39
v_exp_f32 v32, v180
v_exp_f32 v33, v181
v_exp_f32 v34, v182
v_exp_f32 v35, v183
v_add_f32 v25, v25, v32
cvt v198,v32,v33
v_add_f32 v25, v25, v33
v_add_f32 v25, v25, v34
cvt v199,v34,v35
v_add_f32 v25, v25, v35
v_exp_f32 v36, v184
v_exp_f32 v37, v185
v_exp_f32 v38, v186
v_exp_f32 v39, v187
v_add_f32 v26, v26, v36
cvt v202,v36,v37
v_add_f32 v26, v26, v37
v_add_f32 v26, v26, v38
cvt v203,v38,v39
v_add_f32 v26, v26, v39
s_nop 3
s_setpc_b64 s[0:1]
L_w3_rare1:
s_nop 15
s_mov_b32 s47, 4294901760
v_max3_f32 v41, v160, v161, v162
v_max3_f32 v42, v164, v165, v166
v_max3_f32 v43, v168, v169, v170
v_max3_f32 v41, v41, v163, v176
v_max3_f32 v42, v42, v167, v180
v_max3_f32 v43, v43, v171, v184
v_max3_f32 v41, v41, v177, v178
v_max3_f32 v42, v42, v181, v182
v_max3_f32 v43, v43, v185, v186
v_max_f32 v41, v41, v179
v_max_f32 v42, v42, v183
v_max_f32 v43, v43, v187
v_mov_b32 v32, v41
v_mov_b32 v33, v42
v_mov_b32 v34, v43
v_permlane32_swap_b32 v41, v32
v_permlane32_swap_b32 v42, v33
v_permlane32_swap_b32 v43, v34
v_max_f32 v41, v41, v32
v_max_f32 v42, v42, v33
v_max_f32 v43, v43, v34
v_mov_b32 v32, v41
v_mov_b32 v33, v42
v_mov_b32 v34, v43
v_permlane16_swap_b32 v41, v32
v_permlane16_swap_b32 v42, v33
v_permlane16_swap_b32 v43, v34
v_max_f32 v41, v41, v32
v_max_f32 v42, v42, v33
v_max_f32 v43, v43, v34
v_max_f32 v41, 0, v41
v_max_f32 v42, 0, v42
v_max_f32 v43, 0, v43
v_ceil_f32 v41, v41
v_ceil_f32 v42, v42
v_ceil_f32 v43, v43
v_exp_f32 v36, -v41
v_exp_f32 v37, -v42
v_exp_f32 v38, -v43
v_sub_f32 v160, v160, v41
v_sub_f32 v161, v161, v41
v_sub_f32 v162, v162, v41
v_sub_f32 v163, v163, v41
v_sub_f32 v176, v176, v41
v_sub_f32 v177, v177, v41
v_sub_f32 v178, v178, v41
v_sub_f32 v179, v179, v41
v_sub_f32 v224, v224, v41
v_sub_f32 v225, v225, v41
v_sub_f32 v226, v226, v41
v_sub_f32 v227, v227, v41
v_mul_f32 v28, v28, v36
ard v208,a0
ard v209,a1
ard v210,a2
ard v211,a3
ard v212,a16
ard v213,a17
ard v214,a18
ard v215,a19
v_mul_f32 v208, v208, v36
v_mul_f32 v209, v209, v36
v_mul_f32 v210, v210, v36
v_mul_f32 v211, v211, v36
v_mul_f32 v212, v212, v36
v_mul_f32 v213, v213, v36
v_mul_f32 v214, v214, v36
v_mul_f32 v215, v215, v36
awr a0,v208
awr a1,v209
awr a2,v210
awr a3,v211
awr a16,v212
awr a17,v213
awr a18,v214
awr a19,v215
ard v208,a32
ard v209,a33
ard v210,a34
ard v211,a35
ard v212,a48
ard v213,a49
ard v214,a50
ard v215,a51
v_mul_f32 v208, v208, v36
v_mul_f32 v209, v209, v36
v_mul_f32 v210, v210, v36
v_mul_f32 v211, v211, v36
v_mul_f32 v212, v212, v36
v_mul_f32 v213, v213, v36
v_mul_f32 v214, v214, v36
v_mul_f32 v215, v215, v36
awr a32,v208
awr a33,v209
awr a34,v210
awr a35,v211
awr a48,v212
awr a49,v213
awr a50,v214
awr a51,v215
ard v208,a64
ard v209,a65
ard v210,a66
ard v211,a67
ard v212,a80
ard v213,a81
ard v214,a82
ard v215,a83
v_mul_f32 v208, v208, v36
v_mul_f32 v209, v209, v36
v_mul_f32 v210, v210, v36
v_mul_f32 v211, v211, v36
v_mul_f32 v212, v212, v36
v_mul_f32 v213, v213, v36
v_mul_f32 v214, v214, v36
v_mul_f32 v215, v215, v36
awr a64,v208
awr a65,v209
awr a66,v210
awr a67,v211
awr a80,v212
awr a81,v213
awr a82,v214
awr a83,v215
ard v208,a96
ard v209,a97
ard v210,a98
ard v211,a99
ard v212,a112
ard v213,a113
ard v214,a114
ard v215,a115
v_mul_f32 v208, v208, v36
v_mul_f32 v209, v209, v36
v_mul_f32 v210, v210, v36
v_mul_f32 v211, v211, v36
v_mul_f32 v212, v212, v36
v_mul_f32 v213, v213, v36
v_mul_f32 v214, v214, v36
v_mul_f32 v215, v215, v36
awr a96,v208
awr a97,v209
awr a98,v210
awr a99,v211
awr a112,v212
awr a113,v213
awr a114,v214
awr a115,v215
ard v208,a128
ard v209,a129
ard v210,a130
ard v211,a131
ard v212,a144
ard v213,a145
ard v214,a146
ard v215,a147
v_mul_f32 v208, v208, v36
v_mul_f32 v209, v209, v36
v_mul_f32 v210, v210, v36
v_mul_f32 v211, v211, v36
v_mul_f32 v212, v212, v36
v_mul_f32 v213, v213, v36
v_mul_f32 v214, v214, v36
v_mul_f32 v215, v215, v36
awr a128,v208
awr a129,v209
awr a130,v210
awr a131,v211
awr a144,v212
awr a145,v213
awr a146,v214
awr a147,v215
ard v208,a160
ard v209,a161
ard v210,a162
ard v211,a163
ard v212,a176
ard v213,a177
ard v214,a178
ard v215,a179
v_mul_f32 v208, v208, v36
v_mul_f32 v209, v209, v36
v_mul_f32 v210, v210, v36
v_mul_f32 v211, v211, v36
v_mul_f32 v212, v212, v36
v_mul_f32 v213, v213, v36
v_mul_f32 v214, v214, v36
v_mul_f32 v215, v215, v36
awr a160,v208
awr a161,v209
awr a162,v210
awr a163,v211
awr a176,v212
awr a177,v213
awr a178,v214
awr a179,v215
v_lshlrev_b32 v208, 16, v192
v_and_b32 v209, s47, v192
v_lshlrev_b32 v210, 16, v193
v_and_b32 v211, s47, v193
v_lshlrev_b32 v212, 16, v194
v_and_b32 v213, s47, v194
v_lshlrev_b32 v214, 16, v195
v_and_b32 v215, s47, v195
v_mul_f32 v208, v208, v36
v_mul_f32 v209, v209, v36
v_mul_f32 v210, v210, v36
v_mul_f32 v211, v211, v36
v_mul_f32 v212, v212, v36
v_mul_f32 v213, v213, v36
v_mul_f32 v214, v214, v36
v_mul_f32 v215, v215, v36
cvt v192,v208,v209
cvt v193,v210,v211
cvt v194,v212,v213
cvt v195,v214,v215
v_sub_f32 v164, v164, v42
v_sub_f32 v165, v165, v42
v_sub_f32 v166, v166, v42
v_sub_f32 v167, v167, v42
v_sub_f32 v180, v180, v42
v_sub_f32 v181, v181, v42
v_sub_f32 v182, v182, v42
v_sub_f32 v183, v183, v42
v_sub_f32 v228, v228, v42
v_sub_f32 v229, v229, v42
v_sub_f32 v230, v230, v42
v_sub_f32 v231, v231, v42
v_mul_f32 v29, v29, v37
ard v208,a4
ard v209,a5
ard v210,a6
ard v211,a7
ard v212,a20
ard v213,a21
ard v214,a22
ard v215,a23
v_mul_f32 v208, v208, v37
v_mul_f32 v209, v209, v37
v_mul_f32 v210, v210, v37
v_mul_f32 v211, v211, v37
v_mul_f32 v212, v212, v37
v_mul_f32 v213, v213, v37
v_mul_f32 v214, v214, v37
v_mul_f32 v215, v215, v37
awr a4,v208
awr a5,v209
awr a6,v210
awr a7,v211
awr a20,v212
awr a21,v213
awr a22,v214
awr a23,v215
ard v208,a36
ard v209,a37
ard v210,a38
ard v211,a39
ard v212,a52
ard v213,a53
ard v214,a54
ard v215,a55
v_mul_f32 v208, v208, v37
v_mul_f32 v209, v209, v37
v_mul_f32 v210, v210, v37
v_mul_f32 v211, v211, v37
v_mul_f32 v212, v212, v37
v_mul_f32 v213, v213, v37
v_mul_f32 v214, v214, v37
v_mul_f32 v215, v215, v37
awr a36,v208
awr a37,v209
awr a38,v210
awr a39,v211
awr a52,v212
awr a53,v213
awr a54,v214
awr a55,v215
ard v208,a68
ard v209,a69
ard v210,a70
ard v211,a71
ard v212,a84
ard v213,a85
ard v214,a86
ard v215,a87
v_mul_f32 v208, v208, v37
v_mul_f32 v209, v209, v37
v_mul_f32 v210, v210, v37
v_mul_f32 v211, v211, v37
v_mul_f32 v212, v212, v37
v_mul_f32 v213, v213, v37
v_mul_f32 v214, v214, v37
v_mul_f32 v215, v215, v37
awr a68,v208
awr a69,v209
awr a70,v210
awr a71,v211
awr a84,v212
awr a85,v213
awr a86,v214
awr a87,v215
ard v208,a100
ard v209,a101
ard v210,a102
ard v211,a103
ard v212,a116
ard v213,a117
ard v214,a118
ard v215,a119
v_mul_f32 v208, v208, v37
v_mul_f32 v209, v209, v37
v_mul_f32 v210, v210, v37
v_mul_f32 v211, v211, v37
v_mul_f32 v212, v212, v37
v_mul_f32 v213, v213, v37
v_mul_f32 v214, v214, v37
v_mul_f32 v215, v215, v37
awr a100,v208
awr a101,v209
awr a102,v210
awr a103,v211
awr a116,v212
awr a117,v213
awr a118,v214
awr a119,v215
ard v208,a132
ard v209,a133
ard v210,a134
ard v211,a135
ard v212,a148
ard v213,a149
ard v214,a150
ard v215,a151
v_mul_f32 v208, v208, v37
v_mul_f32 v209, v209, v37
v_mul_f32 v210, v210, v37
v_mul_f32 v211, v211, v37
v_mul_f32 v212, v212, v37
v_mul_f32 v213, v213, v37
v_mul_f32 v214, v214, v37
v_mul_f32 v215, v215, v37
awr a132,v208
awr a133,v209
awr a134,v210
awr a135,v211
awr a148,v212
awr a149,v213
awr a150,v214
awr a151,v215
ard v208,a164
ard v209,a165
ard v210,a166
ard v211,a167
ard v212,a180
ard v213,a181
ard v214,a182
ard v215,a183
v_mul_f32 v208, v208, v37
v_mul_f32 v209, v209, v37
v_mul_f32 v210, v210, v37
v_mul_f32 v211, v211, v37
v_mul_f32 v212, v212, v37
v_mul_f32 v213, v213, v37
v_mul_f32 v214, v214, v37
v_mul_f32 v215, v215, v37
awr a164,v208
awr a165,v209
awr a166,v210
awr a167,v211
awr a180,v212
awr a181,v213
awr a182,v214
awr a183,v215
v_lshlrev_b32 v208, 16, v196
v_and_b32 v209, s47, v196
v_lshlrev_b32 v210, 16, v197
v_and_b32 v211, s47, v197
v_lshlrev_b32 v212, 16, v198
v_and_b32 v213, s47, v198
v_lshlrev_b32 v214, 16, v199
v_and_b32 v215, s47, v199
v_mul_f32 v208, v208, v37
v_mul_f32 v209, v209, v37
v_mul_f32 v210, v210, v37
v_mul_f32 v211, v211, v37
v_mul_f32 v212, v212, v37
v_mul_f32 v213, v213, v37
v_mul_f32 v214, v214, v37
v_mul_f32 v215, v215, v37
cvt v196,v208,v209
cvt v197,v210,v211
cvt v198,v212,v213
cvt v199,v214,v215
v_sub_f32 v168, v168, v43
v_sub_f32 v169, v169, v43
v_sub_f32 v170, v170, v43
v_sub_f32 v171, v171, v43
v_sub_f32 v184, v184, v43
v_sub_f32 v185, v185, v43
v_sub_f32 v186, v186, v43
v_sub_f32 v187, v187, v43
v_sub_f32 v232, v232, v43
v_sub_f32 v233, v233, v43
v_sub_f32 v234, v234, v43
v_sub_f32 v235, v235, v43
v_mul_f32 v30, v30, v38
ard v208,a8
ard v209,a9
ard v210,a10
ard v211,a11
ard v212,a24
ard v213,a25
ard v214,a26
ard v215,a27
v_mul_f32 v208, v208, v38
v_mul_f32 v209, v209, v38
v_mul_f32 v210, v210, v38
v_mul_f32 v211, v211, v38
v_mul_f32 v212, v212, v38
v_mul_f32 v213, v213, v38
v_mul_f32 v214, v214, v38
v_mul_f32 v215, v215, v38
awr a8,v208
awr a9,v209
awr a10,v210
awr a11,v211
awr a24,v212
awr a25,v213
awr a26,v214
awr a27,v215
ard v208,a40
ard v209,a41
ard v210,a42
ard v211,a43
ard v212,a56
ard v213,a57
ard v214,a58
ard v215,a59
v_mul_f32 v208, v208, v38
v_mul_f32 v209, v209, v38
v_mul_f32 v210, v210, v38
v_mul_f32 v211, v211, v38
v_mul_f32 v212, v212, v38
v_mul_f32 v213, v213, v38
v_mul_f32 v214, v214, v38
v_mul_f32 v215, v215, v38
awr a40,v208
awr a41,v209
awr a42,v210
awr a43,v211
awr a56,v212
awr a57,v213
awr a58,v214
awr a59,v215
ard v208,a72
ard v209,a73
ard v210,a74
ard v211,a75
ard v212,a88
ard v213,a89
ard v214,a90
ard v215,a91
v_mul_f32 v208, v208, v38
v_mul_f32 v209, v209, v38
v_mul_f32 v210, v210, v38
v_mul_f32 v211, v211, v38
v_mul_f32 v212, v212, v38
v_mul_f32 v213, v213, v38
v_mul_f32 v214, v214, v38
v_mul_f32 v215, v215, v38
awr a72,v208
awr a73,v209
awr a74,v210
awr a75,v211
awr a88,v212
awr a89,v213
awr a90,v214
awr a91,v215
ard v208,a104
ard v209,a105
ard v210,a106
ard v211,a107
ard v212,a120
ard v213,a121
ard v214,a122
ard v215,a123
v_mul_f32 v208, v208, v38
v_mul_f32 v209, v209, v38
v_mul_f32 v210, v210, v38
v_mul_f32 v211, v211, v38
v_mul_f32 v212, v212, v38
v_mul_f32 v213, v213, v38
v_mul_f32 v214, v214, v38
v_mul_f32 v215, v215, v38
awr a104,v208
awr a105,v209
awr a106,v210
awr a107,v211
awr a120,v212
awr a121,v213
awr a122,v214
awr a123,v215
ard v208,a136
ard v209,a137
ard v210,a138
ard v211,a139
ard v212,a152
ard v213,a153
ard v214,a154
ard v215,a155
v_mul_f32 v208, v208, v38
v_mul_f32 v209, v209, v38
v_mul_f32 v210, v210, v38
v_mul_f32 v211, v211, v38
v_mul_f32 v212, v212, v38
v_mul_f32 v213, v213, v38
v_mul_f32 v214, v214, v38
v_mul_f32 v215, v215, v38
awr a136,v208
awr a137,v209
awr a138,v210
awr a139,v211
awr a152,v212
awr a153,v213
awr a154,v214
awr a155,v215
ard v208,a168
ard v209,a169
ard v210,a170
ard v211,a171
ard v212,a184
ard v213,a185
ard v214,a186
ard v215,a187
v_mul_f32 v208, v208, v38
v_mul_f32 v209, v209, v38
v_mul_f32 v210, v210, v38
v_mul_f32 v211, v211, v38
v_mul_f32 v212, v212, v38
v_mul_f32 v213, v213, v38
v_mul_f32 v214, v214, v38
v_mul_f32 v215, v215, v38
awr a168,v208
awr a169,v209
awr a170,v210
awr a171,v211
awr a184,v212
awr a185,v213
awr a186,v214
awr a187,v215
v_lshlrev_b32 v208, 16, v200
v_and_b32 v209, s47, v200
v_lshlrev_b32 v210, 16, v201
v_and_b32 v211, s47, v201
v_lshlrev_b32 v212, 16, v202
v_and_b32 v213, s47, v202
v_lshlrev_b32 v214, 16, v203
v_and_b32 v215, s47, v203
v_mul_f32 v208, v208, v38
v_mul_f32 v209, v209, v38
v_mul_f32 v210, v210, v38
v_mul_f32 v211, v211, v38
v_mul_f32 v212, v212, v38
v_mul_f32 v213, v213, v38
v_mul_f32 v214, v214, v38
v_mul_f32 v215, v215, v38
cvt v200,v208,v209
cvt v201,v210,v211
cvt v202,v212,v213
cvt v203,v214,v215
v_exp_f32 v32, v160
v_exp_f32 v33, v161
v_exp_f32 v34, v162
v_exp_f32 v35, v163
v_add_f32 v24, v32, v33
cvt v208,v32,v33
v_add_f32 v24, v24, v34
cvt v209,v34,v35
v_add_f32 v24, v24, v35
v_exp_f32 v36, v164
v_exp_f32 v37, v165
v_exp_f32 v38, v166
v_exp_f32 v39, v167
v_add_f32 v25, v36, v37
cvt v212,v36,v37
v_add_f32 v25, v25, v38
cvt v213,v38,v39
v_add_f32 v25, v25, v39
v_exp_f32 v32, v168
v_exp_f32 v33, v169
v_exp_f32 v34, v170
v_exp_f32 v35, v171
v_add_f32 v26, v32, v33
cvt v216,v32,v33
v_add_f32 v26, v26, v34
cvt v217,v34,v35
v_add_f32 v26, v26, v35
v_exp_f32 v36, v176
v_exp_f32 v37, v177
v_exp_f32 v38, v178
v_exp_f32 v39, v179
v_add_f32 v24, v24, v36
cvt v210,v36,v37
v_add_f32 v24, v24, v37
v_add_f32 v24, v24, v38
cvt v211,v38,v39
v_add_f32 v24, v24, v39
v_exp_f32 v32, v180
v_exp_f32 v33, v181
v_exp_f32 v34, v182
v_exp_f32 v35, v183
v_add_f32 v25, v25, v32
cvt v214,v32,v33
v_add_f32 v25, v25, v33
v_add_f32 v25, v25, v34
cvt v215,v34,v35
v_add_f32 v25, v25, v35
v_exp_f32 v36, v184
v_exp_f32 v37, v185
v_exp_f32 v38, v186
v_exp_f32 v39, v187
v_add_f32 v26, v26, v36
cvt v218,v36,v37
v_add_f32 v26, v26, v37
v_add_f32 v26, v26, v38
cvt v219,v38,v39
v_add_f32 v26, v26, v39
s_nop 3
s_setpc_b64 s[0:1]
L_w3_rare2:
s_nop 15
s_mov_b32 s47, 4294901760
v_max3_f32 v41, v160, v161, v162
v_max3_f32 v42, v164, v165, v166
v_max3_f32 v43, v168, v169, v170
v_max3_f32 v41, v41, v163, v176
v_max3_f32 v42, v42, v167, v180
v_max3_f32 v43, v43, v171, v184
v_max3_f32 v41, v41, v177, v178
v_max3_f32 v42, v42, v181, v182
v_max3_f32 v43, v43, v185, v186
v_max_f32 v41, v41, v179
v_max_f32 v42, v42, v183
v_max_f32 v43, v43, v187
v_mov_b32 v32, v41
v_mov_b32 v33, v42
v_mov_b32 v34, v43
v_permlane32_swap_b32 v41, v32
v_permlane32_swap_b32 v42, v33
v_permlane32_swap_b32 v43, v34
v_max_f32 v41, v41, v32
v_max_f32 v42, v42, v33
v_max_f32 v43, v43, v34
v_mov_b32 v32, v41
v_mov_b32 v33, v42
v_mov_b32 v34, v43
v_permlane16_swap_b32 v41, v32
v_permlane16_swap_b32 v42, v33
v_permlane16_swap_b32 v43, v34
v_max_f32 v41, v41, v32
v_max_f32 v42, v42, v33
v_max_f32 v43, v43, v34
v_max_f32 v41, 0, v41
v_max_f32 v42, 0, v42
v_max_f32 v43, 0, v43
v_ceil_f32 v41, v41
v_ceil_f32 v42, v42
v_ceil_f32 v43, v43
v_exp_f32 v36, -v41
v_exp_f32 v37, -v42
v_exp_f32 v38, -v43
v_sub_f32 v160, v160, v41
v_sub_f32 v161, v161, v41
v_sub_f32 v162, v162, v41
v_sub_f32 v163, v163, v41
v_sub_f32 v176, v176, v41
v_sub_f32 v177, v177, v41
v_sub_f32 v178, v178, v41
v_sub_f32 v179, v179, v41
v_sub_f32 v224, v224, v41
v_sub_f32 v225, v225, v41
v_sub_f32 v226, v226, v41
v_sub_f32 v227, v227, v41
v_mul_f32 v28, v28, v36
ard v240,a0
ard v241,a1
ard v242,a2
ard v243,a3
ard v244,a16
ard v245,a17
ard v246,a18
ard v247,a19
v_mul_f32 v240, v240, v36
v_mul_f32 v241, v241, v36
v_mul_f32 v242, v242, v36
v_mul_f32 v243, v243, v36
v_mul_f32 v244, v244, v36
v_mul_f32 v245, v245, v36
v_mul_f32 v246, v246, v36
v_mul_f32 v247, v247, v36
awr a0,v240
awr a1,v241
awr a2,v242
awr a3,v243
awr a16,v244
awr a17,v245
awr a18,v246
awr a19,v247
ard v240,a32
ard v241,a33
ard v242,a34
ard v243,a35
ard v244,a48
ard v245,a49
ard v246,a50
ard v247,a51
v_mul_f32 v240, v240, v36
v_mul_f32 v241, v241, v36
v_mul_f32 v242, v242, v36
v_mul_f32 v243, v243, v36
v_mul_f32 v244, v244, v36
v_mul_f32 v245, v245, v36
v_mul_f32 v246, v246, v36
v_mul_f32 v247, v247, v36
awr a32,v240
awr a33,v241
awr a34,v242
awr a35,v243
awr a48,v244
awr a49,v245
awr a50,v246
awr a51,v247
ard v240,a64
ard v241,a65
ard v242,a66
ard v243,a67
ard v244,a80
ard v245,a81
ard v246,a82
ard v247,a83
v_mul_f32 v240, v240, v36
v_mul_f32 v241, v241, v36
v_mul_f32 v242, v242, v36
v_mul_f32 v243, v243, v36
v_mul_f32 v244, v244, v36
v_mul_f32 v245, v245, v36
v_mul_f32 v246, v246, v36
v_mul_f32 v247, v247, v36
awr a64,v240
awr a65,v241
awr a66,v242
awr a67,v243
awr a80,v244
awr a81,v245
awr a82,v246
awr a83,v247
ard v240,a96
ard v241,a97
ard v242,a98
ard v243,a99
ard v244,a112
ard v245,a113
ard v246,a114
ard v247,a115
v_mul_f32 v240, v240, v36
v_mul_f32 v241, v241, v36
v_mul_f32 v242, v242, v36
v_mul_f32 v243, v243, v36
v_mul_f32 v244, v244, v36
v_mul_f32 v245, v245, v36
v_mul_f32 v246, v246, v36
v_mul_f32 v247, v247, v36
awr a96,v240
awr a97,v241
awr a98,v242
awr a99,v243
awr a112,v244
awr a113,v245
awr a114,v246
awr a115,v247
ard v240,a128
ard v241,a129
ard v242,a130
ard v243,a131
ard v244,a144
ard v245,a145
ard v246,a146
ard v247,a147
v_mul_f32 v240, v240, v36
v_mul_f32 v241, v241, v36
v_mul_f32 v242, v242, v36
v_mul_f32 v243, v243, v36
v_mul_f32 v244, v244, v36
v_mul_f32 v245, v245, v36
v_mul_f32 v246, v246, v36
v_mul_f32 v247, v247, v36
awr a128,v240
awr a129,v241
awr a130,v242
awr a131,v243
awr a144,v244
awr a145,v245
awr a146,v246
awr a147,v247
ard v240,a160
ard v241,a161
ard v242,a162
ard v243,a163
ard v244,a176
ard v245,a177
ard v246,a178
ard v247,a179
v_mul_f32 v240, v240, v36
v_mul_f32 v241, v241, v36
v_mul_f32 v242, v242, v36
v_mul_f32 v243, v243, v36
v_mul_f32 v244, v244, v36
v_mul_f32 v245, v245, v36
v_mul_f32 v246, v246, v36
v_mul_f32 v247, v247, v36
awr a160,v240
awr a161,v241
awr a162,v242
awr a163,v243
awr a176,v244
awr a177,v245
awr a178,v246
awr a179,v247
v_lshlrev_b32 v240, 16, v192
v_and_b32 v241, s47, v192
v_lshlrev_b32 v242, 16, v193
v_and_b32 v243, s47, v193
v_lshlrev_b32 v244, 16, v194
v_and_b32 v245, s47, v194
v_lshlrev_b32 v246, 16, v195
v_and_b32 v247, s47, v195
v_mul_f32 v240, v240, v36
v_mul_f32 v241, v241, v36
v_mul_f32 v242, v242, v36
v_mul_f32 v243, v243, v36
v_mul_f32 v244, v244, v36
v_mul_f32 v245, v245, v36
v_mul_f32 v246, v246, v36
v_mul_f32 v247, v247, v36
cvt v192,v240,v241
cvt v193,v242,v243
cvt v194,v244,v245
cvt v195,v246,v247
v_lshlrev_b32 v240, 16, v208
v_and_b32 v241, s47, v208
v_lshlrev_b32 v242, 16, v209
v_and_b32 v243, s47, v209
v_lshlrev_b32 v244, 16, v210
v_and_b32 v245, s47, v210
v_lshlrev_b32 v246, 16, v211
v_and_b32 v247, s47, v211
v_mul_f32 v240, v240, v36
v_mul_f32 v241, v241, v36
v_mul_f32 v242, v242, v36
v_mul_f32 v243, v243, v36
v_mul_f32 v244, v244, v36
v_mul_f32 v245, v245, v36
v_mul_f32 v246, v246, v36
v_mul_f32 v247, v247, v36
cvt v208,v240,v241
cvt v209,v242,v243
cvt v210,v244,v245
cvt v211,v246,v247
v_sub_f32 v164, v164, v42
v_sub_f32 v165, v165, v42
v_sub_f32 v166, v166, v42
v_sub_f32 v167, v167, v42
v_sub_f32 v180, v180, v42
v_sub_f32 v181, v181, v42
v_sub_f32 v182, v182, v42
v_sub_f32 v183, v183, v42
v_sub_f32 v228, v228, v42
v_sub_f32 v229, v229, v42
v_sub_f32 v230, v230, v42
v_sub_f32 v231, v231, v42
v_mul_f32 v29, v29, v37
ard v240,a4
ard v241,a5
ard v242,a6
ard v243,a7
ard v244,a20
ard v245,a21
ard v246,a22
ard v247,a23
v_mul_f32 v240, v240, v37
v_mul_f32 v241, v241, v37
v_mul_f32 v242, v242, v37
v_mul_f32 v243, v243, v37
v_mul_f32 v244, v244, v37
v_mul_f32 v245, v245, v37
v_mul_f32 v246, v246, v37
v_mul_f32 v247, v247, v37
awr a4,v240
awr a5,v241
awr a6,v242
awr a7,v243
awr a20,v244
awr a21,v245
awr a22,v246
awr a23,v247
ard v240,a36
ard v241,a37
ard v242,a38
ard v243,a39
ard v244,a52
ard v245,a53
ard v246,a54
ard v247,a55
v_mul_f32 v240, v240, v37
v_mul_f32 v241, v241, v37
v_mul_f32 v242, v242, v37
v_mul_f32 v243, v243, v37
v_mul_f32 v244, v244, v37
v_mul_f32 v245, v245, v37
v_mul_f32 v246, v246, v37
v_mul_f32 v247, v247, v37
awr a36,v240
awr a37,v241
awr a38,v242
awr a39,v243
awr a52,v244
awr a53,v245
awr a54,v246
awr a55,v247
ard v240,a68
ard v241,a69
ard v242,a70
ard v243,a71
ard v244,a84
ard v245,a85
ard v246,a86
ard v247,a87
v_mul_f32 v240, v240, v37
v_mul_f32 v241, v241, v37
v_mul_f32 v242, v242, v37
v_mul_f32 v243, v243, v37
v_mul_f32 v244, v244, v37
v_mul_f32 v245, v245, v37
v_mul_f32 v246, v246, v37
v_mul_f32 v247, v247, v37
awr a68,v240
awr a69,v241
awr a70,v242
awr a71,v243
awr a84,v244
awr a85,v245
awr a86,v246
awr a87,v247
ard v240,a100
ard v241,a101
ard v242,a102
ard v243,a103
ard v244,a116
ard v245,a117
ard v246,a118
ard v247,a119
v_mul_f32 v240, v240, v37
v_mul_f32 v241, v241, v37
v_mul_f32 v242, v242, v37
v_mul_f32 v243, v243, v37
v_mul_f32 v244, v244, v37
v_mul_f32 v245, v245, v37
v_mul_f32 v246, v246, v37
v_mul_f32 v247, v247, v37
awr a100,v240
awr a101,v241
awr a102,v242
awr a103,v243
awr a116,v244
awr a117,v245
awr a118,v246
awr a119,v247
ard v240,a132
ard v241,a133
ard v242,a134
ard v243,a135
ard v244,a148
ard v245,a149
ard v246,a150
ard v247,a151
v_mul_f32 v240, v240, v37
v_mul_f32 v241, v241, v37
v_mul_f32 v242, v242, v37
v_mul_f32 v243, v243, v37
v_mul_f32 v244, v244, v37
v_mul_f32 v245, v245, v37
v_mul_f32 v246, v246, v37
v_mul_f32 v247, v247, v37
awr a132,v240
awr a133,v241
awr a134,v242
awr a135,v243
awr a148,v244
awr a149,v245
awr a150,v246
awr a151,v247
ard v240,a164
ard v241,a165
ard v242,a166
ard v243,a167
ard v244,a180
ard v245,a181
ard v246,a182
ard v247,a183
v_mul_f32 v240, v240, v37
v_mul_f32 v241, v241, v37
v_mul_f32 v242, v242, v37
v_mul_f32 v243, v243, v37
v_mul_f32 v244, v244, v37
v_mul_f32 v245, v245, v37
v_mul_f32 v246, v246, v37
v_mul_f32 v247, v247, v37
awr a164,v240
awr a165,v241
awr a166,v242
awr a167,v243
awr a180,v244
awr a181,v245
awr a182,v246
awr a183,v247
v_lshlrev_b32 v240, 16, v196
v_and_b32 v241, s47, v196
v_lshlrev_b32 v242, 16, v197
v_and_b32 v243, s47, v197
v_lshlrev_b32 v244, 16, v198
v_and_b32 v245, s47, v198
v_lshlrev_b32 v246, 16, v199
v_and_b32 v247, s47, v199
v_mul_f32 v240, v240, v37
v_mul_f32 v241, v241, v37
v_mul_f32 v242, v242, v37
v_mul_f32 v243, v243, v37
v_mul_f32 v244, v244, v37
v_mul_f32 v245, v245, v37
v_mul_f32 v246, v246, v37
v_mul_f32 v247, v247, v37
cvt v196,v240,v241
cvt v197,v242,v243
cvt v198,v244,v245
cvt v199,v246,v247
v_lshlrev_b32 v240, 16, v212
v_and_b32 v241, s47, v212
v_lshlrev_b32 v242, 16, v213
v_and_b32 v243, s47, v213
v_lshlrev_b32 v244, 16, v214
v_and_b32 v245, s47, v214
v_lshlrev_b32 v246, 16, v215
v_and_b32 v247, s47, v215
v_mul_f32 v240, v240, v37
v_mul_f32 v241, v241, v37
v_mul_f32 v242, v242, v37
v_mul_f32 v243, v243, v37
v_mul_f32 v244, v244, v37
v_mul_f32 v245, v245, v37
v_mul_f32 v246, v246, v37
v_mul_f32 v247, v247, v37
cvt v212,v240,v241
cvt v213,v242,v243
cvt v214,v244,v245
cvt v215,v246,v247
v_sub_f32 v168, v168, v43
v_sub_f32 v169, v169, v43
v_sub_f32 v170, v170, v43
v_sub_f32 v171, v171, v43
v_sub_f32 v184, v184, v43
v_sub_f32 v185, v185, v43
v_sub_f32 v186, v186, v43
v_sub_f32 v187, v187, v43
v_sub_f32 v232, v232, v43
v_sub_f32 v233, v233, v43
v_sub_f32 v234, v234, v43
v_sub_f32 v235, v235, v43
v_mul_f32 v30, v30, v38
ard v240,a8
ard v241,a9
ard v242,a10
ard v243,a11
ard v244,a24
ard v245,a25
ard v246,a26
ard v247,a27
v_mul_f32 v240, v240, v38
v_mul_f32 v241, v241, v38
v_mul_f32 v242, v242, v38
v_mul_f32 v243, v243, v38
v_mul_f32 v244, v244, v38
v_mul_f32 v245, v245, v38
v_mul_f32 v246, v246, v38
v_mul_f32 v247, v247, v38
awr a8,v240
awr a9,v241
awr a10,v242
awr a11,v243
awr a24,v244
awr a25,v245
awr a26,v246
awr a27,v247
ard v240,a40
ard v241,a41
ard v242,a42
ard v243,a43
ard v244,a56
ard v245,a57
ard v246,a58
ard v247,a59
v_mul_f32 v240, v240, v38
v_mul_f32 v241, v241, v38
v_mul_f32 v242, v242, v38
v_mul_f32 v243, v243, v38
v_mul_f32 v244, v244, v38
v_mul_f32 v245, v245, v38
v_mul_f32 v246, v246, v38
v_mul_f32 v247, v247, v38
awr a40,v240
awr a41,v241
awr a42,v242
awr a43,v243
awr a56,v244
awr a57,v245
awr a58,v246
awr a59,v247
ard v240,a72
ard v241,a73
ard v242,a74
ard v243,a75
ard v244,a88
ard v245,a89
ard v246,a90
ard v247,a91
v_mul_f32 v240, v240, v38
v_mul_f32 v241, v241, v38
v_mul_f32 v242, v242, v38
v_mul_f32 v243, v243, v38
v_mul_f32 v244, v244, v38
v_mul_f32 v245, v245, v38
v_mul_f32 v246, v246, v38
v_mul_f32 v247, v247, v38
awr a72,v240
awr a73,v241
awr a74,v242
awr a75,v243
awr a88,v244
awr a89,v245
awr a90,v246
awr a91,v247
ard v240,a104
ard v241,a105
ard v242,a106
ard v243,a107
ard v244,a120
ard v245,a121
ard v246,a122
ard v247,a123
v_mul_f32 v240, v240, v38
v_mul_f32 v241, v241, v38
v_mul_f32 v242, v242, v38
v_mul_f32 v243, v243, v38
v_mul_f32 v244, v244, v38
v_mul_f32 v245, v245, v38
v_mul_f32 v246, v246, v38
v_mul_f32 v247, v247, v38
awr a104,v240
awr a105,v241
awr a106,v242
awr a107,v243
awr a120,v244
awr a121,v245
awr a122,v246
awr a123,v247
ard v240,a136
ard v241,a137
ard v242,a138
ard v243,a139
ard v244,a152
ard v245,a153
ard v246,a154
ard v247,a155
v_mul_f32 v240, v240, v38
v_mul_f32 v241, v241, v38
v_mul_f32 v242, v242, v38
v_mul_f32 v243, v243, v38
v_mul_f32 v244, v244, v38
v_mul_f32 v245, v245, v38
v_mul_f32 v246, v246, v38
v_mul_f32 v247, v247, v38
awr a136,v240
awr a137,v241
awr a138,v242
awr a139,v243
awr a152,v244
awr a153,v245
awr a154,v246
awr a155,v247
ard v240,a168
ard v241,a169
ard v242,a170
ard v243,a171
ard v244,a184
ard v245,a185
ard v246,a186
ard v247,a187
v_mul_f32 v240, v240, v38
v_mul_f32 v241, v241, v38
v_mul_f32 v242, v242, v38
v_mul_f32 v243, v243, v38
v_mul_f32 v244, v244, v38
v_mul_f32 v245, v245, v38
v_mul_f32 v246, v246, v38
v_mul_f32 v247, v247, v38
awr a168,v240
awr a169,v241
awr a170,v242
awr a171,v243
awr a184,v244
awr a185,v245
awr a186,v246
awr a187,v247
v_lshlrev_b32 v240, 16, v200
v_and_b32 v241, s47, v200
v_lshlrev_b32 v242, 16, v201
v_and_b32 v243, s47, v201
v_lshlrev_b32 v244, 16, v202
v_and_b32 v245, s47, v202
v_lshlrev_b32 v246, 16, v203
v_and_b32 v247, s47, v203
v_mul_f32 v240, v240, v38
v_mul_f32 v241, v241, v38
v_mul_f32 v242, v242, v38
v_mul_f32 v243, v243, v38
v_mul_f32 v244, v244, v38
v_mul_f32 v245, v245, v38
v_mul_f32 v246, v246, v38
v_mul_f32 v247, v247, v38
cvt v200,v240,v241
cvt v201,v242,v243
cvt v202,v244,v245
cvt v203,v246,v247
v_lshlrev_b32 v240, 16, v216
v_and_b32 v241, s47, v216
v_lshlrev_b32 v242, 16, v217
v_and_b32 v243, s47, v217
v_lshlrev_b32 v244, 16, v218
v_and_b32 v245, s47, v218
v_lshlrev_b32 v246, 16, v219
v_and_b32 v247, s47, v219
v_mul_f32 v240, v240, v38
v_mul_f32 v241, v241, v38
v_mul_f32 v242, v242, v38
v_mul_f32 v243, v243, v38
v_mul_f32 v244, v244, v38
v_mul_f32 v245, v245, v38
v_mul_f32 v246, v246, v38
v_mul_f32 v247, v247, v38
cvt v216,v240,v241
cvt v217,v242,v243
cvt v218,v244,v245
cvt v219,v246,v247
v_exp_f32 v32, v160
v_exp_f32 v33, v161
v_exp_f32 v34, v162
v_exp_f32 v35, v163
v_add_f32 v24, v32, v33
cvt v240,v32,v33
v_add_f32 v24, v24, v34
cvt v241,v34,v35
v_add_f32 v24, v24, v35
v_exp_f32 v36, v164
v_exp_f32 v37, v165
v_exp_f32 v38, v166
v_exp_f32 v39, v167
v_add_f32 v25, v36, v37
cvt v244,v36,v37
v_add_f32 v25, v25, v38
cvt v245,v38,v39
v_add_f32 v25, v25, v39
v_exp_f32 v32, v168
v_exp_f32 v33, v169
v_exp_f32 v34, v170
v_exp_f32 v35, v171
v_add_f32 v26, v32, v33
cvt v248,v32,v33
v_add_f32 v26, v26, v34
cvt v249,v34,v35
v_add_f32 v26, v26, v35
v_exp_f32 v36, v176
v_exp_f32 v37, v177
v_exp_f32 v38, v178
v_exp_f32 v39, v179
v_add_f32 v24, v24, v36
cvt v242,v36,v37
v_add_f32 v24, v24, v37
v_add_f32 v24, v24, v38
cvt v243,v38,v39
v_add_f32 v24, v24, v39
v_exp_f32 v32, v180
v_exp_f32 v33, v181
v_exp_f32 v34, v182
v_exp_f32 v35, v183
v_add_f32 v25, v25, v32
cvt v246,v32,v33
v_add_f32 v25, v25, v33
v_add_f32 v25, v25, v34
cvt v247,v34,v35
v_add_f32 v25, v25, v35
v_exp_f32 v36, v184
v_exp_f32 v37, v185
v_exp_f32 v38, v186
v_exp_f32 v39, v187
v_add_f32 v26, v26, v36
cvt v250,v36,v37
v_add_f32 v26, v26, v37
v_add_f32 v26, v26, v38
cvt v251,v38,v39
v_add_f32 v26, v26, v39
s_nop 3
s_setpc_b64 s[0:1]
L_w3_rare3:
s_nop 15
s_mov_b32 s47, 4294901760
v_max3_f32 v41, v160, v161, v162
v_max3_f32 v42, v164, v165, v166
v_max3_f32 v43, v168, v169, v170
v_max3_f32 v41, v41, v163, v176
v_max3_f32 v42, v42, v167, v180
v_max3_f32 v43, v43, v171, v184
v_max3_f32 v41, v41, v177, v178
v_max3_f32 v42, v42, v181, v182
v_max3_f32 v43, v43, v185, v186
v_max_f32 v41, v41, v179
v_max_f32 v42, v42, v183
v_max_f32 v43, v43, v187
v_mov_b32 v32, v41
v_mov_b32 v33, v42
v_mov_b32 v34, v43
v_permlane32_swap_b32 v41, v32
v_permlane32_swap_b32 v42, v33
v_permlane32_swap_b32 v43, v34
v_max_f32 v41, v41, v32
v_max_f32 v42, v42, v33
v_max_f32 v43, v43, v34
v_mov_b32 v32, v41
v_mov_b32 v33, v42
v_mov_b32 v34, v43
v_permlane16_swap_b32 v41, v32
v_permlane16_swap_b32 v42, v33
v_permlane16_swap_b32 v43, v34
v_max_f32 v41, v41, v32
v_max_f32 v42, v42, v33
v_max_f32 v43, v43, v34
v_max_f32 v41, 0, v41
v_max_f32 v42, 0, v42
v_max_f32 v43, 0, v43
v_ceil_f32 v41, v41
v_ceil_f32 v42, v42
v_ceil_f32 v43, v43
v_exp_f32 v36, -v41
v_exp_f32 v37, -v42
v_exp_f32 v38, -v43
v_sub_f32 v160, v160, v41
v_sub_f32 v161, v161, v41
v_sub_f32 v162, v162, v41
v_sub_f32 v163, v163, v41
v_sub_f32 v176, v176, v41
v_sub_f32 v177, v177, v41
v_sub_f32 v178, v178, v41
v_sub_f32 v179, v179, v41
v_sub_f32 v224, v224, v41
v_sub_f32 v225, v225, v41
v_sub_f32 v226, v226, v41
v_sub_f32 v227, v227, v41
v_mul_f32 v28, v28, v36
ard v48,a0
ard v49,a1
ard v50,a2
ard v51,a3
ard v52,a16
ard v53,a17
ard v54,a18
ard v55,a19
v_mul_f32 v48, v48, v36
v_mul_f32 v49, v49, v36
v_mul_f32 v50, v50, v36
v_mul_f32 v51, v51, v36
v_mul_f32 v52, v52, v36
v_mul_f32 v53, v53, v36
v_mul_f32 v54, v54, v36
v_mul_f32 v55, v55, v36
awr a0,v48
awr a1,v49
awr a2,v50
awr a3,v51
awr a16,v52
awr a17,v53
awr a18,v54
awr a19,v55
ard v48,a32
ard v49,a33
ard v50,a34
ard v51,a35
ard v52,a48
ard v53,a49
ard v54,a50
ard v55,a51
v_mul_f32 v48, v48, v36
v_mul_f32 v49, v49, v36
v_mul_f32 v50, v50, v36
v_mul_f32 v51, v51, v36
v_mul_f32 v52, v52, v36
v_mul_f32 v53, v53, v36
v_mul_f32 v54, v54, v36
v_mul_f32 v55, v55, v36
awr a32,v48
awr a33,v49
awr a34,v50
awr a35,v51
awr a48,v52
awr a49,v53
awr a50,v54
awr a51,v55
ard v48,a64
ard v49,a65
ard v50,a66
ard v51,a67
ard v52,a80
ard v53,a81
ard v54,a82
ard v55,a83
v_mul_f32 v48, v48, v36
v_mul_f32 v49, v49, v36
v_mul_f32 v50, v50, v36
v_mul_f32 v51, v51, v36
v_mul_f32 v52, v52, v36
v_mul_f32 v53, v53, v36
v_mul_f32 v54, v54, v36
v_mul_f32 v55, v55, v36
awr a64,v48
awr a65,v49
awr a66,v50
awr a67,v51
awr a80,v52
awr a81,v53
awr a82,v54
awr a83,v55
ard v48,a96
ard v49,a97
ard v50,a98
ard v51,a99
ard v52,a112
ard v53,a113
ard v54,a114
ard v55,a115
v_mul_f32 v48, v48, v36
v_mul_f32 v49, v49, v36
v_mul_f32 v50, v50, v36
v_mul_f32 v51, v51, v36
v_mul_f32 v52, v52, v36
v_mul_f32 v53, v53, v36
v_mul_f32 v54, v54, v36
v_mul_f32 v55, v55, v36
awr a96,v48
awr a97,v49
awr a98,v50
awr a99,v51
awr a112,v52
awr a113,v53
awr a114,v54
awr a115,v55
ard v48,a128
ard v49,a129
ard v50,a130
ard v51,a131
ard v52,a144
ard v53,a145
ard v54,a146
ard v55,a147
v_mul_f32 v48, v48, v36
v_mul_f32 v49, v49, v36
v_mul_f32 v50, v50, v36
v_mul_f32 v51, v51, v36
v_mul_f32 v52, v52, v36
v_mul_f32 v53, v53, v36
v_mul_f32 v54, v54, v36
v_mul_f32 v55, v55, v36
awr a128,v48
awr a129,v49
awr a130,v50
awr a131,v51
awr a144,v52
awr a145,v53
awr a146,v54
awr a147,v55
ard v48,a160
ard v49,a161
ard v50,a162
ard v51,a163
ard v52,a176
ard v53,a177
ard v54,a178
ard v55,a179
v_mul_f32 v48, v48, v36
v_mul_f32 v49, v49, v36
v_mul_f32 v50, v50, v36
v_mul_f32 v51, v51, v36
v_mul_f32 v52, v52, v36
v_mul_f32 v53, v53, v36
v_mul_f32 v54, v54, v36
v_mul_f32 v55, v55, v36
awr a160,v48
awr a161,v49
awr a162,v50
awr a163,v51
awr a176,v52
awr a177,v53
awr a178,v54
awr a179,v55
v_lshlrev_b32 v48, 16, v240
v_and_b32 v49, s47, v240
v_lshlrev_b32 v50, 16, v241
v_and_b32 v51, s47, v241
v_lshlrev_b32 v52, 16, v242
v_and_b32 v53, s47, v242
v_lshlrev_b32 v54, 16, v243
v_and_b32 v55, s47, v243
v_mul_f32 v48, v48, v36
v_mul_f32 v49, v49, v36
v_mul_f32 v50, v50, v36
v_mul_f32 v51, v51, v36
v_mul_f32 v52, v52, v36
v_mul_f32 v53, v53, v36
v_mul_f32 v54, v54, v36
v_mul_f32 v55, v55, v36
cvt v240,v48,v49
cvt v241,v50,v51
cvt v242,v52,v53
cvt v243,v54,v55
v_sub_f32 v164, v164, v42
v_sub_f32 v165, v165, v42
v_sub_f32 v166, v166, v42
v_sub_f32 v167, v167, v42
v_sub_f32 v180, v180, v42
v_sub_f32 v181, v181, v42
v_sub_f32 v182, v182, v42
v_sub_f32 v183, v183, v42
v_sub_f32 v228, v228, v42
v_sub_f32 v229, v229, v42
v_sub_f32 v230, v230, v42
v_sub_f32 v231, v231, v42
v_mul_f32 v29, v29, v37
ard v48,a4
ard v49,a5
ard v50,a6
ard v51,a7
ard v52,a20
ard v53,a21
ard v54,a22
ard v55,a23
v_mul_f32 v48, v48, v37
v_mul_f32 v49, v49, v37
v_mul_f32 v50, v50, v37
v_mul_f32 v51, v51, v37
v_mul_f32 v52, v52, v37
v_mul_f32 v53, v53, v37
v_mul_f32 v54, v54, v37
v_mul_f32 v55, v55, v37
awr a4,v48
awr a5,v49
awr a6,v50
awr a7,v51
awr a20,v52
awr a21,v53
awr a22,v54
awr a23,v55
ard v48,a36
ard v49,a37
ard v50,a38
ard v51,a39
ard v52,a52
ard v53,a53
ard v54,a54
ard v55,a55
v_mul_f32 v48, v48, v37
v_mul_f32 v49, v49, v37
v_mul_f32 v50, v50, v37
v_mul_f32 v51, v51, v37
v_mul_f32 v52, v52, v37
v_mul_f32 v53, v53, v37
v_mul_f32 v54, v54, v37
v_mul_f32 v55, v55, v37
awr a36,v48
awr a37,v49
awr a38,v50
awr a39,v51
awr a52,v52
awr a53,v53
awr a54,v54
awr a55,v55
ard v48,a68
ard v49,a69
ard v50,a70
ard v51,a71
ard v52,a84
ard v53,a85
ard v54,a86
ard v55,a87
v_mul_f32 v48, v48, v37
v_mul_f32 v49, v49, v37
v_mul_f32 v50, v50, v37
v_mul_f32 v51, v51, v37
v_mul_f32 v52, v52, v37
v_mul_f32 v53, v53, v37
v_mul_f32 v54, v54, v37
v_mul_f32 v55, v55, v37
awr a68,v48
awr a69,v49
awr a70,v50
awr a71,v51
awr a84,v52
awr a85,v53
awr a86,v54
awr a87,v55
ard v48,a100
ard v49,a101
ard v50,a102
ard v51,a103
ard v52,a116
ard v53,a117
ard v54,a118
ard v55,a119
v_mul_f32 v48, v48, v37
v_mul_f32 v49, v49, v37
v_mul_f32 v50, v50, v37
v_mul_f32 v51, v51, v37
v_mul_f32 v52, v52, v37
v_mul_f32 v53, v53, v37
v_mul_f32 v54, v54, v37
v_mul_f32 v55, v55, v37
awr a100,v48
awr a101,v49
awr a102,v50
awr a103,v51
awr a116,v52
awr a117,v53
awr a118,v54
awr a119,v55
ard v48,a132
ard v49,a133
ard v50,a134
ard v51,a135
ard v52,a148
ard v53,a149
ard v54,a150
ard v55,a151
v_mul_f32 v48, v48, v37
v_mul_f32 v49, v49, v37
v_mul_f32 v50, v50, v37
v_mul_f32 v51, v51, v37
v_mul_f32 v52, v52, v37
v_mul_f32 v53, v53, v37
v_mul_f32 v54, v54, v37
v_mul_f32 v55, v55, v37
awr a132,v48
awr a133,v49
awr a134,v50
awr a135,v51
awr a148,v52
awr a149,v53
awr a150,v54
awr a151,v55
ard v48,a164
ard v49,a165
ard v50,a166
ard v51,a167
ard v52,a180
ard v53,a181
ard v54,a182
ard v55,a183
v_mul_f32 v48, v48, v37
v_mul_f32 v49, v49, v37
v_mul_f32 v50, v50, v37
v_mul_f32 v51, v51, v37
v_mul_f32 v52, v52, v37
v_mul_f32 v53, v53, v37
v_mul_f32 v54, v54, v37
v_mul_f32 v55, v55, v37
awr a164,v48
awr a165,v49
awr a166,v50
awr a167,v51
awr a180,v52
awr a181,v53
awr a182,v54
awr a183,v55
v_lshlrev_b32 v48, 16, v244
v_and_b32 v49, s47, v244
v_lshlrev_b32 v50, 16, v245
v_and_b32 v51, s47, v245
v_lshlrev_b32 v52, 16, v246
v_and_b32 v53, s47, v246
v_lshlrev_b32 v54, 16, v247
v_and_b32 v55, s47, v247
v_mul_f32 v48, v48, v37
v_mul_f32 v49, v49, v37
v_mul_f32 v50, v50, v37
v_mul_f32 v51, v51, v37
v_mul_f32 v52, v52, v37
v_mul_f32 v53, v53, v37
v_mul_f32 v54, v54, v37
v_mul_f32 v55, v55, v37
cvt v244,v48,v49
cvt v245,v50,v51
cvt v246,v52,v53
cvt v247,v54,v55
v_sub_f32 v168, v168, v43
v_sub_f32 v169, v169, v43
v_sub_f32 v170, v170, v43
v_sub_f32 v171, v171, v43
v_sub_f32 v184, v184, v43
v_sub_f32 v185, v185, v43
v_sub_f32 v186, v186, v43
v_sub_f32 v187, v187, v43
v_sub_f32 v232, v232, v43
v_sub_f32 v233, v233, v43
v_sub_f32 v234, v234, v43
v_sub_f32 v235, v235, v43
v_mul_f32 v30, v30, v38
ard v48,a8
ard v49,a9
ard v50,a10
ard v51,a11
ard v52,a24
ard v53,a25
ard v54,a26
ard v55,a27
v_mul_f32 v48, v48, v38
v_mul_f32 v49, v49, v38
v_mul_f32 v50, v50, v38
v_mul_f32 v51, v51, v38
v_mul_f32 v52, v52, v38
v_mul_f32 v53, v53, v38
v_mul_f32 v54, v54, v38
v_mul_f32 v55, v55, v38
awr a8,v48
awr a9,v49
awr a10,v50
awr a11,v51
awr a24,v52
awr a25,v53
awr a26,v54
awr a27,v55
ard v48,a40
ard v49,a41
ard v50,a42
ard v51,a43
ard v52,a56
ard v53,a57
ard v54,a58
ard v55,a59
v_mul_f32 v48, v48, v38
v_mul_f32 v49, v49, v38
v_mul_f32 v50, v50, v38
v_mul_f32 v51, v51, v38
v_mul_f32 v52, v52, v38
v_mul_f32 v53, v53, v38
v_mul_f32 v54, v54, v38
v_mul_f32 v55, v55, v38
awr a40,v48
awr a41,v49
awr a42,v50
awr a43,v51
awr a56,v52
awr a57,v53
awr a58,v54
awr a59,v55
ard v48,a72
ard v49,a73
ard v50,a74
ard v51,a75
ard v52,a88
ard v53,a89
ard v54,a90
ard v55,a91
v_mul_f32 v48, v48, v38
v_mul_f32 v49, v49, v38
v_mul_f32 v50, v50, v38
v_mul_f32 v51, v51, v38
v_mul_f32 v52, v52, v38
v_mul_f32 v53, v53, v38
v_mul_f32 v54, v54, v38
v_mul_f32 v55, v55, v38
awr a72,v48
awr a73,v49
awr a74,v50
awr a75,v51
awr a88,v52
awr a89,v53
awr a90,v54
awr a91,v55
ard v48,a104
ard v49,a105
ard v50,a106
ard v51,a107
ard v52,a120
ard v53,a121
ard v54,a122
ard v55,a123
v_mul_f32 v48, v48, v38
v_mul_f32 v49, v49, v38
v_mul_f32 v50, v50, v38
v_mul_f32 v51, v51, v38
v_mul_f32 v52, v52, v38
v_mul_f32 v53, v53, v38
v_mul_f32 v54, v54, v38
v_mul_f32 v55, v55, v38
awr a104,v48
awr a105,v49
awr a106,v50
awr a107,v51
awr a120,v52
awr a121,v53
awr a122,v54
awr a123,v55
ard v48,a136
ard v49,a137
ard v50,a138
ard v51,a139
ard v52,a152
ard v53,a153
ard v54,a154
ard v55,a155
v_mul_f32 v48, v48, v38
v_mul_f32 v49, v49, v38
v_mul_f32 v50, v50, v38
v_mul_f32 v51, v51, v38
v_mul_f32 v52, v52, v38
v_mul_f32 v53, v53, v38
v_mul_f32 v54, v54, v38
v_mul_f32 v55, v55, v38
awr a136,v48
awr a137,v49
awr a138,v50
awr a139,v51
awr a152,v52
awr a153,v53
awr a154,v54
awr a155,v55
ard v48,a168
ard v49,a169
ard v50,a170
ard v51,a171
ard v52,a184
ard v53,a185
ard v54,a186
ard v55,a187
v_mul_f32 v48, v48, v38
v_mul_f32 v49, v49, v38
v_mul_f32 v50, v50, v38
v_mul_f32 v51, v51, v38
v_mul_f32 v52, v52, v38
v_mul_f32 v53, v53, v38
v_mul_f32 v54, v54, v38
v_mul_f32 v55, v55, v38
awr a168,v48
awr a169,v49
awr a170,v50
awr a171,v51
awr a184,v52
awr a185,v53
awr a186,v54
awr a187,v55
v_lshlrev_b32 v48, 16, v248
v_and_b32 v49, s47, v248
v_lshlrev_b32 v50, 16, v249
v_and_b32 v51, s47, v249
v_lshlrev_b32 v52, 16, v250
v_and_b32 v53, s47, v250
v_lshlrev_b32 v54, 16, v251
v_and_b32 v55, s47, v251
v_mul_f32 v48, v48, v38
v_mul_f32 v49, v49, v38
v_mul_f32 v50, v50, v38
v_mul_f32 v51, v51, v38
v_mul_f32 v52, v52, v38
v_mul_f32 v53, v53, v38
v_mul_f32 v54, v54, v38
v_mul_f32 v55, v55, v38
cvt v248,v48,v49
cvt v249,v50,v51
cvt v250,v52,v53
cvt v251,v54,v55
v_exp_f32 v32, v160
v_exp_f32 v33, v161
v_exp_f32 v34, v162
v_exp_f32 v35, v163
v_add_f32 v24, v32, v33
cvt v48,v32,v33
v_add_f32 v24, v24, v34
cvt v49,v34,v35
v_add_f32 v24, v24, v35
v_exp_f32 v36, v164
v_exp_f32 v37, v165
v_exp_f32 v38, v166
v_exp_f32 v39, v167
v_add_f32 v25, v36, v37
cvt v52,v36,v37
v_add_f32 v25, v25, v38
cvt v53,v38,v39
v_add_f32 v25, v25, v39
v_exp_f32 v32, v168
v_exp_f32 v33, v169
v_exp_f32 v34, v170
v_exp_f32 v35, v171
v_add_f32 v26, v32, v33
cvt v56,v32,v33
v_add_f32 v26, v26, v34
cvt v57,v34,v35
v_add_f32 v26, v26, v35
v_exp_f32 v36, v176
v_exp_f32 v37, v177
v_exp_f32 v38, v178
v_exp_f32 v39, v179
v_add_f32 v24, v24, v36
cvt v50,v36,v37
v_add_f32 v24, v24, v37
v_add_f32 v24, v24, v38
cvt v51,v38,v39
v_add_f32 v24, v24, v39
v_exp_f32 v32, v180
v_exp_f32 v33, v181
v_exp_f32 v34, v182
v_exp_f32 v35, v183
v_add_f32 v25, v25, v32
cvt v54,v32,v33
v_add_f32 v25, v25, v33
v_add_f32 v25, v25, v34
cvt v55,v34,v35
v_add_f32 v25, v25, v35
v_exp_f32 v36, v184
v_exp_f32 v37, v185
v_exp_f32 v38, v186
v_exp_f32 v39, v187
v_add_f32 v26, v26, v36
cvt v58,v36,v37
v_add_f32 v26, v26, v37
v_add_f32 v26, v26, v38
cvt v59,v38,v39
v_add_f32 v26, v26, v39
s_nop 3
s_setpc_b64 s[0:1]
s_endpgm
.section .rodata,"a"
.p2align 6
.amdhsa_kernel standalone__mha_block_cached__near_ridge_kernel
  .amdhsa_next_free_vgpr 512
  .amdhsa_next_free_sgpr 102
  .amdhsa_accum_offset 256
  .amdhsa_group_segment_fixed_size 0
  .amdhsa_kernarg_size 64
  .amdhsa_user_sgpr_count 2
  .amdhsa_user_sgpr_kernarg_segment_ptr 1
  .amdhsa_system_sgpr_workgroup_id_x 1
  .amdhsa_float_denorm_mode_32 3
.end_amdhsa_kernel
```
